```python
import torch

def _softmax(x, axis=-1):
    return torch.softmax(x, dim=axis)
def _gelu(x):
    return torch.nn.functional.gelu(x, approximate="tanh")
def _silu(x):
    return torch.nn.functional.silu(x)
def _sigmoid(x):
    return torch.sigmoid(x)
def _layernorm(x, axis=-1, eps=1e-5):
    m = x.mean(dim=axis, keepdim=True)
    v = x.var(dim=axis, keepdim=True, unbiased=False)
    return (x - m) / torch.sqrt(v + eps)
def _scatter_add(tgt, idx, src, axis=0):
    return tgt.clone().index_add_(axis, idx, src)
def _segment_sum(src, seg, n):
    out = torch.zeros((n,) + src.shape[1:], dtype=src.dtype)
    return out.index_add_(0, seg, src)
def _pad(x, pw):
    flat = tuple(v for pair in reversed(pw) for v in pair)
    return torch.nn.functional.pad(x, flat)

kernel_name = 'standalone__structured_sparse_n_m__ragged'

def setup_inputs():

    _w = (lambda a: (lambda t: t.to(torch.bfloat16) if t.is_floating_point() else t)(torch.as_tensor(a)))
    B, S, D = 16, 4096, 576
    assert D % 4 == 0, "d_model must be divisible by M=4 for 2:4 sparsity"
    return {
        "x": _w((lambda *s: torch.randn(*s, dtype=torch.bfloat16) * 0.05)(B, S, D)),
        "w": _w((lambda *s: torch.randn(*s, dtype=torch.bfloat16) * 0.05)(D, D)),
        "b": _w((lambda *s: torch.randn(*s, dtype=torch.bfloat16) * 0.05)(D)),
    }

def reference(x, w, b):
    B, S, D = x.shape
    N, M = 2, 4
    G = D // M
    wg = w.reshape(G, M, D)
    mag = torch.abs(wg)
    order = torch.argsort(mag, 1)
    thr = (lambda x, i, axis: torch.take_along_dim(x, i, dim=axis))(mag, order[:, M - N:M - N + 1, :], 1)
    mask = (lambda x, dt: x.to(dt))(mag >= thr, w.dtype)
    wp = (wg * mask).reshape(D, D)
    return torch.einsum("bsd,df->bsf", x, wp) + b
```

```asm
; @launch grid=(256,1,1) block=(256,1,1) lds=163840
.amdgcn_target "amdgcn-amd-amdhsa--gfx950"
.text
.globl standalone__structured_sparse_n_m__ragged_kernel
.p2align 8
.type standalone__structured_sparse_n_m__ragged_kernel,@function
standalone__structured_sparse_n_m__ragged_kernel:
s_cmp_ge_u32 s2, 256
s_cbranch_scc1 L_end_standalone__structured_sparse_n_m__ragged_kernel
s_load_dwordx8 s[4:11], s[0:1], 0
s_load_dwordx4 s[12:15], s[0:1], 32
v_lshrrev_b32 v1, 6, v0
v_and_b32 v7, 63, v0
v_readfirstlane_b32 s40, v1
s_mov_b32 s18, 75497472
s_mov_b32 s19, 0x20000
s_mov_b32 s22, 0
s_mov_b32 s23, 0x20000
s_mov_b32 s26, 301989888
s_mov_b32 s27, 0x20000
s_mov_b32 s30, 663552
s_mov_b32 s31, 0x20000
s_mov_b32 s34, 1152
s_mov_b32 s35, 0x20000
s_mov_b32 s38, 256
s_mov_b32 s39, 0x20000
s_mov_b32 s86, 0
s_mov_b32 s41, 3
s_lshr_b32 s84, s2, 3
s_mul_i32 s84, s84, 2
s_and_b32 s47, s2, 7
s_add_u32 s84, s84, s47
s_cmp_lt_u32 s47, 2
s_cselect_b32 s84, s84, 63
s_cmp_ge_u32 s84, 41
s_cbranch_scc1 L_cons
s_and_b32 s48, s84, 3
s_lshr_b32 s49, s84, 2
s_sub_u32 s50, s84, 36
s_lshl_b32 s51, s40, 4
s_lshl_b32 s52, s50, 1
s_lshl_b32 s53, s48, 8
s_cmp_lt_u32 s84, 36
s_cselect_b32 s52, s49, s52
s_cselect_b32 s53, s53, 1024
s_cselect_b32 s54, 8, 73728
s_cselect_b32 s55, 32, 8
s_cselect_b32 s56, 16, 32
s_cselect_b32 s57, 128, 64
s_mul_i32 s52, s52, 73728
s_mul_i32 s58, s40, 18432
v_and_b32 v58, 1, v7
v_bfe_u32 v59, v7, 1, 1
v_bfe_u32 v60, v7, 2, 2
v_bfe_u32 v62, v7, 4, 1
v_lshrrev_b32 v63, 5, v7
v_lshl_add_u32 v50, v58, 2, s52
v_mad_u32_u24 v50, v59, s54, v50
v_mad_u32_u24 v50, v60, s55, v50
v_mad_u32_u24 v50, v62, s56, v50
v_mad_u32_u24 v50, v63, s57, v50
v_add_u32 v50, s53, v50
v_add_u32 v50, s58, v50
v_add_u32 v62, 4608, v50
v_add_u32 v63, 9216, v50
v_add_u32 v64, 13824, v50
s_waitcnt lgkmcnt(0)
s_mov_b32 s28, s6
s_and_b32 s29, s7, 0xffff
buffer_load_dword v8, v50, s[28:31], 0 offen offset:0
buffer_load_dword v9, v50, s[28:31], 0 offen offset:1152
buffer_load_dword v10, v50, s[28:31], 0 offen offset:2304
buffer_load_dword v11, v50, s[28:31], 0 offen offset:3456
buffer_load_dword v12, v62, s[28:31], 0 offen offset:0
buffer_load_dword v13, v62, s[28:31], 0 offen offset:1152
buffer_load_dword v14, v62, s[28:31], 0 offen offset:2304
buffer_load_dword v15, v62, s[28:31], 0 offen offset:3456
buffer_load_dword v16, v63, s[28:31], 0 offen offset:0
buffer_load_dword v17, v63, s[28:31], 0 offen offset:1152
buffer_load_dword v18, v63, s[28:31], 0 offen offset:2304
buffer_load_dword v19, v63, s[28:31], 0 offen offset:3456
buffer_load_dword v20, v64, s[28:31], 0 offen offset:0
buffer_load_dword v21, v64, s[28:31], 0 offen offset:1152
buffer_load_dword v22, v64, s[28:31], 0 offen offset:2304
buffer_load_dword v23, v64, s[28:31], 0 offen offset:3456
s_mov_b32 s16, s4
s_and_b32 s17, s5, 0xffff
s_mov_b32 s24, s14
s_and_b32 s25, s15, 0xffff
s_mov_b32 s32, s8
s_and_b32 s33, s9, 0xffff
s_mov_b32 s20, s10
s_and_b32 s21, s11, 0xffff
s_mov_b32 s36, s12
s_and_b32 s37, s13, 0xffff
s_mul_i32 s52, s48, 9
s_add_u32 s52, s52, s49
s_mul_i32 s53, s52, 9
s_mul_i32 s54, s50, 18
s_add_u32 s54, s54, 8
s_lshl_b32 s55, s52, 2
s_add_u32 s55, s55, s40
s_lshl_b32 s56, s50, 2
s_add_u32 s56, s56, s40
s_cmp_eq_u32 s84, 40
s_cselect_b32 s57, 0x100000, 9
s_cmp_lt_u32 s84, 36
s_cselect_b32 s53, s53, s54
s_cselect_b32 s54, 2, 81
s_cselect_b32 s57, 1, s57
s_cselect_b32 s55, s55, s56
s_mov_b32 s56, 331776
s_cselect_b32 s56, s56, 368640
s_mov_b32 s58, 373760
s_cselect_b32 s58, s58, 382976
s_cselect_b32 s59, 16, 4
s_cselect_b32 s60, 4, 64
s_cselect_b32 s61, 12, 11
s_cselect_b32 s62, 0, 0x8000
v_lshrrev_b32 v61, 4, v7
v_lshlrev_b32 v62, 1, v58
v_lshl_add_u32 v60, v60, 2, v62
v_mul_u32_u24 v51, s54, v61
v_mad_u32_u24 v51, v59, s57, v51
v_add_lshl_u32 v51, v51, s53, 6
v_add3_u32 v51, v51, v60, s51
v_lshl_add_u32 v51, v51, 4, s86
s_lshl_b32 s52, s55, 8
s_add_u32 s52, s52, s56
s_add_u32 s52, s52, s86
v_add_u32 v62, v60, v59
v_mul_u32_u24 v52, s59, v62
v_mad_u32_u24 v52, v61, s60, v52
v_add_u32 v52, s52, v52
s_lshl_b32 s52, s55, 6
s_add_u32 s58, s58, s52
s_add_u32 s58, s58, s86
s_lshl_b32 s52, s51, 1
s_add_u32 s52, s52, s62
v_lshl_add_u32 v62, v61, 1, v59
v_lshlrev_b32 v62, s61, v62
v_lshl_add_u32 v53, v60, 7, v62
v_add_u32 v53, s52, v53
v_add_u32 v54, 128, v53
v_lshl_add_u32 v65, v7, 2, s58
s_mov_b32 s75, 0
s_mov_b32 s73, 0x05060100
v_mov_b32 v55, 0x05040100
v_mov_b32 v62, 0x03020706
v_cmp_eq_u32 vcc, 1, v59
v_mov_b32 v56, 0x0f0a0500
v_mov_b32 v57, 0xf0a05000
v_cndmask_b32 v55, v55, v62, vcc
s_mov_b32 s64, 0x5040500
s_mov_b32 s65, 0x5040501
s_mov_b32 s66, 0x5040502
s_mov_b32 s67, 0x5040503
s_mov_b32 s68, 0x7060700
s_mov_b32 s69, 0x7060701
s_mov_b32 s70, 0x7060702
s_mov_b32 s71, 0x7060703
s_mov_b32 s72, 0x05060102
s_waitcnt vmcnt(12)
v_perm_b32 v24, v8, v56, s64
v_perm_b32 v25, v9, v56, s65
v_perm_b32 v26, v10, v56, s66
v_perm_b32 v27, v11, v56, s67
v_max3_f32 v28, |v24|, |v25|, |v26|
v_med3_f32 v29, |v24|, |v25|, |v26|
v_min3_f32 v30, |v24|, |v25|, |v26|
v_med3_f32 v32, v28, v29, |v27|
v_med3_f32 v33, v29, v30, |v27|
v_max_f32 v31, v28, |v27|
v_cmp_eq_u32_sdwa vcc, v33, v32 src0_sel:WORD_1 src1_sel:WORD_1
v_perm_b32 v36, v31, v32, s72
v_bfi_b32 v44, 51, v32, v31
s_waitcnt vmcnt(0)
s_cbranch_vccnz L_tie0
L_tb0:
v_perm_b32 v24, v8, v56, s68
v_perm_b32 v25, v9, v56, s69
v_perm_b32 v26, v10, v56, s70
v_perm_b32 v27, v11, v56, s71
v_max3_f32 v28, |v24|, |v25|, |v26|
v_med3_f32 v29, |v24|, |v25|, |v26|
v_min3_f32 v30, |v24|, |v25|, |v26|
v_med3_f32 v32, v28, v29, |v27|
v_med3_f32 v33, v29, v30, |v27|
v_max_f32 v31, v28, |v27|
v_cmp_eq_u32_sdwa vcc, v33, v32 src0_sel:WORD_1 src1_sel:WORD_1
v_perm_b32 v40, v31, v32, s72
v_bfi_b32 v46, 51, v32, v31
s_cbranch_vccnz L_tie1
L_tb1:
v_perm_b32 v24, v12, v57, s64
v_perm_b32 v25, v13, v57, s65
v_perm_b32 v26, v14, v57, s66
v_perm_b32 v27, v15, v57, s67
v_max3_f32 v28, |v24|, |v25|, |v26|
v_med3_f32 v29, |v24|, |v25|, |v26|
v_min3_f32 v30, |v24|, |v25|, |v26|
v_med3_f32 v32, v28, v29, |v27|
v_med3_f32 v33, v29, v30, |v27|
v_max_f32 v31, v28, |v27|
v_cmp_eq_u32_sdwa vcc, v33, v32 src0_sel:WORD_1 src1_sel:WORD_1
v_perm_b32 v37, v31, v32, s72
v_bfi_b32 v31, 51, v32, v31
v_or_b32 v44, v44, v31
s_cbranch_vccnz L_tie2
L_tb2:
v_perm_b32 v24, v12, v57, s68
v_perm_b32 v25, v13, v57, s69
v_perm_b32 v26, v14, v57, s70
v_perm_b32 v27, v15, v57, s71
v_max3_f32 v28, |v24|, |v25|, |v26|
v_med3_f32 v29, |v24|, |v25|, |v26|
v_min3_f32 v30, |v24|, |v25|, |v26|
v_med3_f32 v32, v28, v29, |v27|
v_med3_f32 v33, v29, v30, |v27|
v_max_f32 v31, v28, |v27|
v_cmp_eq_u32_sdwa vcc, v33, v32 src0_sel:WORD_1 src1_sel:WORD_1
v_perm_b32 v41, v31, v32, s72
v_bfi_b32 v31, 51, v32, v31
v_or_b32 v46, v46, v31
s_cbranch_vccnz L_tie3
L_tb3:
v_perm_b32 v24, v16, v56, s64
v_perm_b32 v25, v17, v56, s65
v_perm_b32 v26, v18, v56, s66
v_perm_b32 v27, v19, v56, s67
v_max3_f32 v28, |v24|, |v25|, |v26|
v_med3_f32 v29, |v24|, |v25|, |v26|
v_min3_f32 v30, |v24|, |v25|, |v26|
v_med3_f32 v32, v28, v29, |v27|
v_med3_f32 v33, v29, v30, |v27|
v_max_f32 v31, v28, |v27|
v_cmp_eq_u32_sdwa vcc, v33, v32 src0_sel:WORD_1 src1_sel:WORD_1
v_perm_b32 v38, v31, v32, s72
v_bfi_b32 v45, 51, v32, v31
s_cbranch_vccnz L_tie4
L_tb4:
v_perm_b32 v24, v16, v56, s68
v_perm_b32 v25, v17, v56, s69
v_perm_b32 v26, v18, v56, s70
v_perm_b32 v27, v19, v56, s71
v_max3_f32 v28, |v24|, |v25|, |v26|
v_med3_f32 v29, |v24|, |v25|, |v26|
v_min3_f32 v30, |v24|, |v25|, |v26|
v_med3_f32 v32, v28, v29, |v27|
v_med3_f32 v33, v29, v30, |v27|
v_max_f32 v31, v28, |v27|
v_cmp_eq_u32_sdwa vcc, v33, v32 src0_sel:WORD_1 src1_sel:WORD_1
v_perm_b32 v42, v31, v32, s72
v_bfi_b32 v47, 51, v32, v31
s_cbranch_vccnz L_tie5
L_tb5:
v_perm_b32 v24, v20, v57, s64
v_perm_b32 v25, v21, v57, s65
v_perm_b32 v26, v22, v57, s66
v_perm_b32 v27, v23, v57, s67
v_max3_f32 v28, |v24|, |v25|, |v26|
v_med3_f32 v29, |v24|, |v25|, |v26|
v_min3_f32 v30, |v24|, |v25|, |v26|
v_med3_f32 v32, v28, v29, |v27|
v_med3_f32 v33, v29, v30, |v27|
v_max_f32 v31, v28, |v27|
v_cmp_eq_u32_sdwa vcc, v33, v32 src0_sel:WORD_1 src1_sel:WORD_1
v_perm_b32 v39, v31, v32, s72
v_bfi_b32 v31, 51, v32, v31
v_or_b32 v45, v45, v31
s_cbranch_vccnz L_tie6
L_tb6:
v_perm_b32 v24, v20, v57, s68
v_perm_b32 v25, v21, v57, s69
v_perm_b32 v26, v22, v57, s70
v_perm_b32 v27, v23, v57, s71
v_max3_f32 v28, |v24|, |v25|, |v26|
v_med3_f32 v29, |v24|, |v25|, |v26|
v_min3_f32 v30, |v24|, |v25|, |v26|
v_med3_f32 v32, v28, v29, |v27|
v_med3_f32 v33, v29, v30, |v27|
v_max_f32 v31, v28, |v27|
v_cmp_eq_u32_sdwa vcc, v33, v32 src0_sel:WORD_1 src1_sel:WORD_1
v_perm_b32 v43, v31, v32, s72
v_bfi_b32 v31, 51, v32, v31
v_or_b32 v47, v47, v31
s_cbranch_vccnz L_tie7
L_tb7:
buffer_store_dwordx4 v[36:39], v51, s[24:27], 0 offen sc1
s_mov_b32 s52, 0x0c0c0400
s_mov_b32 s53, 0x04000c0c
v_perm_b32 v48, v45, v44, s52
v_perm_b32 v49, v47, v46, s53
v_or_b32 v48, v48, v49
buffer_store_dwordx4 v[40:43], v51, s[24:27], 0 offen offset:16 sc1
s_cmp_gt_u32 s75, 15
s_cselect_b32 s52, -1, 0
s_min_u32 s75, s75, 15
s_lshl_b32 s53, -1, s75
v_mov_b32 v62, s52
v_mov_b32_dpp v49, v48 quad_perm:[2,3,0,1] row_mask:0xf bank_mask:0xf
v_perm_b32 v48, v49, v48, v55
buffer_store_dword v48, v52, s[24:27], 0 offen sc1
s_and_b32 exec_lo, s53, 0xffff
s_mov_b32 exec_hi, 0
buffer_store_dword v62, v65, s[24:27], 0 offen sc1
s_mov_b64 exec, -1
s_waitcnt vmcnt(0)
s_barrier
s_cmp_lg_u32 s40, 0
s_cbranch_scc1 L_cons2
v_mov_b32 v8, 1
s_mov_b64 exec, 1
buffer_atomic_add v8, off, s[36:39], 0 offset:128 sc0 sc1
v_mov_b32 v9, 1
s_waitcnt vmcnt(0)
v_readfirstlane_b32 s47, v8
s_nop 3
s_cmp_lg_u32 s47, 40
s_cbranch_scc1 L_notlast
buffer_store_dword v9, off, s[36:39], 0 sc1
L_notlast:
s_mov_b64 exec, -1
L_cons2:
v_lshrrev_b32 v72, 3, v7
v_and_b32 v73, 7, v7
v_xor_b32 v73, v73, v72
v_mul_u32_u24 v72, 1152, v72
s_and_b32 s47, s40, 1
s_mul_i32 s47, s47, 9216
s_lshr_b32 s3, s40, 1
s_lshl_b32 s3, s3, 7
s_add_u32 s47, s47, s3
v_lshl_add_u32 v72, v73, 4, v72
v_add_u32 v3, s47, v72
s_lshl_b32 s44, s40, 10
s_mul_i32 s45, s2, 18432
s_mov_b32 s46, s45
s_branch L_cons3
L_tie0:
s_mov_b64 exec, vcc
v_cmp_lt_u32 vcc, 0xffff, v33
v_min_f32 v30, v30, |v27|
v_perm_b32 v63, v33, v53, s73
v_bfe_u32 v62, v33, 0, 2
v_lshl_add_u32 v63, v62, 1, v63
v_mbcnt_lo_u32_b32 v62, vcc_lo, 0
v_mbcnt_hi_u32_b32 v62, vcc_hi, v62
v_add_u32 v63, 0, v63
v_add_u32 v62, s75, v62
s_bcnt1_i32_b64 s52, vcc
s_add_u32 s75, s75, s52
s_mov_b64 s[48:49], vcc
s_mov_b64 exec, vcc
v_cmp_gt_u32 vcc, 15, v62
v_lshl_add_u32 v62, v62, 2, s58
s_nop 0
s_mov_b64 exec, vcc
s_cbranch_execz L_ts00
buffer_store_dword v63, v62, s[24:27], 0 offen sc1
L_ts00:
s_mov_b64 exec, s[48:49]
v_cmp_eq_u32_sdwa vcc, v30, v33 src0_sel:WORD_1 src1_sel:WORD_1
s_nop 4
s_cbranch_vccz L_te0
v_perm_b32 v63, v30, v53, s73
v_bfe_u32 v62, v30, 0, 2
v_lshl_add_u32 v63, v62, 1, v63
v_mbcnt_lo_u32_b32 v62, vcc_lo, 0
v_mbcnt_hi_u32_b32 v62, vcc_hi, v62
v_add_u32 v63, 0, v63
v_add_u32 v62, s75, v62
s_bcnt1_i32_b64 s52, vcc
s_add_u32 s75, s75, s52
s_mov_b64 s[48:49], vcc
s_mov_b64 exec, vcc
v_cmp_gt_u32 vcc, 15, v62
v_lshl_add_u32 v62, v62, 2, s58
s_nop 0
s_mov_b64 exec, vcc
s_cbranch_execz L_ts01
buffer_store_dword v63, v62, s[24:27], 0 offen sc1
L_ts01:
L_te0:
s_mov_b64 exec, -1
s_branch L_tb0
L_tie1:
s_mov_b64 exec, vcc
v_cmp_lt_u32 vcc, 0xffff, v33
v_min_f32 v30, v30, |v27|
v_perm_b32 v63, v33, v54, s73
v_bfe_u32 v62, v33, 0, 2
v_lshl_add_u32 v63, v62, 1, v63
v_mbcnt_lo_u32_b32 v62, vcc_lo, 0
v_mbcnt_hi_u32_b32 v62, vcc_hi, v62
v_add_u32 v63, 0, v63
v_add_u32 v62, s75, v62
s_bcnt1_i32_b64 s52, vcc
s_add_u32 s75, s75, s52
s_mov_b64 s[48:49], vcc
s_mov_b64 exec, vcc
v_cmp_gt_u32 vcc, 15, v62
v_lshl_add_u32 v62, v62, 2, s58
s_nop 0
s_mov_b64 exec, vcc
s_cbranch_execz L_ts10
buffer_store_dword v63, v62, s[24:27], 0 offen sc1
L_ts10:
s_mov_b64 exec, s[48:49]
v_cmp_eq_u32_sdwa vcc, v30, v33 src0_sel:WORD_1 src1_sel:WORD_1
s_nop 4
s_cbranch_vccz L_te1
v_perm_b32 v63, v30, v54, s73
v_bfe_u32 v62, v30, 0, 2
v_lshl_add_u32 v63, v62, 1, v63
v_mbcnt_lo_u32_b32 v62, vcc_lo, 0
v_mbcnt_hi_u32_b32 v62, vcc_hi, v62
v_add_u32 v63, 0, v63
v_add_u32 v62, s75, v62
s_bcnt1_i32_b64 s52, vcc
s_add_u32 s75, s75, s52
s_mov_b64 s[48:49], vcc
s_mov_b64 exec, vcc
v_cmp_gt_u32 vcc, 15, v62
v_lshl_add_u32 v62, v62, 2, s58
s_nop 0
s_mov_b64 exec, vcc
s_cbranch_execz L_ts11
buffer_store_dword v63, v62, s[24:27], 0 offen sc1
L_ts11:
L_te1:
s_mov_b64 exec, -1
s_branch L_tb1
L_tie2:
s_mov_b64 exec, vcc
v_cmp_lt_u32 vcc, 0xffff, v33
v_min_f32 v30, v30, |v27|
v_perm_b32 v63, v33, v53, s73
v_bfe_u32 v62, v33, 4, 2
v_lshl_add_u32 v63, v62, 1, v63
v_mbcnt_lo_u32_b32 v62, vcc_lo, 0
v_mbcnt_hi_u32_b32 v62, vcc_hi, v62
v_add_u32 v63, 8, v63
v_add_u32 v62, s75, v62
s_bcnt1_i32_b64 s52, vcc
s_add_u32 s75, s75, s52
s_mov_b64 s[48:49], vcc
s_mov_b64 exec, vcc
v_cmp_gt_u32 vcc, 15, v62
v_lshl_add_u32 v62, v62, 2, s58
s_nop 0
s_mov_b64 exec, vcc
s_cbranch_execz L_ts20
buffer_store_dword v63, v62, s[24:27], 0 offen sc1
L_ts20:
s_mov_b64 exec, s[48:49]
v_cmp_eq_u32_sdwa vcc, v30, v33 src0_sel:WORD_1 src1_sel:WORD_1
s_nop 4
s_cbranch_vccz L_te2
v_perm_b32 v63, v30, v53, s73
v_bfe_u32 v62, v30, 4, 2
v_lshl_add_u32 v63, v62, 1, v63
v_mbcnt_lo_u32_b32 v62, vcc_lo, 0
v_mbcnt_hi_u32_b32 v62, vcc_hi, v62
v_add_u32 v63, 8, v63
v_add_u32 v62, s75, v62
s_bcnt1_i32_b64 s52, vcc
s_add_u32 s75, s75, s52
s_mov_b64 s[48:49], vcc
s_mov_b64 exec, vcc
v_cmp_gt_u32 vcc, 15, v62
v_lshl_add_u32 v62, v62, 2, s58
s_nop 0
s_mov_b64 exec, vcc
s_cbranch_execz L_ts21
buffer_store_dword v63, v62, s[24:27], 0 offen sc1
L_ts21:
L_te2:
s_mov_b64 exec, -1
s_branch L_tb2
L_tie3:
s_mov_b64 exec, vcc
v_cmp_lt_u32 vcc, 0xffff, v33
v_min_f32 v30, v30, |v27|
v_perm_b32 v63, v33, v54, s73
v_bfe_u32 v62, v33, 4, 2
v_lshl_add_u32 v63, v62, 1, v63
v_mbcnt_lo_u32_b32 v62, vcc_lo, 0
v_mbcnt_hi_u32_b32 v62, vcc_hi, v62
v_add_u32 v63, 8, v63
v_add_u32 v62, s75, v62
s_bcnt1_i32_b64 s52, vcc
s_add_u32 s75, s75, s52
s_mov_b64 s[48:49], vcc
s_mov_b64 exec, vcc
v_cmp_gt_u32 vcc, 15, v62
v_lshl_add_u32 v62, v62, 2, s58
s_nop 0
s_mov_b64 exec, vcc
s_cbranch_execz L_ts30
buffer_store_dword v63, v62, s[24:27], 0 offen sc1
L_ts30:
s_mov_b64 exec, s[48:49]
v_cmp_eq_u32_sdwa vcc, v30, v33 src0_sel:WORD_1 src1_sel:WORD_1
s_nop 4
s_cbranch_vccz L_te3
v_perm_b32 v63, v30, v54, s73
v_bfe_u32 v62, v30, 4, 2
v_lshl_add_u32 v63, v62, 1, v63
v_mbcnt_lo_u32_b32 v62, vcc_lo, 0
v_mbcnt_hi_u32_b32 v62, vcc_hi, v62
v_add_u32 v63, 8, v63
v_add_u32 v62, s75, v62
s_bcnt1_i32_b64 s52, vcc
s_add_u32 s75, s75, s52
s_mov_b64 s[48:49], vcc
s_mov_b64 exec, vcc
v_cmp_gt_u32 vcc, 15, v62
v_lshl_add_u32 v62, v62, 2, s58
s_nop 0
s_mov_b64 exec, vcc
s_cbranch_execz L_ts31
buffer_store_dword v63, v62, s[24:27], 0 offen sc1
L_ts31:
L_te3:
s_mov_b64 exec, -1
s_branch L_tb3
L_tie4:
s_mov_b64 exec, vcc
v_cmp_lt_u32 vcc, 0xffff, v33
v_min_f32 v30, v30, |v27|
v_perm_b32 v63, v33, v53, s73
v_bfe_u32 v62, v33, 0, 2
v_lshl_add_u32 v63, v62, 1, v63
v_mbcnt_lo_u32_b32 v62, vcc_lo, 0
v_mbcnt_hi_u32_b32 v62, vcc_hi, v62
v_add_u32 v63, 16, v63
v_add_u32 v62, s75, v62
s_bcnt1_i32_b64 s52, vcc
s_add_u32 s75, s75, s52
s_mov_b64 s[48:49], vcc
s_mov_b64 exec, vcc
v_cmp_gt_u32 vcc, 15, v62
v_lshl_add_u32 v62, v62, 2, s58
s_nop 0
s_mov_b64 exec, vcc
s_cbranch_execz L_ts40
buffer_store_dword v63, v62, s[24:27], 0 offen sc1
L_ts40:
s_mov_b64 exec, s[48:49]
v_cmp_eq_u32_sdwa vcc, v30, v33 src0_sel:WORD_1 src1_sel:WORD_1
s_nop 4
s_cbranch_vccz L_te4
v_perm_b32 v63, v30, v53, s73
v_bfe_u32 v62, v30, 0, 2
v_lshl_add_u32 v63, v62, 1, v63
v_mbcnt_lo_u32_b32 v62, vcc_lo, 0
v_mbcnt_hi_u32_b32 v62, vcc_hi, v62
v_add_u32 v63, 16, v63
v_add_u32 v62, s75, v62
s_bcnt1_i32_b64 s52, vcc
s_add_u32 s75, s75, s52
s_mov_b64 s[48:49], vcc
s_mov_b64 exec, vcc
v_cmp_gt_u32 vcc, 15, v62
v_lshl_add_u32 v62, v62, 2, s58
s_nop 0
s_mov_b64 exec, vcc
s_cbranch_execz L_ts41
buffer_store_dword v63, v62, s[24:27], 0 offen sc1
L_ts41:
L_te4:
s_mov_b64 exec, -1
s_branch L_tb4
L_tie5:
s_mov_b64 exec, vcc
v_cmp_lt_u32 vcc, 0xffff, v33
v_min_f32 v30, v30, |v27|
v_perm_b32 v63, v33, v54, s73
v_bfe_u32 v62, v33, 0, 2
v_lshl_add_u32 v63, v62, 1, v63
v_mbcnt_lo_u32_b32 v62, vcc_lo, 0
v_mbcnt_hi_u32_b32 v62, vcc_hi, v62
v_add_u32 v63, 16, v63
v_add_u32 v62, s75, v62
s_bcnt1_i32_b64 s52, vcc
s_add_u32 s75, s75, s52
s_mov_b64 s[48:49], vcc
s_mov_b64 exec, vcc
v_cmp_gt_u32 vcc, 15, v62
v_lshl_add_u32 v62, v62, 2, s58
s_nop 0
s_mov_b64 exec, vcc
s_cbranch_execz L_ts50
buffer_store_dword v63, v62, s[24:27], 0 offen sc1
L_ts50:
s_mov_b64 exec, s[48:49]
v_cmp_eq_u32_sdwa vcc, v30, v33 src0_sel:WORD_1 src1_sel:WORD_1
s_nop 4
s_cbranch_vccz L_te5
v_perm_b32 v63, v30, v54, s73
v_bfe_u32 v62, v30, 0, 2
v_lshl_add_u32 v63, v62, 1, v63
v_mbcnt_lo_u32_b32 v62, vcc_lo, 0
v_mbcnt_hi_u32_b32 v62, vcc_hi, v62
v_add_u32 v63, 16, v63
v_add_u32 v62, s75, v62
s_bcnt1_i32_b64 s52, vcc
s_add_u32 s75, s75, s52
s_mov_b64 s[48:49], vcc
s_mov_b64 exec, vcc
v_cmp_gt_u32 vcc, 15, v62
v_lshl_add_u32 v62, v62, 2, s58
s_nop 0
s_mov_b64 exec, vcc
s_cbranch_execz L_ts51
buffer_store_dword v63, v62, s[24:27], 0 offen sc1
L_ts51:
L_te5:
s_mov_b64 exec, -1
s_branch L_tb5
L_tie6:
s_mov_b64 exec, vcc
v_cmp_lt_u32 vcc, 0xffff, v33
v_min_f32 v30, v30, |v27|
v_perm_b32 v63, v33, v53, s73
v_bfe_u32 v62, v33, 4, 2
v_lshl_add_u32 v63, v62, 1, v63
v_mbcnt_lo_u32_b32 v62, vcc_lo, 0
v_mbcnt_hi_u32_b32 v62, vcc_hi, v62
v_add_u32 v63, 24, v63
v_add_u32 v62, s75, v62
s_bcnt1_i32_b64 s52, vcc
s_add_u32 s75, s75, s52
s_mov_b64 s[48:49], vcc
s_mov_b64 exec, vcc
v_cmp_gt_u32 vcc, 15, v62
v_lshl_add_u32 v62, v62, 2, s58
s_nop 0
s_mov_b64 exec, vcc
s_cbranch_execz L_ts60
buffer_store_dword v63, v62, s[24:27], 0 offen sc1
L_ts60:
s_mov_b64 exec, s[48:49]
v_cmp_eq_u32_sdwa vcc, v30, v33 src0_sel:WORD_1 src1_sel:WORD_1
s_nop 4
s_cbranch_vccz L_te6
v_perm_b32 v63, v30, v53, s73
v_bfe_u32 v62, v30, 4, 2
v_lshl_add_u32 v63, v62, 1, v63
v_mbcnt_lo_u32_b32 v62, vcc_lo, 0
v_mbcnt_hi_u32_b32 v62, vcc_hi, v62
v_add_u32 v63, 24, v63
v_add_u32 v62, s75, v62
s_bcnt1_i32_b64 s52, vcc
s_add_u32 s75, s75, s52
s_mov_b64 s[48:49], vcc
s_mov_b64 exec, vcc
v_cmp_gt_u32 vcc, 15, v62
v_lshl_add_u32 v62, v62, 2, s58
s_nop 0
s_mov_b64 exec, vcc
s_cbranch_execz L_ts61
buffer_store_dword v63, v62, s[24:27], 0 offen sc1
L_ts61:
L_te6:
s_mov_b64 exec, -1
s_branch L_tb6
L_tie7:
s_mov_b64 exec, vcc
v_cmp_lt_u32 vcc, 0xffff, v33
v_min_f32 v30, v30, |v27|
v_perm_b32 v63, v33, v54, s73
v_bfe_u32 v62, v33, 4, 2
v_lshl_add_u32 v63, v62, 1, v63
v_mbcnt_lo_u32_b32 v62, vcc_lo, 0
v_mbcnt_hi_u32_b32 v62, vcc_hi, v62
v_add_u32 v63, 24, v63
v_add_u32 v62, s75, v62
s_bcnt1_i32_b64 s52, vcc
s_add_u32 s75, s75, s52
s_mov_b64 s[48:49], vcc
s_mov_b64 exec, vcc
v_cmp_gt_u32 vcc, 15, v62
v_lshl_add_u32 v62, v62, 2, s58
s_nop 0
s_mov_b64 exec, vcc
s_cbranch_execz L_ts70
buffer_store_dword v63, v62, s[24:27], 0 offen sc1
L_ts70:
s_mov_b64 exec, s[48:49]
v_cmp_eq_u32_sdwa vcc, v30, v33 src0_sel:WORD_1 src1_sel:WORD_1
s_nop 4
s_cbranch_vccz L_te7
v_perm_b32 v63, v30, v54, s73
v_bfe_u32 v62, v30, 4, 2
v_lshl_add_u32 v63, v62, 1, v63
v_mbcnt_lo_u32_b32 v62, vcc_lo, 0
v_mbcnt_hi_u32_b32 v62, vcc_hi, v62
v_add_u32 v63, 24, v63
v_add_u32 v62, s75, v62
s_bcnt1_i32_b64 s52, vcc
s_add_u32 s75, s75, s52
s_mov_b64 s[48:49], vcc
s_mov_b64 exec, vcc
v_cmp_gt_u32 vcc, 15, v62
v_lshl_add_u32 v62, v62, 2, s58
s_nop 0
s_mov_b64 exec, vcc
s_cbranch_execz L_ts71
buffer_store_dword v63, v62, s[24:27], 0 offen sc1
L_ts71:
L_te7:
s_mov_b64 exec, -1
s_branch L_tb7
L_cons:
v_lshrrev_b32 v72, 3, v7
v_and_b32 v73, 7, v7
v_xor_b32 v73, v73, v72
v_mul_u32_u24 v72, 1152, v72
s_and_b32 s47, s40, 1
s_mul_i32 s47, s47, 9216
s_lshr_b32 s3, s40, 1
s_lshl_b32 s3, s3, 7
s_add_u32 s47, s47, s3
v_lshl_add_u32 v72, v73, 4, v72
v_add_u32 v3, s47, v72
s_lshl_b32 s44, s40, 10
s_mul_i32 s45, s2, 18432
s_mov_b32 s46, s45
s_waitcnt lgkmcnt(0)
s_mov_b32 s28, s6
s_and_b32 s29, s7, 0xffff
s_mov_b32 s16, s4
s_and_b32 s17, s5, 0xffff
s_mov_b32 s24, s14
s_and_b32 s25, s15, 0xffff
s_mov_b32 s32, s8
s_and_b32 s33, s9, 0xffff
s_mov_b32 s20, s10
s_and_b32 s21, s11, 0xffff
s_mov_b32 s36, s12
s_and_b32 s37, s13, 0xffff
L_cons3:
s_lshr_b32 s47, s40, 1
s_lshl_b32 s3, s47, 11
s_sub_u32 s8, 15488, s3
s_lshl_b32 s3, s47, 7
s_add_u32 s7, s45, 128
s_sub_u32 s7, s7, s3
s_sub_u32 s10, s47, 1
s_sub_u32 s11, 0, s47
s_mov_b32 s9, s44
v_and_b32 v80, 3, v7
v_bfe_u32 v81, v7, 2, 2
v_bfe_u32 v82, v7, 4, 1
v_lshlrev_b32 v81, 3, v81
v_lshl_add_u32 v81, v80, 5, v81
v_lshl_add_u32 v81, v82, 7, v81
s_lshl_b32 s47, s40, 8
v_add_u32 v81, s47, v81
s_lshl_b32 s47, s40, 5
s_add_u32 s47, s47, 1024
v_lshl_add_u32 v80, v80, 3, s47
v_cmp_gt_u32 vcc, 32, v7
s_nop 1
v_cndmask_b32 v80, v80, v81, vcc
buffer_load_dwordx2 v[84:85], v80, s[32:35], 0 offen
s_mov_b32 s41, 3
L_pf:
s_add_u32 m0, s44, 0
s_nop 0
buffer_load_dwordx4 v3, s[16:19], s45 offen offset:0 nt lds
s_add_u32 m0, s44, 3840
s_nop 0
buffer_load_dwordx4 v3, s[16:19], s45 offen offset:256 nt lds
s_add_u32 m0, s44, 7680
s_nop 0
buffer_load_dwordx4 v3, s[16:19], s45 offen offset:512 nt lds
s_add_u32 m0, s44, 11520
s_nop 0
buffer_load_dwordx4 v3, s[16:19], s45 offen offset:768 nt lds
s_add_u32 m0, s44, s8
s_mov_b64 exec, s[10:11]
buffer_load_dwordx4 v3, s[16:19], s7 offen offset:896 nt lds
s_mov_b64 exec, -1
s_add_u32 s7, s7, 4718592
s_add_u32 s44, s44, 18432
s_add_u32 s45, s45, 4718592
s_sub_u32 s41, s41, 1
s_cmp_lg_u32 s41, 0
s_cbranch_scc1 L_pf
v_and_b32 v72, 15, v7
v_lshrrev_b32 v73, 4, v7
v_and_b32 v74, 7, v7
v_xor_b32 v74, v74, v73
v_lshlrev_b32 v74, 4, v74
v_lshl_add_u32 v0, v72, 7, v74
v_xor_b32 v1, 64, v0
s_lshl_b32 s47, s40, 10
s_add_u32 s47, s47, 147456
v_lshl_add_u32 v2, v73, 4, s47
v_and_b32 v74, 14, v7
v_mul_u32_u24 v4, 1152, v74
v_and_b32 v74, 1, v7
v_lshl_add_u32 v4, v74, 4, v4
v_lshl_add_u32 v4, v73, 5, v4
s_lshl_b32 s47, s40, 8
v_add_u32 v4, s47, v4
s_lshl_b32 s47, s40, 5
s_add_u32 s47, s47, 1024
v_lshrrev_b32 v72, 2, v7
v_and_b32 v73, 3, v7
v_lshl_add_u32 v6, v73, 4, v72
v_lshlrev_b32 v6, 2, v6
v_mul_u32_u24 v5, 1152, v72
v_lshl_add_u32 v5, v73, 3, v5
v_add_u32 v5, s47, v5
s_mov_b32 s80, 0x55555555
s_mov_b32 s81, 0x55555555
s_mov_b32 s82, 0xaaaaaaaa
s_mov_b32 s83, 0xaaaaaaaa
s_mul_i32 s47, s40, 2816
s_add_u32 s47, s47, 151552
v_lshl_add_u32 v88, v7, 4, s47
v_lshl_add_u32 v89, v7, 2, s47
v_mov_b32 v76, 0
v_mov_b32 v77, 0
v_mov_b32 v78, 0
v_mov_b32 v79, 0
v_mov_b32 v90, 0xdddddddd
ds_write_b128 v88, v[76:79]
ds_write_b32 v89, v90 offset:1024
ds_write_b32 v89, v90 offset:1280
ds_write_b32 v89, v90 offset:1536
ds_write_b32 v89, v90 offset:1792
ds_write_b32 v89, v90 offset:2048
ds_write_b32 v89, v90 offset:2304
ds_write_b32 v89, v90 offset:2560
s_lshl_b32 s47, s40, 2
s_add_u32 s47, s47, 163072
v_mov_b32 v88, s47
ds_write_b32 v88, v76
s_waitcnt vmcnt(15)
v_lshlrev_b32 v76, 16, v84
v_and_b32 v77, 0xffff0000, v84
v_lshlrev_b32 v78, 16, v85
v_and_b32 v79, 0xffff0000, v85
s_lshl_b32 s47, s40, 10
s_add_u32 s47, s47, 147456
v_lshl_add_u32 v80, v7, 4, s47
s_mov_b32 exec_hi, 15
ds_write_b128 v80, v[76:79]
s_mov_b64 exec, -1
s_mul_i32 s47, s40, 2304
s_add_u32 s47, s47, 373760
v_lshl_add_u32 v72, v7, 6, s47
s_mov_b32 s47, 380672
v_lshl_add_u32 v73, v7, 6, s47
v_lshrrev_b32 v74, 2, v7
v_cmp_gt_u32 vcc, 36, v7
v_lshlrev_b32 v90, 11, v74
v_subrev_u32 v74, 9, v74
v_lshlrev_b32 v74, 12, v74
v_cndmask_b32 v72, v73, v72, vcc
v_cndmask_b32 v90, v74, v90, vcc
v_cmp_gt_u32 vcc, 56, v7
v_mov_b32 v73, 0x40000000
s_lshr_b32 s47, s2, 3
s_lshl_b32 s47, s47, 2
s_add_u32 s47, s47, s40
s_mul_i32 s47, s47, 3072
v_cndmask_b32 v72, v73, v72, vcc
v_lshl_add_u32 v94, v7, 4, s47
s_mul_i32 s47, s40, 82944
s_add_u32 s47, s47, s86
v_lshl_add_u32 v104, v7, 4, s47
s_mul_i32 s47, s40, 9216
s_add_u32 s47, s47, s86
s_add_u32 s47, s47, 331776
v_lshl_add_u32 v105, v7, 4, s47
s_lshl_b32 s47, s40, 6
s_add_u32 s47, s47, s86
s_add_u32 s47, s47, 368640
v_and_b32 v106, 15, v7
v_lshl_add_u32 v106, v106, 2, s47
v_lshrrev_b32 v107, 4, v7
v_lshl_add_u32 v106, v107, 8, v106
s_mul_i32 s93, s40, 2816
s_add_u32 s93, s93, 151552
s_add_u32 s94, s40, 8
v_mov_b32 v89, 1
v_lshl_add_u32 v91, v7, 2, s93
v_and_b32 v74, 15, v7
v_and_b32 v73, 7, v7
v_lshlrev_b32 v73, 4, v73
v_lshl_add_u32 v93, v74, 7, v73
v_lshl_or_b32 v93, v93, 16, v93
s_add_u32 s96, s93, 256
s_add_u32 s97, s93, 1024
s_cmp_lg_u32 s40, 0
s_cbranch_scc1 L_ready
s_mov_b64 exec, 1
s_mov_b32 s3, 20000
L_poll:
buffer_load_dword v8, off, s[36:39], 0 sc1
s_sub_u32 s3, s3, 1
s_cbranch_scc1 L_giveup
s_waitcnt vmcnt(0)
v_readfirstlane_b32 s47, v8
s_nop 3
s_cmp_eq_u32 s47, 0
s_cbranch_scc1 L_poll
L_polled:
s_mov_b64 exec, -1
L_ready:
s_waitcnt lgkmcnt(0)
s_barrier
buffer_load_dwordx4 v[8:11], v72, s[24:27], 0 offen offset:0 sc1
buffer_load_dwordx4 v[12:15], v72, s[24:27], 0 offen offset:16 sc1
buffer_load_dwordx4 v[16:19], v72, s[24:27], 0 offen offset:32 sc1
buffer_load_dwordx4 v[20:23], v72, s[24:27], 0 offen offset:48 sc1
buffer_load_dwordx4 v[76:79], v94, s[24:27], 0 offen offset:0 sc1
buffer_load_dwordx4 v[80:83], v94, s[24:27], 0 offen offset:1024 sc1
buffer_load_dwordx4 v[84:87], v94, s[24:27], 0 offen offset:2048 sc1
buffer_load_dword v174, v106, s[24:27], 0 offen offset:0 sc1
buffer_load_dword v175, v106, s[24:27], 0 offen offset:1024 sc1
buffer_load_dword v176, v106, s[24:27], 0 offen offset:2048 sc1
buffer_load_dword v177, v106, s[24:27], 0 offen offset:3072 sc1
s_mov_b32 s99, 4096
buffer_load_dword v178, v106, s[24:27], s99 offen offset:0 sc1
s_mov_b32 s98, 0
buffer_load_dwordx4 v[138:141], v105, s[24:27], s98 offen sc1
s_mov_b32 s99, 0
buffer_load_dwordx4 a[0:3], v104, s[24:27], s99 offen offset:0 sc1
buffer_load_dwordx4 a[4:7], v104, s[24:27], s99 offen offset:1024 sc1
buffer_load_dwordx4 a[8:11], v104, s[24:27], s99 offen offset:2048 sc1
s_waitcnt vmcnt(12)
v_cmp_ne_u32 s[90:91], 0, v23
v_cmp_ne_u32 s[78:79], 0, v16
v_bfe_u32 v72, v8, 12, 4
v_cmp_ne_u32 s[48:49], 0, v8
v_cmp_eq_u32 vcc, s94, v72
v_min_u32 v72, 8, v72
v_lshl_add_u32 v24, v72, 2, s93
s_and_b32 s49, s49, 15
s_or_b32 s49, s49, vcc_hi
s_mov_b64 exec, s[48:49]
ds_add_rtn_u32 v40, v24, v89
s_mov_b64 exec, -1
buffer_load_dwordx4 a[12:15], v104, s[24:27], s99 offen offset:3072 sc1
v_bfe_u32 v72, v9, 12, 4
v_cmp_ne_u32 s[50:51], 0, v9
v_cmp_eq_u32 vcc, s94, v72
v_min_u32 v72, 8, v72
v_lshl_add_u32 v25, v72, 2, s93
s_and_b32 s51, s51, 15
s_or_b32 s51, s51, vcc_hi
s_mov_b64 exec, s[50:51]
ds_add_rtn_u32 v41, v25, v89
s_mov_b64 exec, -1
s_mov_b32 s99, 4096
buffer_load_dwordx4 a[16:19], v104, s[24:27], s99 offen offset:0 sc1
v_bfe_u32 v72, v10, 12, 4
v_cmp_ne_u32 s[52:53], 0, v10
v_cmp_eq_u32 vcc, s94, v72
v_min_u32 v72, 8, v72
v_lshl_add_u32 v26, v72, 2, s93
s_and_b32 s53, s53, 15
s_or_b32 s53, s53, vcc_hi
s_mov_b64 exec, s[52:53]
ds_add_rtn_u32 v42, v26, v89
s_mov_b64 exec, -1
buffer_load_dwordx4 a[20:23], v104, s[24:27], s99 offen offset:1024 sc1
v_bfe_u32 v72, v11, 12, 4
v_cmp_ne_u32 s[54:55], 0, v11
v_cmp_eq_u32 vcc, s94, v72
v_min_u32 v72, 8, v72
v_lshl_add_u32 v27, v72, 2, s93
s_and_b32 s55, s55, 15
s_or_b32 s55, s55, vcc_hi
s_mov_b64 exec, s[54:55]
ds_add_rtn_u32 v43, v27, v89
s_mov_b64 exec, -1
buffer_load_dwordx4 a[24:27], v104, s[24:27], s99 offen offset:2048 sc1
v_bfe_u32 v72, v12, 12, 4
v_cmp_ne_u32 s[56:57], 0, v12
v_cmp_eq_u32 vcc, s94, v72
v_min_u32 v72, 8, v72
v_lshl_add_u32 v28, v72, 2, s93
s_and_b32 s57, s57, 15
s_or_b32 s57, s57, vcc_hi
s_mov_b64 exec, s[56:57]
ds_add_rtn_u32 v44, v28, v89
s_mov_b64 exec, -1
buffer_load_dwordx4 a[28:31], v104, s[24:27], s99 offen offset:3072 sc1
v_bfe_u32 v72, v13, 12, 4
v_cmp_ne_u32 s[58:59], 0, v13
v_cmp_eq_u32 vcc, s94, v72
v_min_u32 v72, 8, v72
v_lshl_add_u32 v29, v72, 2, s93
s_and_b32 s59, s59, 15
s_or_b32 s59, s59, vcc_hi
s_mov_b64 exec, s[58:59]
ds_add_rtn_u32 v45, v29, v89
s_mov_b64 exec, -1
s_mov_b32 s99, 8192
buffer_load_dwordx4 a[32:35], v104, s[24:27], s99 offen offset:0 sc1
v_bfe_u32 v72, v14, 12, 4
v_cmp_ne_u32 s[60:61], 0, v14
v_cmp_eq_u32 vcc, s94, v72
v_min_u32 v72, 8, v72
v_lshl_add_u32 v30, v72, 2, s93
s_and_b32 s61, s61, 15
s_or_b32 s61, s61, vcc_hi
s_mov_b64 exec, s[60:61]
ds_add_rtn_u32 v46, v30, v89
s_mov_b64 exec, -1
s_mov_b32 s98, 1024
buffer_load_dwordx4 v[142:145], v105, s[24:27], s98 offen sc1
buffer_load_dwordx4 a[36:39], v104, s[24:27], s99 offen offset:1024 sc1
v_bfe_u32 v72, v15, 12, 4
v_cmp_ne_u32 s[62:63], 0, v15
v_cmp_eq_u32 vcc, s94, v72
v_min_u32 v72, 8, v72
v_lshl_add_u32 v31, v72, 2, s93
s_and_b32 s63, s63, 15
s_or_b32 s63, s63, vcc_hi
s_mov_b64 exec, s[62:63]
ds_add_rtn_u32 v47, v31, v89
s_mov_b64 exec, -1
buffer_load_dwordx4 a[40:43], v104, s[24:27], s99 offen offset:2048 sc1
s_cmp_lg_u64 s[78:79], 0
s_cbranch_scc1 L_more1
L_more1b:
ds_read_b32 v72, v91
v_mov_b32 v92, 0
s_mov_b32 s47, 0
s_mov_b32 s92, 0
s_mov_b32 s89, 0
buffer_load_dwordx4 a[44:47], v104, s[24:27], s99 offen offset:3072 sc1
s_mov_b32 s99, 12288
buffer_load_dwordx4 a[48:51], v104, s[24:27], s99 offen offset:0 sc1
buffer_load_dwordx4 a[52:55], v104, s[24:27], s99 offen offset:1024 sc1
s_waitcnt lgkmcnt(0)
v_readlane_b32 s3, v72, 0
s_max_u32 s47, s47, 0
v_writelane_b32 v92, s47, 0
s_nop 1
s_add_u32 s47, s47, s3
s_cmp_gt_u32 s47, 32
s_addc_u32 s92, s92, 0
v_readlane_b32 s3, v72, 1
s_max_u32 s47, s47, 0
v_writelane_b32 v92, s47, 1
s_nop 1
s_add_u32 s47, s47, s3
s_cmp_gt_u32 s47, 64
s_addc_u32 s92, s92, 0
s_cmp_gt_u32 s47, 32
s_addc_u32 s89, s89, 0
buffer_load_dwordx4 a[56:59], v104, s[24:27], s99 offen offset:2048 sc1
v_readlane_b32 s3, v72, 2
s_max_u32 s47, s47, 32
v_writelane_b32 v92, s47, 2
s_nop 1
s_add_u32 s47, s47, s3
s_cmp_gt_u32 s47, 64
s_addc_u32 s92, s92, 0
buffer_load_dwordx4 a[60:63], v104, s[24:27], s99 offen offset:3072 sc1
v_readlane_b32 s3, v72, 3
s_max_u32 s47, s47, 32
v_writelane_b32 v92, s47, 3
s_nop 1
s_add_u32 s47, s47, s3
s_cmp_gt_u32 s47, 96
s_addc_u32 s92, s92, 0
s_cmp_gt_u32 s47, 64
s_addc_u32 s89, s89, 0
s_mov_b32 s99, 16384
buffer_load_dwordx4 a[64:67], v104, s[24:27], s99 offen offset:0 sc1
v_readlane_b32 s3, v72, 4
s_max_u32 s47, s47, 64
v_writelane_b32 v92, s47, 4
s_nop 1
s_add_u32 s47, s47, s3
s_cmp_gt_u32 s47, 96
s_addc_u32 s92, s92, 0
buffer_load_dwordx4 a[68:71], v104, s[24:27], s99 offen offset:1024 sc1
v_readlane_b32 s3, v72, 5
s_max_u32 s47, s47, 64
v_writelane_b32 v92, s47, 5
s_nop 1
s_add_u32 s47, s47, s3
s_cmp_gt_u32 s47, 128
s_addc_u32 s92, s92, 0
s_cmp_gt_u32 s47, 96
s_addc_u32 s89, s89, 0
s_mov_b32 s98, 2048
buffer_load_dwordx4 v[146:149], v105, s[24:27], s98 offen sc1
v_readlane_b32 s3, v72, 6
s_max_u32 s47, s47, 96
v_writelane_b32 v92, s47, 6
s_nop 1
s_add_u32 s47, s47, s3
s_cmp_gt_u32 s47, 128
s_addc_u32 s92, s92, 0
buffer_load_dwordx4 a[72:75], v104, s[24:27], s99 offen offset:2048 sc1
v_readlane_b32 s3, v72, 7
s_max_u32 s47, s47, 96
v_writelane_b32 v92, s47, 7
s_nop 1
s_add_u32 s47, s47, s3
s_cmp_gt_u32 s47, 160
s_addc_u32 s92, s92, 0
s_cmp_gt_u32 s47, 128
s_addc_u32 s89, s89, 0
buffer_load_dwordx4 a[76:79], v104, s[24:27], s99 offen offset:3072 sc1
v_readlane_b32 s3, v72, 8
s_max_u32 s47, s47, 128
v_writelane_b32 v92, s47, 8
s_nop 1
s_add_u32 s47, s47, s3
s_cmp_gt_u32 s47, 160
s_addc_u32 s92, s92, 0
s_cmp_gt_u32 s47, 152
s_addc_u32 s89, s89, 0
s_mov_b32 s99, 20480
buffer_load_dwordx4 a[80:83], v104, s[24:27], s99 offen offset:0 sc1
s_or_b32 s90, s90, s92
s_cmp_lg_u64 s[90:91], 0
s_cselect_b64 s[90:91], -1, 0
v_mov_b32 v73, 163072
s_mov_b64 exec, s[90:91]
ds_write_b32 v73, v89
s_mov_b64 exec, -1
buffer_load_dwordx4 a[84:87], v104, s[24:27], s99 offen offset:1024 sc1
ds_bpermute_b32 v56, v24, v92
ds_bpermute_b32 v57, v25, v92
ds_bpermute_b32 v58, v26, v92
ds_bpermute_b32 v59, v27, v92
ds_bpermute_b32 v60, v28, v92
ds_bpermute_b32 v61, v29, v92
ds_bpermute_b32 v62, v30, v92
ds_bpermute_b32 v63, v31, v92
buffer_load_dwordx4 a[88:91], v104, s[24:27], s99 offen offset:2048 sc1
buffer_load_dwordx4 a[92:95], v104, s[24:27], s99 offen offset:3072 sc1
s_waitcnt lgkmcnt(0)
s_mov_b32 s99, 24576
buffer_load_dwordx4 a[96:99], v104, s[24:27], s99 offen offset:0 sc1
v_add_u32 v40, v40, v56
v_bfe_u32 v72, v40, 2, 2
v_and_b32 v73, 3, v40
v_lshl_or_b32 v72, v73, 2, v72
v_and_or_b32 v40, v40, -16, v72
v_and_b32 v72, 0xffff087e, v8
v_add_u32 v72, v90, v72
v_lshl_add_u32 v73, v40, 2, s96
v_bfe_u32 v74, v24, 2, 4
v_lshrrev_b32 v75, 5, v40
v_add_u32 v74, v74, v75
v_and_b32 v75, 1, v74
v_lshrrev_b32 v74, 1, v74
v_and_b32 v88, 7, v40
v_lshl_add_u32 v75, v75, 3, v88
v_lshlrev_b32 v75, 1, v75
v_lshlrev_b32 v75, v75, v89
buffer_load_dwordx4 a[100:103], v104, s[24:27], s99 offen offset:1024 sc1
v_bfe_u32 v88, v40, 3, 2
v_lshl_add_u32 v74, v74, 2, v88
v_bfe_u32 v88, v8, 7, 4
v_lshl_add_u32 v74, v74, 4, v88
v_lshl_add_u32 v74, v74, 2, s97
s_andn2_b64 exec, s[48:49], s[90:91]
ds_write_b32 v73, v72
ds_xor_b32 v74, v75
s_mov_b64 exec, -1
buffer_load_dwordx4 a[104:107], v104, s[24:27], s99 offen offset:2048 sc1
v_add_u32 v41, v41, v57
v_bfe_u32 v72, v41, 2, 2
v_and_b32 v73, 3, v41
v_lshl_or_b32 v72, v73, 2, v72
v_and_or_b32 v41, v41, -16, v72
v_and_b32 v72, 0xffff087e, v9
v_add_u32 v72, v90, v72
v_lshl_add_u32 v73, v41, 2, s96
s_mov_b32 s98, 3072
buffer_load_dwordx4 v[150:153], v105, s[24:27], s98 offen sc1
v_bfe_u32 v74, v25, 2, 4
v_lshrrev_b32 v75, 5, v41
v_add_u32 v74, v74, v75
v_and_b32 v75, 1, v74
v_lshrrev_b32 v74, 1, v74
v_and_b32 v88, 7, v41
v_lshl_add_u32 v75, v75, 3, v88
v_lshlrev_b32 v75, 1, v75
v_lshlrev_b32 v75, v75, v89
buffer_load_dwordx4 a[108:111], v104, s[24:27], s99 offen offset:3072 sc1
v_bfe_u32 v88, v41, 3, 2
v_lshl_add_u32 v74, v74, 2, v88
v_bfe_u32 v88, v9, 7, 4
v_lshl_add_u32 v74, v74, 4, v88
v_lshl_add_u32 v74, v74, 2, s97
s_andn2_b64 exec, s[50:51], s[90:91]
ds_write_b32 v73, v72
ds_xor_b32 v74, v75
s_mov_b64 exec, -1
s_mov_b32 s99, 28672
buffer_load_dwordx4 a[112:115], v104, s[24:27], s99 offen offset:0 sc1
v_add_u32 v42, v42, v58
v_bfe_u32 v72, v42, 2, 2
v_and_b32 v73, 3, v42
v_lshl_or_b32 v72, v73, 2, v72
v_and_or_b32 v42, v42, -16, v72
v_and_b32 v72, 0xffff087e, v10
v_add_u32 v72, v90, v72
v_lshl_add_u32 v73, v42, 2, s96
buffer_load_dwordx4 a[116:119], v104, s[24:27], s99 offen offset:1024 sc1
v_bfe_u32 v74, v26, 2, 4
v_lshrrev_b32 v75, 5, v42
v_add_u32 v74, v74, v75
v_and_b32 v75, 1, v74
v_lshrrev_b32 v74, 1, v74
v_and_b32 v88, 7, v42
v_lshl_add_u32 v75, v75, 3, v88
v_lshlrev_b32 v75, 1, v75
v_lshlrev_b32 v75, v75, v89
buffer_load_dwordx4 a[120:123], v104, s[24:27], s99 offen offset:2048 sc1
v_bfe_u32 v88, v42, 3, 2
v_lshl_add_u32 v74, v74, 2, v88
v_bfe_u32 v88, v10, 7, 4
v_lshl_add_u32 v74, v74, 4, v88
v_lshl_add_u32 v74, v74, 2, s97
s_andn2_b64 exec, s[52:53], s[90:91]
ds_write_b32 v73, v72
ds_xor_b32 v74, v75
s_mov_b64 exec, -1
buffer_load_dwordx4 a[124:127], v104, s[24:27], s99 offen offset:3072 sc1
v_add_u32 v43, v43, v59
v_bfe_u32 v72, v43, 2, 2
v_and_b32 v73, 3, v43
v_lshl_or_b32 v72, v73, 2, v72
v_and_or_b32 v43, v43, -16, v72
v_and_b32 v72, 0xffff087e, v11
v_add_u32 v72, v90, v72
v_lshl_add_u32 v73, v43, 2, s96
s_mov_b32 s99, 32768
buffer_load_dwordx4 a[128:131], v104, s[24:27], s99 offen offset:0 sc1
v_bfe_u32 v74, v27, 2, 4
v_lshrrev_b32 v75, 5, v43
v_add_u32 v74, v74, v75
v_and_b32 v75, 1, v74
v_lshrrev_b32 v74, 1, v74
v_and_b32 v88, 7, v43
v_lshl_add_u32 v75, v75, 3, v88
v_lshlrev_b32 v75, 1, v75
v_lshlrev_b32 v75, v75, v89
buffer_load_dwordx4 a[132:135], v104, s[24:27], s99 offen offset:1024 sc1
v_bfe_u32 v88, v43, 3, 2
v_lshl_add_u32 v74, v74, 2, v88
v_bfe_u32 v88, v11, 7, 4
v_lshl_add_u32 v74, v74, 4, v88
v_lshl_add_u32 v74, v74, 2, s97
s_andn2_b64 exec, s[54:55], s[90:91]
ds_write_b32 v73, v72
ds_xor_b32 v74, v75
s_mov_b64 exec, -1
buffer_load_dwordx4 a[136:139], v104, s[24:27], s99 offen offset:2048 sc1
v_add_u32 v44, v44, v60
v_bfe_u32 v72, v44, 2, 2
v_and_b32 v73, 3, v44
v_lshl_or_b32 v72, v73, 2, v72
v_and_or_b32 v44, v44, -16, v72
v_and_b32 v72, 0xffff087e, v12
v_add_u32 v72, v90, v72
v_lshl_add_u32 v73, v44, 2, s96
buffer_load_dwordx4 a[140:143], v104, s[24:27], s99 offen offset:3072 sc1
v_bfe_u32 v74, v28, 2, 4
v_lshrrev_b32 v75, 5, v44
v_add_u32 v74, v74, v75
v_and_b32 v75, 1, v74
v_lshrrev_b32 v74, 1, v74
v_and_b32 v88, 7, v44
v_lshl_add_u32 v75, v75, 3, v88
v_lshlrev_b32 v75, 1, v75
v_lshlrev_b32 v75, v75, v89
s_mov_b32 s98, 4096
buffer_load_dwordx4 v[154:157], v105, s[24:27], s98 offen sc1
v_bfe_u32 v88, v44, 3, 2
v_lshl_add_u32 v74, v74, 2, v88
v_bfe_u32 v88, v12, 7, 4
v_lshl_add_u32 v74, v74, 4, v88
v_lshl_add_u32 v74, v74, 2, s97
s_andn2_b64 exec, s[56:57], s[90:91]
ds_write_b32 v73, v72
ds_xor_b32 v74, v75
s_mov_b64 exec, -1
s_mov_b32 s99, 36864
buffer_load_dwordx4 a[144:147], v104, s[24:27], s99 offen offset:0 sc1
v_add_u32 v45, v45, v61
v_bfe_u32 v72, v45, 2, 2
v_and_b32 v73, 3, v45
v_lshl_or_b32 v72, v73, 2, v72
v_and_or_b32 v45, v45, -16, v72
v_and_b32 v72, 0xffff087e, v13
v_add_u32 v72, v90, v72
v_lshl_add_u32 v73, v45, 2, s96
buffer_load_dwordx4 a[148:151], v104, s[24:27], s99 offen offset:1024 sc1
v_bfe_u32 v74, v29, 2, 4
v_lshrrev_b32 v75, 5, v45
v_add_u32 v74, v74, v75
v_and_b32 v75, 1, v74
v_lshrrev_b32 v74, 1, v74
v_and_b32 v88, 7, v45
v_lshl_add_u32 v75, v75, 3, v88
v_lshlrev_b32 v75, 1, v75
v_lshlrev_b32 v75, v75, v89
buffer_load_dwordx4 a[152:155], v104, s[24:27], s99 offen offset:2048 sc1
v_bfe_u32 v88, v45, 3, 2
v_lshl_add_u32 v74, v74, 2, v88
v_bfe_u32 v88, v13, 7, 4
v_lshl_add_u32 v74, v74, 4, v88
v_lshl_add_u32 v74, v74, 2, s97
s_andn2_b64 exec, s[58:59], s[90:91]
ds_write_b32 v73, v72
ds_xor_b32 v74, v75
s_mov_b64 exec, -1
buffer_load_dwordx4 a[156:159], v104, s[24:27], s99 offen offset:3072 sc1
v_add_u32 v46, v46, v62
v_bfe_u32 v72, v46, 2, 2
v_and_b32 v73, 3, v46
v_lshl_or_b32 v72, v73, 2, v72
v_and_or_b32 v46, v46, -16, v72
v_and_b32 v72, 0xffff087e, v14
v_add_u32 v72, v90, v72
v_lshl_add_u32 v73, v46, 2, s96
s_mov_b32 s99, 40960
buffer_load_dwordx4 a[160:163], v104, s[24:27], s99 offen offset:0 sc1
v_bfe_u32 v74, v30, 2, 4
v_lshrrev_b32 v75, 5, v46
v_add_u32 v74, v74, v75
v_and_b32 v75, 1, v74
v_lshrrev_b32 v74, 1, v74
v_and_b32 v88, 7, v46
v_lshl_add_u32 v75, v75, 3, v88
v_lshlrev_b32 v75, 1, v75
v_lshlrev_b32 v75, v75, v89
buffer_load_dwordx4 a[164:167], v104, s[24:27], s99 offen offset:1024 sc1
v_bfe_u32 v88, v46, 3, 2
v_lshl_add_u32 v74, v74, 2, v88
v_bfe_u32 v88, v14, 7, 4
v_lshl_add_u32 v74, v74, 4, v88
v_lshl_add_u32 v74, v74, 2, s97
s_andn2_b64 exec, s[60:61], s[90:91]
ds_write_b32 v73, v72
ds_xor_b32 v74, v75
s_mov_b64 exec, -1
buffer_load_dwordx4 a[168:171], v104, s[24:27], s99 offen offset:2048 sc1
v_add_u32 v47, v47, v63
v_bfe_u32 v72, v47, 2, 2
v_and_b32 v73, 3, v47
v_lshl_or_b32 v72, v73, 2, v72
v_and_or_b32 v47, v47, -16, v72
v_and_b32 v72, 0xffff087e, v15
v_add_u32 v72, v90, v72
v_lshl_add_u32 v73, v47, 2, s96
buffer_load_dwordx4 a[172:175], v104, s[24:27], s99 offen offset:3072 sc1
v_bfe_u32 v74, v31, 2, 4
v_lshrrev_b32 v75, 5, v47
v_add_u32 v74, v74, v75
v_and_b32 v75, 1, v74
v_lshrrev_b32 v74, 1, v74
v_and_b32 v88, 7, v47
v_lshl_add_u32 v75, v75, 3, v88
v_lshlrev_b32 v75, 1, v75
v_lshlrev_b32 v75, v75, v89
s_mov_b32 s99, 45056
buffer_load_dwordx4 a[176:179], v104, s[24:27], s99 offen offset:0 sc1
v_bfe_u32 v88, v47, 3, 2
v_lshl_add_u32 v74, v74, 2, v88
v_bfe_u32 v88, v15, 7, 4
v_lshl_add_u32 v74, v74, 4, v88
v_lshl_add_u32 v74, v74, 2, s97
s_andn2_b64 exec, s[62:63], s[90:91]
ds_write_b32 v73, v72
ds_xor_b32 v74, v75
s_mov_b64 exec, -1
s_mov_b32 s98, 5120
buffer_load_dwordx4 v[158:161], v105, s[24:27], s98 offen sc1
s_cmp_lg_u64 s[78:79], 0
s_cbranch_scc1 L_more2
L_more2b:
v_lshrrev_b32 v72, 4, v7
v_lshl_add_u32 v73, v72, 5, s96
v_lshl_add_u32 v74, v72, 4, s96
s_mov_b32 s95, 0x07060302
s_mov_b32 s97, 0x05040100
s_mov_b32 s93, 0x00010001
buffer_load_dwordx4 a[180:183], v104, s[24:27], s99 offen offset:1024 sc1
ds_read_b32 v179, v91 offset:1024
ds_read_b32 v180, v91 offset:1280
ds_read_b32 v181, v91 offset:1536
ds_read_b32 v182, v91 offset:1792
ds_read_b32 v183, v91 offset:2048
ds_read_b32 v184, v91 offset:2304
ds_read_b32 v185, v91 offset:2560
ds_read_b128 v[24:27], v73 offset:0
ds_read_b128 v[28:31], v73 offset:16
ds_read_b128 v[32:35], v74 offset:0
ds_read_b128 v[36:39], v74 offset:64
buffer_load_dwordx4 a[184:187], v104, s[24:27], s99 offen offset:2048 sc1
buffer_load_dwordx4 a[188:191], v104, s[24:27], s99 offen offset:3072 sc1
s_mov_b32 s99, 49152
buffer_load_dwordx4 a[192:195], v104, s[24:27], s99 offen offset:0 sc1
s_waitcnt lgkmcnt(2)
v_perm_b32 v114, v25, v24, s95
v_perm_b32 v115, v27, v26, s95
v_perm_b32 v116, v29, v28, s95
v_perm_b32 v117, v31, v30, s95
ds_write_b128 v2, v[114:117] offset:576
buffer_load_dwordx4 a[196:199], v104, s[24:27], s99 offen offset:1024 sc1
buffer_load_dwordx4 a[200:203], v104, s[24:27], s99 offen offset:2048 sc1
buffer_load_dwordx4 a[204:207], v104, s[24:27], s99 offen offset:3072 sc1
s_waitcnt lgkmcnt(1)
v_perm_b32 v118, v33, v32, s97
v_perm_b32 v119, v35, v34, s97
v_perm_b32 v120, v37, v36, s97
v_perm_b32 v121, v39, v38, s97
v_perm_b32 v24, v33, v32, s95
v_perm_b32 v25, v35, v34, s95
v_perm_b32 v26, v37, v36, s95
v_perm_b32 v27, v39, v38, s95
v_pk_min_u16 v24, v24, s93
v_pk_min_u16 v25, v25, s93
v_pk_min_u16 v26, v26, s93
v_pk_min_u16 v27, v27, s93
s_mov_b32 s99, 53248
buffer_load_dwordx4 a[208:211], v104, s[24:27], s99 offen offset:0 sc1
v_pk_mul_lo_u16 v24, v24, v93
v_pk_mul_lo_u16 v25, v25, v93
v_pk_mul_lo_u16 v26, v26, v93
v_pk_mul_lo_u16 v27, v27, v93
v_xor_b32 v118, v24, v118
v_xor_b32 v119, v25, v119
v_xor_b32 v120, v26, v120
v_xor_b32 v121, v27, v121
buffer_load_dwordx4 a[212:215], v104, s[24:27], s99 offen offset:1024 sc1
ds_read_b128 v[24:27], v73 offset:128
ds_read_b128 v[28:31], v73 offset:144
ds_read_b128 v[32:35], v74 offset:128
ds_read_b128 v[36:39], v74 offset:192
s_mov_b32 s98, 6144
buffer_load_dwordx4 v[162:165], v105, s[24:27], s98 offen sc1
buffer_load_dwordx4 a[216:219], v104, s[24:27], s99 offen offset:2048 sc1
s_waitcnt lgkmcnt(2)
v_perm_b32 v114, v25, v24, s95
v_perm_b32 v115, v27, v26, s95
v_perm_b32 v116, v29, v28, s95
v_perm_b32 v117, v31, v30, s95
ds_write_b128 v2, v[114:117] offset:640
buffer_load_dwordx4 a[220:223], v104, s[24:27], s99 offen offset:3072 sc1
s_mov_b32 s99, 57344
buffer_load_dwordx4 a[224:227], v104, s[24:27], s99 offen offset:0 sc1
buffer_load_dwordx4 a[228:231], v104, s[24:27], s99 offen offset:1024 sc1
s_waitcnt lgkmcnt(1)
v_perm_b32 v122, v33, v32, s97
v_perm_b32 v123, v35, v34, s97
v_perm_b32 v124, v37, v36, s97
v_perm_b32 v125, v39, v38, s97
buffer_load_dwordx4 a[232:235], v104, s[24:27], s99 offen offset:2048 sc1
v_perm_b32 v24, v33, v32, s95
v_perm_b32 v25, v35, v34, s95
v_perm_b32 v26, v37, v36, s95
v_perm_b32 v27, v39, v38, s95
v_pk_min_u16 v24, v24, s93
v_pk_min_u16 v25, v25, s93
v_pk_min_u16 v26, v26, s93
v_pk_min_u16 v27, v27, s93
v_pk_mul_lo_u16 v24, v24, v93
v_pk_mul_lo_u16 v25, v25, v93
v_pk_mul_lo_u16 v26, v26, v93
v_pk_mul_lo_u16 v27, v27, v93
v_xor_b32 v122, v24, v122
v_xor_b32 v123, v25, v123
v_xor_b32 v124, v26, v124
v_xor_b32 v125, v27, v125
buffer_load_dwordx4 a[236:239], v104, s[24:27], s99 offen offset:3072 sc1
ds_read_b128 v[24:27], v73 offset:256
ds_read_b128 v[28:31], v73 offset:272
ds_read_b128 v[32:35], v74 offset:256
ds_read_b128 v[36:39], v74 offset:320
s_mov_b32 s99, 61440
buffer_load_dwordx4 a[240:243], v104, s[24:27], s99 offen offset:0 sc1
buffer_load_dwordx4 a[244:247], v104, s[24:27], s99 offen offset:1024 sc1
buffer_load_dwordx4 a[248:251], v104, s[24:27], s99 offen offset:2048 sc1
s_waitcnt lgkmcnt(2)
v_perm_b32 v114, v25, v24, s95
v_perm_b32 v115, v27, v26, s95
v_perm_b32 v116, v29, v28, s95
v_perm_b32 v117, v31, v30, s95
ds_write_b128 v2, v[114:117] offset:704
s_mov_b32 s98, 7168
buffer_load_dwordx4 v[166:169], v105, s[24:27], s98 offen sc1
buffer_load_dwordx4 a[252:255], v104, s[24:27], s99 offen offset:3072 sc1
s_waitcnt lgkmcnt(1)
v_perm_b32 v126, v33, v32, s97
v_perm_b32 v127, v35, v34, s97
v_perm_b32 v128, v37, v36, s97
v_perm_b32 v129, v39, v38, s97
s_mov_b32 s99, 65536
buffer_load_dwordx4 v[186:189], v104, s[24:27], s99 offen offset:0 sc1
v_perm_b32 v24, v33, v32, s95
v_perm_b32 v25, v35, v34, s95
v_perm_b32 v26, v37, v36, s95
v_perm_b32 v27, v39, v38, s95
v_pk_min_u16 v24, v24, s93
v_pk_min_u16 v25, v25, s93
v_pk_min_u16 v26, v26, s93
v_pk_min_u16 v27, v27, s93
buffer_load_dwordx4 v[190:193], v104, s[24:27], s99 offen offset:1024 sc1
v_pk_mul_lo_u16 v24, v24, v93
v_pk_mul_lo_u16 v25, v25, v93
v_pk_mul_lo_u16 v26, v26, v93
v_pk_mul_lo_u16 v27, v27, v93
v_xor_b32 v126, v24, v126
v_xor_b32 v127, v25, v127
v_xor_b32 v128, v26, v128
v_xor_b32 v129, v27, v129
buffer_load_dwordx4 v[194:197], v104, s[24:27], s99 offen offset:2048 sc1
ds_read_b128 v[24:27], v73 offset:384
ds_read_b128 v[28:31], v73 offset:400
ds_read_b128 v[32:35], v74 offset:384
ds_read_b128 v[36:39], v74 offset:448
buffer_load_dwordx4 v[198:201], v104, s[24:27], s99 offen offset:3072 sc1
s_mov_b32 s99, 69632
buffer_load_dwordx4 v[202:205], v104, s[24:27], s99 offen offset:0 sc1
s_waitcnt lgkmcnt(2)
v_perm_b32 v114, v25, v24, s95
v_perm_b32 v115, v27, v26, s95
v_perm_b32 v116, v29, v28, s95
v_perm_b32 v117, v31, v30, s95
ds_write_b128 v2, v[114:117] offset:768
buffer_load_dwordx4 v[206:209], v104, s[24:27], s99 offen offset:1024 sc1
buffer_load_dwordx4 v[210:213], v104, s[24:27], s99 offen offset:2048 sc1
buffer_load_dwordx4 v[214:217], v104, s[24:27], s99 offen offset:3072 sc1
s_waitcnt lgkmcnt(1)
v_perm_b32 v130, v33, v32, s97
v_perm_b32 v131, v35, v34, s97
v_perm_b32 v132, v37, v36, s97
v_perm_b32 v133, v39, v38, s97
v_perm_b32 v24, v33, v32, s95
v_perm_b32 v25, v35, v34, s95
v_perm_b32 v26, v37, v36, s95
v_perm_b32 v27, v39, v38, s95
v_pk_min_u16 v24, v24, s93
v_pk_min_u16 v25, v25, s93
v_pk_min_u16 v26, v26, s93
v_pk_min_u16 v27, v27, s93
s_mov_b32 s98, 8192
buffer_load_dwordx4 v[170:173], v105, s[24:27], s98 offen sc1
v_pk_mul_lo_u16 v24, v24, v93
v_pk_mul_lo_u16 v25, v25, v93
v_pk_mul_lo_u16 v26, v26, v93
v_pk_mul_lo_u16 v27, v27, v93
v_xor_b32 v130, v24, v130
v_xor_b32 v131, v25, v131
v_xor_b32 v132, v26, v132
v_xor_b32 v133, v27, v133
s_mov_b32 s99, 73728
buffer_load_dwordx4 v[218:221], v104, s[24:27], s99 offen offset:0 sc1
ds_read_b128 v[24:27], v73 offset:512
ds_read_b128 v[28:31], v73 offset:528
ds_read_b128 v[32:35], v74 offset:512
ds_read_b128 v[36:39], v74 offset:576
buffer_load_dwordx4 v[222:225], v104, s[24:27], s99 offen offset:1024 sc1
buffer_load_dwordx4 v[226:229], v104, s[24:27], s99 offen offset:2048 sc1
buffer_load_dwordx4 v[230:233], v104, s[24:27], s99 offen offset:3072 sc1
s_waitcnt lgkmcnt(2)
v_perm_b32 v114, v25, v24, s95
v_perm_b32 v115, v27, v26, s95
v_perm_b32 v116, v29, v28, s95
v_perm_b32 v117, v31, v30, s95
ds_write_b128 v2, v[114:117] offset:832
s_mov_b32 s99, 77824
buffer_load_dwordx4 v[234:237], v104, s[24:27], s99 offen offset:0 sc1
buffer_load_dwordx4 v[238:241], v104, s[24:27], s99 offen offset:1024 sc1
s_waitcnt lgkmcnt(1)
v_perm_b32 v134, v33, v32, s97
v_perm_b32 v135, v35, v34, s97
v_perm_b32 v136, v37, v36, s97
v_perm_b32 v137, v39, v38, s97
buffer_load_dwordx4 v[242:245], v104, s[24:27], s99 offen offset:2048 sc1
v_perm_b32 v24, v33, v32, s95
v_perm_b32 v25, v35, v34, s95
v_perm_b32 v26, v37, v36, s95
v_perm_b32 v27, v39, v38, s95
v_pk_min_u16 v24, v24, s93
v_pk_min_u16 v25, v25, s93
v_pk_min_u16 v26, v26, s93
v_pk_min_u16 v27, v27, s93
buffer_load_dwordx4 v[246:249], v104, s[24:27], s99 offen offset:3072 sc1
v_pk_mul_lo_u16 v24, v24, v93
v_pk_mul_lo_u16 v25, v25, v93
v_pk_mul_lo_u16 v26, v26, v93
v_pk_mul_lo_u16 v27, v27, v93
v_xor_b32 v134, v24, v134
v_xor_b32 v135, v25, v135
v_xor_b32 v136, v26, v136
v_xor_b32 v137, v27, v137
s_mov_b32 s99, 81920
buffer_load_dwordx4 v[250:253], v104, s[24:27], s99 offen offset:0 sc1
s_mov_b32 s41, 0
s_mov_b32 s42, 0
s_mov_b32 s4, 0
s_mov_b32 s5, 18432
s_mov_b32 s6, 0
s_mov_b64 vcc, s[80:81]
v_mov_b32 v108, 163072
s_waitcnt vmcnt(0) lgkmcnt(0)
s_barrier
ds_read_b32 v108, v108
s_cmp_lg_u32 s89, 0
s_cbranch_scc1 L_linked
v_add_u32_sdwa v76, s4, v118 dst_sel:DWORD dst_unused:UNUSED_PAD src0_sel:DWORD src1_sel:WORD_0
v_add_u32_sdwa v77, s4, v118 dst_sel:DWORD dst_unused:UNUSED_PAD src0_sel:DWORD src1_sel:WORD_1
v_add_u32_sdwa v78, s4, v119 dst_sel:DWORD dst_unused:UNUSED_PAD src0_sel:DWORD src1_sel:WORD_0
v_add_u32_sdwa v79, s4, v119 dst_sel:DWORD dst_unused:UNUSED_PAD src0_sel:DWORD src1_sel:WORD_1
v_add_u32_sdwa v80, s4, v120 dst_sel:DWORD dst_unused:UNUSED_PAD src0_sel:DWORD src1_sel:WORD_0
v_add_u32_sdwa v81, s4, v120 dst_sel:DWORD dst_unused:UNUSED_PAD src0_sel:DWORD src1_sel:WORD_1
v_add_u32_sdwa v82, s4, v121 dst_sel:DWORD dst_unused:UNUSED_PAD src0_sel:DWORD src1_sel:WORD_0
v_add_u32_sdwa v83, s4, v121 dst_sel:DWORD dst_unused:UNUSED_PAD src0_sel:DWORD src1_sel:WORD_1
ds_read_b128 v[44:47], v0 offset:0
ds_read_b128 v[48:51], v1 offset:0
ds_read_b128 v[8:11], v2 offset:0
ds_read_b128 v[52:55], v0 offset:2048
ds_read_b128 v[12:15], v2 offset:64
ds_read_b128 v[56:59], v1 offset:2048
ds_read_b128 v[16:19], v2 offset:128
ds_read_u16 v76, v76
ds_read_b128 v[20:23], v2 offset:192
ds_read_u16 v77, v77
ds_read_b128 v[24:27], v2 offset:256
ds_read_u16 v78, v78
ds_read_b128 v[28:31], v2 offset:320
s_waitcnt lgkmcnt(0)
v_readfirstlane_b32 s47, v108
s_nop 3
s_cmp_lg_u32 s47, 0
s_cbranch_scc1 L_slow
.p2align 6
L_loop:
v_smfmac_f32_16x16x64_bf16 v[8:11], a[0:3], v[44:51], v138
s_waitcnt lgkmcnt(7)
ds_read_b128 v[32:35], v2 offset:384
v_cvt_pk_bf16_f32 v106, v36, v37
v_smfmac_f32_16x16x64_bf16 v[8:11], a[36:39], v[52:59], v142
ds_read_u16 v79, v79
v_cvt_pk_bf16_f32 v107, v38, v39
v_smfmac_f32_16x16x64_bf16 v[12:15], a[4:7], v[44:51], v138 abid:1
ds_read_b128 v[36:39], v2 offset:448
v_cvt_pk_bf16_f32 v112, v40, v41
v_smfmac_f32_16x16x64_bf16 v[12:15], a[40:43], v[52:59], v142 abid:1
s_waitcnt lgkmcnt(9)
ds_read_u16 v80, v80
v_cvt_pk_bf16_f32 v113, v42, v43
v_smfmac_f32_16x16x64_bf16 v[16:19], a[8:11], v[44:51], v139
s_cmp_eq_u32 s4, 129024
ds_read_b128 v[40:43], v2 offset:512
v_cndmask_b32_dpp v108, v96, v92, vcc quad_perm:[1,0,3,2] row_mask:0xf bank_mask:0xf
v_smfmac_f32_16x16x64_bf16 v[16:19], a[44:47], v[52:59], v143
s_waitcnt lgkmcnt(9)
ds_read_u16 v81, v81
v_cndmask_b32_dpp v109, v97, v93, vcc quad_perm:[1,0,3,2] row_mask:0xf bank_mask:0xf
v_smfmac_f32_16x16x64_bf16 v[20:23], a[12:15], v[44:51], v139 abid:1
s_cselect_b32 s43, -129024, s5
ds_read_u16 v82, v82
v_cndmask_b32_dpp v110, v98, v94, vcc quad_perm:[1,0,3,2] row_mask:0xf bank_mask:0xf
v_smfmac_f32_16x16x64_bf16 v[20:23], a[48:51], v[52:59], v143 abid:1
s_waitcnt lgkmcnt(9)
ds_read_u16 v83, v83
v_cndmask_b32_dpp v111, v99, v95, vcc quad_perm:[1,0,3,2] row_mask:0xf bank_mask:0xf
v_smfmac_f32_16x16x64_bf16 v[24:27], a[16:19], v[44:51], v140
s_add_u32 s4, s4, s43
ds_read_b128 v[114:117], v2 offset:576
v_add_u32_sdwa v84, s42, v122 dst_sel:DWORD dst_unused:UNUSED_PAD src0_sel:DWORD src1_sel:WORD_0
v_smfmac_f32_16x16x64_bf16 v[24:27], a[52:55], v[52:59], v144
buffer_store_dwordx4 v[108:111], v4, s[20:23], s46 offen offset:0
s_mov_b64 vcc, s[82:83]
s_waitcnt lgkmcnt(9)
ds_read_b128 v[60:63], v0 offset:4096
v_cndmask_b32_dpp v96, v92, v96, vcc quad_perm:[1,0,3,2] row_mask:0xf bank_mask:0xf
v_cndmask_b32_dpp v97, v93, v97, vcc quad_perm:[1,0,3,2] row_mask:0xf bank_mask:0xf
v_smfmac_f32_16x16x64_bf16 v[28:31], a[20:23], v[44:51], v140 abid:1
s_add_u32 s41, s41, 1
ds_read_b128 v[64:67], v1 offset:4096
v_add_u32_sdwa v85, s42, v122 dst_sel:DWORD dst_unused:UNUSED_PAD src0_sel:DWORD src1_sel:WORD_1
v_smfmac_f32_16x16x64_bf16 v[28:31], a[56:59], v[52:59], v144 abid:1
s_waitcnt lgkmcnt(10)
ds_read_u16 v84, v84
v_cndmask_b32_dpp v98, v94, v98, vcc quad_perm:[1,0,3,2] row_mask:0xf bank_mask:0xf
v_smfmac_f32_16x16x64_bf16 v[32:35], a[24:27], v[44:51], v141
ds_read_u16 v85, v85
v_cndmask_b32_dpp v99, v95, v99, vcc quad_perm:[1,0,3,2] row_mask:0xf bank_mask:0xf
v_smfmac_f32_16x16x64_bf16 v[32:35], a[60:63], v[52:59], v145
s_waitcnt lgkmcnt(10)
ds_read_b128 v[68:71], v0 offset:6144
v_add_u32_sdwa v86, s42, v123 dst_sel:DWORD dst_unused:UNUSED_PAD src0_sel:DWORD src1_sel:WORD_0
v_smfmac_f32_16x16x64_bf16 v[36:39], a[28:31], v[44:51], v141 abid:1
ds_read_u16 v86, v86
v_add_u32_sdwa v87, s42, v123 dst_sel:DWORD dst_unused:UNUSED_PAD src0_sel:DWORD src1_sel:WORD_1
v_smfmac_f32_16x16x64_bf16 v[36:39], a[64:67], v[52:59], v145 abid:1
s_waitcnt lgkmcnt(10)
ds_read_u16 v87, v87
v_add_u32_sdwa v88, s42, v124 dst_sel:DWORD dst_unused:UNUSED_PAD src0_sel:DWORD src1_sel:WORD_0
v_smfmac_f32_16x16x64_bf16 v[40:43], a[32:35], v[44:51], v174
buffer_store_dwordx4 v[96:99], v4, s[20:23], s46 offen offset:1152
s_mov_b64 vcc, s[80:81]
ds_read_u16 v88, v88
v_cndmask_b32_dpp v92, v104, v100, vcc quad_perm:[1,0,3,2] row_mask:0xf bank_mask:0xf
v_cndmask_b32_dpp v93, v105, v101, vcc quad_perm:[1,0,3,2] row_mask:0xf bank_mask:0xf
v_smfmac_f32_16x16x64_bf16 v[40:43], a[68:71], v[52:59], v174 abid:1
s_waitcnt lgkmcnt(8)
ds_read_b128 v[72:75], v1 offset:6144
v_cndmask_b32_dpp v94, v106, v102, vcc quad_perm:[1,0,3,2] row_mask:0xf bank_mask:0xf
v_smfmac_f32_16x16x64_bf16 v[8:11], v[114:117], v[76:83], v179
ds_bpermute_b32 v112, v6, v112
v_add_u32_sdwa v89, s42, v124 dst_sel:DWORD dst_unused:UNUSED_PAD src0_sel:DWORD src1_sel:WORD_1
v_smfmac_f32_16x16x64_bf16 v[12:15], v[114:117], v[76:83], v179 abid:1
s_waitcnt lgkmcnt(8)
ds_read_u16 v89, v89
v_cndmask_b32_dpp v95, v107, v103, vcc quad_perm:[1,0,3,2] row_mask:0xf bank_mask:0xf
v_smfmac_f32_16x16x64_bf16 v[8:11], a[72:75], v[60:67], v146
ds_read_b128 v[114:117], v2 offset:640
v_add_u32_sdwa v90, s42, v125 dst_sel:DWORD dst_unused:UNUSED_PAD src0_sel:DWORD src1_sel:WORD_0
v_smfmac_f32_16x16x64_bf16 v[12:15], a[76:79], v[60:67], v146 abid:1
ds_read_u16 v90, v90
v_add_u32_sdwa v91, s42, v125 dst_sel:DWORD dst_unused:UNUSED_PAD src0_sel:DWORD src1_sel:WORD_1
v_smfmac_f32_16x16x64_bf16 v[16:19], a[80:83], v[60:67], v147
ds_read_u16 v91, v91
v_add_u32_sdwa v76, s42, v126 dst_sel:DWORD dst_unused:UNUSED_PAD src0_sel:DWORD src1_sel:WORD_0
v_smfmac_f32_16x16x64_bf16 v[20:23], a[84:87], v[60:67], v147 abid:1
buffer_store_dwordx4 v[92:95], v4, s[20:23], s46 offen offset:128
s_mov_b64 vcc, s[82:83]
ds_read_u16 v76, v76
v_cndmask_b32_dpp v104, v100, v104, vcc quad_perm:[1,0,3,2] row_mask:0xf bank_mask:0xf
v_cndmask_b32_dpp v105, v101, v105, vcc quad_perm:[1,0,3,2] row_mask:0xf bank_mask:0xf
v_smfmac_f32_16x16x64_bf16 v[24:27], a[88:91], v[60:67], v148
ds_bpermute_b32 v113, v6, v113
v_cndmask_b32_dpp v106, v102, v106, vcc quad_perm:[1,0,3,2] row_mask:0xf bank_mask:0xf
v_smfmac_f32_16x16x64_bf16 v[28:31], a[92:95], v[60:67], v148 abid:1
ds_read_b128 v[44:47], v0 offset:8192
v_add_u32_sdwa v77, s42, v126 dst_sel:DWORD dst_unused:UNUSED_PAD src0_sel:DWORD src1_sel:WORD_1
v_smfmac_f32_16x16x64_bf16 v[32:35], a[96:99], v[60:67], v149
ds_read_u16 v77, v77
v_cndmask_b32_dpp v107, v103, v107, vcc quad_perm:[1,0,3,2] row_mask:0xf bank_mask:0xf
v_smfmac_f32_16x16x64_bf16 v[36:39], a[100:103], v[60:67], v149 abid:1
ds_read_b128 v[48:51], v1 offset:8192
v_add_u32_sdwa v78, s42, v127 dst_sel:DWORD dst_unused:UNUSED_PAD src0_sel:DWORD src1_sel:WORD_0
v_smfmac_f32_16x16x64_bf16 v[40:43], a[104:107], v[60:67], v175
s_waitcnt lgkmcnt(10)
ds_read_u16 v78, v78
v_add_u32_sdwa v79, s42, v127 dst_sel:DWORD dst_unused:UNUSED_PAD src0_sel:DWORD src1_sel:WORD_1
v_smfmac_f32_16x16x64_bf16 v[8:11], a[108:111], v[68:75], v150
ds_read_u16 v79, v79
v_add_u32_sdwa v80, s42, v128 dst_sel:DWORD dst_unused:UNUSED_PAD src0_sel:DWORD src1_sel:WORD_0
v_smfmac_f32_16x16x64_bf16 v[12:15], a[112:115], v[68:75], v150 abid:1
buffer_store_dwordx4 v[104:107], v4, s[20:23], s46 offen offset:1280
s_mov_b64 vcc, s[80:81]
ds_read_u16 v80, v80
v_add_u32_sdwa v81, s42, v128 dst_sel:DWORD dst_unused:UNUSED_PAD src0_sel:DWORD src1_sel:WORD_1
v_add_u32_sdwa v82, s42, v129 dst_sel:DWORD dst_unused:UNUSED_PAD src0_sel:DWORD src1_sel:WORD_0
v_smfmac_f32_16x16x64_bf16 v[16:19], a[116:119], v[68:75], v151
ds_read_u16 v81, v81
v_add_u32_sdwa v92, s42, v130 dst_sel:DWORD dst_unused:UNUSED_PAD src0_sel:DWORD src1_sel:WORD_0
v_smfmac_f32_16x16x64_bf16 v[20:23], a[120:123], v[68:75], v151 abid:1
ds_read_u16 v82, v82
v_add_u32_sdwa v83, s42, v129 dst_sel:DWORD dst_unused:UNUSED_PAD src0_sel:DWORD src1_sel:WORD_1
v_smfmac_f32_16x16x64_bf16 v[24:27], a[124:127], v[68:75], v152
ds_read_b128 v[52:55], v0 offset:10240
v_add_u32_sdwa v93, s42, v130 dst_sel:DWORD dst_unused:UNUSED_PAD src0_sel:DWORD src1_sel:WORD_1
v_smfmac_f32_16x16x64_bf16 v[28:31], a[128:131], v[68:75], v152 abid:1
s_waitcnt lgkmcnt(11)
ds_read_u16 v92, v92
v_add_u32_sdwa v94, s42, v131 dst_sel:DWORD dst_unused:UNUSED_PAD src0_sel:DWORD src1_sel:WORD_0
v_smfmac_f32_16x16x64_bf16 v[16:19], v[114:117], v[84:91], v180 abid:1
ds_read_b128 v[56:59], v1 offset:10240
v_add_u32_sdwa v95, s42, v131 dst_sel:DWORD dst_unused:UNUSED_PAD src0_sel:DWORD src1_sel:WORD_1
v_smfmac_f32_16x16x64_bf16 v[20:23], v[114:117], v[84:91], v181
s_waitcnt lgkmcnt(11)
ds_read_u16 v83, v83
v_add_u32_sdwa v96, s42, v132 dst_sel:DWORD dst_unused:UNUSED_PAD src0_sel:DWORD src1_sel:WORD_0
v_smfmac_f32_16x16x64_bf16 v[32:35], a[132:135], v[68:75], v153
buffer_store_dwordx2 v[112:113], v5, s[20:23], s46 offen
ds_read_b128 v[114:117], v2 offset:704
v_add_u32_sdwa v97, s42, v132 dst_sel:DWORD dst_unused:UNUSED_PAD src0_sel:DWORD src1_sel:WORD_1
v_smfmac_f32_16x16x64_bf16 v[36:39], a[136:139], v[68:75], v153 abid:1
s_mov_b32 s22, 75497472
ds_read_u16 v93, v93
v_add_u32_sdwa v98, s42, v133 dst_sel:DWORD dst_unused:UNUSED_PAD src0_sel:DWORD src1_sel:WORD_0
v_smfmac_f32_16x16x64_bf16 v[40:43], a[140:143], v[68:75], v175 abid:1
s_waitcnt lgkmcnt(11)
ds_read_u16 v94, v94
v_add_u32_sdwa v99, s42, v133 dst_sel:DWORD dst_unused:UNUSED_PAD src0_sel:DWORD src1_sel:WORD_1
v_smfmac_f32_16x16x64_bf16 v[8:11], a[144:147], v[44:51], v154
s_add_u32 s46, s46, s6
ds_read_u16 v95, v95
v_add_u32_sdwa v84, s42, v134 dst_sel:DWORD dst_unused:UNUSED_PAD src0_sel:DWORD src1_sel:WORD_0
v_smfmac_f32_16x16x64_bf16 v[12:15], a[148:151], v[44:51], v154 abid:1
s_mov_b32 s6, 4718592
ds_read_u16 v96, v96
v_add_u32_sdwa v85, s42, v134 dst_sel:DWORD dst_unused:UNUSED_PAD src0_sel:DWORD src1_sel:WORD_1
v_smfmac_f32_16x16x64_bf16 v[16:19], a[152:155], v[44:51], v155
s_add_u32 m0, s44, 0
ds_read_u16 v97, v97
v_add_u32_sdwa v86, s42, v135 dst_sel:DWORD dst_unused:UNUSED_PAD src0_sel:DWORD src1_sel:WORD_0
v_smfmac_f32_16x16x64_bf16 v[20:23], a[156:159], v[44:51], v155 abid:1
buffer_load_dwordx4 v3, s[16:19], s45 offen offset:0 nt lds
v_add_u32_sdwa v87, s42, v135 dst_sel:DWORD dst_unused:UNUSED_PAD src0_sel:DWORD src1_sel:WORD_1
v_smfmac_f32_16x16x64_bf16 v[24:27], a[160:163], v[44:51], v156
ds_read_u16 v98, v98
v_add_u32_sdwa v88, s42, v136 dst_sel:DWORD dst_unused:UNUSED_PAD src0_sel:DWORD src1_sel:WORD_0
v_smfmac_f32_16x16x64_bf16 v[28:31], a[164:167], v[44:51], v156 abid:1
ds_read_u16 v99, v99
v_add_u32_sdwa v89, s42, v136 dst_sel:DWORD dst_unused:UNUSED_PAD src0_sel:DWORD src1_sel:WORD_1
v_smfmac_f32_16x16x64_bf16 v[32:35], a[168:171], v[44:51], v157
ds_read_u16 v84, v84
v_smfmac_f32_16x16x64_bf16 v[36:39], a[172:175], v[44:51], v157 abid:1
ds_read_u16 v85, v85
v_smfmac_f32_16x16x64_bf16 v[40:43], a[176:179], v[44:51], v176
s_waitcnt lgkmcnt(11)
s_add_u32 m0, s44, 3840
ds_read_b128 v[44:47], v0 offset:12288
v_smfmac_f32_16x16x64_bf16 v[8:11], a[180:183], v[52:59], v158
s_waitcnt lgkmcnt(10)
buffer_load_dwordx4 v3, s[16:19], s45 offen offset:256 nt lds
v_smfmac_f32_16x16x64_bf16 v[24:27], v[114:117], v[76:83], v182
ds_read_b128 v[48:51], v1 offset:12288
v_smfmac_f32_16x16x64_bf16 v[28:31], v[114:117], v[76:83], v182 abid:1
ds_read_b128 v[114:117], v2 offset:768
v_add_u32_sdwa v76, s4, v118 dst_sel:DWORD dst_unused:UNUSED_PAD src0_sel:DWORD src1_sel:WORD_0
v_smfmac_f32_16x16x64_bf16 v[12:15], a[184:187], v[52:59], v158 abid:1
ds_read_u16 v86, v86
v_add_u32_sdwa v77, s4, v118 dst_sel:DWORD dst_unused:UNUSED_PAD src0_sel:DWORD src1_sel:WORD_1
v_smfmac_f32_16x16x64_bf16 v[16:19], a[188:191], v[52:59], v159
ds_read_b128 v[60:63], v0 offset:14336
v_add_u32_sdwa v78, s4, v119 dst_sel:DWORD dst_unused:UNUSED_PAD src0_sel:DWORD src1_sel:WORD_0
v_smfmac_f32_16x16x64_bf16 v[20:23], a[192:195], v[52:59], v159 abid:1
s_add_u32 m0, s44, 7680
ds_read_u16 v87, v87
v_add_u32_sdwa v79, s4, v119 dst_sel:DWORD dst_unused:UNUSED_PAD src0_sel:DWORD src1_sel:WORD_1
v_smfmac_f32_16x16x64_bf16 v[24:27], a[196:199], v[52:59], v160
buffer_load_dwordx4 v3, s[16:19], s45 offen offset:512 nt lds
v_add_u32_sdwa v80, s4, v120 dst_sel:DWORD dst_unused:UNUSED_PAD src0_sel:DWORD src1_sel:WORD_0
v_smfmac_f32_16x16x64_bf16 v[28:31], a[200:203], v[52:59], v160 abid:1
ds_read_b128 v[64:67], v1 offset:14336
v_add_u32_sdwa v81, s4, v120 dst_sel:DWORD dst_unused:UNUSED_PAD src0_sel:DWORD src1_sel:WORD_1
v_smfmac_f32_16x16x64_bf16 v[32:35], a[204:207], v[52:59], v161
ds_read_b128 v[68:71], v0 offset:16384
v_add_u32_sdwa v82, s4, v121 dst_sel:DWORD dst_unused:UNUSED_PAD src0_sel:DWORD src1_sel:WORD_0
v_smfmac_f32_16x16x64_bf16 v[36:39], a[208:211], v[52:59], v161 abid:1
ds_read_b128 v[72:75], v1 offset:16384
v_add_u32_sdwa v83, s4, v121 dst_sel:DWORD dst_unused:UNUSED_PAD src0_sel:DWORD src1_sel:WORD_1
v_smfmac_f32_16x16x64_bf16 v[40:43], a[212:215], v[52:59], v176 abid:1
s_waitcnt lgkmcnt(7)
ds_read_u16 v88, v88
v_add_u32 v0, s43, v0
v_smfmac_f32_16x16x64_bf16 v[8:11], a[216:219], v[44:51], v162
s_add_u32 m0, s44, 11520
ds_read_u16 v89, v89
v_add_u32 v1, s43, v1
v_smfmac_f32_16x16x64_bf16 v[12:15], a[220:223], v[44:51], v162 abid:1
buffer_load_dwordx4 v3, s[16:19], s45 offen offset:768 nt lds
v_smfmac_f32_16x16x64_bf16 v[16:19], a[224:227], v[44:51], v163
s_waitcnt lgkmcnt(8)
v_smfmac_f32_16x16x64_bf16 v[32:35], v[114:117], v[92:99], v183 abid:1
v_smfmac_f32_16x16x64_bf16 v[36:39], v[114:117], v[92:99], v184
ds_read_b128 v[114:117], v2 offset:832
v_smfmac_f32_16x16x64_bf16 v[20:23], a[228:231], v[44:51], v163 abid:1
v_smfmac_f32_16x16x64_bf16 v[24:27], a[232:235], v[44:51], v164
s_add_u32 m0, s44, s8
v_smfmac_f32_16x16x64_bf16 v[28:31], a[236:239], v[44:51], v164 abid:1
s_mov_b64 exec, s[10:11]
buffer_load_dwordx4 v3, s[16:19], s7 offen offset:896 nt lds
s_mov_b64 exec, -1
v_smfmac_f32_16x16x64_bf16 v[32:35], a[240:243], v[44:51], v165
s_add_u32 s45, s45, 4718592
v_smfmac_f32_16x16x64_bf16 v[36:39], a[244:247], v[44:51], v165 abid:1
s_add_u32 s7, s7, 4718592
v_smfmac_f32_16x16x64_bf16 v[40:43], a[248:251], v[44:51], v177
s_waitcnt lgkmcnt(5)
v_smfmac_f32_16x16x64_bf16 v[8:11], a[252:255], v[60:67], v166
s_waitcnt lgkmcnt(3)
v_smfmac_f32_16x16x64_bf16 v[8:11], v[218:221], v[68:75], v170
v_smfmac_f32_16x16x64_bf16 v[12:15], v[186:189], v[60:67], v166 abid:1
v_smfmac_f32_16x16x64_bf16 v[12:15], v[222:225], v[68:75], v170 abid:1
s_waitcnt lgkmcnt(0)
v_smfmac_f32_16x16x64_bf16 v[40:43], v[114:117], v[84:91], v185
s_waitcnt vmcnt(20)
s_barrier
v_smfmac_f32_16x16x64_bf16 v[16:19], v[190:193], v[60:67], v167
s_mov_b32 s42, s4
ds_read_b128 v[44:47], v0 offset:0
v_cvt_pk_bf16_f32 v92, v8, v9
v_smfmac_f32_16x16x64_bf16 v[16:19], v[226:229], v[68:75], v171
s_cmp_lt_u32 s41, 13
ds_read_b128 v[48:51], v1 offset:0
v_cvt_pk_bf16_f32 v93, v10, v11
v_smfmac_f32_16x16x64_bf16 v[20:23], v[194:197], v[60:67], v167 abid:1
s_cselect_b32 s18, s22, 0
ds_read_b128 v[8:11], v2 offset:0
v_cvt_pk_bf16_f32 v94, v12, v13
v_smfmac_f32_16x16x64_bf16 v[20:23], v[230:233], v[68:75], v171 abid:1
s_add_u32 s44, s44, s5
ds_read_b128 v[52:55], v0 offset:2048
v_cvt_pk_bf16_f32 v95, v14, v15
v_smfmac_f32_16x16x64_bf16 v[24:27], v[198:201], v[60:67], v168
s_cmp_ge_u32 s44, 147456
ds_read_b128 v[12:15], v2 offset:64
v_cvt_pk_bf16_f32 v96, v16, v17
v_smfmac_f32_16x16x64_bf16 v[24:27], v[234:237], v[68:75], v172
s_cselect_b32 s44, s9, s44
ds_read_b128 v[56:59], v1 offset:2048
v_cvt_pk_bf16_f32 v97, v18, v19
v_smfmac_f32_16x16x64_bf16 v[28:31], v[202:205], v[60:67], v168 abid:1
ds_read_b128 v[16:19], v2 offset:128
v_cvt_pk_bf16_f32 v98, v20, v21
v_smfmac_f32_16x16x64_bf16 v[28:31], v[238:241], v[68:75], v172 abid:1
ds_read_u16 v76, v76
v_cvt_pk_bf16_f32 v99, v22, v23
v_smfmac_f32_16x16x64_bf16 v[32:35], v[206:209], v[60:67], v169
ds_read_b128 v[20:23], v2 offset:192
v_cvt_pk_bf16_f32 v100, v24, v25
v_smfmac_f32_16x16x64_bf16 v[32:35], v[242:245], v[68:75], v173
ds_read_u16 v77, v77
v_cvt_pk_bf16_f32 v101, v26, v27
v_smfmac_f32_16x16x64_bf16 v[36:39], v[210:213], v[60:67], v169 abid:1
ds_read_b128 v[24:27], v2 offset:256
v_cvt_pk_bf16_f32 v102, v28, v29
v_smfmac_f32_16x16x64_bf16 v[36:39], v[246:249], v[68:75], v173 abid:1
ds_read_u16 v78, v78
v_cvt_pk_bf16_f32 v103, v30, v31
v_smfmac_f32_16x16x64_bf16 v[40:43], v[214:217], v[60:67], v177 abid:1
s_cmp_lt_u32 s41, 16
ds_read_b128 v[28:31], v2 offset:320
v_cvt_pk_bf16_f32 v104, v32, v33
v_smfmac_f32_16x16x64_bf16 v[40:43], v[250:253], v[68:75], v178
s_waitcnt lgkmcnt(10)
v_cvt_pk_bf16_f32 v105, v34, v35
s_cbranch_scc1 L_loop
s_nop 7
v_cvt_pk_bf16_f32 v106, v36, v37
v_cvt_pk_bf16_f32 v107, v38, v39
v_cvt_pk_bf16_f32 v112, v40, v41
v_cvt_pk_bf16_f32 v113, v42, v43
s_nop 1
v_cndmask_b32_dpp v108, v96, v92, vcc quad_perm:[1,0,3,2] row_mask:0xf bank_mask:0xf
s_nop 1
v_cndmask_b32_dpp v109, v97, v93, vcc quad_perm:[1,0,3,2] row_mask:0xf bank_mask:0xf
s_nop 1
v_cndmask_b32_dpp v110, v98, v94, vcc quad_perm:[1,0,3,2] row_mask:0xf bank_mask:0xf
s_nop 1
v_cndmask_b32_dpp v111, v99, v95, vcc quad_perm:[1,0,3,2] row_mask:0xf bank_mask:0xf
s_waitcnt lgkmcnt(0)
buffer_store_dwordx4 v[108:111], v4, s[20:23], s46 offen offset:0
s_nop 1
s_mov_b64 vcc, s[82:83]
s_nop 1
v_cndmask_b32_dpp v96, v92, v96, vcc quad_perm:[1,0,3,2] row_mask:0xf bank_mask:0xf
s_nop 1
v_cndmask_b32_dpp v97, v93, v97, vcc quad_perm:[1,0,3,2] row_mask:0xf bank_mask:0xf
s_nop 1
v_cndmask_b32_dpp v98, v94, v98, vcc quad_perm:[1,0,3,2] row_mask:0xf bank_mask:0xf
s_nop 1
v_cndmask_b32_dpp v99, v95, v99, vcc quad_perm:[1,0,3,2] row_mask:0xf bank_mask:0xf
s_waitcnt lgkmcnt(0)
buffer_store_dwordx4 v[96:99], v4, s[20:23], s46 offen offset:1152
s_nop 1
s_mov_b64 vcc, s[80:81]
s_nop 1
v_cndmask_b32_dpp v92, v104, v100, vcc quad_perm:[1,0,3,2] row_mask:0xf bank_mask:0xf
s_nop 1
v_cndmask_b32_dpp v93, v105, v101, vcc quad_perm:[1,0,3,2] row_mask:0xf bank_mask:0xf
s_nop 1
v_cndmask_b32_dpp v94, v106, v102, vcc quad_perm:[1,0,3,2] row_mask:0xf bank_mask:0xf
s_nop 1
ds_bpermute_b32 v112, v6, v112
s_nop 1
v_cndmask_b32_dpp v95, v107, v103, vcc quad_perm:[1,0,3,2] row_mask:0xf bank_mask:0xf
s_waitcnt lgkmcnt(0)
buffer_store_dwordx4 v[92:95], v4, s[20:23], s46 offen offset:128
s_nop 1
s_mov_b64 vcc, s[82:83]
s_nop 1
v_cndmask_b32_dpp v104, v100, v104, vcc quad_perm:[1,0,3,2] row_mask:0xf bank_mask:0xf
s_nop 1
v_cndmask_b32_dpp v105, v101, v105, vcc quad_perm:[1,0,3,2] row_mask:0xf bank_mask:0xf
s_nop 1
ds_bpermute_b32 v113, v6, v113
s_nop 1
v_cndmask_b32_dpp v106, v102, v106, vcc quad_perm:[1,0,3,2] row_mask:0xf bank_mask:0xf
s_nop 1
v_cndmask_b32_dpp v107, v103, v107, vcc quad_perm:[1,0,3,2] row_mask:0xf bank_mask:0xf
s_waitcnt lgkmcnt(0)
buffer_store_dwordx4 v[104:107], v4, s[20:23], s46 offen offset:1280
s_nop 1
s_mov_b64 vcc, s[80:81]
s_waitcnt lgkmcnt(0)
buffer_store_dwordx2 v[112:113], v5, s[20:23], s46 offen
s_nop 1
L_fin:
L_end_standalone__structured_sparse_n_m__ragged_kernel:
s_endpgm
L_more1:
v_bfe_u32 v72, v16, 12, 4
v_cmp_ne_u32 s[64:65], 0, v16
v_cmp_eq_u32 vcc, s94, v72
v_min_u32 v72, 8, v72
v_lshl_add_u32 v32, v72, 2, s93
s_and_b32 s65, s65, 15
s_or_b32 s65, s65, vcc_hi
s_mov_b64 exec, s[64:65]
ds_add_rtn_u32 v48, v32, v89
s_mov_b64 exec, -1
v_bfe_u32 v72, v17, 12, 4
v_cmp_ne_u32 s[66:67], 0, v17
v_cmp_eq_u32 vcc, s94, v72
v_min_u32 v72, 8, v72
v_lshl_add_u32 v33, v72, 2, s93
s_and_b32 s67, s67, 15
s_or_b32 s67, s67, vcc_hi
s_mov_b64 exec, s[66:67]
ds_add_rtn_u32 v49, v33, v89
s_mov_b64 exec, -1
v_bfe_u32 v72, v18, 12, 4
v_cmp_ne_u32 s[68:69], 0, v18
v_cmp_eq_u32 vcc, s94, v72
v_min_u32 v72, 8, v72
v_lshl_add_u32 v34, v72, 2, s93
s_and_b32 s69, s69, 15
s_or_b32 s69, s69, vcc_hi
s_mov_b64 exec, s[68:69]
ds_add_rtn_u32 v50, v34, v89
s_mov_b64 exec, -1
v_bfe_u32 v72, v19, 12, 4
v_cmp_ne_u32 s[70:71], 0, v19
v_cmp_eq_u32 vcc, s94, v72
v_min_u32 v72, 8, v72
v_lshl_add_u32 v35, v72, 2, s93
s_and_b32 s71, s71, 15
s_or_b32 s71, s71, vcc_hi
s_mov_b64 exec, s[70:71]
ds_add_rtn_u32 v51, v35, v89
s_mov_b64 exec, -1
v_bfe_u32 v72, v20, 12, 4
v_cmp_ne_u32 s[72:73], 0, v20
v_cmp_eq_u32 vcc, s94, v72
v_min_u32 v72, 8, v72
v_lshl_add_u32 v36, v72, 2, s93
s_and_b32 s73, s73, 15
s_or_b32 s73, s73, vcc_hi
s_mov_b64 exec, s[72:73]
ds_add_rtn_u32 v52, v36, v89
s_mov_b64 exec, -1
v_bfe_u32 v72, v21, 12, 4
v_cmp_ne_u32 s[74:75], 0, v21
v_cmp_eq_u32 vcc, s94, v72
v_min_u32 v72, 8, v72
v_lshl_add_u32 v37, v72, 2, s93
s_and_b32 s75, s75, 15
s_or_b32 s75, s75, vcc_hi
s_mov_b64 exec, s[74:75]
ds_add_rtn_u32 v53, v37, v89
s_mov_b64 exec, -1
v_bfe_u32 v72, v22, 12, 4
v_cmp_ne_u32 s[76:77], 0, v22
v_cmp_eq_u32 vcc, s94, v72
v_min_u32 v72, 8, v72
v_lshl_add_u32 v38, v72, 2, s93
s_and_b32 s77, s77, 15
s_or_b32 s77, s77, vcc_hi
s_mov_b64 exec, s[76:77]
ds_add_rtn_u32 v54, v38, v89
s_mov_b64 exec, -1
s_branch L_more1b
L_more2:
ds_bpermute_b32 v64, v32, v92
ds_bpermute_b32 v65, v33, v92
ds_bpermute_b32 v66, v34, v92
ds_bpermute_b32 v67, v35, v92
ds_bpermute_b32 v68, v36, v92
ds_bpermute_b32 v69, v37, v92
ds_bpermute_b32 v70, v38, v92
s_waitcnt lgkmcnt(0)
v_add_u32 v48, v48, v64
v_bfe_u32 v72, v48, 2, 2
v_and_b32 v73, 3, v48
v_lshl_or_b32 v72, v73, 2, v72
v_and_or_b32 v48, v48, -16, v72
v_and_b32 v72, 0xffff087e, v16
v_add_u32 v72, v90, v72
v_lshl_add_u32 v73, v48, 2, s96
v_bfe_u32 v74, v32, 2, 4
v_lshrrev_b32 v75, 5, v48
v_add_u32 v74, v74, v75
v_and_b32 v75, 1, v74
v_lshrrev_b32 v74, 1, v74
v_and_b32 v88, 7, v48
v_lshl_add_u32 v75, v75, 3, v88
v_lshlrev_b32 v75, 1, v75
v_lshlrev_b32 v75, v75, v89
v_bfe_u32 v88, v48, 3, 2
v_lshl_add_u32 v74, v74, 2, v88
v_bfe_u32 v88, v16, 7, 4
v_lshl_add_u32 v74, v74, 4, v88
v_lshl_add_u32 v74, v74, 2, s97
s_andn2_b64 exec, s[64:65], s[90:91]
ds_write_b32 v73, v72
ds_xor_b32 v74, v75
s_mov_b64 exec, -1
v_add_u32 v49, v49, v65
v_bfe_u32 v72, v49, 2, 2
v_and_b32 v73, 3, v49
v_lshl_or_b32 v72, v73, 2, v72
v_and_or_b32 v49, v49, -16, v72
v_and_b32 v72, 0xffff087e, v17
v_add_u32 v72, v90, v72
v_lshl_add_u32 v73, v49, 2, s96
v_bfe_u32 v74, v33, 2, 4
v_lshrrev_b32 v75, 5, v49
v_add_u32 v74, v74, v75
v_and_b32 v75, 1, v74
v_lshrrev_b32 v74, 1, v74
v_and_b32 v88, 7, v49
v_lshl_add_u32 v75, v75, 3, v88
v_lshlrev_b32 v75, 1, v75
v_lshlrev_b32 v75, v75, v89
v_bfe_u32 v88, v49, 3, 2
v_lshl_add_u32 v74, v74, 2, v88
v_bfe_u32 v88, v17, 7, 4
v_lshl_add_u32 v74, v74, 4, v88
v_lshl_add_u32 v74, v74, 2, s97
s_andn2_b64 exec, s[66:67], s[90:91]
ds_write_b32 v73, v72
ds_xor_b32 v74, v75
s_mov_b64 exec, -1
v_add_u32 v50, v50, v66
v_bfe_u32 v72, v50, 2, 2
v_and_b32 v73, 3, v50
v_lshl_or_b32 v72, v73, 2, v72
v_and_or_b32 v50, v50, -16, v72
v_and_b32 v72, 0xffff087e, v18
v_add_u32 v72, v90, v72
v_lshl_add_u32 v73, v50, 2, s96
v_bfe_u32 v74, v34, 2, 4
v_lshrrev_b32 v75, 5, v50
v_add_u32 v74, v74, v75
v_and_b32 v75, 1, v74
v_lshrrev_b32 v74, 1, v74
v_and_b32 v88, 7, v50
v_lshl_add_u32 v75, v75, 3, v88
v_lshlrev_b32 v75, 1, v75
v_lshlrev_b32 v75, v75, v89
v_bfe_u32 v88, v50, 3, 2
v_lshl_add_u32 v74, v74, 2, v88
v_bfe_u32 v88, v18, 7, 4
v_lshl_add_u32 v74, v74, 4, v88
v_lshl_add_u32 v74, v74, 2, s97
s_andn2_b64 exec, s[68:69], s[90:91]
ds_write_b32 v73, v72
ds_xor_b32 v74, v75
s_mov_b64 exec, -1
v_add_u32 v51, v51, v67
v_bfe_u32 v72, v51, 2, 2
v_and_b32 v73, 3, v51
v_lshl_or_b32 v72, v73, 2, v72
v_and_or_b32 v51, v51, -16, v72
v_and_b32 v72, 0xffff087e, v19
v_add_u32 v72, v90, v72
v_lshl_add_u32 v73, v51, 2, s96
v_bfe_u32 v74, v35, 2, 4
v_lshrrev_b32 v75, 5, v51
v_add_u32 v74, v74, v75
v_and_b32 v75, 1, v74
v_lshrrev_b32 v74, 1, v74
v_and_b32 v88, 7, v51
v_lshl_add_u32 v75, v75, 3, v88
v_lshlrev_b32 v75, 1, v75
v_lshlrev_b32 v75, v75, v89
v_bfe_u32 v88, v51, 3, 2
v_lshl_add_u32 v74, v74, 2, v88
v_bfe_u32 v88, v19, 7, 4
v_lshl_add_u32 v74, v74, 4, v88
v_lshl_add_u32 v74, v74, 2, s97
s_andn2_b64 exec, s[70:71], s[90:91]
ds_write_b32 v73, v72
ds_xor_b32 v74, v75
s_mov_b64 exec, -1
v_add_u32 v52, v52, v68
v_bfe_u32 v72, v52, 2, 2
v_and_b32 v73, 3, v52
v_lshl_or_b32 v72, v73, 2, v72
v_and_or_b32 v52, v52, -16, v72
v_and_b32 v72, 0xffff087e, v20
v_add_u32 v72, v90, v72
v_lshl_add_u32 v73, v52, 2, s96
v_bfe_u32 v74, v36, 2, 4
v_lshrrev_b32 v75, 5, v52
v_add_u32 v74, v74, v75
v_and_b32 v75, 1, v74
v_lshrrev_b32 v74, 1, v74
v_and_b32 v88, 7, v52
v_lshl_add_u32 v75, v75, 3, v88
v_lshlrev_b32 v75, 1, v75
v_lshlrev_b32 v75, v75, v89
v_bfe_u32 v88, v52, 3, 2
v_lshl_add_u32 v74, v74, 2, v88
v_bfe_u32 v88, v20, 7, 4
v_lshl_add_u32 v74, v74, 4, v88
v_lshl_add_u32 v74, v74, 2, s97
s_andn2_b64 exec, s[72:73], s[90:91]
ds_write_b32 v73, v72
ds_xor_b32 v74, v75
s_mov_b64 exec, -1
v_add_u32 v53, v53, v69
v_bfe_u32 v72, v53, 2, 2
v_and_b32 v73, 3, v53
v_lshl_or_b32 v72, v73, 2, v72
v_and_or_b32 v53, v53, -16, v72
v_and_b32 v72, 0xffff087e, v21
v_add_u32 v72, v90, v72
v_lshl_add_u32 v73, v53, 2, s96
v_bfe_u32 v74, v37, 2, 4
v_lshrrev_b32 v75, 5, v53
v_add_u32 v74, v74, v75
v_and_b32 v75, 1, v74
v_lshrrev_b32 v74, 1, v74
v_and_b32 v88, 7, v53
v_lshl_add_u32 v75, v75, 3, v88
v_lshlrev_b32 v75, 1, v75
v_lshlrev_b32 v75, v75, v89
v_bfe_u32 v88, v53, 3, 2
v_lshl_add_u32 v74, v74, 2, v88
v_bfe_u32 v88, v21, 7, 4
v_lshl_add_u32 v74, v74, 4, v88
v_lshl_add_u32 v74, v74, 2, s97
s_andn2_b64 exec, s[74:75], s[90:91]
ds_write_b32 v73, v72
ds_xor_b32 v74, v75
s_mov_b64 exec, -1
v_add_u32 v54, v54, v70
v_bfe_u32 v72, v54, 2, 2
v_and_b32 v73, 3, v54
v_lshl_or_b32 v72, v73, 2, v72
v_and_or_b32 v54, v54, -16, v72
v_and_b32 v72, 0xffff087e, v22
v_add_u32 v72, v90, v72
v_lshl_add_u32 v73, v54, 2, s96
v_bfe_u32 v74, v38, 2, 4
v_lshrrev_b32 v75, 5, v54
v_add_u32 v74, v74, v75
v_and_b32 v75, 1, v74
v_lshrrev_b32 v74, 1, v74
v_and_b32 v88, 7, v54
v_lshl_add_u32 v75, v75, 3, v88
v_lshlrev_b32 v75, 1, v75
v_lshlrev_b32 v75, v75, v89
v_bfe_u32 v88, v54, 3, 2
v_lshl_add_u32 v74, v74, 2, v88
v_bfe_u32 v88, v22, 7, 4
v_lshl_add_u32 v74, v74, 4, v88
v_lshl_add_u32 v74, v74, 2, s97
s_andn2_b64 exec, s[76:77], s[90:91]
ds_write_b32 v73, v72
ds_xor_b32 v74, v75
s_mov_b64 exec, -1
s_branch L_more2b
L_giveup:
s_waitcnt vmcnt(0)
v_mov_b32 v8, 163072
v_mov_b32 v9, 1
ds_write_b32 v8, v9
s_branch L_polled
L_linked:
v_add_u32_sdwa v76, s4, v118 dst_sel:DWORD dst_unused:UNUSED_PAD src0_sel:DWORD src1_sel:WORD_0
v_add_u32_sdwa v77, s4, v118 dst_sel:DWORD dst_unused:UNUSED_PAD src0_sel:DWORD src1_sel:WORD_1
v_add_u32_sdwa v78, s4, v119 dst_sel:DWORD dst_unused:UNUSED_PAD src0_sel:DWORD src1_sel:WORD_0
v_add_u32_sdwa v79, s4, v119 dst_sel:DWORD dst_unused:UNUSED_PAD src0_sel:DWORD src1_sel:WORD_1
v_add_u32_sdwa v80, s4, v120 dst_sel:DWORD dst_unused:UNUSED_PAD src0_sel:DWORD src1_sel:WORD_0
v_add_u32_sdwa v81, s4, v120 dst_sel:DWORD dst_unused:UNUSED_PAD src0_sel:DWORD src1_sel:WORD_1
v_add_u32_sdwa v82, s4, v121 dst_sel:DWORD dst_unused:UNUSED_PAD src0_sel:DWORD src1_sel:WORD_0
v_add_u32_sdwa v83, s4, v121 dst_sel:DWORD dst_unused:UNUSED_PAD src0_sel:DWORD src1_sel:WORD_1
ds_read_b128 v[44:47], v0 offset:0
ds_read_b128 v[48:51], v1 offset:0
ds_read_b128 v[8:11], v2 offset:0
ds_read_b128 v[52:55], v0 offset:2048
ds_read_b128 v[12:15], v2 offset:64
ds_read_b128 v[56:59], v1 offset:2048
ds_read_b128 v[16:19], v2 offset:128
ds_read_u16 v76, v76
ds_read_b128 v[20:23], v2 offset:192
ds_read_u16 v77, v77
ds_read_b128 v[24:27], v2 offset:256
ds_read_u16 v78, v78
ds_read_b128 v[28:31], v2 offset:320
s_waitcnt lgkmcnt(0)
v_readfirstlane_b32 s47, v108
s_nop 3
s_cmp_lg_u32 s47, 0
s_cbranch_scc1 L_slow
.p2align 6
L_loopk:
v_smfmac_f32_16x16x64_bf16 v[8:11], a[0:3], v[44:51], v138
s_waitcnt lgkmcnt(7)
ds_read_b128 v[32:35], v2 offset:384
v_cvt_pk_bf16_f32 v106, v36, v37
v_smfmac_f32_16x16x64_bf16 v[8:11], a[36:39], v[52:59], v142
ds_read_u16 v79, v79
v_cvt_pk_bf16_f32 v107, v38, v39
v_smfmac_f32_16x16x64_bf16 v[12:15], a[4:7], v[44:51], v138 abid:1
ds_read_b128 v[36:39], v2 offset:448
v_cvt_pk_bf16_f32 v112, v40, v41
v_smfmac_f32_16x16x64_bf16 v[12:15], a[40:43], v[52:59], v142 abid:1
s_waitcnt lgkmcnt(9)
ds_read_u16 v80, v80
v_cvt_pk_bf16_f32 v113, v42, v43
v_smfmac_f32_16x16x64_bf16 v[16:19], a[8:11], v[44:51], v139
s_cmp_eq_u32 s4, 129024
ds_read_b128 v[40:43], v2 offset:512
v_cndmask_b32_dpp v108, v96, v92, vcc quad_perm:[1,0,3,2] row_mask:0xf bank_mask:0xf
v_smfmac_f32_16x16x64_bf16 v[16:19], a[44:47], v[52:59], v143
s_waitcnt lgkmcnt(9)
ds_read_u16 v81, v81
v_cndmask_b32_dpp v109, v97, v93, vcc quad_perm:[1,0,3,2] row_mask:0xf bank_mask:0xf
v_smfmac_f32_16x16x64_bf16 v[20:23], a[12:15], v[44:51], v139 abid:1
s_cselect_b32 s43, -129024, s5
ds_read_u16 v82, v82
v_cndmask_b32_dpp v110, v98, v94, vcc quad_perm:[1,0,3,2] row_mask:0xf bank_mask:0xf
v_smfmac_f32_16x16x64_bf16 v[20:23], a[48:51], v[52:59], v143 abid:1
s_waitcnt lgkmcnt(9)
ds_read_u16 v83, v83
v_cndmask_b32_dpp v111, v99, v95, vcc quad_perm:[1,0,3,2] row_mask:0xf bank_mask:0xf
v_smfmac_f32_16x16x64_bf16 v[24:27], a[16:19], v[44:51], v140
s_add_u32 s4, s4, s43
ds_read_b128 v[114:117], v2 offset:576
v_add_u32_sdwa v84, s42, v122 dst_sel:DWORD dst_unused:UNUSED_PAD src0_sel:DWORD src1_sel:WORD_0
v_smfmac_f32_16x16x64_bf16 v[24:27], a[52:55], v[52:59], v144
buffer_store_dwordx4 v[108:111], v4, s[20:23], s46 offen offset:0
s_mov_b64 vcc, s[82:83]
s_waitcnt lgkmcnt(9)
ds_read_b128 v[60:63], v0 offset:4096
v_cndmask_b32_dpp v96, v92, v96, vcc quad_perm:[1,0,3,2] row_mask:0xf bank_mask:0xf
v_cndmask_b32_dpp v97, v93, v97, vcc quad_perm:[1,0,3,2] row_mask:0xf bank_mask:0xf
v_smfmac_f32_16x16x64_bf16 v[28:31], a[20:23], v[44:51], v140 abid:1
s_add_u32 s41, s41, 1
ds_read_b128 v[64:67], v1 offset:4096
v_cndmask_b32_dpp v98, v94, v98, vcc quad_perm:[1,0,3,2] row_mask:0xf bank_mask:0xf
v_smfmac_f32_16x16x64_bf16 v[28:31], a[56:59], v[52:59], v144 abid:1
s_waitcnt lgkmcnt(10)
ds_read_u16 v84, v84
v_add_u32_sdwa v85, s42, v122 dst_sel:DWORD dst_unused:UNUSED_PAD src0_sel:DWORD src1_sel:WORD_1
v_smfmac_f32_16x16x64_bf16 v[32:35], a[24:27], v[44:51], v141
ds_read_u16 v85, v85
v_cndmask_b32_dpp v99, v95, v99, vcc quad_perm:[1,0,3,2] row_mask:0xf bank_mask:0xf
v_smfmac_f32_16x16x64_bf16 v[32:35], a[60:63], v[52:59], v145
s_waitcnt lgkmcnt(10)
ds_read_b128 v[68:71], v0 offset:6144
v_add_u32_sdwa v86, s42, v123 dst_sel:DWORD dst_unused:UNUSED_PAD src0_sel:DWORD src1_sel:WORD_0
v_smfmac_f32_16x16x64_bf16 v[36:39], a[28:31], v[44:51], v141 abid:1
ds_read_u16 v86, v86
v_add_u32_sdwa v87, s42, v123 dst_sel:DWORD dst_unused:UNUSED_PAD src0_sel:DWORD src1_sel:WORD_1
v_smfmac_f32_16x16x64_bf16 v[36:39], a[64:67], v[52:59], v145 abid:1
s_waitcnt lgkmcnt(10)
ds_read_u16 v87, v87
v_add_u32_sdwa v88, s42, v124 dst_sel:DWORD dst_unused:UNUSED_PAD src0_sel:DWORD src1_sel:WORD_0
v_smfmac_f32_16x16x64_bf16 v[40:43], a[32:35], v[44:51], v174
buffer_store_dwordx4 v[96:99], v4, s[20:23], s46 offen offset:1152
s_mov_b64 vcc, s[80:81]
ds_read_b128 v[72:75], v1 offset:6144
v_cndmask_b32_dpp v92, v104, v100, vcc quad_perm:[1,0,3,2] row_mask:0xf bank_mask:0xf
v_cndmask_b32_dpp v93, v105, v101, vcc quad_perm:[1,0,3,2] row_mask:0xf bank_mask:0xf
v_smfmac_f32_16x16x64_bf16 v[40:43], a[68:71], v[52:59], v174 abid:1
s_waitcnt lgkmcnt(8)
ds_read_u16 v88, v88
v_cndmask_b32_dpp v94, v106, v102, vcc quad_perm:[1,0,3,2] row_mask:0xf bank_mask:0xf
v_smfmac_f32_16x16x64_bf16 v[8:11], v[114:117], v[76:83], v179
ds_bpermute_b32 v112, v6, v112
v_cndmask_b32_dpp v95, v107, v103, vcc quad_perm:[1,0,3,2] row_mask:0xf bank_mask:0xf
v_smfmac_f32_16x16x64_bf16 v[12:15], v[114:117], v[76:83], v179 abid:1
s_waitcnt lgkmcnt(8)
ds_read_b128 v[114:117], v2 offset:640
v_add_u32_sdwa v89, s42, v124 dst_sel:DWORD dst_unused:UNUSED_PAD src0_sel:DWORD src1_sel:WORD_1
v_smfmac_f32_16x16x64_bf16 v[8:11], a[72:75], v[60:67], v146
ds_read_u16 v89, v89
v_add_u32_sdwa v90, s42, v125 dst_sel:DWORD dst_unused:UNUSED_PAD src0_sel:DWORD src1_sel:WORD_0
v_smfmac_f32_16x16x64_bf16 v[12:15], a[76:79], v[60:67], v146 abid:1
ds_read_u16 v90, v90
v_add_u32_sdwa v91, s42, v125 dst_sel:DWORD dst_unused:UNUSED_PAD src0_sel:DWORD src1_sel:WORD_1
v_smfmac_f32_16x16x64_bf16 v[16:19], a[80:83], v[60:67], v147
ds_read_u16 v91, v91
v_add_u32_sdwa v76, s42, v126 dst_sel:DWORD dst_unused:UNUSED_PAD src0_sel:DWORD src1_sel:WORD_0
v_smfmac_f32_16x16x64_bf16 v[20:23], a[84:87], v[60:67], v147 abid:1
buffer_store_dwordx4 v[92:95], v4, s[20:23], s46 offen offset:128
s_mov_b64 vcc, s[82:83]
ds_bpermute_b32 v113, v6, v113
v_cndmask_b32_dpp v104, v100, v104, vcc quad_perm:[1,0,3,2] row_mask:0xf bank_mask:0xf
v_cndmask_b32_dpp v105, v101, v105, vcc quad_perm:[1,0,3,2] row_mask:0xf bank_mask:0xf
v_smfmac_f32_16x16x64_bf16 v[24:27], a[88:91], v[60:67], v148
ds_read_u16 v76, v76
v_cndmask_b32_dpp v106, v102, v106, vcc quad_perm:[1,0,3,2] row_mask:0xf bank_mask:0xf
v_smfmac_f32_16x16x64_bf16 v[28:31], a[92:95], v[60:67], v148 abid:1
ds_read_b128 v[44:47], v0 offset:8192
v_cndmask_b32_dpp v107, v103, v107, vcc quad_perm:[1,0,3,2] row_mask:0xf bank_mask:0xf
v_smfmac_f32_16x16x64_bf16 v[32:35], a[96:99], v[60:67], v149
ds_read_b128 v[48:51], v1 offset:8192
v_add_u32_sdwa v77, s42, v126 dst_sel:DWORD dst_unused:UNUSED_PAD src0_sel:DWORD src1_sel:WORD_1
v_smfmac_f32_16x16x64_bf16 v[36:39], a[100:103], v[60:67], v149 abid:1
ds_read_u16 v77, v77
v_add_u32_sdwa v78, s42, v127 dst_sel:DWORD dst_unused:UNUSED_PAD src0_sel:DWORD src1_sel:WORD_0
v_smfmac_f32_16x16x64_bf16 v[40:43], a[104:107], v[60:67], v175
s_waitcnt lgkmcnt(11)
ds_read_u16 v78, v78
v_add_u32_sdwa v79, s42, v127 dst_sel:DWORD dst_unused:UNUSED_PAD src0_sel:DWORD src1_sel:WORD_1
v_smfmac_f32_16x16x64_bf16 v[8:11], a[108:111], v[68:75], v150
ds_read_u16 v79, v79
v_add_u32_sdwa v80, s42, v128 dst_sel:DWORD dst_unused:UNUSED_PAD src0_sel:DWORD src1_sel:WORD_0
v_smfmac_f32_16x16x64_bf16 v[12:15], a[112:115], v[68:75], v150 abid:1
buffer_store_dwordx4 v[104:107], v4, s[20:23], s46 offen offset:1280
s_mov_b64 vcc, s[80:81]
ds_read_u16 v80, v80
v_add_u32_sdwa v81, s42, v128 dst_sel:DWORD dst_unused:UNUSED_PAD src0_sel:DWORD src1_sel:WORD_1
v_add_u32_sdwa v82, s42, v129 dst_sel:DWORD dst_unused:UNUSED_PAD src0_sel:DWORD src1_sel:WORD_0
v_smfmac_f32_16x16x64_bf16 v[16:19], a[116:119], v[68:75], v151
ds_read_u16 v81, v81
v_add_u32_sdwa v83, s42, v129 dst_sel:DWORD dst_unused:UNUSED_PAD src0_sel:DWORD src1_sel:WORD_1
v_smfmac_f32_16x16x64_bf16 v[20:23], a[120:123], v[68:75], v151 abid:1
ds_read_b128 v[52:55], v0 offset:10240
v_add_u32_sdwa v92, s42, v130 dst_sel:DWORD dst_unused:UNUSED_PAD src0_sel:DWORD src1_sel:WORD_0
v_smfmac_f32_16x16x64_bf16 v[24:27], a[124:127], v[68:75], v152
ds_read_u16 v82, v82
v_add_u32_sdwa v93, s42, v130 dst_sel:DWORD dst_unused:UNUSED_PAD src0_sel:DWORD src1_sel:WORD_1
v_smfmac_f32_16x16x64_bf16 v[28:31], a[128:131], v[68:75], v152 abid:1
ds_read_b128 v[56:59], v1 offset:10240
v_add_u32_sdwa v94, s42, v131 dst_sel:DWORD dst_unused:UNUSED_PAD src0_sel:DWORD src1_sel:WORD_0
v_smfmac_f32_16x16x64_bf16 v[32:35], a[132:135], v[68:75], v153
s_waitcnt lgkmcnt(12)
ds_read_u16 v83, v83
v_add_u32_sdwa v95, s42, v131 dst_sel:DWORD dst_unused:UNUSED_PAD src0_sel:DWORD src1_sel:WORD_1
v_smfmac_f32_16x16x64_bf16 v[12:15], v[114:117], v[84:91], v180
s_waitcnt lgkmcnt(12)
ds_read_u16 v92, v92
v_add_u32_sdwa v96, s42, v132 dst_sel:DWORD dst_unused:UNUSED_PAD src0_sel:DWORD src1_sel:WORD_0
v_smfmac_f32_16x16x64_bf16 v[16:19], v[114:117], v[84:91], v180 abid:1
buffer_store_dwordx2 v[112:113], v5, s[20:23], s46 offen
ds_read_u16 v93, v93
v_add_u32_sdwa v97, s42, v132 dst_sel:DWORD dst_unused:UNUSED_PAD src0_sel:DWORD src1_sel:WORD_1
v_smfmac_f32_16x16x64_bf16 v[20:23], v[114:117], v[84:91], v181
s_mov_b32 s22, 75497472
ds_read_b128 v[114:117], v2 offset:704
v_add_u32_sdwa v98, s42, v133 dst_sel:DWORD dst_unused:UNUSED_PAD src0_sel:DWORD src1_sel:WORD_0
v_smfmac_f32_16x16x64_bf16 v[36:39], a[136:139], v[68:75], v153 abid:1
s_add_u32 s46, s46, s6
ds_read_u16 v94, v94
v_add_u32_sdwa v84, s42, v134 dst_sel:DWORD dst_unused:UNUSED_PAD src0_sel:DWORD src1_sel:WORD_0
v_smfmac_f32_16x16x64_bf16 v[40:43], a[140:143], v[68:75], v175 abid:1
s_waitcnt lgkmcnt(13)
ds_read_u16 v95, v95
v_add_u32_sdwa v99, s42, v133 dst_sel:DWORD dst_unused:UNUSED_PAD src0_sel:DWORD src1_sel:WORD_1
v_smfmac_f32_16x16x64_bf16 v[8:11], a[144:147], v[44:51], v154
s_mov_b32 s6, 4718592
ds_read_u16 v96, v96
v_add_u32_sdwa v85, s42, v134 dst_sel:DWORD dst_unused:UNUSED_PAD src0_sel:DWORD src1_sel:WORD_1
v_smfmac_f32_16x16x64_bf16 v[12:15], a[148:151], v[44:51], v154 abid:1
s_add_u32 m0, s44, 0
ds_read_u16 v97, v97
v_add_u32_sdwa v86, s42, v135 dst_sel:DWORD dst_unused:UNUSED_PAD src0_sel:DWORD src1_sel:WORD_0
v_smfmac_f32_16x16x64_bf16 v[16:19], a[152:155], v[44:51], v155
buffer_load_dwordx4 v3, s[16:19], s45 offen offset:0 nt lds
v_add_u32_sdwa v87, s42, v135 dst_sel:DWORD dst_unused:UNUSED_PAD src0_sel:DWORD src1_sel:WORD_1
v_smfmac_f32_16x16x64_bf16 v[20:23], a[156:159], v[44:51], v155 abid:1
ds_read_u16 v98, v98
v_add_u32_sdwa v88, s42, v136 dst_sel:DWORD dst_unused:UNUSED_PAD src0_sel:DWORD src1_sel:WORD_0
v_smfmac_f32_16x16x64_bf16 v[24:27], a[160:163], v[44:51], v156
ds_read_u16 v84, v84
v_add_u32_sdwa v89, s42, v136 dst_sel:DWORD dst_unused:UNUSED_PAD src0_sel:DWORD src1_sel:WORD_1
v_smfmac_f32_16x16x64_bf16 v[28:31], a[164:167], v[44:51], v156 abid:1
ds_read_u16 v99, v99
v_add_u32_sdwa v90, s42, v137 dst_sel:DWORD dst_unused:UNUSED_PAD src0_sel:DWORD src1_sel:WORD_0
v_smfmac_f32_16x16x64_bf16 v[32:35], a[168:171], v[44:51], v157
ds_read_u16 v85, v85
v_add_u32_sdwa v91, s42, v137 dst_sel:DWORD dst_unused:UNUSED_PAD src0_sel:DWORD src1_sel:WORD_1
v_smfmac_f32_16x16x64_bf16 v[36:39], a[172:175], v[44:51], v157 abid:1
s_add_u32 m0, s44, 3840
ds_read_u16 v86, v86
v_smfmac_f32_16x16x64_bf16 v[40:43], a[176:179], v[44:51], v176
s_waitcnt lgkmcnt(13)
buffer_load_dwordx4 v3, s[16:19], s45 offen offset:256 nt lds
v_smfmac_f32_16x16x64_bf16 v[8:11], a[180:183], v[52:59], v158
ds_read_b128 v[44:47], v0 offset:12288
v_smfmac_f32_16x16x64_bf16 v[12:15], a[184:187], v[52:59], v158 abid:1
s_waitcnt lgkmcnt(10)
ds_read_b128 v[48:51], v1 offset:12288
v_smfmac_f32_16x16x64_bf16 v[20:23], v[114:117], v[76:83], v181 abid:1
ds_read_u16 v87, v87
v_smfmac_f32_16x16x64_bf16 v[24:27], v[114:117], v[76:83], v182
ds_read_u16 v88, v88
v_smfmac_f32_16x16x64_bf16 v[28:31], v[114:117], v[76:83], v182 abid:1
s_add_u32 m0, s44, 7680
ds_read_b128 v[114:117], v2 offset:768
v_add_u32_sdwa v76, s4, v118 dst_sel:DWORD dst_unused:UNUSED_PAD src0_sel:DWORD src1_sel:WORD_0
v_smfmac_f32_16x16x64_bf16 v[16:19], a[188:191], v[52:59], v159
buffer_load_dwordx4 v3, s[16:19], s45 offen offset:512 nt lds
v_add_u32_sdwa v77, s4, v118 dst_sel:DWORD dst_unused:UNUSED_PAD src0_sel:DWORD src1_sel:WORD_1
v_smfmac_f32_16x16x64_bf16 v[20:23], a[192:195], v[52:59], v159 abid:1
ds_read_b128 v[60:63], v0 offset:14336
v_add_u32_sdwa v78, s4, v119 dst_sel:DWORD dst_unused:UNUSED_PAD src0_sel:DWORD src1_sel:WORD_0
v_smfmac_f32_16x16x64_bf16 v[24:27], a[196:199], v[52:59], v160
ds_read_u16 v89, v89
v_add_u32_sdwa v79, s4, v119 dst_sel:DWORD dst_unused:UNUSED_PAD src0_sel:DWORD src1_sel:WORD_1
v_smfmac_f32_16x16x64_bf16 v[28:31], a[200:203], v[52:59], v160 abid:1
ds_read_b128 v[64:67], v1 offset:14336
v_add_u32_sdwa v80, s4, v120 dst_sel:DWORD dst_unused:UNUSED_PAD src0_sel:DWORD src1_sel:WORD_0
v_smfmac_f32_16x16x64_bf16 v[32:35], a[204:207], v[52:59], v161
ds_read_b128 v[68:71], v0 offset:16384
v_add_u32_sdwa v81, s4, v120 dst_sel:DWORD dst_unused:UNUSED_PAD src0_sel:DWORD src1_sel:WORD_1
v_smfmac_f32_16x16x64_bf16 v[36:39], a[208:211], v[52:59], v161 abid:1
s_add_u32 m0, s44, 11520
ds_read_b128 v[72:75], v1 offset:16384
v_add_u32_sdwa v82, s4, v121 dst_sel:DWORD dst_unused:UNUSED_PAD src0_sel:DWORD src1_sel:WORD_0
v_smfmac_f32_16x16x64_bf16 v[40:43], a[212:215], v[52:59], v176 abid:1
s_waitcnt lgkmcnt(8)
buffer_load_dwordx4 v3, s[16:19], s45 offen offset:768 nt lds
v_add_u32_sdwa v83, s4, v121 dst_sel:DWORD dst_unused:UNUSED_PAD src0_sel:DWORD src1_sel:WORD_1
v_smfmac_f32_16x16x64_bf16 v[8:11], a[216:219], v[44:51], v162
ds_read_u16 v90, v90
v_add_u32 v0, s43, v0
v_smfmac_f32_16x16x64_bf16 v[12:15], a[220:223], v[44:51], v162 abid:1
ds_read_u16 v91, v91
v_add_u32 v1, s43, v1
v_smfmac_f32_16x16x64_bf16 v[16:19], a[224:227], v[44:51], v163
v_smfmac_f32_16x16x64_bf16 v[20:23], a[228:231], v[44:51], v163 abid:1
s_waitcnt lgkmcnt(7)
v_smfmac_f32_16x16x64_bf16 v[28:31], v[114:117], v[92:99], v183
s_add_u32 m0, s44, s8
v_smfmac_f32_16x16x64_bf16 v[32:35], v[114:117], v[92:99], v183 abid:1
s_mov_b64 exec, s[10:11]
buffer_load_dwordx4 v3, s[16:19], s7 offen offset:896 nt lds
s_mov_b64 exec, -1
v_smfmac_f32_16x16x64_bf16 v[36:39], v[114:117], v[92:99], v184
s_add_u32 s45, s45, 4718592
ds_read_b128 v[114:117], v2 offset:832
v_smfmac_f32_16x16x64_bf16 v[24:27], a[232:235], v[44:51], v164
s_add_u32 s7, s7, 4718592
v_smfmac_f32_16x16x64_bf16 v[28:31], a[236:239], v[44:51], v164 abid:1
v_smfmac_f32_16x16x64_bf16 v[32:35], a[240:243], v[44:51], v165
v_smfmac_f32_16x16x64_bf16 v[36:39], a[244:247], v[44:51], v165 abid:1
v_smfmac_f32_16x16x64_bf16 v[40:43], a[248:251], v[44:51], v177
s_waitcnt lgkmcnt(5)
v_smfmac_f32_16x16x64_bf16 v[8:11], a[252:255], v[60:67], v166
s_waitcnt lgkmcnt(3)
v_smfmac_f32_16x16x64_bf16 v[8:11], v[218:221], v[68:75], v170
v_smfmac_f32_16x16x64_bf16 v[12:15], v[186:189], v[60:67], v166 abid:1
v_smfmac_f32_16x16x64_bf16 v[12:15], v[222:225], v[68:75], v170 abid:1
s_waitcnt lgkmcnt(0)
v_smfmac_f32_16x16x64_bf16 v[36:39], v[114:117], v[84:91], v184 abid:1
v_smfmac_f32_16x16x64_bf16 v[40:43], v[114:117], v[84:91], v185
s_waitcnt vmcnt(20)
s_barrier
v_smfmac_f32_16x16x64_bf16 v[16:19], v[190:193], v[60:67], v167
s_mov_b32 s42, s4
ds_read_b128 v[44:47], v0 offset:0
v_cvt_pk_bf16_f32 v92, v8, v9
v_smfmac_f32_16x16x64_bf16 v[16:19], v[226:229], v[68:75], v171
s_cmp_lt_u32 s41, 13
ds_read_b128 v[48:51], v1 offset:0
v_cvt_pk_bf16_f32 v93, v10, v11
v_smfmac_f32_16x16x64_bf16 v[20:23], v[194:197], v[60:67], v167 abid:1
s_cselect_b32 s18, s22, 0
ds_read_b128 v[8:11], v2 offset:0
v_cvt_pk_bf16_f32 v94, v12, v13
v_smfmac_f32_16x16x64_bf16 v[20:23], v[230:233], v[68:75], v171 abid:1
s_add_u32 s44, s44, s5
ds_read_b128 v[52:55], v0 offset:2048
v_cvt_pk_bf16_f32 v95, v14, v15
v_smfmac_f32_16x16x64_bf16 v[24:27], v[198:201], v[60:67], v168
s_cmp_ge_u32 s44, 147456
ds_read_b128 v[12:15], v2 offset:64
v_cvt_pk_bf16_f32 v96, v16, v17
v_smfmac_f32_16x16x64_bf16 v[24:27], v[234:237], v[68:75], v172
s_cselect_b32 s44, s9, s44
ds_read_b128 v[56:59], v1 offset:2048
v_cvt_pk_bf16_f32 v97, v18, v19
v_smfmac_f32_16x16x64_bf16 v[28:31], v[202:205], v[60:67], v168 abid:1
ds_read_b128 v[16:19], v2 offset:128
v_cvt_pk_bf16_f32 v98, v20, v21
v_smfmac_f32_16x16x64_bf16 v[28:31], v[238:241], v[68:75], v172 abid:1
ds_read_u16 v76, v76
v_cvt_pk_bf16_f32 v99, v22, v23
v_smfmac_f32_16x16x64_bf16 v[32:35], v[206:209], v[60:67], v169
ds_read_b128 v[20:23], v2 offset:192
v_cvt_pk_bf16_f32 v100, v24, v25
v_smfmac_f32_16x16x64_bf16 v[32:35], v[242:245], v[68:75], v173
ds_read_u16 v77, v77
v_cvt_pk_bf16_f32 v101, v26, v27
v_smfmac_f32_16x16x64_bf16 v[36:39], v[210:213], v[60:67], v169 abid:1
ds_read_b128 v[24:27], v2 offset:256
v_cvt_pk_bf16_f32 v102, v28, v29
v_smfmac_f32_16x16x64_bf16 v[36:39], v[246:249], v[68:75], v173 abid:1
ds_read_u16 v78, v78
v_cvt_pk_bf16_f32 v103, v30, v31
v_smfmac_f32_16x16x64_bf16 v[40:43], v[214:217], v[60:67], v177 abid:1
s_cmp_lt_u32 s41, 16
ds_read_b128 v[28:31], v2 offset:320
v_cvt_pk_bf16_f32 v104, v32, v33
v_smfmac_f32_16x16x64_bf16 v[40:43], v[250:253], v[68:75], v178
s_waitcnt lgkmcnt(10)
v_cvt_pk_bf16_f32 v105, v34, v35
s_cbranch_scc1 L_loopk
s_nop 7
v_cvt_pk_bf16_f32 v106, v36, v37
v_cvt_pk_bf16_f32 v107, v38, v39
v_cvt_pk_bf16_f32 v112, v40, v41
v_cvt_pk_bf16_f32 v113, v42, v43
s_nop 1
v_cndmask_b32_dpp v108, v96, v92, vcc quad_perm:[1,0,3,2] row_mask:0xf bank_mask:0xf
s_nop 1
v_cndmask_b32_dpp v109, v97, v93, vcc quad_perm:[1,0,3,2] row_mask:0xf bank_mask:0xf
s_nop 1
v_cndmask_b32_dpp v110, v98, v94, vcc quad_perm:[1,0,3,2] row_mask:0xf bank_mask:0xf
s_nop 1
v_cndmask_b32_dpp v111, v99, v95, vcc quad_perm:[1,0,3,2] row_mask:0xf bank_mask:0xf
s_waitcnt lgkmcnt(0)
buffer_store_dwordx4 v[108:111], v4, s[20:23], s46 offen offset:0
s_nop 1
s_mov_b64 vcc, s[82:83]
s_nop 1
v_cndmask_b32_dpp v96, v92, v96, vcc quad_perm:[1,0,3,2] row_mask:0xf bank_mask:0xf
s_nop 1
v_cndmask_b32_dpp v97, v93, v97, vcc quad_perm:[1,0,3,2] row_mask:0xf bank_mask:0xf
s_nop 1
v_cndmask_b32_dpp v98, v94, v98, vcc quad_perm:[1,0,3,2] row_mask:0xf bank_mask:0xf
s_nop 1
v_cndmask_b32_dpp v99, v95, v99, vcc quad_perm:[1,0,3,2] row_mask:0xf bank_mask:0xf
s_waitcnt lgkmcnt(0)
buffer_store_dwordx4 v[96:99], v4, s[20:23], s46 offen offset:1152
s_nop 1
s_mov_b64 vcc, s[80:81]
s_nop 1
v_cndmask_b32_dpp v92, v104, v100, vcc quad_perm:[1,0,3,2] row_mask:0xf bank_mask:0xf
s_nop 1
v_cndmask_b32_dpp v93, v105, v101, vcc quad_perm:[1,0,3,2] row_mask:0xf bank_mask:0xf
s_nop 1
v_cndmask_b32_dpp v94, v106, v102, vcc quad_perm:[1,0,3,2] row_mask:0xf bank_mask:0xf
s_nop 1
ds_bpermute_b32 v112, v6, v112
s_nop 1
v_cndmask_b32_dpp v95, v107, v103, vcc quad_perm:[1,0,3,2] row_mask:0xf bank_mask:0xf
s_waitcnt lgkmcnt(0)
buffer_store_dwordx4 v[92:95], v4, s[20:23], s46 offen offset:128
s_nop 1
s_mov_b64 vcc, s[82:83]
s_nop 1
ds_bpermute_b32 v113, v6, v113
s_nop 1
v_cndmask_b32_dpp v104, v100, v104, vcc quad_perm:[1,0,3,2] row_mask:0xf bank_mask:0xf
s_nop 1
v_cndmask_b32_dpp v105, v101, v105, vcc quad_perm:[1,0,3,2] row_mask:0xf bank_mask:0xf
s_nop 1
v_cndmask_b32_dpp v106, v102, v106, vcc quad_perm:[1,0,3,2] row_mask:0xf bank_mask:0xf
s_nop 1
v_cndmask_b32_dpp v107, v103, v107, vcc quad_perm:[1,0,3,2] row_mask:0xf bank_mask:0xf
s_waitcnt lgkmcnt(0)
buffer_store_dwordx4 v[104:107], v4, s[20:23], s46 offen offset:1280
s_nop 1
s_mov_b64 vcc, s[80:81]
s_waitcnt lgkmcnt(0)
buffer_store_dwordx2 v[112:113], v5, s[20:23], s46 offen
s_nop 1
s_branch L_fin
L_slow:
s_waitcnt vmcnt(0) lgkmcnt(0)
s_mov_b32 s87, 0
L_sm:
s_lshl_b32 s86, s2, 1
s_add_u32 s86, s86, s87
s_add_u32 s86, s86, 1
s_mul_i32 s86, s86, 393216
s_mov_b32 s84, 0
L_st:
s_and_b32 s48, s84, 3
s_lshr_b32 s49, s84, 2
s_sub_u32 s50, s84, 36
s_lshl_b32 s51, s40, 4
s_lshl_b32 s52, s50, 1
s_lshl_b32 s53, s48, 8
s_cmp_lt_u32 s84, 36
s_cselect_b32 s52, s49, s52
s_cselect_b32 s53, s53, 1024
s_cselect_b32 s54, 8, 73728
s_cselect_b32 s55, 32, 8
s_cselect_b32 s56, 16, 32
s_cselect_b32 s57, 128, 64
s_mul_i32 s52, s52, 73728
s_mul_i32 s58, s40, 18432
v_and_b32 v58, 1, v7
v_bfe_u32 v59, v7, 1, 1
v_bfe_u32 v60, v7, 2, 2
v_bfe_u32 v62, v7, 4, 1
v_lshrrev_b32 v63, 5, v7
v_lshl_add_u32 v50, v58, 2, s52
v_mad_u32_u24 v50, v59, s54, v50
v_mad_u32_u24 v50, v60, s55, v50
v_mad_u32_u24 v50, v62, s56, v50
v_mad_u32_u24 v50, v63, s57, v50
v_add_u32 v50, s53, v50
v_add_u32 v50, s58, v50
v_add_u32 v62, 4608, v50
v_add_u32 v63, 9216, v50
v_add_u32 v64, 13824, v50
buffer_load_dword v8, v50, s[28:31], 0 offen offset:0
buffer_load_dword v9, v50, s[28:31], 0 offen offset:1152
buffer_load_dword v10, v50, s[28:31], 0 offen offset:2304
buffer_load_dword v11, v50, s[28:31], 0 offen offset:3456
buffer_load_dword v12, v62, s[28:31], 0 offen offset:0
buffer_load_dword v13, v62, s[28:31], 0 offen offset:1152
buffer_load_dword v14, v62, s[28:31], 0 offen offset:2304
buffer_load_dword v15, v62, s[28:31], 0 offen offset:3456
buffer_load_dword v16, v63, s[28:31], 0 offen offset:0
buffer_load_dword v17, v63, s[28:31], 0 offen offset:1152
buffer_load_dword v18, v63, s[28:31], 0 offen offset:2304
buffer_load_dword v19, v63, s[28:31], 0 offen offset:3456
buffer_load_dword v20, v64, s[28:31], 0 offen offset:0
buffer_load_dword v21, v64, s[28:31], 0 offen offset:1152
buffer_load_dword v22, v64, s[28:31], 0 offen offset:2304
buffer_load_dword v23, v64, s[28:31], 0 offen offset:3456
s_mul_i32 s52, s48, 9
s_add_u32 s52, s52, s49
s_mul_i32 s53, s52, 9
s_mul_i32 s54, s50, 18
s_add_u32 s54, s54, 8
s_lshl_b32 s55, s52, 2
s_add_u32 s55, s55, s40
s_lshl_b32 s56, s50, 2
s_add_u32 s56, s56, s40
s_cmp_eq_u32 s84, 40
s_cselect_b32 s57, 0x100000, 9
s_cmp_lt_u32 s84, 36
s_cselect_b32 s53, s53, s54
s_cselect_b32 s54, 2, 81
s_cselect_b32 s57, 1, s57
s_cselect_b32 s55, s55, s56
s_mov_b32 s56, 331776
s_cselect_b32 s56, s56, 368640
s_mov_b32 s58, 373760
s_cselect_b32 s58, s58, 382976
s_cselect_b32 s59, 16, 4
s_cselect_b32 s60, 4, 64
s_cselect_b32 s61, 12, 11
s_cselect_b32 s62, 0, 0x8000
v_lshrrev_b32 v61, 4, v7
v_lshlrev_b32 v62, 1, v58
v_lshl_add_u32 v60, v60, 2, v62
v_mul_u32_u24 v51, s54, v61
v_mad_u32_u24 v51, v59, s57, v51
v_add_lshl_u32 v51, v51, s53, 6
v_add3_u32 v51, v51, v60, s51
v_lshl_add_u32 v51, v51, 4, s86
s_lshl_b32 s52, s55, 8
s_add_u32 s52, s52, s56
s_add_u32 s52, s52, s86
v_add_u32 v62, v60, v59
v_mul_u32_u24 v52, s59, v62
v_mad_u32_u24 v52, v61, s60, v52
v_add_u32 v52, s52, v52
v_mov_b32 v55, 0x05040100
v_mov_b32 v62, 0x03020706
v_cmp_eq_u32 vcc, 1, v59
v_mov_b32 v56, 0x0f0a0500
v_mov_b32 v57, 0xf0a05000
v_cndmask_b32 v55, v55, v62, vcc
s_mov_b32 s64, 0x5040500
s_mov_b32 s65, 0x5040501
s_mov_b32 s66, 0x5040502
s_mov_b32 s67, 0x5040503
s_mov_b32 s68, 0x7060700
s_mov_b32 s69, 0x7060701
s_mov_b32 s70, 0x7060702
s_mov_b32 s71, 0x7060703
s_mov_b32 s72, 0x05060102
s_cmp_lg_u32 s87, 0
s_waitcnt vmcnt(12)
v_perm_b32 v24, v8, v56, s64
v_perm_b32 v25, v9, v56, s65
v_perm_b32 v26, v10, v56, s66
v_perm_b32 v27, v11, v56, s67
v_max3_f32 v28, |v24|, |v25|, |v26|
v_med3_f32 v29, |v24|, |v25|, |v26|
v_min3_f32 v30, |v24|, |v25|, |v26|
v_med3_f32 v32, v28, v29, |v27|
v_med3_f32 v33, v29, v30, |v27|
v_max_f32 v31, v28, |v27|
v_cmp_eq_u32_sdwa vcc, v33, v32 src0_sel:WORD_1 src1_sel:WORD_1
s_cbranch_scc0 L_rb0g
v_min_f32 v30, v30, |v27|
v_cndmask_b32 v31, 0, v33, vcc
v_cmp_eq_u32_sdwa vcc, v30, v32 src0_sel:WORD_1 src1_sel:WORD_1
s_nop 1
v_cndmask_b32 v32, 0, v30, vcc
L_rb0g:
v_perm_b32 v36, v31, v32, s72
v_bfi_b32 v44, 51, v32, v31
v_perm_b32 v24, v8, v56, s68
v_perm_b32 v25, v9, v56, s69
v_perm_b32 v26, v10, v56, s70
v_perm_b32 v27, v11, v56, s71
v_max3_f32 v28, |v24|, |v25|, |v26|
v_med3_f32 v29, |v24|, |v25|, |v26|
v_min3_f32 v30, |v24|, |v25|, |v26|
v_med3_f32 v32, v28, v29, |v27|
v_med3_f32 v33, v29, v30, |v27|
v_max_f32 v31, v28, |v27|
v_cmp_eq_u32_sdwa vcc, v33, v32 src0_sel:WORD_1 src1_sel:WORD_1
s_cbranch_scc0 L_rb1g
v_min_f32 v30, v30, |v27|
v_cndmask_b32 v31, 0, v33, vcc
v_cmp_eq_u32_sdwa vcc, v30, v32 src0_sel:WORD_1 src1_sel:WORD_1
s_nop 1
v_cndmask_b32 v32, 0, v30, vcc
L_rb1g:
v_perm_b32 v40, v31, v32, s72
v_bfi_b32 v46, 51, v32, v31
s_waitcnt vmcnt(8)
v_perm_b32 v24, v12, v57, s64
v_perm_b32 v25, v13, v57, s65
v_perm_b32 v26, v14, v57, s66
v_perm_b32 v27, v15, v57, s67
v_max3_f32 v28, |v24|, |v25|, |v26|
v_med3_f32 v29, |v24|, |v25|, |v26|
v_min3_f32 v30, |v24|, |v25|, |v26|
v_med3_f32 v32, v28, v29, |v27|
v_med3_f32 v33, v29, v30, |v27|
v_max_f32 v31, v28, |v27|
v_cmp_eq_u32_sdwa vcc, v33, v32 src0_sel:WORD_1 src1_sel:WORD_1
s_cbranch_scc0 L_rb2g
v_min_f32 v30, v30, |v27|
v_cndmask_b32 v31, 0, v33, vcc
v_cmp_eq_u32_sdwa vcc, v30, v32 src0_sel:WORD_1 src1_sel:WORD_1
s_nop 1
v_cndmask_b32 v32, 0, v30, vcc
L_rb2g:
v_perm_b32 v37, v31, v32, s72
v_bfi_b32 v31, 51, v32, v31
v_or_b32 v44, v44, v31
v_perm_b32 v24, v12, v57, s68
v_perm_b32 v25, v13, v57, s69
v_perm_b32 v26, v14, v57, s70
v_perm_b32 v27, v15, v57, s71
v_max3_f32 v28, |v24|, |v25|, |v26|
v_med3_f32 v29, |v24|, |v25|, |v26|
v_min3_f32 v30, |v24|, |v25|, |v26|
v_med3_f32 v32, v28, v29, |v27|
v_med3_f32 v33, v29, v30, |v27|
v_max_f32 v31, v28, |v27|
v_cmp_eq_u32_sdwa vcc, v33, v32 src0_sel:WORD_1 src1_sel:WORD_1
s_cbranch_scc0 L_rb3g
v_min_f32 v30, v30, |v27|
v_cndmask_b32 v31, 0, v33, vcc
v_cmp_eq_u32_sdwa vcc, v30, v32 src0_sel:WORD_1 src1_sel:WORD_1
s_nop 1
v_cndmask_b32 v32, 0, v30, vcc
L_rb3g:
v_perm_b32 v41, v31, v32, s72
v_bfi_b32 v31, 51, v32, v31
v_or_b32 v46, v46, v31
s_waitcnt vmcnt(4)
v_perm_b32 v24, v16, v56, s64
v_perm_b32 v25, v17, v56, s65
v_perm_b32 v26, v18, v56, s66
v_perm_b32 v27, v19, v56, s67
v_max3_f32 v28, |v24|, |v25|, |v26|
v_med3_f32 v29, |v24|, |v25|, |v26|
v_min3_f32 v30, |v24|, |v25|, |v26|
v_med3_f32 v32, v28, v29, |v27|
v_med3_f32 v33, v29, v30, |v27|
v_max_f32 v31, v28, |v27|
v_cmp_eq_u32_sdwa vcc, v33, v32 src0_sel:WORD_1 src1_sel:WORD_1
s_cbranch_scc0 L_rb4g
v_min_f32 v30, v30, |v27|
v_cndmask_b32 v31, 0, v33, vcc
v_cmp_eq_u32_sdwa vcc, v30, v32 src0_sel:WORD_1 src1_sel:WORD_1
s_nop 1
v_cndmask_b32 v32, 0, v30, vcc
L_rb4g:
v_perm_b32 v38, v31, v32, s72
v_bfi_b32 v45, 51, v32, v31
v_perm_b32 v24, v16, v56, s68
v_perm_b32 v25, v17, v56, s69
v_perm_b32 v26, v18, v56, s70
v_perm_b32 v27, v19, v56, s71
v_max3_f32 v28, |v24|, |v25|, |v26|
v_med3_f32 v29, |v24|, |v25|, |v26|
v_min3_f32 v30, |v24|, |v25|, |v26|
v_med3_f32 v32, v28, v29, |v27|
v_med3_f32 v33, v29, v30, |v27|
v_max_f32 v31, v28, |v27|
v_cmp_eq_u32_sdwa vcc, v33, v32 src0_sel:WORD_1 src1_sel:WORD_1
s_cbranch_scc0 L_rb5g
v_min_f32 v30, v30, |v27|
v_cndmask_b32 v31, 0, v33, vcc
v_cmp_eq_u32_sdwa vcc, v30, v32 src0_sel:WORD_1 src1_sel:WORD_1
s_nop 1
v_cndmask_b32 v32, 0, v30, vcc
L_rb5g:
v_perm_b32 v42, v31, v32, s72
v_bfi_b32 v47, 51, v32, v31
s_waitcnt vmcnt(0)
v_perm_b32 v24, v20, v57, s64
v_perm_b32 v25, v21, v57, s65
v_perm_b32 v26, v22, v57, s66
v_perm_b32 v27, v23, v57, s67
v_max3_f32 v28, |v24|, |v25|, |v26|
v_med3_f32 v29, |v24|, |v25|, |v26|
v_min3_f32 v30, |v24|, |v25|, |v26|
v_med3_f32 v32, v28, v29, |v27|
v_med3_f32 v33, v29, v30, |v27|
v_max_f32 v31, v28, |v27|
v_cmp_eq_u32_sdwa vcc, v33, v32 src0_sel:WORD_1 src1_sel:WORD_1
s_cbranch_scc0 L_rb6g
v_min_f32 v30, v30, |v27|
v_cndmask_b32 v31, 0, v33, vcc
v_cmp_eq_u32_sdwa vcc, v30, v32 src0_sel:WORD_1 src1_sel:WORD_1
s_nop 1
v_cndmask_b32 v32, 0, v30, vcc
L_rb6g:
v_perm_b32 v39, v31, v32, s72
v_bfi_b32 v31, 51, v32, v31
v_or_b32 v45, v45, v31
v_perm_b32 v24, v20, v57, s68
v_perm_b32 v25, v21, v57, s69
v_perm_b32 v26, v22, v57, s70
v_perm_b32 v27, v23, v57, s71
v_max3_f32 v28, |v24|, |v25|, |v26|
v_med3_f32 v29, |v24|, |v25|, |v26|
v_min3_f32 v30, |v24|, |v25|, |v26|
v_med3_f32 v32, v28, v29, |v27|
v_med3_f32 v33, v29, v30, |v27|
v_max_f32 v31, v28, |v27|
v_cmp_eq_u32_sdwa vcc, v33, v32 src0_sel:WORD_1 src1_sel:WORD_1
s_cbranch_scc0 L_rb7g
v_min_f32 v30, v30, |v27|
v_cndmask_b32 v31, 0, v33, vcc
v_cmp_eq_u32_sdwa vcc, v30, v32 src0_sel:WORD_1 src1_sel:WORD_1
s_nop 1
v_cndmask_b32 v32, 0, v30, vcc
L_rb7g:
v_perm_b32 v43, v31, v32, s72
v_bfi_b32 v31, 51, v32, v31
v_or_b32 v47, v47, v31
buffer_store_dwordx4 v[36:39], v51, s[24:27], 0 offen sc1
s_mov_b32 s52, 0x0c0c0400
s_mov_b32 s53, 0x04000c0c
v_perm_b32 v48, v45, v44, s52
v_perm_b32 v49, v47, v46, s53
v_or_b32 v48, v48, v49
buffer_store_dwordx4 v[40:43], v51, s[24:27], 0 offen offset:16 sc1
s_nop 0
v_mov_b32_dpp v49, v48 quad_perm:[2,3,0,1] row_mask:0xf bank_mask:0xf
v_perm_b32 v48, v49, v48, v55
buffer_store_dword v48, v52, s[24:27], 0 offen sc1
s_waitcnt vmcnt(0)
s_add_u32 s84, s84, 1
s_cmp_lt_u32 s84, 41
s_cbranch_scc1 L_st
s_add_u32 s87, s87, 1
s_cmp_lt_u32 s87, 2
s_cbranch_scc1 L_sm
v_lshrrev_b32 v72, 3, v7
v_and_b32 v73, 7, v7
v_xor_b32 v73, v73, v72
v_mul_u32_u24 v72, 1152, v72
s_and_b32 s47, s40, 1
s_mul_i32 s47, s47, 9216
s_lshr_b32 s3, s40, 1
s_lshl_b32 s3, s3, 7
s_add_u32 s47, s47, s3
v_lshl_add_u32 v72, v73, 4, v72
v_add_u32 v3, s47, v72
s_lshl_b32 s44, s40, 10
s_mul_i32 s45, s2, 18432
s_mov_b32 s46, s45
s_lshr_b32 s47, s40, 1
s_lshl_b32 s3, s47, 11
s_sub_u32 s8, 15488, s3
s_lshl_b32 s3, s47, 7
s_add_u32 s7, s45, 128
s_sub_u32 s7, s7, s3
s_sub_u32 s10, s47, 1
s_sub_u32 s11, 0, s47
s_mov_b32 s9, s44
s_mov_b32 s22, 75497472
s_mov_b32 s41, 0
L_stile:
s_barrier
s_add_u32 m0, s44, 0
s_nop 0
buffer_load_dwordx4 v3, s[16:19], s45 offen offset:0 nt lds
s_add_u32 m0, s44, 3840
s_nop 0
buffer_load_dwordx4 v3, s[16:19], s45 offen offset:256 nt lds
s_add_u32 m0, s44, 7680
s_nop 0
buffer_load_dwordx4 v3, s[16:19], s45 offen offset:512 nt lds
s_add_u32 m0, s44, 11520
s_nop 0
buffer_load_dwordx4 v3, s[16:19], s45 offen offset:768 nt lds
s_add_u32 m0, s44, s8
s_mov_b64 exec, s[10:11]
buffer_load_dwordx4 v3, s[16:19], s7 offen offset:896 nt lds
s_mov_b64 exec, -1
ds_read_b128 v[8:11], v2 offset:0
ds_read_b128 v[12:15], v2 offset:64
ds_read_b128 v[16:19], v2 offset:128
ds_read_b128 v[20:23], v2 offset:192
ds_read_b128 v[24:27], v2 offset:256
ds_read_b128 v[28:31], v2 offset:320
ds_read_b128 v[32:35], v2 offset:384
ds_read_b128 v[36:39], v2 offset:448
ds_read_b128 v[40:43], v2 offset:512
s_mov_b32 s87, 0
L_spass:
s_lshl_b32 s86, s2, 1
s_add_u32 s86, s86, s87
s_add_u32 s86, s86, 1
s_mul_i32 s86, s86, 393216
s_mul_i32 s47, s40, 82944
s_add_u32 s47, s47, s86
v_lshl_add_u32 v104, v7, 4, s47
s_mul_i32 s47, s40, 9216
s_add_u32 s47, s47, s86
s_add_u32 s47, s47, 331776
v_lshl_add_u32 v105, v7, 4, s47
s_lshl_b32 s47, s40, 6
s_add_u32 s47, s47, s86
s_add_u32 s47, s47, 368640
v_and_b32 v106, 15, v7
v_lshl_add_u32 v106, v106, 2, s47
v_lshrrev_b32 v107, 4, v7
v_lshl_add_u32 v106, v107, 8, v106
buffer_load_dword v174, v106, s[24:27], 0 offen offset:0 sc1
buffer_load_dword v175, v106, s[24:27], 0 offen offset:1024 sc1
buffer_load_dword v176, v106, s[24:27], 0 offen offset:2048 sc1
buffer_load_dword v177, v106, s[24:27], 0 offen offset:3072 sc1
s_mov_b32 s99, 4096
buffer_load_dword v178, v106, s[24:27], s99 offen offset:0 sc1
s_mov_b32 s98, 0
buffer_load_dwordx4 v[138:141], v105, s[24:27], s98 offen sc1
s_mov_b32 s99, 0
buffer_load_dwordx4 a[0:3], v104, s[24:27], s99 offen offset:0 sc1
buffer_load_dwordx4 a[4:7], v104, s[24:27], s99 offen offset:1024 sc1
buffer_load_dwordx4 a[8:11], v104, s[24:27], s99 offen offset:2048 sc1
buffer_load_dwordx4 a[12:15], v104, s[24:27], s99 offen offset:3072 sc1
s_mov_b32 s99, 4096
buffer_load_dwordx4 a[16:19], v104, s[24:27], s99 offen offset:0 sc1
buffer_load_dwordx4 a[20:23], v104, s[24:27], s99 offen offset:1024 sc1
buffer_load_dwordx4 a[24:27], v104, s[24:27], s99 offen offset:2048 sc1
buffer_load_dwordx4 a[28:31], v104, s[24:27], s99 offen offset:3072 sc1
s_mov_b32 s99, 8192
buffer_load_dwordx4 a[32:35], v104, s[24:27], s99 offen offset:0 sc1
s_mov_b32 s98, 1024
buffer_load_dwordx4 v[142:145], v105, s[24:27], s98 offen sc1
buffer_load_dwordx4 a[36:39], v104, s[24:27], s99 offen offset:1024 sc1
buffer_load_dwordx4 a[40:43], v104, s[24:27], s99 offen offset:2048 sc1
buffer_load_dwordx4 a[44:47], v104, s[24:27], s99 offen offset:3072 sc1
s_mov_b32 s99, 12288
buffer_load_dwordx4 a[48:51], v104, s[24:27], s99 offen offset:0 sc1
buffer_load_dwordx4 a[52:55], v104, s[24:27], s99 offen offset:1024 sc1
buffer_load_dwordx4 a[56:59], v104, s[24:27], s99 offen offset:2048 sc1
buffer_load_dwordx4 a[60:63], v104, s[24:27], s99 offen offset:3072 sc1
s_mov_b32 s99, 16384
buffer_load_dwordx4 a[64:67], v104, s[24:27], s99 offen offset:0 sc1
buffer_load_dwordx4 a[68:71], v104, s[24:27], s99 offen offset:1024 sc1
s_mov_b32 s98, 2048
buffer_load_dwordx4 v[146:149], v105, s[24:27], s98 offen sc1
buffer_load_dwordx4 a[72:75], v104, s[24:27], s99 offen offset:2048 sc1
buffer_load_dwordx4 a[76:79], v104, s[24:27], s99 offen offset:3072 sc1
s_mov_b32 s99, 20480
buffer_load_dwordx4 a[80:83], v104, s[24:27], s99 offen offset:0 sc1
buffer_load_dwordx4 a[84:87], v104, s[24:27], s99 offen offset:1024 sc1
buffer_load_dwordx4 a[88:91], v104, s[24:27], s99 offen offset:2048 sc1
buffer_load_dwordx4 a[92:95], v104, s[24:27], s99 offen offset:3072 sc1
s_mov_b32 s99, 24576
buffer_load_dwordx4 a[96:99], v104, s[24:27], s99 offen offset:0 sc1
buffer_load_dwordx4 a[100:103], v104, s[24:27], s99 offen offset:1024 sc1
buffer_load_dwordx4 a[104:107], v104, s[24:27], s99 offen offset:2048 sc1
s_mov_b32 s98, 3072
buffer_load_dwordx4 v[150:153], v105, s[24:27], s98 offen sc1
buffer_load_dwordx4 a[108:111], v104, s[24:27], s99 offen offset:3072 sc1
s_mov_b32 s99, 28672
buffer_load_dwordx4 a[112:115], v104, s[24:27], s99 offen offset:0 sc1
buffer_load_dwordx4 a[116:119], v104, s[24:27], s99 offen offset:1024 sc1
buffer_load_dwordx4 a[120:123], v104, s[24:27], s99 offen offset:2048 sc1
buffer_load_dwordx4 a[124:127], v104, s[24:27], s99 offen offset:3072 sc1
s_mov_b32 s99, 32768
buffer_load_dwordx4 a[128:131], v104, s[24:27], s99 offen offset:0 sc1
buffer_load_dwordx4 a[132:135], v104, s[24:27], s99 offen offset:1024 sc1
buffer_load_dwordx4 a[136:139], v104, s[24:27], s99 offen offset:2048 sc1
buffer_load_dwordx4 a[140:143], v104, s[24:27], s99 offen offset:3072 sc1
s_mov_b32 s98, 4096
buffer_load_dwordx4 v[154:157], v105, s[24:27], s98 offen sc1
s_mov_b32 s99, 36864
buffer_load_dwordx4 a[144:147], v104, s[24:27], s99 offen offset:0 sc1
buffer_load_dwordx4 a[148:151], v104, s[24:27], s99 offen offset:1024 sc1
buffer_load_dwordx4 a[152:155], v104, s[24:27], s99 offen offset:2048 sc1
buffer_load_dwordx4 a[156:159], v104, s[24:27], s99 offen offset:3072 sc1
s_mov_b32 s99, 40960
buffer_load_dwordx4 a[160:163], v104, s[24:27], s99 offen offset:0 sc1
buffer_load_dwordx4 a[164:167], v104, s[24:27], s99 offen offset:1024 sc1
buffer_load_dwordx4 a[168:171], v104, s[24:27], s99 offen offset:2048 sc1
buffer_load_dwordx4 a[172:175], v104, s[24:27], s99 offen offset:3072 sc1
s_mov_b32 s99, 45056
buffer_load_dwordx4 a[176:179], v104, s[24:27], s99 offen offset:0 sc1
s_mov_b32 s98, 5120
buffer_load_dwordx4 v[158:161], v105, s[24:27], s98 offen sc1
buffer_load_dwordx4 a[180:183], v104, s[24:27], s99 offen offset:1024 sc1
buffer_load_dwordx4 a[184:187], v104, s[24:27], s99 offen offset:2048 sc1
buffer_load_dwordx4 a[188:191], v104, s[24:27], s99 offen offset:3072 sc1
s_mov_b32 s99, 49152
buffer_load_dwordx4 a[192:195], v104, s[24:27], s99 offen offset:0 sc1
buffer_load_dwordx4 a[196:199], v104, s[24:27], s99 offen offset:1024 sc1
buffer_load_dwordx4 a[200:203], v104, s[24:27], s99 offen offset:2048 sc1
buffer_load_dwordx4 a[204:207], v104, s[24:27], s99 offen offset:3072 sc1
s_mov_b32 s99, 53248
buffer_load_dwordx4 a[208:211], v104, s[24:27], s99 offen offset:0 sc1
buffer_load_dwordx4 a[212:215], v104, s[24:27], s99 offen offset:1024 sc1
s_mov_b32 s98, 6144
buffer_load_dwordx4 v[162:165], v105, s[24:27], s98 offen sc1
buffer_load_dwordx4 a[216:219], v104, s[24:27], s99 offen offset:2048 sc1
buffer_load_dwordx4 a[220:223], v104, s[24:27], s99 offen offset:3072 sc1
s_mov_b32 s99, 57344
buffer_load_dwordx4 a[224:227], v104, s[24:27], s99 offen offset:0 sc1
buffer_load_dwordx4 a[228:231], v104, s[24:27], s99 offen offset:1024 sc1
buffer_load_dwordx4 a[232:235], v104, s[24:27], s99 offen offset:2048 sc1
buffer_load_dwordx4 a[236:239], v104, s[24:27], s99 offen offset:3072 sc1
s_mov_b32 s99, 61440
buffer_load_dwordx4 a[240:243], v104, s[24:27], s99 offen offset:0 sc1
buffer_load_dwordx4 a[244:247], v104, s[24:27], s99 offen offset:1024 sc1
buffer_load_dwordx4 a[248:251], v104, s[24:27], s99 offen offset:2048 sc1
s_mov_b32 s98, 7168
buffer_load_dwordx4 v[166:169], v105, s[24:27], s98 offen sc1
buffer_load_dwordx4 a[252:255], v104, s[24:27], s99 offen offset:3072 sc1
s_mov_b32 s99, 65536
buffer_load_dwordx4 v[186:189], v104, s[24:27], s99 offen offset:0 sc1
buffer_load_dwordx4 v[190:193], v104, s[24:27], s99 offen offset:1024 sc1
buffer_load_dwordx4 v[194:197], v104, s[24:27], s99 offen offset:2048 sc1
buffer_load_dwordx4 v[198:201], v104, s[24:27], s99 offen offset:3072 sc1
s_mov_b32 s99, 69632
buffer_load_dwordx4 v[202:205], v104, s[24:27], s99 offen offset:0 sc1
buffer_load_dwordx4 v[206:209], v104, s[24:27], s99 offen offset:1024 sc1
buffer_load_dwordx4 v[210:213], v104, s[24:27], s99 offen offset:2048 sc1
buffer_load_dwordx4 v[214:217], v104, s[24:27], s99 offen offset:3072 sc1
s_mov_b32 s98, 8192
buffer_load_dwordx4 v[170:173], v105, s[24:27], s98 offen sc1
s_mov_b32 s99, 73728
buffer_load_dwordx4 v[218:221], v104, s[24:27], s99 offen offset:0 sc1
buffer_load_dwordx4 v[222:225], v104, s[24:27], s99 offen offset:1024 sc1
buffer_load_dwordx4 v[226:229], v104, s[24:27], s99 offen offset:2048 sc1
buffer_load_dwordx4 v[230:233], v104, s[24:27], s99 offen offset:3072 sc1
s_mov_b32 s99, 77824
buffer_load_dwordx4 v[234:237], v104, s[24:27], s99 offen offset:0 sc1
buffer_load_dwordx4 v[238:241], v104, s[24:27], s99 offen offset:1024 sc1
buffer_load_dwordx4 v[242:245], v104, s[24:27], s99 offen offset:2048 sc1
buffer_load_dwordx4 v[246:249], v104, s[24:27], s99 offen offset:3072 sc1
s_mov_b32 s99, 81920
buffer_load_dwordx4 v[250:253], v104, s[24:27], s99 offen offset:0 sc1
s_waitcnt vmcnt(0)
s_barrier
ds_read_b128 v[44:47], v0 offset:0
ds_read_b128 v[48:51], v1 offset:0
s_waitcnt lgkmcnt(0)
v_smfmac_f32_16x16x64_bf16 v[8:11], a[0:3], v[44:51], v138
v_smfmac_f32_16x16x64_bf16 v[12:15], a[4:7], v[44:51], v138 abid:1
v_smfmac_f32_16x16x64_bf16 v[16:19], a[8:11], v[44:51], v139
v_smfmac_f32_16x16x64_bf16 v[20:23], a[12:15], v[44:51], v139 abid:1
v_smfmac_f32_16x16x64_bf16 v[24:27], a[16:19], v[44:51], v140
v_smfmac_f32_16x16x64_bf16 v[28:31], a[20:23], v[44:51], v140 abid:1
v_smfmac_f32_16x16x64_bf16 v[32:35], a[24:27], v[44:51], v141
v_smfmac_f32_16x16x64_bf16 v[36:39], a[28:31], v[44:51], v141 abid:1
v_smfmac_f32_16x16x64_bf16 v[40:43], a[32:35], v[44:51], v174
s_nop 7
ds_read_b128 v[44:47], v0 offset:2048
ds_read_b128 v[48:51], v1 offset:2048
s_waitcnt lgkmcnt(0)
v_smfmac_f32_16x16x64_bf16 v[8:11], a[36:39], v[44:51], v142
v_smfmac_f32_16x16x64_bf16 v[12:15], a[40:43], v[44:51], v142 abid:1
v_smfmac_f32_16x16x64_bf16 v[16:19], a[44:47], v[44:51], v143
v_smfmac_f32_16x16x64_bf16 v[20:23], a[48:51], v[44:51], v143 abid:1
v_smfmac_f32_16x16x64_bf16 v[24:27], a[52:55], v[44:51], v144
v_smfmac_f32_16x16x64_bf16 v[28:31], a[56:59], v[44:51], v144 abid:1
v_smfmac_f32_16x16x64_bf16 v[32:35], a[60:63], v[44:51], v145
v_smfmac_f32_16x16x64_bf16 v[36:39], a[64:67], v[44:51], v145 abid:1
v_smfmac_f32_16x16x64_bf16 v[40:43], a[68:71], v[44:51], v174 abid:1
s_nop 7
ds_read_b128 v[44:47], v0 offset:4096
ds_read_b128 v[48:51], v1 offset:4096
s_waitcnt lgkmcnt(0)
v_smfmac_f32_16x16x64_bf16 v[8:11], a[72:75], v[44:51], v146
v_smfmac_f32_16x16x64_bf16 v[12:15], a[76:79], v[44:51], v146 abid:1
v_smfmac_f32_16x16x64_bf16 v[16:19], a[80:83], v[44:51], v147
v_smfmac_f32_16x16x64_bf16 v[20:23], a[84:87], v[44:51], v147 abid:1
v_smfmac_f32_16x16x64_bf16 v[24:27], a[88:91], v[44:51], v148
v_smfmac_f32_16x16x64_bf16 v[28:31], a[92:95], v[44:51], v148 abid:1
v_smfmac_f32_16x16x64_bf16 v[32:35], a[96:99], v[44:51], v149
v_smfmac_f32_16x16x64_bf16 v[36:39], a[100:103], v[44:51], v149 abid:1
v_smfmac_f32_16x16x64_bf16 v[40:43], a[104:107], v[44:51], v175
s_nop 7
ds_read_b128 v[44:47], v0 offset:6144
ds_read_b128 v[48:51], v1 offset:6144
s_waitcnt lgkmcnt(0)
v_smfmac_f32_16x16x64_bf16 v[8:11], a[108:111], v[44:51], v150
v_smfmac_f32_16x16x64_bf16 v[12:15], a[112:115], v[44:51], v150 abid:1
v_smfmac_f32_16x16x64_bf16 v[16:19], a[116:119], v[44:51], v151
v_smfmac_f32_16x16x64_bf16 v[20:23], a[120:123], v[44:51], v151 abid:1
v_smfmac_f32_16x16x64_bf16 v[24:27], a[124:127], v[44:51], v152
v_smfmac_f32_16x16x64_bf16 v[28:31], a[128:131], v[44:51], v152 abid:1
v_smfmac_f32_16x16x64_bf16 v[32:35], a[132:135], v[44:51], v153
v_smfmac_f32_16x16x64_bf16 v[36:39], a[136:139], v[44:51], v153 abid:1
v_smfmac_f32_16x16x64_bf16 v[40:43], a[140:143], v[44:51], v175 abid:1
s_nop 7
ds_read_b128 v[44:47], v0 offset:8192
ds_read_b128 v[48:51], v1 offset:8192
s_waitcnt lgkmcnt(0)
v_smfmac_f32_16x16x64_bf16 v[8:11], a[144:147], v[44:51], v154
v_smfmac_f32_16x16x64_bf16 v[12:15], a[148:151], v[44:51], v154 abid:1
v_smfmac_f32_16x16x64_bf16 v[16:19], a[152:155], v[44:51], v155
v_smfmac_f32_16x16x64_bf16 v[20:23], a[156:159], v[44:51], v155 abid:1
v_smfmac_f32_16x16x64_bf16 v[24:27], a[160:163], v[44:51], v156
v_smfmac_f32_16x16x64_bf16 v[28:31], a[164:167], v[44:51], v156 abid:1
v_smfmac_f32_16x16x64_bf16 v[32:35], a[168:171], v[44:51], v157
v_smfmac_f32_16x16x64_bf16 v[36:39], a[172:175], v[44:51], v157 abid:1
v_smfmac_f32_16x16x64_bf16 v[40:43], a[176:179], v[44:51], v176
s_nop 7
ds_read_b128 v[44:47], v0 offset:10240
ds_read_b128 v[48:51], v1 offset:10240
s_waitcnt lgkmcnt(0)
v_smfmac_f32_16x16x64_bf16 v[8:11], a[180:183], v[44:51], v158
v_smfmac_f32_16x16x64_bf16 v[12:15], a[184:187], v[44:51], v158 abid:1
v_smfmac_f32_16x16x64_bf16 v[16:19], a[188:191], v[44:51], v159
v_smfmac_f32_16x16x64_bf16 v[20:23], a[192:195], v[44:51], v159 abid:1
v_smfmac_f32_16x16x64_bf16 v[24:27], a[196:199], v[44:51], v160
v_smfmac_f32_16x16x64_bf16 v[28:31], a[200:203], v[44:51], v160 abid:1
v_smfmac_f32_16x16x64_bf16 v[32:35], a[204:207], v[44:51], v161
v_smfmac_f32_16x16x64_bf16 v[36:39], a[208:211], v[44:51], v161 abid:1
v_smfmac_f32_16x16x64_bf16 v[40:43], a[212:215], v[44:51], v176 abid:1
s_nop 7
ds_read_b128 v[44:47], v0 offset:12288
ds_read_b128 v[48:51], v1 offset:12288
s_waitcnt lgkmcnt(0)
v_smfmac_f32_16x16x64_bf16 v[8:11], a[216:219], v[44:51], v162
v_smfmac_f32_16x16x64_bf16 v[12:15], a[220:223], v[44:51], v162 abid:1
v_smfmac_f32_16x16x64_bf16 v[16:19], a[224:227], v[44:51], v163
v_smfmac_f32_16x16x64_bf16 v[20:23], a[228:231], v[44:51], v163 abid:1
v_smfmac_f32_16x16x64_bf16 v[24:27], a[232:235], v[44:51], v164
v_smfmac_f32_16x16x64_bf16 v[28:31], a[236:239], v[44:51], v164 abid:1
v_smfmac_f32_16x16x64_bf16 v[32:35], a[240:243], v[44:51], v165
v_smfmac_f32_16x16x64_bf16 v[36:39], a[244:247], v[44:51], v165 abid:1
v_smfmac_f32_16x16x64_bf16 v[40:43], a[248:251], v[44:51], v177
s_nop 7
ds_read_b128 v[44:47], v0 offset:14336
ds_read_b128 v[48:51], v1 offset:14336
s_waitcnt lgkmcnt(0)
v_smfmac_f32_16x16x64_bf16 v[8:11], a[252:255], v[44:51], v166
v_smfmac_f32_16x16x64_bf16 v[12:15], v[186:189], v[44:51], v166 abid:1
v_smfmac_f32_16x16x64_bf16 v[16:19], v[190:193], v[44:51], v167
v_smfmac_f32_16x16x64_bf16 v[20:23], v[194:197], v[44:51], v167 abid:1
v_smfmac_f32_16x16x64_bf16 v[24:27], v[198:201], v[44:51], v168
v_smfmac_f32_16x16x64_bf16 v[28:31], v[202:205], v[44:51], v168 abid:1
v_smfmac_f32_16x16x64_bf16 v[32:35], v[206:209], v[44:51], v169
v_smfmac_f32_16x16x64_bf16 v[36:39], v[210:213], v[44:51], v169 abid:1
v_smfmac_f32_16x16x64_bf16 v[40:43], v[214:217], v[44:51], v177 abid:1
s_nop 7
ds_read_b128 v[44:47], v0 offset:16384
ds_read_b128 v[48:51], v1 offset:16384
s_waitcnt lgkmcnt(0)
v_smfmac_f32_16x16x64_bf16 v[8:11], v[218:221], v[44:51], v170
v_smfmac_f32_16x16x64_bf16 v[12:15], v[222:225], v[44:51], v170 abid:1
v_smfmac_f32_16x16x64_bf16 v[16:19], v[226:229], v[44:51], v171
v_smfmac_f32_16x16x64_bf16 v[20:23], v[230:233], v[44:51], v171 abid:1
v_smfmac_f32_16x16x64_bf16 v[24:27], v[234:237], v[44:51], v172
v_smfmac_f32_16x16x64_bf16 v[28:31], v[238:241], v[44:51], v172 abid:1
v_smfmac_f32_16x16x64_bf16 v[32:35], v[242:245], v[44:51], v173
v_smfmac_f32_16x16x64_bf16 v[36:39], v[246:249], v[44:51], v173 abid:1
v_smfmac_f32_16x16x64_bf16 v[40:43], v[250:253], v[44:51], v178
s_nop 7
s_add_u32 s87, s87, 1
s_cmp_lt_u32 s87, 2
s_cbranch_scc1 L_spass
v_cvt_pk_bf16_f32 v92, v8, v9
v_cvt_pk_bf16_f32 v93, v10, v11
v_cvt_pk_bf16_f32 v94, v12, v13
v_cvt_pk_bf16_f32 v95, v14, v15
v_cvt_pk_bf16_f32 v96, v16, v17
v_cvt_pk_bf16_f32 v97, v18, v19
v_cvt_pk_bf16_f32 v98, v20, v21
v_cvt_pk_bf16_f32 v99, v22, v23
v_cvt_pk_bf16_f32 v100, v24, v25
v_cvt_pk_bf16_f32 v101, v26, v27
v_cvt_pk_bf16_f32 v102, v28, v29
v_cvt_pk_bf16_f32 v103, v30, v31
v_cvt_pk_bf16_f32 v104, v32, v33
v_cvt_pk_bf16_f32 v105, v34, v35
s_mov_b64 vcc, s[80:81]
s_nop 7
v_cvt_pk_bf16_f32 v106, v36, v37
v_cvt_pk_bf16_f32 v107, v38, v39
v_cvt_pk_bf16_f32 v112, v40, v41
v_cvt_pk_bf16_f32 v113, v42, v43
s_nop 1
v_cndmask_b32_dpp v108, v96, v92, vcc quad_perm:[1,0,3,2] row_mask:0xf bank_mask:0xf
s_nop 1
v_cndmask_b32_dpp v109, v97, v93, vcc quad_perm:[1,0,3,2] row_mask:0xf bank_mask:0xf
s_nop 1
v_cndmask_b32_dpp v110, v98, v94, vcc quad_perm:[1,0,3,2] row_mask:0xf bank_mask:0xf
s_nop 1
v_cndmask_b32_dpp v111, v99, v95, vcc quad_perm:[1,0,3,2] row_mask:0xf bank_mask:0xf
s_waitcnt lgkmcnt(0)
buffer_store_dwordx4 v[108:111], v4, s[20:23], s46 offen offset:0
s_nop 1
s_mov_b64 vcc, s[82:83]
s_nop 1
v_cndmask_b32_dpp v96, v92, v96, vcc quad_perm:[1,0,3,2] row_mask:0xf bank_mask:0xf
s_nop 1
v_cndmask_b32_dpp v97, v93, v97, vcc quad_perm:[1,0,3,2] row_mask:0xf bank_mask:0xf
s_nop 1
v_cndmask_b32_dpp v98, v94, v98, vcc quad_perm:[1,0,3,2] row_mask:0xf bank_mask:0xf
s_nop 1
v_cndmask_b32_dpp v99, v95, v99, vcc quad_perm:[1,0,3,2] row_mask:0xf bank_mask:0xf
s_waitcnt lgkmcnt(0)
buffer_store_dwordx4 v[96:99], v4, s[20:23], s46 offen offset:1152
s_nop 1
s_mov_b64 vcc, s[80:81]
s_nop 1
v_cndmask_b32_dpp v92, v104, v100, vcc quad_perm:[1,0,3,2] row_mask:0xf bank_mask:0xf
s_nop 1
v_cndmask_b32_dpp v93, v105, v101, vcc quad_perm:[1,0,3,2] row_mask:0xf bank_mask:0xf
s_nop 1
v_cndmask_b32_dpp v94, v106, v102, vcc quad_perm:[1,0,3,2] row_mask:0xf bank_mask:0xf
s_nop 1
ds_bpermute_b32 v112, v6, v112
s_nop 1
v_cndmask_b32_dpp v95, v107, v103, vcc quad_perm:[1,0,3,2] row_mask:0xf bank_mask:0xf
s_waitcnt lgkmcnt(0)
buffer_store_dwordx4 v[92:95], v4, s[20:23], s46 offen offset:128
s_nop 1
s_mov_b64 vcc, s[82:83]
s_nop 1
v_cndmask_b32_dpp v104, v100, v104, vcc quad_perm:[1,0,3,2] row_mask:0xf bank_mask:0xf
s_nop 1
v_cndmask_b32_dpp v105, v101, v105, vcc quad_perm:[1,0,3,2] row_mask:0xf bank_mask:0xf
s_nop 1
ds_bpermute_b32 v113, v6, v113
s_nop 1
v_cndmask_b32_dpp v106, v102, v106, vcc quad_perm:[1,0,3,2] row_mask:0xf bank_mask:0xf
s_nop 1
v_cndmask_b32_dpp v107, v103, v107, vcc quad_perm:[1,0,3,2] row_mask:0xf bank_mask:0xf
s_waitcnt lgkmcnt(0)
buffer_store_dwordx4 v[104:107], v4, s[20:23], s46 offen offset:1280
s_nop 1
s_mov_b64 vcc, s[80:81]
s_waitcnt lgkmcnt(0)
buffer_store_dwordx2 v[112:113], v5, s[20:23], s46 offen
s_nop 1
s_add_u32 s45, s45, 4718592
s_add_u32 s7, s7, 4718592
s_add_u32 s46, s46, 4718592
s_add_u32 s41, s41, 1
s_cmp_lt_u32 s41, 16
s_cbranch_scc1 L_stile
s_branch L_fin
.section .rodata,"a"
.p2align 6
.amdhsa_kernel standalone__structured_sparse_n_m__ragged_kernel
  .amdhsa_next_free_vgpr 512
  .amdhsa_next_free_sgpr 102
  .amdhsa_accum_offset 256
  .amdhsa_group_segment_fixed_size 0
  .amdhsa_float_denorm_mode_32 3
  .amdhsa_kernarg_size 48
  .amdhsa_user_sgpr_count 2
  .amdhsa_user_sgpr_kernarg_segment_ptr 1
  .amdhsa_system_sgpr_workgroup_id_x 1
.end_amdhsa_kernel
```

```asm
; @launch grid=(256,1,1) block=(256,1,1) lds=163840
.amdgcn_target "amdgcn-amd-amdhsa--gfx950"
.text
.globl standalone__structured_sparse_n_m__ragged_kernel
.p2align 8
.type standalone__structured_sparse_n_m__ragged_kernel,@function
standalone__structured_sparse_n_m__ragged_kernel:
s_cmp_ge_u32 s2, 256
s_cbranch_scc1 L_end_standalone__structured_sparse_n_m__ragged_kernel
s_load_dwordx8 s[4:11], s[0:1], 0
s_load_dwordx4 s[12:15], s[0:1], 32
s_getpc_b64 s[96:97]
v_lshrrev_b32 v2, 1, v0
v_lshlrev_b32 v2, 7, v2
global_load_dword v120, v2, s[96:97]
v_lshrrev_b32 v1, 6, v0
v_and_b32 v7, 63, v0
v_readfirstlane_b32 s40, v1
s_mov_b32 s18, 75497472
s_mov_b32 s19, 0x20000
s_mov_b32 s22, 0
s_mov_b32 s23, 0x20000
s_mov_b32 s26, 301989888
s_mov_b32 s27, 0x20000
s_mov_b32 s30, 663552
s_mov_b32 s31, 0x20000
s_mov_b32 s34, 1152
s_mov_b32 s35, 0x20000
s_mov_b32 s38, 256
s_mov_b32 s39, 0x20000
s_mov_b32 s86, 0
s_lshr_b32 s84, s2, 3
s_mul_i32 s84, s84, 2
s_and_b32 s47, s2, 7
s_add_u32 s84, s84, s47
s_cmp_lt_u32 s47, 2
s_cselect_b32 s84, s84, 63
s_cmp_lt_u32 s84, 41
s_cbranch_scc1 L_prod
s_mov_b32 s85, 0x301fff
s_mov_b32 s47, 0x301fff
s_bitcmp1_b32 s2, 0
s_cselect_b32 s85, s85, 0x801fe0
s_cselect_b32 s47, s47, 0x801fe0
s_bitcmp1_b32 s2, 3
s_cselect_b32 s85, s47, s85
v_lshrrev_b32 v72, 3, v7
v_and_b32 v73, 7, v7
v_xor_b32 v73, v73, v72
v_mul_u32_u24 v72, 1152, v72
s_and_b32 s47, s40, 1
s_mul_i32 s47, s47, 9216
s_lshr_b32 s3, s40, 1
s_lshl_b32 s3, s3, 7
s_add_u32 s47, s47, s3
v_lshl_add_u32 v72, v73, 4, v72
v_add_u32 v3, s47, v72
s_lshl_b32 s44, s40, 10
s_mul_i32 s45, s2, 18432
s_mov_b32 s46, s45
s_waitcnt lgkmcnt(0)
s_mov_b32 s28, s6
s_and_b32 s29, s7, 0xffff
s_mov_b32 s16, s4
s_and_b32 s17, s5, 0xffff
s_mov_b32 s24, s14
s_and_b32 s25, s15, 0xffff
s_mov_b32 s32, s8
s_and_b32 s33, s9, 0xffff
s_mov_b32 s20, s10
s_and_b32 s21, s11, 0xffff
s_mov_b32 s36, s12
s_and_b32 s37, s13, 0xffff
L_cons3:
s_lshr_b32 s47, s40, 1
s_lshl_b32 s3, s47, 11
s_sub_u32 s8, 15488, s3
s_lshl_b32 s3, s47, 7
s_add_u32 s7, s45, 128
s_sub_u32 s7, s7, s3
s_sub_u32 s10, s47, 1
s_sub_u32 s11, 0, s47
s_mov_b32 s9, s44
s_mov_b32 s13, 4718592
s_mov_b32 s15, 16
s_mov_b32 s14, s13
s_bfe_u32 s88, s85, 0x40014
L_pf:
s_add_u32 m0, s44, 0
s_nop 0
buffer_load_dwordx4 v3, s[16:19], s45 offen offset:0 nt lds
s_add_u32 m0, s44, 3840
s_nop 0
buffer_load_dwordx4 v3, s[16:19], s45 offen offset:256 nt lds
s_add_u32 m0, s44, 7680
s_nop 0
buffer_load_dwordx4 v3, s[16:19], s45 offen offset:512 nt lds
s_add_u32 m0, s44, 11520
s_nop 0
buffer_load_dwordx4 v3, s[16:19], s45 offen offset:768 nt lds
s_add_u32 m0, s44, s8
s_mov_b64 exec, s[10:11]
buffer_load_dwordx4 v3, s[16:19], s7 offen offset:896 nt lds
s_mov_b64 exec, -1
s_add_u32 s7, s7, s13
s_add_u32 s44, s44, 18432
s_add_u32 s45, s45, s13
s_mov_b32 s13, 4718592
s_sub_u32 s88, s88, 1
s_cmp_lg_u32 s88, 0
s_cbranch_scc1 L_pf
L_pf_e:
s_branch L_rest
L_prod:
s_and_b32 s48, s84, 3
s_lshr_b32 s49, s84, 2
s_sub_u32 s50, s84, 36
s_lshl_b32 s51, s40, 4
s_lshl_b32 s52, s50, 1
s_lshl_b32 s53, s48, 8
s_cmp_lt_u32 s84, 36
s_cselect_b32 s52, s49, s52
s_cselect_b32 s53, s53, 1024
s_cselect_b32 s54, 8, 73728
s_cselect_b32 s55, 32, 8
s_cselect_b32 s56, 16, 32
s_cselect_b32 s57, 128, 64
s_mul_i32 s52, s52, 73728
s_mul_i32 s58, s40, 18432
v_and_b32 v58, 1, v7
v_bfe_u32 v59, v7, 1, 1
v_bfe_u32 v60, v7, 2, 2
v_bfe_u32 v62, v7, 4, 1
v_lshrrev_b32 v63, 5, v7
v_lshl_add_u32 v50, v58, 2, s52
v_mad_u32_u24 v50, v59, s54, v50
v_mad_u32_u24 v50, v60, s55, v50
v_mad_u32_u24 v50, v62, s56, v50
v_mad_u32_u24 v50, v63, s57, v50
v_add_u32 v50, s53, v50
v_add_u32 v50, s58, v50
v_add_u32 v62, 4608, v50
v_add_u32 v63, 9216, v50
v_add_u32 v64, 13824, v50
s_waitcnt lgkmcnt(0)
s_mov_b32 s28, s6
s_and_b32 s29, s7, 0xffff
buffer_load_dword v8, v50, s[28:31], 0 offen offset:0
buffer_load_dword v9, v50, s[28:31], 0 offen offset:1152
buffer_load_dword v10, v50, s[28:31], 0 offen offset:2304
buffer_load_dword v11, v50, s[28:31], 0 offen offset:3456
buffer_load_dword v12, v62, s[28:31], 0 offen offset:0
buffer_load_dword v13, v62, s[28:31], 0 offen offset:1152
buffer_load_dword v14, v62, s[28:31], 0 offen offset:2304
buffer_load_dword v15, v62, s[28:31], 0 offen offset:3456
buffer_load_dword v16, v63, s[28:31], 0 offen offset:0
buffer_load_dword v17, v63, s[28:31], 0 offen offset:1152
buffer_load_dword v18, v63, s[28:31], 0 offen offset:2304
buffer_load_dword v19, v63, s[28:31], 0 offen offset:3456
buffer_load_dword v20, v64, s[28:31], 0 offen offset:0
buffer_load_dword v21, v64, s[28:31], 0 offen offset:1152
buffer_load_dword v22, v64, s[28:31], 0 offen offset:2304
buffer_load_dword v23, v64, s[28:31], 0 offen offset:3456
s_mov_b32 s16, s4
s_and_b32 s17, s5, 0xffff
s_mov_b32 s24, s14
s_and_b32 s25, s15, 0xffff
s_mov_b32 s32, s8
s_and_b32 s33, s9, 0xffff
s_mov_b32 s20, s10
s_and_b32 s21, s11, 0xffff
s_mov_b32 s36, s12
s_and_b32 s37, s13, 0xffff
s_mul_i32 s52, s48, 9
s_add_u32 s52, s52, s49
s_mul_i32 s53, s52, 9
s_mul_i32 s54, s50, 18
s_add_u32 s54, s54, 8
s_lshl_b32 s55, s52, 2
s_add_u32 s55, s55, s40
s_lshl_b32 s56, s50, 2
s_add_u32 s56, s56, s40
s_cmp_eq_u32 s84, 40
s_cselect_b32 s57, 0x100000, 9
s_cmp_lt_u32 s84, 36
s_cselect_b32 s53, s53, s54
s_cselect_b32 s54, 2, 81
s_cselect_b32 s57, 1, s57
s_cselect_b32 s55, s55, s56
s_mov_b32 s56, 331776
s_cselect_b32 s56, s56, 368640
s_mov_b32 s58, 373760
s_cselect_b32 s58, s58, 382976
s_cselect_b32 s59, 16, 4
s_cselect_b32 s60, 4, 64
s_cselect_b32 s61, 12, 11
s_cselect_b32 s62, 1, 0x8001
v_lshrrev_b32 v61, 4, v7
v_lshlrev_b32 v62, 1, v58
v_lshl_add_u32 v60, v60, 2, v62
v_add_u32 v62, v60, v59
v_mul_u32_u24 v51, s54, v61
v_add_lshl_u32 v51, v51, s53, 6
v_add3_u32 v51, v51, v62, s51
v_lshl_add_u32 v51, v51, 4, s86
s_lshl_b32 s57, s57, 10
v_add_u32 v66, s57, v51
s_lshl_b32 s52, s55, 8
s_add_u32 s52, s52, s56
s_add_u32 s52, s52, s86
v_mul_u32_u24 v52, s59, v62
v_mad_u32_u24 v52, v61, s60, v52
v_add_u32 v52, s52, v52
s_lshl_b32 s52, s55, 6
s_add_u32 s58, s58, s52
s_add_u32 s58, s58, s86
s_lshl_b32 s52, s51, 1
s_add_u32 s52, s52, s62
v_lshl_add_u32 v62, v61, 1, v59
v_lshlrev_b32 v62, s61, v62
v_lshl_add_u32 v53, v60, 7, v62
v_add_u32 v53, s52, v53
v_lshl_add_u32 v65, v7, 2, s58
s_mov_b32 s75, 0
s_mov_b32 s73, 0x05060100
s_mov_b32 s74, 0xffff
v_mov_b32 v55, 0x05040100
v_mov_b32 v62, 0x03020706
v_cmp_eq_u32 vcc, 1, v59
v_mov_b32 v68, 0xf0a0500
v_mov_b32 v69, 0x8f8a8580
v_mov_b32 v70, 0x1f1a1510
v_mov_b32 v71, 0x9f9a9590
v_mov_b32 v72, 0x2f2a2520
v_mov_b32 v73, 0xafaaa5a0
v_mov_b32 v74, 0x3f3a3530
v_mov_b32 v75, 0xbfbab5b0
v_cndmask_b32 v55, v55, v62, vcc
v_mov_b64 v[76:77], 0
v_mov_b64 v[78:79], 0
v_mov_b64 v[80:81], 0
v_mov_b32 v82, 0
s_mov_b32 s64, 0x5040500
s_mov_b32 s65, 0x5040501
s_mov_b32 s66, 0x5040502
s_mov_b32 s67, 0x5040503
s_mov_b32 s68, 0x7060700
s_mov_b32 s69, 0x7060701
s_mov_b32 s70, 0x7060702
s_mov_b32 s71, 0x7060703
s_mov_b32 s72, 0x05060102
s_waitcnt vmcnt(12)
v_perm_b32 v24, v8, v68, s64
v_perm_b32 v25, v9, v68, s65
v_perm_b32 v26, v10, v68, s66
v_perm_b32 v27, v11, v68, s67
v_max3_f32 v28, |v24|, |v25|, |v26|
v_med3_f32 v29, |v24|, |v25|, |v26|
v_min3_f32 v30, |v24|, |v25|, |v26|
v_med3_f32 v32, v28, v29, |v27|
v_med3_f32 v33, v29, v30, |v27|
v_max_f32 v31, v28, |v27|
v_perm_b32 v36, v31, v32, s72
v_bfi_b32 v44, 3, v32, v31
v_cmpx_eq_u32_sdwa vcc, v33, v32 src0_sel:WORD_1 src1_sel:WORD_1
v_mov_b32 v76, v33
v_min_f32 v77, v30, |v27|
s_mov_b64 exec, -1
v_perm_b32 v24, v8, v69, s68
v_perm_b32 v25, v9, v69, s69
v_perm_b32 v26, v10, v69, s70
v_perm_b32 v27, v11, v69, s71
v_max3_f32 v28, |v24|, |v25|, |v26|
v_med3_f32 v29, |v24|, |v25|, |v26|
v_min3_f32 v30, |v24|, |v25|, |v26|
v_med3_f32 v32, v28, v29, |v27|
v_med3_f32 v33, v29, v30, |v27|
v_max_f32 v31, v28, |v27|
v_perm_b32 v40, v31, v32, s72
v_bfi_b32 v46, 3, v32, v31
v_cmpx_eq_u32_sdwa vcc, v33, v32 src0_sel:WORD_1 src1_sel:WORD_1
v_mov_b64 v[78:79], v[76:77]
v_mov_b32 v76, v33
v_min_f32 v77, v30, |v27|
s_mov_b64 exec, -1
s_waitcnt vmcnt(8)
v_perm_b32 v24, v12, v70, s64
v_perm_b32 v25, v13, v70, s65
v_perm_b32 v26, v14, v70, s66
v_perm_b32 v27, v15, v70, s67
v_max3_f32 v28, |v24|, |v25|, |v26|
v_med3_f32 v29, |v24|, |v25|, |v26|
v_min3_f32 v30, |v24|, |v25|, |v26|
v_med3_f32 v32, v28, v29, |v27|
v_med3_f32 v33, v29, v30, |v27|
v_max_f32 v31, v28, |v27|
v_perm_b32 v37, v31, v32, s72
v_bfi_b32 v31, 3, v32, v31
v_lshlrev_b32 v31, 4, v31
v_bfi_b32 v44, 15, v44, v31
v_cmpx_eq_u32_sdwa vcc, v33, v32 src0_sel:WORD_1 src1_sel:WORD_1
v_mov_b64 v[80:81], v[78:79]
v_mov_b64 v[78:79], v[76:77]
v_mov_b32 v76, v33
v_min_f32 v77, v30, |v27|
s_mov_b64 exec, -1
v_perm_b32 v24, v12, v71, s68
v_perm_b32 v25, v13, v71, s69
v_perm_b32 v26, v14, v71, s70
v_perm_b32 v27, v15, v71, s71
v_max3_f32 v28, |v24|, |v25|, |v26|
v_med3_f32 v29, |v24|, |v25|, |v26|
v_min3_f32 v30, |v24|, |v25|, |v26|
v_med3_f32 v32, v28, v29, |v27|
v_med3_f32 v33, v29, v30, |v27|
v_max_f32 v31, v28, |v27|
v_perm_b32 v41, v31, v32, s72
v_bfi_b32 v31, 3, v32, v31
v_lshlrev_b32 v31, 4, v31
v_bfi_b32 v46, 15, v46, v31
v_cmpx_eq_u32_sdwa vcc, v33, v32 src0_sel:WORD_1 src1_sel:WORD_1
v_or_b32 v82, v82, v80
v_mov_b64 v[80:81], v[78:79]
v_mov_b64 v[78:79], v[76:77]
v_mov_b32 v76, v33
v_min_f32 v77, v30, |v27|
s_mov_b64 exec, -1
s_waitcnt vmcnt(4)
v_perm_b32 v24, v16, v72, s64
v_perm_b32 v25, v17, v72, s65
v_perm_b32 v26, v18, v72, s66
v_perm_b32 v27, v19, v72, s67
v_max3_f32 v28, |v24|, |v25|, |v26|
v_med3_f32 v29, |v24|, |v25|, |v26|
v_min3_f32 v30, |v24|, |v25|, |v26|
v_med3_f32 v32, v28, v29, |v27|
v_med3_f32 v33, v29, v30, |v27|
v_max_f32 v31, v28, |v27|
v_perm_b32 v38, v31, v32, s72
v_bfi_b32 v45, 3, v32, v31
v_cmpx_eq_u32_sdwa vcc, v33, v32 src0_sel:WORD_1 src1_sel:WORD_1
v_or_b32 v82, v82, v80
v_mov_b64 v[80:81], v[78:79]
v_mov_b64 v[78:79], v[76:77]
v_mov_b32 v76, v33
v_min_f32 v77, v30, |v27|
s_mov_b64 exec, -1
v_perm_b32 v24, v16, v73, s68
v_perm_b32 v25, v17, v73, s69
v_perm_b32 v26, v18, v73, s70
v_perm_b32 v27, v19, v73, s71
v_max3_f32 v28, |v24|, |v25|, |v26|
v_med3_f32 v29, |v24|, |v25|, |v26|
v_min3_f32 v30, |v24|, |v25|, |v26|
v_med3_f32 v32, v28, v29, |v27|
v_med3_f32 v33, v29, v30, |v27|
v_max_f32 v31, v28, |v27|
v_perm_b32 v42, v31, v32, s72
v_bfi_b32 v47, 3, v32, v31
v_cmpx_eq_u32_sdwa vcc, v33, v32 src0_sel:WORD_1 src1_sel:WORD_1
v_or_b32 v82, v82, v80
v_mov_b64 v[80:81], v[78:79]
v_mov_b64 v[78:79], v[76:77]
v_mov_b32 v76, v33
v_min_f32 v77, v30, |v27|
s_mov_b64 exec, -1
s_waitcnt vmcnt(0)
v_perm_b32 v24, v20, v74, s64
v_perm_b32 v25, v21, v74, s65
v_perm_b32 v26, v22, v74, s66
v_perm_b32 v27, v23, v74, s67
v_max3_f32 v28, |v24|, |v25|, |v26|
v_med3_f32 v29, |v24|, |v25|, |v26|
v_min3_f32 v30, |v24|, |v25|, |v26|
v_med3_f32 v32, v28, v29, |v27|
v_med3_f32 v33, v29, v30, |v27|
v_max_f32 v31, v28, |v27|
v_perm_b32 v39, v31, v32, s72
v_bfi_b32 v31, 3, v32, v31
v_lshlrev_b32 v31, 4, v31
v_bfi_b32 v45, 15, v45, v31
v_cmpx_eq_u32_sdwa vcc, v33, v32 src0_sel:WORD_1 src1_sel:WORD_1
v_or_b32 v82, v82, v80
v_mov_b64 v[80:81], v[78:79]
v_mov_b64 v[78:79], v[76:77]
v_mov_b32 v76, v33
v_min_f32 v77, v30, |v27|
s_mov_b64 exec, -1
v_perm_b32 v24, v20, v75, s68
v_perm_b32 v25, v21, v75, s69
v_perm_b32 v26, v22, v75, s70
v_perm_b32 v27, v23, v75, s71
v_max3_f32 v28, |v24|, |v25|, |v26|
v_med3_f32 v29, |v24|, |v25|, |v26|
v_min3_f32 v30, |v24|, |v25|, |v26|
v_med3_f32 v32, v28, v29, |v27|
v_med3_f32 v33, v29, v30, |v27|
v_max_f32 v31, v28, |v27|
v_perm_b32 v43, v31, v32, s72
v_bfi_b32 v31, 3, v32, v31
v_lshlrev_b32 v31, 4, v31
v_bfi_b32 v47, 15, v47, v31
v_cmpx_eq_u32_sdwa vcc, v33, v32 src0_sel:WORD_1 src1_sel:WORD_1
v_or_b32 v82, v82, v80
v_mov_b64 v[80:81], v[78:79]
v_mov_b64 v[78:79], v[76:77]
v_mov_b32 v76, v33
v_min_f32 v77, v30, |v27|
s_mov_b64 exec, -1
s_mov_b32 vcc_lo, 0x33333333
s_mov_b32 vcc_hi, 0x33333333
v_cndmask_b32_dpp v24, v40, v36, vcc quad_perm:[2,3,0,1] row_mask:0xf bank_mask:0xf
v_cndmask_b32_dpp v25, v41, v37, vcc quad_perm:[2,3,0,1] row_mask:0xf bank_mask:0xf
v_cndmask_b32_dpp v26, v42, v38, vcc quad_perm:[2,3,0,1] row_mask:0xf bank_mask:0xf
v_cndmask_b32_dpp v27, v43, v39, vcc quad_perm:[2,3,0,1] row_mask:0xf bank_mask:0xf
s_not_b64 vcc, vcc
buffer_store_dwordx4 v[24:27], v51, s[24:27], 0 offen sc1
v_cndmask_b32_dpp v40, v36, v40, vcc quad_perm:[2,3,0,1] row_mask:0xf bank_mask:0xf
v_cndmask_b32_dpp v41, v37, v41, vcc quad_perm:[2,3,0,1] row_mask:0xf bank_mask:0xf
v_cndmask_b32_dpp v42, v38, v42, vcc quad_perm:[2,3,0,1] row_mask:0xf bank_mask:0xf
v_cndmask_b32_dpp v43, v39, v43, vcc quad_perm:[2,3,0,1] row_mask:0xf bank_mask:0xf
s_mov_b32 s52, 0x0c0c0400
s_mov_b32 s53, 0x04000c0c
buffer_store_dwordx4 v[40:43], v66, s[24:27], 0 offen sc1
v_perm_b32 v48, v45, v44, s52
v_perm_b32 v49, v47, v46, s53
v_or_b32 v48, v48, v49
s_nop 1
v_mov_b32_dpp v49, v48 quad_perm:[2,3,0,1] row_mask:0xf bank_mask:0xf
v_perm_b32 v48, v49, v48, v55
buffer_store_dword v48, v52, s[24:27], 0 offen sc1
v_cmp_lt_u32 s[50:51], s74, v82
L_emit:
v_cmp_lt_u32 vcc, s74, v76
v_cmp_eq_u32_sdwa s[48:49], v77, v76 src0_sel:WORD_1 src1_sel:WORD_1
v_perm_b32 v63, v76, v53, s73
v_bfe_u32 v62, v76, 2, 4
v_and_b32 v64, 0x80, v76
v_lshl_add_u32 v63, v62, 1, v63
v_mbcnt_lo_u32_b32 v62, vcc_lo, 0
v_mbcnt_hi_u32_b32 v62, vcc_hi, v62
v_add_u32 v63, v64, v63
v_add_u32 v62, s75, v62
s_bcnt1_i32_b64 s52, vcc
s_add_u32 s75, s75, s52
v_cmp_gt_u32 s[52:53], 15, v62
v_lshl_add_u32 v62, v62, 2, s58
s_and_b64 s[48:49], s[48:49], vcc
s_and_b64 exec, s[52:53], vcc
s_cbranch_execz L_emit1
buffer_store_dword v63, v62, s[24:27], 0 offen sc1
L_emit1:
s_mov_b64 exec, s[48:49]
v_mov_b32 v76, v77
v_mov_b32 v77, 0
s_not_b64 exec, exec
v_mov_b64 v[76:77], v[78:79]
v_mov_b64 v[78:79], v[80:81]
v_mov_b64 v[80:81], 0
s_mov_b64 exec, -1
v_or3_b32 v62, v76, v78, v80
v_cmp_lt_u32 vcc, s74, v62
s_cmp_lg_u64 s[50:51], 0
s_cselect_b32 s52, 99, s75
s_cmp_gt_u32 s52, 15
s_cselect_b32 s52, -1, 0
s_min_u32 s53, s75, 15
s_cbranch_vccnz L_emit
s_lshl_b32 s53, -1, s53
v_mov_b32 v62, s52
s_and_b32 exec_lo, s53, 0xffff
s_mov_b32 exec_hi, 0
buffer_store_dword v62, v65, s[24:27], 0 offen sc1
s_mov_b64 exec, -1
s_waitcnt vmcnt(0)
s_mov_b32 s85, 0x2101fff
s_mov_b32 s47, 0x2101fff
s_bitcmp1_b32 s2, 0
s_cselect_b32 s85, s85, 0x2201ffe
s_cselect_b32 s47, s47, 0x2201ffe
s_bitcmp1_b32 s2, 3
s_cselect_b32 s85, s47, s85
s_barrier
s_cmp_lg_u32 s40, 0
s_cbranch_scc1 L_cons2
v_mov_b32 v8, 1
s_mov_b64 exec, 1
buffer_atomic_add v8, off, s[36:39], 0 offset:128 sc0 sc1
v_mov_b32 v9, 1
s_waitcnt vmcnt(0)
v_readfirstlane_b32 s47, v8
s_nop 3
s_cmp_lg_u32 s47, 40
s_cbranch_scc1 L_notlast
buffer_store_dword v9, off, s[36:39], 0 sc1
L_notlast:
s_mov_b64 exec, -1
L_cons2:
v_lshrrev_b32 v72, 3, v7
v_and_b32 v73, 7, v7
v_xor_b32 v73, v73, v72
v_mul_u32_u24 v72, 1152, v72
s_and_b32 s47, s40, 1
s_mul_i32 s47, s47, 9216
s_lshr_b32 s3, s40, 1
s_lshl_b32 s3, s3, 7
s_add_u32 s47, s47, s3
v_lshl_add_u32 v72, v73, 4, v72
v_add_u32 v3, s47, v72
s_lshl_b32 s44, s40, 10
s_mul_i32 s45, s2, 18432
s_mov_b32 s46, s45
s_barrier
s_branch L_cons3
L_rest:
s_mov_b32 s92, 0xc002
s_mov_b32 s3, 0xc006
s_cmp_lt_u32 s84, 41
s_cselect_b32 s92, s3, s92
s_mov_b32 s87, 0x2
s_mov_b32 s3, 0x0
s_cmp_lt_u32 s84, 41
s_cselect_b32 s87, s3, s87
v_and_b32 v80, 3, v7
v_bfe_u32 v81, v7, 2, 2
v_bfe_u32 v82, v7, 4, 1
v_lshlrev_b32 v81, 3, v81
v_lshl_add_u32 v81, v80, 5, v81
v_lshl_add_u32 v81, v82, 7, v81
s_lshl_b32 s47, s40, 8
v_add_u32 v81, s47, v81
s_lshl_b32 s47, s40, 5
s_add_u32 s47, s47, 1024
v_lshl_add_u32 v80, v80, 3, s47
v_cmp_gt_u32 vcc, 32, v7
s_nop 1
v_cndmask_b32 v80, v80, v81, vcc
buffer_load_dwordx2 v[110:111], v80, s[32:35], 0 offen
v_and_b32 v72, 15, v7
v_lshrrev_b32 v73, 4, v7
v_and_b32 v74, 7, v7
v_xor_b32 v74, v74, v73
v_lshlrev_b32 v74, 4, v74
v_lshl_add_u32 v0, v72, 7, v74
v_xor_b32 v1, 64, v0
s_mul_i32 s93, s40, 3584
s_add_u32 s93, s93, 147456
v_lshl_add_u32 v2, v73, 4, s93
v_and_b32 v74, 14, v7
v_mul_u32_u24 v4, 1152, v74
v_and_b32 v74, 1, v7
v_lshl_add_u32 v4, v74, 4, v4
v_lshl_add_u32 v4, v73, 5, v4
s_lshl_b32 s47, s40, 8
v_add_u32 v4, s47, v4
s_lshl_b32 s47, s40, 5
s_add_u32 s47, s47, 1024
v_lshrrev_b32 v72, 2, v7
v_and_b32 v73, 3, v7
v_lshl_add_u32 v6, v73, 4, v72
v_lshlrev_b32 v6, 2, v6
v_mul_u32_u24 v5, 1152, v72
v_lshl_add_u32 v5, v73, 3, v5
v_add_u32 v5, s47, v5
s_mov_b32 s80, 0x55555555
s_mov_b32 s81, 0x55555555
s_mov_b32 s82, 0xaaaaaaaa
s_mov_b32 s83, 0xaaaaaaaa
v_lshl_add_u32 v109, v7, 4, s93
v_lshl_add_u32 v89, v7, 2, s93
v_mov_b32 v76, 0
v_mov_b32 v77, 0
v_mov_b32 v78, 0
v_mov_b32 v79, 0
v_mov_b32 v90, 0xdddddddd
ds_write_b128 v109, v[76:79]
ds_write_b32 v89, v90 offset:1792
ds_write_b32 v89, v90 offset:2048
ds_write_b32 v89, v90 offset:2304
ds_write_b32 v89, v90 offset:2560
ds_write_b32 v89, v90 offset:2816
ds_write_b32 v89, v90 offset:3072
ds_write_b32 v89, v90 offset:3328
s_lshl_b32 s47, s40, 2
s_add_u32 s47, s47, 162048
v_mov_b32 v88, s47
ds_write_b32 v88, v76
s_mul_i32 s47, s40, 2304
s_add_u32 s47, s47, 373760
v_lshl_add_u32 v72, v7, 6, s47
s_mov_b32 s47, 380672
v_lshl_add_u32 v73, v7, 6, s47
v_lshrrev_b32 v74, 2, v7
v_cmp_gt_u32 vcc, 36, v7
v_lshlrev_b32 v90, 11, v74
v_subrev_u32 v74, 9, v74
v_lshlrev_b32 v74, 12, v74
v_cndmask_b32 v72, v73, v72, vcc
v_cndmask_b32 v90, v74, v90, vcc
s_lshl_b32 s47, s40, 12
s_add_u32 s47, s47, 0x8001
v_mov_b32 v88, 1
v_mov_b32 v94, 0xf001
v_mov_b32 v95, s47
v_cndmask_b32 v94, v94, v88, vcc
v_cndmask_b32 v95, v95, v88, vcc
v_cndmask_b32 v96, 0, 28, vcc
v_cndmask_b32 v97, 32, 0, vcc
v_add_u32 v97, s93, v97
v_cmp_gt_u32 vcc, 56, v7
v_mov_b32 v73, 0x40000000
s_lshr_b32 s47, s2, 3
s_lshl_b32 s47, s47, 2
s_add_u32 s47, s47, s40
s_mul_i32 s47, s47, 3072
v_cndmask_b32 v72, v73, v72, vcc
v_lshl_add_u32 v93, v7, 4, s47
s_mul_i32 s47, s40, 82944
s_add_u32 s47, s47, s86
v_lshl_add_u32 v104, v7, 4, s47
s_mul_i32 s47, s40, 9216
s_add_u32 s47, s47, s86
s_add_u32 s47, s47, 331776
v_lshl_add_u32 v105, v7, 4, s47
s_lshl_b32 s47, s40, 6
s_add_u32 s47, s47, s86
s_add_u32 s47, s47, 368640
v_and_b32 v106, 15, v7
v_lshl_add_u32 v106, v106, 2, s47
v_lshrrev_b32 v107, 4, v7
v_lshl_add_u32 v106, v107, 8, v106
v_and_b32 v74, 15, v7
v_and_b32 v73, 7, v7
v_lshlrev_b32 v100, 1, v73
v_lshlrev_b32 v100, v100, v88
v_lshlrev_b32 v73, 4, v73
v_lshl_add_u32 v92, v74, 7, v73
v_lshl_or_b32 v92, v92, 16, v92
v_lshrrev_b32 v98, 5, v7
v_bfe_u32 v99, v7, 3, 2
v_lshl_add_u32 v99, v99, 6, s93
v_lshl_add_u32 v101, v7, 1, s93
v_lshrrev_b32 v102, 4, v7
v_lshl_add_u32 v102, v102, 3, s93
v_lshrrev_b32 v103, 1, v7
v_lshlrev_b32 v103, 5, v103
s_mov_b32 s89, 0
s_cmp_lg_u32 s40, 0
s_cbranch_scc1 L_ready
s_mov_b64 exec, 1
s_mov_b32 s3, 20000
L_poll:
buffer_load_dword v8, off, s[36:39], 0 sc1
s_sub_u32 s3, s3, 1
s_cbranch_scc1 L_giveup
s_waitcnt vmcnt(0)
v_readfirstlane_b32 s47, v8
s_nop 3
s_cmp_eq_u32 s47, 0
s_cbranch_scc1 L_poll
L_polled:
s_mov_b64 exec, -1
L_ready:
s_waitcnt lgkmcnt(0)
s_barrier
buffer_load_dwordx4 v[8:11], v72, s[24:27], 0 offen offset:0 sc1
buffer_load_dwordx4 v[12:15], v72, s[24:27], 0 offen offset:16 sc1
buffer_load_dwordx4 v[16:19], v72, s[24:27], 0 offen offset:32 sc1
buffer_load_dwordx4 v[20:23], v72, s[24:27], 0 offen offset:48 sc1
buffer_load_dwordx4 v[76:79], v93, s[24:27], 0 offen offset:0 sc1
buffer_load_dwordx4 v[80:83], v93, s[24:27], 0 offen offset:1024 sc1
buffer_load_dwordx4 v[84:87], v93, s[24:27], 0 offen offset:2048 sc1
buffer_load_dword v174, v106, s[24:27], 0 offen offset:0 sc1
buffer_load_dword v175, v106, s[24:27], 0 offen offset:1024 sc1
buffer_load_dword v176, v106, s[24:27], 0 offen offset:2048 sc1
buffer_load_dword v177, v106, s[24:27], 0 offen offset:3072 sc1
s_mov_b32 s99, 4096
buffer_load_dword v178, v106, s[24:27], s99 offen offset:0 sc1
s_mov_b32 s98, 0
buffer_load_dwordx4 v[138:141], v105, s[24:27], s98 offen sc1
s_mov_b32 s99, 0
buffer_load_dwordx4 a[0:3], v104, s[24:27], s99 offen offset:0 sc1
buffer_load_dwordx4 a[4:7], v104, s[24:27], s99 offen offset:1024 sc1
buffer_load_dwordx4 a[8:11], v104, s[24:27], s99 offen offset:2048 sc1
s_waitcnt vmcnt(12)
v_cmp_ne_u32 s[90:91], 0, v23
v_cmp_ne_u32 s[78:79], 0, v16
v_and_b32 v73, v94, v8
v_lshrrev_b32 v72, 10, v8
v_cmp_eq_u32 s[48:49], v73, v95
v_and_or_b32 v24, v72, v96, v97
s_mov_b64 exec, s[48:49]
ds_add_rtn_u32 v40, v24, v88
s_mov_b64 exec, -1
buffer_load_dwordx4 a[12:15], v104, s[24:27], s99 offen offset:3072 sc1
v_and_b32 v73, v94, v9
v_lshrrev_b32 v72, 10, v9
v_cmp_eq_u32 s[50:51], v73, v95
v_and_or_b32 v25, v72, v96, v97
s_mov_b64 exec, s[50:51]
ds_add_rtn_u32 v41, v25, v88
s_mov_b64 exec, -1
v_and_b32 v73, v94, v10
v_lshrrev_b32 v72, 10, v10
v_cmp_eq_u32 s[52:53], v73, v95
v_and_or_b32 v26, v72, v96, v97
s_mov_b64 exec, s[52:53]
ds_add_rtn_u32 v42, v26, v88
s_mov_b64 exec, -1
s_mov_b32 s99, 4096
buffer_load_dwordx4 a[16:19], v104, s[24:27], s99 offen offset:0 sc1
v_and_b32 v73, v94, v11
v_lshrrev_b32 v72, 10, v11
v_cmp_eq_u32 s[54:55], v73, v95
v_and_or_b32 v27, v72, v96, v97
s_mov_b64 exec, s[54:55]
ds_add_rtn_u32 v43, v27, v88
s_mov_b64 exec, -1
buffer_load_dwordx4 a[20:23], v104, s[24:27], s99 offen offset:1024 sc1
v_and_b32 v73, v94, v12
v_lshrrev_b32 v72, 10, v12
v_cmp_eq_u32 s[56:57], v73, v95
v_and_or_b32 v28, v72, v96, v97
s_mov_b64 exec, s[56:57]
ds_add_rtn_u32 v44, v28, v88
s_mov_b64 exec, -1
buffer_load_dwordx4 a[24:27], v104, s[24:27], s99 offen offset:2048 sc1
v_and_b32 v73, v94, v13
v_lshrrev_b32 v72, 10, v13
v_cmp_eq_u32 s[58:59], v73, v95
v_and_or_b32 v29, v72, v96, v97
s_mov_b64 exec, s[58:59]
ds_add_rtn_u32 v45, v29, v88
s_mov_b64 exec, -1
v_and_b32 v73, v94, v14
v_lshrrev_b32 v72, 10, v14
v_cmp_eq_u32 s[60:61], v73, v95
v_and_or_b32 v30, v72, v96, v97
s_mov_b64 exec, s[60:61]
ds_add_rtn_u32 v46, v30, v88
s_mov_b64 exec, -1
buffer_load_dwordx4 a[28:31], v104, s[24:27], s99 offen offset:3072 sc1
v_and_b32 v73, v94, v15
v_lshrrev_b32 v72, 10, v15
v_cmp_eq_u32 s[62:63], v73, v95
v_and_or_b32 v31, v72, v96, v97
s_mov_b64 exec, s[62:63]
ds_add_rtn_u32 v47, v31, v88
s_mov_b64 exec, -1
s_mov_b32 s99, 8192
buffer_load_dwordx4 a[32:35], v104, s[24:27], s99 offen offset:0 sc1
s_cmp_lg_u64 s[78:79], 0
s_cbranch_scc1 L_more1
L_more1b:
ds_read_b32 v72, v89
v_mov_b32 v73, 0
s_mov_b32 s98, 1024
buffer_load_dwordx4 v[142:145], v105, s[24:27], s98 offen sc1
buffer_load_dwordx4 a[36:39], v104, s[24:27], s99 offen offset:1024 sc1
buffer_load_dwordx4 a[40:43], v104, s[24:27], s99 offen offset:2048 sc1
s_waitcnt lgkmcnt(0)
s_mov_b64 vcc, s[80:81]
v_cndmask_b32_dpp v73, v72, v73, vcc quad_perm:[0,0,2,2] row_mask:0xf bank_mask:0xf
v_add_u32 v91, v103, v73
v_add_u32 v73, v72, v73
v_cmp_lt_u32 vcc, 32, v73
s_or_b32 s90, s90, s91
s_and_b32 s47, vcc_lo, 0x1ff
s_or_b32 s47, s47, s90
s_cbranch_scc1 L_greedy
L_greedyb:
buffer_load_dwordx4 a[44:47], v104, s[24:27], s99 offen offset:3072 sc1
ds_bpermute_b32 v56, v24, v91
ds_bpermute_b32 v57, v25, v91
ds_bpermute_b32 v58, v26, v91
ds_bpermute_b32 v59, v27, v91
ds_bpermute_b32 v60, v28, v91
ds_bpermute_b32 v61, v29, v91
ds_bpermute_b32 v62, v30, v91
ds_bpermute_b32 v63, v31, v91
s_mov_b32 s99, 12288
buffer_load_dwordx4 a[48:51], v104, s[24:27], s99 offen offset:0 sc1
buffer_load_dwordx4 a[52:55], v104, s[24:27], s99 offen offset:1024 sc1
buffer_load_dwordx4 a[56:59], v104, s[24:27], s99 offen offset:2048 sc1
s_waitcnt lgkmcnt(7)
v_add_u32 v73, v40, v56
v_and_b32 v72, 0x87e, v8
v_lshl_add_u32 v73, v73, 1, s93
v_add_u32 v72, v90, v72
s_andn2_b64 exec, s[48:49], s[90:91]
ds_write_b16_d16_hi v73, v8 offset:64
ds_write_b16 v73, v72 offset:384
ds_write_b16 v73, v8 offset:704
s_mov_b64 exec, -1
buffer_load_dwordx4 a[60:63], v104, s[24:27], s99 offen offset:3072 sc1
s_waitcnt lgkmcnt(9)
v_add_u32 v73, v41, v57
v_and_b32 v72, 0x87e, v9
v_lshl_add_u32 v73, v73, 1, s93
v_add_u32 v72, v90, v72
s_andn2_b64 exec, s[50:51], s[90:91]
ds_write_b16_d16_hi v73, v9 offset:64
ds_write_b16 v73, v72 offset:384
ds_write_b16 v73, v9 offset:704
s_mov_b64 exec, -1
s_mov_b32 s99, 16384
buffer_load_dwordx4 a[64:67], v104, s[24:27], s99 offen offset:0 sc1
s_waitcnt lgkmcnt(11)
v_add_u32 v73, v42, v58
v_and_b32 v72, 0x87e, v10
v_lshl_add_u32 v73, v73, 1, s93
v_add_u32 v72, v90, v72
s_andn2_b64 exec, s[52:53], s[90:91]
ds_write_b16_d16_hi v73, v10 offset:64
ds_write_b16 v73, v72 offset:384
ds_write_b16 v73, v10 offset:704
s_mov_b64 exec, -1
buffer_load_dwordx4 a[68:71], v104, s[24:27], s99 offen offset:1024 sc1
s_waitcnt lgkmcnt(13)
v_add_u32 v73, v43, v59
v_and_b32 v72, 0x87e, v11
v_lshl_add_u32 v73, v73, 1, s93
v_add_u32 v72, v90, v72
s_andn2_b64 exec, s[54:55], s[90:91]
ds_write_b16_d16_hi v73, v11 offset:64
ds_write_b16 v73, v72 offset:384
ds_write_b16 v73, v11 offset:704
s_mov_b64 exec, -1
s_mov_b32 s98, 2048
buffer_load_dwordx4 v[146:149], v105, s[24:27], s98 offen sc1
s_waitcnt lgkmcnt(15)
v_add_u32 v73, v44, v60
v_and_b32 v72, 0x87e, v12
v_lshl_add_u32 v73, v73, 1, s93
v_add_u32 v72, v90, v72
s_andn2_b64 exec, s[56:57], s[90:91]
ds_write_b16_d16_hi v73, v12 offset:64
ds_write_b16 v73, v72 offset:384
ds_write_b16 v73, v12 offset:704
s_mov_b64 exec, -1
buffer_load_dwordx4 a[72:75], v104, s[24:27], s99 offen offset:2048 sc1
s_waitcnt lgkmcnt(15)
v_add_u32 v73, v45, v61
v_and_b32 v72, 0x87e, v13
v_lshl_add_u32 v73, v73, 1, s93
v_add_u32 v72, v90, v72
s_andn2_b64 exec, s[58:59], s[90:91]
ds_write_b16_d16_hi v73, v13 offset:64
ds_write_b16 v73, v72 offset:384
ds_write_b16 v73, v13 offset:704
s_mov_b64 exec, -1
buffer_load_dwordx4 a[76:79], v104, s[24:27], s99 offen offset:3072 sc1
s_waitcnt lgkmcnt(15)
v_add_u32 v73, v46, v62
v_and_b32 v72, 0x87e, v14
v_lshl_add_u32 v73, v73, 1, s93
v_add_u32 v72, v90, v72
s_andn2_b64 exec, s[60:61], s[90:91]
ds_write_b16_d16_hi v73, v14 offset:64
ds_write_b16 v73, v72 offset:384
ds_write_b16 v73, v14 offset:704
s_mov_b64 exec, -1
s_mov_b32 s99, 20480
buffer_load_dwordx4 a[80:83], v104, s[24:27], s99 offen offset:0 sc1
s_waitcnt lgkmcnt(15)
v_add_u32 v73, v47, v63
v_and_b32 v72, 0x87e, v15
v_lshl_add_u32 v73, v73, 1, s93
v_add_u32 v72, v90, v72
s_andn2_b64 exec, s[62:63], s[90:91]
ds_write_b16_d16_hi v73, v15 offset:64
ds_write_b16 v73, v72 offset:384
ds_write_b16 v73, v15 offset:704
s_mov_b64 exec, -1
buffer_load_dwordx4 a[84:87], v104, s[24:27], s99 offen offset:1024 sc1
buffer_load_dwordx4 a[88:91], v104, s[24:27], s99 offen offset:2048 sc1
s_cmp_lg_u64 s[78:79], 0
s_cbranch_scc1 L_more2
L_more2b:
ds_read_u16 v8, v101 offset:704
ds_read_u16 v9, v101 offset:832
ds_read_u16 v10, v101 offset:960
ds_read2_b64 v[118:121], v102 offset0:48 offset1:52
ds_read2_b64 v[122:125], v102 offset0:56 offset1:60
ds_read2_b64 v[126:129], v102 offset0:64 offset1:68
ds_read2_b64 v[130:133], v102 offset0:72 offset1:76
ds_read2_b64 v[134:137], v102 offset0:80 offset1:84
buffer_load_dwordx4 a[92:95], v104, s[24:27], s99 offen offset:3072 sc1
s_mov_b32 s99, 24576
buffer_load_dwordx4 a[96:99], v104, s[24:27], s99 offen offset:0 sc1
buffer_load_dwordx4 a[100:103], v104, s[24:27], s99 offen offset:1024 sc1
s_waitcnt lgkmcnt(5)
v_lshrrev_b32 v72, 12, v8
v_cmp_ne_u32 vcc, 0, v8
v_min_u32 v72, 8, v72
v_add3_u32 v72, v72, v98, 0
v_lshlrev_b32 v73, 4, v72
v_lshrrev_b32 v72, 1, v72
buffer_load_dwordx4 a[104:107], v104, s[24:27], s99 offen offset:2048 sc1
v_lshlrev_b32 v73, v73, v100
v_lshl_add_u32 v72, v72, 8, v99
v_bfe_u32 v74, v8, 7, 4
v_lshl_add_u32 v72, v74, 2, v72
s_mov_b64 exec, vcc
ds_xor_b32 v72, v73 offset:1792
s_mov_b64 exec, -1
v_lshrrev_b32 v72, 12, v9
v_cmp_ne_u32 vcc, 0, v9
v_min_u32 v72, 8, v72
v_add3_u32 v72, v72, v98, 2
v_lshlrev_b32 v73, 4, v72
v_lshrrev_b32 v72, 1, v72
s_mov_b32 s98, 3072
buffer_load_dwordx4 v[150:153], v105, s[24:27], s98 offen sc1
v_lshlrev_b32 v73, v73, v100
v_lshl_add_u32 v72, v72, 8, v99
v_bfe_u32 v74, v9, 7, 4
v_lshl_add_u32 v72, v74, 2, v72
s_mov_b64 exec, vcc
ds_xor_b32 v72, v73 offset:1792
s_mov_b64 exec, -1
buffer_load_dwordx4 a[108:111], v104, s[24:27], s99 offen offset:3072 sc1
v_lshrrev_b32 v72, 12, v10
v_cmp_ne_u32 vcc, 0, v10
v_min_u32 v72, 8, v72
v_add3_u32 v72, v72, v98, 4
v_lshlrev_b32 v73, 4, v72
v_lshrrev_b32 v72, 1, v72
v_lshlrev_b32 v73, v73, v100
v_lshl_add_u32 v72, v72, 8, v99
v_bfe_u32 v74, v10, 7, 4
v_lshl_add_u32 v72, v74, 2, v72
s_mov_b64 exec, vcc
s_mov_b32 exec_hi, 0
ds_xor_b32 v72, v73 offset:1792
s_mov_b64 exec, -1
s_mov_b32 s99, 28672
buffer_load_dwordx4 a[112:115], v104, s[24:27], s99 offen offset:0 sc1
ds_read_b32 v179, v89 offset:1792
ds_read_b32 v180, v89 offset:2048
ds_read_b32 v181, v89 offset:2304
ds_read_b32 v182, v89 offset:2560
ds_read_b32 v183, v89 offset:2816
ds_read_b32 v184, v89 offset:3072
ds_read_b32 v185, v89 offset:3328
buffer_load_dwordx4 a[116:119], v104, s[24:27], s99 offen offset:1024 sc1
s_waitcnt lgkmcnt(10)
v_xor_b32 v118, v92, v118
v_xor_b32 v119, v92, v119
v_xor_b32 v120, v92, v120
v_xor_b32 v121, v92, v121
buffer_load_dwordx4 a[120:123], v104, s[24:27], s99 offen offset:2048 sc1
v_xor_b32 v122, v92, v122
v_xor_b32 v123, v92, v123
v_xor_b32 v124, v92, v124
v_xor_b32 v125, v92, v125
v_xor_b32 v126, v92, v126
v_xor_b32 v127, v92, v127
v_xor_b32 v128, v92, v128
v_xor_b32 v129, v92, v129
buffer_load_dwordx4 a[124:127], v104, s[24:27], s99 offen offset:3072 sc1
v_xor_b32 v130, v92, v130
v_xor_b32 v131, v92, v131
v_xor_b32 v132, v92, v132
v_xor_b32 v133, v92, v133
v_xor_b32 v134, v92, v134
v_xor_b32 v135, v92, v135
v_xor_b32 v136, v92, v136
v_xor_b32 v137, v92, v137
v_lshlrev_b32 v114, 16, v110
v_and_b32 v115, 0xffff0000, v110
v_lshlrev_b32 v116, 16, v111
v_and_b32 v117, 0xffff0000, v111
s_mov_b32 exec_hi, 15
ds_write_b128 v109, v[114:117] offset:1024
s_mov_b64 exec, -1
s_mov_b32 s99, 32768
buffer_load_dwordx4 a[128:131], v104, s[24:27], s99 offen offset:0 sc1
buffer_load_dwordx4 a[132:135], v104, s[24:27], s99 offen offset:1024 sc1
buffer_load_dwordx4 a[136:139], v104, s[24:27], s99 offen offset:2048 sc1
buffer_load_dwordx4 a[140:143], v104, s[24:27], s99 offen offset:3072 sc1
s_mov_b32 s98, 4096
buffer_load_dwordx4 v[154:157], v105, s[24:27], s98 offen sc1
s_mov_b32 s99, 36864
buffer_load_dwordx4 a[144:147], v104, s[24:27], s99 offen offset:0 sc1
buffer_load_dwordx4 a[148:151], v104, s[24:27], s99 offen offset:1024 sc1
buffer_load_dwordx4 a[152:155], v104, s[24:27], s99 offen offset:2048 sc1
buffer_load_dwordx4 a[156:159], v104, s[24:27], s99 offen offset:3072 sc1
s_mov_b32 s99, 40960
buffer_load_dwordx4 a[160:163], v104, s[24:27], s99 offen offset:0 sc1
buffer_load_dwordx4 a[164:167], v104, s[24:27], s99 offen offset:1024 sc1
buffer_load_dwordx4 a[168:171], v104, s[24:27], s99 offen offset:2048 sc1
buffer_load_dwordx4 a[172:175], v104, s[24:27], s99 offen offset:3072 sc1
s_mov_b32 s99, 45056
buffer_load_dwordx4 a[176:179], v104, s[24:27], s99 offen offset:0 sc1
s_mov_b32 s98, 5120
buffer_load_dwordx4 v[158:161], v105, s[24:27], s98 offen sc1
buffer_load_dwordx4 a[180:183], v104, s[24:27], s99 offen offset:1024 sc1
buffer_load_dwordx4 a[184:187], v104, s[24:27], s99 offen offset:2048 sc1
buffer_load_dwordx4 a[188:191], v104, s[24:27], s99 offen offset:3072 sc1
s_mov_b32 s99, 49152
buffer_load_dwordx4 a[192:195], v104, s[24:27], s99 offen offset:0 sc1
buffer_load_dwordx4 a[196:199], v104, s[24:27], s99 offen offset:1024 sc1
buffer_load_dwordx4 a[200:203], v104, s[24:27], s99 offen offset:2048 sc1
buffer_load_dwordx4 a[204:207], v104, s[24:27], s99 offen offset:3072 sc1
s_mov_b32 s99, 53248
buffer_load_dwordx4 a[208:211], v104, s[24:27], s99 offen offset:0 sc1
buffer_load_dwordx4 a[212:215], v104, s[24:27], s99 offen offset:1024 sc1
s_mov_b32 s98, 6144
buffer_load_dwordx4 v[162:165], v105, s[24:27], s98 offen sc1
buffer_load_dwordx4 a[216:219], v104, s[24:27], s99 offen offset:2048 sc1
buffer_load_dwordx4 a[220:223], v104, s[24:27], s99 offen offset:3072 sc1
s_mov_b32 s99, 57344
buffer_load_dwordx4 a[224:227], v104, s[24:27], s99 offen offset:0 sc1
buffer_load_dwordx4 a[228:231], v104, s[24:27], s99 offen offset:1024 sc1
buffer_load_dwordx4 a[232:235], v104, s[24:27], s99 offen offset:2048 sc1
s_mov_b32 s41, 0
s_mov_b32 s42, 0
s_mov_b32 s4, 0
s_mov_b32 s5, 18432
s_mov_b32 s6, 0
s_mov_b64 vcc, s[80:81]
s_bfm_b32 s12, s15, 0
s_andn2_b32 s12, s12, s85
v_mov_b32 v108, 162048
s_waitcnt lgkmcnt(0)
s_barrier
ds_read_b32 v108, v108
s_cmp_lg_u32 s89, 0
s_cbranch_scc1 L_linked
v_add_u32_sdwa v76, s4, v118 dst_sel:DWORD dst_unused:UNUSED_PAD src0_sel:DWORD src1_sel:WORD_0
v_add_u32_sdwa v77, s4, v118 dst_sel:DWORD dst_unused:UNUSED_PAD src0_sel:DWORD src1_sel:WORD_1
v_add_u32_sdwa v78, s4, v119 dst_sel:DWORD dst_unused:UNUSED_PAD src0_sel:DWORD src1_sel:WORD_0
v_add_u32_sdwa v79, s4, v119 dst_sel:DWORD dst_unused:UNUSED_PAD src0_sel:DWORD src1_sel:WORD_1
v_add_u32_sdwa v80, s4, v120 dst_sel:DWORD dst_unused:UNUSED_PAD src0_sel:DWORD src1_sel:WORD_0
v_add_u32_sdwa v81, s4, v120 dst_sel:DWORD dst_unused:UNUSED_PAD src0_sel:DWORD src1_sel:WORD_1
buffer_load_dwordx4 a[236:239], v104, s[24:27], s99 offen offset:3072 sc1
v_add_u32_sdwa v82, s4, v121 dst_sel:DWORD dst_unused:UNUSED_PAD src0_sel:DWORD src1_sel:WORD_0
v_add_u32_sdwa v83, s4, v121 dst_sel:DWORD dst_unused:UNUSED_PAD src0_sel:DWORD src1_sel:WORD_1
v_add_u32_sdwa v84, s42, v122 dst_sel:DWORD dst_unused:UNUSED_PAD src0_sel:DWORD src1_sel:WORD_0
v_add_u32_sdwa v85, s42, v122 dst_sel:DWORD dst_unused:UNUSED_PAD src0_sel:DWORD src1_sel:WORD_1
v_add_u32_sdwa v86, s42, v123 dst_sel:DWORD dst_unused:UNUSED_PAD src0_sel:DWORD src1_sel:WORD_0
ds_read_b128 v[44:47], v0 offset:0
s_mov_b32 s99, 61440
buffer_load_dwordx4 a[240:243], v104, s[24:27], s99 offen offset:0 sc1
ds_read_b128 v[48:51], v1 offset:0
ds_read_b128 v[52:55], v0 offset:2048
ds_read_b128 v[56:59], v1 offset:2048
ds_read_u16 v76, v76
ds_read_u16 v77, v77
ds_read_b128 v[8:11], v2 offset:1024
buffer_load_dwordx4 a[244:247], v104, s[24:27], s99 offen offset:1024 sc1
ds_read_u16 v78, v78
ds_read_b128 v[12:15], v2 offset:1088
ds_read_u16 v79, v79
ds_read_b128 v[16:19], v2 offset:1152
ds_read_u16 v80, v80
ds_read_b128 v[20:23], v2 offset:1216
buffer_load_dwordx4 a[248:251], v104, s[24:27], s99 offen offset:2048 sc1
ds_read_u16 v81, v81
ds_read_b128 v[24:27], v2 offset:1280
ds_read_u16 v82, v82
ds_read_b128 v[28:31], v2 offset:1344
s_mov_b32 s98, 7168
buffer_load_dwordx4 v[166:169], v105, s[24:27], s98 offen sc1
buffer_load_dwordx4 a[252:255], v104, s[24:27], s99 offen offset:3072 sc1
s_mov_b32 s99, 65536
buffer_load_dwordx4 v[186:189], v104, s[24:27], s99 offen offset:0 sc1
buffer_load_dwordx4 v[190:193], v104, s[24:27], s99 offen offset:1024 sc1
buffer_load_dwordx4 v[194:197], v104, s[24:27], s99 offen offset:2048 sc1
buffer_load_dwordx4 v[198:201], v104, s[24:27], s99 offen offset:3072 sc1
s_waitcnt lgkmcnt(0)
v_readfirstlane_b32 s47, v108
s_nop 3
s_cmp_lg_u32 s47, 0
s_cbranch_scc1 L_slow
s_mov_b32 s99, 69632
buffer_load_dwordx4 v[202:205], v104, s[24:27], s99 offen offset:0 sc1
buffer_load_dwordx4 v[206:209], v104, s[24:27], s99 offen offset:1024 sc1
buffer_load_dwordx4 v[210:213], v104, s[24:27], s99 offen offset:2048 sc1
buffer_load_dwordx4 v[214:217], v104, s[24:27], s99 offen offset:3072 sc1
s_mov_b32 s98, 8192
buffer_load_dwordx4 v[170:173], v105, s[24:27], s98 offen sc1
s_mov_b32 s99, 73728
buffer_load_dwordx4 v[218:221], v104, s[24:27], s99 offen offset:0 sc1
buffer_load_dwordx4 v[222:225], v104, s[24:27], s99 offen offset:1024 sc1
buffer_load_dwordx4 v[226:229], v104, s[24:27], s99 offen offset:2048 sc1
buffer_load_dwordx4 v[230:233], v104, s[24:27], s99 offen offset:3072 sc1
s_mov_b32 s99, 77824
buffer_load_dwordx4 v[234:237], v104, s[24:27], s99 offen offset:0 sc1
buffer_load_dwordx4 v[238:241], v104, s[24:27], s99 offen offset:1024 sc1
buffer_load_dwordx4 v[242:245], v104, s[24:27], s99 offen offset:2048 sc1
buffer_load_dwordx4 v[246:249], v104, s[24:27], s99 offen offset:3072 sc1
s_mov_b32 s99, 81920
buffer_load_dwordx4 v[250:253], v104, s[24:27], s99 offen offset:0 sc1
s_bfe_u32 s88, s85, 0x40018
s_cbranch_scc0 L_pf2_e
L_pf2:
s_add_u32 m0, s44, 0
s_nop 0
buffer_load_dwordx4 v3, s[16:19], s45 offen offset:0 nt lds
s_add_u32 m0, s44, 3840
s_nop 0
buffer_load_dwordx4 v3, s[16:19], s45 offen offset:256 nt lds
s_add_u32 m0, s44, 7680
s_nop 0
buffer_load_dwordx4 v3, s[16:19], s45 offen offset:512 nt lds
s_add_u32 m0, s44, 11520
s_nop 0
buffer_load_dwordx4 v3, s[16:19], s45 offen offset:768 nt lds
s_add_u32 m0, s44, s8
s_mov_b64 exec, s[10:11]
buffer_load_dwordx4 v3, s[16:19], s7 offen offset:896 nt lds
s_mov_b64 exec, -1
s_add_u32 s7, s7, s13
s_add_u32 s44, s44, 18432
s_add_u32 s45, s45, s13
s_mov_b32 s13, 4718592
s_sub_u32 s88, s88, 1
s_cmp_lg_u32 s88, 0
s_cbranch_scc1 L_pf2
L_pf2_e:
s_cmp_ge_u32 s44, 147456
s_cselect_b32 s44, s9, s44
s_waitcnt vmcnt(20)
s_bitcmp1_b32 s85, 0
s_cbranch_scc0 L_loopn
.p2align 6
L_loop:
v_smfmac_f32_16x16x64_bf16 v[8:11], a[0:3], v[44:51], v138
ds_read_b128 v[32:35], v2 offset:1408
v_cvt_pk_bf16_f32 v106, v36, v37
v_smfmac_f32_16x16x64_bf16 v[8:11], a[36:39], v[52:59], v142
s_waitcnt lgkmcnt(9)
ds_read_b128 v[60:63], v0 offset:4096
v_cvt_pk_bf16_f32 v107, v38, v39
v_smfmac_f32_16x16x64_bf16 v[12:15], a[4:7], v[44:51], v138 abid:1
ds_read_b128 v[36:39], v2 offset:1472
v_cvt_pk_bf16_f32 v112, v40, v41
v_smfmac_f32_16x16x64_bf16 v[12:15], a[40:43], v[52:59], v142 abid:1
s_waitcnt lgkmcnt(9)
ds_read_u16 v84, v84
v_cvt_pk_bf16_f32 v113, v42, v43
v_smfmac_f32_16x16x64_bf16 v[16:19], a[8:11], v[44:51], v139
s_cmp_eq_u32 s4, 129024
ds_read_b128 v[40:43], v2 offset:1536
v_cndmask_b32_dpp v108, v96, v92, vcc quad_perm:[1,0,3,2] row_mask:0xf bank_mask:0xf
v_smfmac_f32_16x16x64_bf16 v[16:19], a[44:47], v[52:59], v143
s_waitcnt lgkmcnt(9)
ds_read_b128 v[64:67], v1 offset:4096
v_cndmask_b32_dpp v109, v97, v93, vcc quad_perm:[1,0,3,2] row_mask:0xf bank_mask:0xf
v_smfmac_f32_16x16x64_bf16 v[20:23], a[12:15], v[44:51], v139 abid:1
s_cselect_b32 s43, -129024, s5
ds_read_b128 v[68:71], v0 offset:6144
v_cndmask_b32_dpp v110, v98, v94, vcc quad_perm:[1,0,3,2] row_mask:0xf bank_mask:0xf
v_smfmac_f32_16x16x64_bf16 v[20:23], a[48:51], v[52:59], v143 abid:1
s_waitcnt lgkmcnt(9)
ds_read_b128 v[72:75], v1 offset:6144
v_cndmask_b32_dpp v111, v99, v95, vcc quad_perm:[1,0,3,2] row_mask:0xf bank_mask:0xf
v_smfmac_f32_16x16x64_bf16 v[24:27], a[16:19], v[44:51], v140
s_add_u32 s4, s4, s43
ds_read_u16 v83, v83
v_add_u32_sdwa v87, s42, v123 dst_sel:DWORD dst_unused:UNUSED_PAD src0_sel:DWORD src1_sel:WORD_1
v_smfmac_f32_16x16x64_bf16 v[24:27], a[52:55], v[52:59], v144
buffer_store_dwordx4 v[108:111], v4, s[20:23], s46 offen offset:0
s_mov_b64 vcc, s[82:83]
s_waitcnt lgkmcnt(9)
ds_read_b128 v[114:117], v2 offset:64
v_cndmask_b32_dpp v96, v92, v96, vcc quad_perm:[1,0,3,2] row_mask:0xf bank_mask:0xf
v_cndmask_b32_dpp v97, v93, v97, vcc quad_perm:[1,0,3,2] row_mask:0xf bank_mask:0xf
v_smfmac_f32_16x16x64_bf16 v[28:31], a[20:23], v[44:51], v140 abid:1
s_add_u32 s41, s41, 1
ds_read_u16 v85, v85
v_cndmask_b32_dpp v98, v94, v98, vcc quad_perm:[1,0,3,2] row_mask:0xf bank_mask:0xf
v_smfmac_f32_16x16x64_bf16 v[28:31], a[56:59], v[52:59], v144 abid:1
s_waitcnt lgkmcnt(10)
ds_read_u16 v86, v86
v_cndmask_b32_dpp v99, v95, v99, vcc quad_perm:[1,0,3,2] row_mask:0xf bank_mask:0xf
v_smfmac_f32_16x16x64_bf16 v[32:35], a[24:27], v[44:51], v141
ds_read_u16 v87, v87
v_add_u32_sdwa v88, s42, v124 dst_sel:DWORD dst_unused:UNUSED_PAD src0_sel:DWORD src1_sel:WORD_0
v_smfmac_f32_16x16x64_bf16 v[32:35], a[60:63], v[52:59], v145
s_waitcnt lgkmcnt(10)
ds_read_u16 v88, v88
v_add_u32_sdwa v89, s42, v124 dst_sel:DWORD dst_unused:UNUSED_PAD src0_sel:DWORD src1_sel:WORD_1
v_smfmac_f32_16x16x64_bf16 v[36:39], a[28:31], v[44:51], v141 abid:1
ds_read_u16 v89, v89
v_add_u32_sdwa v90, s42, v125 dst_sel:DWORD dst_unused:UNUSED_PAD src0_sel:DWORD src1_sel:WORD_0
v_smfmac_f32_16x16x64_bf16 v[36:39], a[64:67], v[52:59], v145 abid:1
s_waitcnt lgkmcnt(10)
ds_read_u16 v90, v90
v_add_u32_sdwa v91, s42, v125 dst_sel:DWORD dst_unused:UNUSED_PAD src0_sel:DWORD src1_sel:WORD_1
v_smfmac_f32_16x16x64_bf16 v[40:43], a[32:35], v[44:51], v174
buffer_store_dwordx4 v[96:99], v4, s[20:23], s46 offen offset:1152
s_mov_b64 vcc, s[80:81]
ds_read_u16 v91, v91
v_cndmask_b32_dpp v92, v104, v100, vcc quad_perm:[1,0,3,2] row_mask:0xf bank_mask:0xf
v_cndmask_b32_dpp v93, v105, v101, vcc quad_perm:[1,0,3,2] row_mask:0xf bank_mask:0xf
v_smfmac_f32_16x16x64_bf16 v[40:43], a[68:71], v[52:59], v174 abid:1
s_waitcnt lgkmcnt(11)
ds_bpermute_b32 v112, v6, v112
v_cndmask_b32_dpp v94, v106, v102, vcc quad_perm:[1,0,3,2] row_mask:0xf bank_mask:0xf
v_smfmac_f32_16x16x64_bf16 v[8:11], a[72:75], v[60:67], v146
s_waitcnt lgkmcnt(10)
ds_bpermute_b32 v113, v6, v113
v_cndmask_b32_dpp v95, v107, v103, vcc quad_perm:[1,0,3,2] row_mask:0xf bank_mask:0xf
v_smfmac_f32_16x16x64_bf16 v[8:11], a[108:111], v[68:75], v150
s_waitcnt lgkmcnt(9)
ds_read_b128 v[44:47], v0 offset:8192
v_smfmac_f32_16x16x64_bf16 v[8:11], v[114:117], v[76:83], v179
ds_read_b128 v[48:51], v1 offset:8192
v_smfmac_f32_16x16x64_bf16 v[12:15], v[114:117], v[76:83], v179 abid:1
ds_read_b128 v[114:117], v2 offset:128
v_add_u32_sdwa v76, s42, v126 dst_sel:DWORD dst_unused:UNUSED_PAD src0_sel:DWORD src1_sel:WORD_0
v_smfmac_f32_16x16x64_bf16 v[12:15], a[76:79], v[60:67], v146 abid:1
ds_read_u16 v76, v76
v_add_u32_sdwa v77, s42, v126 dst_sel:DWORD dst_unused:UNUSED_PAD src0_sel:DWORD src1_sel:WORD_1
v_smfmac_f32_16x16x64_bf16 v[12:15], a[112:115], v[68:75], v150 abid:1
buffer_store_dwordx4 v[92:95], v4, s[20:23], s46 offen offset:128
s_mov_b64 vcc, s[82:83]
ds_read_u16 v77, v77
v_cndmask_b32_dpp v104, v100, v104, vcc quad_perm:[1,0,3,2] row_mask:0xf bank_mask:0xf
v_add_u32_sdwa v78, s42, v127 dst_sel:DWORD dst_unused:UNUSED_PAD src0_sel:DWORD src1_sel:WORD_0
v_smfmac_f32_16x16x64_bf16 v[24:27], a[88:91], v[60:67], v148
ds_read_u16 v78, v78
v_cndmask_b32_dpp v105, v101, v105, vcc quad_perm:[1,0,3,2] row_mask:0xf bank_mask:0xf
v_smfmac_f32_16x16x64_bf16 v[24:27], a[124:127], v[68:75], v152
ds_read_b128 v[52:55], v0 offset:10240
v_cndmask_b32_dpp v106, v102, v106, vcc quad_perm:[1,0,3,2] row_mask:0xf bank_mask:0xf
v_smfmac_f32_16x16x64_bf16 v[28:31], a[92:95], v[60:67], v148 abid:1
ds_read_b128 v[56:59], v1 offset:10240
v_add_u32_sdwa v79, s42, v127 dst_sel:DWORD dst_unused:UNUSED_PAD src0_sel:DWORD src1_sel:WORD_1
v_smfmac_f32_16x16x64_bf16 v[28:31], a[128:131], v[68:75], v152 abid:1
ds_read_u16 v79, v79
v_cndmask_b32_dpp v107, v103, v107, vcc quad_perm:[1,0,3,2] row_mask:0xf bank_mask:0xf
v_smfmac_f32_16x16x64_bf16 v[32:35], a[96:99], v[60:67], v149
ds_read_b128 v[92:95], v0 offset:12288
v_add_u32_sdwa v80, s42, v128 dst_sel:DWORD dst_unused:UNUSED_PAD src0_sel:DWORD src1_sel:WORD_0
v_smfmac_f32_16x16x64_bf16 v[32:35], a[132:135], v[68:75], v153
ds_read_u16 v80, v80
v_add_u32_sdwa v81, s42, v128 dst_sel:DWORD dst_unused:UNUSED_PAD src0_sel:DWORD src1_sel:WORD_1
v_smfmac_f32_16x16x64_bf16 v[16:19], a[80:83], v[60:67], v147
buffer_store_dwordx4 v[104:107], v4, s[20:23], s46 offen offset:1280
s_mov_b64 vcc, s[80:81]
ds_read_u16 v81, v81
v_add_u32_sdwa v82, s42, v129 dst_sel:DWORD dst_unused:UNUSED_PAD src0_sel:DWORD src1_sel:WORD_0
v_add_u32_sdwa v83, s42, v129 dst_sel:DWORD dst_unused:UNUSED_PAD src0_sel:DWORD src1_sel:WORD_1
v_smfmac_f32_16x16x64_bf16 v[16:19], a[116:119], v[68:75], v151
s_waitcnt lgkmcnt(9)
ds_read_b128 v[96:99], v1 offset:12288
v_add_u32_sdwa v100, s42, v130 dst_sel:DWORD dst_unused:UNUSED_PAD src0_sel:DWORD src1_sel:WORD_0
v_smfmac_f32_16x16x64_bf16 v[16:19], v[114:117], v[84:91], v180 abid:1
ds_read_u16 v100, v100
v_add_u32_sdwa v101, s42, v130 dst_sel:DWORD dst_unused:UNUSED_PAD src0_sel:DWORD src1_sel:WORD_1
v_smfmac_f32_16x16x64_bf16 v[20:23], v[114:117], v[84:91], v181
ds_read_u16 v82, v82
v_add_u32_sdwa v102, s42, v131 dst_sel:DWORD dst_unused:UNUSED_PAD src0_sel:DWORD src1_sel:WORD_0
v_smfmac_f32_16x16x64_bf16 v[20:23], a[84:87], v[60:67], v147 abid:1
ds_read_u16 v101, v101
v_add_u32_sdwa v103, s42, v131 dst_sel:DWORD dst_unused:UNUSED_PAD src0_sel:DWORD src1_sel:WORD_1
v_smfmac_f32_16x16x64_bf16 v[20:23], a[120:123], v[68:75], v151 abid:1
ds_read_u16 v83, v83
v_add_u32_sdwa v104, s42, v132 dst_sel:DWORD dst_unused:UNUSED_PAD src0_sel:DWORD src1_sel:WORD_0
v_smfmac_f32_16x16x64_bf16 v[36:39], a[100:103], v[60:67], v149 abid:1
ds_read_b128 v[114:117], v2 offset:192
v_add_u32_sdwa v105, s42, v132 dst_sel:DWORD dst_unused:UNUSED_PAD src0_sel:DWORD src1_sel:WORD_1
v_smfmac_f32_16x16x64_bf16 v[36:39], a[136:139], v[68:75], v153 abid:1
buffer_store_dwordx2 v[112:113], v5, s[20:23], s46 offen
ds_read_u16 v102, v102
v_add_u32_sdwa v106, s42, v133 dst_sel:DWORD dst_unused:UNUSED_PAD src0_sel:DWORD src1_sel:WORD_0
v_smfmac_f32_16x16x64_bf16 v[40:43], a[104:107], v[60:67], v175
s_mov_b32 s22, 75497472
ds_read_u16 v103, v103
v_add_u32_sdwa v107, s42, v133 dst_sel:DWORD dst_unused:UNUSED_PAD src0_sel:DWORD src1_sel:WORD_1
v_smfmac_f32_16x16x64_bf16 v[40:43], a[140:143], v[68:75], v175 abid:1
s_add_u32 s46, s46, s6
ds_read_u16 v104, v104
v_add_u32_sdwa v84, s42, v134 dst_sel:DWORD dst_unused:UNUSED_PAD src0_sel:DWORD src1_sel:WORD_0
v_smfmac_f32_16x16x64_bf16 v[8:11], a[144:147], v[44:51], v154
s_waitcnt lgkmcnt(13)
ds_read_u16 v105, v105
v_add_u32_sdwa v85, s42, v134 dst_sel:DWORD dst_unused:UNUSED_PAD src0_sel:DWORD src1_sel:WORD_1
v_smfmac_f32_16x16x64_bf16 v[8:11], a[180:183], v[52:59], v158
s_waitcnt lgkmcnt(9)
ds_read_u16 v106, v106
v_add_u32_sdwa v86, s42, v135 dst_sel:DWORD dst_unused:UNUSED_PAD src0_sel:DWORD src1_sel:WORD_0
v_smfmac_f32_16x16x64_bf16 v[8:11], a[216:219], v[92:99], v162
s_mov_b32 s6, s14
ds_read_u16 v107, v107
v_add_u32_sdwa v87, s42, v135 dst_sel:DWORD dst_unused:UNUSED_PAD src0_sel:DWORD src1_sel:WORD_1
v_smfmac_f32_16x16x64_bf16 v[24:27], a[160:163], v[44:51], v156
s_add_u32 m0, s44, 0
ds_read_u16 v84, v84
v_add_u32_sdwa v88, s42, v136 dst_sel:DWORD dst_unused:UNUSED_PAD src0_sel:DWORD src1_sel:WORD_0
v_smfmac_f32_16x16x64_bf16 v[24:27], a[196:199], v[52:59], v160
buffer_load_dwordx4 v3, s[16:19], s45 offen offset:0 nt lds
v_add_u32_sdwa v89, s42, v136 dst_sel:DWORD dst_unused:UNUSED_PAD src0_sel:DWORD src1_sel:WORD_1
v_smfmac_f32_16x16x64_bf16 v[24:27], a[232:235], v[92:99], v164
s_waitcnt lgkmcnt(7)
ds_read_u16 v85, v85
v_add_u32_sdwa v90, s42, v137 dst_sel:DWORD dst_unused:UNUSED_PAD src0_sel:DWORD src1_sel:WORD_0
v_smfmac_f32_16x16x64_bf16 v[24:27], v[114:117], v[76:83], v182
s_mov_b32 s14, 4718592
ds_read_u16 v86, v86
v_add_u32_sdwa v91, s42, v137 dst_sel:DWORD dst_unused:UNUSED_PAD src0_sel:DWORD src1_sel:WORD_1
v_smfmac_f32_16x16x64_bf16 v[28:31], v[114:117], v[76:83], v182 abid:1
ds_read_b128 v[114:117], v2 offset:256
v_add_u32_sdwa v76, s4, v118 dst_sel:DWORD dst_unused:UNUSED_PAD src0_sel:DWORD src1_sel:WORD_0
v_smfmac_f32_16x16x64_bf16 v[28:31], a[164:167], v[44:51], v156 abid:1
ds_read_u16 v87, v87
v_add_u32_sdwa v77, s4, v118 dst_sel:DWORD dst_unused:UNUSED_PAD src0_sel:DWORD src1_sel:WORD_1
v_smfmac_f32_16x16x64_bf16 v[28:31], a[200:203], v[52:59], v160 abid:1
ds_read_u16 v88, v88
v_add_u32_sdwa v78, s4, v119 dst_sel:DWORD dst_unused:UNUSED_PAD src0_sel:DWORD src1_sel:WORD_0
v_smfmac_f32_16x16x64_bf16 v[28:31], a[236:239], v[92:99], v164 abid:1
ds_read_b128 v[60:63], v0 offset:14336
v_add_u32_sdwa v79, s4, v119 dst_sel:DWORD dst_unused:UNUSED_PAD src0_sel:DWORD src1_sel:WORD_1
v_smfmac_f32_16x16x64_bf16 v[12:15], a[148:151], v[44:51], v154 abid:1
s_add_u32 m0, s44, 3840
ds_read_u16 v89, v89
v_add_u32_sdwa v80, s4, v120 dst_sel:DWORD dst_unused:UNUSED_PAD src0_sel:DWORD src1_sel:WORD_0
v_smfmac_f32_16x16x64_bf16 v[12:15], a[184:187], v[52:59], v158 abid:1
buffer_load_dwordx4 v3, s[16:19], s45 offen offset:256 nt lds
v_add_u32_sdwa v81, s4, v120 dst_sel:DWORD dst_unused:UNUSED_PAD src0_sel:DWORD src1_sel:WORD_1
v_smfmac_f32_16x16x64_bf16 v[12:15], a[220:223], v[92:99], v162 abid:1
ds_read_b128 v[64:67], v1 offset:14336
v_add_u32_sdwa v82, s4, v121 dst_sel:DWORD dst_unused:UNUSED_PAD src0_sel:DWORD src1_sel:WORD_0
v_smfmac_f32_16x16x64_bf16 v[32:35], a[168:171], v[44:51], v157
ds_read_b128 v[68:71], v0 offset:16384
v_add_u32_sdwa v83, s4, v121 dst_sel:DWORD dst_unused:UNUSED_PAD src0_sel:DWORD src1_sel:WORD_1
v_smfmac_f32_16x16x64_bf16 v[32:35], a[204:207], v[52:59], v161
ds_read_u16 v90, v90
v_smfmac_f32_16x16x64_bf16 v[32:35], a[240:243], v[92:99], v165
s_waitcnt lgkmcnt(7)
ds_read_b128 v[72:75], v1 offset:16384
v_add_u32 v0, s43, v0
v_smfmac_f32_16x16x64_bf16 v[32:35], v[114:117], v[100:107], v183 abid:1
ds_read_u16 v91, v91
v_add_u32 v1, s43, v1
v_smfmac_f32_16x16x64_bf16 v[36:39], v[114:117], v[100:107], v184
ds_read_b128 v[114:117], v2 offset:320
v_smfmac_f32_16x16x64_bf16 v[36:39], a[172:175], v[44:51], v157 abid:1
s_add_u32 m0, s44, 7680
v_smfmac_f32_16x16x64_bf16 v[36:39], a[208:211], v[52:59], v161 abid:1
buffer_load_dwordx4 v3, s[16:19], s45 offen offset:512 nt lds
v_smfmac_f32_16x16x64_bf16 v[36:39], a[244:247], v[92:99], v165 abid:1
v_smfmac_f32_16x16x64_bf16 v[16:19], a[152:155], v[44:51], v155
s_add_u32 m0, s44, 11520
v_smfmac_f32_16x16x64_bf16 v[16:19], a[188:191], v[52:59], v159
buffer_load_dwordx4 v3, s[16:19], s45 offen offset:768 nt lds
v_smfmac_f32_16x16x64_bf16 v[16:19], a[224:227], v[92:99], v163
v_smfmac_f32_16x16x64_bf16 v[20:23], a[156:159], v[44:51], v155 abid:1
s_add_u32 m0, s44, s8
v_smfmac_f32_16x16x64_bf16 v[20:23], a[192:195], v[52:59], v159 abid:1
s_mov_b64 exec, s[10:11]
buffer_load_dwordx4 v3, s[16:19], s7 offen offset:896 nt lds
s_mov_b64 exec, -1
v_smfmac_f32_16x16x64_bf16 v[20:23], a[228:231], v[92:99], v163 abid:1
s_add_u32 s45, s45, 4718592
s_add_u32 s7, s7, 4718592
s_add_u32 s44, s44, s5
v_smfmac_f32_16x16x64_bf16 v[40:43], a[176:179], v[44:51], v176
s_cmp_ge_u32 s44, 147456
s_cselect_b32 s44, s9, s44
s_bitcmp1_b32 s92, s41
v_smfmac_f32_16x16x64_bf16 v[40:43], a[212:215], v[52:59], v176 abid:1
s_cbranch_scc1 L_loop_w
L_loop_wb:
v_smfmac_f32_16x16x64_bf16 v[40:43], a[248:251], v[92:99], v177
s_waitcnt lgkmcnt(0)
v_smfmac_f32_16x16x64_bf16 v[40:43], v[114:117], v[84:91], v185
s_waitcnt vmcnt(20)
s_barrier
v_smfmac_f32_16x16x64_bf16 v[8:11], a[252:255], v[60:67], v166
s_mov_b32 s42, s4
ds_read_b128 v[44:47], v0 offset:0
v_smfmac_f32_16x16x64_bf16 v[8:11], v[218:221], v[68:75], v170
ds_read_b128 v[48:51], v1 offset:0
v_add_u32_sdwa v84, s42, v122 dst_sel:DWORD dst_unused:UNUSED_PAD src0_sel:DWORD src1_sel:WORD_0
v_smfmac_f32_16x16x64_bf16 v[12:15], v[186:189], v[60:67], v166 abid:1
ds_read_b128 v[52:55], v0 offset:2048
v_add_u32_sdwa v85, s42, v122 dst_sel:DWORD dst_unused:UNUSED_PAD src0_sel:DWORD src1_sel:WORD_1
v_smfmac_f32_16x16x64_bf16 v[12:15], v[222:225], v[68:75], v170 abid:1
ds_read_b128 v[56:59], v1 offset:2048
v_add_u32_sdwa v86, s42, v123 dst_sel:DWORD dst_unused:UNUSED_PAD src0_sel:DWORD src1_sel:WORD_0
v_smfmac_f32_16x16x64_bf16 v[16:19], v[190:193], v[60:67], v167
ds_read_u16 v76, v76
v_cvt_pk_bf16_f32 v92, v8, v9
v_smfmac_f32_16x16x64_bf16 v[16:19], v[226:229], v[68:75], v171
ds_read_u16 v77, v77
v_cvt_pk_bf16_f32 v93, v10, v11
v_smfmac_f32_16x16x64_bf16 v[20:23], v[194:197], v[60:67], v167 abid:1
ds_read_b128 v[8:11], v2 offset:1024
v_cvt_pk_bf16_f32 v94, v12, v13
v_smfmac_f32_16x16x64_bf16 v[20:23], v[230:233], v[68:75], v171 abid:1
ds_read_u16 v78, v78
v_cvt_pk_bf16_f32 v95, v14, v15
v_smfmac_f32_16x16x64_bf16 v[24:27], v[198:201], v[60:67], v168
ds_read_b128 v[12:15], v2 offset:1088
v_cvt_pk_bf16_f32 v96, v16, v17
v_smfmac_f32_16x16x64_bf16 v[24:27], v[234:237], v[68:75], v172
ds_read_u16 v79, v79
v_cvt_pk_bf16_f32 v97, v18, v19
v_smfmac_f32_16x16x64_bf16 v[28:31], v[202:205], v[60:67], v168 abid:1
ds_read_b128 v[16:19], v2 offset:1152
v_cvt_pk_bf16_f32 v98, v20, v21
v_smfmac_f32_16x16x64_bf16 v[28:31], v[238:241], v[68:75], v172 abid:1
ds_read_u16 v80, v80
v_cvt_pk_bf16_f32 v99, v22, v23
v_smfmac_f32_16x16x64_bf16 v[32:35], v[206:209], v[60:67], v169
ds_read_b128 v[20:23], v2 offset:1216
v_cvt_pk_bf16_f32 v100, v24, v25
v_smfmac_f32_16x16x64_bf16 v[32:35], v[242:245], v[68:75], v173
ds_read_u16 v81, v81
v_cvt_pk_bf16_f32 v101, v26, v27
v_smfmac_f32_16x16x64_bf16 v[36:39], v[210:213], v[60:67], v169 abid:1
ds_read_b128 v[24:27], v2 offset:1280
v_cvt_pk_bf16_f32 v102, v28, v29
v_smfmac_f32_16x16x64_bf16 v[36:39], v[246:249], v[68:75], v173 abid:1
ds_read_u16 v82, v82
v_cvt_pk_bf16_f32 v103, v30, v31
v_smfmac_f32_16x16x64_bf16 v[40:43], v[214:217], v[60:67], v177 abid:1
s_bitcmp1_b32 s85, s41
ds_read_b128 v[28:31], v2 offset:1344
v_cvt_pk_bf16_f32 v104, v32, v33
v_smfmac_f32_16x16x64_bf16 v[40:43], v[250:253], v[68:75], v178
s_waitcnt lgkmcnt(10)
v_cvt_pk_bf16_f32 v105, v34, v35
s_cbranch_scc1 L_loop
.p2align 3
L_loopn:
v_smfmac_f32_16x16x64_bf16 v[8:11], a[0:3], v[44:51], v138
ds_read_b128 v[32:35], v2 offset:1408
v_cvt_pk_bf16_f32 v106, v36, v37
v_smfmac_f32_16x16x64_bf16 v[8:11], a[36:39], v[52:59], v142
s_waitcnt lgkmcnt(9)
ds_read_b128 v[60:63], v0 offset:4096
v_cvt_pk_bf16_f32 v107, v38, v39
v_smfmac_f32_16x16x64_bf16 v[12:15], a[4:7], v[44:51], v138 abid:1
ds_read_b128 v[36:39], v2 offset:1472
v_cvt_pk_bf16_f32 v112, v40, v41
v_smfmac_f32_16x16x64_bf16 v[12:15], a[40:43], v[52:59], v142 abid:1
s_waitcnt lgkmcnt(9)
ds_read_u16 v84, v84
v_cvt_pk_bf16_f32 v113, v42, v43
v_smfmac_f32_16x16x64_bf16 v[16:19], a[8:11], v[44:51], v139
s_cmp_eq_u32 s4, 129024
ds_read_b128 v[40:43], v2 offset:1536
v_cndmask_b32_dpp v108, v96, v92, vcc quad_perm:[1,0,3,2] row_mask:0xf bank_mask:0xf
v_smfmac_f32_16x16x64_bf16 v[16:19], a[44:47], v[52:59], v143
s_waitcnt lgkmcnt(9)
ds_read_b128 v[64:67], v1 offset:4096
v_cndmask_b32_dpp v109, v97, v93, vcc quad_perm:[1,0,3,2] row_mask:0xf bank_mask:0xf
v_smfmac_f32_16x16x64_bf16 v[20:23], a[12:15], v[44:51], v139 abid:1
s_cselect_b32 s43, -129024, s5
ds_read_b128 v[68:71], v0 offset:6144
v_cndmask_b32_dpp v110, v98, v94, vcc quad_perm:[1,0,3,2] row_mask:0xf bank_mask:0xf
v_smfmac_f32_16x16x64_bf16 v[20:23], a[48:51], v[52:59], v143 abid:1
s_waitcnt lgkmcnt(9)
ds_read_b128 v[72:75], v1 offset:6144
v_cndmask_b32_dpp v111, v99, v95, vcc quad_perm:[1,0,3,2] row_mask:0xf bank_mask:0xf
v_smfmac_f32_16x16x64_bf16 v[24:27], a[16:19], v[44:51], v140
s_add_u32 s4, s4, s43
ds_read_u16 v83, v83
v_add_u32_sdwa v87, s42, v123 dst_sel:DWORD dst_unused:UNUSED_PAD src0_sel:DWORD src1_sel:WORD_1
v_smfmac_f32_16x16x64_bf16 v[24:27], a[52:55], v[52:59], v144
buffer_store_dwordx4 v[108:111], v4, s[20:23], s46 offen offset:0
s_mov_b64 vcc, s[82:83]
s_waitcnt lgkmcnt(9)
ds_read_b128 v[114:117], v2 offset:64
v_cndmask_b32_dpp v96, v92, v96, vcc quad_perm:[1,0,3,2] row_mask:0xf bank_mask:0xf
v_cndmask_b32_dpp v97, v93, v97, vcc quad_perm:[1,0,3,2] row_mask:0xf bank_mask:0xf
v_smfmac_f32_16x16x64_bf16 v[28:31], a[20:23], v[44:51], v140 abid:1
s_add_u32 s41, s41, 1
ds_read_u16 v85, v85
v_cndmask_b32_dpp v98, v94, v98, vcc quad_perm:[1,0,3,2] row_mask:0xf bank_mask:0xf
v_smfmac_f32_16x16x64_bf16 v[28:31], a[56:59], v[52:59], v144 abid:1
s_waitcnt lgkmcnt(10)
ds_read_u16 v86, v86
v_cndmask_b32_dpp v99, v95, v99, vcc quad_perm:[1,0,3,2] row_mask:0xf bank_mask:0xf
v_smfmac_f32_16x16x64_bf16 v[32:35], a[24:27], v[44:51], v141
ds_read_u16 v87, v87
v_add_u32_sdwa v88, s42, v124 dst_sel:DWORD dst_unused:UNUSED_PAD src0_sel:DWORD src1_sel:WORD_0
v_smfmac_f32_16x16x64_bf16 v[32:35], a[60:63], v[52:59], v145
s_waitcnt lgkmcnt(10)
ds_read_u16 v88, v88
v_add_u32_sdwa v89, s42, v124 dst_sel:DWORD dst_unused:UNUSED_PAD src0_sel:DWORD src1_sel:WORD_1
v_smfmac_f32_16x16x64_bf16 v[36:39], a[28:31], v[44:51], v141 abid:1
ds_read_u16 v89, v89
v_add_u32_sdwa v90, s42, v125 dst_sel:DWORD dst_unused:UNUSED_PAD src0_sel:DWORD src1_sel:WORD_0
v_smfmac_f32_16x16x64_bf16 v[36:39], a[64:67], v[52:59], v145 abid:1
s_waitcnt lgkmcnt(10)
ds_read_u16 v90, v90
v_add_u32_sdwa v91, s42, v125 dst_sel:DWORD dst_unused:UNUSED_PAD src0_sel:DWORD src1_sel:WORD_1
v_smfmac_f32_16x16x64_bf16 v[40:43], a[32:35], v[44:51], v174
buffer_store_dwordx4 v[96:99], v4, s[20:23], s46 offen offset:1152
s_mov_b64 vcc, s[80:81]
ds_read_u16 v91, v91
v_cndmask_b32_dpp v92, v104, v100, vcc quad_perm:[1,0,3,2] row_mask:0xf bank_mask:0xf
v_cndmask_b32_dpp v93, v105, v101, vcc quad_perm:[1,0,3,2] row_mask:0xf bank_mask:0xf
v_smfmac_f32_16x16x64_bf16 v[40:43], a[68:71], v[52:59], v174 abid:1
s_waitcnt lgkmcnt(11)
ds_bpermute_b32 v112, v6, v112
v_cndmask_b32_dpp v94, v106, v102, vcc quad_perm:[1,0,3,2] row_mask:0xf bank_mask:0xf
v_smfmac_f32_16x16x64_bf16 v[8:11], a[72:75], v[60:67], v146
s_waitcnt lgkmcnt(10)
ds_bpermute_b32 v113, v6, v113
v_cndmask_b32_dpp v95, v107, v103, vcc quad_perm:[1,0,3,2] row_mask:0xf bank_mask:0xf
v_smfmac_f32_16x16x64_bf16 v[8:11], a[108:111], v[68:75], v150
s_waitcnt lgkmcnt(9)
ds_read_b128 v[44:47], v0 offset:8192
v_smfmac_f32_16x16x64_bf16 v[8:11], v[114:117], v[76:83], v179
ds_read_b128 v[48:51], v1 offset:8192
v_smfmac_f32_16x16x64_bf16 v[12:15], v[114:117], v[76:83], v179 abid:1
ds_read_b128 v[114:117], v2 offset:128
v_add_u32_sdwa v76, s42, v126 dst_sel:DWORD dst_unused:UNUSED_PAD src0_sel:DWORD src1_sel:WORD_0
v_smfmac_f32_16x16x64_bf16 v[12:15], a[76:79], v[60:67], v146 abid:1
ds_read_u16 v76, v76
v_add_u32_sdwa v77, s42, v126 dst_sel:DWORD dst_unused:UNUSED_PAD src0_sel:DWORD src1_sel:WORD_1
v_smfmac_f32_16x16x64_bf16 v[12:15], a[112:115], v[68:75], v150 abid:1
buffer_store_dwordx4 v[92:95], v4, s[20:23], s46 offen offset:128
s_mov_b64 vcc, s[82:83]
ds_read_u16 v77, v77
v_cndmask_b32_dpp v104, v100, v104, vcc quad_perm:[1,0,3,2] row_mask:0xf bank_mask:0xf
v_add_u32_sdwa v78, s42, v127 dst_sel:DWORD dst_unused:UNUSED_PAD src0_sel:DWORD src1_sel:WORD_0
v_smfmac_f32_16x16x64_bf16 v[24:27], a[88:91], v[60:67], v148
ds_read_u16 v78, v78
v_cndmask_b32_dpp v105, v101, v105, vcc quad_perm:[1,0,3,2] row_mask:0xf bank_mask:0xf
v_smfmac_f32_16x16x64_bf16 v[24:27], a[124:127], v[68:75], v152
ds_read_b128 v[52:55], v0 offset:10240
v_cndmask_b32_dpp v106, v102, v106, vcc quad_perm:[1,0,3,2] row_mask:0xf bank_mask:0xf
v_smfmac_f32_16x16x64_bf16 v[28:31], a[92:95], v[60:67], v148 abid:1
ds_read_b128 v[56:59], v1 offset:10240
v_add_u32_sdwa v79, s42, v127 dst_sel:DWORD dst_unused:UNUSED_PAD src0_sel:DWORD src1_sel:WORD_1
v_smfmac_f32_16x16x64_bf16 v[28:31], a[128:131], v[68:75], v152 abid:1
ds_read_u16 v79, v79
v_cndmask_b32_dpp v107, v103, v107, vcc quad_perm:[1,0,3,2] row_mask:0xf bank_mask:0xf
v_smfmac_f32_16x16x64_bf16 v[32:35], a[96:99], v[60:67], v149
ds_read_b128 v[92:95], v0 offset:12288
v_add_u32_sdwa v80, s42, v128 dst_sel:DWORD dst_unused:UNUSED_PAD src0_sel:DWORD src1_sel:WORD_0
v_smfmac_f32_16x16x64_bf16 v[32:35], a[132:135], v[68:75], v153
ds_read_u16 v80, v80
v_add_u32_sdwa v81, s42, v128 dst_sel:DWORD dst_unused:UNUSED_PAD src0_sel:DWORD src1_sel:WORD_1
v_smfmac_f32_16x16x64_bf16 v[16:19], a[80:83], v[60:67], v147
buffer_store_dwordx4 v[104:107], v4, s[20:23], s46 offen offset:1280
s_mov_b64 vcc, s[80:81]
ds_read_u16 v81, v81
v_add_u32_sdwa v82, s42, v129 dst_sel:DWORD dst_unused:UNUSED_PAD src0_sel:DWORD src1_sel:WORD_0
v_add_u32_sdwa v83, s42, v129 dst_sel:DWORD dst_unused:UNUSED_PAD src0_sel:DWORD src1_sel:WORD_1
v_smfmac_f32_16x16x64_bf16 v[16:19], a[116:119], v[68:75], v151
s_waitcnt lgkmcnt(9)
ds_read_b128 v[96:99], v1 offset:12288
v_add_u32_sdwa v100, s42, v130 dst_sel:DWORD dst_unused:UNUSED_PAD src0_sel:DWORD src1_sel:WORD_0
v_smfmac_f32_16x16x64_bf16 v[16:19], v[114:117], v[84:91], v180 abid:1
ds_read_u16 v100, v100
v_add_u32_sdwa v101, s42, v130 dst_sel:DWORD dst_unused:UNUSED_PAD src0_sel:DWORD src1_sel:WORD_1
v_smfmac_f32_16x16x64_bf16 v[20:23], v[114:117], v[84:91], v181
ds_read_u16 v82, v82
v_add_u32_sdwa v102, s42, v131 dst_sel:DWORD dst_unused:UNUSED_PAD src0_sel:DWORD src1_sel:WORD_0
v_smfmac_f32_16x16x64_bf16 v[20:23], a[84:87], v[60:67], v147 abid:1
ds_read_u16 v101, v101
v_add_u32_sdwa v103, s42, v131 dst_sel:DWORD dst_unused:UNUSED_PAD src0_sel:DWORD src1_sel:WORD_1
v_smfmac_f32_16x16x64_bf16 v[20:23], a[120:123], v[68:75], v151 abid:1
ds_read_u16 v83, v83
v_add_u32_sdwa v104, s42, v132 dst_sel:DWORD dst_unused:UNUSED_PAD src0_sel:DWORD src1_sel:WORD_0
v_smfmac_f32_16x16x64_bf16 v[36:39], a[100:103], v[60:67], v149 abid:1
ds_read_b128 v[114:117], v2 offset:192
v_add_u32_sdwa v105, s42, v132 dst_sel:DWORD dst_unused:UNUSED_PAD src0_sel:DWORD src1_sel:WORD_1
v_smfmac_f32_16x16x64_bf16 v[36:39], a[136:139], v[68:75], v153 abid:1
buffer_store_dwordx2 v[112:113], v5, s[20:23], s46 offen
ds_read_u16 v102, v102
v_add_u32_sdwa v106, s42, v133 dst_sel:DWORD dst_unused:UNUSED_PAD src0_sel:DWORD src1_sel:WORD_0
v_smfmac_f32_16x16x64_bf16 v[40:43], a[104:107], v[60:67], v175
s_mov_b32 s22, 75497472
ds_read_u16 v103, v103
v_add_u32_sdwa v107, s42, v133 dst_sel:DWORD dst_unused:UNUSED_PAD src0_sel:DWORD src1_sel:WORD_1
v_smfmac_f32_16x16x64_bf16 v[40:43], a[140:143], v[68:75], v175 abid:1
s_add_u32 s46, s46, s6
ds_read_u16 v104, v104
v_add_u32_sdwa v84, s42, v134 dst_sel:DWORD dst_unused:UNUSED_PAD src0_sel:DWORD src1_sel:WORD_0
v_smfmac_f32_16x16x64_bf16 v[8:11], a[144:147], v[44:51], v154
s_waitcnt lgkmcnt(13)
ds_read_u16 v105, v105
v_add_u32_sdwa v85, s42, v134 dst_sel:DWORD dst_unused:UNUSED_PAD src0_sel:DWORD src1_sel:WORD_1
v_smfmac_f32_16x16x64_bf16 v[8:11], a[180:183], v[52:59], v158
s_waitcnt lgkmcnt(9)
ds_read_u16 v106, v106
v_add_u32_sdwa v86, s42, v135 dst_sel:DWORD dst_unused:UNUSED_PAD src0_sel:DWORD src1_sel:WORD_0
v_smfmac_f32_16x16x64_bf16 v[8:11], a[216:219], v[92:99], v162
s_mov_b32 s6, s14
ds_read_u16 v107, v107
v_add_u32_sdwa v87, s42, v135 dst_sel:DWORD dst_unused:UNUSED_PAD src0_sel:DWORD src1_sel:WORD_1
v_smfmac_f32_16x16x64_bf16 v[24:27], a[160:163], v[44:51], v156
s_mov_b32 s14, 4718592
ds_read_u16 v84, v84
v_add_u32_sdwa v88, s42, v136 dst_sel:DWORD dst_unused:UNUSED_PAD src0_sel:DWORD src1_sel:WORD_0
v_smfmac_f32_16x16x64_bf16 v[24:27], a[196:199], v[52:59], v160
v_add_u32_sdwa v89, s42, v136 dst_sel:DWORD dst_unused:UNUSED_PAD src0_sel:DWORD src1_sel:WORD_1
v_smfmac_f32_16x16x64_bf16 v[24:27], a[232:235], v[92:99], v164
s_waitcnt lgkmcnt(7)
ds_read_u16 v85, v85
v_add_u32_sdwa v90, s42, v137 dst_sel:DWORD dst_unused:UNUSED_PAD src0_sel:DWORD src1_sel:WORD_0
v_smfmac_f32_16x16x64_bf16 v[24:27], v[114:117], v[76:83], v182
ds_read_u16 v86, v86
v_add_u32_sdwa v91, s42, v137 dst_sel:DWORD dst_unused:UNUSED_PAD src0_sel:DWORD src1_sel:WORD_1
v_smfmac_f32_16x16x64_bf16 v[28:31], v[114:117], v[76:83], v182 abid:1
ds_read_b128 v[114:117], v2 offset:256
v_add_u32_sdwa v76, s4, v118 dst_sel:DWORD dst_unused:UNUSED_PAD src0_sel:DWORD src1_sel:WORD_0
v_smfmac_f32_16x16x64_bf16 v[28:31], a[164:167], v[44:51], v156 abid:1
ds_read_u16 v87, v87
v_add_u32_sdwa v77, s4, v118 dst_sel:DWORD dst_unused:UNUSED_PAD src0_sel:DWORD src1_sel:WORD_1
v_smfmac_f32_16x16x64_bf16 v[28:31], a[200:203], v[52:59], v160 abid:1
ds_read_u16 v88, v88
v_add_u32_sdwa v78, s4, v119 dst_sel:DWORD dst_unused:UNUSED_PAD src0_sel:DWORD src1_sel:WORD_0
v_smfmac_f32_16x16x64_bf16 v[28:31], a[236:239], v[92:99], v164 abid:1
ds_read_b128 v[60:63], v0 offset:14336
v_add_u32_sdwa v79, s4, v119 dst_sel:DWORD dst_unused:UNUSED_PAD src0_sel:DWORD src1_sel:WORD_1
v_smfmac_f32_16x16x64_bf16 v[12:15], a[148:151], v[44:51], v154 abid:1
ds_read_u16 v89, v89
v_add_u32_sdwa v80, s4, v120 dst_sel:DWORD dst_unused:UNUSED_PAD src0_sel:DWORD src1_sel:WORD_0
v_smfmac_f32_16x16x64_bf16 v[12:15], a[184:187], v[52:59], v158 abid:1
v_add_u32_sdwa v81, s4, v120 dst_sel:DWORD dst_unused:UNUSED_PAD src0_sel:DWORD src1_sel:WORD_1
v_smfmac_f32_16x16x64_bf16 v[12:15], a[220:223], v[92:99], v162 abid:1
ds_read_b128 v[64:67], v1 offset:14336
v_add_u32_sdwa v82, s4, v121 dst_sel:DWORD dst_unused:UNUSED_PAD src0_sel:DWORD src1_sel:WORD_0
v_smfmac_f32_16x16x64_bf16 v[32:35], a[168:171], v[44:51], v157
ds_read_b128 v[68:71], v0 offset:16384
v_add_u32_sdwa v83, s4, v121 dst_sel:DWORD dst_unused:UNUSED_PAD src0_sel:DWORD src1_sel:WORD_1
v_smfmac_f32_16x16x64_bf16 v[32:35], a[204:207], v[52:59], v161
ds_read_u16 v90, v90
v_smfmac_f32_16x16x64_bf16 v[32:35], a[240:243], v[92:99], v165
s_waitcnt lgkmcnt(7)
ds_read_b128 v[72:75], v1 offset:16384
v_add_u32 v0, s43, v0
v_smfmac_f32_16x16x64_bf16 v[32:35], v[114:117], v[100:107], v183 abid:1
ds_read_u16 v91, v91
v_add_u32 v1, s43, v1
v_smfmac_f32_16x16x64_bf16 v[36:39], v[114:117], v[100:107], v184
ds_read_b128 v[114:117], v2 offset:320
v_smfmac_f32_16x16x64_bf16 v[36:39], a[172:175], v[44:51], v157 abid:1
v_smfmac_f32_16x16x64_bf16 v[36:39], a[208:211], v[52:59], v161 abid:1
v_smfmac_f32_16x16x64_bf16 v[36:39], a[244:247], v[92:99], v165 abid:1
v_smfmac_f32_16x16x64_bf16 v[16:19], a[152:155], v[44:51], v155
v_smfmac_f32_16x16x64_bf16 v[16:19], a[188:191], v[52:59], v159
v_smfmac_f32_16x16x64_bf16 v[16:19], a[224:227], v[92:99], v163
v_smfmac_f32_16x16x64_bf16 v[20:23], a[156:159], v[44:51], v155 abid:1
v_smfmac_f32_16x16x64_bf16 v[20:23], a[192:195], v[52:59], v159 abid:1
v_smfmac_f32_16x16x64_bf16 v[20:23], a[228:231], v[92:99], v163 abid:1
v_smfmac_f32_16x16x64_bf16 v[40:43], a[176:179], v[44:51], v176
s_bitcmp1_b32 s92, s41
v_smfmac_f32_16x16x64_bf16 v[40:43], a[212:215], v[52:59], v176 abid:1
s_cbranch_scc1 L_loopn_w
L_loopn_wb:
v_smfmac_f32_16x16x64_bf16 v[40:43], a[248:251], v[92:99], v177
s_waitcnt lgkmcnt(0)
v_smfmac_f32_16x16x64_bf16 v[40:43], v[114:117], v[84:91], v185
s_waitcnt vmcnt(20)
s_barrier
v_smfmac_f32_16x16x64_bf16 v[8:11], a[252:255], v[60:67], v166
s_mov_b32 s42, s4
ds_read_b128 v[44:47], v0 offset:0
v_smfmac_f32_16x16x64_bf16 v[8:11], v[218:221], v[68:75], v170
ds_read_b128 v[48:51], v1 offset:0
v_add_u32_sdwa v84, s42, v122 dst_sel:DWORD dst_unused:UNUSED_PAD src0_sel:DWORD src1_sel:WORD_0
v_smfmac_f32_16x16x64_bf16 v[12:15], v[186:189], v[60:67], v166 abid:1
ds_read_b128 v[52:55], v0 offset:2048
v_add_u32_sdwa v85, s42, v122 dst_sel:DWORD dst_unused:UNUSED_PAD src0_sel:DWORD src1_sel:WORD_1
v_smfmac_f32_16x16x64_bf16 v[12:15], v[222:225], v[68:75], v170 abid:1
ds_read_b128 v[56:59], v1 offset:2048
v_add_u32_sdwa v86, s42, v123 dst_sel:DWORD dst_unused:UNUSED_PAD src0_sel:DWORD src1_sel:WORD_0
v_smfmac_f32_16x16x64_bf16 v[16:19], v[190:193], v[60:67], v167
ds_read_u16 v76, v76
v_cvt_pk_bf16_f32 v92, v8, v9
v_smfmac_f32_16x16x64_bf16 v[16:19], v[226:229], v[68:75], v171
ds_read_u16 v77, v77
v_cvt_pk_bf16_f32 v93, v10, v11
v_smfmac_f32_16x16x64_bf16 v[20:23], v[194:197], v[60:67], v167 abid:1
ds_read_b128 v[8:11], v2 offset:1024
v_cvt_pk_bf16_f32 v94, v12, v13
v_smfmac_f32_16x16x64_bf16 v[20:23], v[230:233], v[68:75], v171 abid:1
ds_read_u16 v78, v78
v_cvt_pk_bf16_f32 v95, v14, v15
v_smfmac_f32_16x16x64_bf16 v[24:27], v[198:201], v[60:67], v168
ds_read_b128 v[12:15], v2 offset:1088
v_cvt_pk_bf16_f32 v96, v16, v17
v_smfmac_f32_16x16x64_bf16 v[24:27], v[234:237], v[68:75], v172
ds_read_u16 v79, v79
v_cvt_pk_bf16_f32 v97, v18, v19
v_smfmac_f32_16x16x64_bf16 v[28:31], v[202:205], v[60:67], v168 abid:1
ds_read_b128 v[16:19], v2 offset:1152
v_cvt_pk_bf16_f32 v98, v20, v21
v_smfmac_f32_16x16x64_bf16 v[28:31], v[238:241], v[68:75], v172 abid:1
ds_read_u16 v80, v80
v_cvt_pk_bf16_f32 v99, v22, v23
v_smfmac_f32_16x16x64_bf16 v[32:35], v[206:209], v[60:67], v169
ds_read_b128 v[20:23], v2 offset:1216
v_cvt_pk_bf16_f32 v100, v24, v25
v_smfmac_f32_16x16x64_bf16 v[32:35], v[242:245], v[68:75], v173
ds_read_u16 v81, v81
v_cvt_pk_bf16_f32 v101, v26, v27
v_smfmac_f32_16x16x64_bf16 v[36:39], v[210:213], v[60:67], v169 abid:1
ds_read_b128 v[24:27], v2 offset:1280
v_cvt_pk_bf16_f32 v102, v28, v29
v_smfmac_f32_16x16x64_bf16 v[36:39], v[246:249], v[68:75], v173 abid:1
ds_read_u16 v82, v82
v_cvt_pk_bf16_f32 v103, v30, v31
v_smfmac_f32_16x16x64_bf16 v[40:43], v[214:217], v[60:67], v177 abid:1
s_bitcmp1_b32 s12, s41
ds_read_b128 v[28:31], v2 offset:1344
v_cvt_pk_bf16_f32 v104, v32, v33
v_smfmac_f32_16x16x64_bf16 v[40:43], v[250:253], v[68:75], v178
s_waitcnt lgkmcnt(10)
v_cvt_pk_bf16_f32 v105, v34, v35
s_cbranch_scc1 L_loopn
s_cmp_lt_u32 s41, s15
s_cbranch_scc1 L_loop
s_nop 7
v_cvt_pk_bf16_f32 v106, v36, v37
v_cvt_pk_bf16_f32 v107, v38, v39
v_cvt_pk_bf16_f32 v112, v40, v41
v_cvt_pk_bf16_f32 v113, v42, v43
s_nop 1
v_cndmask_b32_dpp v108, v96, v92, vcc quad_perm:[1,0,3,2] row_mask:0xf bank_mask:0xf
s_nop 1
v_cndmask_b32_dpp v109, v97, v93, vcc quad_perm:[1,0,3,2] row_mask:0xf bank_mask:0xf
s_nop 1
v_cndmask_b32_dpp v110, v98, v94, vcc quad_perm:[1,0,3,2] row_mask:0xf bank_mask:0xf
s_nop 1
v_cndmask_b32_dpp v111, v99, v95, vcc quad_perm:[1,0,3,2] row_mask:0xf bank_mask:0xf
s_waitcnt lgkmcnt(0)
buffer_store_dwordx4 v[108:111], v4, s[20:23], s46 offen offset:0
s_nop 1
s_mov_b64 vcc, s[82:83]
s_nop 1
v_cndmask_b32_dpp v96, v92, v96, vcc quad_perm:[1,0,3,2] row_mask:0xf bank_mask:0xf
s_nop 1
v_cndmask_b32_dpp v97, v93, v97, vcc quad_perm:[1,0,3,2] row_mask:0xf bank_mask:0xf
s_nop 1
v_cndmask_b32_dpp v98, v94, v98, vcc quad_perm:[1,0,3,2] row_mask:0xf bank_mask:0xf
s_nop 1
v_cndmask_b32_dpp v99, v95, v99, vcc quad_perm:[1,0,3,2] row_mask:0xf bank_mask:0xf
s_waitcnt lgkmcnt(0)
buffer_store_dwordx4 v[96:99], v4, s[20:23], s46 offen offset:1152
s_nop 1
s_mov_b64 vcc, s[80:81]
s_nop 1
v_cndmask_b32_dpp v92, v104, v100, vcc quad_perm:[1,0,3,2] row_mask:0xf bank_mask:0xf
s_nop 1
v_cndmask_b32_dpp v93, v105, v101, vcc quad_perm:[1,0,3,2] row_mask:0xf bank_mask:0xf
s_nop 1
ds_bpermute_b32 v112, v6, v112
s_nop 1
v_cndmask_b32_dpp v94, v106, v102, vcc quad_perm:[1,0,3,2] row_mask:0xf bank_mask:0xf
s_nop 1
ds_bpermute_b32 v113, v6, v113
s_nop 1
v_cndmask_b32_dpp v95, v107, v103, vcc quad_perm:[1,0,3,2] row_mask:0xf bank_mask:0xf
s_waitcnt lgkmcnt(0)
buffer_store_dwordx4 v[92:95], v4, s[20:23], s46 offen offset:128
s_nop 1
s_mov_b64 vcc, s[82:83]
s_nop 1
v_cndmask_b32_dpp v104, v100, v104, vcc quad_perm:[1,0,3,2] row_mask:0xf bank_mask:0xf
s_nop 1
v_cndmask_b32_dpp v105, v101, v105, vcc quad_perm:[1,0,3,2] row_mask:0xf bank_mask:0xf
s_nop 1
v_cndmask_b32_dpp v106, v102, v106, vcc quad_perm:[1,0,3,2] row_mask:0xf bank_mask:0xf
s_nop 1
v_cndmask_b32_dpp v107, v103, v107, vcc quad_perm:[1,0,3,2] row_mask:0xf bank_mask:0xf
s_waitcnt lgkmcnt(0)
buffer_store_dwordx4 v[104:107], v4, s[20:23], s46 offen offset:1280
s_nop 1
s_mov_b64 vcc, s[80:81]
s_waitcnt lgkmcnt(0)
buffer_store_dwordx2 v[112:113], v5, s[20:23], s46 offen
s_nop 1
L_fin:
L_end_standalone__structured_sparse_n_m__ragged_kernel:
s_endpgm
L_more1:
v_and_b32 v73, v94, v16
v_lshrrev_b32 v72, 10, v16
v_cmp_eq_u32 s[64:65], v73, v95
v_and_or_b32 v32, v72, v96, v97
s_mov_b64 exec, s[64:65]
ds_add_rtn_u32 v48, v32, v88
s_mov_b64 exec, -1
v_and_b32 v73, v94, v17
v_lshrrev_b32 v72, 10, v17
v_cmp_eq_u32 s[66:67], v73, v95
v_and_or_b32 v33, v72, v96, v97
s_mov_b64 exec, s[66:67]
ds_add_rtn_u32 v49, v33, v88
s_mov_b64 exec, -1
v_and_b32 v73, v94, v18
v_lshrrev_b32 v72, 10, v18
v_cmp_eq_u32 s[68:69], v73, v95
v_and_or_b32 v34, v72, v96, v97
s_mov_b64 exec, s[68:69]
ds_add_rtn_u32 v50, v34, v88
s_mov_b64 exec, -1
v_and_b32 v73, v94, v19
v_lshrrev_b32 v72, 10, v19
v_cmp_eq_u32 s[70:71], v73, v95
v_and_or_b32 v35, v72, v96, v97
s_mov_b64 exec, s[70:71]
ds_add_rtn_u32 v51, v35, v88
s_mov_b64 exec, -1
v_and_b32 v73, v94, v20
v_lshrrev_b32 v72, 10, v20
v_cmp_eq_u32 s[72:73], v73, v95
v_and_or_b32 v36, v72, v96, v97
s_mov_b64 exec, s[72:73]
ds_add_rtn_u32 v52, v36, v88
s_mov_b64 exec, -1
v_and_b32 v73, v94, v21
v_lshrrev_b32 v72, 10, v21
v_cmp_eq_u32 s[74:75], v73, v95
v_and_or_b32 v37, v72, v96, v97
s_mov_b64 exec, s[74:75]
ds_add_rtn_u32 v53, v37, v88
s_mov_b64 exec, -1
v_and_b32 v73, v94, v22
v_lshrrev_b32 v72, 10, v22
v_cmp_eq_u32 s[76:77], v73, v95
v_and_or_b32 v38, v72, v96, v97
s_mov_b64 exec, s[76:77]
ds_add_rtn_u32 v54, v38, v88
s_mov_b64 exec, -1
s_branch L_more1b
L_greedy:
s_mov_b32 s47, 0
s_mov_b32 s89, 1
v_readlane_b32 s3, v72, 0
s_max_u32 s47, s47, 0
v_writelane_b32 v91, s47, 0
s_nop 1
s_add_u32 s47, s47, s3
s_cmp_gt_u32 s47, 32
s_cselect_b32 s90, 1, s90
v_readlane_b32 s3, v72, 1
s_max_u32 s47, s47, 0
v_writelane_b32 v91, s47, 1
s_nop 1
s_add_u32 s47, s47, s3
s_cmp_gt_u32 s47, 64
s_cselect_b32 s90, 1, s90
v_readlane_b32 s3, v72, 2
s_max_u32 s47, s47, 32
v_writelane_b32 v91, s47, 2
s_nop 1
s_add_u32 s47, s47, s3
s_cmp_gt_u32 s47, 64
s_cselect_b32 s90, 1, s90
v_readlane_b32 s3, v72, 3
s_max_u32 s47, s47, 32
v_writelane_b32 v91, s47, 3
s_nop 1
s_add_u32 s47, s47, s3
s_cmp_gt_u32 s47, 96
s_cselect_b32 s90, 1, s90
v_readlane_b32 s3, v72, 4
s_max_u32 s47, s47, 64
v_writelane_b32 v91, s47, 4
s_nop 1
s_add_u32 s47, s47, s3
s_cmp_gt_u32 s47, 96
s_cselect_b32 s90, 1, s90
v_readlane_b32 s3, v72, 5
s_max_u32 s47, s47, 64
v_writelane_b32 v91, s47, 5
s_nop 1
s_add_u32 s47, s47, s3
s_cmp_gt_u32 s47, 128
s_cselect_b32 s90, 1, s90
v_readlane_b32 s3, v72, 6
s_max_u32 s47, s47, 96
v_writelane_b32 v91, s47, 6
s_nop 1
s_add_u32 s47, s47, s3
s_cmp_gt_u32 s47, 128
s_cselect_b32 s90, 1, s90
v_readlane_b32 s3, v72, 7
s_max_u32 s47, s47, 96
v_writelane_b32 v91, s47, 7
s_nop 1
s_add_u32 s47, s47, s3
s_cmp_gt_u32 s47, 160
s_cselect_b32 s90, 1, s90
v_readlane_b32 s3, v72, 8
s_max_u32 s47, s47, 128
v_writelane_b32 v91, s47, 8
s_nop 1
s_add_u32 s47, s47, s3
s_cmp_gt_u32 s47, 160
s_cselect_b32 s90, 1, s90
s_cmp_lg_u32 s90, 0
s_cselect_b64 s[90:91], -1, 0
v_mov_b32 v73, 162048
s_mov_b64 exec, s[90:91]
ds_write_b32 v73, v88
s_mov_b64 exec, -1
s_branch L_greedyb
L_more2:
ds_bpermute_b32 v64, v32, v91
ds_bpermute_b32 v65, v33, v91
ds_bpermute_b32 v66, v34, v91
ds_bpermute_b32 v67, v35, v91
ds_bpermute_b32 v68, v36, v91
ds_bpermute_b32 v69, v37, v91
ds_bpermute_b32 v70, v38, v91
s_waitcnt lgkmcnt(0)
v_add_u32 v73, v48, v64
v_and_b32 v72, 0x87e, v16
v_lshl_add_u32 v73, v73, 1, s93
v_add_u32 v72, v90, v72
s_andn2_b64 exec, s[64:65], s[90:91]
ds_write_b16_d16_hi v73, v16 offset:64
ds_write_b16 v73, v72 offset:384
ds_write_b16 v73, v16 offset:704
s_mov_b64 exec, -1
v_add_u32 v73, v49, v65
v_and_b32 v72, 0x87e, v17
v_lshl_add_u32 v73, v73, 1, s93
v_add_u32 v72, v90, v72
s_andn2_b64 exec, s[66:67], s[90:91]
ds_write_b16_d16_hi v73, v17 offset:64
ds_write_b16 v73, v72 offset:384
ds_write_b16 v73, v17 offset:704
s_mov_b64 exec, -1
v_add_u32 v73, v50, v66
v_and_b32 v72, 0x87e, v18
v_lshl_add_u32 v73, v73, 1, s93
v_add_u32 v72, v90, v72
s_andn2_b64 exec, s[68:69], s[90:91]
ds_write_b16_d16_hi v73, v18 offset:64
ds_write_b16 v73, v72 offset:384
ds_write_b16 v73, v18 offset:704
s_mov_b64 exec, -1
v_add_u32 v73, v51, v67
v_and_b32 v72, 0x87e, v19
v_lshl_add_u32 v73, v73, 1, s93
v_add_u32 v72, v90, v72
s_andn2_b64 exec, s[70:71], s[90:91]
ds_write_b16_d16_hi v73, v19 offset:64
ds_write_b16 v73, v72 offset:384
ds_write_b16 v73, v19 offset:704
s_mov_b64 exec, -1
v_add_u32 v73, v52, v68
v_and_b32 v72, 0x87e, v20
v_lshl_add_u32 v73, v73, 1, s93
v_add_u32 v72, v90, v72
s_andn2_b64 exec, s[72:73], s[90:91]
ds_write_b16_d16_hi v73, v20 offset:64
ds_write_b16 v73, v72 offset:384
ds_write_b16 v73, v20 offset:704
s_mov_b64 exec, -1
v_add_u32 v73, v53, v69
v_and_b32 v72, 0x87e, v21
v_lshl_add_u32 v73, v73, 1, s93
v_add_u32 v72, v90, v72
s_andn2_b64 exec, s[74:75], s[90:91]
ds_write_b16_d16_hi v73, v21 offset:64
ds_write_b16 v73, v72 offset:384
ds_write_b16 v73, v21 offset:704
s_mov_b64 exec, -1
v_add_u32 v73, v54, v70
v_and_b32 v72, 0x87e, v22
v_lshl_add_u32 v73, v73, 1, s93
v_add_u32 v72, v90, v72
s_andn2_b64 exec, s[76:77], s[90:91]
ds_write_b16_d16_hi v73, v22 offset:64
ds_write_b16 v73, v72 offset:384
ds_write_b16 v73, v22 offset:704
s_mov_b64 exec, -1
s_branch L_more2b
L_giveup:
s_waitcnt vmcnt(0)
v_mov_b32 v8, 162048
v_mov_b32 v9, 1
ds_write_b32 v8, v9
s_branch L_polled
L_loop_w:
s_bitcmp1_b32 s87, s41
s_waitcnt vmcnt(10)
s_cbranch_scc0 L_loop_wb
s_waitcnt vmcnt(0)
s_branch L_loop_wb
L_loopn_w:
s_bitcmp1_b32 s87, s41
s_waitcnt vmcnt(10)
s_cbranch_scc0 L_loopn_wb
s_waitcnt vmcnt(0)
s_branch L_loopn_wb
L_linked:
v_add_u32_sdwa v76, s4, v118 dst_sel:DWORD dst_unused:UNUSED_PAD src0_sel:DWORD src1_sel:WORD_0
v_add_u32_sdwa v77, s4, v118 dst_sel:DWORD dst_unused:UNUSED_PAD src0_sel:DWORD src1_sel:WORD_1
v_add_u32_sdwa v78, s4, v119 dst_sel:DWORD dst_unused:UNUSED_PAD src0_sel:DWORD src1_sel:WORD_0
v_add_u32_sdwa v79, s4, v119 dst_sel:DWORD dst_unused:UNUSED_PAD src0_sel:DWORD src1_sel:WORD_1
v_add_u32_sdwa v80, s4, v120 dst_sel:DWORD dst_unused:UNUSED_PAD src0_sel:DWORD src1_sel:WORD_0
v_add_u32_sdwa v81, s4, v120 dst_sel:DWORD dst_unused:UNUSED_PAD src0_sel:DWORD src1_sel:WORD_1
buffer_load_dwordx4 a[236:239], v104, s[24:27], s99 offen offset:3072 sc1
v_add_u32_sdwa v82, s4, v121 dst_sel:DWORD dst_unused:UNUSED_PAD src0_sel:DWORD src1_sel:WORD_0
v_add_u32_sdwa v83, s4, v121 dst_sel:DWORD dst_unused:UNUSED_PAD src0_sel:DWORD src1_sel:WORD_1
v_add_u32_sdwa v84, s42, v122 dst_sel:DWORD dst_unused:UNUSED_PAD src0_sel:DWORD src1_sel:WORD_0
v_add_u32_sdwa v85, s42, v122 dst_sel:DWORD dst_unused:UNUSED_PAD src0_sel:DWORD src1_sel:WORD_1
v_add_u32_sdwa v86, s42, v123 dst_sel:DWORD dst_unused:UNUSED_PAD src0_sel:DWORD src1_sel:WORD_0
ds_read_b128 v[44:47], v0 offset:0
s_mov_b32 s99, 61440
buffer_load_dwordx4 a[240:243], v104, s[24:27], s99 offen offset:0 sc1
ds_read_b128 v[48:51], v1 offset:0
ds_read_b128 v[52:55], v0 offset:2048
ds_read_b128 v[56:59], v1 offset:2048
ds_read_u16 v76, v76
ds_read_u16 v77, v77
ds_read_b128 v[8:11], v2 offset:1024
buffer_load_dwordx4 a[244:247], v104, s[24:27], s99 offen offset:1024 sc1
ds_read_u16 v78, v78
ds_read_b128 v[12:15], v2 offset:1088
ds_read_u16 v79, v79
ds_read_b128 v[16:19], v2 offset:1152
ds_read_u16 v80, v80
ds_read_b128 v[20:23], v2 offset:1216
buffer_load_dwordx4 a[248:251], v104, s[24:27], s99 offen offset:2048 sc1
ds_read_u16 v81, v81
ds_read_b128 v[24:27], v2 offset:1280
ds_read_u16 v82, v82
ds_read_b128 v[28:31], v2 offset:1344
s_mov_b32 s98, 7168
buffer_load_dwordx4 v[166:169], v105, s[24:27], s98 offen sc1
buffer_load_dwordx4 a[252:255], v104, s[24:27], s99 offen offset:3072 sc1
s_mov_b32 s99, 65536
buffer_load_dwordx4 v[186:189], v104, s[24:27], s99 offen offset:0 sc1
buffer_load_dwordx4 v[190:193], v104, s[24:27], s99 offen offset:1024 sc1
buffer_load_dwordx4 v[194:197], v104, s[24:27], s99 offen offset:2048 sc1
buffer_load_dwordx4 v[198:201], v104, s[24:27], s99 offen offset:3072 sc1
s_waitcnt lgkmcnt(0)
v_readfirstlane_b32 s47, v108
s_nop 3
s_cmp_lg_u32 s47, 0
s_cbranch_scc1 L_slow
s_mov_b32 s99, 69632
buffer_load_dwordx4 v[202:205], v104, s[24:27], s99 offen offset:0 sc1
buffer_load_dwordx4 v[206:209], v104, s[24:27], s99 offen offset:1024 sc1
buffer_load_dwordx4 v[210:213], v104, s[24:27], s99 offen offset:2048 sc1
buffer_load_dwordx4 v[214:217], v104, s[24:27], s99 offen offset:3072 sc1
s_mov_b32 s98, 8192
buffer_load_dwordx4 v[170:173], v105, s[24:27], s98 offen sc1
s_mov_b32 s99, 73728
buffer_load_dwordx4 v[218:221], v104, s[24:27], s99 offen offset:0 sc1
buffer_load_dwordx4 v[222:225], v104, s[24:27], s99 offen offset:1024 sc1
buffer_load_dwordx4 v[226:229], v104, s[24:27], s99 offen offset:2048 sc1
buffer_load_dwordx4 v[230:233], v104, s[24:27], s99 offen offset:3072 sc1
s_mov_b32 s99, 77824
buffer_load_dwordx4 v[234:237], v104, s[24:27], s99 offen offset:0 sc1
buffer_load_dwordx4 v[238:241], v104, s[24:27], s99 offen offset:1024 sc1
buffer_load_dwordx4 v[242:245], v104, s[24:27], s99 offen offset:2048 sc1
buffer_load_dwordx4 v[246:249], v104, s[24:27], s99 offen offset:3072 sc1
s_mov_b32 s99, 81920
buffer_load_dwordx4 v[250:253], v104, s[24:27], s99 offen offset:0 sc1
s_bfe_u32 s88, s85, 0x40018
s_cbranch_scc0 L_pf2k_e
L_pf2k:
s_add_u32 m0, s44, 0
s_nop 0
buffer_load_dwordx4 v3, s[16:19], s45 offen offset:0 nt lds
s_add_u32 m0, s44, 3840
s_nop 0
buffer_load_dwordx4 v3, s[16:19], s45 offen offset:256 nt lds
s_add_u32 m0, s44, 7680
s_nop 0
buffer_load_dwordx4 v3, s[16:19], s45 offen offset:512 nt lds
s_add_u32 m0, s44, 11520
s_nop 0
buffer_load_dwordx4 v3, s[16:19], s45 offen offset:768 nt lds
s_add_u32 m0, s44, s8
s_mov_b64 exec, s[10:11]
buffer_load_dwordx4 v3, s[16:19], s7 offen offset:896 nt lds
s_mov_b64 exec, -1
s_add_u32 s7, s7, s13
s_add_u32 s44, s44, 18432
s_add_u32 s45, s45, s13
s_mov_b32 s13, 4718592
s_sub_u32 s88, s88, 1
s_cmp_lg_u32 s88, 0
s_cbranch_scc1 L_pf2k
L_pf2k_e:
s_cmp_ge_u32 s44, 147456
s_cselect_b32 s44, s9, s44
s_waitcnt vmcnt(20)
s_bitcmp1_b32 s85, 0
s_cbranch_scc0 L_loopnk
.p2align 6
L_loopk:
v_smfmac_f32_16x16x64_bf16 v[8:11], a[0:3], v[44:51], v138
ds_read_b128 v[32:35], v2 offset:1408
v_cvt_pk_bf16_f32 v106, v36, v37
v_smfmac_f32_16x16x64_bf16 v[8:11], a[36:39], v[52:59], v142
s_waitcnt lgkmcnt(9)
ds_read_b128 v[60:63], v0 offset:4096
v_cvt_pk_bf16_f32 v107, v38, v39
v_smfmac_f32_16x16x64_bf16 v[12:15], a[4:7], v[44:51], v138 abid:1
ds_read_b128 v[36:39], v2 offset:1472
v_cvt_pk_bf16_f32 v112, v40, v41
v_smfmac_f32_16x16x64_bf16 v[12:15], a[40:43], v[52:59], v142 abid:1
s_waitcnt lgkmcnt(9)
ds_read_u16 v84, v84
v_cvt_pk_bf16_f32 v113, v42, v43
v_smfmac_f32_16x16x64_bf16 v[16:19], a[8:11], v[44:51], v139
s_cmp_eq_u32 s4, 129024
ds_read_b128 v[40:43], v2 offset:1536
v_cndmask_b32_dpp v108, v96, v92, vcc quad_perm:[1,0,3,2] row_mask:0xf bank_mask:0xf
v_smfmac_f32_16x16x64_bf16 v[16:19], a[44:47], v[52:59], v143
s_waitcnt lgkmcnt(9)
ds_read_b128 v[64:67], v1 offset:4096
v_cndmask_b32_dpp v109, v97, v93, vcc quad_perm:[1,0,3,2] row_mask:0xf bank_mask:0xf
v_smfmac_f32_16x16x64_bf16 v[20:23], a[12:15], v[44:51], v139 abid:1
s_cselect_b32 s43, -129024, s5
ds_read_b128 v[68:71], v0 offset:6144
v_cndmask_b32_dpp v110, v98, v94, vcc quad_perm:[1,0,3,2] row_mask:0xf bank_mask:0xf
v_smfmac_f32_16x16x64_bf16 v[20:23], a[48:51], v[52:59], v143 abid:1
s_waitcnt lgkmcnt(9)
ds_read_b128 v[72:75], v1 offset:6144
v_cndmask_b32_dpp v111, v99, v95, vcc quad_perm:[1,0,3,2] row_mask:0xf bank_mask:0xf
v_smfmac_f32_16x16x64_bf16 v[24:27], a[16:19], v[44:51], v140
s_add_u32 s4, s4, s43
ds_read_u16 v83, v83
v_add_u32_sdwa v87, s42, v123 dst_sel:DWORD dst_unused:UNUSED_PAD src0_sel:DWORD src1_sel:WORD_1
v_smfmac_f32_16x16x64_bf16 v[24:27], a[52:55], v[52:59], v144
buffer_store_dwordx4 v[108:111], v4, s[20:23], s46 offen offset:0
s_mov_b64 vcc, s[82:83]
s_waitcnt lgkmcnt(9)
ds_read_b128 v[114:117], v2 offset:64
v_cndmask_b32_dpp v96, v92, v96, vcc quad_perm:[1,0,3,2] row_mask:0xf bank_mask:0xf
v_cndmask_b32_dpp v97, v93, v97, vcc quad_perm:[1,0,3,2] row_mask:0xf bank_mask:0xf
v_smfmac_f32_16x16x64_bf16 v[28:31], a[20:23], v[44:51], v140 abid:1
s_add_u32 s41, s41, 1
ds_read_u16 v85, v85
v_cndmask_b32_dpp v98, v94, v98, vcc quad_perm:[1,0,3,2] row_mask:0xf bank_mask:0xf
v_smfmac_f32_16x16x64_bf16 v[28:31], a[56:59], v[52:59], v144 abid:1
s_waitcnt lgkmcnt(10)
ds_read_u16 v86, v86
v_cndmask_b32_dpp v99, v95, v99, vcc quad_perm:[1,0,3,2] row_mask:0xf bank_mask:0xf
v_smfmac_f32_16x16x64_bf16 v[32:35], a[24:27], v[44:51], v141
ds_read_u16 v87, v87
v_add_u32_sdwa v88, s42, v124 dst_sel:DWORD dst_unused:UNUSED_PAD src0_sel:DWORD src1_sel:WORD_0
v_smfmac_f32_16x16x64_bf16 v[32:35], a[60:63], v[52:59], v145
s_waitcnt lgkmcnt(10)
ds_read_u16 v88, v88
v_add_u32_sdwa v89, s42, v124 dst_sel:DWORD dst_unused:UNUSED_PAD src0_sel:DWORD src1_sel:WORD_1
v_smfmac_f32_16x16x64_bf16 v[36:39], a[28:31], v[44:51], v141 abid:1
ds_read_u16 v89, v89
v_add_u32_sdwa v90, s42, v125 dst_sel:DWORD dst_unused:UNUSED_PAD src0_sel:DWORD src1_sel:WORD_0
v_smfmac_f32_16x16x64_bf16 v[36:39], a[64:67], v[52:59], v145 abid:1
s_waitcnt lgkmcnt(10)
ds_read_u16 v90, v90
v_add_u32_sdwa v91, s42, v125 dst_sel:DWORD dst_unused:UNUSED_PAD src0_sel:DWORD src1_sel:WORD_1
v_smfmac_f32_16x16x64_bf16 v[40:43], a[32:35], v[44:51], v174
buffer_store_dwordx4 v[96:99], v4, s[20:23], s46 offen offset:1152
s_mov_b64 vcc, s[80:81]
ds_read_u16 v91, v91
v_cndmask_b32_dpp v92, v104, v100, vcc quad_perm:[1,0,3,2] row_mask:0xf bank_mask:0xf
v_cndmask_b32_dpp v93, v105, v101, vcc quad_perm:[1,0,3,2] row_mask:0xf bank_mask:0xf
v_smfmac_f32_16x16x64_bf16 v[40:43], a[68:71], v[52:59], v174 abid:1
s_waitcnt lgkmcnt(11)
ds_bpermute_b32 v112, v6, v112
v_cndmask_b32_dpp v94, v106, v102, vcc quad_perm:[1,0,3,2] row_mask:0xf bank_mask:0xf
v_smfmac_f32_16x16x64_bf16 v[8:11], a[72:75], v[60:67], v146
s_waitcnt lgkmcnt(10)
ds_bpermute_b32 v113, v6, v113
v_cndmask_b32_dpp v95, v107, v103, vcc quad_perm:[1,0,3,2] row_mask:0xf bank_mask:0xf
v_smfmac_f32_16x16x64_bf16 v[8:11], a[108:111], v[68:75], v150
s_waitcnt lgkmcnt(9)
ds_read_b128 v[44:47], v0 offset:8192
v_smfmac_f32_16x16x64_bf16 v[8:11], v[114:117], v[76:83], v179
ds_read_b128 v[48:51], v1 offset:8192
v_smfmac_f32_16x16x64_bf16 v[12:15], v[114:117], v[76:83], v179 abid:1
ds_read_b128 v[114:117], v2 offset:128
v_add_u32_sdwa v76, s42, v126 dst_sel:DWORD dst_unused:UNUSED_PAD src0_sel:DWORD src1_sel:WORD_0
v_smfmac_f32_16x16x64_bf16 v[12:15], a[76:79], v[60:67], v146 abid:1
ds_read_u16 v76, v76
v_add_u32_sdwa v77, s42, v126 dst_sel:DWORD dst_unused:UNUSED_PAD src0_sel:DWORD src1_sel:WORD_1
v_smfmac_f32_16x16x64_bf16 v[12:15], a[112:115], v[68:75], v150 abid:1
buffer_store_dwordx4 v[92:95], v4, s[20:23], s46 offen offset:128
s_mov_b64 vcc, s[82:83]
ds_read_u16 v77, v77
v_cndmask_b32_dpp v104, v100, v104, vcc quad_perm:[1,0,3,2] row_mask:0xf bank_mask:0xf
v_cndmask_b32_dpp v105, v101, v105, vcc quad_perm:[1,0,3,2] row_mask:0xf bank_mask:0xf
v_smfmac_f32_16x16x64_bf16 v[24:27], a[88:91], v[60:67], v148
ds_read_b128 v[52:55], v0 offset:10240
v_add_u32_sdwa v78, s42, v127 dst_sel:DWORD dst_unused:UNUSED_PAD src0_sel:DWORD src1_sel:WORD_0
v_smfmac_f32_16x16x64_bf16 v[24:27], a[124:127], v[68:75], v152
ds_read_u16 v78, v78
v_cndmask_b32_dpp v106, v102, v106, vcc quad_perm:[1,0,3,2] row_mask:0xf bank_mask:0xf
v_smfmac_f32_16x16x64_bf16 v[28:31], a[92:95], v[60:67], v148 abid:1
ds_read_b128 v[56:59], v1 offset:10240
v_cndmask_b32_dpp v107, v103, v107, vcc quad_perm:[1,0,3,2] row_mask:0xf bank_mask:0xf
v_smfmac_f32_16x16x64_bf16 v[28:31], a[128:131], v[68:75], v152 abid:1
ds_read_b128 v[92:95], v0 offset:12288
v_add_u32_sdwa v79, s42, v127 dst_sel:DWORD dst_unused:UNUSED_PAD src0_sel:DWORD src1_sel:WORD_1
v_smfmac_f32_16x16x64_bf16 v[32:35], a[96:99], v[60:67], v149
ds_read_u16 v79, v79
v_add_u32_sdwa v80, s42, v128 dst_sel:DWORD dst_unused:UNUSED_PAD src0_sel:DWORD src1_sel:WORD_0
v_smfmac_f32_16x16x64_bf16 v[32:35], a[132:135], v[68:75], v153
ds_read_u16 v80, v80
v_add_u32_sdwa v81, s42, v128 dst_sel:DWORD dst_unused:UNUSED_PAD src0_sel:DWORD src1_sel:WORD_1
v_smfmac_f32_16x16x64_bf16 v[16:19], a[80:83], v[60:67], v147
buffer_store_dwordx4 v[104:107], v4, s[20:23], s46 offen offset:1280
s_mov_b64 vcc, s[80:81]
ds_read_u16 v81, v81
v_add_u32_sdwa v82, s42, v129 dst_sel:DWORD dst_unused:UNUSED_PAD src0_sel:DWORD src1_sel:WORD_0
v_add_u32_sdwa v83, s42, v129 dst_sel:DWORD dst_unused:UNUSED_PAD src0_sel:DWORD src1_sel:WORD_1
v_smfmac_f32_16x16x64_bf16 v[16:19], a[116:119], v[68:75], v151
s_waitcnt lgkmcnt(9)
ds_read_b128 v[96:99], v1 offset:12288
v_add_u32_sdwa v100, s42, v130 dst_sel:DWORD dst_unused:UNUSED_PAD src0_sel:DWORD src1_sel:WORD_0
v_smfmac_f32_16x16x64_bf16 v[16:19], v[114:117], v[84:91], v180 abid:1
ds_read_u16 v82, v82
v_add_u32_sdwa v101, s42, v130 dst_sel:DWORD dst_unused:UNUSED_PAD src0_sel:DWORD src1_sel:WORD_1
v_smfmac_f32_16x16x64_bf16 v[12:15], v[114:117], v[84:91], v180
ds_read_u16 v100, v100
v_add_u32_sdwa v102, s42, v131 dst_sel:DWORD dst_unused:UNUSED_PAD src0_sel:DWORD src1_sel:WORD_0
v_smfmac_f32_16x16x64_bf16 v[20:23], v[114:117], v[84:91], v181
ds_read_u16 v83, v83
v_add_u32_sdwa v103, s42, v131 dst_sel:DWORD dst_unused:UNUSED_PAD src0_sel:DWORD src1_sel:WORD_1
v_smfmac_f32_16x16x64_bf16 v[20:23], a[84:87], v[60:67], v147 abid:1
ds_read_b128 v[114:117], v2 offset:192
v_add_u32_sdwa v104, s42, v132 dst_sel:DWORD dst_unused:UNUSED_PAD src0_sel:DWORD src1_sel:WORD_0
v_smfmac_f32_16x16x64_bf16 v[20:23], a[120:123], v[68:75], v151 abid:1
ds_read_u16 v101, v101
v_add_u32_sdwa v105, s42, v132 dst_sel:DWORD dst_unused:UNUSED_PAD src0_sel:DWORD src1_sel:WORD_1
v_smfmac_f32_16x16x64_bf16 v[36:39], a[100:103], v[60:67], v149 abid:1
buffer_store_dwordx2 v[112:113], v5, s[20:23], s46 offen
ds_read_u16 v102, v102
v_add_u32_sdwa v106, s42, v133 dst_sel:DWORD dst_unused:UNUSED_PAD src0_sel:DWORD src1_sel:WORD_0
v_smfmac_f32_16x16x64_bf16 v[36:39], a[136:139], v[68:75], v153 abid:1
s_mov_b32 s22, 75497472
ds_read_u16 v103, v103
v_add_u32_sdwa v107, s42, v133 dst_sel:DWORD dst_unused:UNUSED_PAD src0_sel:DWORD src1_sel:WORD_1
v_smfmac_f32_16x16x64_bf16 v[40:43], a[104:107], v[60:67], v175
s_add_u32 s46, s46, s6
ds_read_u16 v104, v104
v_add_u32_sdwa v84, s42, v134 dst_sel:DWORD dst_unused:UNUSED_PAD src0_sel:DWORD src1_sel:WORD_0
v_smfmac_f32_16x16x64_bf16 v[40:43], a[140:143], v[68:75], v175 abid:1
s_mov_b32 s6, s14
ds_read_u16 v105, v105
v_add_u32_sdwa v85, s42, v134 dst_sel:DWORD dst_unused:UNUSED_PAD src0_sel:DWORD src1_sel:WORD_1
v_smfmac_f32_16x16x64_bf16 v[8:11], a[144:147], v[44:51], v154
s_waitcnt lgkmcnt(14)
ds_read_u16 v106, v106
v_add_u32_sdwa v86, s42, v135 dst_sel:DWORD dst_unused:UNUSED_PAD src0_sel:DWORD src1_sel:WORD_0
v_smfmac_f32_16x16x64_bf16 v[8:11], a[180:183], v[52:59], v158
s_waitcnt lgkmcnt(10)
ds_read_u16 v107, v107
v_add_u32_sdwa v87, s42, v135 dst_sel:DWORD dst_unused:UNUSED_PAD src0_sel:DWORD src1_sel:WORD_1
v_smfmac_f32_16x16x64_bf16 v[8:11], a[216:219], v[92:99], v162
s_add_u32 m0, s44, 0
ds_read_u16 v84, v84
v_add_u32_sdwa v88, s42, v136 dst_sel:DWORD dst_unused:UNUSED_PAD src0_sel:DWORD src1_sel:WORD_0
v_smfmac_f32_16x16x64_bf16 v[24:27], a[160:163], v[44:51], v156
buffer_load_dwordx4 v3, s[16:19], s45 offen offset:0 nt lds
v_add_u32_sdwa v89, s42, v136 dst_sel:DWORD dst_unused:UNUSED_PAD src0_sel:DWORD src1_sel:WORD_1
v_smfmac_f32_16x16x64_bf16 v[24:27], a[196:199], v[52:59], v160
s_mov_b32 s14, 4718592
ds_read_u16 v85, v85
v_add_u32_sdwa v90, s42, v137 dst_sel:DWORD dst_unused:UNUSED_PAD src0_sel:DWORD src1_sel:WORD_0
v_smfmac_f32_16x16x64_bf16 v[24:27], a[232:235], v[92:99], v164
s_waitcnt lgkmcnt(9)
ds_read_u16 v86, v86
v_add_u32_sdwa v91, s42, v137 dst_sel:DWORD dst_unused:UNUSED_PAD src0_sel:DWORD src1_sel:WORD_1
v_smfmac_f32_16x16x64_bf16 v[24:27], v[114:117], v[76:83], v182
ds_read_u16 v87, v87
v_smfmac_f32_16x16x64_bf16 v[20:23], v[114:117], v[76:83], v181 abid:1
ds_read_u16 v88, v88
v_smfmac_f32_16x16x64_bf16 v[28:31], v[114:117], v[76:83], v182 abid:1
ds_read_b128 v[114:117], v2 offset:256
v_add_u32_sdwa v76, s4, v118 dst_sel:DWORD dst_unused:UNUSED_PAD src0_sel:DWORD src1_sel:WORD_0
v_smfmac_f32_16x16x64_bf16 v[28:31], a[164:167], v[44:51], v156 abid:1
ds_read_b128 v[60:63], v0 offset:14336
v_add_u32_sdwa v77, s4, v118 dst_sel:DWORD dst_unused:UNUSED_PAD src0_sel:DWORD src1_sel:WORD_1
v_smfmac_f32_16x16x64_bf16 v[28:31], a[200:203], v[52:59], v160 abid:1
s_add_u32 m0, s44, 3840
ds_read_u16 v89, v89
v_add_u32_sdwa v78, s4, v119 dst_sel:DWORD dst_unused:UNUSED_PAD src0_sel:DWORD src1_sel:WORD_0
v_smfmac_f32_16x16x64_bf16 v[28:31], a[236:239], v[92:99], v164 abid:1
buffer_load_dwordx4 v3, s[16:19], s45 offen offset:256 nt lds
v_add_u32_sdwa v79, s4, v119 dst_sel:DWORD dst_unused:UNUSED_PAD src0_sel:DWORD src1_sel:WORD_1
v_smfmac_f32_16x16x64_bf16 v[12:15], a[148:151], v[44:51], v154 abid:1
ds_read_b128 v[64:67], v1 offset:14336
v_add_u32_sdwa v80, s4, v120 dst_sel:DWORD dst_unused:UNUSED_PAD src0_sel:DWORD src1_sel:WORD_0
v_smfmac_f32_16x16x64_bf16 v[12:15], a[184:187], v[52:59], v158 abid:1
ds_read_b128 v[68:71], v0 offset:16384
v_add_u32_sdwa v81, s4, v120 dst_sel:DWORD dst_unused:UNUSED_PAD src0_sel:DWORD src1_sel:WORD_1
v_smfmac_f32_16x16x64_bf16 v[12:15], a[220:223], v[92:99], v162 abid:1
ds_read_u16 v90, v90
v_add_u32_sdwa v82, s4, v121 dst_sel:DWORD dst_unused:UNUSED_PAD src0_sel:DWORD src1_sel:WORD_0
v_smfmac_f32_16x16x64_bf16 v[32:35], a[168:171], v[44:51], v157
ds_read_b128 v[72:75], v1 offset:16384
v_add_u32_sdwa v83, s4, v121 dst_sel:DWORD dst_unused:UNUSED_PAD src0_sel:DWORD src1_sel:WORD_1
v_smfmac_f32_16x16x64_bf16 v[32:35], a[204:207], v[52:59], v161
ds_read_u16 v91, v91
v_add_u32 v0, s43, v0
v_smfmac_f32_16x16x64_bf16 v[32:35], a[240:243], v[92:99], v165
s_waitcnt lgkmcnt(7)
v_add_u32 v1, s43, v1
v_smfmac_f32_16x16x64_bf16 v[32:35], v[114:117], v[100:107], v183 abid:1
s_add_u32 m0, s44, 7680
v_smfmac_f32_16x16x64_bf16 v[28:31], v[114:117], v[100:107], v183
buffer_load_dwordx4 v3, s[16:19], s45 offen offset:512 nt lds
v_smfmac_f32_16x16x64_bf16 v[36:39], v[114:117], v[100:107], v184
ds_read_b128 v[114:117], v2 offset:320
v_smfmac_f32_16x16x64_bf16 v[36:39], a[172:175], v[44:51], v157 abid:1
s_add_u32 m0, s44, 11520
v_smfmac_f32_16x16x64_bf16 v[36:39], a[208:211], v[52:59], v161 abid:1
buffer_load_dwordx4 v3, s[16:19], s45 offen offset:768 nt lds
v_smfmac_f32_16x16x64_bf16 v[36:39], a[244:247], v[92:99], v165 abid:1
v_smfmac_f32_16x16x64_bf16 v[16:19], a[152:155], v[44:51], v155
s_add_u32 m0, s44, s8
v_smfmac_f32_16x16x64_bf16 v[16:19], a[188:191], v[52:59], v159
s_mov_b64 exec, s[10:11]
buffer_load_dwordx4 v3, s[16:19], s7 offen offset:896 nt lds
s_mov_b64 exec, -1
v_smfmac_f32_16x16x64_bf16 v[16:19], a[224:227], v[92:99], v163
s_add_u32 s45, s45, 4718592
s_add_u32 s7, s7, 4718592
s_add_u32 s44, s44, s5
v_smfmac_f32_16x16x64_bf16 v[20:23], a[156:159], v[44:51], v155 abid:1
s_cmp_ge_u32 s44, 147456
s_cselect_b32 s44, s9, s44
v_smfmac_f32_16x16x64_bf16 v[20:23], a[192:195], v[52:59], v159 abid:1
v_smfmac_f32_16x16x64_bf16 v[20:23], a[228:231], v[92:99], v163 abid:1
v_smfmac_f32_16x16x64_bf16 v[40:43], a[176:179], v[44:51], v176
s_bitcmp1_b32 s92, s41
v_smfmac_f32_16x16x64_bf16 v[40:43], a[212:215], v[52:59], v176 abid:1
s_cbranch_scc1 L_loopk_w
L_loopk_wb:
v_smfmac_f32_16x16x64_bf16 v[40:43], a[248:251], v[92:99], v177
s_waitcnt lgkmcnt(0)
v_smfmac_f32_16x16x64_bf16 v[40:43], v[114:117], v[84:91], v185
v_smfmac_f32_16x16x64_bf16 v[36:39], v[114:117], v[84:91], v184 abid:1
s_waitcnt vmcnt(20)
s_barrier
v_smfmac_f32_16x16x64_bf16 v[8:11], a[252:255], v[60:67], v166
s_mov_b32 s42, s4
ds_read_b128 v[44:47], v0 offset:0
v_smfmac_f32_16x16x64_bf16 v[8:11], v[218:221], v[68:75], v170
ds_read_b128 v[48:51], v1 offset:0
v_add_u32_sdwa v84, s42, v122 dst_sel:DWORD dst_unused:UNUSED_PAD src0_sel:DWORD src1_sel:WORD_0
v_smfmac_f32_16x16x64_bf16 v[12:15], v[186:189], v[60:67], v166 abid:1
ds_read_b128 v[52:55], v0 offset:2048
v_add_u32_sdwa v85, s42, v122 dst_sel:DWORD dst_unused:UNUSED_PAD src0_sel:DWORD src1_sel:WORD_1
v_smfmac_f32_16x16x64_bf16 v[12:15], v[222:225], v[68:75], v170 abid:1
ds_read_b128 v[56:59], v1 offset:2048
v_add_u32_sdwa v86, s42, v123 dst_sel:DWORD dst_unused:UNUSED_PAD src0_sel:DWORD src1_sel:WORD_0
v_smfmac_f32_16x16x64_bf16 v[16:19], v[190:193], v[60:67], v167
ds_read_u16 v76, v76
v_cvt_pk_bf16_f32 v92, v8, v9
v_smfmac_f32_16x16x64_bf16 v[16:19], v[226:229], v[68:75], v171
ds_read_u16 v77, v77
v_cvt_pk_bf16_f32 v93, v10, v11
v_smfmac_f32_16x16x64_bf16 v[20:23], v[194:197], v[60:67], v167 abid:1
ds_read_b128 v[8:11], v2 offset:1024
v_cvt_pk_bf16_f32 v94, v12, v13
v_smfmac_f32_16x16x64_bf16 v[20:23], v[230:233], v[68:75], v171 abid:1
ds_read_u16 v78, v78
v_cvt_pk_bf16_f32 v95, v14, v15
v_smfmac_f32_16x16x64_bf16 v[24:27], v[198:201], v[60:67], v168
ds_read_b128 v[12:15], v2 offset:1088
v_cvt_pk_bf16_f32 v96, v16, v17
v_smfmac_f32_16x16x64_bf16 v[24:27], v[234:237], v[68:75], v172
ds_read_u16 v79, v79
v_cvt_pk_bf16_f32 v97, v18, v19
v_smfmac_f32_16x16x64_bf16 v[28:31], v[202:205], v[60:67], v168 abid:1
ds_read_b128 v[16:19], v2 offset:1152
v_cvt_pk_bf16_f32 v98, v20, v21
v_smfmac_f32_16x16x64_bf16 v[28:31], v[238:241], v[68:75], v172 abid:1
ds_read_u16 v80, v80
v_cvt_pk_bf16_f32 v99, v22, v23
v_smfmac_f32_16x16x64_bf16 v[32:35], v[206:209], v[60:67], v169
ds_read_b128 v[20:23], v2 offset:1216
v_cvt_pk_bf16_f32 v100, v24, v25
v_smfmac_f32_16x16x64_bf16 v[32:35], v[242:245], v[68:75], v173
ds_read_u16 v81, v81
v_cvt_pk_bf16_f32 v101, v26, v27
v_smfmac_f32_16x16x64_bf16 v[36:39], v[210:213], v[60:67], v169 abid:1
ds_read_b128 v[24:27], v2 offset:1280
v_cvt_pk_bf16_f32 v102, v28, v29
v_smfmac_f32_16x16x64_bf16 v[36:39], v[246:249], v[68:75], v173 abid:1
ds_read_u16 v82, v82
v_cvt_pk_bf16_f32 v103, v30, v31
v_smfmac_f32_16x16x64_bf16 v[40:43], v[214:217], v[60:67], v177 abid:1
s_bitcmp1_b32 s85, s41
ds_read_b128 v[28:31], v2 offset:1344
v_cvt_pk_bf16_f32 v104, v32, v33
v_smfmac_f32_16x16x64_bf16 v[40:43], v[250:253], v[68:75], v178
s_waitcnt lgkmcnt(10)
v_cvt_pk_bf16_f32 v105, v34, v35
s_cbranch_scc1 L_loopk
.p2align 3
L_loopnk:
v_smfmac_f32_16x16x64_bf16 v[8:11], a[0:3], v[44:51], v138
ds_read_b128 v[32:35], v2 offset:1408
v_cvt_pk_bf16_f32 v106, v36, v37
v_smfmac_f32_16x16x64_bf16 v[8:11], a[36:39], v[52:59], v142
s_waitcnt lgkmcnt(9)
ds_read_b128 v[60:63], v0 offset:4096
v_cvt_pk_bf16_f32 v107, v38, v39
v_smfmac_f32_16x16x64_bf16 v[12:15], a[4:7], v[44:51], v138 abid:1
ds_read_b128 v[36:39], v2 offset:1472
v_cvt_pk_bf16_f32 v112, v40, v41
v_smfmac_f32_16x16x64_bf16 v[12:15], a[40:43], v[52:59], v142 abid:1
s_waitcnt lgkmcnt(9)
ds_read_u16 v84, v84
v_cvt_pk_bf16_f32 v113, v42, v43
v_smfmac_f32_16x16x64_bf16 v[16:19], a[8:11], v[44:51], v139
s_cmp_eq_u32 s4, 129024
ds_read_b128 v[40:43], v2 offset:1536
v_cndmask_b32_dpp v108, v96, v92, vcc quad_perm:[1,0,3,2] row_mask:0xf bank_mask:0xf
v_smfmac_f32_16x16x64_bf16 v[16:19], a[44:47], v[52:59], v143
s_waitcnt lgkmcnt(9)
ds_read_b128 v[64:67], v1 offset:4096
v_cndmask_b32_dpp v109, v97, v93, vcc quad_perm:[1,0,3,2] row_mask:0xf bank_mask:0xf
v_smfmac_f32_16x16x64_bf16 v[20:23], a[12:15], v[44:51], v139 abid:1
s_cselect_b32 s43, -129024, s5
ds_read_b128 v[68:71], v0 offset:6144
v_cndmask_b32_dpp v110, v98, v94, vcc quad_perm:[1,0,3,2] row_mask:0xf bank_mask:0xf
v_smfmac_f32_16x16x64_bf16 v[20:23], a[48:51], v[52:59], v143 abid:1
s_waitcnt lgkmcnt(9)
ds_read_b128 v[72:75], v1 offset:6144
v_cndmask_b32_dpp v111, v99, v95, vcc quad_perm:[1,0,3,2] row_mask:0xf bank_mask:0xf
v_smfmac_f32_16x16x64_bf16 v[24:27], a[16:19], v[44:51], v140
s_add_u32 s4, s4, s43
ds_read_u16 v83, v83
v_add_u32_sdwa v87, s42, v123 dst_sel:DWORD dst_unused:UNUSED_PAD src0_sel:DWORD src1_sel:WORD_1
v_smfmac_f32_16x16x64_bf16 v[24:27], a[52:55], v[52:59], v144
buffer_store_dwordx4 v[108:111], v4, s[20:23], s46 offen offset:0
s_mov_b64 vcc, s[82:83]
s_waitcnt lgkmcnt(9)
ds_read_b128 v[114:117], v2 offset:64
v_cndmask_b32_dpp v96, v92, v96, vcc quad_perm:[1,0,3,2] row_mask:0xf bank_mask:0xf
v_cndmask_b32_dpp v97, v93, v97, vcc quad_perm:[1,0,3,2] row_mask:0xf bank_mask:0xf
v_smfmac_f32_16x16x64_bf16 v[28:31], a[20:23], v[44:51], v140 abid:1
s_add_u32 s41, s41, 1
ds_read_u16 v85, v85
v_cndmask_b32_dpp v98, v94, v98, vcc quad_perm:[1,0,3,2] row_mask:0xf bank_mask:0xf
v_smfmac_f32_16x16x64_bf16 v[28:31], a[56:59], v[52:59], v144 abid:1
s_waitcnt lgkmcnt(10)
ds_read_u16 v86, v86
v_cndmask_b32_dpp v99, v95, v99, vcc quad_perm:[1,0,3,2] row_mask:0xf bank_mask:0xf
v_smfmac_f32_16x16x64_bf16 v[32:35], a[24:27], v[44:51], v141
ds_read_u16 v87, v87
v_add_u32_sdwa v88, s42, v124 dst_sel:DWORD dst_unused:UNUSED_PAD src0_sel:DWORD src1_sel:WORD_0
v_smfmac_f32_16x16x64_bf16 v[32:35], a[60:63], v[52:59], v145
s_waitcnt lgkmcnt(10)
ds_read_u16 v88, v88
v_add_u32_sdwa v89, s42, v124 dst_sel:DWORD dst_unused:UNUSED_PAD src0_sel:DWORD src1_sel:WORD_1
v_smfmac_f32_16x16x64_bf16 v[36:39], a[28:31], v[44:51], v141 abid:1
ds_read_u16 v89, v89
v_add_u32_sdwa v90, s42, v125 dst_sel:DWORD dst_unused:UNUSED_PAD src0_sel:DWORD src1_sel:WORD_0
v_smfmac_f32_16x16x64_bf16 v[36:39], a[64:67], v[52:59], v145 abid:1
s_waitcnt lgkmcnt(10)
ds_read_u16 v90, v90
v_add_u32_sdwa v91, s42, v125 dst_sel:DWORD dst_unused:UNUSED_PAD src0_sel:DWORD src1_sel:WORD_1
v_smfmac_f32_16x16x64_bf16 v[40:43], a[32:35], v[44:51], v174
buffer_store_dwordx4 v[96:99], v4, s[20:23], s46 offen offset:1152
s_mov_b64 vcc, s[80:81]
ds_read_u16 v91, v91
v_cndmask_b32_dpp v92, v104, v100, vcc quad_perm:[1,0,3,2] row_mask:0xf bank_mask:0xf
v_cndmask_b32_dpp v93, v105, v101, vcc quad_perm:[1,0,3,2] row_mask:0xf bank_mask:0xf
v_smfmac_f32_16x16x64_bf16 v[40:43], a[68:71], v[52:59], v174 abid:1
s_waitcnt lgkmcnt(11)
ds_bpermute_b32 v112, v6, v112
v_cndmask_b32_dpp v94, v106, v102, vcc quad_perm:[1,0,3,2] row_mask:0xf bank_mask:0xf
v_smfmac_f32_16x16x64_bf16 v[8:11], a[72:75], v[60:67], v146
s_waitcnt lgkmcnt(10)
ds_bpermute_b32 v113, v6, v113
v_cndmask_b32_dpp v95, v107, v103, vcc quad_perm:[1,0,3,2] row_mask:0xf bank_mask:0xf
v_smfmac_f32_16x16x64_bf16 v[8:11], a[108:111], v[68:75], v150
s_waitcnt lgkmcnt(9)
ds_read_b128 v[44:47], v0 offset:8192
v_smfmac_f32_16x16x64_bf16 v[8:11], v[114:117], v[76:83], v179
ds_read_b128 v[48:51], v1 offset:8192
v_smfmac_f32_16x16x64_bf16 v[12:15], v[114:117], v[76:83], v179 abid:1
ds_read_b128 v[114:117], v2 offset:128
v_add_u32_sdwa v76, s42, v126 dst_sel:DWORD dst_unused:UNUSED_PAD src0_sel:DWORD src1_sel:WORD_0
v_smfmac_f32_16x16x64_bf16 v[12:15], a[76:79], v[60:67], v146 abid:1
ds_read_u16 v76, v76
v_add_u32_sdwa v77, s42, v126 dst_sel:DWORD dst_unused:UNUSED_PAD src0_sel:DWORD src1_sel:WORD_1
v_smfmac_f32_16x16x64_bf16 v[12:15], a[112:115], v[68:75], v150 abid:1
buffer_store_dwordx4 v[92:95], v4, s[20:23], s46 offen offset:128
s_mov_b64 vcc, s[82:83]
ds_read_u16 v77, v77
v_cndmask_b32_dpp v104, v100, v104, vcc quad_perm:[1,0,3,2] row_mask:0xf bank_mask:0xf
v_cndmask_b32_dpp v105, v101, v105, vcc quad_perm:[1,0,3,2] row_mask:0xf bank_mask:0xf
v_smfmac_f32_16x16x64_bf16 v[24:27], a[88:91], v[60:67], v148
ds_read_b128 v[52:55], v0 offset:10240
v_add_u32_sdwa v78, s42, v127 dst_sel:DWORD dst_unused:UNUSED_PAD src0_sel:DWORD src1_sel:WORD_0
v_smfmac_f32_16x16x64_bf16 v[24:27], a[124:127], v[68:75], v152
ds_read_u16 v78, v78
v_cndmask_b32_dpp v106, v102, v106, vcc quad_perm:[1,0,3,2] row_mask:0xf bank_mask:0xf
v_smfmac_f32_16x16x64_bf16 v[28:31], a[92:95], v[60:67], v148 abid:1
ds_read_b128 v[56:59], v1 offset:10240
v_cndmask_b32_dpp v107, v103, v107, vcc quad_perm:[1,0,3,2] row_mask:0xf bank_mask:0xf
v_smfmac_f32_16x16x64_bf16 v[28:31], a[128:131], v[68:75], v152 abid:1
ds_read_b128 v[92:95], v0 offset:12288
v_add_u32_sdwa v79, s42, v127 dst_sel:DWORD dst_unused:UNUSED_PAD src0_sel:DWORD src1_sel:WORD_1
v_smfmac_f32_16x16x64_bf16 v[32:35], a[96:99], v[60:67], v149
ds_read_u16 v79, v79
v_add_u32_sdwa v80, s42, v128 dst_sel:DWORD dst_unused:UNUSED_PAD src0_sel:DWORD src1_sel:WORD_0
v_smfmac_f32_16x16x64_bf16 v[32:35], a[132:135], v[68:75], v153
ds_read_u16 v80, v80
v_add_u32_sdwa v81, s42, v128 dst_sel:DWORD dst_unused:UNUSED_PAD src0_sel:DWORD src1_sel:WORD_1
v_smfmac_f32_16x16x64_bf16 v[16:19], a[80:83], v[60:67], v147
buffer_store_dwordx4 v[104:107], v4, s[20:23], s46 offen offset:1280
s_mov_b64 vcc, s[80:81]
ds_read_u16 v81, v81
v_add_u32_sdwa v82, s42, v129 dst_sel:DWORD dst_unused:UNUSED_PAD src0_sel:DWORD src1_sel:WORD_0
v_add_u32_sdwa v83, s42, v129 dst_sel:DWORD dst_unused:UNUSED_PAD src0_sel:DWORD src1_sel:WORD_1
v_smfmac_f32_16x16x64_bf16 v[16:19], a[116:119], v[68:75], v151
s_waitcnt lgkmcnt(9)
ds_read_b128 v[96:99], v1 offset:12288
v_add_u32_sdwa v100, s42, v130 dst_sel:DWORD dst_unused:UNUSED_PAD src0_sel:DWORD src1_sel:WORD_0
v_smfmac_f32_16x16x64_bf16 v[16:19], v[114:117], v[84:91], v180 abid:1
ds_read_u16 v82, v82
v_add_u32_sdwa v101, s42, v130 dst_sel:DWORD dst_unused:UNUSED_PAD src0_sel:DWORD src1_sel:WORD_1
v_smfmac_f32_16x16x64_bf16 v[12:15], v[114:117], v[84:91], v180
ds_read_u16 v100, v100
v_add_u32_sdwa v102, s42, v131 dst_sel:DWORD dst_unused:UNUSED_PAD src0_sel:DWORD src1_sel:WORD_0
v_smfmac_f32_16x16x64_bf16 v[20:23], v[114:117], v[84:91], v181
ds_read_u16 v83, v83
v_add_u32_sdwa v103, s42, v131 dst_sel:DWORD dst_unused:UNUSED_PAD src0_sel:DWORD src1_sel:WORD_1
v_smfmac_f32_16x16x64_bf16 v[20:23], a[84:87], v[60:67], v147 abid:1
ds_read_b128 v[114:117], v2 offset:192
v_add_u32_sdwa v104, s42, v132 dst_sel:DWORD dst_unused:UNUSED_PAD src0_sel:DWORD src1_sel:WORD_0
v_smfmac_f32_16x16x64_bf16 v[20:23], a[120:123], v[68:75], v151 abid:1
ds_read_u16 v101, v101
v_add_u32_sdwa v105, s42, v132 dst_sel:DWORD dst_unused:UNUSED_PAD src0_sel:DWORD src1_sel:WORD_1
v_smfmac_f32_16x16x64_bf16 v[36:39], a[100:103], v[60:67], v149 abid:1
buffer_store_dwordx2 v[112:113], v5, s[20:23], s46 offen
ds_read_u16 v102, v102
v_add_u32_sdwa v106, s42, v133 dst_sel:DWORD dst_unused:UNUSED_PAD src0_sel:DWORD src1_sel:WORD_0
v_smfmac_f32_16x16x64_bf16 v[36:39], a[136:139], v[68:75], v153 abid:1
s_mov_b32 s22, 75497472
ds_read_u16 v103, v103
v_add_u32_sdwa v107, s42, v133 dst_sel:DWORD dst_unused:UNUSED_PAD src0_sel:DWORD src1_sel:WORD_1
v_smfmac_f32_16x16x64_bf16 v[40:43], a[104:107], v[60:67], v175
s_add_u32 s46, s46, s6
ds_read_u16 v104, v104
v_add_u32_sdwa v84, s42, v134 dst_sel:DWORD dst_unused:UNUSED_PAD src0_sel:DWORD src1_sel:WORD_0
v_smfmac_f32_16x16x64_bf16 v[40:43], a[140:143], v[68:75], v175 abid:1
s_mov_b32 s6, s14
ds_read_u16 v105, v105
v_add_u32_sdwa v85, s42, v134 dst_sel:DWORD dst_unused:UNUSED_PAD src0_sel:DWORD src1_sel:WORD_1
v_smfmac_f32_16x16x64_bf16 v[8:11], a[144:147], v[44:51], v154
s_waitcnt lgkmcnt(14)
ds_read_u16 v106, v106
v_add_u32_sdwa v86, s42, v135 dst_sel:DWORD dst_unused:UNUSED_PAD src0_sel:DWORD src1_sel:WORD_0
v_smfmac_f32_16x16x64_bf16 v[8:11], a[180:183], v[52:59], v158
s_waitcnt lgkmcnt(10)
ds_read_u16 v107, v107
v_add_u32_sdwa v87, s42, v135 dst_sel:DWORD dst_unused:UNUSED_PAD src0_sel:DWORD src1_sel:WORD_1
v_smfmac_f32_16x16x64_bf16 v[8:11], a[216:219], v[92:99], v162
s_mov_b32 s14, 4718592
ds_read_u16 v84, v84
v_add_u32_sdwa v88, s42, v136 dst_sel:DWORD dst_unused:UNUSED_PAD src0_sel:DWORD src1_sel:WORD_0
v_smfmac_f32_16x16x64_bf16 v[24:27], a[160:163], v[44:51], v156
v_add_u32_sdwa v89, s42, v136 dst_sel:DWORD dst_unused:UNUSED_PAD src0_sel:DWORD src1_sel:WORD_1
v_smfmac_f32_16x16x64_bf16 v[24:27], a[196:199], v[52:59], v160
ds_read_u16 v85, v85
v_add_u32_sdwa v90, s42, v137 dst_sel:DWORD dst_unused:UNUSED_PAD src0_sel:DWORD src1_sel:WORD_0
v_smfmac_f32_16x16x64_bf16 v[24:27], a[232:235], v[92:99], v164
s_waitcnt lgkmcnt(9)
ds_read_u16 v86, v86
v_add_u32_sdwa v91, s42, v137 dst_sel:DWORD dst_unused:UNUSED_PAD src0_sel:DWORD src1_sel:WORD_1
v_smfmac_f32_16x16x64_bf16 v[24:27], v[114:117], v[76:83], v182
ds_read_u16 v87, v87
v_smfmac_f32_16x16x64_bf16 v[20:23], v[114:117], v[76:83], v181 abid:1
ds_read_u16 v88, v88
v_smfmac_f32_16x16x64_bf16 v[28:31], v[114:117], v[76:83], v182 abid:1
ds_read_b128 v[114:117], v2 offset:256
v_add_u32_sdwa v76, s4, v118 dst_sel:DWORD dst_unused:UNUSED_PAD src0_sel:DWORD src1_sel:WORD_0
v_smfmac_f32_16x16x64_bf16 v[28:31], a[164:167], v[44:51], v156 abid:1
ds_read_b128 v[60:63], v0 offset:14336
v_add_u32_sdwa v77, s4, v118 dst_sel:DWORD dst_unused:UNUSED_PAD src0_sel:DWORD src1_sel:WORD_1
v_smfmac_f32_16x16x64_bf16 v[28:31], a[200:203], v[52:59], v160 abid:1
ds_read_u16 v89, v89
v_add_u32_sdwa v78, s4, v119 dst_sel:DWORD dst_unused:UNUSED_PAD src0_sel:DWORD src1_sel:WORD_0
v_smfmac_f32_16x16x64_bf16 v[28:31], a[236:239], v[92:99], v164 abid:1
v_add_u32_sdwa v79, s4, v119 dst_sel:DWORD dst_unused:UNUSED_PAD src0_sel:DWORD src1_sel:WORD_1
v_smfmac_f32_16x16x64_bf16 v[12:15], a[148:151], v[44:51], v154 abid:1
ds_read_b128 v[64:67], v1 offset:14336
v_add_u32_sdwa v80, s4, v120 dst_sel:DWORD dst_unused:UNUSED_PAD src0_sel:DWORD src1_sel:WORD_0
v_smfmac_f32_16x16x64_bf16 v[12:15], a[184:187], v[52:59], v158 abid:1
ds_read_b128 v[68:71], v0 offset:16384
v_add_u32_sdwa v81, s4, v120 dst_sel:DWORD dst_unused:UNUSED_PAD src0_sel:DWORD src1_sel:WORD_1
v_smfmac_f32_16x16x64_bf16 v[12:15], a[220:223], v[92:99], v162 abid:1
ds_read_u16 v90, v90
v_add_u32_sdwa v82, s4, v121 dst_sel:DWORD dst_unused:UNUSED_PAD src0_sel:DWORD src1_sel:WORD_0
v_smfmac_f32_16x16x64_bf16 v[32:35], a[168:171], v[44:51], v157
ds_read_b128 v[72:75], v1 offset:16384
v_add_u32_sdwa v83, s4, v121 dst_sel:DWORD dst_unused:UNUSED_PAD src0_sel:DWORD src1_sel:WORD_1
v_smfmac_f32_16x16x64_bf16 v[32:35], a[204:207], v[52:59], v161
ds_read_u16 v91, v91
v_add_u32 v0, s43, v0
v_smfmac_f32_16x16x64_bf16 v[32:35], a[240:243], v[92:99], v165
s_waitcnt lgkmcnt(7)
v_add_u32 v1, s43, v1
v_smfmac_f32_16x16x64_bf16 v[32:35], v[114:117], v[100:107], v183 abid:1
v_smfmac_f32_16x16x64_bf16 v[28:31], v[114:117], v[100:107], v183
v_smfmac_f32_16x16x64_bf16 v[36:39], v[114:117], v[100:107], v184
ds_read_b128 v[114:117], v2 offset:320
v_smfmac_f32_16x16x64_bf16 v[36:39], a[172:175], v[44:51], v157 abid:1
v_smfmac_f32_16x16x64_bf16 v[36:39], a[208:211], v[52:59], v161 abid:1
v_smfmac_f32_16x16x64_bf16 v[36:39], a[244:247], v[92:99], v165 abid:1
v_smfmac_f32_16x16x64_bf16 v[16:19], a[152:155], v[44:51], v155
v_smfmac_f32_16x16x64_bf16 v[16:19], a[188:191], v[52:59], v159
v_smfmac_f32_16x16x64_bf16 v[16:19], a[224:227], v[92:99], v163
v_smfmac_f32_16x16x64_bf16 v[20:23], a[156:159], v[44:51], v155 abid:1
v_smfmac_f32_16x16x64_bf16 v[20:23], a[192:195], v[52:59], v159 abid:1
v_smfmac_f32_16x16x64_bf16 v[20:23], a[228:231], v[92:99], v163 abid:1
v_smfmac_f32_16x16x64_bf16 v[40:43], a[176:179], v[44:51], v176
s_bitcmp1_b32 s92, s41
v_smfmac_f32_16x16x64_bf16 v[40:43], a[212:215], v[52:59], v176 abid:1
s_cbranch_scc1 L_loopnk_w
L_loopnk_wb:
v_smfmac_f32_16x16x64_bf16 v[40:43], a[248:251], v[92:99], v177
s_waitcnt lgkmcnt(0)
v_smfmac_f32_16x16x64_bf16 v[40:43], v[114:117], v[84:91], v185
v_smfmac_f32_16x16x64_bf16 v[36:39], v[114:117], v[84:91], v184 abid:1
s_waitcnt vmcnt(20)
s_barrier
v_smfmac_f32_16x16x64_bf16 v[8:11], a[252:255], v[60:67], v166
s_mov_b32 s42, s4
ds_read_b128 v[44:47], v0 offset:0
v_smfmac_f32_16x16x64_bf16 v[8:11], v[218:221], v[68:75], v170
ds_read_b128 v[48:51], v1 offset:0
v_add_u32_sdwa v84, s42, v122 dst_sel:DWORD dst_unused:UNUSED_PAD src0_sel:DWORD src1_sel:WORD_0
v_smfmac_f32_16x16x64_bf16 v[12:15], v[186:189], v[60:67], v166 abid:1
ds_read_b128 v[52:55], v0 offset:2048
v_add_u32_sdwa v85, s42, v122 dst_sel:DWORD dst_unused:UNUSED_PAD src0_sel:DWORD src1_sel:WORD_1
v_smfmac_f32_16x16x64_bf16 v[12:15], v[222:225], v[68:75], v170 abid:1
ds_read_b128 v[56:59], v1 offset:2048
v_add_u32_sdwa v86, s42, v123 dst_sel:DWORD dst_unused:UNUSED_PAD src0_sel:DWORD src1_sel:WORD_0
v_smfmac_f32_16x16x64_bf16 v[16:19], v[190:193], v[60:67], v167
ds_read_u16 v76, v76
v_cvt_pk_bf16_f32 v92, v8, v9
v_smfmac_f32_16x16x64_bf16 v[16:19], v[226:229], v[68:75], v171
ds_read_u16 v77, v77
v_cvt_pk_bf16_f32 v93, v10, v11
v_smfmac_f32_16x16x64_bf16 v[20:23], v[194:197], v[60:67], v167 abid:1
ds_read_b128 v[8:11], v2 offset:1024
v_cvt_pk_bf16_f32 v94, v12, v13
v_smfmac_f32_16x16x64_bf16 v[20:23], v[230:233], v[68:75], v171 abid:1
ds_read_u16 v78, v78
v_cvt_pk_bf16_f32 v95, v14, v15
v_smfmac_f32_16x16x64_bf16 v[24:27], v[198:201], v[60:67], v168
ds_read_b128 v[12:15], v2 offset:1088
v_cvt_pk_bf16_f32 v96, v16, v17
v_smfmac_f32_16x16x64_bf16 v[24:27], v[234:237], v[68:75], v172
ds_read_u16 v79, v79
v_cvt_pk_bf16_f32 v97, v18, v19
v_smfmac_f32_16x16x64_bf16 v[28:31], v[202:205], v[60:67], v168 abid:1
ds_read_b128 v[16:19], v2 offset:1152
v_cvt_pk_bf16_f32 v98, v20, v21
v_smfmac_f32_16x16x64_bf16 v[28:31], v[238:241], v[68:75], v172 abid:1
ds_read_u16 v80, v80
v_cvt_pk_bf16_f32 v99, v22, v23
v_smfmac_f32_16x16x64_bf16 v[32:35], v[206:209], v[60:67], v169
ds_read_b128 v[20:23], v2 offset:1216
v_cvt_pk_bf16_f32 v100, v24, v25
v_smfmac_f32_16x16x64_bf16 v[32:35], v[242:245], v[68:75], v173
ds_read_u16 v81, v81
v_cvt_pk_bf16_f32 v101, v26, v27
v_smfmac_f32_16x16x64_bf16 v[36:39], v[210:213], v[60:67], v169 abid:1
ds_read_b128 v[24:27], v2 offset:1280
v_cvt_pk_bf16_f32 v102, v28, v29
v_smfmac_f32_16x16x64_bf16 v[36:39], v[246:249], v[68:75], v173 abid:1
ds_read_u16 v82, v82
v_cvt_pk_bf16_f32 v103, v30, v31
v_smfmac_f32_16x16x64_bf16 v[40:43], v[214:217], v[60:67], v177 abid:1
s_bitcmp1_b32 s12, s41
ds_read_b128 v[28:31], v2 offset:1344
v_cvt_pk_bf16_f32 v104, v32, v33
v_smfmac_f32_16x16x64_bf16 v[40:43], v[250:253], v[68:75], v178
s_waitcnt lgkmcnt(10)
v_cvt_pk_bf16_f32 v105, v34, v35
s_cbranch_scc1 L_loopnk
s_cmp_lt_u32 s41, s15
s_cbranch_scc1 L_loopk
s_nop 7
v_cvt_pk_bf16_f32 v106, v36, v37
v_cvt_pk_bf16_f32 v107, v38, v39
v_cvt_pk_bf16_f32 v112, v40, v41
v_cvt_pk_bf16_f32 v113, v42, v43
s_nop 1
v_cndmask_b32_dpp v108, v96, v92, vcc quad_perm:[1,0,3,2] row_mask:0xf bank_mask:0xf
s_nop 1
v_cndmask_b32_dpp v109, v97, v93, vcc quad_perm:[1,0,3,2] row_mask:0xf bank_mask:0xf
s_nop 1
v_cndmask_b32_dpp v110, v98, v94, vcc quad_perm:[1,0,3,2] row_mask:0xf bank_mask:0xf
s_nop 1
v_cndmask_b32_dpp v111, v99, v95, vcc quad_perm:[1,0,3,2] row_mask:0xf bank_mask:0xf
s_waitcnt lgkmcnt(0)
buffer_store_dwordx4 v[108:111], v4, s[20:23], s46 offen offset:0
s_nop 1
s_mov_b64 vcc, s[82:83]
s_nop 1
v_cndmask_b32_dpp v96, v92, v96, vcc quad_perm:[1,0,3,2] row_mask:0xf bank_mask:0xf
s_nop 1
v_cndmask_b32_dpp v97, v93, v97, vcc quad_perm:[1,0,3,2] row_mask:0xf bank_mask:0xf
s_nop 1
v_cndmask_b32_dpp v98, v94, v98, vcc quad_perm:[1,0,3,2] row_mask:0xf bank_mask:0xf
s_nop 1
v_cndmask_b32_dpp v99, v95, v99, vcc quad_perm:[1,0,3,2] row_mask:0xf bank_mask:0xf
s_waitcnt lgkmcnt(0)
buffer_store_dwordx4 v[96:99], v4, s[20:23], s46 offen offset:1152
s_nop 1
s_mov_b64 vcc, s[80:81]
s_nop 1
v_cndmask_b32_dpp v92, v104, v100, vcc quad_perm:[1,0,3,2] row_mask:0xf bank_mask:0xf
s_nop 1
v_cndmask_b32_dpp v93, v105, v101, vcc quad_perm:[1,0,3,2] row_mask:0xf bank_mask:0xf
s_nop 1
ds_bpermute_b32 v112, v6, v112
s_nop 1
v_cndmask_b32_dpp v94, v106, v102, vcc quad_perm:[1,0,3,2] row_mask:0xf bank_mask:0xf
s_nop 1
ds_bpermute_b32 v113, v6, v113
s_nop 1
v_cndmask_b32_dpp v95, v107, v103, vcc quad_perm:[1,0,3,2] row_mask:0xf bank_mask:0xf
s_waitcnt lgkmcnt(0)
buffer_store_dwordx4 v[92:95], v4, s[20:23], s46 offen offset:128
s_nop 1
s_mov_b64 vcc, s[82:83]
s_nop 1
v_cndmask_b32_dpp v104, v100, v104, vcc quad_perm:[1,0,3,2] row_mask:0xf bank_mask:0xf
s_nop 1
v_cndmask_b32_dpp v105, v101, v105, vcc quad_perm:[1,0,3,2] row_mask:0xf bank_mask:0xf
s_nop 1
v_cndmask_b32_dpp v106, v102, v106, vcc quad_perm:[1,0,3,2] row_mask:0xf bank_mask:0xf
s_nop 1
v_cndmask_b32_dpp v107, v103, v107, vcc quad_perm:[1,0,3,2] row_mask:0xf bank_mask:0xf
s_waitcnt lgkmcnt(0)
buffer_store_dwordx4 v[104:107], v4, s[20:23], s46 offen offset:1280
s_nop 1
s_mov_b64 vcc, s[80:81]
s_waitcnt lgkmcnt(0)
buffer_store_dwordx2 v[112:113], v5, s[20:23], s46 offen
s_nop 1
s_branch L_fin
L_loopk_w:
s_bitcmp1_b32 s87, s41
s_waitcnt vmcnt(10)
s_cbranch_scc0 L_loopk_wb
s_waitcnt vmcnt(0)
s_branch L_loopk_wb
L_loopnk_w:
s_bitcmp1_b32 s87, s41
s_waitcnt vmcnt(10)
s_cbranch_scc0 L_loopnk_wb
s_waitcnt vmcnt(0)
s_branch L_loopnk_wb
L_slow:
s_waitcnt vmcnt(0) lgkmcnt(0)
s_mov_b32 s87, 0
L_sm:
s_lshl_b32 s86, s2, 1
s_add_u32 s86, s86, s87
s_add_u32 s86, s86, 1
s_mul_i32 s86, s86, 393216
s_mov_b32 s84, 0
L_st:
s_and_b32 s48, s84, 3
s_lshr_b32 s49, s84, 2
s_sub_u32 s50, s84, 36
s_lshl_b32 s51, s40, 4
s_lshl_b32 s52, s50, 1
s_lshl_b32 s53, s48, 8
s_cmp_lt_u32 s84, 36
s_cselect_b32 s52, s49, s52
s_cselect_b32 s53, s53, 1024
s_cselect_b32 s54, 8, 73728
s_cselect_b32 s55, 32, 8
s_cselect_b32 s56, 16, 32
s_cselect_b32 s57, 128, 64
s_mul_i32 s52, s52, 73728
s_mul_i32 s58, s40, 18432
v_and_b32 v58, 1, v7
v_bfe_u32 v59, v7, 1, 1
v_bfe_u32 v60, v7, 2, 2
v_bfe_u32 v62, v7, 4, 1
v_lshrrev_b32 v63, 5, v7
v_lshl_add_u32 v50, v58, 2, s52
v_mad_u32_u24 v50, v59, s54, v50
v_mad_u32_u24 v50, v60, s55, v50
v_mad_u32_u24 v50, v62, s56, v50
v_mad_u32_u24 v50, v63, s57, v50
v_add_u32 v50, s53, v50
v_add_u32 v50, s58, v50
v_add_u32 v62, 4608, v50
v_add_u32 v63, 9216, v50
v_add_u32 v64, 13824, v50
buffer_load_dword v8, v50, s[28:31], 0 offen offset:0
buffer_load_dword v9, v50, s[28:31], 0 offen offset:1152
buffer_load_dword v10, v50, s[28:31], 0 offen offset:2304
buffer_load_dword v11, v50, s[28:31], 0 offen offset:3456
buffer_load_dword v12, v62, s[28:31], 0 offen offset:0
buffer_load_dword v13, v62, s[28:31], 0 offen offset:1152
buffer_load_dword v14, v62, s[28:31], 0 offen offset:2304
buffer_load_dword v15, v62, s[28:31], 0 offen offset:3456
buffer_load_dword v16, v63, s[28:31], 0 offen offset:0
buffer_load_dword v17, v63, s[28:31], 0 offen offset:1152
buffer_load_dword v18, v63, s[28:31], 0 offen offset:2304
buffer_load_dword v19, v63, s[28:31], 0 offen offset:3456
buffer_load_dword v20, v64, s[28:31], 0 offen offset:0
buffer_load_dword v21, v64, s[28:31], 0 offen offset:1152
buffer_load_dword v22, v64, s[28:31], 0 offen offset:2304
buffer_load_dword v23, v64, s[28:31], 0 offen offset:3456
s_mul_i32 s52, s48, 9
s_add_u32 s52, s52, s49
s_mul_i32 s53, s52, 9
s_mul_i32 s54, s50, 18
s_add_u32 s54, s54, 8
s_lshl_b32 s55, s52, 2
s_add_u32 s55, s55, s40
s_lshl_b32 s56, s50, 2
s_add_u32 s56, s56, s40
s_cmp_eq_u32 s84, 40
s_cselect_b32 s57, 0x100000, 9
s_cmp_lt_u32 s84, 36
s_cselect_b32 s53, s53, s54
s_cselect_b32 s54, 2, 81
s_cselect_b32 s57, 1, s57
s_cselect_b32 s55, s55, s56
s_mov_b32 s56, 331776
s_cselect_b32 s56, s56, 368640
s_mov_b32 s58, 373760
s_cselect_b32 s58, s58, 382976
s_cselect_b32 s59, 16, 4
s_cselect_b32 s60, 4, 64
s_cselect_b32 s61, 12, 11
s_cselect_b32 s62, 1, 0x8001
v_lshrrev_b32 v61, 4, v7
v_lshlrev_b32 v62, 1, v58
v_lshl_add_u32 v60, v60, 2, v62
v_add_u32 v62, v60, v59
v_mul_u32_u24 v51, s54, v61
v_add_lshl_u32 v51, v51, s53, 6
v_add3_u32 v51, v51, v62, s51
v_lshl_add_u32 v51, v51, 4, s86
s_lshl_b32 s57, s57, 10
v_add_u32 v66, s57, v51
s_lshl_b32 s52, s55, 8
s_add_u32 s52, s52, s56
s_add_u32 s52, s52, s86
v_mul_u32_u24 v52, s59, v62
v_mad_u32_u24 v52, v61, s60, v52
v_add_u32 v52, s52, v52
v_mov_b32 v55, 0x05040100
v_mov_b32 v62, 0x03020706
v_cmp_eq_u32 vcc, 1, v59
v_mov_b32 v68, 0xf0a0500
v_mov_b32 v69, 0x8f8a8580
v_mov_b32 v70, 0x1f1a1510
v_mov_b32 v71, 0x9f9a9590
v_mov_b32 v72, 0x2f2a2520
v_mov_b32 v73, 0xafaaa5a0
v_mov_b32 v74, 0x3f3a3530
v_mov_b32 v75, 0xbfbab5b0
v_cndmask_b32 v55, v55, v62, vcc
s_mov_b32 s64, 0x5040500
s_mov_b32 s65, 0x5040501
s_mov_b32 s66, 0x5040502
s_mov_b32 s67, 0x5040503
s_mov_b32 s68, 0x7060700
s_mov_b32 s69, 0x7060701
s_mov_b32 s70, 0x7060702
s_mov_b32 s71, 0x7060703
s_mov_b32 s72, 0x05060102
s_cmp_lg_u32 s87, 0
s_waitcnt vmcnt(12)
v_perm_b32 v24, v8, v68, s64
v_perm_b32 v25, v9, v68, s65
v_perm_b32 v26, v10, v68, s66
v_perm_b32 v27, v11, v68, s67
v_max3_f32 v28, |v24|, |v25|, |v26|
v_med3_f32 v29, |v24|, |v25|, |v26|
v_min3_f32 v30, |v24|, |v25|, |v26|
v_med3_f32 v32, v28, v29, |v27|
v_med3_f32 v33, v29, v30, |v27|
v_max_f32 v31, v28, |v27|
v_cmp_eq_u32_sdwa vcc, v33, v32 src0_sel:WORD_1 src1_sel:WORD_1
s_cbranch_scc0 L_rb0g
v_min_f32 v30, v30, |v27|
v_cndmask_b32 v31, 0, v33, vcc
v_cmp_eq_u32_sdwa vcc, v30, v32 src0_sel:WORD_1 src1_sel:WORD_1
s_nop 1
v_cndmask_b32 v32, 0, v30, vcc
L_rb0g:
v_perm_b32 v36, v31, v32, s72
v_bfi_b32 v44, 3, v32, v31
v_perm_b32 v24, v8, v69, s68
v_perm_b32 v25, v9, v69, s69
v_perm_b32 v26, v10, v69, s70
v_perm_b32 v27, v11, v69, s71
v_max3_f32 v28, |v24|, |v25|, |v26|
v_med3_f32 v29, |v24|, |v25|, |v26|
v_min3_f32 v30, |v24|, |v25|, |v26|
v_med3_f32 v32, v28, v29, |v27|
v_med3_f32 v33, v29, v30, |v27|
v_max_f32 v31, v28, |v27|
v_cmp_eq_u32_sdwa vcc, v33, v32 src0_sel:WORD_1 src1_sel:WORD_1
s_cbranch_scc0 L_rb1g
v_min_f32 v30, v30, |v27|
v_cndmask_b32 v31, 0, v33, vcc
v_cmp_eq_u32_sdwa vcc, v30, v32 src0_sel:WORD_1 src1_sel:WORD_1
s_nop 1
v_cndmask_b32 v32, 0, v30, vcc
L_rb1g:
v_perm_b32 v40, v31, v32, s72
v_bfi_b32 v46, 3, v32, v31
s_waitcnt vmcnt(8)
v_perm_b32 v24, v12, v70, s64
v_perm_b32 v25, v13, v70, s65
v_perm_b32 v26, v14, v70, s66
v_perm_b32 v27, v15, v70, s67
v_max3_f32 v28, |v24|, |v25|, |v26|
v_med3_f32 v29, |v24|, |v25|, |v26|
v_min3_f32 v30, |v24|, |v25|, |v26|
v_med3_f32 v32, v28, v29, |v27|
v_med3_f32 v33, v29, v30, |v27|
v_max_f32 v31, v28, |v27|
v_cmp_eq_u32_sdwa vcc, v33, v32 src0_sel:WORD_1 src1_sel:WORD_1
s_cbranch_scc0 L_rb2g
v_min_f32 v30, v30, |v27|
v_cndmask_b32 v31, 0, v33, vcc
v_cmp_eq_u32_sdwa vcc, v30, v32 src0_sel:WORD_1 src1_sel:WORD_1
s_nop 1
v_cndmask_b32 v32, 0, v30, vcc
L_rb2g:
v_perm_b32 v37, v31, v32, s72
v_bfi_b32 v31, 3, v32, v31
v_lshlrev_b32 v31, 4, v31
v_bfi_b32 v44, 15, v44, v31
v_perm_b32 v24, v12, v71, s68
v_perm_b32 v25, v13, v71, s69
v_perm_b32 v26, v14, v71, s70
v_perm_b32 v27, v15, v71, s71
v_max3_f32 v28, |v24|, |v25|, |v26|
v_med3_f32 v29, |v24|, |v25|, |v26|
v_min3_f32 v30, |v24|, |v25|, |v26|
v_med3_f32 v32, v28, v29, |v27|
v_med3_f32 v33, v29, v30, |v27|
v_max_f32 v31, v28, |v27|
v_cmp_eq_u32_sdwa vcc, v33, v32 src0_sel:WORD_1 src1_sel:WORD_1
s_cbranch_scc0 L_rb3g
v_min_f32 v30, v30, |v27|
v_cndmask_b32 v31, 0, v33, vcc
v_cmp_eq_u32_sdwa vcc, v30, v32 src0_sel:WORD_1 src1_sel:WORD_1
s_nop 1
v_cndmask_b32 v32, 0, v30, vcc
L_rb3g:
v_perm_b32 v41, v31, v32, s72
v_bfi_b32 v31, 3, v32, v31
v_lshlrev_b32 v31, 4, v31
v_bfi_b32 v46, 15, v46, v31
s_waitcnt vmcnt(4)
v_perm_b32 v24, v16, v72, s64
v_perm_b32 v25, v17, v72, s65
v_perm_b32 v26, v18, v72, s66
v_perm_b32 v27, v19, v72, s67
v_max3_f32 v28, |v24|, |v25|, |v26|
v_med3_f32 v29, |v24|, |v25|, |v26|
v_min3_f32 v30, |v24|, |v25|, |v26|
v_med3_f32 v32, v28, v29, |v27|
v_med3_f32 v33, v29, v30, |v27|
v_max_f32 v31, v28, |v27|
v_cmp_eq_u32_sdwa vcc, v33, v32 src0_sel:WORD_1 src1_sel:WORD_1
s_cbranch_scc0 L_rb4g
v_min_f32 v30, v30, |v27|
v_cndmask_b32 v31, 0, v33, vcc
v_cmp_eq_u32_sdwa vcc, v30, v32 src0_sel:WORD_1 src1_sel:WORD_1
s_nop 1
v_cndmask_b32 v32, 0, v30, vcc
L_rb4g:
v_perm_b32 v38, v31, v32, s72
v_bfi_b32 v45, 3, v32, v31
v_perm_b32 v24, v16, v73, s68
v_perm_b32 v25, v17, v73, s69
v_perm_b32 v26, v18, v73, s70
v_perm_b32 v27, v19, v73, s71
v_max3_f32 v28, |v24|, |v25|, |v26|
v_med3_f32 v29, |v24|, |v25|, |v26|
v_min3_f32 v30, |v24|, |v25|, |v26|
v_med3_f32 v32, v28, v29, |v27|
v_med3_f32 v33, v29, v30, |v27|
v_max_f32 v31, v28, |v27|
v_cmp_eq_u32_sdwa vcc, v33, v32 src0_sel:WORD_1 src1_sel:WORD_1
s_cbranch_scc0 L_rb5g
v_min_f32 v30, v30, |v27|
v_cndmask_b32 v31, 0, v33, vcc
v_cmp_eq_u32_sdwa vcc, v30, v32 src0_sel:WORD_1 src1_sel:WORD_1
s_nop 1
v_cndmask_b32 v32, 0, v30, vcc
L_rb5g:
v_perm_b32 v42, v31, v32, s72
v_bfi_b32 v47, 3, v32, v31
s_waitcnt vmcnt(0)
v_perm_b32 v24, v20, v74, s64
v_perm_b32 v25, v21, v74, s65
v_perm_b32 v26, v22, v74, s66
v_perm_b32 v27, v23, v74, s67
v_max3_f32 v28, |v24|, |v25|, |v26|
v_med3_f32 v29, |v24|, |v25|, |v26|
v_min3_f32 v30, |v24|, |v25|, |v26|
v_med3_f32 v32, v28, v29, |v27|
v_med3_f32 v33, v29, v30, |v27|
v_max_f32 v31, v28, |v27|
v_cmp_eq_u32_sdwa vcc, v33, v32 src0_sel:WORD_1 src1_sel:WORD_1
s_cbranch_scc0 L_rb6g
v_min_f32 v30, v30, |v27|
v_cndmask_b32 v31, 0, v33, vcc
v_cmp_eq_u32_sdwa vcc, v30, v32 src0_sel:WORD_1 src1_sel:WORD_1
s_nop 1
v_cndmask_b32 v32, 0, v30, vcc
L_rb6g:
v_perm_b32 v39, v31, v32, s72
v_bfi_b32 v31, 3, v32, v31
v_lshlrev_b32 v31, 4, v31
v_bfi_b32 v45, 15, v45, v31
v_perm_b32 v24, v20, v75, s68
v_perm_b32 v25, v21, v75, s69
v_perm_b32 v26, v22, v75, s70
v_perm_b32 v27, v23, v75, s71
v_max3_f32 v28, |v24|, |v25|, |v26|
v_med3_f32 v29, |v24|, |v25|, |v26|
v_min3_f32 v30, |v24|, |v25|, |v26|
v_med3_f32 v32, v28, v29, |v27|
v_med3_f32 v33, v29, v30, |v27|
v_max_f32 v31, v28, |v27|
v_cmp_eq_u32_sdwa vcc, v33, v32 src0_sel:WORD_1 src1_sel:WORD_1
s_cbranch_scc0 L_rb7g
v_min_f32 v30, v30, |v27|
v_cndmask_b32 v31, 0, v33, vcc
v_cmp_eq_u32_sdwa vcc, v30, v32 src0_sel:WORD_1 src1_sel:WORD_1
s_nop 1
v_cndmask_b32 v32, 0, v30, vcc
L_rb7g:
v_perm_b32 v43, v31, v32, s72
v_bfi_b32 v31, 3, v32, v31
v_lshlrev_b32 v31, 4, v31
v_bfi_b32 v47, 15, v47, v31
s_mov_b32 vcc_lo, 0x33333333
s_mov_b32 vcc_hi, 0x33333333
v_cndmask_b32_dpp v24, v40, v36, vcc quad_perm:[2,3,0,1] row_mask:0xf bank_mask:0xf
v_cndmask_b32_dpp v25, v41, v37, vcc quad_perm:[2,3,0,1] row_mask:0xf bank_mask:0xf
v_cndmask_b32_dpp v26, v42, v38, vcc quad_perm:[2,3,0,1] row_mask:0xf bank_mask:0xf
v_cndmask_b32_dpp v27, v43, v39, vcc quad_perm:[2,3,0,1] row_mask:0xf bank_mask:0xf
s_not_b64 vcc, vcc
buffer_store_dwordx4 v[24:27], v51, s[24:27], 0 offen sc1
v_cndmask_b32_dpp v40, v36, v40, vcc quad_perm:[2,3,0,1] row_mask:0xf bank_mask:0xf
v_cndmask_b32_dpp v41, v37, v41, vcc quad_perm:[2,3,0,1] row_mask:0xf bank_mask:0xf
v_cndmask_b32_dpp v42, v38, v42, vcc quad_perm:[2,3,0,1] row_mask:0xf bank_mask:0xf
v_cndmask_b32_dpp v43, v39, v43, vcc quad_perm:[2,3,0,1] row_mask:0xf bank_mask:0xf
s_mov_b32 s52, 0x0c0c0400
s_mov_b32 s53, 0x04000c0c
buffer_store_dwordx4 v[40:43], v66, s[24:27], 0 offen sc1
v_perm_b32 v48, v45, v44, s52
v_perm_b32 v49, v47, v46, s53
v_or_b32 v48, v48, v49
s_nop 1
v_mov_b32_dpp v49, v48 quad_perm:[2,3,0,1] row_mask:0xf bank_mask:0xf
v_perm_b32 v48, v49, v48, v55
buffer_store_dword v48, v52, s[24:27], 0 offen sc1
s_waitcnt vmcnt(0)
s_add_u32 s84, s84, 1
s_cmp_lt_u32 s84, 41
s_cbranch_scc1 L_st
s_add_u32 s87, s87, 1
s_cmp_lt_u32 s87, 2
s_cbranch_scc1 L_sm
v_lshrrev_b32 v72, 3, v7
v_and_b32 v73, 7, v7
v_xor_b32 v73, v73, v72
v_mul_u32_u24 v72, 1152, v72
s_and_b32 s47, s40, 1
s_mul_i32 s47, s47, 9216
s_lshr_b32 s3, s40, 1
s_lshl_b32 s3, s3, 7
s_add_u32 s47, s47, s3
v_lshl_add_u32 v72, v73, 4, v72
v_add_u32 v3, s47, v72
s_lshl_b32 s44, s40, 10
s_mul_i32 s45, s2, 18432
s_mov_b32 s46, s45
s_lshr_b32 s47, s40, 1
s_lshl_b32 s3, s47, 11
s_sub_u32 s8, 15488, s3
s_lshl_b32 s3, s47, 7
s_add_u32 s7, s45, 128
s_sub_u32 s7, s7, s3
s_sub_u32 s10, s47, 1
s_sub_u32 s11, 0, s47
s_mov_b32 s9, s44
s_mov_b32 s13, 4718592
s_mov_b32 s15, 16
s_mov_b32 s14, s13
s_mov_b32 s22, 75497472
s_mov_b32 s18, 75497472
s_mov_b32 s41, 0
L_stile:
s_barrier
s_add_u32 m0, s44, 0
s_nop 0
buffer_load_dwordx4 v3, s[16:19], s45 offen offset:0 nt lds
s_add_u32 m0, s44, 3840
s_nop 0
buffer_load_dwordx4 v3, s[16:19], s45 offen offset:256 nt lds
s_add_u32 m0, s44, 7680
s_nop 0
buffer_load_dwordx4 v3, s[16:19], s45 offen offset:512 nt lds
s_add_u32 m0, s44, 11520
s_nop 0
buffer_load_dwordx4 v3, s[16:19], s45 offen offset:768 nt lds
s_add_u32 m0, s44, s8
s_mov_b64 exec, s[10:11]
buffer_load_dwordx4 v3, s[16:19], s7 offen offset:896 nt lds
s_mov_b64 exec, -1
ds_read_b128 v[8:11], v2 offset:1024
ds_read_b128 v[12:15], v2 offset:1088
ds_read_b128 v[16:19], v2 offset:1152
ds_read_b128 v[20:23], v2 offset:1216
ds_read_b128 v[24:27], v2 offset:1280
ds_read_b128 v[28:31], v2 offset:1344
ds_read_b128 v[32:35], v2 offset:1408
ds_read_b128 v[36:39], v2 offset:1472
ds_read_b128 v[40:43], v2 offset:1536
s_mov_b32 s87, 0
L_spass:
s_lshl_b32 s86, s2, 1
s_add_u32 s86, s86, s87
s_add_u32 s86, s86, 1
s_mul_i32 s86, s86, 393216
s_mul_i32 s47, s40, 82944
s_add_u32 s47, s47, s86
v_lshl_add_u32 v104, v7, 4, s47
s_mul_i32 s47, s40, 9216
s_add_u32 s47, s47, s86
s_add_u32 s47, s47, 331776
v_lshl_add_u32 v105, v7, 4, s47
s_lshl_b32 s47, s40, 6
s_add_u32 s47, s47, s86
s_add_u32 s47, s47, 368640
v_and_b32 v106, 15, v7
v_lshl_add_u32 v106, v106, 2, s47
v_lshrrev_b32 v107, 4, v7
v_lshl_add_u32 v106, v107, 8, v106
buffer_load_dword v174, v106, s[24:27], 0 offen offset:0 sc1
buffer_load_dword v175, v106, s[24:27], 0 offen offset:1024 sc1
buffer_load_dword v176, v106, s[24:27], 0 offen offset:2048 sc1
buffer_load_dword v177, v106, s[24:27], 0 offen offset:3072 sc1
s_mov_b32 s99, 4096
buffer_load_dword v178, v106, s[24:27], s99 offen offset:0 sc1
s_mov_b32 s98, 0
buffer_load_dwordx4 v[138:141], v105, s[24:27], s98 offen sc1
s_mov_b32 s99, 0
buffer_load_dwordx4 a[0:3], v104, s[24:27], s99 offen offset:0 sc1
buffer_load_dwordx4 a[4:7], v104, s[24:27], s99 offen offset:1024 sc1
buffer_load_dwordx4 a[8:11], v104, s[24:27], s99 offen offset:2048 sc1
buffer_load_dwordx4 a[12:15], v104, s[24:27], s99 offen offset:3072 sc1
s_mov_b32 s99, 4096
buffer_load_dwordx4 a[16:19], v104, s[24:27], s99 offen offset:0 sc1
buffer_load_dwordx4 a[20:23], v104, s[24:27], s99 offen offset:1024 sc1
buffer_load_dwordx4 a[24:27], v104, s[24:27], s99 offen offset:2048 sc1
buffer_load_dwordx4 a[28:31], v104, s[24:27], s99 offen offset:3072 sc1
s_mov_b32 s99, 8192
buffer_load_dwordx4 a[32:35], v104, s[24:27], s99 offen offset:0 sc1
s_mov_b32 s98, 1024
buffer_load_dwordx4 v[142:145], v105, s[24:27], s98 offen sc1
buffer_load_dwordx4 a[36:39], v104, s[24:27], s99 offen offset:1024 sc1
buffer_load_dwordx4 a[40:43], v104, s[24:27], s99 offen offset:2048 sc1
buffer_load_dwordx4 a[44:47], v104, s[24:27], s99 offen offset:3072 sc1
s_mov_b32 s99, 12288
buffer_load_dwordx4 a[48:51], v104, s[24:27], s99 offen offset:0 sc1
buffer_load_dwordx4 a[52:55], v104, s[24:27], s99 offen offset:1024 sc1
buffer_load_dwordx4 a[56:59], v104, s[24:27], s99 offen offset:2048 sc1
buffer_load_dwordx4 a[60:63], v104, s[24:27], s99 offen offset:3072 sc1
s_mov_b32 s99, 16384
buffer_load_dwordx4 a[64:67], v104, s[24:27], s99 offen offset:0 sc1
buffer_load_dwordx4 a[68:71], v104, s[24:27], s99 offen offset:1024 sc1
s_mov_b32 s98, 2048
buffer_load_dwordx4 v[146:149], v105, s[24:27], s98 offen sc1
buffer_load_dwordx4 a[72:75], v104, s[24:27], s99 offen offset:2048 sc1
buffer_load_dwordx4 a[76:79], v104, s[24:27], s99 offen offset:3072 sc1
s_mov_b32 s99, 20480
buffer_load_dwordx4 a[80:83], v104, s[24:27], s99 offen offset:0 sc1
buffer_load_dwordx4 a[84:87], v104, s[24:27], s99 offen offset:1024 sc1
buffer_load_dwordx4 a[88:91], v104, s[24:27], s99 offen offset:2048 sc1
buffer_load_dwordx4 a[92:95], v104, s[24:27], s99 offen offset:3072 sc1
s_mov_b32 s99, 24576
buffer_load_dwordx4 a[96:99], v104, s[24:27], s99 offen offset:0 sc1
buffer_load_dwordx4 a[100:103], v104, s[24:27], s99 offen offset:1024 sc1
buffer_load_dwordx4 a[104:107], v104, s[24:27], s99 offen offset:2048 sc1
s_mov_b32 s98, 3072
buffer_load_dwordx4 v[150:153], v105, s[24:27], s98 offen sc1
buffer_load_dwordx4 a[108:111], v104, s[24:27], s99 offen offset:3072 sc1
s_mov_b32 s99, 28672
buffer_load_dwordx4 a[112:115], v104, s[24:27], s99 offen offset:0 sc1
buffer_load_dwordx4 a[116:119], v104, s[24:27], s99 offen offset:1024 sc1
buffer_load_dwordx4 a[120:123], v104, s[24:27], s99 offen offset:2048 sc1
buffer_load_dwordx4 a[124:127], v104, s[24:27], s99 offen offset:3072 sc1
s_mov_b32 s99, 32768
buffer_load_dwordx4 a[128:131], v104, s[24:27], s99 offen offset:0 sc1
buffer_load_dwordx4 a[132:135], v104, s[24:27], s99 offen offset:1024 sc1
buffer_load_dwordx4 a[136:139], v104, s[24:27], s99 offen offset:2048 sc1
buffer_load_dwordx4 a[140:143], v104, s[24:27], s99 offen offset:3072 sc1
s_mov_b32 s98, 4096
buffer_load_dwordx4 v[154:157], v105, s[24:27], s98 offen sc1
s_mov_b32 s99, 36864
buffer_load_dwordx4 a[144:147], v104, s[24:27], s99 offen offset:0 sc1
buffer_load_dwordx4 a[148:151], v104, s[24:27], s99 offen offset:1024 sc1
buffer_load_dwordx4 a[152:155], v104, s[24:27], s99 offen offset:2048 sc1
buffer_load_dwordx4 a[156:159], v104, s[24:27], s99 offen offset:3072 sc1
s_mov_b32 s99, 40960
buffer_load_dwordx4 a[160:163], v104, s[24:27], s99 offen offset:0 sc1
buffer_load_dwordx4 a[164:167], v104, s[24:27], s99 offen offset:1024 sc1
buffer_load_dwordx4 a[168:171], v104, s[24:27], s99 offen offset:2048 sc1
buffer_load_dwordx4 a[172:175], v104, s[24:27], s99 offen offset:3072 sc1
s_mov_b32 s99, 45056
buffer_load_dwordx4 a[176:179], v104, s[24:27], s99 offen offset:0 sc1
s_mov_b32 s98, 5120
buffer_load_dwordx4 v[158:161], v105, s[24:27], s98 offen sc1
buffer_load_dwordx4 a[180:183], v104, s[24:27], s99 offen offset:1024 sc1
buffer_load_dwordx4 a[184:187], v104, s[24:27], s99 offen offset:2048 sc1
buffer_load_dwordx4 a[188:191], v104, s[24:27], s99 offen offset:3072 sc1
s_mov_b32 s99, 49152
buffer_load_dwordx4 a[192:195], v104, s[24:27], s99 offen offset:0 sc1
buffer_load_dwordx4 a[196:199], v104, s[24:27], s99 offen offset:1024 sc1
buffer_load_dwordx4 a[200:203], v104, s[24:27], s99 offen offset:2048 sc1
buffer_load_dwordx4 a[204:207], v104, s[24:27], s99 offen offset:3072 sc1
s_mov_b32 s99, 53248
buffer_load_dwordx4 a[208:211], v104, s[24:27], s99 offen offset:0 sc1
buffer_load_dwordx4 a[212:215], v104, s[24:27], s99 offen offset:1024 sc1
s_mov_b32 s98, 6144
buffer_load_dwordx4 v[162:165], v105, s[24:27], s98 offen sc1
buffer_load_dwordx4 a[216:219], v104, s[24:27], s99 offen offset:2048 sc1
buffer_load_dwordx4 a[220:223], v104, s[24:27], s99 offen offset:3072 sc1
s_mov_b32 s99, 57344
buffer_load_dwordx4 a[224:227], v104, s[24:27], s99 offen offset:0 sc1
buffer_load_dwordx4 a[228:231], v104, s[24:27], s99 offen offset:1024 sc1
buffer_load_dwordx4 a[232:235], v104, s[24:27], s99 offen offset:2048 sc1
buffer_load_dwordx4 a[236:239], v104, s[24:27], s99 offen offset:3072 sc1
s_mov_b32 s99, 61440
buffer_load_dwordx4 a[240:243], v104, s[24:27], s99 offen offset:0 sc1
buffer_load_dwordx4 a[244:247], v104, s[24:27], s99 offen offset:1024 sc1
buffer_load_dwordx4 a[248:251], v104, s[24:27], s99 offen offset:2048 sc1
s_mov_b32 s98, 7168
buffer_load_dwordx4 v[166:169], v105, s[24:27], s98 offen sc1
buffer_load_dwordx4 a[252:255], v104, s[24:27], s99 offen offset:3072 sc1
s_mov_b32 s99, 65536
buffer_load_dwordx4 v[186:189], v104, s[24:27], s99 offen offset:0 sc1
buffer_load_dwordx4 v[190:193], v104, s[24:27], s99 offen offset:1024 sc1
buffer_load_dwordx4 v[194:197], v104, s[24:27], s99 offen offset:2048 sc1
buffer_load_dwordx4 v[198:201], v104, s[24:27], s99 offen offset:3072 sc1
s_mov_b32 s99, 69632
buffer_load_dwordx4 v[202:205], v104, s[24:27], s99 offen offset:0 sc1
buffer_load_dwordx4 v[206:209], v104, s[24:27], s99 offen offset:1024 sc1
buffer_load_dwordx4 v[210:213], v104, s[24:27], s99 offen offset:2048 sc1
buffer_load_dwordx4 v[214:217], v104, s[24:27], s99 offen offset:3072 sc1
s_mov_b32 s98, 8192
buffer_load_dwordx4 v[170:173], v105, s[24:27], s98 offen sc1
s_mov_b32 s99, 73728
buffer_load_dwordx4 v[218:221], v104, s[24:27], s99 offen offset:0 sc1
buffer_load_dwordx4 v[222:225], v104, s[24:27], s99 offen offset:1024 sc1
buffer_load_dwordx4 v[226:229], v104, s[24:27], s99 offen offset:2048 sc1
buffer_load_dwordx4 v[230:233], v104, s[24:27], s99 offen offset:3072 sc1
s_mov_b32 s99, 77824
buffer_load_dwordx4 v[234:237], v104, s[24:27], s99 offen offset:0 sc1
buffer_load_dwordx4 v[238:241], v104, s[24:27], s99 offen offset:1024 sc1
buffer_load_dwordx4 v[242:245], v104, s[24:27], s99 offen offset:2048 sc1
buffer_load_dwordx4 v[246:249], v104, s[24:27], s99 offen offset:3072 sc1
s_mov_b32 s99, 81920
buffer_load_dwordx4 v[250:253], v104, s[24:27], s99 offen offset:0 sc1
s_waitcnt vmcnt(0)
s_barrier
ds_read_b128 v[44:47], v0 offset:0
ds_read_b128 v[48:51], v1 offset:0
s_waitcnt lgkmcnt(0)
v_smfmac_f32_16x16x64_bf16 v[8:11], a[0:3], v[44:51], v138
v_smfmac_f32_16x16x64_bf16 v[12:15], a[4:7], v[44:51], v138 abid:1
v_smfmac_f32_16x16x64_bf16 v[16:19], a[8:11], v[44:51], v139
v_smfmac_f32_16x16x64_bf16 v[20:23], a[12:15], v[44:51], v139 abid:1
v_smfmac_f32_16x16x64_bf16 v[24:27], a[16:19], v[44:51], v140
v_smfmac_f32_16x16x64_bf16 v[28:31], a[20:23], v[44:51], v140 abid:1
v_smfmac_f32_16x16x64_bf16 v[32:35], a[24:27], v[44:51], v141
v_smfmac_f32_16x16x64_bf16 v[36:39], a[28:31], v[44:51], v141 abid:1
v_smfmac_f32_16x16x64_bf16 v[40:43], a[32:35], v[44:51], v174
s_nop 7
ds_read_b128 v[44:47], v0 offset:2048
ds_read_b128 v[48:51], v1 offset:2048
s_waitcnt lgkmcnt(0)
v_smfmac_f32_16x16x64_bf16 v[8:11], a[36:39], v[44:51], v142
v_smfmac_f32_16x16x64_bf16 v[12:15], a[40:43], v[44:51], v142 abid:1
v_smfmac_f32_16x16x64_bf16 v[16:19], a[44:47], v[44:51], v143
v_smfmac_f32_16x16x64_bf16 v[20:23], a[48:51], v[44:51], v143 abid:1
v_smfmac_f32_16x16x64_bf16 v[24:27], a[52:55], v[44:51], v144
v_smfmac_f32_16x16x64_bf16 v[28:31], a[56:59], v[44:51], v144 abid:1
v_smfmac_f32_16x16x64_bf16 v[32:35], a[60:63], v[44:51], v145
v_smfmac_f32_16x16x64_bf16 v[36:39], a[64:67], v[44:51], v145 abid:1
v_smfmac_f32_16x16x64_bf16 v[40:43], a[68:71], v[44:51], v174 abid:1
s_nop 7
ds_read_b128 v[44:47], v0 offset:4096
ds_read_b128 v[48:51], v1 offset:4096
s_waitcnt lgkmcnt(0)
v_smfmac_f32_16x16x64_bf16 v[8:11], a[72:75], v[44:51], v146
v_smfmac_f32_16x16x64_bf16 v[12:15], a[76:79], v[44:51], v146 abid:1
v_smfmac_f32_16x16x64_bf16 v[16:19], a[80:83], v[44:51], v147
v_smfmac_f32_16x16x64_bf16 v[20:23], a[84:87], v[44:51], v147 abid:1
v_smfmac_f32_16x16x64_bf16 v[24:27], a[88:91], v[44:51], v148
v_smfmac_f32_16x16x64_bf16 v[28:31], a[92:95], v[44:51], v148 abid:1
v_smfmac_f32_16x16x64_bf16 v[32:35], a[96:99], v[44:51], v149
v_smfmac_f32_16x16x64_bf16 v[36:39], a[100:103], v[44:51], v149 abid:1
v_smfmac_f32_16x16x64_bf16 v[40:43], a[104:107], v[44:51], v175
s_nop 7
ds_read_b128 v[44:47], v0 offset:6144
ds_read_b128 v[48:51], v1 offset:6144
s_waitcnt lgkmcnt(0)
v_smfmac_f32_16x16x64_bf16 v[8:11], a[108:111], v[44:51], v150
v_smfmac_f32_16x16x64_bf16 v[12:15], a[112:115], v[44:51], v150 abid:1
v_smfmac_f32_16x16x64_bf16 v[16:19], a[116:119], v[44:51], v151
v_smfmac_f32_16x16x64_bf16 v[20:23], a[120:123], v[44:51], v151 abid:1
v_smfmac_f32_16x16x64_bf16 v[24:27], a[124:127], v[44:51], v152
v_smfmac_f32_16x16x64_bf16 v[28:31], a[128:131], v[44:51], v152 abid:1
v_smfmac_f32_16x16x64_bf16 v[32:35], a[132:135], v[44:51], v153
v_smfmac_f32_16x16x64_bf16 v[36:39], a[136:139], v[44:51], v153 abid:1
v_smfmac_f32_16x16x64_bf16 v[40:43], a[140:143], v[44:51], v175 abid:1
s_nop 7
ds_read_b128 v[44:47], v0 offset:8192
ds_read_b128 v[48:51], v1 offset:8192
s_waitcnt lgkmcnt(0)
v_smfmac_f32_16x16x64_bf16 v[8:11], a[144:147], v[44:51], v154
v_smfmac_f32_16x16x64_bf16 v[12:15], a[148:151], v[44:51], v154 abid:1
v_smfmac_f32_16x16x64_bf16 v[16:19], a[152:155], v[44:51], v155
v_smfmac_f32_16x16x64_bf16 v[20:23], a[156:159], v[44:51], v155 abid:1
v_smfmac_f32_16x16x64_bf16 v[24:27], a[160:163], v[44:51], v156
v_smfmac_f32_16x16x64_bf16 v[28:31], a[164:167], v[44:51], v156 abid:1
v_smfmac_f32_16x16x64_bf16 v[32:35], a[168:171], v[44:51], v157
v_smfmac_f32_16x16x64_bf16 v[36:39], a[172:175], v[44:51], v157 abid:1
v_smfmac_f32_16x16x64_bf16 v[40:43], a[176:179], v[44:51], v176
s_nop 7
ds_read_b128 v[44:47], v0 offset:10240
ds_read_b128 v[48:51], v1 offset:10240
s_waitcnt lgkmcnt(0)
v_smfmac_f32_16x16x64_bf16 v[8:11], a[180:183], v[44:51], v158
v_smfmac_f32_16x16x64_bf16 v[12:15], a[184:187], v[44:51], v158 abid:1
v_smfmac_f32_16x16x64_bf16 v[16:19], a[188:191], v[44:51], v159
v_smfmac_f32_16x16x64_bf16 v[20:23], a[192:195], v[44:51], v159 abid:1
v_smfmac_f32_16x16x64_bf16 v[24:27], a[196:199], v[44:51], v160
v_smfmac_f32_16x16x64_bf16 v[28:31], a[200:203], v[44:51], v160 abid:1
v_smfmac_f32_16x16x64_bf16 v[32:35], a[204:207], v[44:51], v161
v_smfmac_f32_16x16x64_bf16 v[36:39], a[208:211], v[44:51], v161 abid:1
v_smfmac_f32_16x16x64_bf16 v[40:43], a[212:215], v[44:51], v176 abid:1
s_nop 7
ds_read_b128 v[44:47], v0 offset:12288
ds_read_b128 v[48:51], v1 offset:12288
s_waitcnt lgkmcnt(0)
v_smfmac_f32_16x16x64_bf16 v[8:11], a[216:219], v[44:51], v162
v_smfmac_f32_16x16x64_bf16 v[12:15], a[220:223], v[44:51], v162 abid:1
v_smfmac_f32_16x16x64_bf16 v[16:19], a[224:227], v[44:51], v163
v_smfmac_f32_16x16x64_bf16 v[20:23], a[228:231], v[44:51], v163 abid:1
v_smfmac_f32_16x16x64_bf16 v[24:27], a[232:235], v[44:51], v164
v_smfmac_f32_16x16x64_bf16 v[28:31], a[236:239], v[44:51], v164 abid:1
v_smfmac_f32_16x16x64_bf16 v[32:35], a[240:243], v[44:51], v165
v_smfmac_f32_16x16x64_bf16 v[36:39], a[244:247], v[44:51], v165 abid:1
v_smfmac_f32_16x16x64_bf16 v[40:43], a[248:251], v[44:51], v177
s_nop 7
ds_read_b128 v[44:47], v0 offset:14336
ds_read_b128 v[48:51], v1 offset:14336
s_waitcnt lgkmcnt(0)
v_smfmac_f32_16x16x64_bf16 v[8:11], a[252:255], v[44:51], v166
v_smfmac_f32_16x16x64_bf16 v[12:15], v[186:189], v[44:51], v166 abid:1
v_smfmac_f32_16x16x64_bf16 v[16:19], v[190:193], v[44:51], v167
v_smfmac_f32_16x16x64_bf16 v[20:23], v[194:197], v[44:51], v167 abid:1
v_smfmac_f32_16x16x64_bf16 v[24:27], v[198:201], v[44:51], v168
v_smfmac_f32_16x16x64_bf16 v[28:31], v[202:205], v[44:51], v168 abid:1
v_smfmac_f32_16x16x64_bf16 v[32:35], v[206:209], v[44:51], v169
v_smfmac_f32_16x16x64_bf16 v[36:39], v[210:213], v[44:51], v169 abid:1
v_smfmac_f32_16x16x64_bf16 v[40:43], v[214:217], v[44:51], v177 abid:1
s_nop 7
ds_read_b128 v[44:47], v0 offset:16384
ds_read_b128 v[48:51], v1 offset:16384
s_waitcnt lgkmcnt(0)
v_smfmac_f32_16x16x64_bf16 v[8:11], v[218:221], v[44:51], v170
v_smfmac_f32_16x16x64_bf16 v[12:15], v[222:225], v[44:51], v170 abid:1
v_smfmac_f32_16x16x64_bf16 v[16:19], v[226:229], v[44:51], v171
v_smfmac_f32_16x16x64_bf16 v[20:23], v[230:233], v[44:51], v171 abid:1
v_smfmac_f32_16x16x64_bf16 v[24:27], v[234:237], v[44:51], v172
v_smfmac_f32_16x16x64_bf16 v[28:31], v[238:241], v[44:51], v172 abid:1
v_smfmac_f32_16x16x64_bf16 v[32:35], v[242:245], v[44:51], v173
v_smfmac_f32_16x16x64_bf16 v[36:39], v[246:249], v[44:51], v173 abid:1
v_smfmac_f32_16x16x64_bf16 v[40:43], v[250:253], v[44:51], v178
s_nop 7
s_add_u32 s87, s87, 1
s_cmp_lt_u32 s87, 2
s_cbranch_scc1 L_spass
v_cvt_pk_bf16_f32 v92, v8, v9
v_cvt_pk_bf16_f32 v93, v10, v11
v_cvt_pk_bf16_f32 v94, v12, v13
v_cvt_pk_bf16_f32 v95, v14, v15
v_cvt_pk_bf16_f32 v96, v16, v17
v_cvt_pk_bf16_f32 v97, v18, v19
v_cvt_pk_bf16_f32 v98, v20, v21
v_cvt_pk_bf16_f32 v99, v22, v23
v_cvt_pk_bf16_f32 v100, v24, v25
v_cvt_pk_bf16_f32 v101, v26, v27
v_cvt_pk_bf16_f32 v102, v28, v29
v_cvt_pk_bf16_f32 v103, v30, v31
v_cvt_pk_bf16_f32 v104, v32, v33
v_cvt_pk_bf16_f32 v105, v34, v35
s_mov_b64 vcc, s[80:81]
s_nop 7
v_cvt_pk_bf16_f32 v106, v36, v37
v_cvt_pk_bf16_f32 v107, v38, v39
v_cvt_pk_bf16_f32 v112, v40, v41
v_cvt_pk_bf16_f32 v113, v42, v43
s_nop 1
v_cndmask_b32_dpp v108, v96, v92, vcc quad_perm:[1,0,3,2] row_mask:0xf bank_mask:0xf
s_nop 1
v_cndmask_b32_dpp v109, v97, v93, vcc quad_perm:[1,0,3,2] row_mask:0xf bank_mask:0xf
s_nop 1
v_cndmask_b32_dpp v110, v98, v94, vcc quad_perm:[1,0,3,2] row_mask:0xf bank_mask:0xf
s_nop 1
v_cndmask_b32_dpp v111, v99, v95, vcc quad_perm:[1,0,3,2] row_mask:0xf bank_mask:0xf
s_waitcnt lgkmcnt(0)
buffer_store_dwordx4 v[108:111], v4, s[20:23], s46 offen offset:0
s_nop 1
s_mov_b64 vcc, s[82:83]
s_nop 1
v_cndmask_b32_dpp v96, v92, v96, vcc quad_perm:[1,0,3,2] row_mask:0xf bank_mask:0xf
s_nop 1
v_cndmask_b32_dpp v97, v93, v97, vcc quad_perm:[1,0,3,2] row_mask:0xf bank_mask:0xf
s_nop 1
v_cndmask_b32_dpp v98, v94, v98, vcc quad_perm:[1,0,3,2] row_mask:0xf bank_mask:0xf
s_nop 1
v_cndmask_b32_dpp v99, v95, v99, vcc quad_perm:[1,0,3,2] row_mask:0xf bank_mask:0xf
s_waitcnt lgkmcnt(0)
buffer_store_dwordx4 v[96:99], v4, s[20:23], s46 offen offset:1152
s_nop 1
s_mov_b64 vcc, s[80:81]
s_nop 1
v_cndmask_b32_dpp v92, v104, v100, vcc quad_perm:[1,0,3,2] row_mask:0xf bank_mask:0xf
s_nop 1
v_cndmask_b32_dpp v93, v105, v101, vcc quad_perm:[1,0,3,2] row_mask:0xf bank_mask:0xf
s_nop 1
ds_bpermute_b32 v112, v6, v112
s_nop 1
v_cndmask_b32_dpp v94, v106, v102, vcc quad_perm:[1,0,3,2] row_mask:0xf bank_mask:0xf
s_nop 1
ds_bpermute_b32 v113, v6, v113
s_nop 1
v_cndmask_b32_dpp v95, v107, v103, vcc quad_perm:[1,0,3,2] row_mask:0xf bank_mask:0xf
s_waitcnt lgkmcnt(0)
buffer_store_dwordx4 v[92:95], v4, s[20:23], s46 offen offset:128
s_nop 1
s_mov_b64 vcc, s[82:83]
s_nop 1
v_cndmask_b32_dpp v104, v100, v104, vcc quad_perm:[1,0,3,2] row_mask:0xf bank_mask:0xf
s_nop 1
v_cndmask_b32_dpp v105, v101, v105, vcc quad_perm:[1,0,3,2] row_mask:0xf bank_mask:0xf
s_nop 1
v_cndmask_b32_dpp v106, v102, v106, vcc quad_perm:[1,0,3,2] row_mask:0xf bank_mask:0xf
s_nop 1
v_cndmask_b32_dpp v107, v103, v107, vcc quad_perm:[1,0,3,2] row_mask:0xf bank_mask:0xf
s_waitcnt lgkmcnt(0)
buffer_store_dwordx4 v[104:107], v4, s[20:23], s46 offen offset:1280
s_nop 1
s_mov_b64 vcc, s[80:81]
s_waitcnt lgkmcnt(0)
buffer_store_dwordx2 v[112:113], v5, s[20:23], s46 offen
s_nop 1
s_add_u32 s45, s45, s13
s_add_u32 s7, s7, s13
s_add_u32 s46, s46, s13
s_mov_b32 s13, 4718592
s_add_u32 s41, s41, 1
s_cmp_lt_u32 s41, s15
s_cbranch_scc1 L_stile
s_branch L_fin
.section .rodata,"a"
.p2align 6
.amdhsa_kernel standalone__structured_sparse_n_m__ragged_kernel
  .amdhsa_next_free_vgpr 512
  .amdhsa_next_free_sgpr 102
  .amdhsa_accum_offset 256
  .amdhsa_group_segment_fixed_size 0
  .amdhsa_float_denorm_mode_32 3
  .amdhsa_kernarg_size 48
  .amdhsa_user_sgpr_count 2
  .amdhsa_user_sgpr_kernarg_segment_ptr 1
  .amdhsa_system_sgpr_workgroup_id_x 1
.end_amdhsa_kernel
```

```asm
; @launch grid=(256,1,1) block=(256,1,1) lds=163840
.amdgcn_target "amdgcn-amd-amdhsa--gfx950"
.text
.globl standalone__structured_sparse_n_m__ragged_kernel
.p2align 8
.type standalone__structured_sparse_n_m__ragged_kernel,@function
standalone__structured_sparse_n_m__ragged_kernel:
s_cmp_ge_u32 s2, 256
s_cbranch_scc1 L_end_standalone__structured_sparse_n_m__ragged_kernel
s_load_dwordx8 s[4:11], s[0:1], 0
s_load_dwordx4 s[12:15], s[0:1], 32
s_getpc_b64 s[96:97]
v_lshlrev_b32 v2, 7, v0
v_min_u32 v2, L_slow-standalone__structured_sparse_n_m__ragged_kernel, v2
global_load_dword v120, v2, s[96:97]
v_lshrrev_b32 v1, 6, v0
v_and_b32 v7, 63, v0
v_readfirstlane_b32 s40, v1
s_mov_b32 s18, 75497472
s_mov_b32 s19, 0x20000
s_mov_b32 s22, 0
s_mov_b32 s23, 0x20000
s_mov_b32 s26, 301989888
s_mov_b32 s27, 0x20000
s_mov_b32 s30, 663552
s_mov_b32 s31, 0x20000
s_mov_b32 s34, 1152
s_mov_b32 s35, 0x20000
s_mov_b32 s38, 256
s_mov_b32 s39, 0x20000
s_mov_b32 s86, 0
s_lshr_b32 s84, s2, 3
s_mul_i32 s84, s84, 2
s_and_b32 s47, s2, 7
s_add_u32 s84, s84, s47
s_cmp_lt_u32 s47, 2
s_cselect_b32 s84, s84, 63
s_cmp_lt_u32 s84, 41
s_cbranch_scc1 L_prod
s_mov_b32 s85, 0x800000
s_mov_b32 s47, 0x800000
s_bitcmp1_b32 s2, 3
s_cselect_b32 s85, s85, 0x230001c
s_cselect_b32 s47, s47, 0x230001c
s_bitcmp1_b32 s2, 4
s_cselect_b32 s85, s47, s85
v_lshrrev_b32 v72, 3, v7
v_and_b32 v73, 7, v7
v_xor_b32 v73, v73, v72
v_mul_u32_u24 v72, 1152, v72
s_and_b32 s47, s40, 1
s_mul_i32 s47, s47, 9216
s_lshr_b32 s3, s40, 1
s_lshl_b32 s3, s3, 7
s_add_u32 s47, s47, s3
v_lshl_add_u32 v72, v73, 4, v72
v_add_u32 v3, s47, v72
s_lshl_b32 s44, s40, 10
s_mul_i32 s45, s2, 18432
s_mov_b32 s46, s45
s_waitcnt lgkmcnt(0)
s_mov_b32 s28, s6
s_and_b32 s29, s7, 0xffff
s_mov_b32 s16, s4
s_and_b32 s17, s5, 0xffff
s_mov_b32 s24, s14
s_and_b32 s25, s15, 0xffff
s_mov_b32 s32, s8
s_and_b32 s33, s9, 0xffff
s_mov_b32 s20, s10
s_and_b32 s21, s11, 0xffff
s_mov_b32 s36, s12
s_and_b32 s37, s13, 0xffff
L_cons3:
s_lshr_b32 s47, s40, 1
s_lshl_b32 s3, s47, 11
s_sub_u32 s8, 15488, s3
s_lshl_b32 s3, s47, 7
s_add_u32 s7, s45, 128
s_sub_u32 s7, s7, s3
s_sub_u32 s10, s47, 1
s_sub_u32 s11, 0, s47
s_mov_b32 s9, s44
s_mov_b32 s13, 4718592
s_mov_b32 s15, 16
s_mov_b32 s14, s13
s_bfe_u32 s88, s85, 0x40014
L_pf:
s_add_u32 m0, s44, 0
s_nop 0
buffer_load_dwordx4 v3, s[16:19], s45 offen offset:0 nt lds
s_add_u32 m0, s44, 3840
s_nop 0
buffer_load_dwordx4 v3, s[16:19], s45 offen offset:256 nt lds
s_add_u32 m0, s44, 7680
s_nop 0
buffer_load_dwordx4 v3, s[16:19], s45 offen offset:512 nt lds
s_add_u32 m0, s44, 11520
s_nop 0
buffer_load_dwordx4 v3, s[16:19], s45 offen offset:768 nt lds
s_add_u32 m0, s44, s8
s_mov_b64 exec, s[10:11]
buffer_load_dwordx4 v3, s[16:19], s7 offen offset:896 nt lds
s_mov_b64 exec, -1
s_add_u32 s7, s7, s13
s_add_u32 s44, s44, 18560
s_add_u32 s45, s45, s13
s_mov_b32 s13, 4718592
s_sub_u32 s88, s88, 1
s_cmp_lg_u32 s88, 0
s_cbranch_scc1 L_pf
L_pf_e:
s_branch L_rest
L_prod:
s_and_b32 s48, s84, 3
s_lshr_b32 s49, s84, 2
s_sub_u32 s50, s84, 36
s_lshl_b32 s51, s40, 4
s_lshl_b32 s52, s50, 1
s_lshl_b32 s53, s48, 8
s_cmp_lt_u32 s84, 36
s_cselect_b32 s52, s49, s52
s_cselect_b32 s53, s53, 1024
s_cselect_b32 s54, 8, 73728
s_cselect_b32 s55, 32, 8
s_cselect_b32 s56, 16, 32
s_cselect_b32 s57, 128, 64
s_mul_i32 s52, s52, 73728
s_mul_i32 s58, s40, 18432
v_and_b32 v58, 1, v7
v_bfe_u32 v59, v7, 1, 1
v_bfe_u32 v60, v7, 2, 2
v_bfe_u32 v62, v7, 4, 1
v_lshrrev_b32 v63, 5, v7
v_lshl_add_u32 v50, v58, 2, s52
v_mad_u32_u24 v50, v59, s54, v50
v_mad_u32_u24 v50, v60, s55, v50
v_mad_u32_u24 v50, v62, s56, v50
v_mad_u32_u24 v50, v63, s57, v50
v_add_u32 v50, s53, v50
v_add_u32 v50, s58, v50
v_add_u32 v62, 4608, v50
v_add_u32 v63, 9216, v50
v_add_u32 v64, 13824, v50
s_waitcnt lgkmcnt(0)
s_mov_b32 s28, s6
s_and_b32 s29, s7, 0xffff
buffer_load_dword v8, v50, s[28:31], 0 offen offset:0
buffer_load_dword v9, v50, s[28:31], 0 offen offset:1152
buffer_load_dword v10, v50, s[28:31], 0 offen offset:2304
buffer_load_dword v11, v50, s[28:31], 0 offen offset:3456
buffer_load_dword v12, v62, s[28:31], 0 offen offset:0
buffer_load_dword v13, v62, s[28:31], 0 offen offset:1152
buffer_load_dword v14, v62, s[28:31], 0 offen offset:2304
buffer_load_dword v15, v62, s[28:31], 0 offen offset:3456
buffer_load_dword v16, v63, s[28:31], 0 offen offset:0
buffer_load_dword v17, v63, s[28:31], 0 offen offset:1152
buffer_load_dword v18, v63, s[28:31], 0 offen offset:2304
buffer_load_dword v19, v63, s[28:31], 0 offen offset:3456
buffer_load_dword v20, v64, s[28:31], 0 offen offset:0
buffer_load_dword v21, v64, s[28:31], 0 offen offset:1152
buffer_load_dword v22, v64, s[28:31], 0 offen offset:2304
buffer_load_dword v23, v64, s[28:31], 0 offen offset:3456
s_mov_b32 s16, s4
s_and_b32 s17, s5, 0xffff
s_mov_b32 s24, s14
s_and_b32 s25, s15, 0xffff
s_mov_b32 s32, s8
s_and_b32 s33, s9, 0xffff
s_mov_b32 s20, s10
s_and_b32 s21, s11, 0xffff
s_mov_b32 s36, s12
s_and_b32 s37, s13, 0xffff
s_mul_i32 s52, s48, 9
s_add_u32 s52, s52, s49
s_mul_i32 s53, s52, 9
s_mul_i32 s54, s50, 18
s_add_u32 s54, s54, 8
s_lshl_b32 s55, s52, 2
s_add_u32 s55, s55, s40
s_lshl_b32 s56, s50, 2
s_add_u32 s56, s56, s40
s_cmp_eq_u32 s84, 40
s_cselect_b32 s57, 0x100000, 9
s_cmp_lt_u32 s84, 36
s_cselect_b32 s53, s53, s54
s_cselect_b32 s54, 2, 81
s_cselect_b32 s57, 1, s57
s_cselect_b32 s55, s55, s56
s_mov_b32 s56, 331776
s_cselect_b32 s56, s56, 368640
s_mov_b32 s58, 373760
s_cselect_b32 s58, s58, 382976
s_cselect_b32 s59, 16, 4
s_cselect_b32 s60, 4, 64
s_cselect_b32 s61, 12, 11
s_cselect_b32 s62, 1, 0x8001
v_lshrrev_b32 v61, 4, v7
v_lshlrev_b32 v62, 1, v58
v_lshl_add_u32 v60, v60, 2, v62
v_add_u32 v62, v60, v59
v_mul_u32_u24 v51, s54, v61
v_add_lshl_u32 v51, v51, s53, 6
v_add3_u32 v51, v51, v62, s51
v_lshl_add_u32 v51, v51, 4, s86
s_lshl_b32 s57, s57, 10
v_add_u32 v66, s57, v51
s_lshl_b32 s52, s55, 8
s_add_u32 s52, s52, s56
s_add_u32 s52, s52, s86
v_mul_u32_u24 v52, s59, v62
v_mad_u32_u24 v52, v61, s60, v52
v_add_u32 v52, s52, v52
s_lshl_b32 s52, s55, 6
s_add_u32 s58, s58, s52
s_add_u32 s58, s58, s86
s_lshl_b32 s52, s51, 1
s_add_u32 s52, s52, s62
v_lshl_add_u32 v62, v61, 1, v59
v_lshlrev_b32 v62, s61, v62
v_lshl_add_u32 v53, v60, 7, v62
v_add_u32 v53, s52, v53
v_lshl_add_u32 v65, v7, 2, s58
s_lshl_b32 s52, s84, 2
s_add_u32 s52, s52, s40
s_lshl_b32 s52, s52, 7
s_add_u32 s52, s52, 268435456
v_writelane_b32 v65, s52, 16
s_mov_b32 s75, 0
s_mov_b32 s73, 0x05060100
s_mov_b32 s74, 0xffff
v_mov_b32 v55, 0x05040100
v_mov_b32 v62, 0x03020706
v_cmp_eq_u32 vcc, 1, v59
v_mov_b32 v68, 0xf0a0500
v_mov_b32 v69, 0x8f8a8580
v_mov_b32 v70, 0x1f1a1510
v_mov_b32 v71, 0x9f9a9590
v_mov_b32 v72, 0x2f2a2520
v_mov_b32 v73, 0xafaaa5a0
v_mov_b32 v74, 0x3f3a3530
v_mov_b32 v75, 0xbfbab5b0
v_cndmask_b32 v55, v55, v62, vcc
v_mov_b64 v[76:77], 0
v_mov_b64 v[78:79], 0
v_mov_b64 v[80:81], 0
v_mov_b32 v82, 0
s_mov_b32 s64, 0x5040500
s_mov_b32 s65, 0x5040501
s_mov_b32 s66, 0x5040502
s_mov_b32 s67, 0x5040503
s_mov_b32 s68, 0x7060700
s_mov_b32 s69, 0x7060701
s_mov_b32 s70, 0x7060702
s_mov_b32 s71, 0x7060703
s_mov_b32 s72, 0x05060102
s_waitcnt vmcnt(12)
v_perm_b32 v24, v8, v68, s64
v_perm_b32 v25, v9, v68, s65
v_perm_b32 v26, v10, v68, s66
v_perm_b32 v27, v11, v68, s67
v_max3_f32 v28, |v24|, |v25|, |v26|
v_med3_f32 v29, |v24|, |v25|, |v26|
v_min3_f32 v30, |v24|, |v25|, |v26|
v_med3_f32 v32, v28, v29, |v27|
v_med3_f32 v33, v29, v30, |v27|
v_max_f32 v31, v28, |v27|
v_perm_b32 v36, v31, v32, s72
v_bfi_b32 v44, 3, v32, v31
v_cmpx_eq_u32_sdwa vcc, v33, v32 src0_sel:WORD_1 src1_sel:WORD_1
v_mov_b32 v76, v33
v_min_f32 v77, v30, |v27|
s_mov_b64 exec, -1
v_perm_b32 v24, v8, v69, s68
v_perm_b32 v25, v9, v69, s69
v_perm_b32 v26, v10, v69, s70
v_perm_b32 v27, v11, v69, s71
v_max3_f32 v28, |v24|, |v25|, |v26|
v_med3_f32 v29, |v24|, |v25|, |v26|
v_min3_f32 v30, |v24|, |v25|, |v26|
v_med3_f32 v32, v28, v29, |v27|
v_med3_f32 v33, v29, v30, |v27|
v_max_f32 v31, v28, |v27|
v_perm_b32 v40, v31, v32, s72
v_bfi_b32 v46, 3, v32, v31
v_cmpx_eq_u32_sdwa vcc, v33, v32 src0_sel:WORD_1 src1_sel:WORD_1
v_mov_b64 v[78:79], v[76:77]
v_mov_b32 v76, v33
v_min_f32 v77, v30, |v27|
s_mov_b64 exec, -1
s_waitcnt vmcnt(8)
v_perm_b32 v24, v12, v70, s64
v_perm_b32 v25, v13, v70, s65
v_perm_b32 v26, v14, v70, s66
v_perm_b32 v27, v15, v70, s67
v_max3_f32 v28, |v24|, |v25|, |v26|
v_med3_f32 v29, |v24|, |v25|, |v26|
v_min3_f32 v30, |v24|, |v25|, |v26|
v_med3_f32 v32, v28, v29, |v27|
v_med3_f32 v33, v29, v30, |v27|
v_max_f32 v31, v28, |v27|
v_perm_b32 v37, v31, v32, s72
v_bfi_b32 v31, 3, v32, v31
v_lshlrev_b32 v31, 4, v31
v_bfi_b32 v44, 15, v44, v31
v_cmpx_eq_u32_sdwa vcc, v33, v32 src0_sel:WORD_1 src1_sel:WORD_1
v_mov_b64 v[80:81], v[78:79]
v_mov_b64 v[78:79], v[76:77]
v_mov_b32 v76, v33
v_min_f32 v77, v30, |v27|
s_mov_b64 exec, -1
v_perm_b32 v24, v12, v71, s68
v_perm_b32 v25, v13, v71, s69
v_perm_b32 v26, v14, v71, s70
v_perm_b32 v27, v15, v71, s71
v_max3_f32 v28, |v24|, |v25|, |v26|
v_med3_f32 v29, |v24|, |v25|, |v26|
v_min3_f32 v30, |v24|, |v25|, |v26|
v_med3_f32 v32, v28, v29, |v27|
v_med3_f32 v33, v29, v30, |v27|
v_max_f32 v31, v28, |v27|
v_perm_b32 v41, v31, v32, s72
v_bfi_b32 v31, 3, v32, v31
v_lshlrev_b32 v31, 4, v31
v_bfi_b32 v46, 15, v46, v31
v_cmpx_eq_u32_sdwa vcc, v33, v32 src0_sel:WORD_1 src1_sel:WORD_1
v_or_b32 v82, v82, v80
v_mov_b64 v[80:81], v[78:79]
v_mov_b64 v[78:79], v[76:77]
v_mov_b32 v76, v33
v_min_f32 v77, v30, |v27|
s_mov_b64 exec, -1
s_waitcnt vmcnt(4)
v_perm_b32 v24, v16, v72, s64
v_perm_b32 v25, v17, v72, s65
v_perm_b32 v26, v18, v72, s66
v_perm_b32 v27, v19, v72, s67
v_max3_f32 v28, |v24|, |v25|, |v26|
v_med3_f32 v29, |v24|, |v25|, |v26|
v_min3_f32 v30, |v24|, |v25|, |v26|
v_med3_f32 v32, v28, v29, |v27|
v_med3_f32 v33, v29, v30, |v27|
v_max_f32 v31, v28, |v27|
v_perm_b32 v38, v31, v32, s72
v_bfi_b32 v45, 3, v32, v31
v_cmpx_eq_u32_sdwa vcc, v33, v32 src0_sel:WORD_1 src1_sel:WORD_1
v_or_b32 v82, v82, v80
v_mov_b64 v[80:81], v[78:79]
v_mov_b64 v[78:79], v[76:77]
v_mov_b32 v76, v33
v_min_f32 v77, v30, |v27|
s_mov_b64 exec, -1
v_perm_b32 v24, v16, v73, s68
v_perm_b32 v25, v17, v73, s69
v_perm_b32 v26, v18, v73, s70
v_perm_b32 v27, v19, v73, s71
v_max3_f32 v28, |v24|, |v25|, |v26|
v_med3_f32 v29, |v24|, |v25|, |v26|
v_min3_f32 v30, |v24|, |v25|, |v26|
v_med3_f32 v32, v28, v29, |v27|
v_med3_f32 v33, v29, v30, |v27|
v_max_f32 v31, v28, |v27|
v_perm_b32 v42, v31, v32, s72
v_bfi_b32 v47, 3, v32, v31
v_cmpx_eq_u32_sdwa vcc, v33, v32 src0_sel:WORD_1 src1_sel:WORD_1
v_or_b32 v82, v82, v80
v_mov_b64 v[80:81], v[78:79]
v_mov_b64 v[78:79], v[76:77]
v_mov_b32 v76, v33
v_min_f32 v77, v30, |v27|
s_mov_b64 exec, -1
s_waitcnt vmcnt(0)
v_perm_b32 v24, v20, v74, s64
v_perm_b32 v25, v21, v74, s65
v_perm_b32 v26, v22, v74, s66
v_perm_b32 v27, v23, v74, s67
v_max3_f32 v28, |v24|, |v25|, |v26|
v_med3_f32 v29, |v24|, |v25|, |v26|
v_min3_f32 v30, |v24|, |v25|, |v26|
v_med3_f32 v32, v28, v29, |v27|
v_med3_f32 v33, v29, v30, |v27|
v_max_f32 v31, v28, |v27|
v_perm_b32 v39, v31, v32, s72
v_bfi_b32 v31, 3, v32, v31
v_lshlrev_b32 v31, 4, v31
v_bfi_b32 v45, 15, v45, v31
v_cmpx_eq_u32_sdwa vcc, v33, v32 src0_sel:WORD_1 src1_sel:WORD_1
v_or_b32 v82, v82, v80
v_mov_b64 v[80:81], v[78:79]
v_mov_b64 v[78:79], v[76:77]
v_mov_b32 v76, v33
v_min_f32 v77, v30, |v27|
s_mov_b64 exec, -1
v_perm_b32 v24, v20, v75, s68
v_perm_b32 v25, v21, v75, s69
v_perm_b32 v26, v22, v75, s70
v_perm_b32 v27, v23, v75, s71
v_max3_f32 v28, |v24|, |v25|, |v26|
v_med3_f32 v29, |v24|, |v25|, |v26|
v_min3_f32 v30, |v24|, |v25|, |v26|
v_med3_f32 v32, v28, v29, |v27|
v_med3_f32 v33, v29, v30, |v27|
v_max_f32 v31, v28, |v27|
v_perm_b32 v43, v31, v32, s72
v_bfi_b32 v31, 3, v32, v31
v_lshlrev_b32 v31, 4, v31
v_bfi_b32 v47, 15, v47, v31
v_cmpx_eq_u32_sdwa vcc, v33, v32 src0_sel:WORD_1 src1_sel:WORD_1
v_or_b32 v82, v82, v80
v_mov_b64 v[80:81], v[78:79]
v_mov_b64 v[78:79], v[76:77]
v_mov_b32 v76, v33
v_min_f32 v77, v30, |v27|
s_mov_b64 exec, -1
s_mov_b32 vcc_lo, 0x33333333
s_mov_b32 vcc_hi, 0x33333333
v_cndmask_b32_dpp v24, v40, v36, vcc quad_perm:[2,3,0,1] row_mask:0xf bank_mask:0xf
v_cndmask_b32_dpp v25, v41, v37, vcc quad_perm:[2,3,0,1] row_mask:0xf bank_mask:0xf
v_cndmask_b32_dpp v26, v42, v38, vcc quad_perm:[2,3,0,1] row_mask:0xf bank_mask:0xf
v_cndmask_b32_dpp v27, v43, v39, vcc quad_perm:[2,3,0,1] row_mask:0xf bank_mask:0xf
s_not_b64 vcc, vcc
buffer_store_dwordx4 v[24:27], v51, s[24:27], 0 offen sc1
v_cndmask_b32_dpp v40, v36, v40, vcc quad_perm:[2,3,0,1] row_mask:0xf bank_mask:0xf
v_cndmask_b32_dpp v41, v37, v41, vcc quad_perm:[2,3,0,1] row_mask:0xf bank_mask:0xf
v_cndmask_b32_dpp v42, v38, v42, vcc quad_perm:[2,3,0,1] row_mask:0xf bank_mask:0xf
v_cndmask_b32_dpp v43, v39, v43, vcc quad_perm:[2,3,0,1] row_mask:0xf bank_mask:0xf
s_mov_b32 s52, 0x0c0c0400
s_mov_b32 s53, 0x04000c0c
buffer_store_dwordx4 v[40:43], v66, s[24:27], 0 offen sc1
v_perm_b32 v48, v45, v44, s52
v_perm_b32 v49, v47, v46, s53
v_or_b32 v48, v48, v49
s_nop 1
v_mov_b32_dpp v49, v48 quad_perm:[2,3,0,1] row_mask:0xf bank_mask:0xf
v_perm_b32 v48, v49, v48, v55
buffer_store_dword v48, v52, s[24:27], 0 offen sc1
v_cmp_lt_u32 s[50:51], s74, v82
L_emit:
v_cmp_lt_u32 vcc, s74, v76
v_cmp_eq_u32_sdwa s[48:49], v77, v76 src0_sel:WORD_1 src1_sel:WORD_1
v_perm_b32 v63, v76, v53, s73
v_bfe_u32 v62, v76, 2, 4
v_and_b32 v64, 0x80, v76
v_lshl_add_u32 v63, v62, 1, v63
v_mbcnt_lo_u32_b32 v62, vcc_lo, 0
v_mbcnt_hi_u32_b32 v62, vcc_hi, v62
v_add_u32 v63, v64, v63
v_add_u32 v62, s75, v62
s_bcnt1_i32_b64 s52, vcc
s_add_u32 s75, s75, s52
v_cmp_gt_u32 s[52:53], 15, v62
v_lshl_add_u32 v62, v62, 2, s58
s_and_b64 s[48:49], s[48:49], vcc
s_and_b64 exec, s[52:53], vcc
s_cbranch_execz L_emit1
buffer_store_dword v63, v62, s[24:27], 0 offen sc1
L_emit1:
s_mov_b64 exec, s[48:49]
v_mov_b32 v76, v77
v_mov_b32 v77, 0
s_not_b64 exec, exec
v_mov_b64 v[76:77], v[78:79]
v_mov_b64 v[78:79], v[80:81]
v_mov_b64 v[80:81], 0
s_mov_b64 exec, -1
v_or3_b32 v62, v76, v78, v80
v_cmp_lt_u32 vcc, s74, v62
s_cmp_lg_u64 s[50:51], 0
s_cselect_b32 s52, 99, s75
s_cmp_gt_u32 s52, 15
s_cselect_b32 s52, -1, 0
s_min_u32 s53, s75, 15
s_cbranch_vccnz L_emit
s_lshl_b32 s53, -1, s53
v_mov_b32 v62, s52
s_and_b32 exec_lo, s53, 131071
s_mov_b32 exec_hi, 0
buffer_store_dword v62, v65, s[24:27], 0 offen sc1
s_mov_b64 exec, -1
s_waitcnt vmcnt(0)
s_mov_b32 s85, 0x230001c
s_barrier
s_cmp_lg_u32 s40, 0
s_cbranch_scc1 L_cons2
v_mov_b32 v8, 1
s_mov_b64 exec, 1
buffer_atomic_add v8, off, s[36:39], 0 offset:128 sc0 sc1
v_mov_b32 v9, 1
s_waitcnt vmcnt(0)
v_readfirstlane_b32 s47, v8
s_nop 3
s_cmp_lg_u32 s47, 40
s_cbranch_scc1 L_notlast
buffer_store_dword v9, off, s[36:39], 0 sc1
L_notlast:
s_mov_b64 exec, -1
L_cons2:
v_lshrrev_b32 v72, 3, v7
v_and_b32 v73, 7, v7
v_xor_b32 v73, v73, v72
v_mul_u32_u24 v72, 1152, v72
s_and_b32 s47, s40, 1
s_mul_i32 s47, s47, 9216
s_lshr_b32 s3, s40, 1
s_lshl_b32 s3, s3, 7
s_add_u32 s47, s47, s3
v_lshl_add_u32 v72, v73, 4, v72
v_add_u32 v3, s47, v72
s_lshl_b32 s44, s40, 10
s_mul_i32 s45, s2, 18432
s_mov_b32 s46, s45
s_barrier
s_branch L_cons3
L_rest:
s_mov_b32 s92, 0x40
s_mov_b32 s47, 0x40
s_bitcmp1_b32 s2, 3
s_cselect_b32 s92, s92, 0x48
s_cselect_b32 s47, s47, 0x48
s_bitcmp1_b32 s2, 4
s_cselect_b32 s92, s47, s92
s_mov_b32 s3, 0x48
s_cmp_lt_u32 s84, 41
s_cselect_b32 s92, s3, s92
s_mov_b32 s87, 0x40
s_mov_b32 s3, 0x40
s_cmp_lt_u32 s84, 41
s_cselect_b32 s87, s3, s87
v_and_b32 v80, 3, v7
v_bfe_u32 v81, v7, 2, 2
v_bfe_u32 v82, v7, 4, 1
v_lshlrev_b32 v81, 3, v81
v_lshl_add_u32 v81, v80, 5, v81
v_lshl_add_u32 v81, v82, 7, v81
s_lshl_b32 s47, s40, 8
v_add_u32 v81, s47, v81
s_lshl_b32 s47, s40, 5
s_add_u32 s47, s47, 1024
v_lshl_add_u32 v80, v80, 3, s47
v_cmp_gt_u32 vcc, 32, v7
s_nop 1
v_cndmask_b32 v80, v80, v81, vcc
buffer_load_dwordx2 v[110:111], v80, s[32:35], 0 offen
v_and_b32 v72, 15, v7
v_lshrrev_b32 v73, 4, v7
v_and_b32 v74, 7, v7
v_xor_b32 v74, v74, v73
v_lshlrev_b32 v74, 4, v74
v_lshl_add_u32 v0, v72, 7, v74
v_xor_b32 v1, 64, v0
s_mul_i32 s93, s40, 3584
s_add_u32 s93, s93, 148480
v_lshl_add_u32 v2, v73, 4, s93
v_and_b32 v74, 14, v7
v_mul_u32_u24 v4, 1152, v74
v_and_b32 v74, 1, v7
v_lshl_add_u32 v4, v74, 4, v4
v_lshl_add_u32 v4, v73, 5, v4
s_lshl_b32 s47, s40, 8
v_add_u32 v4, s47, v4
s_lshl_b32 s47, s40, 5
s_add_u32 s47, s47, 1024
v_lshrrev_b32 v72, 2, v7
v_and_b32 v73, 3, v7
v_lshl_add_u32 v6, v73, 4, v72
v_lshlrev_b32 v6, 2, v6
v_mul_u32_u24 v5, 1152, v72
v_lshl_add_u32 v5, v73, 3, v5
v_add_u32 v5, s47, v5
s_mov_b32 s80, 0x55555555
s_mov_b32 s81, 0x55555555
s_mov_b32 s82, 0xaaaaaaaa
s_mov_b32 s83, 0xaaaaaaaa
v_lshl_add_u32 v109, v7, 4, s93
v_lshl_add_u32 v89, v7, 2, s93
v_mov_b32 v76, 0
v_mov_b32 v77, 0
v_mov_b32 v78, 0
v_mov_b32 v79, 0
v_mov_b32 v90, 0xdddddddd
ds_write_b128 v109, v[76:79]
ds_write_b32 v89, v90 offset:1792
ds_write_b32 v89, v90 offset:2048
ds_write_b32 v89, v90 offset:2304
ds_write_b32 v89, v90 offset:2560
ds_write_b32 v89, v90 offset:2816
ds_write_b32 v89, v90 offset:3072
ds_write_b32 v89, v90 offset:3328
s_lshl_b32 s47, s40, 2
s_add_u32 s47, s47, 163072
v_mov_b32 v88, s47
ds_write_b32 v88, v76
s_mul_i32 s47, s40, 2304
s_add_u32 s47, s47, 373760
v_lshl_add_u32 v72, v7, 6, s47
s_mov_b32 s47, 380672
v_lshl_add_u32 v73, v7, 6, s47
v_lshrrev_b32 v74, 2, v7
v_cmp_gt_u32 vcc, 36, v7
v_lshlrev_b32 v90, 11, v74
v_subrev_u32 v74, 9, v74
v_lshlrev_b32 v74, 12, v74
v_cndmask_b32 v72, v73, v72, vcc
v_cndmask_b32 v90, v74, v90, vcc
s_lshl_b32 s47, s40, 12
s_add_u32 s47, s47, 0x8001
v_mov_b32 v88, 1
v_mov_b32 v94, 0xf001
v_mov_b32 v95, s47
v_cndmask_b32 v94, v94, v88, vcc
v_cndmask_b32 v95, v95, v88, vcc
v_cndmask_b32 v96, 0, 28, vcc
v_cndmask_b32 v97, 32, 0, vcc
v_add_u32 v97, s93, v97
v_cmp_gt_u32 vcc, 56, v7
v_mov_b32 v73, 0x40000000
s_lshr_b32 s47, s2, 3
s_lshl_b32 s47, s47, 2
s_add_u32 s47, s47, s40
s_mul_i32 s47, s47, 3072
v_cndmask_b32 v72, v73, v72, vcc
v_lshl_add_u32 v93, v7, 4, s47
s_mul_i32 s47, s40, 82944
s_add_u32 s47, s47, s86
v_lshl_add_u32 v112, v7, 4, s47
s_mul_i32 s47, s40, 9216
s_add_u32 s47, s47, s86
s_add_u32 s47, s47, 331776
v_lshl_add_u32 v113, v7, 4, s47
s_lshl_b32 s47, s40, 6
s_add_u32 s47, s47, s86
s_add_u32 s47, s47, 368640
v_and_b32 v106, 15, v7
v_lshl_add_u32 v106, v106, 2, s47
v_lshrrev_b32 v107, 4, v7
v_lshl_add_u32 v106, v107, 8, v106
v_and_b32 v74, 15, v7
v_and_b32 v73, 7, v7
v_lshlrev_b32 v100, 1, v73
v_lshlrev_b32 v100, v100, v88
v_lshlrev_b32 v73, 4, v73
v_lshl_add_u32 v92, v74, 7, v73
v_lshl_or_b32 v92, v92, 16, v92
v_lshrrev_b32 v98, 5, v7
v_bfe_u32 v99, v7, 3, 2
v_lshl_add_u32 v99, v99, 6, s93
v_lshl_add_u32 v101, v7, 1, s93
v_lshrrev_b32 v102, 4, v7
v_lshl_add_u32 v102, v102, 3, s93
v_lshrrev_b32 v103, 1, v7
v_lshlrev_b32 v103, 5, v103
s_mov_b32 s89, 0
s_cmp_lg_u32 s40, 0
s_cbranch_scc1 L_ready
s_mov_b64 exec, 1
s_mov_b32 s3, 20000
L_poll:
buffer_load_dword v8, off, s[36:39], 0 sc1
s_sub_u32 s3, s3, 1
s_cbranch_scc1 L_giveup
s_waitcnt vmcnt(0)
v_readfirstlane_b32 s47, v8
s_nop 3
s_cmp_eq_u32 s47, 0
s_cbranch_scc1 L_poll
L_polled:
s_mov_b64 exec, -1
L_ready:
s_waitcnt lgkmcnt(0)
s_barrier
buffer_load_dwordx4 v[8:11], v72, s[24:27], 0 offen offset:0 sc1
buffer_load_dwordx4 v[12:15], v72, s[24:27], 0 offen offset:16 sc1
buffer_load_dwordx4 v[16:19], v72, s[24:27], 0 offen offset:32 sc1
buffer_load_dwordx4 v[20:23], v72, s[24:27], 0 offen offset:48 sc1
buffer_load_dwordx4 v[76:79], v93, s[24:27], 0 offen offset:0 sc1
buffer_load_dwordx4 v[80:83], v93, s[24:27], 0 offen offset:1024 sc1
buffer_load_dwordx4 v[84:87], v93, s[24:27], 0 offen offset:2048 sc1
buffer_load_dword v174, v106, s[24:27], 0 offen offset:0 sc1
buffer_load_dword v175, v106, s[24:27], 0 offen offset:1024 sc1
buffer_load_dword v176, v106, s[24:27], 0 offen offset:2048 sc1
buffer_load_dword v177, v106, s[24:27], 0 offen offset:3072 sc1
s_mov_b32 s99, 4096
buffer_load_dword v178, v106, s[24:27], s99 offen offset:0 sc1
s_mov_b32 s98, 0
buffer_load_dwordx4 v[138:141], v113, s[24:27], s98 offen sc1
s_mov_b32 s99, 0
buffer_load_dwordx4 a[0:3], v112, s[24:27], s99 offen offset:0 sc1
buffer_load_dwordx4 a[4:7], v112, s[24:27], s99 offen offset:1024 sc1
buffer_load_dwordx4 a[8:11], v112, s[24:27], s99 offen offset:2048 sc1
s_waitcnt vmcnt(12)
v_cmp_ne_u32 s[90:91], 0, v23
v_cmp_ne_u32 s[78:79], 0, v16
v_and_b32 v73, v94, v8
v_lshrrev_b32 v72, 10, v8
v_cmp_eq_u32 s[48:49], v73, v95
v_and_or_b32 v24, v72, v96, v97
s_mov_b64 exec, s[48:49]
ds_add_rtn_u32 v40, v24, v88
s_mov_b64 exec, -1
v_and_b32 v73, v94, v9
v_lshrrev_b32 v72, 10, v9
v_cmp_eq_u32 s[50:51], v73, v95
v_and_or_b32 v25, v72, v96, v97
s_mov_b64 exec, s[50:51]
ds_add_rtn_u32 v41, v25, v88
s_mov_b64 exec, -1
buffer_load_dwordx4 a[12:15], v112, s[24:27], s99 offen offset:3072 sc1
v_and_b32 v73, v94, v10
v_lshrrev_b32 v72, 10, v10
v_cmp_eq_u32 s[52:53], v73, v95
v_and_or_b32 v26, v72, v96, v97
s_mov_b64 exec, s[52:53]
ds_add_rtn_u32 v42, v26, v88
s_mov_b64 exec, -1
v_and_b32 v73, v94, v11
v_lshrrev_b32 v72, 10, v11
v_cmp_eq_u32 s[54:55], v73, v95
v_and_or_b32 v27, v72, v96, v97
s_mov_b64 exec, s[54:55]
ds_add_rtn_u32 v43, v27, v88
s_mov_b64 exec, -1
s_mov_b32 s99, 4096
buffer_load_dwordx4 a[16:19], v112, s[24:27], s99 offen offset:0 sc1
v_and_b32 v73, v94, v12
v_lshrrev_b32 v72, 10, v12
v_cmp_eq_u32 s[56:57], v73, v95
v_and_or_b32 v28, v72, v96, v97
s_mov_b64 exec, s[56:57]
ds_add_rtn_u32 v44, v28, v88
s_mov_b64 exec, -1
v_and_b32 v73, v94, v13
v_lshrrev_b32 v72, 10, v13
v_cmp_eq_u32 s[58:59], v73, v95
v_and_or_b32 v29, v72, v96, v97
s_mov_b64 exec, s[58:59]
ds_add_rtn_u32 v45, v29, v88
s_mov_b64 exec, -1
buffer_load_dwordx4 a[20:23], v112, s[24:27], s99 offen offset:1024 sc1
v_and_b32 v73, v94, v14
v_lshrrev_b32 v72, 10, v14
v_cmp_eq_u32 s[60:61], v73, v95
v_and_or_b32 v30, v72, v96, v97
s_mov_b64 exec, s[60:61]
ds_add_rtn_u32 v46, v30, v88
s_mov_b64 exec, -1
v_and_b32 v73, v94, v15
v_lshrrev_b32 v72, 10, v15
v_cmp_eq_u32 s[62:63], v73, v95
v_and_or_b32 v31, v72, v96, v97
s_mov_b64 exec, s[62:63]
ds_add_rtn_u32 v47, v31, v88
s_mov_b64 exec, -1
buffer_load_dwordx4 a[24:27], v112, s[24:27], s99 offen offset:2048 sc1
s_cmp_lg_u64 s[78:79], 0
s_cbranch_scc1 L_more1
L_more1b:
ds_read_b32 v72, v89
v_mov_b32 v73, 0
buffer_load_dwordx4 a[28:31], v112, s[24:27], s99 offen offset:3072 sc1
s_mov_b32 s99, 8192
buffer_load_dwordx4 a[32:35], v112, s[24:27], s99 offen offset:0 sc1
s_waitcnt lgkmcnt(0)
s_mov_b64 vcc, s[80:81]
v_cndmask_b32_dpp v73, v72, v73, vcc quad_perm:[0,0,2,2] row_mask:0xf bank_mask:0xf
v_add_u32 v91, v103, v73
v_add_u32 v73, v72, v73
v_cmp_lt_u32 vcc, 32, v73
s_or_b32 s90, s90, s91
s_and_b32 s47, vcc_lo, 0x1ff
s_or_b32 s47, s47, s90
s_cbranch_scc1 L_greedy
L_greedyb:
s_mov_b32 s98, 1024
buffer_load_dwordx4 v[142:145], v113, s[24:27], s98 offen sc1
ds_bpermute_b32 v56, v24, v91
ds_bpermute_b32 v57, v25, v91
ds_bpermute_b32 v58, v26, v91
ds_bpermute_b32 v59, v27, v91
ds_bpermute_b32 v60, v28, v91
ds_bpermute_b32 v61, v29, v91
ds_bpermute_b32 v62, v30, v91
ds_bpermute_b32 v63, v31, v91
buffer_load_dwordx4 a[36:39], v112, s[24:27], s99 offen offset:1024 sc1
buffer_load_dwordx4 a[40:43], v112, s[24:27], s99 offen offset:2048 sc1
s_waitcnt lgkmcnt(7)
v_add_u32 v73, v40, v56
v_and_b32 v72, 0x87e, v8
v_lshl_add_u32 v73, v73, 1, s93
v_add_u32 v72, v90, v72
s_andn2_b64 exec, s[48:49], s[90:91]
ds_write_b16_d16_hi v73, v8 offset:64
ds_write_b16 v73, v72 offset:384
ds_write_b16 v73, v8 offset:704
s_mov_b64 exec, -1
buffer_load_dwordx4 a[44:47], v112, s[24:27], s99 offen offset:3072 sc1
s_waitcnt lgkmcnt(9)
v_add_u32 v73, v41, v57
v_and_b32 v72, 0x87e, v9
v_lshl_add_u32 v73, v73, 1, s93
v_add_u32 v72, v90, v72
s_andn2_b64 exec, s[50:51], s[90:91]
ds_write_b16_d16_hi v73, v9 offset:64
ds_write_b16 v73, v72 offset:384
ds_write_b16 v73, v9 offset:704
s_mov_b64 exec, -1
s_mov_b32 s99, 12288
buffer_load_dwordx4 a[48:51], v112, s[24:27], s99 offen offset:0 sc1
s_waitcnt lgkmcnt(11)
v_add_u32 v73, v42, v58
v_and_b32 v72, 0x87e, v10
v_lshl_add_u32 v73, v73, 1, s93
v_add_u32 v72, v90, v72
s_andn2_b64 exec, s[52:53], s[90:91]
ds_write_b16_d16_hi v73, v10 offset:64
ds_write_b16 v73, v72 offset:384
ds_write_b16 v73, v10 offset:704
s_mov_b64 exec, -1
buffer_load_dwordx4 a[52:55], v112, s[24:27], s99 offen offset:1024 sc1
s_waitcnt lgkmcnt(13)
v_add_u32 v73, v43, v59
v_and_b32 v72, 0x87e, v11
v_lshl_add_u32 v73, v73, 1, s93
v_add_u32 v72, v90, v72
s_andn2_b64 exec, s[54:55], s[90:91]
ds_write_b16_d16_hi v73, v11 offset:64
ds_write_b16 v73, v72 offset:384
ds_write_b16 v73, v11 offset:704
s_mov_b64 exec, -1
s_waitcnt lgkmcnt(15)
v_add_u32 v73, v44, v60
v_and_b32 v72, 0x87e, v12
v_lshl_add_u32 v73, v73, 1, s93
v_add_u32 v72, v90, v72
s_andn2_b64 exec, s[56:57], s[90:91]
ds_write_b16_d16_hi v73, v12 offset:64
ds_write_b16 v73, v72 offset:384
ds_write_b16 v73, v12 offset:704
s_mov_b64 exec, -1
buffer_load_dwordx4 a[56:59], v112, s[24:27], s99 offen offset:2048 sc1
s_waitcnt lgkmcnt(15)
v_add_u32 v73, v45, v61
v_and_b32 v72, 0x87e, v13
v_lshl_add_u32 v73, v73, 1, s93
v_add_u32 v72, v90, v72
s_andn2_b64 exec, s[58:59], s[90:91]
ds_write_b16_d16_hi v73, v13 offset:64
ds_write_b16 v73, v72 offset:384
ds_write_b16 v73, v13 offset:704
s_mov_b64 exec, -1
buffer_load_dwordx4 a[60:63], v112, s[24:27], s99 offen offset:3072 sc1
s_waitcnt lgkmcnt(15)
v_add_u32 v73, v46, v62
v_and_b32 v72, 0x87e, v14
v_lshl_add_u32 v73, v73, 1, s93
v_add_u32 v72, v90, v72
s_andn2_b64 exec, s[60:61], s[90:91]
ds_write_b16_d16_hi v73, v14 offset:64
ds_write_b16 v73, v72 offset:384
ds_write_b16 v73, v14 offset:704
s_mov_b64 exec, -1
s_waitcnt lgkmcnt(15)
v_add_u32 v73, v47, v63
v_and_b32 v72, 0x87e, v15
v_lshl_add_u32 v73, v73, 1, s93
v_add_u32 v72, v90, v72
s_andn2_b64 exec, s[62:63], s[90:91]
ds_write_b16_d16_hi v73, v15 offset:64
ds_write_b16 v73, v72 offset:384
ds_write_b16 v73, v15 offset:704
s_mov_b64 exec, -1
s_mov_b32 s99, 16384
buffer_load_dwordx4 a[64:67], v112, s[24:27], s99 offen offset:0 sc1
s_cmp_lg_u64 s[78:79], 0
s_cbranch_scc1 L_more2
L_more2b:
ds_read_u16 v8, v101 offset:704
ds_read_u16 v9, v101 offset:832
ds_read_u16 v10, v101 offset:960
ds_read2_b64 v[118:121], v102 offset0:48 offset1:52
ds_read2_b64 v[122:125], v102 offset0:56 offset1:60
ds_read2_b64 v[126:129], v102 offset0:64 offset1:68
ds_read2_b64 v[130:133], v102 offset0:72 offset1:76
ds_read2_b64 v[134:137], v102 offset0:80 offset1:84
buffer_load_dwordx4 a[68:71], v112, s[24:27], s99 offen offset:1024 sc1
s_mov_b32 s98, 2048
buffer_load_dwordx4 v[146:149], v113, s[24:27], s98 offen sc1
buffer_load_dwordx4 a[72:75], v112, s[24:27], s99 offen offset:2048 sc1
s_waitcnt lgkmcnt(5)
v_lshrrev_b32 v72, 12, v8
v_cmp_ne_u32 vcc, 0, v8
v_min_u32 v72, 8, v72
v_add3_u32 v72, v72, v98, 0
v_lshlrev_b32 v73, 4, v72
v_lshrrev_b32 v72, 1, v72
v_lshlrev_b32 v73, v73, v100
v_lshl_add_u32 v72, v72, 8, v99
v_bfe_u32 v74, v8, 7, 4
v_lshl_add_u32 v72, v74, 2, v72
s_mov_b64 exec, vcc
ds_xor_b32 v72, v73 offset:1792
s_mov_b64 exec, -1
buffer_load_dwordx4 a[76:79], v112, s[24:27], s99 offen offset:3072 sc1
v_lshrrev_b32 v72, 12, v9
v_cmp_ne_u32 vcc, 0, v9
v_min_u32 v72, 8, v72
v_add3_u32 v72, v72, v98, 2
v_lshlrev_b32 v73, 4, v72
v_lshrrev_b32 v72, 1, v72
v_lshlrev_b32 v73, v73, v100
v_lshl_add_u32 v72, v72, 8, v99
v_bfe_u32 v74, v9, 7, 4
v_lshl_add_u32 v72, v74, 2, v72
s_mov_b64 exec, vcc
ds_xor_b32 v72, v73 offset:1792
s_mov_b64 exec, -1
s_mov_b32 s99, 20480
buffer_load_dwordx4 a[80:83], v112, s[24:27], s99 offen offset:0 sc1
v_lshrrev_b32 v72, 12, v10
v_cmp_ne_u32 vcc, 0, v10
v_min_u32 v72, 8, v72
v_add3_u32 v72, v72, v98, 4
v_lshlrev_b32 v73, 4, v72
v_lshrrev_b32 v72, 1, v72
v_lshlrev_b32 v73, v73, v100
v_lshl_add_u32 v72, v72, 8, v99
v_bfe_u32 v74, v10, 7, 4
v_lshl_add_u32 v72, v74, 2, v72
s_mov_b64 exec, vcc
s_mov_b32 exec_hi, 0
ds_xor_b32 v72, v73 offset:1792
s_mov_b64 exec, -1
buffer_load_dwordx4 a[84:87], v112, s[24:27], s99 offen offset:1024 sc1
ds_read_b32 v179, v89 offset:1792
ds_read_b32 v180, v89 offset:2048
ds_read_b32 v181, v89 offset:2304
ds_read_b32 v182, v89 offset:2560
ds_read_b32 v183, v89 offset:2816
ds_read_b32 v184, v89 offset:3072
ds_read_b32 v185, v89 offset:3328
s_waitcnt lgkmcnt(10)
v_xor_b32 v118, v92, v118
v_xor_b32 v119, v92, v119
v_xor_b32 v120, v92, v120
v_xor_b32 v121, v92, v121
buffer_load_dwordx4 a[88:91], v112, s[24:27], s99 offen offset:2048 sc1
v_xor_b32 v122, v92, v122
v_xor_b32 v123, v92, v123
v_xor_b32 v124, v92, v124
v_xor_b32 v125, v92, v125
v_xor_b32 v126, v92, v126
v_xor_b32 v127, v92, v127
v_xor_b32 v128, v92, v128
v_xor_b32 v129, v92, v129
v_xor_b32 v130, v92, v130
v_xor_b32 v131, v92, v131
v_xor_b32 v132, v92, v132
v_xor_b32 v133, v92, v133
buffer_load_dwordx4 a[92:95], v112, s[24:27], s99 offen offset:3072 sc1
v_xor_b32 v134, v92, v134
v_xor_b32 v135, v92, v135
v_xor_b32 v136, v92, v136
v_xor_b32 v137, v92, v137
v_lshlrev_b32 v114, 16, v110
v_and_b32 v115, 0xffff0000, v110
v_lshlrev_b32 v116, 16, v111
v_and_b32 v117, 0xffff0000, v111
s_mov_b32 exec_hi, 15
ds_write_b128 v109, v[114:117] offset:1024
s_mov_b64 exec, -1
s_mov_b32 s41, 2
s_mov_b32 s42, 0
s_mov_b32 s4, 37120
s_mov_b32 s22, 75497472
s_mov_b32 s5, 18560
s_mov_b32 s6, 4718592
s_mov_b64 vcc, s[80:81]
s_andn2_b32 s12, 31, s85
s_mov_b32 s59, 5
s_add_u32 s48, s46, 9437184
s_add_u32 s49, s48, 4718592
s_add_u32 s50, s49, 4718592
s_sub_u32 s58, s7, s45
s_lshr_b32 s47, s2, 5
s_mul_i32 s57, s47, 589824
s_add_u32 s57, s57, 42467328
s_lshl_b32 s47, s47, 7
s_add_u32 s47, s47, 268435456
s_add_u32 s32, s24, s47
s_addc_u32 s33, s25, 0
s_cmp_eq_u32 s40, 0
s_cselect_b32 s34, 4, 0
s_cselect_b64 s[62:63], 1, 0
s_waitcnt lgkmcnt(0)
v_mov_b32 v114, 163072
s_barrier
ds_read_b32 v114, v114
ds_read_b128 v[44:47], v0 offset:0
ds_read_b128 v[48:51], v1 offset:0
s_waitcnt vmcnt(18)
ds_read_b128 v[76:79], v2 offset:1024
ds_read_b128 v[80:83], v2 offset:1088
ds_read_b128 v[84:87], v2 offset:1152
ds_read_b128 v[88:91], v2 offset:1216
ds_read_b128 v[92:95], v2 offset:1280
ds_read_b128 v[96:99], v2 offset:1344
ds_read_b128 v[100:103], v2 offset:1408
ds_read_b128 v[104:107], v2 offset:1472
ds_read_b128 v[108:111], v2 offset:1536
s_mov_b32 s99, 24576
buffer_load_dwordx4 a[96:99], v112, s[24:27], s99 offen offset:0 sc1
ds_read_b128 v[8:11], v2 offset:1024
ds_read_b128 v[12:15], v2 offset:1088
ds_read_b128 v[16:19], v2 offset:1152
ds_read_b128 v[20:23], v2 offset:1216
ds_read_b128 v[24:27], v2 offset:1280
ds_read_b128 v[28:31], v2 offset:1344
ds_read_b128 v[32:35], v2 offset:1408
ds_read_b128 v[36:39], v2 offset:1472
ds_read_b128 v[40:43], v2 offset:1536
buffer_load_dwordx4 a[100:103], v112, s[24:27], s99 offen offset:1024 sc1
s_waitcnt lgkmcnt(15)
v_readfirstlane_b32 s47, v114
v_add_u32_sdwa v60, s42, v118 dst_sel:DWORD dst_unused:UNUSED_PAD src0_sel:DWORD src1_sel:WORD_0
s_nop 2
s_cmp_lg_u32 s47, 0
s_cbranch_scc1 L_slow
v_smfmac_f32_16x16x64_bf16 v[76:79], a[0:3], v[44:51], v138
ds_read_b128 v[52:55], v0 offset:18560
ds_read_b128 v[56:59], v1 offset:18560
ds_read_u16 v68, v60 offset:18560
ds_read_u16 v60, v60
v_add_u32_sdwa v61, s42, v118 dst_sel:DWORD dst_unused:UNUSED_PAD src0_sel:DWORD src1_sel:WORD_1
v_smfmac_f32_16x16x64_bf16 v[80:83], a[4:7], v[44:51], v138 abid:1
ds_read_u16 v69, v61 offset:18560
ds_read_u16 v61, v61
v_add_u32_sdwa v62, s42, v119 dst_sel:DWORD dst_unused:UNUSED_PAD src0_sel:DWORD src1_sel:WORD_0
v_smfmac_f32_16x16x64_bf16 v[84:87], a[8:11], v[44:51], v139
buffer_load_dwordx4 a[104:107], v112, s[24:27], s99 offen offset:2048 sc1
ds_read_u16 v70, v62 offset:18560
ds_read_u16 v62, v62
v_add_u32_sdwa v63, s42, v119 dst_sel:DWORD dst_unused:UNUSED_PAD src0_sel:DWORD src1_sel:WORD_1
s_waitcnt lgkmcnt(15)
v_smfmac_f32_16x16x64_bf16 v[88:91], a[12:15], v[44:51], v139 abid:1
ds_read_u16 v71, v63 offset:18560
ds_read_u16 v63, v63
v_add_u32_sdwa v64, s42, v120 dst_sel:DWORD dst_unused:UNUSED_PAD src0_sel:DWORD src1_sel:WORD_0
v_smfmac_f32_16x16x64_bf16 v[92:95], a[16:19], v[44:51], v140
s_mov_b32 s98, 3072
buffer_load_dwordx4 v[150:153], v113, s[24:27], s98 offen sc1
ds_read_u16 v72, v64 offset:18560
ds_read_u16 v64, v64
v_add_u32_sdwa v65, s42, v120 dst_sel:DWORD dst_unused:UNUSED_PAD src0_sel:DWORD src1_sel:WORD_1
v_smfmac_f32_16x16x64_bf16 v[96:99], a[20:23], v[44:51], v140 abid:1
ds_read_u16 v73, v65 offset:18560
ds_read_u16 v65, v65
v_add_u32_sdwa v66, s42, v121 dst_sel:DWORD dst_unused:UNUSED_PAD src0_sel:DWORD src1_sel:WORD_0
v_smfmac_f32_16x16x64_bf16 v[100:103], a[24:27], v[44:51], v141
buffer_load_dwordx4 a[108:111], v112, s[24:27], s99 offen offset:3072 sc1
ds_read_u16 v74, v66 offset:18560
ds_read_u16 v66, v66
v_add_u32_sdwa v67, s42, v121 dst_sel:DWORD dst_unused:UNUSED_PAD src0_sel:DWORD src1_sel:WORD_1
v_smfmac_f32_16x16x64_bf16 v[104:107], a[28:31], v[44:51], v141 abid:1
ds_read_u16 v75, v67 offset:18560
ds_read_u16 v67, v67
s_waitcnt vmcnt(18)
v_smfmac_f32_16x16x64_bf16 v[108:111], a[32:35], v[44:51], v174
ds_read_b128 v[114:117], v2 offset:64
s_waitcnt lgkmcnt(15)
v_smfmac_f32_16x16x64_bf16 v[8:11], a[0:3], v[52:59], v138
s_mov_b32 s99, 28672
buffer_load_dwordx4 a[112:115], v112, s[24:27], s99 offen offset:0 sc1
ds_read_b128 v[44:47], v0 offset:2048
v_smfmac_f32_16x16x64_bf16 v[12:15], a[4:7], v[52:59], v138 abid:1
ds_read_b128 v[48:51], v1 offset:2048
v_smfmac_f32_16x16x64_bf16 v[16:19], a[8:11], v[52:59], v139
buffer_load_dwordx4 a[116:119], v112, s[24:27], s99 offen offset:1024 sc1
v_smfmac_f32_16x16x64_bf16 v[20:23], a[12:15], v[52:59], v139 abid:1
v_smfmac_f32_16x16x64_bf16 v[24:27], a[16:19], v[52:59], v140
buffer_load_dwordx4 a[120:123], v112, s[24:27], s99 offen offset:2048 sc1
v_smfmac_f32_16x16x64_bf16 v[28:31], a[20:23], v[52:59], v140 abid:1
v_smfmac_f32_16x16x64_bf16 v[32:35], a[24:27], v[52:59], v141
v_smfmac_f32_16x16x64_bf16 v[36:39], a[28:31], v[52:59], v141 abid:1
buffer_load_dwordx4 a[124:127], v112, s[24:27], s99 offen offset:3072 sc1
v_smfmac_f32_16x16x64_bf16 v[40:43], a[32:35], v[52:59], v174
s_waitcnt lgkmcnt(2)
v_smfmac_f32_16x16x64_bf16 v[8:11], v[114:117], v[68:75], v179
s_mov_b32 s99, 32768
buffer_load_dwordx4 a[128:131], v112, s[24:27], s99 offen offset:0 sc1
v_smfmac_f32_16x16x64_bf16 v[12:15], v[114:117], v[68:75], v179 abid:1
v_smfmac_f32_16x16x64_bf16 v[76:79], v[114:117], v[60:67], v179
buffer_load_dwordx4 a[132:135], v112, s[24:27], s99 offen offset:1024 sc1
v_smfmac_f32_16x16x64_bf16 v[80:83], v[114:117], v[60:67], v179 abid:1
v_add_u32_sdwa v60, s42, v122 dst_sel:DWORD dst_unused:UNUSED_PAD src0_sel:DWORD src1_sel:WORD_0
s_waitcnt lgkmcnt(0)
v_smfmac_f32_16x16x64_bf16 v[76:79], a[36:39], v[44:51], v142
ds_read_b128 v[52:55], v0 offset:20608
ds_read_b128 v[56:59], v1 offset:20608
ds_read_u16 v68, v60 offset:18560
ds_read_u16 v60, v60
v_add_u32_sdwa v61, s42, v122 dst_sel:DWORD dst_unused:UNUSED_PAD src0_sel:DWORD src1_sel:WORD_1
v_smfmac_f32_16x16x64_bf16 v[80:83], a[40:43], v[44:51], v142 abid:1
buffer_load_dwordx4 a[136:139], v112, s[24:27], s99 offen offset:2048 sc1
ds_read_u16 v69, v61 offset:18560
ds_read_u16 v61, v61
v_add_u32_sdwa v62, s42, v123 dst_sel:DWORD dst_unused:UNUSED_PAD src0_sel:DWORD src1_sel:WORD_0
v_smfmac_f32_16x16x64_bf16 v[84:87], a[44:47], v[44:51], v143
ds_read_u16 v70, v62 offset:18560
ds_read_u16 v62, v62
v_add_u32_sdwa v63, s42, v123 dst_sel:DWORD dst_unused:UNUSED_PAD src0_sel:DWORD src1_sel:WORD_1
s_waitcnt vmcnt(18)
v_smfmac_f32_16x16x64_bf16 v[88:91], a[48:51], v[44:51], v143 abid:1
buffer_load_dwordx4 a[140:143], v112, s[24:27], s99 offen offset:3072 sc1
ds_read_u16 v71, v63 offset:18560
ds_read_u16 v63, v63
v_add_u32_sdwa v64, s42, v124 dst_sel:DWORD dst_unused:UNUSED_PAD src0_sel:DWORD src1_sel:WORD_0
v_smfmac_f32_16x16x64_bf16 v[92:95], a[52:55], v[44:51], v144
ds_read_u16 v72, v64 offset:18560
ds_read_u16 v64, v64
v_add_u32_sdwa v65, s42, v124 dst_sel:DWORD dst_unused:UNUSED_PAD src0_sel:DWORD src1_sel:WORD_1
v_smfmac_f32_16x16x64_bf16 v[96:99], a[56:59], v[44:51], v144 abid:1
s_mov_b32 s98, 4096
buffer_load_dwordx4 v[154:157], v113, s[24:27], s98 offen sc1
ds_read_u16 v73, v65 offset:18560
ds_read_u16 v65, v65
v_add_u32_sdwa v66, s42, v125 dst_sel:DWORD dst_unused:UNUSED_PAD src0_sel:DWORD src1_sel:WORD_0
v_smfmac_f32_16x16x64_bf16 v[100:103], a[60:63], v[44:51], v145
ds_read_u16 v74, v66 offset:18560
ds_read_u16 v66, v66
v_add_u32_sdwa v67, s42, v125 dst_sel:DWORD dst_unused:UNUSED_PAD src0_sel:DWORD src1_sel:WORD_1
v_smfmac_f32_16x16x64_bf16 v[104:107], a[64:67], v[44:51], v145 abid:1
ds_read_u16 v75, v67 offset:18560
ds_read_u16 v67, v67
v_smfmac_f32_16x16x64_bf16 v[108:111], a[68:71], v[44:51], v174 abid:1
s_mov_b32 s99, 36864
buffer_load_dwordx4 a[144:147], v112, s[24:27], s99 offen offset:0 sc1
ds_read_b128 v[114:117], v2 offset:128
s_waitcnt lgkmcnt(15)
v_smfmac_f32_16x16x64_bf16 v[8:11], a[36:39], v[52:59], v142
ds_read_b128 v[44:47], v0 offset:4096
v_smfmac_f32_16x16x64_bf16 v[12:15], a[40:43], v[52:59], v142 abid:1
buffer_load_dwordx4 a[148:151], v112, s[24:27], s99 offen offset:1024 sc1
ds_read_b128 v[48:51], v1 offset:4096
v_smfmac_f32_16x16x64_bf16 v[16:19], a[44:47], v[52:59], v143
v_smfmac_f32_16x16x64_bf16 v[20:23], a[48:51], v[52:59], v143 abid:1
buffer_load_dwordx4 a[152:155], v112, s[24:27], s99 offen offset:2048 sc1
v_smfmac_f32_16x16x64_bf16 v[24:27], a[52:55], v[52:59], v144
v_smfmac_f32_16x16x64_bf16 v[28:31], a[56:59], v[52:59], v144 abid:1
v_smfmac_f32_16x16x64_bf16 v[32:35], a[60:63], v[52:59], v145
buffer_load_dwordx4 a[156:159], v112, s[24:27], s99 offen offset:3072 sc1
v_smfmac_f32_16x16x64_bf16 v[36:39], a[64:67], v[52:59], v145 abid:1
v_smfmac_f32_16x16x64_bf16 v[40:43], a[68:71], v[52:59], v174 abid:1
s_mov_b32 s99, 40960
buffer_load_dwordx4 a[160:163], v112, s[24:27], s99 offen offset:0 sc1
s_waitcnt lgkmcnt(2)
v_smfmac_f32_16x16x64_bf16 v[12:15], v[114:117], v[68:75], v180
v_smfmac_f32_16x16x64_bf16 v[16:19], v[114:117], v[68:75], v180 abid:1
buffer_load_dwordx4 a[164:167], v112, s[24:27], s99 offen offset:1024 sc1
v_smfmac_f32_16x16x64_bf16 v[20:23], v[114:117], v[68:75], v181
v_smfmac_f32_16x16x64_bf16 v[80:83], v[114:117], v[60:67], v180
v_smfmac_f32_16x16x64_bf16 v[84:87], v[114:117], v[60:67], v180 abid:1
buffer_load_dwordx4 a[168:171], v112, s[24:27], s99 offen offset:2048 sc1
v_smfmac_f32_16x16x64_bf16 v[88:91], v[114:117], v[60:67], v181
v_add_u32_sdwa v60, s42, v126 dst_sel:DWORD dst_unused:UNUSED_PAD src0_sel:DWORD src1_sel:WORD_0
s_waitcnt lgkmcnt(0)
s_waitcnt vmcnt(18)
v_smfmac_f32_16x16x64_bf16 v[76:79], a[72:75], v[44:51], v146
buffer_load_dwordx4 a[172:175], v112, s[24:27], s99 offen offset:3072 sc1
ds_read_b128 v[52:55], v0 offset:22656
ds_read_b128 v[56:59], v1 offset:22656
ds_read_u16 v68, v60 offset:18560
ds_read_u16 v60, v60
v_add_u32_sdwa v61, s42, v126 dst_sel:DWORD dst_unused:UNUSED_PAD src0_sel:DWORD src1_sel:WORD_1
v_smfmac_f32_16x16x64_bf16 v[80:83], a[76:79], v[44:51], v146 abid:1
ds_read_u16 v69, v61 offset:18560
ds_read_u16 v61, v61
v_add_u32_sdwa v62, s42, v127 dst_sel:DWORD dst_unused:UNUSED_PAD src0_sel:DWORD src1_sel:WORD_0
v_smfmac_f32_16x16x64_bf16 v[84:87], a[80:83], v[44:51], v147
s_mov_b32 s99, 45056
buffer_load_dwordx4 a[176:179], v112, s[24:27], s99 offen offset:0 sc1
ds_read_u16 v70, v62 offset:18560
ds_read_u16 v62, v62
v_add_u32_sdwa v63, s42, v127 dst_sel:DWORD dst_unused:UNUSED_PAD src0_sel:DWORD src1_sel:WORD_1
v_smfmac_f32_16x16x64_bf16 v[88:91], a[84:87], v[44:51], v147 abid:1
ds_read_u16 v71, v63 offset:18560
ds_read_u16 v63, v63
v_add_u32_sdwa v64, s42, v128 dst_sel:DWORD dst_unused:UNUSED_PAD src0_sel:DWORD src1_sel:WORD_0
v_smfmac_f32_16x16x64_bf16 v[92:95], a[88:91], v[44:51], v148
ds_read_u16 v72, v64 offset:18560
ds_read_u16 v64, v64
v_add_u32_sdwa v65, s42, v128 dst_sel:DWORD dst_unused:UNUSED_PAD src0_sel:DWORD src1_sel:WORD_1
v_smfmac_f32_16x16x64_bf16 v[96:99], a[92:95], v[44:51], v148 abid:1
s_mov_b32 s98, 5120
buffer_load_dwordx4 v[158:161], v113, s[24:27], s98 offen sc1
ds_read_u16 v73, v65 offset:18560
ds_read_u16 v65, v65
v_add_u32_sdwa v66, s42, v129 dst_sel:DWORD dst_unused:UNUSED_PAD src0_sel:DWORD src1_sel:WORD_0
v_smfmac_f32_16x16x64_bf16 v[100:103], a[96:99], v[44:51], v149
ds_read_u16 v74, v66 offset:18560
ds_read_u16 v66, v66
v_add_u32_sdwa v67, s42, v129 dst_sel:DWORD dst_unused:UNUSED_PAD src0_sel:DWORD src1_sel:WORD_1
v_smfmac_f32_16x16x64_bf16 v[104:107], a[100:103], v[44:51], v149 abid:1
buffer_load_dwordx4 a[180:183], v112, s[24:27], s99 offen offset:1024 sc1
ds_read_u16 v75, v67 offset:18560
ds_read_u16 v67, v67
v_smfmac_f32_16x16x64_bf16 v[108:111], a[104:107], v[44:51], v175
ds_read_b128 v[114:117], v2 offset:192
s_waitcnt lgkmcnt(15)
v_smfmac_f32_16x16x64_bf16 v[8:11], a[72:75], v[52:59], v146
buffer_load_dwordx4 a[184:187], v112, s[24:27], s99 offen offset:2048 sc1
ds_read_b128 v[44:47], v0 offset:6144
v_smfmac_f32_16x16x64_bf16 v[12:15], a[76:79], v[52:59], v146 abid:1
ds_read_b128 v[48:51], v1 offset:6144
v_smfmac_f32_16x16x64_bf16 v[16:19], a[80:83], v[52:59], v147
v_smfmac_f32_16x16x64_bf16 v[20:23], a[84:87], v[52:59], v147 abid:1
buffer_load_dwordx4 a[188:191], v112, s[24:27], s99 offen offset:3072 sc1
v_smfmac_f32_16x16x64_bf16 v[24:27], a[88:91], v[52:59], v148
v_smfmac_f32_16x16x64_bf16 v[28:31], a[92:95], v[52:59], v148 abid:1
s_mov_b32 s99, 49152
buffer_load_dwordx4 a[192:195], v112, s[24:27], s99 offen offset:0 sc1
v_smfmac_f32_16x16x64_bf16 v[32:35], a[96:99], v[52:59], v149
v_smfmac_f32_16x16x64_bf16 v[36:39], a[100:103], v[52:59], v149 abid:1
buffer_load_dwordx4 a[196:199], v112, s[24:27], s99 offen offset:1024 sc1
v_smfmac_f32_16x16x64_bf16 v[40:43], a[104:107], v[52:59], v175
s_waitcnt lgkmcnt(2)
v_smfmac_f32_16x16x64_bf16 v[20:23], v[114:117], v[68:75], v181 abid:1
v_smfmac_f32_16x16x64_bf16 v[24:27], v[114:117], v[68:75], v182
buffer_load_dwordx4 a[200:203], v112, s[24:27], s99 offen offset:2048 sc1
v_smfmac_f32_16x16x64_bf16 v[28:31], v[114:117], v[68:75], v182 abid:1
v_smfmac_f32_16x16x64_bf16 v[88:91], v[114:117], v[60:67], v181 abid:1
buffer_load_dwordx4 a[204:207], v112, s[24:27], s99 offen offset:3072 sc1
v_smfmac_f32_16x16x64_bf16 v[92:95], v[114:117], v[60:67], v182
v_smfmac_f32_16x16x64_bf16 v[96:99], v[114:117], v[60:67], v182 abid:1
s_mov_b32 s99, 53248
buffer_load_dwordx4 a[208:211], v112, s[24:27], s99 offen offset:0 sc1
v_add_u32_sdwa v60, s42, v130 dst_sel:DWORD dst_unused:UNUSED_PAD src0_sel:DWORD src1_sel:WORD_0
s_waitcnt lgkmcnt(0)
s_waitcnt vmcnt(18)
v_smfmac_f32_16x16x64_bf16 v[76:79], a[108:111], v[44:51], v150
ds_read_b128 v[52:55], v0 offset:24704
ds_read_b128 v[56:59], v1 offset:24704
ds_read_u16 v68, v60 offset:18560
ds_read_u16 v60, v60
v_add_u32_sdwa v61, s42, v130 dst_sel:DWORD dst_unused:UNUSED_PAD src0_sel:DWORD src1_sel:WORD_1
v_smfmac_f32_16x16x64_bf16 v[80:83], a[112:115], v[44:51], v150 abid:1
ds_read_u16 v69, v61 offset:18560
ds_read_u16 v61, v61
v_add_u32_sdwa v62, s42, v131 dst_sel:DWORD dst_unused:UNUSED_PAD src0_sel:DWORD src1_sel:WORD_0
v_smfmac_f32_16x16x64_bf16 v[84:87], a[116:119], v[44:51], v151
buffer_load_dwordx4 a[212:215], v112, s[24:27], s99 offen offset:1024 sc1
ds_read_u16 v70, v62 offset:18560
ds_read_u16 v62, v62
v_add_u32_sdwa v63, s42, v131 dst_sel:DWORD dst_unused:UNUSED_PAD src0_sel:DWORD src1_sel:WORD_1
v_smfmac_f32_16x16x64_bf16 v[88:91], a[120:123], v[44:51], v151 abid:1
ds_read_u16 v71, v63 offset:18560
ds_read_u16 v63, v63
v_add_u32_sdwa v64, s42, v132 dst_sel:DWORD dst_unused:UNUSED_PAD src0_sel:DWORD src1_sel:WORD_0
v_smfmac_f32_16x16x64_bf16 v[92:95], a[124:127], v[44:51], v152
s_mov_b32 s98, 6144
buffer_load_dwordx4 v[162:165], v113, s[24:27], s98 offen sc1
ds_read_u16 v72, v64 offset:18560
ds_read_u16 v64, v64
v_add_u32_sdwa v65, s42, v132 dst_sel:DWORD dst_unused:UNUSED_PAD src0_sel:DWORD src1_sel:WORD_1
v_smfmac_f32_16x16x64_bf16 v[96:99], a[128:131], v[44:51], v152 abid:1
ds_read_u16 v73, v65 offset:18560
ds_read_u16 v65, v65
v_add_u32_sdwa v66, s42, v133 dst_sel:DWORD dst_unused:UNUSED_PAD src0_sel:DWORD src1_sel:WORD_0
v_smfmac_f32_16x16x64_bf16 v[100:103], a[132:135], v[44:51], v153
buffer_load_dwordx4 a[216:219], v112, s[24:27], s99 offen offset:2048 sc1
ds_read_u16 v74, v66 offset:18560
ds_read_u16 v66, v66
v_add_u32_sdwa v67, s42, v133 dst_sel:DWORD dst_unused:UNUSED_PAD src0_sel:DWORD src1_sel:WORD_1
v_smfmac_f32_16x16x64_bf16 v[104:107], a[136:139], v[44:51], v153 abid:1
ds_read_u16 v75, v67 offset:18560
ds_read_u16 v67, v67
v_smfmac_f32_16x16x64_bf16 v[108:111], a[140:143], v[44:51], v175 abid:1
ds_read_b128 v[114:117], v2 offset:256
s_waitcnt lgkmcnt(15)
v_smfmac_f32_16x16x64_bf16 v[8:11], a[108:111], v[52:59], v150
buffer_load_dwordx4 a[220:223], v112, s[24:27], s99 offen offset:3072 sc1
ds_read_b128 v[44:47], v0 offset:8192
v_smfmac_f32_16x16x64_bf16 v[12:15], a[112:115], v[52:59], v150 abid:1
ds_read_b128 v[48:51], v1 offset:8192
v_smfmac_f32_16x16x64_bf16 v[16:19], a[116:119], v[52:59], v151
s_mov_b32 s99, 57344
buffer_load_dwordx4 a[224:227], v112, s[24:27], s99 offen offset:0 sc1
v_smfmac_f32_16x16x64_bf16 v[20:23], a[120:123], v[52:59], v151 abid:1
v_smfmac_f32_16x16x64_bf16 v[24:27], a[124:127], v[52:59], v152
buffer_load_dwordx4 a[228:231], v112, s[24:27], s99 offen offset:1024 sc1
v_smfmac_f32_16x16x64_bf16 v[28:31], a[128:131], v[52:59], v152 abid:1
v_smfmac_f32_16x16x64_bf16 v[32:35], a[132:135], v[52:59], v153
v_smfmac_f32_16x16x64_bf16 v[36:39], a[136:139], v[52:59], v153 abid:1
buffer_load_dwordx4 a[232:235], v112, s[24:27], s99 offen offset:2048 sc1
v_smfmac_f32_16x16x64_bf16 v[40:43], a[140:143], v[52:59], v175 abid:1
s_waitcnt lgkmcnt(2)
v_smfmac_f32_16x16x64_bf16 v[28:31], v[114:117], v[68:75], v183
buffer_load_dwordx4 a[236:239], v112, s[24:27], s99 offen offset:3072 sc1
v_smfmac_f32_16x16x64_bf16 v[32:35], v[114:117], v[68:75], v183 abid:1
v_smfmac_f32_16x16x64_bf16 v[36:39], v[114:117], v[68:75], v184
s_mov_b32 s99, 61440
buffer_load_dwordx4 a[240:243], v112, s[24:27], s99 offen offset:0 sc1
v_smfmac_f32_16x16x64_bf16 v[96:99], v[114:117], v[60:67], v183
v_smfmac_f32_16x16x64_bf16 v[100:103], v[114:117], v[60:67], v183 abid:1
v_smfmac_f32_16x16x64_bf16 v[104:107], v[114:117], v[60:67], v184
buffer_load_dwordx4 a[244:247], v112, s[24:27], s99 offen offset:1024 sc1
v_add_u32_sdwa v60, s42, v134 dst_sel:DWORD dst_unused:UNUSED_PAD src0_sel:DWORD src1_sel:WORD_0
s_waitcnt lgkmcnt(0)
s_waitcnt vmcnt(18)
v_smfmac_f32_16x16x64_bf16 v[76:79], a[144:147], v[44:51], v154
ds_read_b128 v[52:55], v0 offset:26752
ds_read_b128 v[56:59], v1 offset:26752
ds_read_u16 v68, v60 offset:18560
ds_read_u16 v60, v60
v_add_u32_sdwa v61, s42, v134 dst_sel:DWORD dst_unused:UNUSED_PAD src0_sel:DWORD src1_sel:WORD_1
v_smfmac_f32_16x16x64_bf16 v[80:83], a[148:151], v[44:51], v154 abid:1
buffer_load_dwordx4 a[248:251], v112, s[24:27], s99 offen offset:2048 sc1
ds_read_u16 v69, v61 offset:18560
ds_read_u16 v61, v61
v_add_u32_sdwa v62, s42, v135 dst_sel:DWORD dst_unused:UNUSED_PAD src0_sel:DWORD src1_sel:WORD_0
v_smfmac_f32_16x16x64_bf16 v[84:87], a[152:155], v[44:51], v155
ds_read_u16 v70, v62 offset:18560
ds_read_u16 v62, v62
v_add_u32_sdwa v63, s42, v135 dst_sel:DWORD dst_unused:UNUSED_PAD src0_sel:DWORD src1_sel:WORD_1
v_smfmac_f32_16x16x64_bf16 v[88:91], a[156:159], v[44:51], v155 abid:1
s_mov_b32 s98, 7168
buffer_load_dwordx4 v[166:169], v113, s[24:27], s98 offen sc1
ds_read_u16 v71, v63 offset:18560
ds_read_u16 v63, v63
v_add_u32_sdwa v64, s42, v136 dst_sel:DWORD dst_unused:UNUSED_PAD src0_sel:DWORD src1_sel:WORD_0
v_smfmac_f32_16x16x64_bf16 v[92:95], a[160:163], v[44:51], v156
ds_read_u16 v72, v64 offset:18560
ds_read_u16 v64, v64
v_add_u32_sdwa v65, s42, v136 dst_sel:DWORD dst_unused:UNUSED_PAD src0_sel:DWORD src1_sel:WORD_1
v_smfmac_f32_16x16x64_bf16 v[96:99], a[164:167], v[44:51], v156 abid:1
ds_read_u16 v73, v65 offset:18560
ds_read_u16 v65, v65
v_add_u32_sdwa v66, s42, v137 dst_sel:DWORD dst_unused:UNUSED_PAD src0_sel:DWORD src1_sel:WORD_0
v_smfmac_f32_16x16x64_bf16 v[100:103], a[168:171], v[44:51], v157
s_mov_b32 s98, 8192
buffer_load_dwordx4 v[170:173], v113, s[24:27], s98 offen sc1
ds_read_u16 v74, v66 offset:18560
ds_read_u16 v66, v66
v_add_u32_sdwa v67, s42, v137 dst_sel:DWORD dst_unused:UNUSED_PAD src0_sel:DWORD src1_sel:WORD_1
v_smfmac_f32_16x16x64_bf16 v[104:107], a[172:175], v[44:51], v157 abid:1
ds_read_u16 v75, v67 offset:18560
ds_read_u16 v67, v67
v_smfmac_f32_16x16x64_bf16 v[108:111], a[176:179], v[44:51], v176
s_mov_b32 s99, 69632
buffer_load_dwordx4 v[214:217], v112, s[24:27], s99 offen offset:3072 sc1
ds_read_b128 v[114:117], v2 offset:320
s_waitcnt lgkmcnt(15)
v_smfmac_f32_16x16x64_bf16 v[8:11], a[144:147], v[52:59], v154
ds_read_b128 v[44:47], v0 offset:10240
v_smfmac_f32_16x16x64_bf16 v[12:15], a[148:151], v[52:59], v154 abid:1
s_mov_b32 s99, 81920
buffer_load_dwordx4 v[250:253], v112, s[24:27], s99 offen offset:0 sc1
ds_read_b128 v[48:51], v1 offset:10240
v_smfmac_f32_16x16x64_bf16 v[16:19], a[152:155], v[52:59], v155
v_smfmac_f32_16x16x64_bf16 v[20:23], a[156:159], v[52:59], v155 abid:1
v_smfmac_f32_16x16x64_bf16 v[24:27], a[160:163], v[52:59], v156
s_mov_b32 s99, 61440
buffer_load_dwordx4 a[252:255], v112, s[24:27], s99 offen offset:3072 sc1
v_smfmac_f32_16x16x64_bf16 v[28:31], a[164:167], v[52:59], v156 abid:1
v_smfmac_f32_16x16x64_bf16 v[32:35], a[168:171], v[52:59], v157
s_mov_b32 s99, 73728
buffer_load_dwordx4 v[218:221], v112, s[24:27], s99 offen offset:0 sc1
v_smfmac_f32_16x16x64_bf16 v[36:39], a[172:175], v[52:59], v157 abid:1
v_smfmac_f32_16x16x64_bf16 v[40:43], a[176:179], v[52:59], v176
s_mov_b32 s99, 65536
buffer_load_dwordx4 v[186:189], v112, s[24:27], s99 offen offset:0 sc1
s_waitcnt lgkmcnt(2)
v_smfmac_f32_16x16x64_bf16 v[36:39], v[114:117], v[68:75], v184 abid:1
v_smfmac_f32_16x16x64_bf16 v[40:43], v[114:117], v[68:75], v185
v_smfmac_f32_16x16x64_bf16 v[104:107], v[114:117], v[60:67], v184 abid:1
s_mov_b32 s99, 73728
buffer_load_dwordx4 v[222:225], v112, s[24:27], s99 offen offset:1024 sc1
v_smfmac_f32_16x16x64_bf16 v[108:111], v[114:117], v[60:67], v185
s_waitcnt lgkmcnt(0)
s_waitcnt vmcnt(18)
v_smfmac_f32_16x16x64_bf16 v[76:79], a[180:183], v[44:51], v158
s_mov_b32 s99, 65536
buffer_load_dwordx4 v[190:193], v112, s[24:27], s99 offen offset:1024 sc1
ds_read_b128 v[52:55], v0 offset:28800
ds_read_b128 v[56:59], v1 offset:28800
v_smfmac_f32_16x16x64_bf16 v[80:83], a[184:187], v[44:51], v158 abid:1
v_smfmac_f32_16x16x64_bf16 v[84:87], a[188:191], v[44:51], v159
s_mov_b32 s99, 73728
buffer_load_dwordx4 v[226:229], v112, s[24:27], s99 offen offset:2048 sc1
ds_read_b128 v[60:63], v0 offset:32896
v_smfmac_f32_16x16x64_bf16 v[88:91], a[192:195], v[44:51], v159 abid:1
ds_read_b128 v[64:67], v1 offset:32896
v_smfmac_f32_16x16x64_bf16 v[92:95], a[196:199], v[44:51], v160
v_smfmac_f32_16x16x64_bf16 v[96:99], a[200:203], v[44:51], v160 abid:1
s_mov_b32 s99, 65536
buffer_load_dwordx4 v[194:197], v112, s[24:27], s99 offen offset:2048 sc1
v_smfmac_f32_16x16x64_bf16 v[100:103], a[204:207], v[44:51], v161
v_smfmac_f32_16x16x64_bf16 v[104:107], a[208:211], v[44:51], v161 abid:1
s_mov_b32 s99, 73728
buffer_load_dwordx4 v[230:233], v112, s[24:27], s99 offen offset:3072 sc1
v_smfmac_f32_16x16x64_bf16 v[108:111], a[212:215], v[44:51], v176 abid:1
s_waitcnt lgkmcnt(2)
v_smfmac_f32_16x16x64_bf16 v[8:11], a[180:183], v[52:59], v158
s_mov_b32 s99, 65536
buffer_load_dwordx4 v[198:201], v112, s[24:27], s99 offen offset:3072 sc1
ds_read_b128 v[44:47], v0 offset:12288
v_smfmac_f32_16x16x64_bf16 v[12:15], a[184:187], v[52:59], v158 abid:1
ds_read_b128 v[48:51], v1 offset:12288
v_smfmac_f32_16x16x64_bf16 v[16:19], a[188:191], v[52:59], v159
v_smfmac_f32_16x16x64_bf16 v[20:23], a[192:195], v[52:59], v159 abid:1
s_mov_b32 s99, 77824
buffer_load_dwordx4 v[234:237], v112, s[24:27], s99 offen offset:0 sc1
v_smfmac_f32_16x16x64_bf16 v[24:27], a[196:199], v[52:59], v160
v_smfmac_f32_16x16x64_bf16 v[28:31], a[200:203], v[52:59], v160 abid:1
s_mov_b32 s99, 69632
buffer_load_dwordx4 v[202:205], v112, s[24:27], s99 offen offset:0 sc1
v_smfmac_f32_16x16x64_bf16 v[32:35], a[204:207], v[52:59], v161
v_smfmac_f32_16x16x64_bf16 v[36:39], a[208:211], v[52:59], v161 abid:1
s_mov_b32 s99, 77824
buffer_load_dwordx4 v[238:241], v112, s[24:27], s99 offen offset:1024 sc1
v_smfmac_f32_16x16x64_bf16 v[40:43], a[212:215], v[52:59], v176 abid:1
s_waitcnt lgkmcnt(0)
s_waitcnt vmcnt(18)
v_smfmac_f32_16x16x64_bf16 v[76:79], a[216:219], v[44:51], v162
ds_read_b128 v[52:55], v0 offset:30848
ds_read_b128 v[56:59], v1 offset:30848
v_smfmac_f32_16x16x64_bf16 v[80:83], a[220:223], v[44:51], v162 abid:1
s_mov_b32 s99, 69632
buffer_load_dwordx4 v[206:209], v112, s[24:27], s99 offen offset:1024 sc1
v_smfmac_f32_16x16x64_bf16 v[84:87], a[224:227], v[44:51], v163
ds_read_b128 v[68:71], v0 offset:34944
v_smfmac_f32_16x16x64_bf16 v[88:91], a[228:231], v[44:51], v163 abid:1
s_mov_b32 s99, 77824
buffer_load_dwordx4 v[242:245], v112, s[24:27], s99 offen offset:2048 sc1
ds_read_b128 v[72:75], v1 offset:34944
v_smfmac_f32_16x16x64_bf16 v[92:95], a[232:235], v[44:51], v164
v_smfmac_f32_16x16x64_bf16 v[96:99], a[236:239], v[44:51], v164 abid:1
s_mov_b32 s99, 69632
buffer_load_dwordx4 v[210:213], v112, s[24:27], s99 offen offset:2048 sc1
v_smfmac_f32_16x16x64_bf16 v[100:103], a[240:243], v[44:51], v165
s_waitcnt vmcnt(18)
v_smfmac_f32_16x16x64_bf16 v[104:107], a[244:247], v[44:51], v165 abid:1
v_smfmac_f32_16x16x64_bf16 v[108:111], a[248:251], v[44:51], v177
s_mov_b32 s99, 77824
buffer_load_dwordx4 v[246:249], v112, s[24:27], s99 offen offset:3072 sc1
s_waitcnt lgkmcnt(2)
v_smfmac_f32_16x16x64_bf16 v[8:11], a[216:219], v[52:59], v162
ds_read_b128 v[44:47], v0 offset:14336
v_smfmac_f32_16x16x64_bf16 v[12:15], a[220:223], v[52:59], v162 abid:1
ds_read_b128 v[48:51], v1 offset:14336
v_smfmac_f32_16x16x64_bf16 v[16:19], a[224:227], v[52:59], v163
v_smfmac_f32_16x16x64_bf16 v[20:23], a[228:231], v[52:59], v163 abid:1
v_smfmac_f32_16x16x64_bf16 v[24:27], a[232:235], v[52:59], v164
v_smfmac_f32_16x16x64_bf16 v[28:31], a[236:239], v[52:59], v164 abid:1
v_smfmac_f32_16x16x64_bf16 v[32:35], a[240:243], v[52:59], v165
v_smfmac_f32_16x16x64_bf16 v[36:39], a[244:247], v[52:59], v165 abid:1
v_smfmac_f32_16x16x64_bf16 v[40:43], a[248:251], v[52:59], v177
ds_read_b128 v[52:55], v0 offset:16384
ds_read_b128 v[56:59], v1 offset:16384
s_waitcnt lgkmcnt(2)
s_waitcnt vmcnt(17)
v_smfmac_f32_16x16x64_bf16 v[108:111], v[214:217], v[44:51], v177 abid:1
s_waitcnt lgkmcnt(0)
s_waitcnt vmcnt(16)
v_smfmac_f32_16x16x64_bf16 v[108:111], v[250:253], v[52:59], v178
v_add_u32 v0, 37120, v0
v_add_u32 v1, 37120, v1
s_waitcnt vmcnt(15)
v_smfmac_f32_16x16x64_bf16 v[76:79], a[252:255], v[44:51], v166
s_waitcnt vmcnt(14)
v_smfmac_f32_16x16x64_bf16 v[76:79], v[218:221], v[52:59], v170
s_nop 1
v_cvt_pk_bf16_f32 v108, v108, v109
v_cvt_pk_bf16_f32 v109, v110, v111
ds_bpermute_b32 v108, v6, v108
ds_bpermute_b32 v109, v6, v109
s_waitcnt vmcnt(13)
v_smfmac_f32_16x16x64_bf16 v[80:83], v[186:189], v[44:51], v166 abid:1
s_waitcnt vmcnt(12)
v_smfmac_f32_16x16x64_bf16 v[80:83], v[222:225], v[52:59], v170 abid:1
v_cvt_pk_bf16_f32 v76, v76, v77
v_cvt_pk_bf16_f32 v77, v78, v79
s_waitcnt vmcnt(11)
v_smfmac_f32_16x16x64_bf16 v[84:87], v[190:193], v[44:51], v167
s_waitcnt vmcnt(10)
v_smfmac_f32_16x16x64_bf16 v[84:87], v[226:229], v[52:59], v171
s_nop 1
v_cvt_pk_bf16_f32 v78, v80, v81
v_cvt_pk_bf16_f32 v79, v82, v83
s_waitcnt lgkmcnt(0)
buffer_store_dwordx2 v[108:109], v5, s[20:23], s46 offen
s_waitcnt vmcnt(10)
v_smfmac_f32_16x16x64_bf16 v[88:91], v[194:197], v[44:51], v167 abid:1
s_waitcnt vmcnt(9)
v_smfmac_f32_16x16x64_bf16 v[88:91], v[230:233], v[52:59], v171 abid:1
v_cvt_pk_bf16_f32 v80, v84, v85
v_cvt_pk_bf16_f32 v81, v86, v87
s_waitcnt vmcnt(8)
v_smfmac_f32_16x16x64_bf16 v[92:95], v[198:201], v[44:51], v168
s_waitcnt vmcnt(7)
v_smfmac_f32_16x16x64_bf16 v[92:95], v[234:237], v[52:59], v172
s_nop 1
v_cvt_pk_bf16_f32 v82, v88, v89
v_cvt_pk_bf16_f32 v83, v90, v91
v_cndmask_b32_dpp v114, v80, v76, vcc quad_perm:[1,0,3,2] row_mask:0xf bank_mask:0xf
v_cndmask_b32_dpp v115, v81, v77, vcc quad_perm:[1,0,3,2] row_mask:0xf bank_mask:0xf
v_cndmask_b32_dpp v116, v82, v78, vcc quad_perm:[1,0,3,2] row_mask:0xf bank_mask:0xf
v_cndmask_b32_dpp v117, v83, v79, vcc quad_perm:[1,0,3,2] row_mask:0xf bank_mask:0xf
buffer_store_dwordx4 v[114:117], v4, s[20:23], s46 offen offset:0 sc1
s_mov_b64 vcc, s[82:83]
s_waitcnt vmcnt(7)
v_smfmac_f32_16x16x64_bf16 v[96:99], v[202:205], v[44:51], v168 abid:1
s_waitcnt vmcnt(6)
v_smfmac_f32_16x16x64_bf16 v[96:99], v[238:241], v[52:59], v172 abid:1
v_cvt_pk_bf16_f32 v84, v92, v93
v_cvt_pk_bf16_f32 v85, v94, v95
v_cndmask_b32_dpp v80, v76, v80, vcc quad_perm:[1,0,3,2] row_mask:0xf bank_mask:0xf
v_cndmask_b32_dpp v81, v77, v81, vcc quad_perm:[1,0,3,2] row_mask:0xf bank_mask:0xf
v_cndmask_b32_dpp v82, v78, v82, vcc quad_perm:[1,0,3,2] row_mask:0xf bank_mask:0xf
v_cndmask_b32_dpp v83, v79, v83, vcc quad_perm:[1,0,3,2] row_mask:0xf bank_mask:0xf
buffer_store_dwordx4 v[80:83], v4, s[20:23], s46 offen offset:1152 sc1
s_mov_b64 vcc, s[80:81]
s_waitcnt vmcnt(6)
v_smfmac_f32_16x16x64_bf16 v[100:103], v[206:209], v[44:51], v169
s_waitcnt vmcnt(5)
v_smfmac_f32_16x16x64_bf16 v[100:103], v[242:245], v[52:59], v173
v_cvt_pk_bf16_f32 v86, v96, v97
v_cvt_pk_bf16_f32 v87, v98, v99
v_add_u32_sdwa v76, s4, v118 dst_sel:DWORD dst_unused:UNUSED_PAD src0_sel:DWORD src1_sel:WORD_0
v_add_u32_sdwa v77, s4, v118 dst_sel:DWORD dst_unused:UNUSED_PAD src0_sel:DWORD src1_sel:WORD_1
v_add_u32_sdwa v78, s4, v119 dst_sel:DWORD dst_unused:UNUSED_PAD src0_sel:DWORD src1_sel:WORD_0
v_add_u32_sdwa v79, s4, v119 dst_sel:DWORD dst_unused:UNUSED_PAD src0_sel:DWORD src1_sel:WORD_1
s_waitcnt vmcnt(4)
v_smfmac_f32_16x16x64_bf16 v[104:107], v[210:213], v[44:51], v169 abid:1
s_waitcnt vmcnt(3)
v_smfmac_f32_16x16x64_bf16 v[104:107], v[246:249], v[52:59], v173 abid:1
v_cvt_pk_bf16_f32 v88, v100, v101
v_cvt_pk_bf16_f32 v89, v102, v103
v_add_u32_sdwa v80, s4, v120 dst_sel:DWORD dst_unused:UNUSED_PAD src0_sel:DWORD src1_sel:WORD_0
v_add_u32_sdwa v81, s4, v120 dst_sel:DWORD dst_unused:UNUSED_PAD src0_sel:DWORD src1_sel:WORD_1
v_add_u32_sdwa v82, s4, v121 dst_sel:DWORD dst_unused:UNUSED_PAD src0_sel:DWORD src1_sel:WORD_0
v_add_u32_sdwa v83, s4, v121 dst_sel:DWORD dst_unused:UNUSED_PAD src0_sel:DWORD src1_sel:WORD_1
s_nop 1
v_cvt_pk_bf16_f32 v90, v104, v105
v_cvt_pk_bf16_f32 v91, v106, v107
v_cndmask_b32_dpp v92, v88, v84, vcc quad_perm:[1,0,3,2] row_mask:0xf bank_mask:0xf
v_cndmask_b32_dpp v93, v89, v85, vcc quad_perm:[1,0,3,2] row_mask:0xf bank_mask:0xf
v_cndmask_b32_dpp v94, v90, v86, vcc quad_perm:[1,0,3,2] row_mask:0xf bank_mask:0xf
v_cndmask_b32_dpp v95, v91, v87, vcc quad_perm:[1,0,3,2] row_mask:0xf bank_mask:0xf
buffer_store_dwordx4 v[92:95], v4, s[20:23], s46 offen offset:128 sc1
s_mov_b64 vcc, s[82:83]
v_cndmask_b32_dpp v88, v84, v88, vcc quad_perm:[1,0,3,2] row_mask:0xf bank_mask:0xf
v_cndmask_b32_dpp v89, v85, v89, vcc quad_perm:[1,0,3,2] row_mask:0xf bank_mask:0xf
v_cndmask_b32_dpp v90, v86, v90, vcc quad_perm:[1,0,3,2] row_mask:0xf bank_mask:0xf
v_cndmask_b32_dpp v91, v87, v91, vcc quad_perm:[1,0,3,2] row_mask:0xf bank_mask:0xf
buffer_store_dwordx4 v[88:91], v4, s[20:23], s46 offen offset:1280 sc1
s_mov_b64 vcc, s[80:81]
s_bfe_u32 s88, s85, 0x40018
s_cbranch_scc0 L_pf2_e
L_pf2:
s_add_u32 m0, s44, 0
s_nop 0
buffer_load_dwordx4 v3, s[16:19], s45 offen offset:0 nt lds
s_add_u32 m0, s44, 3840
s_nop 0
buffer_load_dwordx4 v3, s[16:19], s45 offen offset:256 nt lds
s_add_u32 m0, s44, 7680
s_nop 0
buffer_load_dwordx4 v3, s[16:19], s45 offen offset:512 nt lds
s_add_u32 m0, s44, 11520
s_nop 0
buffer_load_dwordx4 v3, s[16:19], s45 offen offset:768 nt lds
s_add_u32 m0, s44, s8
s_mov_b64 exec, s[10:11]
buffer_load_dwordx4 v3, s[16:19], s7 offen offset:896 nt lds
s_mov_b64 exec, -1
s_add_u32 s7, s7, s13
s_add_u32 s44, s44, 18560
s_add_u32 s45, s45, s13
s_mov_b32 s13, 4718592
s_sub_u32 s88, s88, 1
s_cmp_lg_u32 s88, 0
s_cbranch_scc1 L_pf2
L_pf2_e:
s_cmp_ge_u32 s44, 148480
s_cselect_b32 s44, s9, s44
s_add_u32 s46, s46, 4718592
s_waitcnt lgkmcnt(0)
s_barrier
s_cmp_lg_u32 s89, 0
s_cbranch_scc1 L_loopnk_p3
s_branch L_loopn_p3
.p2align 6
L_loop:
v_smfmac_f32_16x16x64_bf16 v[8:11], a[0:3], v[44:51], v138
ds_read_b128 v[32:35], v2 offset:1408
v_cvt_pk_bf16_f32 v106, v36, v37
v_smfmac_f32_16x16x64_bf16 v[8:11], a[36:39], v[52:59], v142
s_waitcnt lgkmcnt(9)
v_cvt_pk_bf16_f32 v107, v38, v39
v_smfmac_f32_16x16x64_bf16 v[12:15], a[4:7], v[44:51], v138 abid:1
ds_read_b128 v[36:39], v2 offset:1472
v_cvt_pk_bf16_f32 v112, v40, v41
v_smfmac_f32_16x16x64_bf16 v[12:15], a[40:43], v[52:59], v142 abid:1
s_waitcnt lgkmcnt(8)
ds_read_b128 v[60:63], v0 offset:4096
v_cvt_pk_bf16_f32 v113, v42, v43
v_smfmac_f32_16x16x64_bf16 v[16:19], a[8:11], v[44:51], v139
s_cmp_eq_u32 s4, 129920
ds_read_b128 v[40:43], v2 offset:1536
v_cndmask_b32_dpp v108, v96, v92, vcc quad_perm:[1,0,3,2] row_mask:0xf bank_mask:0xf
v_smfmac_f32_16x16x64_bf16 v[16:19], a[44:47], v[52:59], v143
s_waitcnt lgkmcnt(8)
ds_read_u16 v82, v82
v_cndmask_b32_dpp v109, v97, v93, vcc quad_perm:[1,0,3,2] row_mask:0xf bank_mask:0xf
v_smfmac_f32_16x16x64_bf16 v[20:23], a[12:15], v[44:51], v139 abid:1
s_cselect_b32 s43, -129920, s5
ds_read_u16 v84, v84
v_cndmask_b32_dpp v110, v98, v94, vcc quad_perm:[1,0,3,2] row_mask:0xf bank_mask:0xf
v_smfmac_f32_16x16x64_bf16 v[20:23], a[48:51], v[52:59], v143 abid:1
s_waitcnt lgkmcnt(8)
ds_read_b128 v[64:67], v1 offset:4096
v_cndmask_b32_dpp v111, v99, v95, vcc quad_perm:[1,0,3,2] row_mask:0xf bank_mask:0xf
v_smfmac_f32_16x16x64_bf16 v[24:27], a[16:19], v[44:51], v140
s_add_u32 s4, s4, s43
ds_read_b128 v[68:71], v0 offset:6144
v_add_u32_sdwa v87, s42, v123 dst_sel:DWORD dst_unused:UNUSED_PAD src0_sel:DWORD src1_sel:WORD_1
v_smfmac_f32_16x16x64_bf16 v[24:27], a[52:55], v[52:59], v144
buffer_store_dwordx4 v[108:111], v4, s[20:23], s46 offen offset:0 sc1
s_mov_b64 vcc, s[82:83]
s_waitcnt lgkmcnt(8)
ds_read_b128 v[72:75], v1 offset:6144
v_cndmask_b32_dpp v96, v92, v96, vcc quad_perm:[1,0,3,2] row_mask:0xf bank_mask:0xf
v_cndmask_b32_dpp v97, v93, v97, vcc quad_perm:[1,0,3,2] row_mask:0xf bank_mask:0xf
v_smfmac_f32_16x16x64_bf16 v[28:31], a[20:23], v[44:51], v140 abid:1
s_add_u32 s41, s41, 1
ds_read_u16 v83, v83
v_cndmask_b32_dpp v98, v94, v98, vcc quad_perm:[1,0,3,2] row_mask:0xf bank_mask:0xf
v_smfmac_f32_16x16x64_bf16 v[28:31], a[56:59], v[52:59], v144 abid:1
s_waitcnt lgkmcnt(9)
ds_read_b128 v[114:117], v2 offset:64
v_cndmask_b32_dpp v99, v95, v99, vcc quad_perm:[1,0,3,2] row_mask:0xf bank_mask:0xf
v_smfmac_f32_16x16x64_bf16 v[32:35], a[24:27], v[44:51], v141
ds_read_u16 v85, v85
v_add_u32_sdwa v88, s42, v124 dst_sel:DWORD dst_unused:UNUSED_PAD src0_sel:DWORD src1_sel:WORD_0
v_smfmac_f32_16x16x64_bf16 v[32:35], a[60:63], v[52:59], v145
s_waitcnt lgkmcnt(10)
ds_read_u16 v86, v86
v_add_u32_sdwa v89, s42, v124 dst_sel:DWORD dst_unused:UNUSED_PAD src0_sel:DWORD src1_sel:WORD_1
v_smfmac_f32_16x16x64_bf16 v[36:39], a[28:31], v[44:51], v141 abid:1
ds_read_u16 v87, v87
v_add_u32_sdwa v90, s42, v125 dst_sel:DWORD dst_unused:UNUSED_PAD src0_sel:DWORD src1_sel:WORD_0
v_smfmac_f32_16x16x64_bf16 v[36:39], a[64:67], v[52:59], v145 abid:1
s_waitcnt lgkmcnt(10)
ds_read_u16 v88, v88
v_add_u32_sdwa v91, s42, v125 dst_sel:DWORD dst_unused:UNUSED_PAD src0_sel:DWORD src1_sel:WORD_1
v_smfmac_f32_16x16x64_bf16 v[40:43], a[32:35], v[44:51], v174
buffer_store_dwordx4 v[96:99], v4, s[20:23], s46 offen offset:1152 sc1
s_mov_b64 vcc, s[80:81]
ds_read_u16 v89, v89
v_cndmask_b32_dpp v92, v104, v100, vcc quad_perm:[1,0,3,2] row_mask:0xf bank_mask:0xf
v_cndmask_b32_dpp v93, v105, v101, vcc quad_perm:[1,0,3,2] row_mask:0xf bank_mask:0xf
v_smfmac_f32_16x16x64_bf16 v[40:43], a[68:71], v[52:59], v174 abid:1
s_waitcnt lgkmcnt(9)
ds_read_u16 v90, v90
v_cndmask_b32_dpp v94, v106, v102, vcc quad_perm:[1,0,3,2] row_mask:0xf bank_mask:0xf
v_smfmac_f32_16x16x64_bf16 v[8:11], a[72:75], v[60:67], v146
s_waitcnt lgkmcnt(8)
ds_read_u16 v91, v91
v_cndmask_b32_dpp v95, v107, v103, vcc quad_perm:[1,0,3,2] row_mask:0xf bank_mask:0xf
v_smfmac_f32_16x16x64_bf16 v[8:11], a[108:111], v[68:75], v150
s_waitcnt lgkmcnt(7)
ds_bpermute_b32 v112, v6, v112
v_smfmac_f32_16x16x64_bf16 v[8:11], v[114:117], v[76:83], v179
ds_bpermute_b32 v113, v6, v113
v_smfmac_f32_16x16x64_bf16 v[12:15], v[114:117], v[76:83], v179 abid:1
ds_read_b128 v[114:117], v2 offset:128
v_add_u32_sdwa v76, s42, v126 dst_sel:DWORD dst_unused:UNUSED_PAD src0_sel:DWORD src1_sel:WORD_0
v_smfmac_f32_16x16x64_bf16 v[12:15], a[76:79], v[60:67], v146 abid:1
ds_read_u16 v76, v76
v_add_u32_sdwa v77, s42, v126 dst_sel:DWORD dst_unused:UNUSED_PAD src0_sel:DWORD src1_sel:WORD_1
v_smfmac_f32_16x16x64_bf16 v[12:15], a[112:115], v[68:75], v150 abid:1
buffer_store_dwordx4 v[92:95], v4, s[20:23], s46 offen offset:128 sc1
s_mov_b64 vcc, s[82:83]
ds_read_u16 v77, v77
v_cndmask_b32_dpp v104, v100, v104, vcc quad_perm:[1,0,3,2] row_mask:0xf bank_mask:0xf
v_add_u32_sdwa v78, s42, v127 dst_sel:DWORD dst_unused:UNUSED_PAD src0_sel:DWORD src1_sel:WORD_0
v_smfmac_f32_16x16x64_bf16 v[24:27], a[88:91], v[60:67], v148
ds_read_u16 v78, v78
v_cndmask_b32_dpp v105, v101, v105, vcc quad_perm:[1,0,3,2] row_mask:0xf bank_mask:0xf
v_smfmac_f32_16x16x64_bf16 v[24:27], a[124:127], v[68:75], v152
ds_read_b128 v[44:47], v0 offset:8192
v_cndmask_b32_dpp v106, v102, v106, vcc quad_perm:[1,0,3,2] row_mask:0xf bank_mask:0xf
v_smfmac_f32_16x16x64_bf16 v[28:31], a[92:95], v[60:67], v148 abid:1
ds_read_b128 v[48:51], v1 offset:8192
v_add_u32_sdwa v79, s42, v127 dst_sel:DWORD dst_unused:UNUSED_PAD src0_sel:DWORD src1_sel:WORD_1
v_smfmac_f32_16x16x64_bf16 v[28:31], a[128:131], v[68:75], v152 abid:1
ds_read_u16 v79, v79
v_cndmask_b32_dpp v107, v103, v107, vcc quad_perm:[1,0,3,2] row_mask:0xf bank_mask:0xf
v_smfmac_f32_16x16x64_bf16 v[32:35], a[96:99], v[60:67], v149
ds_read_b128 v[52:55], v0 offset:10240
v_add_u32_sdwa v80, s42, v128 dst_sel:DWORD dst_unused:UNUSED_PAD src0_sel:DWORD src1_sel:WORD_0
v_smfmac_f32_16x16x64_bf16 v[32:35], a[132:135], v[68:75], v153
ds_read_u16 v80, v80
v_add_u32_sdwa v81, s42, v128 dst_sel:DWORD dst_unused:UNUSED_PAD src0_sel:DWORD src1_sel:WORD_1
v_smfmac_f32_16x16x64_bf16 v[16:19], a[80:83], v[60:67], v147
buffer_store_dwordx4 v[104:107], v4, s[20:23], s46 offen offset:1280 sc1
s_mov_b64 vcc, s[80:81]
ds_read_b128 v[56:59], v1 offset:10240
v_add_u32_sdwa v82, s42, v129 dst_sel:DWORD dst_unused:UNUSED_PAD src0_sel:DWORD src1_sel:WORD_0
v_add_u32_sdwa v83, s42, v129 dst_sel:DWORD dst_unused:UNUSED_PAD src0_sel:DWORD src1_sel:WORD_1
v_smfmac_f32_16x16x64_bf16 v[16:19], a[116:119], v[68:75], v151
s_waitcnt lgkmcnt(9)
ds_read_b128 v[92:95], v0 offset:12288
v_add_u32_sdwa v100, s42, v130 dst_sel:DWORD dst_unused:UNUSED_PAD src0_sel:DWORD src1_sel:WORD_0
v_smfmac_f32_16x16x64_bf16 v[16:19], v[114:117], v[84:91], v180 abid:1
ds_read_u16 v81, v81
v_add_u32_sdwa v101, s42, v130 dst_sel:DWORD dst_unused:UNUSED_PAD src0_sel:DWORD src1_sel:WORD_1
v_smfmac_f32_16x16x64_bf16 v[20:23], v[114:117], v[84:91], v181
ds_read_b128 v[96:99], v1 offset:12288
v_add_u32_sdwa v102, s42, v131 dst_sel:DWORD dst_unused:UNUSED_PAD src0_sel:DWORD src1_sel:WORD_0
v_smfmac_f32_16x16x64_bf16 v[20:23], a[84:87], v[60:67], v147 abid:1
ds_read_u16 v100, v100
v_add_u32_sdwa v103, s42, v131 dst_sel:DWORD dst_unused:UNUSED_PAD src0_sel:DWORD src1_sel:WORD_1
v_smfmac_f32_16x16x64_bf16 v[20:23], a[120:123], v[68:75], v151 abid:1
ds_read_u16 v82, v82
v_add_u32_sdwa v104, s42, v132 dst_sel:DWORD dst_unused:UNUSED_PAD src0_sel:DWORD src1_sel:WORD_0
v_smfmac_f32_16x16x64_bf16 v[36:39], a[100:103], v[60:67], v149 abid:1
ds_read_u16 v101, v101
v_add_u32_sdwa v105, s42, v132 dst_sel:DWORD dst_unused:UNUSED_PAD src0_sel:DWORD src1_sel:WORD_1
v_smfmac_f32_16x16x64_bf16 v[36:39], a[136:139], v[68:75], v153 abid:1
buffer_store_dwordx2 v[112:113], v5, s[20:23], s46 offen
ds_read_u16 v83, v83
v_add_u32_sdwa v106, s42, v133 dst_sel:DWORD dst_unused:UNUSED_PAD src0_sel:DWORD src1_sel:WORD_0
v_smfmac_f32_16x16x64_bf16 v[40:43], a[104:107], v[60:67], v175
s_mov_b32 s22, 75497472
ds_read_b128 v[114:117], v2 offset:192
v_add_u32_sdwa v107, s42, v133 dst_sel:DWORD dst_unused:UNUSED_PAD src0_sel:DWORD src1_sel:WORD_1
v_smfmac_f32_16x16x64_bf16 v[40:43], a[140:143], v[68:75], v175 abid:1
s_waitcnt lgkmcnt(12)
ds_read_u16 v102, v102
v_add_u32_sdwa v84, s42, v134 dst_sel:DWORD dst_unused:UNUSED_PAD src0_sel:DWORD src1_sel:WORD_0
v_smfmac_f32_16x16x64_bf16 v[8:11], a[144:147], v[44:51], v154
s_waitcnt lgkmcnt(9)
ds_read_u16 v103, v103
v_add_u32_sdwa v85, s42, v134 dst_sel:DWORD dst_unused:UNUSED_PAD src0_sel:DWORD src1_sel:WORD_1
v_smfmac_f32_16x16x64_bf16 v[8:11], a[180:183], v[52:59], v158
s_waitcnt lgkmcnt(7)
ds_read_u16 v104, v104
v_add_u32_sdwa v86, s42, v135 dst_sel:DWORD dst_unused:UNUSED_PAD src0_sel:DWORD src1_sel:WORD_0
v_smfmac_f32_16x16x64_bf16 v[8:11], a[216:219], v[92:99], v162
s_mov_b32 s46, s48
ds_read_u16 v105, v105
v_add_u32_sdwa v87, s42, v135 dst_sel:DWORD dst_unused:UNUSED_PAD src0_sel:DWORD src1_sel:WORD_1
v_smfmac_f32_16x16x64_bf16 v[24:27], a[160:163], v[44:51], v156
s_add_u32 m0, s44, 0
ds_read_u16 v106, v106
v_add_u32_sdwa v88, s42, v136 dst_sel:DWORD dst_unused:UNUSED_PAD src0_sel:DWORD src1_sel:WORD_0
v_smfmac_f32_16x16x64_bf16 v[24:27], a[196:199], v[52:59], v160
buffer_load_dwordx4 v3, s[16:19], s45 offen offset:0 nt lds
v_add_u32_sdwa v89, s42, v136 dst_sel:DWORD dst_unused:UNUSED_PAD src0_sel:DWORD src1_sel:WORD_1
v_smfmac_f32_16x16x64_bf16 v[24:27], a[232:235], v[92:99], v164
s_waitcnt lgkmcnt(5)
ds_read_u16 v107, v107
v_add_u32_sdwa v90, s42, v137 dst_sel:DWORD dst_unused:UNUSED_PAD src0_sel:DWORD src1_sel:WORD_0
v_smfmac_f32_16x16x64_bf16 v[24:27], v[114:117], v[76:83], v182
s_mov_b32 s48, s49
ds_read_u16 v84, v84
v_add_u32_sdwa v91, s42, v137 dst_sel:DWORD dst_unused:UNUSED_PAD src0_sel:DWORD src1_sel:WORD_1
v_smfmac_f32_16x16x64_bf16 v[28:31], v[114:117], v[76:83], v182 abid:1
s_mov_b32 s49, s50
ds_read_b128 v[114:117], v2 offset:256
v_add_u32_sdwa v76, s4, v118 dst_sel:DWORD dst_unused:UNUSED_PAD src0_sel:DWORD src1_sel:WORD_0
v_smfmac_f32_16x16x64_bf16 v[28:31], a[164:167], v[44:51], v156 abid:1
s_add_u32 s50, s50, 4718592
ds_read_u16 v85, v85
v_add_u32_sdwa v77, s4, v118 dst_sel:DWORD dst_unused:UNUSED_PAD src0_sel:DWORD src1_sel:WORD_1
v_smfmac_f32_16x16x64_bf16 v[28:31], a[200:203], v[52:59], v160 abid:1
ds_read_u16 v86, v86
v_add_u32_sdwa v78, s4, v119 dst_sel:DWORD dst_unused:UNUSED_PAD src0_sel:DWORD src1_sel:WORD_0
v_smfmac_f32_16x16x64_bf16 v[28:31], a[236:239], v[92:99], v164 abid:1
ds_read_u16 v87, v87
v_add_u32_sdwa v79, s4, v119 dst_sel:DWORD dst_unused:UNUSED_PAD src0_sel:DWORD src1_sel:WORD_1
v_smfmac_f32_16x16x64_bf16 v[12:15], a[148:151], v[44:51], v154 abid:1
s_add_u32 m0, s44, 3840
ds_read_u16 v88, v88
v_add_u32_sdwa v80, s4, v120 dst_sel:DWORD dst_unused:UNUSED_PAD src0_sel:DWORD src1_sel:WORD_0
v_smfmac_f32_16x16x64_bf16 v[12:15], a[184:187], v[52:59], v158 abid:1
buffer_load_dwordx4 v3, s[16:19], s45 offen offset:256 nt lds
v_add_u32_sdwa v81, s4, v120 dst_sel:DWORD dst_unused:UNUSED_PAD src0_sel:DWORD src1_sel:WORD_1
v_smfmac_f32_16x16x64_bf16 v[12:15], a[220:223], v[92:99], v162 abid:1
ds_read_b128 v[60:63], v0 offset:14336
v_add_u32_sdwa v82, s4, v121 dst_sel:DWORD dst_unused:UNUSED_PAD src0_sel:DWORD src1_sel:WORD_0
v_smfmac_f32_16x16x64_bf16 v[32:35], a[168:171], v[44:51], v157
ds_read_u16 v89, v89
v_add_u32_sdwa v83, s4, v121 dst_sel:DWORD dst_unused:UNUSED_PAD src0_sel:DWORD src1_sel:WORD_1
v_smfmac_f32_16x16x64_bf16 v[32:35], a[204:207], v[52:59], v161
ds_read_b128 v[64:67], v1 offset:14336
v_smfmac_f32_16x16x64_bf16 v[32:35], a[240:243], v[92:99], v165
s_waitcnt lgkmcnt(7)
ds_read_b128 v[68:71], v0 offset:16384
v_smfmac_f32_16x16x64_bf16 v[32:35], v[114:117], v[100:107], v183 abid:1
ds_read_u16 v90, v90
v_smfmac_f32_16x16x64_bf16 v[36:39], v[114:117], v[100:107], v184
ds_read_b128 v[72:75], v1 offset:16384
v_add_u32 v0, s43, v0
v_smfmac_f32_16x16x64_bf16 v[36:39], a[172:175], v[44:51], v157 abid:1
s_add_u32 m0, s44, 7680
ds_read_u16 v91, v91
v_add_u32 v1, s43, v1
v_smfmac_f32_16x16x64_bf16 v[36:39], a[208:211], v[52:59], v161 abid:1
buffer_load_dwordx4 v3, s[16:19], s45 offen offset:512 nt lds
v_smfmac_f32_16x16x64_bf16 v[36:39], a[244:247], v[92:99], v165 abid:1
ds_read_b128 v[114:117], v2 offset:320
v_smfmac_f32_16x16x64_bf16 v[16:19], a[152:155], v[44:51], v155
s_add_u32 m0, s44, 11520
v_smfmac_f32_16x16x64_bf16 v[16:19], a[188:191], v[52:59], v159
buffer_load_dwordx4 v3, s[16:19], s45 offen offset:768 nt lds
v_smfmac_f32_16x16x64_bf16 v[16:19], a[224:227], v[92:99], v163
v_smfmac_f32_16x16x64_bf16 v[20:23], a[156:159], v[44:51], v155 abid:1
s_add_u32 m0, s44, s8
v_smfmac_f32_16x16x64_bf16 v[20:23], a[192:195], v[52:59], v159 abid:1
s_mov_b64 exec, s[10:11]
buffer_load_dwordx4 v3, s[16:19], s7 offen offset:896 nt lds
s_mov_b64 exec, -1
v_smfmac_f32_16x16x64_bf16 v[20:23], a[228:231], v[92:99], v163 abid:1
s_add_u32 s45, s45, 4718592
s_add_u32 s7, s7, 4718592
s_add_u32 s44, s44, s5
v_smfmac_f32_16x16x64_bf16 v[40:43], a[176:179], v[44:51], v176
s_cmp_ge_u32 s44, 148480
s_cselect_b32 s44, s9, s44
s_bitcmp1_b32 s92, s41
v_smfmac_f32_16x16x64_bf16 v[40:43], a[212:215], v[52:59], v176 abid:1
s_cbranch_scc1 L_loop_w
L_loop_wb:
v_smfmac_f32_16x16x64_bf16 v[40:43], a[248:251], v[92:99], v177
s_waitcnt lgkmcnt(0)
v_smfmac_f32_16x16x64_bf16 v[40:43], v[114:117], v[84:91], v185
s_waitcnt vmcnt(20)
s_barrier
v_smfmac_f32_16x16x64_bf16 v[8:11], a[252:255], v[60:67], v166
s_mov_b32 s42, s4
v_smfmac_f32_16x16x64_bf16 v[8:11], v[218:221], v[68:75], v170
ds_read_b128 v[44:47], v0 offset:0
v_add_u32_sdwa v84, s42, v122 dst_sel:DWORD dst_unused:UNUSED_PAD src0_sel:DWORD src1_sel:WORD_0
v_smfmac_f32_16x16x64_bf16 v[12:15], v[186:189], v[60:67], v166 abid:1
ds_read_b128 v[48:51], v1 offset:0
v_add_u32_sdwa v85, s42, v122 dst_sel:DWORD dst_unused:UNUSED_PAD src0_sel:DWORD src1_sel:WORD_1
v_smfmac_f32_16x16x64_bf16 v[12:15], v[222:225], v[68:75], v170 abid:1
ds_read_b128 v[52:55], v0 offset:2048
v_add_u32_sdwa v86, s42, v123 dst_sel:DWORD dst_unused:UNUSED_PAD src0_sel:DWORD src1_sel:WORD_0
v_smfmac_f32_16x16x64_bf16 v[16:19], v[190:193], v[60:67], v167
ds_read_b128 v[56:59], v1 offset:2048
v_cvt_pk_bf16_f32 v92, v8, v9
v_smfmac_f32_16x16x64_bf16 v[16:19], v[226:229], v[68:75], v171
ds_read_u16 v76, v76
v_cvt_pk_bf16_f32 v93, v10, v11
v_smfmac_f32_16x16x64_bf16 v[20:23], v[194:197], v[60:67], v167 abid:1
ds_read_b128 v[8:11], v2 offset:1024
v_cvt_pk_bf16_f32 v94, v12, v13
v_smfmac_f32_16x16x64_bf16 v[20:23], v[230:233], v[68:75], v171 abid:1
ds_read_u16 v77, v77
v_cvt_pk_bf16_f32 v95, v14, v15
v_smfmac_f32_16x16x64_bf16 v[24:27], v[198:201], v[60:67], v168
ds_read_b128 v[12:15], v2 offset:1088
v_cvt_pk_bf16_f32 v96, v16, v17
v_smfmac_f32_16x16x64_bf16 v[24:27], v[234:237], v[68:75], v172
ds_read_u16 v78, v78
v_cvt_pk_bf16_f32 v97, v18, v19
v_smfmac_f32_16x16x64_bf16 v[28:31], v[202:205], v[60:67], v168 abid:1
ds_read_b128 v[16:19], v2 offset:1152
v_cvt_pk_bf16_f32 v98, v20, v21
v_smfmac_f32_16x16x64_bf16 v[28:31], v[238:241], v[68:75], v172 abid:1
ds_read_u16 v79, v79
v_cvt_pk_bf16_f32 v99, v22, v23
v_smfmac_f32_16x16x64_bf16 v[32:35], v[206:209], v[60:67], v169
ds_read_b128 v[20:23], v2 offset:1216
v_cvt_pk_bf16_f32 v100, v24, v25
v_smfmac_f32_16x16x64_bf16 v[32:35], v[242:245], v[68:75], v173
ds_read_u16 v80, v80
v_cvt_pk_bf16_f32 v101, v26, v27
v_smfmac_f32_16x16x64_bf16 v[36:39], v[210:213], v[60:67], v169 abid:1
ds_read_b128 v[24:27], v2 offset:1280
v_cvt_pk_bf16_f32 v102, v28, v29
v_smfmac_f32_16x16x64_bf16 v[36:39], v[246:249], v[68:75], v173 abid:1
ds_read_u16 v81, v81
v_cvt_pk_bf16_f32 v103, v30, v31
v_smfmac_f32_16x16x64_bf16 v[40:43], v[214:217], v[60:67], v177 abid:1
s_bitcmp1_b32 s85, s41
ds_read_b128 v[28:31], v2 offset:1344
v_cvt_pk_bf16_f32 v104, v32, v33
v_smfmac_f32_16x16x64_bf16 v[40:43], v[250:253], v[68:75], v178
s_waitcnt lgkmcnt(10)
v_cvt_pk_bf16_f32 v105, v34, v35
s_cbranch_scc1 L_loop
s_cmp_lg_u32 s41, 5
s_cbranch_scc1 L_loopn
.p2align 3
L_loopc:
v_smfmac_f32_16x16x64_bf16 v[8:11], a[0:3], v[44:51], v138
ds_read_b128 v[32:35], v2 offset:1408
v_cvt_pk_bf16_f32 v106, v36, v37
v_mov_b32 v7, 1
v_smfmac_f32_16x16x64_bf16 v[8:11], a[36:39], v[52:59], v142
s_waitcnt lgkmcnt(9)
buffer_atomic_add v7, v6, s[32:35], 0 offen sc0 sc1
v_cvt_pk_bf16_f32 v107, v38, v39
v_smfmac_f32_16x16x64_bf16 v[12:15], a[4:7], v[44:51], v138 abid:1
ds_read_b128 v[36:39], v2 offset:1472
v_cvt_pk_bf16_f32 v112, v40, v41
v_smfmac_f32_16x16x64_bf16 v[12:15], a[40:43], v[52:59], v142 abid:1
s_waitcnt lgkmcnt(8)
ds_read_b128 v[60:63], v0 offset:4096
v_cvt_pk_bf16_f32 v113, v42, v43
v_smfmac_f32_16x16x64_bf16 v[16:19], a[8:11], v[44:51], v139
s_cmp_eq_u32 s4, 129920
ds_read_b128 v[40:43], v2 offset:1536
v_cndmask_b32_dpp v108, v96, v92, vcc quad_perm:[1,0,3,2] row_mask:0xf bank_mask:0xf
v_smfmac_f32_16x16x64_bf16 v[16:19], a[44:47], v[52:59], v143
s_waitcnt lgkmcnt(8)
ds_read_u16 v82, v82
v_cndmask_b32_dpp v109, v97, v93, vcc quad_perm:[1,0,3,2] row_mask:0xf bank_mask:0xf
v_smfmac_f32_16x16x64_bf16 v[20:23], a[12:15], v[44:51], v139 abid:1
s_cselect_b32 s43, -129920, s5
ds_read_u16 v84, v84
v_cndmask_b32_dpp v110, v98, v94, vcc quad_perm:[1,0,3,2] row_mask:0xf bank_mask:0xf
v_smfmac_f32_16x16x64_bf16 v[20:23], a[48:51], v[52:59], v143 abid:1
s_waitcnt lgkmcnt(8)
ds_read_b128 v[64:67], v1 offset:4096
v_cndmask_b32_dpp v111, v99, v95, vcc quad_perm:[1,0,3,2] row_mask:0xf bank_mask:0xf
v_smfmac_f32_16x16x64_bf16 v[24:27], a[16:19], v[44:51], v140
s_add_u32 s4, s4, s43
ds_read_b128 v[68:71], v0 offset:6144
v_add_u32_sdwa v87, s42, v123 dst_sel:DWORD dst_unused:UNUSED_PAD src0_sel:DWORD src1_sel:WORD_1
v_smfmac_f32_16x16x64_bf16 v[24:27], a[52:55], v[52:59], v144
buffer_store_dwordx4 v[108:111], v4, s[20:23], s46 offen offset:0 sc1
s_mov_b64 vcc, s[82:83]
s_waitcnt lgkmcnt(8)
ds_read_b128 v[72:75], v1 offset:6144
v_cndmask_b32_dpp v96, v92, v96, vcc quad_perm:[1,0,3,2] row_mask:0xf bank_mask:0xf
v_cndmask_b32_dpp v97, v93, v97, vcc quad_perm:[1,0,3,2] row_mask:0xf bank_mask:0xf
v_smfmac_f32_16x16x64_bf16 v[28:31], a[20:23], v[44:51], v140 abid:1
s_add_u32 s7, s45, s58
ds_read_u16 v83, v83
v_cndmask_b32_dpp v98, v94, v98, vcc quad_perm:[1,0,3,2] row_mask:0xf bank_mask:0xf
v_smfmac_f32_16x16x64_bf16 v[28:31], a[56:59], v[52:59], v144 abid:1
s_waitcnt lgkmcnt(9)
ds_read_b128 v[114:117], v2 offset:64
v_cndmask_b32_dpp v99, v95, v99, vcc quad_perm:[1,0,3,2] row_mask:0xf bank_mask:0xf
v_smfmac_f32_16x16x64_bf16 v[32:35], a[24:27], v[44:51], v141
ds_read_u16 v85, v85
v_add_u32_sdwa v88, s42, v124 dst_sel:DWORD dst_unused:UNUSED_PAD src0_sel:DWORD src1_sel:WORD_0
v_smfmac_f32_16x16x64_bf16 v[32:35], a[60:63], v[52:59], v145
s_waitcnt lgkmcnt(10)
ds_read_u16 v86, v86
v_add_u32_sdwa v89, s42, v124 dst_sel:DWORD dst_unused:UNUSED_PAD src0_sel:DWORD src1_sel:WORD_1
v_smfmac_f32_16x16x64_bf16 v[36:39], a[28:31], v[44:51], v141 abid:1
ds_read_u16 v87, v87
v_add_u32_sdwa v90, s42, v125 dst_sel:DWORD dst_unused:UNUSED_PAD src0_sel:DWORD src1_sel:WORD_0
v_smfmac_f32_16x16x64_bf16 v[36:39], a[64:67], v[52:59], v145 abid:1
s_waitcnt lgkmcnt(10)
ds_read_u16 v88, v88
v_add_u32_sdwa v91, s42, v125 dst_sel:DWORD dst_unused:UNUSED_PAD src0_sel:DWORD src1_sel:WORD_1
v_smfmac_f32_16x16x64_bf16 v[40:43], a[32:35], v[44:51], v174
buffer_store_dwordx4 v[96:99], v4, s[20:23], s46 offen offset:1152 sc1
s_mov_b64 vcc, s[80:81]
ds_read_u16 v89, v89
v_cndmask_b32_dpp v92, v104, v100, vcc quad_perm:[1,0,3,2] row_mask:0xf bank_mask:0xf
v_cndmask_b32_dpp v93, v105, v101, vcc quad_perm:[1,0,3,2] row_mask:0xf bank_mask:0xf
v_smfmac_f32_16x16x64_bf16 v[40:43], a[68:71], v[52:59], v174 abid:1
s_waitcnt lgkmcnt(9)
ds_read_u16 v90, v90
v_cndmask_b32_dpp v94, v106, v102, vcc quad_perm:[1,0,3,2] row_mask:0xf bank_mask:0xf
v_smfmac_f32_16x16x64_bf16 v[8:11], a[72:75], v[60:67], v146
s_waitcnt lgkmcnt(8)
ds_read_u16 v91, v91
v_cndmask_b32_dpp v95, v107, v103, vcc quad_perm:[1,0,3,2] row_mask:0xf bank_mask:0xf
v_smfmac_f32_16x16x64_bf16 v[8:11], a[108:111], v[68:75], v150
s_waitcnt lgkmcnt(7)
ds_bpermute_b32 v112, v6, v112
v_smfmac_f32_16x16x64_bf16 v[8:11], v[114:117], v[76:83], v179
ds_bpermute_b32 v113, v6, v113
v_smfmac_f32_16x16x64_bf16 v[12:15], v[114:117], v[76:83], v179 abid:1
ds_read_b128 v[114:117], v2 offset:128
v_add_u32_sdwa v76, s42, v126 dst_sel:DWORD dst_unused:UNUSED_PAD src0_sel:DWORD src1_sel:WORD_0
v_smfmac_f32_16x16x64_bf16 v[12:15], a[76:79], v[60:67], v146 abid:1
ds_read_u16 v76, v76
v_add_u32_sdwa v77, s42, v126 dst_sel:DWORD dst_unused:UNUSED_PAD src0_sel:DWORD src1_sel:WORD_1
v_smfmac_f32_16x16x64_bf16 v[12:15], a[112:115], v[68:75], v150 abid:1
buffer_store_dwordx4 v[92:95], v4, s[20:23], s46 offen offset:128 sc1
s_mov_b64 vcc, s[82:83]
ds_read_u16 v77, v77
v_cndmask_b32_dpp v104, v100, v104, vcc quad_perm:[1,0,3,2] row_mask:0xf bank_mask:0xf
v_add_u32_sdwa v78, s42, v127 dst_sel:DWORD dst_unused:UNUSED_PAD src0_sel:DWORD src1_sel:WORD_0
v_smfmac_f32_16x16x64_bf16 v[24:27], a[88:91], v[60:67], v148
ds_read_u16 v78, v78
v_cndmask_b32_dpp v105, v101, v105, vcc quad_perm:[1,0,3,2] row_mask:0xf bank_mask:0xf
v_smfmac_f32_16x16x64_bf16 v[24:27], a[124:127], v[68:75], v152
ds_read_b128 v[44:47], v0 offset:8192
v_cndmask_b32_dpp v106, v102, v106, vcc quad_perm:[1,0,3,2] row_mask:0xf bank_mask:0xf
v_smfmac_f32_16x16x64_bf16 v[28:31], a[92:95], v[60:67], v148 abid:1
ds_read_b128 v[48:51], v1 offset:8192
v_add_u32_sdwa v79, s42, v127 dst_sel:DWORD dst_unused:UNUSED_PAD src0_sel:DWORD src1_sel:WORD_1
v_smfmac_f32_16x16x64_bf16 v[28:31], a[128:131], v[68:75], v152 abid:1
ds_read_u16 v79, v79
v_cndmask_b32_dpp v107, v103, v107, vcc quad_perm:[1,0,3,2] row_mask:0xf bank_mask:0xf
v_smfmac_f32_16x16x64_bf16 v[32:35], a[96:99], v[60:67], v149
ds_read_b128 v[52:55], v0 offset:10240
v_add_u32_sdwa v80, s42, v128 dst_sel:DWORD dst_unused:UNUSED_PAD src0_sel:DWORD src1_sel:WORD_0
v_smfmac_f32_16x16x64_bf16 v[32:35], a[132:135], v[68:75], v153
ds_read_u16 v80, v80
v_add_u32_sdwa v81, s42, v128 dst_sel:DWORD dst_unused:UNUSED_PAD src0_sel:DWORD src1_sel:WORD_1
v_smfmac_f32_16x16x64_bf16 v[16:19], a[80:83], v[60:67], v147
buffer_store_dwordx4 v[104:107], v4, s[20:23], s46 offen offset:1280 sc1
s_mov_b64 vcc, s[80:81]
ds_read_b128 v[56:59], v1 offset:10240
v_add_u32_sdwa v82, s42, v129 dst_sel:DWORD dst_unused:UNUSED_PAD src0_sel:DWORD src1_sel:WORD_0
v_add_u32_sdwa v83, s42, v129 dst_sel:DWORD dst_unused:UNUSED_PAD src0_sel:DWORD src1_sel:WORD_1
v_smfmac_f32_16x16x64_bf16 v[16:19], a[116:119], v[68:75], v151
s_waitcnt lgkmcnt(9)
ds_read_b128 v[92:95], v0 offset:12288
v_add_u32_sdwa v100, s42, v130 dst_sel:DWORD dst_unused:UNUSED_PAD src0_sel:DWORD src1_sel:WORD_0
v_smfmac_f32_16x16x64_bf16 v[16:19], v[114:117], v[84:91], v180 abid:1
ds_read_u16 v81, v81
v_add_u32_sdwa v101, s42, v130 dst_sel:DWORD dst_unused:UNUSED_PAD src0_sel:DWORD src1_sel:WORD_1
v_smfmac_f32_16x16x64_bf16 v[20:23], v[114:117], v[84:91], v181
ds_read_b128 v[96:99], v1 offset:12288
v_add_u32_sdwa v102, s42, v131 dst_sel:DWORD dst_unused:UNUSED_PAD src0_sel:DWORD src1_sel:WORD_0
v_smfmac_f32_16x16x64_bf16 v[20:23], a[84:87], v[60:67], v147 abid:1
ds_read_u16 v100, v100
v_add_u32_sdwa v103, s42, v131 dst_sel:DWORD dst_unused:UNUSED_PAD src0_sel:DWORD src1_sel:WORD_1
v_smfmac_f32_16x16x64_bf16 v[20:23], a[120:123], v[68:75], v151 abid:1
ds_read_u16 v82, v82
v_add_u32_sdwa v104, s42, v132 dst_sel:DWORD dst_unused:UNUSED_PAD src0_sel:DWORD src1_sel:WORD_0
v_smfmac_f32_16x16x64_bf16 v[36:39], a[100:103], v[60:67], v149 abid:1
ds_read_u16 v101, v101
v_add_u32_sdwa v105, s42, v132 dst_sel:DWORD dst_unused:UNUSED_PAD src0_sel:DWORD src1_sel:WORD_1
v_smfmac_f32_16x16x64_bf16 v[36:39], a[136:139], v[68:75], v153 abid:1
buffer_store_dwordx2 v[112:113], v5, s[20:23], s46 offen
ds_read_u16 v83, v83
v_add_u32_sdwa v106, s42, v133 dst_sel:DWORD dst_unused:UNUSED_PAD src0_sel:DWORD src1_sel:WORD_0
v_smfmac_f32_16x16x64_bf16 v[40:43], a[104:107], v[60:67], v175
s_mov_b32 s46, s48
ds_read_b128 v[114:117], v2 offset:192
v_add_u32_sdwa v107, s42, v133 dst_sel:DWORD dst_unused:UNUSED_PAD src0_sel:DWORD src1_sel:WORD_1
v_smfmac_f32_16x16x64_bf16 v[40:43], a[140:143], v[68:75], v175 abid:1
s_waitcnt lgkmcnt(12)
ds_read_u16 v102, v102
v_add_u32_sdwa v84, s42, v134 dst_sel:DWORD dst_unused:UNUSED_PAD src0_sel:DWORD src1_sel:WORD_0
v_smfmac_f32_16x16x64_bf16 v[8:11], a[144:147], v[44:51], v154
s_waitcnt lgkmcnt(9)
ds_read_u16 v103, v103
v_add_u32_sdwa v85, s42, v134 dst_sel:DWORD dst_unused:UNUSED_PAD src0_sel:DWORD src1_sel:WORD_1
v_smfmac_f32_16x16x64_bf16 v[8:11], a[180:183], v[52:59], v158
s_waitcnt lgkmcnt(7)
ds_read_u16 v104, v104
v_add_u32_sdwa v86, s42, v135 dst_sel:DWORD dst_unused:UNUSED_PAD src0_sel:DWORD src1_sel:WORD_0
v_smfmac_f32_16x16x64_bf16 v[8:11], a[216:219], v[92:99], v162
s_mov_b32 s48, s49
ds_read_u16 v105, v105
v_add_u32_sdwa v87, s42, v135 dst_sel:DWORD dst_unused:UNUSED_PAD src0_sel:DWORD src1_sel:WORD_1
v_smfmac_f32_16x16x64_bf16 v[24:27], a[160:163], v[44:51], v156
s_add_u32 m0, s44, 0
ds_read_u16 v106, v106
v_add_u32_sdwa v88, s42, v136 dst_sel:DWORD dst_unused:UNUSED_PAD src0_sel:DWORD src1_sel:WORD_0
v_smfmac_f32_16x16x64_bf16 v[24:27], a[196:199], v[52:59], v160
buffer_load_dwordx4 v3, s[16:19], s45 offen offset:0 nt lds
v_add_u32_sdwa v89, s42, v136 dst_sel:DWORD dst_unused:UNUSED_PAD src0_sel:DWORD src1_sel:WORD_1
v_smfmac_f32_16x16x64_bf16 v[24:27], a[232:235], v[92:99], v164
s_waitcnt lgkmcnt(5)
ds_read_u16 v107, v107
v_add_u32_sdwa v90, s42, v137 dst_sel:DWORD dst_unused:UNUSED_PAD src0_sel:DWORD src1_sel:WORD_0
v_smfmac_f32_16x16x64_bf16 v[24:27], v[114:117], v[76:83], v182
s_mov_b32 s49, s50
ds_read_u16 v84, v84
v_add_u32_sdwa v91, s42, v137 dst_sel:DWORD dst_unused:UNUSED_PAD src0_sel:DWORD src1_sel:WORD_1
v_smfmac_f32_16x16x64_bf16 v[28:31], v[114:117], v[76:83], v182 abid:1
s_mov_b32 s50, s45
ds_read_b128 v[114:117], v2 offset:256
v_add_u32_sdwa v76, s4, v118 dst_sel:DWORD dst_unused:UNUSED_PAD src0_sel:DWORD src1_sel:WORD_0
v_smfmac_f32_16x16x64_bf16 v[28:31], a[164:167], v[44:51], v156 abid:1
ds_read_u16 v85, v85
v_add_u32_sdwa v77, s4, v118 dst_sel:DWORD dst_unused:UNUSED_PAD src0_sel:DWORD src1_sel:WORD_1
v_smfmac_f32_16x16x64_bf16 v[28:31], a[200:203], v[52:59], v160 abid:1
ds_read_u16 v86, v86
v_add_u32_sdwa v78, s4, v119 dst_sel:DWORD dst_unused:UNUSED_PAD src0_sel:DWORD src1_sel:WORD_0
v_smfmac_f32_16x16x64_bf16 v[28:31], a[236:239], v[92:99], v164 abid:1
ds_read_u16 v87, v87
v_add_u32_sdwa v79, s4, v119 dst_sel:DWORD dst_unused:UNUSED_PAD src0_sel:DWORD src1_sel:WORD_1
v_smfmac_f32_16x16x64_bf16 v[12:15], a[148:151], v[44:51], v154 abid:1
s_add_u32 m0, s44, 3840
ds_read_u16 v88, v88
v_add_u32_sdwa v80, s4, v120 dst_sel:DWORD dst_unused:UNUSED_PAD src0_sel:DWORD src1_sel:WORD_0
v_smfmac_f32_16x16x64_bf16 v[12:15], a[184:187], v[52:59], v158 abid:1
buffer_load_dwordx4 v3, s[16:19], s45 offen offset:256 nt lds
v_add_u32_sdwa v81, s4, v120 dst_sel:DWORD dst_unused:UNUSED_PAD src0_sel:DWORD src1_sel:WORD_1
v_smfmac_f32_16x16x64_bf16 v[12:15], a[220:223], v[92:99], v162 abid:1
ds_read_b128 v[60:63], v0 offset:14336
v_add_u32_sdwa v82, s4, v121 dst_sel:DWORD dst_unused:UNUSED_PAD src0_sel:DWORD src1_sel:WORD_0
v_smfmac_f32_16x16x64_bf16 v[32:35], a[168:171], v[44:51], v157
ds_read_u16 v89, v89
v_add_u32_sdwa v83, s4, v121 dst_sel:DWORD dst_unused:UNUSED_PAD src0_sel:DWORD src1_sel:WORD_1
v_smfmac_f32_16x16x64_bf16 v[32:35], a[204:207], v[52:59], v161
ds_read_b128 v[64:67], v1 offset:14336
v_smfmac_f32_16x16x64_bf16 v[32:35], a[240:243], v[92:99], v165
s_waitcnt lgkmcnt(7)
ds_read_b128 v[68:71], v0 offset:16384
v_smfmac_f32_16x16x64_bf16 v[32:35], v[114:117], v[100:107], v183 abid:1
ds_read_u16 v90, v90
v_smfmac_f32_16x16x64_bf16 v[36:39], v[114:117], v[100:107], v184
ds_read_b128 v[72:75], v1 offset:16384
v_add_u32 v0, s43, v0
v_smfmac_f32_16x16x64_bf16 v[36:39], a[172:175], v[44:51], v157 abid:1
s_add_u32 m0, s44, 7680
ds_read_u16 v91, v91
v_add_u32 v1, s43, v1
v_smfmac_f32_16x16x64_bf16 v[36:39], a[208:211], v[52:59], v161 abid:1
buffer_load_dwordx4 v3, s[16:19], s45 offen offset:512 nt lds
v_smfmac_f32_16x16x64_bf16 v[36:39], a[244:247], v[92:99], v165 abid:1
ds_read_b128 v[114:117], v2 offset:320
v_smfmac_f32_16x16x64_bf16 v[16:19], a[152:155], v[44:51], v155
s_add_u32 m0, s44, 11520
v_smfmac_f32_16x16x64_bf16 v[16:19], a[188:191], v[52:59], v159
buffer_load_dwordx4 v3, s[16:19], s45 offen offset:768 nt lds
v_smfmac_f32_16x16x64_bf16 v[16:19], a[224:227], v[92:99], v163
s_waitcnt vmcnt(9)
s_mov_b64 exec, s[62:63]
ds_write_b32 v0, v7 offset:18432
s_mov_b64 exec, -1
v_smfmac_f32_16x16x64_bf16 v[20:23], a[156:159], v[44:51], v155 abid:1
s_add_u32 m0, s44, s8
v_smfmac_f32_16x16x64_bf16 v[20:23], a[192:195], v[52:59], v159 abid:1
s_mov_b64 exec, s[10:11]
buffer_load_dwordx4 v3, s[16:19], s7 offen offset:896 nt lds
s_mov_b64 exec, -1
v_smfmac_f32_16x16x64_bf16 v[20:23], a[228:231], v[92:99], v163 abid:1
s_add_u32 s44, s44, s5
s_cmp_ge_u32 s44, 148480
s_cselect_b32 s44, s9, s44
v_smfmac_f32_16x16x64_bf16 v[40:43], a[176:179], v[44:51], v176
v_smfmac_f32_16x16x64_bf16 v[40:43], a[212:215], v[52:59], v176 abid:1
v_smfmac_f32_16x16x64_bf16 v[40:43], a[248:251], v[92:99], v177
s_waitcnt lgkmcnt(0)
v_smfmac_f32_16x16x64_bf16 v[40:43], v[114:117], v[84:91], v185
s_barrier
v_smfmac_f32_16x16x64_bf16 v[8:11], a[252:255], v[60:67], v166
s_mov_b32 s42, s4
ds_read_b32 v7, v0 offset:18432
v_smfmac_f32_16x16x64_bf16 v[8:11], v[218:221], v[68:75], v170
ds_read_b128 v[44:47], v0 offset:0
v_add_u32_sdwa v84, s42, v122 dst_sel:DWORD dst_unused:UNUSED_PAD src0_sel:DWORD src1_sel:WORD_0
v_smfmac_f32_16x16x64_bf16 v[12:15], v[186:189], v[60:67], v166 abid:1
ds_read_b128 v[48:51], v1 offset:0
v_add_u32_sdwa v85, s42, v122 dst_sel:DWORD dst_unused:UNUSED_PAD src0_sel:DWORD src1_sel:WORD_1
v_smfmac_f32_16x16x64_bf16 v[12:15], v[222:225], v[68:75], v170 abid:1
ds_read_b128 v[52:55], v0 offset:2048
v_add_u32_sdwa v86, s42, v123 dst_sel:DWORD dst_unused:UNUSED_PAD src0_sel:DWORD src1_sel:WORD_0
v_smfmac_f32_16x16x64_bf16 v[16:19], v[190:193], v[60:67], v167
ds_read_b128 v[56:59], v1 offset:2048
v_cvt_pk_bf16_f32 v92, v8, v9
v_smfmac_f32_16x16x64_bf16 v[16:19], v[226:229], v[68:75], v171
ds_read_u16 v76, v76
v_cvt_pk_bf16_f32 v93, v10, v11
v_smfmac_f32_16x16x64_bf16 v[20:23], v[194:197], v[60:67], v167 abid:1
ds_read_b128 v[8:11], v2 offset:1024
v_cvt_pk_bf16_f32 v94, v12, v13
v_smfmac_f32_16x16x64_bf16 v[20:23], v[230:233], v[68:75], v171 abid:1
ds_read_u16 v77, v77
v_cvt_pk_bf16_f32 v95, v14, v15
v_smfmac_f32_16x16x64_bf16 v[24:27], v[198:201], v[60:67], v168
ds_read_b128 v[12:15], v2 offset:1088
v_cvt_pk_bf16_f32 v96, v16, v17
v_smfmac_f32_16x16x64_bf16 v[24:27], v[234:237], v[68:75], v172
s_waitcnt lgkmcnt(8)
ds_read_u16 v78, v78
v_cvt_pk_bf16_f32 v97, v18, v19
v_readfirstlane_b32 s56, v7
v_smfmac_f32_16x16x64_bf16 v[28:31], v[202:205], v[60:67], v168 abid:1
s_lshr_b32 s60, s56, 5
ds_read_b128 v[16:19], v2 offset:1152
v_cvt_pk_bf16_f32 v98, v20, v21
v_smfmac_f32_16x16x64_bf16 v[28:31], v[238:241], v[68:75], v172 abid:1
s_mul_i32 s60, s60, 4128768
ds_read_u16 v79, v79
v_cvt_pk_bf16_f32 v99, v22, v23
v_smfmac_f32_16x16x64_bf16 v[32:35], v[206:209], v[60:67], v169
s_mul_i32 s61, s56, 18432
ds_read_b128 v[20:23], v2 offset:1216
v_cvt_pk_bf16_f32 v100, v24, v25
v_smfmac_f32_16x16x64_bf16 v[32:35], v[242:245], v[68:75], v173
s_add_u32 s60, s60, s57
ds_read_u16 v80, v80
v_cvt_pk_bf16_f32 v101, v26, v27
v_smfmac_f32_16x16x64_bf16 v[36:39], v[210:213], v[60:67], v169 abid:1
s_add_u32 s45, s60, s61
ds_read_b128 v[24:27], v2 offset:1280
v_cvt_pk_bf16_f32 v102, v28, v29
v_smfmac_f32_16x16x64_bf16 v[36:39], v[246:249], v[68:75], v173 abid:1
ds_read_u16 v81, v81
v_cvt_pk_bf16_f32 v103, v30, v31
v_smfmac_f32_16x16x64_bf16 v[40:43], v[214:217], v[60:67], v177 abid:1
s_cmp_lt_u32 s56, 224
ds_read_b128 v[28:31], v2 offset:1344
v_cvt_pk_bf16_f32 v104, v32, v33
v_smfmac_f32_16x16x64_bf16 v[40:43], v[250:253], v[68:75], v178
s_waitcnt lgkmcnt(10)
v_cvt_pk_bf16_f32 v105, v34, v35
s_cbranch_scc1 L_loopc
s_mov_b32 s41, 0
s_mov_b32 s15, 3
s_mov_b32 s12, 7
s_mov_b32 s92, 4
s_mov_b32 s87, 4
s_mov_b32 s59, -1
.p2align 3
L_loopn:
v_smfmac_f32_16x16x64_bf16 v[8:11], a[0:3], v[44:51], v138
ds_read_b128 v[32:35], v2 offset:1408
v_cvt_pk_bf16_f32 v106, v36, v37
v_smfmac_f32_16x16x64_bf16 v[8:11], a[36:39], v[52:59], v142
s_waitcnt lgkmcnt(9)
v_cvt_pk_bf16_f32 v107, v38, v39
v_smfmac_f32_16x16x64_bf16 v[12:15], a[4:7], v[44:51], v138 abid:1
ds_read_b128 v[36:39], v2 offset:1472
v_cvt_pk_bf16_f32 v112, v40, v41
v_smfmac_f32_16x16x64_bf16 v[12:15], a[40:43], v[52:59], v142 abid:1
s_waitcnt lgkmcnt(8)
ds_read_b128 v[60:63], v0 offset:4096
v_cvt_pk_bf16_f32 v113, v42, v43
v_smfmac_f32_16x16x64_bf16 v[16:19], a[8:11], v[44:51], v139
s_cmp_eq_u32 s4, 129920
ds_read_b128 v[40:43], v2 offset:1536
v_cndmask_b32_dpp v108, v96, v92, vcc quad_perm:[1,0,3,2] row_mask:0xf bank_mask:0xf
v_smfmac_f32_16x16x64_bf16 v[16:19], a[44:47], v[52:59], v143
s_waitcnt lgkmcnt(8)
ds_read_u16 v82, v82
v_cndmask_b32_dpp v109, v97, v93, vcc quad_perm:[1,0,3,2] row_mask:0xf bank_mask:0xf
v_smfmac_f32_16x16x64_bf16 v[20:23], a[12:15], v[44:51], v139 abid:1
s_cselect_b32 s43, -129920, s5
ds_read_u16 v84, v84
v_cndmask_b32_dpp v110, v98, v94, vcc quad_perm:[1,0,3,2] row_mask:0xf bank_mask:0xf
v_smfmac_f32_16x16x64_bf16 v[20:23], a[48:51], v[52:59], v143 abid:1
s_waitcnt lgkmcnt(8)
ds_read_b128 v[64:67], v1 offset:4096
v_cndmask_b32_dpp v111, v99, v95, vcc quad_perm:[1,0,3,2] row_mask:0xf bank_mask:0xf
v_smfmac_f32_16x16x64_bf16 v[24:27], a[16:19], v[44:51], v140
s_add_u32 s4, s4, s43
ds_read_b128 v[68:71], v0 offset:6144
v_add_u32_sdwa v87, s42, v123 dst_sel:DWORD dst_unused:UNUSED_PAD src0_sel:DWORD src1_sel:WORD_1
v_smfmac_f32_16x16x64_bf16 v[24:27], a[52:55], v[52:59], v144
buffer_store_dwordx4 v[108:111], v4, s[20:23], s46 offen offset:0 sc1
s_mov_b64 vcc, s[82:83]
s_waitcnt lgkmcnt(8)
ds_read_b128 v[72:75], v1 offset:6144
v_cndmask_b32_dpp v96, v92, v96, vcc quad_perm:[1,0,3,2] row_mask:0xf bank_mask:0xf
v_cndmask_b32_dpp v97, v93, v97, vcc quad_perm:[1,0,3,2] row_mask:0xf bank_mask:0xf
v_smfmac_f32_16x16x64_bf16 v[28:31], a[20:23], v[44:51], v140 abid:1
s_add_u32 s41, s41, 1
ds_read_u16 v83, v83
v_cndmask_b32_dpp v98, v94, v98, vcc quad_perm:[1,0,3,2] row_mask:0xf bank_mask:0xf
v_smfmac_f32_16x16x64_bf16 v[28:31], a[56:59], v[52:59], v144 abid:1
s_waitcnt lgkmcnt(9)
ds_read_b128 v[114:117], v2 offset:64
v_cndmask_b32_dpp v99, v95, v99, vcc quad_perm:[1,0,3,2] row_mask:0xf bank_mask:0xf
v_smfmac_f32_16x16x64_bf16 v[32:35], a[24:27], v[44:51], v141
ds_read_u16 v85, v85
v_add_u32_sdwa v88, s42, v124 dst_sel:DWORD dst_unused:UNUSED_PAD src0_sel:DWORD src1_sel:WORD_0
v_smfmac_f32_16x16x64_bf16 v[32:35], a[60:63], v[52:59], v145
s_waitcnt lgkmcnt(10)
ds_read_u16 v86, v86
v_add_u32_sdwa v89, s42, v124 dst_sel:DWORD dst_unused:UNUSED_PAD src0_sel:DWORD src1_sel:WORD_1
v_smfmac_f32_16x16x64_bf16 v[36:39], a[28:31], v[44:51], v141 abid:1
ds_read_u16 v87, v87
v_add_u32_sdwa v90, s42, v125 dst_sel:DWORD dst_unused:UNUSED_PAD src0_sel:DWORD src1_sel:WORD_0
v_smfmac_f32_16x16x64_bf16 v[36:39], a[64:67], v[52:59], v145 abid:1
s_waitcnt lgkmcnt(10)
ds_read_u16 v88, v88
v_add_u32_sdwa v91, s42, v125 dst_sel:DWORD dst_unused:UNUSED_PAD src0_sel:DWORD src1_sel:WORD_1
v_smfmac_f32_16x16x64_bf16 v[40:43], a[32:35], v[44:51], v174
buffer_store_dwordx4 v[96:99], v4, s[20:23], s46 offen offset:1152 sc1
s_mov_b64 vcc, s[80:81]
ds_read_u16 v89, v89
v_cndmask_b32_dpp v92, v104, v100, vcc quad_perm:[1,0,3,2] row_mask:0xf bank_mask:0xf
v_cndmask_b32_dpp v93, v105, v101, vcc quad_perm:[1,0,3,2] row_mask:0xf bank_mask:0xf
v_smfmac_f32_16x16x64_bf16 v[40:43], a[68:71], v[52:59], v174 abid:1
s_waitcnt lgkmcnt(9)
ds_read_u16 v90, v90
v_cndmask_b32_dpp v94, v106, v102, vcc quad_perm:[1,0,3,2] row_mask:0xf bank_mask:0xf
v_smfmac_f32_16x16x64_bf16 v[8:11], a[72:75], v[60:67], v146
s_waitcnt lgkmcnt(8)
ds_read_u16 v91, v91
v_cndmask_b32_dpp v95, v107, v103, vcc quad_perm:[1,0,3,2] row_mask:0xf bank_mask:0xf
v_smfmac_f32_16x16x64_bf16 v[8:11], a[108:111], v[68:75], v150
s_waitcnt lgkmcnt(7)
ds_bpermute_b32 v112, v6, v112
v_smfmac_f32_16x16x64_bf16 v[8:11], v[114:117], v[76:83], v179
ds_bpermute_b32 v113, v6, v113
v_smfmac_f32_16x16x64_bf16 v[12:15], v[114:117], v[76:83], v179 abid:1
ds_read_b128 v[114:117], v2 offset:128
v_add_u32_sdwa v76, s42, v126 dst_sel:DWORD dst_unused:UNUSED_PAD src0_sel:DWORD src1_sel:WORD_0
v_smfmac_f32_16x16x64_bf16 v[12:15], a[76:79], v[60:67], v146 abid:1
ds_read_u16 v76, v76
v_add_u32_sdwa v77, s42, v126 dst_sel:DWORD dst_unused:UNUSED_PAD src0_sel:DWORD src1_sel:WORD_1
v_smfmac_f32_16x16x64_bf16 v[12:15], a[112:115], v[68:75], v150 abid:1
buffer_store_dwordx4 v[92:95], v4, s[20:23], s46 offen offset:128 sc1
s_mov_b64 vcc, s[82:83]
ds_read_u16 v77, v77
v_cndmask_b32_dpp v104, v100, v104, vcc quad_perm:[1,0,3,2] row_mask:0xf bank_mask:0xf
v_add_u32_sdwa v78, s42, v127 dst_sel:DWORD dst_unused:UNUSED_PAD src0_sel:DWORD src1_sel:WORD_0
v_smfmac_f32_16x16x64_bf16 v[24:27], a[88:91], v[60:67], v148
ds_read_u16 v78, v78
v_cndmask_b32_dpp v105, v101, v105, vcc quad_perm:[1,0,3,2] row_mask:0xf bank_mask:0xf
v_smfmac_f32_16x16x64_bf16 v[24:27], a[124:127], v[68:75], v152
ds_read_b128 v[44:47], v0 offset:8192
v_cndmask_b32_dpp v106, v102, v106, vcc quad_perm:[1,0,3,2] row_mask:0xf bank_mask:0xf
v_smfmac_f32_16x16x64_bf16 v[28:31], a[92:95], v[60:67], v148 abid:1
ds_read_b128 v[48:51], v1 offset:8192
v_add_u32_sdwa v79, s42, v127 dst_sel:DWORD dst_unused:UNUSED_PAD src0_sel:DWORD src1_sel:WORD_1
v_smfmac_f32_16x16x64_bf16 v[28:31], a[128:131], v[68:75], v152 abid:1
ds_read_u16 v79, v79
v_cndmask_b32_dpp v107, v103, v107, vcc quad_perm:[1,0,3,2] row_mask:0xf bank_mask:0xf
v_smfmac_f32_16x16x64_bf16 v[32:35], a[96:99], v[60:67], v149
ds_read_b128 v[52:55], v0 offset:10240
v_add_u32_sdwa v80, s42, v128 dst_sel:DWORD dst_unused:UNUSED_PAD src0_sel:DWORD src1_sel:WORD_0
v_smfmac_f32_16x16x64_bf16 v[32:35], a[132:135], v[68:75], v153
ds_read_u16 v80, v80
v_add_u32_sdwa v81, s42, v128 dst_sel:DWORD dst_unused:UNUSED_PAD src0_sel:DWORD src1_sel:WORD_1
v_smfmac_f32_16x16x64_bf16 v[16:19], a[80:83], v[60:67], v147
buffer_store_dwordx4 v[104:107], v4, s[20:23], s46 offen offset:1280 sc1
s_mov_b64 vcc, s[80:81]
ds_read_b128 v[56:59], v1 offset:10240
v_add_u32_sdwa v82, s42, v129 dst_sel:DWORD dst_unused:UNUSED_PAD src0_sel:DWORD src1_sel:WORD_0
v_add_u32_sdwa v83, s42, v129 dst_sel:DWORD dst_unused:UNUSED_PAD src0_sel:DWORD src1_sel:WORD_1
v_smfmac_f32_16x16x64_bf16 v[16:19], a[116:119], v[68:75], v151
s_waitcnt lgkmcnt(9)
ds_read_b128 v[92:95], v0 offset:12288
v_add_u32_sdwa v100, s42, v130 dst_sel:DWORD dst_unused:UNUSED_PAD src0_sel:DWORD src1_sel:WORD_0
v_smfmac_f32_16x16x64_bf16 v[16:19], v[114:117], v[84:91], v180 abid:1
ds_read_u16 v81, v81
v_add_u32_sdwa v101, s42, v130 dst_sel:DWORD dst_unused:UNUSED_PAD src0_sel:DWORD src1_sel:WORD_1
v_smfmac_f32_16x16x64_bf16 v[20:23], v[114:117], v[84:91], v181
ds_read_b128 v[96:99], v1 offset:12288
v_add_u32_sdwa v102, s42, v131 dst_sel:DWORD dst_unused:UNUSED_PAD src0_sel:DWORD src1_sel:WORD_0
v_smfmac_f32_16x16x64_bf16 v[20:23], a[84:87], v[60:67], v147 abid:1
ds_read_u16 v100, v100
v_add_u32_sdwa v103, s42, v131 dst_sel:DWORD dst_unused:UNUSED_PAD src0_sel:DWORD src1_sel:WORD_1
v_smfmac_f32_16x16x64_bf16 v[20:23], a[120:123], v[68:75], v151 abid:1
ds_read_u16 v82, v82
v_add_u32_sdwa v104, s42, v132 dst_sel:DWORD dst_unused:UNUSED_PAD src0_sel:DWORD src1_sel:WORD_0
v_smfmac_f32_16x16x64_bf16 v[36:39], a[100:103], v[60:67], v149 abid:1
ds_read_u16 v101, v101
v_add_u32_sdwa v105, s42, v132 dst_sel:DWORD dst_unused:UNUSED_PAD src0_sel:DWORD src1_sel:WORD_1
v_smfmac_f32_16x16x64_bf16 v[36:39], a[136:139], v[68:75], v153 abid:1
buffer_store_dwordx2 v[112:113], v5, s[20:23], s46 offen
ds_read_u16 v83, v83
v_add_u32_sdwa v106, s42, v133 dst_sel:DWORD dst_unused:UNUSED_PAD src0_sel:DWORD src1_sel:WORD_0
v_smfmac_f32_16x16x64_bf16 v[40:43], a[104:107], v[60:67], v175
s_mov_b32 s22, 75497472
ds_read_b128 v[114:117], v2 offset:192
v_add_u32_sdwa v107, s42, v133 dst_sel:DWORD dst_unused:UNUSED_PAD src0_sel:DWORD src1_sel:WORD_1
v_smfmac_f32_16x16x64_bf16 v[40:43], a[140:143], v[68:75], v175 abid:1
s_waitcnt lgkmcnt(12)
ds_read_u16 v102, v102
v_add_u32_sdwa v84, s42, v134 dst_sel:DWORD dst_unused:UNUSED_PAD src0_sel:DWORD src1_sel:WORD_0
v_smfmac_f32_16x16x64_bf16 v[8:11], a[144:147], v[44:51], v154
s_waitcnt lgkmcnt(9)
ds_read_u16 v103, v103
v_add_u32_sdwa v85, s42, v134 dst_sel:DWORD dst_unused:UNUSED_PAD src0_sel:DWORD src1_sel:WORD_1
v_smfmac_f32_16x16x64_bf16 v[8:11], a[180:183], v[52:59], v158
s_waitcnt lgkmcnt(7)
ds_read_u16 v104, v104
v_add_u32_sdwa v86, s42, v135 dst_sel:DWORD dst_unused:UNUSED_PAD src0_sel:DWORD src1_sel:WORD_0
v_smfmac_f32_16x16x64_bf16 v[8:11], a[216:219], v[92:99], v162
s_mov_b32 s46, s48
ds_read_u16 v105, v105
v_add_u32_sdwa v87, s42, v135 dst_sel:DWORD dst_unused:UNUSED_PAD src0_sel:DWORD src1_sel:WORD_1
v_smfmac_f32_16x16x64_bf16 v[24:27], a[160:163], v[44:51], v156
s_mov_b32 s48, s49
ds_read_u16 v106, v106
v_add_u32_sdwa v88, s42, v136 dst_sel:DWORD dst_unused:UNUSED_PAD src0_sel:DWORD src1_sel:WORD_0
v_smfmac_f32_16x16x64_bf16 v[24:27], a[196:199], v[52:59], v160
s_mov_b32 s49, s50
s_add_u32 s50, s50, 4718592
v_add_u32_sdwa v89, s42, v136 dst_sel:DWORD dst_unused:UNUSED_PAD src0_sel:DWORD src1_sel:WORD_1
v_smfmac_f32_16x16x64_bf16 v[24:27], a[232:235], v[92:99], v164
s_waitcnt lgkmcnt(5)
ds_read_u16 v107, v107
v_add_u32_sdwa v90, s42, v137 dst_sel:DWORD dst_unused:UNUSED_PAD src0_sel:DWORD src1_sel:WORD_0
v_smfmac_f32_16x16x64_bf16 v[24:27], v[114:117], v[76:83], v182
ds_read_u16 v84, v84
v_add_u32_sdwa v91, s42, v137 dst_sel:DWORD dst_unused:UNUSED_PAD src0_sel:DWORD src1_sel:WORD_1
v_smfmac_f32_16x16x64_bf16 v[28:31], v[114:117], v[76:83], v182 abid:1
ds_read_b128 v[114:117], v2 offset:256
v_add_u32_sdwa v76, s4, v118 dst_sel:DWORD dst_unused:UNUSED_PAD src0_sel:DWORD src1_sel:WORD_0
v_smfmac_f32_16x16x64_bf16 v[28:31], a[164:167], v[44:51], v156 abid:1
ds_read_u16 v85, v85
v_add_u32_sdwa v77, s4, v118 dst_sel:DWORD dst_unused:UNUSED_PAD src0_sel:DWORD src1_sel:WORD_1
v_smfmac_f32_16x16x64_bf16 v[28:31], a[200:203], v[52:59], v160 abid:1
ds_read_u16 v86, v86
v_add_u32_sdwa v78, s4, v119 dst_sel:DWORD dst_unused:UNUSED_PAD src0_sel:DWORD src1_sel:WORD_0
v_smfmac_f32_16x16x64_bf16 v[28:31], a[236:239], v[92:99], v164 abid:1
ds_read_u16 v87, v87
v_add_u32_sdwa v79, s4, v119 dst_sel:DWORD dst_unused:UNUSED_PAD src0_sel:DWORD src1_sel:WORD_1
v_smfmac_f32_16x16x64_bf16 v[12:15], a[148:151], v[44:51], v154 abid:1
ds_read_u16 v88, v88
v_add_u32_sdwa v80, s4, v120 dst_sel:DWORD dst_unused:UNUSED_PAD src0_sel:DWORD src1_sel:WORD_0
v_smfmac_f32_16x16x64_bf16 v[12:15], a[184:187], v[52:59], v158 abid:1
v_add_u32_sdwa v81, s4, v120 dst_sel:DWORD dst_unused:UNUSED_PAD src0_sel:DWORD src1_sel:WORD_1
v_smfmac_f32_16x16x64_bf16 v[12:15], a[220:223], v[92:99], v162 abid:1
ds_read_b128 v[60:63], v0 offset:14336
v_add_u32_sdwa v82, s4, v121 dst_sel:DWORD dst_unused:UNUSED_PAD src0_sel:DWORD src1_sel:WORD_0
v_smfmac_f32_16x16x64_bf16 v[32:35], a[168:171], v[44:51], v157
ds_read_u16 v89, v89
v_add_u32_sdwa v83, s4, v121 dst_sel:DWORD dst_unused:UNUSED_PAD src0_sel:DWORD src1_sel:WORD_1
v_smfmac_f32_16x16x64_bf16 v[32:35], a[204:207], v[52:59], v161
ds_read_b128 v[64:67], v1 offset:14336
v_smfmac_f32_16x16x64_bf16 v[32:35], a[240:243], v[92:99], v165
s_waitcnt lgkmcnt(7)
ds_read_b128 v[68:71], v0 offset:16384
v_smfmac_f32_16x16x64_bf16 v[32:35], v[114:117], v[100:107], v183 abid:1
ds_read_u16 v90, v90
v_smfmac_f32_16x16x64_bf16 v[36:39], v[114:117], v[100:107], v184
ds_read_b128 v[72:75], v1 offset:16384
v_add_u32 v0, s43, v0
v_smfmac_f32_16x16x64_bf16 v[36:39], a[172:175], v[44:51], v157 abid:1
ds_read_u16 v91, v91
v_add_u32 v1, s43, v1
v_smfmac_f32_16x16x64_bf16 v[36:39], a[208:211], v[52:59], v161 abid:1
v_smfmac_f32_16x16x64_bf16 v[36:39], a[244:247], v[92:99], v165 abid:1
ds_read_b128 v[114:117], v2 offset:320
v_smfmac_f32_16x16x64_bf16 v[16:19], a[152:155], v[44:51], v155
v_smfmac_f32_16x16x64_bf16 v[16:19], a[188:191], v[52:59], v159
v_smfmac_f32_16x16x64_bf16 v[16:19], a[224:227], v[92:99], v163
v_smfmac_f32_16x16x64_bf16 v[20:23], a[156:159], v[44:51], v155 abid:1
v_smfmac_f32_16x16x64_bf16 v[20:23], a[192:195], v[52:59], v159 abid:1
v_smfmac_f32_16x16x64_bf16 v[20:23], a[228:231], v[92:99], v163 abid:1
v_smfmac_f32_16x16x64_bf16 v[40:43], a[176:179], v[44:51], v176
s_bitcmp1_b32 s92, s41
v_smfmac_f32_16x16x64_bf16 v[40:43], a[212:215], v[52:59], v176 abid:1
s_cbranch_scc1 L_loopn_w
L_loopn_wb:
v_smfmac_f32_16x16x64_bf16 v[40:43], a[248:251], v[92:99], v177
s_waitcnt lgkmcnt(0)
v_smfmac_f32_16x16x64_bf16 v[40:43], v[114:117], v[84:91], v185
s_waitcnt vmcnt(20)
s_barrier
L_loopn_p3:
v_smfmac_f32_16x16x64_bf16 v[8:11], a[252:255], v[60:67], v166
s_mov_b32 s42, s4
v_smfmac_f32_16x16x64_bf16 v[8:11], v[218:221], v[68:75], v170
ds_read_b128 v[44:47], v0 offset:0
v_add_u32_sdwa v84, s42, v122 dst_sel:DWORD dst_unused:UNUSED_PAD src0_sel:DWORD src1_sel:WORD_0
v_smfmac_f32_16x16x64_bf16 v[12:15], v[186:189], v[60:67], v166 abid:1
ds_read_b128 v[48:51], v1 offset:0
v_add_u32_sdwa v85, s42, v122 dst_sel:DWORD dst_unused:UNUSED_PAD src0_sel:DWORD src1_sel:WORD_1
v_smfmac_f32_16x16x64_bf16 v[12:15], v[222:225], v[68:75], v170 abid:1
ds_read_b128 v[52:55], v0 offset:2048
v_add_u32_sdwa v86, s42, v123 dst_sel:DWORD dst_unused:UNUSED_PAD src0_sel:DWORD src1_sel:WORD_0
v_smfmac_f32_16x16x64_bf16 v[16:19], v[190:193], v[60:67], v167
ds_read_b128 v[56:59], v1 offset:2048
v_cvt_pk_bf16_f32 v92, v8, v9
v_smfmac_f32_16x16x64_bf16 v[16:19], v[226:229], v[68:75], v171
ds_read_u16 v76, v76
v_cvt_pk_bf16_f32 v93, v10, v11
v_smfmac_f32_16x16x64_bf16 v[20:23], v[194:197], v[60:67], v167 abid:1
ds_read_b128 v[8:11], v2 offset:1024
v_cvt_pk_bf16_f32 v94, v12, v13
v_smfmac_f32_16x16x64_bf16 v[20:23], v[230:233], v[68:75], v171 abid:1
ds_read_u16 v77, v77
v_cvt_pk_bf16_f32 v95, v14, v15
v_smfmac_f32_16x16x64_bf16 v[24:27], v[198:201], v[60:67], v168
ds_read_b128 v[12:15], v2 offset:1088
v_cvt_pk_bf16_f32 v96, v16, v17
v_smfmac_f32_16x16x64_bf16 v[24:27], v[234:237], v[68:75], v172
ds_read_u16 v78, v78
v_cvt_pk_bf16_f32 v97, v18, v19
v_smfmac_f32_16x16x64_bf16 v[28:31], v[202:205], v[60:67], v168 abid:1
ds_read_b128 v[16:19], v2 offset:1152
v_cvt_pk_bf16_f32 v98, v20, v21
v_smfmac_f32_16x16x64_bf16 v[28:31], v[238:241], v[68:75], v172 abid:1
ds_read_u16 v79, v79
v_cvt_pk_bf16_f32 v99, v22, v23
v_smfmac_f32_16x16x64_bf16 v[32:35], v[206:209], v[60:67], v169
ds_read_b128 v[20:23], v2 offset:1216
v_cvt_pk_bf16_f32 v100, v24, v25
v_smfmac_f32_16x16x64_bf16 v[32:35], v[242:245], v[68:75], v173
ds_read_u16 v80, v80
v_cvt_pk_bf16_f32 v101, v26, v27
v_smfmac_f32_16x16x64_bf16 v[36:39], v[210:213], v[60:67], v169 abid:1
ds_read_b128 v[24:27], v2 offset:1280
v_cvt_pk_bf16_f32 v102, v28, v29
v_smfmac_f32_16x16x64_bf16 v[36:39], v[246:249], v[68:75], v173 abid:1
ds_read_u16 v81, v81
v_cvt_pk_bf16_f32 v103, v30, v31
v_smfmac_f32_16x16x64_bf16 v[40:43], v[214:217], v[60:67], v177 abid:1
s_bitcmp1_b32 s12, s41
ds_read_b128 v[28:31], v2 offset:1344
v_cvt_pk_bf16_f32 v104, v32, v33
v_smfmac_f32_16x16x64_bf16 v[40:43], v[250:253], v[68:75], v178
s_waitcnt lgkmcnt(10)
v_cvt_pk_bf16_f32 v105, v34, v35
s_cbranch_scc1 L_loopn
s_cmp_eq_u32 s41, s59
s_cbranch_scc1 L_loopc
s_cmp_lt_u32 s41, s15
s_cbranch_scc1 L_loop
s_nop 7
v_cvt_pk_bf16_f32 v106, v36, v37
v_cvt_pk_bf16_f32 v107, v38, v39
v_cvt_pk_bf16_f32 v112, v40, v41
v_cvt_pk_bf16_f32 v113, v42, v43
s_nop 1
v_cndmask_b32_dpp v108, v96, v92, vcc quad_perm:[1,0,3,2] row_mask:0xf bank_mask:0xf
s_nop 1
v_cndmask_b32_dpp v109, v97, v93, vcc quad_perm:[1,0,3,2] row_mask:0xf bank_mask:0xf
s_nop 1
v_cndmask_b32_dpp v110, v98, v94, vcc quad_perm:[1,0,3,2] row_mask:0xf bank_mask:0xf
s_nop 1
v_cndmask_b32_dpp v111, v99, v95, vcc quad_perm:[1,0,3,2] row_mask:0xf bank_mask:0xf
s_waitcnt lgkmcnt(0)
buffer_store_dwordx4 v[108:111], v4, s[20:23], s46 offen offset:0 sc1
s_nop 1
s_mov_b64 vcc, s[82:83]
s_nop 1
v_cndmask_b32_dpp v96, v92, v96, vcc quad_perm:[1,0,3,2] row_mask:0xf bank_mask:0xf
s_nop 1
v_cndmask_b32_dpp v97, v93, v97, vcc quad_perm:[1,0,3,2] row_mask:0xf bank_mask:0xf
s_nop 1
v_cndmask_b32_dpp v98, v94, v98, vcc quad_perm:[1,0,3,2] row_mask:0xf bank_mask:0xf
s_nop 1
v_cndmask_b32_dpp v99, v95, v99, vcc quad_perm:[1,0,3,2] row_mask:0xf bank_mask:0xf
s_waitcnt lgkmcnt(0)
buffer_store_dwordx4 v[96:99], v4, s[20:23], s46 offen offset:1152 sc1
s_nop 1
s_mov_b64 vcc, s[80:81]
s_nop 1
v_cndmask_b32_dpp v92, v104, v100, vcc quad_perm:[1,0,3,2] row_mask:0xf bank_mask:0xf
s_nop 1
v_cndmask_b32_dpp v93, v105, v101, vcc quad_perm:[1,0,3,2] row_mask:0xf bank_mask:0xf
s_nop 1
v_cndmask_b32_dpp v94, v106, v102, vcc quad_perm:[1,0,3,2] row_mask:0xf bank_mask:0xf
s_nop 1
v_cndmask_b32_dpp v95, v107, v103, vcc quad_perm:[1,0,3,2] row_mask:0xf bank_mask:0xf
s_nop 1
ds_bpermute_b32 v112, v6, v112
s_nop 1
ds_bpermute_b32 v113, v6, v113
s_waitcnt lgkmcnt(0)
buffer_store_dwordx4 v[92:95], v4, s[20:23], s46 offen offset:128 sc1
s_nop 1
s_mov_b64 vcc, s[82:83]
s_nop 1
v_cndmask_b32_dpp v104, v100, v104, vcc quad_perm:[1,0,3,2] row_mask:0xf bank_mask:0xf
s_nop 1
v_cndmask_b32_dpp v105, v101, v105, vcc quad_perm:[1,0,3,2] row_mask:0xf bank_mask:0xf
s_nop 1
v_cndmask_b32_dpp v106, v102, v106, vcc quad_perm:[1,0,3,2] row_mask:0xf bank_mask:0xf
s_nop 1
v_cndmask_b32_dpp v107, v103, v107, vcc quad_perm:[1,0,3,2] row_mask:0xf bank_mask:0xf
s_waitcnt lgkmcnt(0)
buffer_store_dwordx4 v[104:107], v4, s[20:23], s46 offen offset:1280 sc1
s_nop 1
s_mov_b64 vcc, s[80:81]
s_waitcnt lgkmcnt(0)
buffer_store_dwordx2 v[112:113], v5, s[20:23], s46 offen
s_nop 1
L_fin:
L_end_standalone__structured_sparse_n_m__ragged_kernel:
s_endpgm
L_more1:
v_and_b32 v73, v94, v16
v_lshrrev_b32 v72, 10, v16
v_cmp_eq_u32 s[64:65], v73, v95
v_and_or_b32 v32, v72, v96, v97
s_mov_b64 exec, s[64:65]
ds_add_rtn_u32 v48, v32, v88
s_mov_b64 exec, -1
v_and_b32 v73, v94, v17
v_lshrrev_b32 v72, 10, v17
v_cmp_eq_u32 s[66:67], v73, v95
v_and_or_b32 v33, v72, v96, v97
s_mov_b64 exec, s[66:67]
ds_add_rtn_u32 v49, v33, v88
s_mov_b64 exec, -1
v_and_b32 v73, v94, v18
v_lshrrev_b32 v72, 10, v18
v_cmp_eq_u32 s[68:69], v73, v95
v_and_or_b32 v34, v72, v96, v97
s_mov_b64 exec, s[68:69]
ds_add_rtn_u32 v50, v34, v88
s_mov_b64 exec, -1
v_and_b32 v73, v94, v19
v_lshrrev_b32 v72, 10, v19
v_cmp_eq_u32 s[70:71], v73, v95
v_and_or_b32 v35, v72, v96, v97
s_mov_b64 exec, s[70:71]
ds_add_rtn_u32 v51, v35, v88
s_mov_b64 exec, -1
v_and_b32 v73, v94, v20
v_lshrrev_b32 v72, 10, v20
v_cmp_eq_u32 s[72:73], v73, v95
v_and_or_b32 v36, v72, v96, v97
s_mov_b64 exec, s[72:73]
ds_add_rtn_u32 v52, v36, v88
s_mov_b64 exec, -1
v_and_b32 v73, v94, v21
v_lshrrev_b32 v72, 10, v21
v_cmp_eq_u32 s[74:75], v73, v95
v_and_or_b32 v37, v72, v96, v97
s_mov_b64 exec, s[74:75]
ds_add_rtn_u32 v53, v37, v88
s_mov_b64 exec, -1
v_and_b32 v73, v94, v22
v_lshrrev_b32 v72, 10, v22
v_cmp_eq_u32 s[76:77], v73, v95
v_and_or_b32 v38, v72, v96, v97
s_mov_b64 exec, s[76:77]
ds_add_rtn_u32 v54, v38, v88
s_mov_b64 exec, -1
s_branch L_more1b
L_greedy:
s_mov_b32 s47, 0
s_mov_b32 s89, 1
v_readlane_b32 s3, v72, 0
s_max_u32 s47, s47, 0
v_writelane_b32 v91, s47, 0
s_nop 1
s_add_u32 s47, s47, s3
s_cmp_gt_u32 s47, 32
s_cselect_b32 s90, 1, s90
v_readlane_b32 s3, v72, 1
s_max_u32 s47, s47, 0
v_writelane_b32 v91, s47, 1
s_nop 1
s_add_u32 s47, s47, s3
s_cmp_gt_u32 s47, 64
s_cselect_b32 s90, 1, s90
v_readlane_b32 s3, v72, 2
s_max_u32 s47, s47, 32
v_writelane_b32 v91, s47, 2
s_nop 1
s_add_u32 s47, s47, s3
s_cmp_gt_u32 s47, 64
s_cselect_b32 s90, 1, s90
v_readlane_b32 s3, v72, 3
s_max_u32 s47, s47, 32
v_writelane_b32 v91, s47, 3
s_nop 1
s_add_u32 s47, s47, s3
s_cmp_gt_u32 s47, 96
s_cselect_b32 s90, 1, s90
v_readlane_b32 s3, v72, 4
s_max_u32 s47, s47, 64
v_writelane_b32 v91, s47, 4
s_nop 1
s_add_u32 s47, s47, s3
s_cmp_gt_u32 s47, 96
s_cselect_b32 s90, 1, s90
v_readlane_b32 s3, v72, 5
s_max_u32 s47, s47, 64
v_writelane_b32 v91, s47, 5
s_nop 1
s_add_u32 s47, s47, s3
s_cmp_gt_u32 s47, 128
s_cselect_b32 s90, 1, s90
v_readlane_b32 s3, v72, 6
s_max_u32 s47, s47, 96
v_writelane_b32 v91, s47, 6
s_nop 1
s_add_u32 s47, s47, s3
s_cmp_gt_u32 s47, 128
s_cselect_b32 s90, 1, s90
v_readlane_b32 s3, v72, 7
s_max_u32 s47, s47, 96
v_writelane_b32 v91, s47, 7
s_nop 1
s_add_u32 s47, s47, s3
s_cmp_gt_u32 s47, 160
s_cselect_b32 s90, 1, s90
v_readlane_b32 s3, v72, 8
s_max_u32 s47, s47, 128
v_writelane_b32 v91, s47, 8
s_nop 1
s_add_u32 s47, s47, s3
s_cmp_gt_u32 s47, 160
s_cselect_b32 s90, 1, s90
s_cmp_lg_u32 s90, 0
s_cselect_b64 s[90:91], -1, 0
v_mov_b32 v73, 163072
s_mov_b64 exec, s[90:91]
ds_write_b32 v73, v88
s_mov_b64 exec, -1
s_branch L_greedyb
L_more2:
ds_bpermute_b32 v64, v32, v91
ds_bpermute_b32 v65, v33, v91
ds_bpermute_b32 v66, v34, v91
ds_bpermute_b32 v67, v35, v91
ds_bpermute_b32 v68, v36, v91
ds_bpermute_b32 v69, v37, v91
ds_bpermute_b32 v70, v38, v91
s_waitcnt lgkmcnt(0)
v_add_u32 v73, v48, v64
v_and_b32 v72, 0x87e, v16
v_lshl_add_u32 v73, v73, 1, s93
v_add_u32 v72, v90, v72
s_andn2_b64 exec, s[64:65], s[90:91]
ds_write_b16_d16_hi v73, v16 offset:64
ds_write_b16 v73, v72 offset:384
ds_write_b16 v73, v16 offset:704
s_mov_b64 exec, -1
v_add_u32 v73, v49, v65
v_and_b32 v72, 0x87e, v17
v_lshl_add_u32 v73, v73, 1, s93
v_add_u32 v72, v90, v72
s_andn2_b64 exec, s[66:67], s[90:91]
ds_write_b16_d16_hi v73, v17 offset:64
ds_write_b16 v73, v72 offset:384
ds_write_b16 v73, v17 offset:704
s_mov_b64 exec, -1
v_add_u32 v73, v50, v66
v_and_b32 v72, 0x87e, v18
v_lshl_add_u32 v73, v73, 1, s93
v_add_u32 v72, v90, v72
s_andn2_b64 exec, s[68:69], s[90:91]
ds_write_b16_d16_hi v73, v18 offset:64
ds_write_b16 v73, v72 offset:384
ds_write_b16 v73, v18 offset:704
s_mov_b64 exec, -1
v_add_u32 v73, v51, v67
v_and_b32 v72, 0x87e, v19
v_lshl_add_u32 v73, v73, 1, s93
v_add_u32 v72, v90, v72
s_andn2_b64 exec, s[70:71], s[90:91]
ds_write_b16_d16_hi v73, v19 offset:64
ds_write_b16 v73, v72 offset:384
ds_write_b16 v73, v19 offset:704
s_mov_b64 exec, -1
v_add_u32 v73, v52, v68
v_and_b32 v72, 0x87e, v20
v_lshl_add_u32 v73, v73, 1, s93
v_add_u32 v72, v90, v72
s_andn2_b64 exec, s[72:73], s[90:91]
ds_write_b16_d16_hi v73, v20 offset:64
ds_write_b16 v73, v72 offset:384
ds_write_b16 v73, v20 offset:704
s_mov_b64 exec, -1
v_add_u32 v73, v53, v69
v_and_b32 v72, 0x87e, v21
v_lshl_add_u32 v73, v73, 1, s93
v_add_u32 v72, v90, v72
s_andn2_b64 exec, s[74:75], s[90:91]
ds_write_b16_d16_hi v73, v21 offset:64
ds_write_b16 v73, v72 offset:384
ds_write_b16 v73, v21 offset:704
s_mov_b64 exec, -1
v_add_u32 v73, v54, v70
v_and_b32 v72, 0x87e, v22
v_lshl_add_u32 v73, v73, 1, s93
v_add_u32 v72, v90, v72
s_andn2_b64 exec, s[76:77], s[90:91]
ds_write_b16_d16_hi v73, v22 offset:64
ds_write_b16 v73, v72 offset:384
ds_write_b16 v73, v22 offset:704
s_mov_b64 exec, -1
s_branch L_more2b
L_giveup:
s_waitcnt vmcnt(0)
v_mov_b32 v8, 163072
v_mov_b32 v9, 1
ds_write_b32 v8, v9
s_branch L_polled
L_loop_w:
s_bitcmp1_b32 s87, s41
s_waitcnt vmcnt(15)
s_cbranch_scc0 L_loop_wb
s_waitcnt vmcnt(10)
s_branch L_loop_wb
L_loopn_w:
s_bitcmp1_b32 s87, s41
s_waitcnt vmcnt(15)
s_cbranch_scc0 L_loopn_wb
s_waitcnt vmcnt(10)
s_branch L_loopn_wb
L_linked:
.p2align 6
L_loopk:
v_smfmac_f32_16x16x64_bf16 v[8:11], a[0:3], v[44:51], v138
ds_read_b128 v[32:35], v2 offset:1408
v_cvt_pk_bf16_f32 v106, v36, v37
v_smfmac_f32_16x16x64_bf16 v[8:11], a[36:39], v[52:59], v142
s_waitcnt lgkmcnt(9)
v_cvt_pk_bf16_f32 v107, v38, v39
v_smfmac_f32_16x16x64_bf16 v[12:15], a[4:7], v[44:51], v138 abid:1
ds_read_b128 v[36:39], v2 offset:1472
v_cvt_pk_bf16_f32 v112, v40, v41
v_smfmac_f32_16x16x64_bf16 v[12:15], a[40:43], v[52:59], v142 abid:1
s_waitcnt lgkmcnt(8)
ds_read_b128 v[60:63], v0 offset:4096
v_cvt_pk_bf16_f32 v113, v42, v43
v_smfmac_f32_16x16x64_bf16 v[16:19], a[8:11], v[44:51], v139
s_cmp_eq_u32 s4, 129920
ds_read_b128 v[40:43], v2 offset:1536
v_cndmask_b32_dpp v108, v96, v92, vcc quad_perm:[1,0,3,2] row_mask:0xf bank_mask:0xf
v_smfmac_f32_16x16x64_bf16 v[16:19], a[44:47], v[52:59], v143
s_waitcnt lgkmcnt(8)
ds_read_u16 v82, v82
v_cndmask_b32_dpp v109, v97, v93, vcc quad_perm:[1,0,3,2] row_mask:0xf bank_mask:0xf
v_smfmac_f32_16x16x64_bf16 v[20:23], a[12:15], v[44:51], v139 abid:1
s_cselect_b32 s43, -129920, s5
ds_read_u16 v84, v84
v_cndmask_b32_dpp v110, v98, v94, vcc quad_perm:[1,0,3,2] row_mask:0xf bank_mask:0xf
v_smfmac_f32_16x16x64_bf16 v[20:23], a[48:51], v[52:59], v143 abid:1
s_waitcnt lgkmcnt(8)
ds_read_b128 v[64:67], v1 offset:4096
v_cndmask_b32_dpp v111, v99, v95, vcc quad_perm:[1,0,3,2] row_mask:0xf bank_mask:0xf
v_smfmac_f32_16x16x64_bf16 v[24:27], a[16:19], v[44:51], v140
s_add_u32 s4, s4, s43
ds_read_b128 v[68:71], v0 offset:6144
v_add_u32_sdwa v87, s42, v123 dst_sel:DWORD dst_unused:UNUSED_PAD src0_sel:DWORD src1_sel:WORD_1
v_smfmac_f32_16x16x64_bf16 v[24:27], a[52:55], v[52:59], v144
buffer_store_dwordx4 v[108:111], v4, s[20:23], s46 offen offset:0 sc1
s_mov_b64 vcc, s[82:83]
s_waitcnt lgkmcnt(8)
ds_read_b128 v[72:75], v1 offset:6144
v_cndmask_b32_dpp v96, v92, v96, vcc quad_perm:[1,0,3,2] row_mask:0xf bank_mask:0xf
v_cndmask_b32_dpp v97, v93, v97, vcc quad_perm:[1,0,3,2] row_mask:0xf bank_mask:0xf
v_smfmac_f32_16x16x64_bf16 v[28:31], a[20:23], v[44:51], v140 abid:1
s_add_u32 s41, s41, 1
ds_read_u16 v83, v83
v_cndmask_b32_dpp v98, v94, v98, vcc quad_perm:[1,0,3,2] row_mask:0xf bank_mask:0xf
v_smfmac_f32_16x16x64_bf16 v[28:31], a[56:59], v[52:59], v144 abid:1
s_waitcnt lgkmcnt(9)
ds_read_b128 v[114:117], v2 offset:64
v_cndmask_b32_dpp v99, v95, v99, vcc quad_perm:[1,0,3,2] row_mask:0xf bank_mask:0xf
v_smfmac_f32_16x16x64_bf16 v[32:35], a[24:27], v[44:51], v141
ds_read_u16 v85, v85
v_add_u32_sdwa v88, s42, v124 dst_sel:DWORD dst_unused:UNUSED_PAD src0_sel:DWORD src1_sel:WORD_0
v_smfmac_f32_16x16x64_bf16 v[32:35], a[60:63], v[52:59], v145
s_waitcnt lgkmcnt(10)
ds_read_u16 v86, v86
v_add_u32_sdwa v89, s42, v124 dst_sel:DWORD dst_unused:UNUSED_PAD src0_sel:DWORD src1_sel:WORD_1
v_smfmac_f32_16x16x64_bf16 v[36:39], a[28:31], v[44:51], v141 abid:1
ds_read_u16 v87, v87
v_add_u32_sdwa v90, s42, v125 dst_sel:DWORD dst_unused:UNUSED_PAD src0_sel:DWORD src1_sel:WORD_0
v_smfmac_f32_16x16x64_bf16 v[36:39], a[64:67], v[52:59], v145 abid:1
s_waitcnt lgkmcnt(10)
ds_read_u16 v88, v88
v_add_u32_sdwa v91, s42, v125 dst_sel:DWORD dst_unused:UNUSED_PAD src0_sel:DWORD src1_sel:WORD_1
v_smfmac_f32_16x16x64_bf16 v[40:43], a[32:35], v[44:51], v174
buffer_store_dwordx4 v[96:99], v4, s[20:23], s46 offen offset:1152 sc1
s_mov_b64 vcc, s[80:81]
ds_read_u16 v89, v89
v_cndmask_b32_dpp v92, v104, v100, vcc quad_perm:[1,0,3,2] row_mask:0xf bank_mask:0xf
v_cndmask_b32_dpp v93, v105, v101, vcc quad_perm:[1,0,3,2] row_mask:0xf bank_mask:0xf
v_smfmac_f32_16x16x64_bf16 v[40:43], a[68:71], v[52:59], v174 abid:1
s_waitcnt lgkmcnt(9)
ds_read_u16 v90, v90
v_cndmask_b32_dpp v94, v106, v102, vcc quad_perm:[1,0,3,2] row_mask:0xf bank_mask:0xf
v_smfmac_f32_16x16x64_bf16 v[8:11], a[72:75], v[60:67], v146
s_waitcnt lgkmcnt(8)
ds_read_u16 v91, v91
v_cndmask_b32_dpp v95, v107, v103, vcc quad_perm:[1,0,3,2] row_mask:0xf bank_mask:0xf
v_smfmac_f32_16x16x64_bf16 v[8:11], a[108:111], v[68:75], v150
s_waitcnt lgkmcnt(7)
ds_bpermute_b32 v112, v6, v112
v_smfmac_f32_16x16x64_bf16 v[8:11], v[114:117], v[76:83], v179
ds_bpermute_b32 v113, v6, v113
v_smfmac_f32_16x16x64_bf16 v[12:15], v[114:117], v[76:83], v179 abid:1
ds_read_b128 v[114:117], v2 offset:128
v_add_u32_sdwa v76, s42, v126 dst_sel:DWORD dst_unused:UNUSED_PAD src0_sel:DWORD src1_sel:WORD_0
v_smfmac_f32_16x16x64_bf16 v[12:15], a[76:79], v[60:67], v146 abid:1
ds_read_u16 v76, v76
v_add_u32_sdwa v77, s42, v126 dst_sel:DWORD dst_unused:UNUSED_PAD src0_sel:DWORD src1_sel:WORD_1
v_smfmac_f32_16x16x64_bf16 v[12:15], a[112:115], v[68:75], v150 abid:1
buffer_store_dwordx4 v[92:95], v4, s[20:23], s46 offen offset:128 sc1
s_mov_b64 vcc, s[82:83]
ds_read_u16 v77, v77
v_cndmask_b32_dpp v104, v100, v104, vcc quad_perm:[1,0,3,2] row_mask:0xf bank_mask:0xf
v_cndmask_b32_dpp v105, v101, v105, vcc quad_perm:[1,0,3,2] row_mask:0xf bank_mask:0xf
v_smfmac_f32_16x16x64_bf16 v[24:27], a[88:91], v[60:67], v148
ds_read_b128 v[44:47], v0 offset:8192
v_add_u32_sdwa v78, s42, v127 dst_sel:DWORD dst_unused:UNUSED_PAD src0_sel:DWORD src1_sel:WORD_0
v_smfmac_f32_16x16x64_bf16 v[24:27], a[124:127], v[68:75], v152
ds_read_u16 v78, v78
v_cndmask_b32_dpp v106, v102, v106, vcc quad_perm:[1,0,3,2] row_mask:0xf bank_mask:0xf
v_smfmac_f32_16x16x64_bf16 v[28:31], a[92:95], v[60:67], v148 abid:1
ds_read_b128 v[48:51], v1 offset:8192
v_cndmask_b32_dpp v107, v103, v107, vcc quad_perm:[1,0,3,2] row_mask:0xf bank_mask:0xf
v_smfmac_f32_16x16x64_bf16 v[28:31], a[128:131], v[68:75], v152 abid:1
ds_read_b128 v[52:55], v0 offset:10240
v_add_u32_sdwa v79, s42, v127 dst_sel:DWORD dst_unused:UNUSED_PAD src0_sel:DWORD src1_sel:WORD_1
v_smfmac_f32_16x16x64_bf16 v[32:35], a[96:99], v[60:67], v149
ds_read_u16 v79, v79
v_add_u32_sdwa v80, s42, v128 dst_sel:DWORD dst_unused:UNUSED_PAD src0_sel:DWORD src1_sel:WORD_0
v_smfmac_f32_16x16x64_bf16 v[32:35], a[132:135], v[68:75], v153
ds_read_u16 v80, v80
v_add_u32_sdwa v81, s42, v128 dst_sel:DWORD dst_unused:UNUSED_PAD src0_sel:DWORD src1_sel:WORD_1
v_smfmac_f32_16x16x64_bf16 v[16:19], a[80:83], v[60:67], v147
buffer_store_dwordx4 v[104:107], v4, s[20:23], s46 offen offset:1280 sc1
s_mov_b64 vcc, s[80:81]
ds_read_b128 v[56:59], v1 offset:10240
v_add_u32_sdwa v82, s42, v129 dst_sel:DWORD dst_unused:UNUSED_PAD src0_sel:DWORD src1_sel:WORD_0
v_add_u32_sdwa v83, s42, v129 dst_sel:DWORD dst_unused:UNUSED_PAD src0_sel:DWORD src1_sel:WORD_1
v_smfmac_f32_16x16x64_bf16 v[16:19], a[116:119], v[68:75], v151
s_waitcnt lgkmcnt(9)
ds_read_b128 v[92:95], v0 offset:12288
v_add_u32_sdwa v100, s42, v130 dst_sel:DWORD dst_unused:UNUSED_PAD src0_sel:DWORD src1_sel:WORD_0
v_smfmac_f32_16x16x64_bf16 v[16:19], v[114:117], v[84:91], v180 abid:1
ds_read_u16 v81, v81
v_add_u32_sdwa v101, s42, v130 dst_sel:DWORD dst_unused:UNUSED_PAD src0_sel:DWORD src1_sel:WORD_1
v_smfmac_f32_16x16x64_bf16 v[12:15], v[114:117], v[84:91], v180
ds_read_b128 v[96:99], v1 offset:12288
v_add_u32_sdwa v102, s42, v131 dst_sel:DWORD dst_unused:UNUSED_PAD src0_sel:DWORD src1_sel:WORD_0
v_smfmac_f32_16x16x64_bf16 v[20:23], v[114:117], v[84:91], v181
ds_read_u16 v82, v82
v_add_u32_sdwa v103, s42, v131 dst_sel:DWORD dst_unused:UNUSED_PAD src0_sel:DWORD src1_sel:WORD_1
v_smfmac_f32_16x16x64_bf16 v[20:23], a[84:87], v[60:67], v147 abid:1
ds_read_u16 v100, v100
v_add_u32_sdwa v104, s42, v132 dst_sel:DWORD dst_unused:UNUSED_PAD src0_sel:DWORD src1_sel:WORD_0
v_smfmac_f32_16x16x64_bf16 v[20:23], a[120:123], v[68:75], v151 abid:1
ds_read_u16 v83, v83
v_add_u32_sdwa v105, s42, v132 dst_sel:DWORD dst_unused:UNUSED_PAD src0_sel:DWORD src1_sel:WORD_1
v_smfmac_f32_16x16x64_bf16 v[36:39], a[100:103], v[60:67], v149 abid:1
buffer_store_dwordx2 v[112:113], v5, s[20:23], s46 offen
ds_read_b128 v[114:117], v2 offset:192
v_add_u32_sdwa v106, s42, v133 dst_sel:DWORD dst_unused:UNUSED_PAD src0_sel:DWORD src1_sel:WORD_0
v_smfmac_f32_16x16x64_bf16 v[36:39], a[136:139], v[68:75], v153 abid:1
s_mov_b32 s22, 75497472
ds_read_u16 v101, v101
v_add_u32_sdwa v107, s42, v133 dst_sel:DWORD dst_unused:UNUSED_PAD src0_sel:DWORD src1_sel:WORD_1
v_smfmac_f32_16x16x64_bf16 v[40:43], a[104:107], v[60:67], v175
s_mov_b32 s46, s48
ds_read_u16 v102, v102
v_add_u32_sdwa v84, s42, v134 dst_sel:DWORD dst_unused:UNUSED_PAD src0_sel:DWORD src1_sel:WORD_0
v_smfmac_f32_16x16x64_bf16 v[40:43], a[140:143], v[68:75], v175 abid:1
s_waitcnt lgkmcnt(13)
ds_read_u16 v103, v103
v_add_u32_sdwa v85, s42, v134 dst_sel:DWORD dst_unused:UNUSED_PAD src0_sel:DWORD src1_sel:WORD_1
v_smfmac_f32_16x16x64_bf16 v[8:11], a[144:147], v[44:51], v154
s_waitcnt lgkmcnt(10)
ds_read_u16 v104, v104
v_add_u32_sdwa v86, s42, v135 dst_sel:DWORD dst_unused:UNUSED_PAD src0_sel:DWORD src1_sel:WORD_0
v_smfmac_f32_16x16x64_bf16 v[8:11], a[180:183], v[52:59], v158
s_waitcnt lgkmcnt(8)
ds_read_u16 v105, v105
v_add_u32_sdwa v87, s42, v135 dst_sel:DWORD dst_unused:UNUSED_PAD src0_sel:DWORD src1_sel:WORD_1
v_smfmac_f32_16x16x64_bf16 v[8:11], a[216:219], v[92:99], v162
s_add_u32 m0, s44, 0
ds_read_u16 v106, v106
v_add_u32_sdwa v88, s42, v136 dst_sel:DWORD dst_unused:UNUSED_PAD src0_sel:DWORD src1_sel:WORD_0
v_smfmac_f32_16x16x64_bf16 v[24:27], a[160:163], v[44:51], v156
buffer_load_dwordx4 v3, s[16:19], s45 offen offset:0 nt lds
v_add_u32_sdwa v89, s42, v136 dst_sel:DWORD dst_unused:UNUSED_PAD src0_sel:DWORD src1_sel:WORD_1
v_smfmac_f32_16x16x64_bf16 v[24:27], a[196:199], v[52:59], v160
s_mov_b32 s48, s49
ds_read_u16 v107, v107
v_add_u32_sdwa v90, s42, v137 dst_sel:DWORD dst_unused:UNUSED_PAD src0_sel:DWORD src1_sel:WORD_0
v_smfmac_f32_16x16x64_bf16 v[24:27], a[232:235], v[92:99], v164
s_waitcnt lgkmcnt(7)
ds_read_u16 v84, v84
v_add_u32_sdwa v91, s42, v137 dst_sel:DWORD dst_unused:UNUSED_PAD src0_sel:DWORD src1_sel:WORD_1
v_smfmac_f32_16x16x64_bf16 v[24:27], v[114:117], v[76:83], v182
s_mov_b32 s49, s50
ds_read_u16 v85, v85
v_smfmac_f32_16x16x64_bf16 v[20:23], v[114:117], v[76:83], v181 abid:1
s_add_u32 s50, s50, 4718592
ds_read_u16 v86, v86
v_smfmac_f32_16x16x64_bf16 v[28:31], v[114:117], v[76:83], v182 abid:1
ds_read_b128 v[114:117], v2 offset:256
v_add_u32_sdwa v76, s4, v118 dst_sel:DWORD dst_unused:UNUSED_PAD src0_sel:DWORD src1_sel:WORD_0
v_smfmac_f32_16x16x64_bf16 v[28:31], a[164:167], v[44:51], v156 abid:1
ds_read_u16 v87, v87
v_add_u32_sdwa v77, s4, v118 dst_sel:DWORD dst_unused:UNUSED_PAD src0_sel:DWORD src1_sel:WORD_1
v_smfmac_f32_16x16x64_bf16 v[28:31], a[200:203], v[52:59], v160 abid:1
ds_read_u16 v88, v88
v_add_u32_sdwa v78, s4, v119 dst_sel:DWORD dst_unused:UNUSED_PAD src0_sel:DWORD src1_sel:WORD_0
v_smfmac_f32_16x16x64_bf16 v[28:31], a[236:239], v[92:99], v164 abid:1
ds_read_b128 v[60:63], v0 offset:14336
v_add_u32_sdwa v79, s4, v119 dst_sel:DWORD dst_unused:UNUSED_PAD src0_sel:DWORD src1_sel:WORD_1
v_smfmac_f32_16x16x64_bf16 v[12:15], a[148:151], v[44:51], v154 abid:1
ds_read_u16 v89, v89
v_add_u32_sdwa v80, s4, v120 dst_sel:DWORD dst_unused:UNUSED_PAD src0_sel:DWORD src1_sel:WORD_0
v_smfmac_f32_16x16x64_bf16 v[12:15], a[184:187], v[52:59], v158 abid:1
s_add_u32 m0, s44, 3840
ds_read_b128 v[64:67], v1 offset:14336
v_add_u32_sdwa v81, s4, v120 dst_sel:DWORD dst_unused:UNUSED_PAD src0_sel:DWORD src1_sel:WORD_1
v_smfmac_f32_16x16x64_bf16 v[12:15], a[220:223], v[92:99], v162 abid:1
buffer_load_dwordx4 v3, s[16:19], s45 offen offset:256 nt lds
v_add_u32_sdwa v82, s4, v121 dst_sel:DWORD dst_unused:UNUSED_PAD src0_sel:DWORD src1_sel:WORD_0
v_smfmac_f32_16x16x64_bf16 v[32:35], a[168:171], v[44:51], v157
ds_read_b128 v[68:71], v0 offset:16384
v_add_u32_sdwa v83, s4, v121 dst_sel:DWORD dst_unused:UNUSED_PAD src0_sel:DWORD src1_sel:WORD_1
v_smfmac_f32_16x16x64_bf16 v[32:35], a[204:207], v[52:59], v161
ds_read_u16 v90, v90
v_smfmac_f32_16x16x64_bf16 v[32:35], a[240:243], v[92:99], v165
s_waitcnt lgkmcnt(7)
ds_read_b128 v[72:75], v1 offset:16384
v_add_u32 v0, s43, v0
v_smfmac_f32_16x16x64_bf16 v[32:35], v[114:117], v[100:107], v183 abid:1
ds_read_u16 v91, v91
v_add_u32 v1, s43, v1
v_smfmac_f32_16x16x64_bf16 v[28:31], v[114:117], v[100:107], v183
v_smfmac_f32_16x16x64_bf16 v[36:39], v[114:117], v[100:107], v184
ds_read_b128 v[114:117], v2 offset:320
v_smfmac_f32_16x16x64_bf16 v[36:39], a[172:175], v[44:51], v157 abid:1
s_add_u32 m0, s44, 7680
v_smfmac_f32_16x16x64_bf16 v[36:39], a[208:211], v[52:59], v161 abid:1
buffer_load_dwordx4 v3, s[16:19], s45 offen offset:512 nt lds
v_smfmac_f32_16x16x64_bf16 v[36:39], a[244:247], v[92:99], v165 abid:1
v_smfmac_f32_16x16x64_bf16 v[16:19], a[152:155], v[44:51], v155
s_add_u32 m0, s44, 11520
v_smfmac_f32_16x16x64_bf16 v[16:19], a[188:191], v[52:59], v159
buffer_load_dwordx4 v3, s[16:19], s45 offen offset:768 nt lds
v_smfmac_f32_16x16x64_bf16 v[16:19], a[224:227], v[92:99], v163
v_smfmac_f32_16x16x64_bf16 v[20:23], a[156:159], v[44:51], v155 abid:1
s_add_u32 m0, s44, s8
v_smfmac_f32_16x16x64_bf16 v[20:23], a[192:195], v[52:59], v159 abid:1
s_mov_b64 exec, s[10:11]
buffer_load_dwordx4 v3, s[16:19], s7 offen offset:896 nt lds
s_mov_b64 exec, -1
v_smfmac_f32_16x16x64_bf16 v[20:23], a[228:231], v[92:99], v163 abid:1
s_add_u32 s45, s45, 4718592
s_add_u32 s7, s7, 4718592
s_add_u32 s44, s44, s5
v_smfmac_f32_16x16x64_bf16 v[40:43], a[176:179], v[44:51], v176
s_cmp_ge_u32 s44, 148480
s_cselect_b32 s44, s9, s44
s_bitcmp1_b32 s92, s41
v_smfmac_f32_16x16x64_bf16 v[40:43], a[212:215], v[52:59], v176 abid:1
s_cbranch_scc1 L_loopk_w
L_loopk_wb:
v_smfmac_f32_16x16x64_bf16 v[40:43], a[248:251], v[92:99], v177
s_waitcnt lgkmcnt(0)
v_smfmac_f32_16x16x64_bf16 v[40:43], v[114:117], v[84:91], v185
v_smfmac_f32_16x16x64_bf16 v[36:39], v[114:117], v[84:91], v184 abid:1
s_waitcnt vmcnt(20)
s_barrier
v_smfmac_f32_16x16x64_bf16 v[8:11], a[252:255], v[60:67], v166
s_mov_b32 s42, s4
v_smfmac_f32_16x16x64_bf16 v[8:11], v[218:221], v[68:75], v170
ds_read_b128 v[44:47], v0 offset:0
v_add_u32_sdwa v84, s42, v122 dst_sel:DWORD dst_unused:UNUSED_PAD src0_sel:DWORD src1_sel:WORD_0
v_smfmac_f32_16x16x64_bf16 v[12:15], v[186:189], v[60:67], v166 abid:1
ds_read_b128 v[48:51], v1 offset:0
v_add_u32_sdwa v85, s42, v122 dst_sel:DWORD dst_unused:UNUSED_PAD src0_sel:DWORD src1_sel:WORD_1
v_smfmac_f32_16x16x64_bf16 v[12:15], v[222:225], v[68:75], v170 abid:1
ds_read_b128 v[52:55], v0 offset:2048
v_add_u32_sdwa v86, s42, v123 dst_sel:DWORD dst_unused:UNUSED_PAD src0_sel:DWORD src1_sel:WORD_0
v_smfmac_f32_16x16x64_bf16 v[16:19], v[190:193], v[60:67], v167
ds_read_b128 v[56:59], v1 offset:2048
v_cvt_pk_bf16_f32 v92, v8, v9
v_smfmac_f32_16x16x64_bf16 v[16:19], v[226:229], v[68:75], v171
ds_read_u16 v76, v76
v_cvt_pk_bf16_f32 v93, v10, v11
v_smfmac_f32_16x16x64_bf16 v[20:23], v[194:197], v[60:67], v167 abid:1
ds_read_b128 v[8:11], v2 offset:1024
v_cvt_pk_bf16_f32 v94, v12, v13
v_smfmac_f32_16x16x64_bf16 v[20:23], v[230:233], v[68:75], v171 abid:1
ds_read_u16 v77, v77
v_cvt_pk_bf16_f32 v95, v14, v15
v_smfmac_f32_16x16x64_bf16 v[24:27], v[198:201], v[60:67], v168
ds_read_b128 v[12:15], v2 offset:1088
v_cvt_pk_bf16_f32 v96, v16, v17
v_smfmac_f32_16x16x64_bf16 v[24:27], v[234:237], v[68:75], v172
ds_read_u16 v78, v78
v_cvt_pk_bf16_f32 v97, v18, v19
v_smfmac_f32_16x16x64_bf16 v[28:31], v[202:205], v[60:67], v168 abid:1
ds_read_b128 v[16:19], v2 offset:1152
v_cvt_pk_bf16_f32 v98, v20, v21
v_smfmac_f32_16x16x64_bf16 v[28:31], v[238:241], v[68:75], v172 abid:1
ds_read_u16 v79, v79
v_cvt_pk_bf16_f32 v99, v22, v23
v_smfmac_f32_16x16x64_bf16 v[32:35], v[206:209], v[60:67], v169
ds_read_b128 v[20:23], v2 offset:1216
v_cvt_pk_bf16_f32 v100, v24, v25
v_smfmac_f32_16x16x64_bf16 v[32:35], v[242:245], v[68:75], v173
ds_read_u16 v80, v80
v_cvt_pk_bf16_f32 v101, v26, v27
v_smfmac_f32_16x16x64_bf16 v[36:39], v[210:213], v[60:67], v169 abid:1
ds_read_b128 v[24:27], v2 offset:1280
v_cvt_pk_bf16_f32 v102, v28, v29
v_smfmac_f32_16x16x64_bf16 v[36:39], v[246:249], v[68:75], v173 abid:1
ds_read_u16 v81, v81
v_cvt_pk_bf16_f32 v103, v30, v31
v_smfmac_f32_16x16x64_bf16 v[40:43], v[214:217], v[60:67], v177 abid:1
s_bitcmp1_b32 s85, s41
ds_read_b128 v[28:31], v2 offset:1344
v_cvt_pk_bf16_f32 v104, v32, v33
v_smfmac_f32_16x16x64_bf16 v[40:43], v[250:253], v[68:75], v178
s_waitcnt lgkmcnt(10)
v_cvt_pk_bf16_f32 v105, v34, v35
s_cbranch_scc1 L_loopk
s_cmp_lg_u32 s41, 5
s_cbranch_scc1 L_loopnk
.p2align 3
L_loopck:
v_smfmac_f32_16x16x64_bf16 v[8:11], a[0:3], v[44:51], v138
ds_read_b128 v[32:35], v2 offset:1408
v_cvt_pk_bf16_f32 v106, v36, v37
v_mov_b32 v7, 1
v_smfmac_f32_16x16x64_bf16 v[8:11], a[36:39], v[52:59], v142
s_waitcnt lgkmcnt(9)
buffer_atomic_add v7, v6, s[32:35], 0 offen sc0 sc1
v_cvt_pk_bf16_f32 v107, v38, v39
v_smfmac_f32_16x16x64_bf16 v[12:15], a[4:7], v[44:51], v138 abid:1
ds_read_b128 v[36:39], v2 offset:1472
v_cvt_pk_bf16_f32 v112, v40, v41
v_smfmac_f32_16x16x64_bf16 v[12:15], a[40:43], v[52:59], v142 abid:1
s_waitcnt lgkmcnt(8)
ds_read_b128 v[60:63], v0 offset:4096
v_cvt_pk_bf16_f32 v113, v42, v43
v_smfmac_f32_16x16x64_bf16 v[16:19], a[8:11], v[44:51], v139
s_cmp_eq_u32 s4, 129920
ds_read_b128 v[40:43], v2 offset:1536
v_cndmask_b32_dpp v108, v96, v92, vcc quad_perm:[1,0,3,2] row_mask:0xf bank_mask:0xf
v_smfmac_f32_16x16x64_bf16 v[16:19], a[44:47], v[52:59], v143
s_waitcnt lgkmcnt(8)
ds_read_u16 v82, v82
v_cndmask_b32_dpp v109, v97, v93, vcc quad_perm:[1,0,3,2] row_mask:0xf bank_mask:0xf
v_smfmac_f32_16x16x64_bf16 v[20:23], a[12:15], v[44:51], v139 abid:1
s_cselect_b32 s43, -129920, s5
ds_read_u16 v84, v84
v_cndmask_b32_dpp v110, v98, v94, vcc quad_perm:[1,0,3,2] row_mask:0xf bank_mask:0xf
v_smfmac_f32_16x16x64_bf16 v[20:23], a[48:51], v[52:59], v143 abid:1
s_waitcnt lgkmcnt(8)
ds_read_b128 v[64:67], v1 offset:4096
v_cndmask_b32_dpp v111, v99, v95, vcc quad_perm:[1,0,3,2] row_mask:0xf bank_mask:0xf
v_smfmac_f32_16x16x64_bf16 v[24:27], a[16:19], v[44:51], v140
s_add_u32 s4, s4, s43
ds_read_b128 v[68:71], v0 offset:6144
v_add_u32_sdwa v87, s42, v123 dst_sel:DWORD dst_unused:UNUSED_PAD src0_sel:DWORD src1_sel:WORD_1
v_smfmac_f32_16x16x64_bf16 v[24:27], a[52:55], v[52:59], v144
buffer_store_dwordx4 v[108:111], v4, s[20:23], s46 offen offset:0 sc1
s_mov_b64 vcc, s[82:83]
s_waitcnt lgkmcnt(8)
ds_read_b128 v[72:75], v1 offset:6144
v_cndmask_b32_dpp v96, v92, v96, vcc quad_perm:[1,0,3,2] row_mask:0xf bank_mask:0xf
v_cndmask_b32_dpp v97, v93, v97, vcc quad_perm:[1,0,3,2] row_mask:0xf bank_mask:0xf
v_smfmac_f32_16x16x64_bf16 v[28:31], a[20:23], v[44:51], v140 abid:1
s_add_u32 s7, s45, s58
ds_read_u16 v83, v83
v_cndmask_b32_dpp v98, v94, v98, vcc quad_perm:[1,0,3,2] row_mask:0xf bank_mask:0xf
v_smfmac_f32_16x16x64_bf16 v[28:31], a[56:59], v[52:59], v144 abid:1
s_waitcnt lgkmcnt(9)
ds_read_b128 v[114:117], v2 offset:64
v_cndmask_b32_dpp v99, v95, v99, vcc quad_perm:[1,0,3,2] row_mask:0xf bank_mask:0xf
v_smfmac_f32_16x16x64_bf16 v[32:35], a[24:27], v[44:51], v141
ds_read_u16 v85, v85
v_add_u32_sdwa v88, s42, v124 dst_sel:DWORD dst_unused:UNUSED_PAD src0_sel:DWORD src1_sel:WORD_0
v_smfmac_f32_16x16x64_bf16 v[32:35], a[60:63], v[52:59], v145
s_waitcnt lgkmcnt(10)
ds_read_u16 v86, v86
v_add_u32_sdwa v89, s42, v124 dst_sel:DWORD dst_unused:UNUSED_PAD src0_sel:DWORD src1_sel:WORD_1
v_smfmac_f32_16x16x64_bf16 v[36:39], a[28:31], v[44:51], v141 abid:1
ds_read_u16 v87, v87
v_add_u32_sdwa v90, s42, v125 dst_sel:DWORD dst_unused:UNUSED_PAD src0_sel:DWORD src1_sel:WORD_0
v_smfmac_f32_16x16x64_bf16 v[36:39], a[64:67], v[52:59], v145 abid:1
s_waitcnt lgkmcnt(10)
ds_read_u16 v88, v88
v_add_u32_sdwa v91, s42, v125 dst_sel:DWORD dst_unused:UNUSED_PAD src0_sel:DWORD src1_sel:WORD_1
v_smfmac_f32_16x16x64_bf16 v[40:43], a[32:35], v[44:51], v174
buffer_store_dwordx4 v[96:99], v4, s[20:23], s46 offen offset:1152 sc1
s_mov_b64 vcc, s[80:81]
ds_read_u16 v89, v89
v_cndmask_b32_dpp v92, v104, v100, vcc quad_perm:[1,0,3,2] row_mask:0xf bank_mask:0xf
v_cndmask_b32_dpp v93, v105, v101, vcc quad_perm:[1,0,3,2] row_mask:0xf bank_mask:0xf
v_smfmac_f32_16x16x64_bf16 v[40:43], a[68:71], v[52:59], v174 abid:1
s_waitcnt lgkmcnt(9)
ds_read_u16 v90, v90
v_cndmask_b32_dpp v94, v106, v102, vcc quad_perm:[1,0,3,2] row_mask:0xf bank_mask:0xf
v_smfmac_f32_16x16x64_bf16 v[8:11], a[72:75], v[60:67], v146
s_waitcnt lgkmcnt(8)
ds_read_u16 v91, v91
v_cndmask_b32_dpp v95, v107, v103, vcc quad_perm:[1,0,3,2] row_mask:0xf bank_mask:0xf
v_smfmac_f32_16x16x64_bf16 v[8:11], a[108:111], v[68:75], v150
s_waitcnt lgkmcnt(7)
ds_bpermute_b32 v112, v6, v112
v_smfmac_f32_16x16x64_bf16 v[8:11], v[114:117], v[76:83], v179
ds_bpermute_b32 v113, v6, v113
v_smfmac_f32_16x16x64_bf16 v[12:15], v[114:117], v[76:83], v179 abid:1
ds_read_b128 v[114:117], v2 offset:128
v_add_u32_sdwa v76, s42, v126 dst_sel:DWORD dst_unused:UNUSED_PAD src0_sel:DWORD src1_sel:WORD_0
v_smfmac_f32_16x16x64_bf16 v[12:15], a[76:79], v[60:67], v146 abid:1
ds_read_u16 v76, v76
v_add_u32_sdwa v77, s42, v126 dst_sel:DWORD dst_unused:UNUSED_PAD src0_sel:DWORD src1_sel:WORD_1
v_smfmac_f32_16x16x64_bf16 v[12:15], a[112:115], v[68:75], v150 abid:1
buffer_store_dwordx4 v[92:95], v4, s[20:23], s46 offen offset:128 sc1
s_mov_b64 vcc, s[82:83]
ds_read_u16 v77, v77
v_cndmask_b32_dpp v104, v100, v104, vcc quad_perm:[1,0,3,2] row_mask:0xf bank_mask:0xf
v_cndmask_b32_dpp v105, v101, v105, vcc quad_perm:[1,0,3,2] row_mask:0xf bank_mask:0xf
v_smfmac_f32_16x16x64_bf16 v[24:27], a[88:91], v[60:67], v148
ds_read_b128 v[44:47], v0 offset:8192
v_add_u32_sdwa v78, s42, v127 dst_sel:DWORD dst_unused:UNUSED_PAD src0_sel:DWORD src1_sel:WORD_0
v_smfmac_f32_16x16x64_bf16 v[24:27], a[124:127], v[68:75], v152
ds_read_u16 v78, v78
v_cndmask_b32_dpp v106, v102, v106, vcc quad_perm:[1,0,3,2] row_mask:0xf bank_mask:0xf
v_smfmac_f32_16x16x64_bf16 v[28:31], a[92:95], v[60:67], v148 abid:1
ds_read_b128 v[48:51], v1 offset:8192
v_cndmask_b32_dpp v107, v103, v107, vcc quad_perm:[1,0,3,2] row_mask:0xf bank_mask:0xf
v_smfmac_f32_16x16x64_bf16 v[28:31], a[128:131], v[68:75], v152 abid:1
ds_read_b128 v[52:55], v0 offset:10240
v_add_u32_sdwa v79, s42, v127 dst_sel:DWORD dst_unused:UNUSED_PAD src0_sel:DWORD src1_sel:WORD_1
v_smfmac_f32_16x16x64_bf16 v[32:35], a[96:99], v[60:67], v149
ds_read_u16 v79, v79
v_add_u32_sdwa v80, s42, v128 dst_sel:DWORD dst_unused:UNUSED_PAD src0_sel:DWORD src1_sel:WORD_0
v_smfmac_f32_16x16x64_bf16 v[32:35], a[132:135], v[68:75], v153
ds_read_u16 v80, v80
v_add_u32_sdwa v81, s42, v128 dst_sel:DWORD dst_unused:UNUSED_PAD src0_sel:DWORD src1_sel:WORD_1
v_smfmac_f32_16x16x64_bf16 v[16:19], a[80:83], v[60:67], v147
buffer_store_dwordx4 v[104:107], v4, s[20:23], s46 offen offset:1280 sc1
s_mov_b64 vcc, s[80:81]
ds_read_b128 v[56:59], v1 offset:10240
v_add_u32_sdwa v82, s42, v129 dst_sel:DWORD dst_unused:UNUSED_PAD src0_sel:DWORD src1_sel:WORD_0
v_add_u32_sdwa v83, s42, v129 dst_sel:DWORD dst_unused:UNUSED_PAD src0_sel:DWORD src1_sel:WORD_1
v_smfmac_f32_16x16x64_bf16 v[16:19], a[116:119], v[68:75], v151
s_waitcnt lgkmcnt(9)
ds_read_b128 v[92:95], v0 offset:12288
v_add_u32_sdwa v100, s42, v130 dst_sel:DWORD dst_unused:UNUSED_PAD src0_sel:DWORD src1_sel:WORD_0
v_smfmac_f32_16x16x64_bf16 v[16:19], v[114:117], v[84:91], v180 abid:1
ds_read_u16 v81, v81
v_add_u32_sdwa v101, s42, v130 dst_sel:DWORD dst_unused:UNUSED_PAD src0_sel:DWORD src1_sel:WORD_1
v_smfmac_f32_16x16x64_bf16 v[12:15], v[114:117], v[84:91], v180
ds_read_b128 v[96:99], v1 offset:12288
v_add_u32_sdwa v102, s42, v131 dst_sel:DWORD dst_unused:UNUSED_PAD src0_sel:DWORD src1_sel:WORD_0
v_smfmac_f32_16x16x64_bf16 v[20:23], v[114:117], v[84:91], v181
ds_read_u16 v82, v82
v_add_u32_sdwa v103, s42, v131 dst_sel:DWORD dst_unused:UNUSED_PAD src0_sel:DWORD src1_sel:WORD_1
v_smfmac_f32_16x16x64_bf16 v[20:23], a[84:87], v[60:67], v147 abid:1
ds_read_u16 v100, v100
v_add_u32_sdwa v104, s42, v132 dst_sel:DWORD dst_unused:UNUSED_PAD src0_sel:DWORD src1_sel:WORD_0
v_smfmac_f32_16x16x64_bf16 v[20:23], a[120:123], v[68:75], v151 abid:1
ds_read_u16 v83, v83
v_add_u32_sdwa v105, s42, v132 dst_sel:DWORD dst_unused:UNUSED_PAD src0_sel:DWORD src1_sel:WORD_1
v_smfmac_f32_16x16x64_bf16 v[36:39], a[100:103], v[60:67], v149 abid:1
buffer_store_dwordx2 v[112:113], v5, s[20:23], s46 offen
ds_read_b128 v[114:117], v2 offset:192
v_add_u32_sdwa v106, s42, v133 dst_sel:DWORD dst_unused:UNUSED_PAD src0_sel:DWORD src1_sel:WORD_0
v_smfmac_f32_16x16x64_bf16 v[36:39], a[136:139], v[68:75], v153 abid:1
s_mov_b32 s46, s48
ds_read_u16 v101, v101
v_add_u32_sdwa v107, s42, v133 dst_sel:DWORD dst_unused:UNUSED_PAD src0_sel:DWORD src1_sel:WORD_1
v_smfmac_f32_16x16x64_bf16 v[40:43], a[104:107], v[60:67], v175
s_mov_b32 s48, s49
ds_read_u16 v102, v102
v_add_u32_sdwa v84, s42, v134 dst_sel:DWORD dst_unused:UNUSED_PAD src0_sel:DWORD src1_sel:WORD_0
v_smfmac_f32_16x16x64_bf16 v[40:43], a[140:143], v[68:75], v175 abid:1
s_waitcnt lgkmcnt(13)
ds_read_u16 v103, v103
v_add_u32_sdwa v85, s42, v134 dst_sel:DWORD dst_unused:UNUSED_PAD src0_sel:DWORD src1_sel:WORD_1
v_smfmac_f32_16x16x64_bf16 v[8:11], a[144:147], v[44:51], v154
s_waitcnt lgkmcnt(10)
ds_read_u16 v104, v104
v_add_u32_sdwa v86, s42, v135 dst_sel:DWORD dst_unused:UNUSED_PAD src0_sel:DWORD src1_sel:WORD_0
v_smfmac_f32_16x16x64_bf16 v[8:11], a[180:183], v[52:59], v158
s_waitcnt lgkmcnt(8)
ds_read_u16 v105, v105
v_add_u32_sdwa v87, s42, v135 dst_sel:DWORD dst_unused:UNUSED_PAD src0_sel:DWORD src1_sel:WORD_1
v_smfmac_f32_16x16x64_bf16 v[8:11], a[216:219], v[92:99], v162
s_add_u32 m0, s44, 0
ds_read_u16 v106, v106
v_add_u32_sdwa v88, s42, v136 dst_sel:DWORD dst_unused:UNUSED_PAD src0_sel:DWORD src1_sel:WORD_0
v_smfmac_f32_16x16x64_bf16 v[24:27], a[160:163], v[44:51], v156
buffer_load_dwordx4 v3, s[16:19], s45 offen offset:0 nt lds
v_add_u32_sdwa v89, s42, v136 dst_sel:DWORD dst_unused:UNUSED_PAD src0_sel:DWORD src1_sel:WORD_1
v_smfmac_f32_16x16x64_bf16 v[24:27], a[196:199], v[52:59], v160
s_mov_b32 s49, s50
ds_read_u16 v107, v107
v_add_u32_sdwa v90, s42, v137 dst_sel:DWORD dst_unused:UNUSED_PAD src0_sel:DWORD src1_sel:WORD_0
v_smfmac_f32_16x16x64_bf16 v[24:27], a[232:235], v[92:99], v164
s_waitcnt lgkmcnt(7)
ds_read_u16 v84, v84
v_add_u32_sdwa v91, s42, v137 dst_sel:DWORD dst_unused:UNUSED_PAD src0_sel:DWORD src1_sel:WORD_1
v_smfmac_f32_16x16x64_bf16 v[24:27], v[114:117], v[76:83], v182
s_mov_b32 s50, s45
ds_read_u16 v85, v85
v_smfmac_f32_16x16x64_bf16 v[20:23], v[114:117], v[76:83], v181 abid:1
ds_read_u16 v86, v86
v_smfmac_f32_16x16x64_bf16 v[28:31], v[114:117], v[76:83], v182 abid:1
ds_read_b128 v[114:117], v2 offset:256
v_add_u32_sdwa v76, s4, v118 dst_sel:DWORD dst_unused:UNUSED_PAD src0_sel:DWORD src1_sel:WORD_0
v_smfmac_f32_16x16x64_bf16 v[28:31], a[164:167], v[44:51], v156 abid:1
ds_read_u16 v87, v87
v_add_u32_sdwa v77, s4, v118 dst_sel:DWORD dst_unused:UNUSED_PAD src0_sel:DWORD src1_sel:WORD_1
v_smfmac_f32_16x16x64_bf16 v[28:31], a[200:203], v[52:59], v160 abid:1
ds_read_u16 v88, v88
v_add_u32_sdwa v78, s4, v119 dst_sel:DWORD dst_unused:UNUSED_PAD src0_sel:DWORD src1_sel:WORD_0
v_smfmac_f32_16x16x64_bf16 v[28:31], a[236:239], v[92:99], v164 abid:1
ds_read_b128 v[60:63], v0 offset:14336
v_add_u32_sdwa v79, s4, v119 dst_sel:DWORD dst_unused:UNUSED_PAD src0_sel:DWORD src1_sel:WORD_1
v_smfmac_f32_16x16x64_bf16 v[12:15], a[148:151], v[44:51], v154 abid:1
ds_read_u16 v89, v89
v_add_u32_sdwa v80, s4, v120 dst_sel:DWORD dst_unused:UNUSED_PAD src0_sel:DWORD src1_sel:WORD_0
v_smfmac_f32_16x16x64_bf16 v[12:15], a[184:187], v[52:59], v158 abid:1
s_add_u32 m0, s44, 3840
ds_read_b128 v[64:67], v1 offset:14336
v_add_u32_sdwa v81, s4, v120 dst_sel:DWORD dst_unused:UNUSED_PAD src0_sel:DWORD src1_sel:WORD_1
v_smfmac_f32_16x16x64_bf16 v[12:15], a[220:223], v[92:99], v162 abid:1
buffer_load_dwordx4 v3, s[16:19], s45 offen offset:256 nt lds
v_add_u32_sdwa v82, s4, v121 dst_sel:DWORD dst_unused:UNUSED_PAD src0_sel:DWORD src1_sel:WORD_0
v_smfmac_f32_16x16x64_bf16 v[32:35], a[168:171], v[44:51], v157
ds_read_b128 v[68:71], v0 offset:16384
v_add_u32_sdwa v83, s4, v121 dst_sel:DWORD dst_unused:UNUSED_PAD src0_sel:DWORD src1_sel:WORD_1
v_smfmac_f32_16x16x64_bf16 v[32:35], a[204:207], v[52:59], v161
ds_read_u16 v90, v90
v_smfmac_f32_16x16x64_bf16 v[32:35], a[240:243], v[92:99], v165
s_waitcnt lgkmcnt(7)
ds_read_b128 v[72:75], v1 offset:16384
v_add_u32 v0, s43, v0
v_smfmac_f32_16x16x64_bf16 v[32:35], v[114:117], v[100:107], v183 abid:1
ds_read_u16 v91, v91
v_add_u32 v1, s43, v1
v_smfmac_f32_16x16x64_bf16 v[28:31], v[114:117], v[100:107], v183
v_smfmac_f32_16x16x64_bf16 v[36:39], v[114:117], v[100:107], v184
ds_read_b128 v[114:117], v2 offset:320
v_smfmac_f32_16x16x64_bf16 v[36:39], a[172:175], v[44:51], v157 abid:1
s_add_u32 m0, s44, 7680
v_smfmac_f32_16x16x64_bf16 v[36:39], a[208:211], v[52:59], v161 abid:1
buffer_load_dwordx4 v3, s[16:19], s45 offen offset:512 nt lds
v_smfmac_f32_16x16x64_bf16 v[36:39], a[244:247], v[92:99], v165 abid:1
v_smfmac_f32_16x16x64_bf16 v[16:19], a[152:155], v[44:51], v155
s_add_u32 m0, s44, 11520
v_smfmac_f32_16x16x64_bf16 v[16:19], a[188:191], v[52:59], v159
buffer_load_dwordx4 v3, s[16:19], s45 offen offset:768 nt lds
v_smfmac_f32_16x16x64_bf16 v[16:19], a[224:227], v[92:99], v163
s_waitcnt vmcnt(9)
s_mov_b64 exec, s[62:63]
ds_write_b32 v0, v7 offset:18432
s_mov_b64 exec, -1
v_smfmac_f32_16x16x64_bf16 v[20:23], a[156:159], v[44:51], v155 abid:1
s_add_u32 m0, s44, s8
v_smfmac_f32_16x16x64_bf16 v[20:23], a[192:195], v[52:59], v159 abid:1
s_mov_b64 exec, s[10:11]
buffer_load_dwordx4 v3, s[16:19], s7 offen offset:896 nt lds
s_mov_b64 exec, -1
v_smfmac_f32_16x16x64_bf16 v[20:23], a[228:231], v[92:99], v163 abid:1
s_add_u32 s44, s44, s5
s_cmp_ge_u32 s44, 148480
s_cselect_b32 s44, s9, s44
v_smfmac_f32_16x16x64_bf16 v[40:43], a[176:179], v[44:51], v176
v_smfmac_f32_16x16x64_bf16 v[40:43], a[212:215], v[52:59], v176 abid:1
v_smfmac_f32_16x16x64_bf16 v[40:43], a[248:251], v[92:99], v177
s_waitcnt lgkmcnt(0)
v_smfmac_f32_16x16x64_bf16 v[40:43], v[114:117], v[84:91], v185
v_smfmac_f32_16x16x64_bf16 v[36:39], v[114:117], v[84:91], v184 abid:1
s_barrier
v_smfmac_f32_16x16x64_bf16 v[8:11], a[252:255], v[60:67], v166
s_mov_b32 s42, s4
ds_read_b32 v7, v0 offset:18432
v_smfmac_f32_16x16x64_bf16 v[8:11], v[218:221], v[68:75], v170
ds_read_b128 v[44:47], v0 offset:0
v_add_u32_sdwa v84, s42, v122 dst_sel:DWORD dst_unused:UNUSED_PAD src0_sel:DWORD src1_sel:WORD_0
v_smfmac_f32_16x16x64_bf16 v[12:15], v[186:189], v[60:67], v166 abid:1
ds_read_b128 v[48:51], v1 offset:0
v_add_u32_sdwa v85, s42, v122 dst_sel:DWORD dst_unused:UNUSED_PAD src0_sel:DWORD src1_sel:WORD_1
v_smfmac_f32_16x16x64_bf16 v[12:15], v[222:225], v[68:75], v170 abid:1
ds_read_b128 v[52:55], v0 offset:2048
v_add_u32_sdwa v86, s42, v123 dst_sel:DWORD dst_unused:UNUSED_PAD src0_sel:DWORD src1_sel:WORD_0
v_smfmac_f32_16x16x64_bf16 v[16:19], v[190:193], v[60:67], v167
ds_read_b128 v[56:59], v1 offset:2048
v_cvt_pk_bf16_f32 v92, v8, v9
v_smfmac_f32_16x16x64_bf16 v[16:19], v[226:229], v[68:75], v171
ds_read_u16 v76, v76
v_cvt_pk_bf16_f32 v93, v10, v11
v_smfmac_f32_16x16x64_bf16 v[20:23], v[194:197], v[60:67], v167 abid:1
ds_read_b128 v[8:11], v2 offset:1024
v_cvt_pk_bf16_f32 v94, v12, v13
v_smfmac_f32_16x16x64_bf16 v[20:23], v[230:233], v[68:75], v171 abid:1
ds_read_u16 v77, v77
v_cvt_pk_bf16_f32 v95, v14, v15
v_smfmac_f32_16x16x64_bf16 v[24:27], v[198:201], v[60:67], v168
ds_read_b128 v[12:15], v2 offset:1088
v_cvt_pk_bf16_f32 v96, v16, v17
v_smfmac_f32_16x16x64_bf16 v[24:27], v[234:237], v[68:75], v172
s_waitcnt lgkmcnt(8)
ds_read_u16 v78, v78
v_cvt_pk_bf16_f32 v97, v18, v19
v_readfirstlane_b32 s56, v7
v_smfmac_f32_16x16x64_bf16 v[28:31], v[202:205], v[60:67], v168 abid:1
s_lshr_b32 s60, s56, 5
ds_read_b128 v[16:19], v2 offset:1152
v_cvt_pk_bf16_f32 v98, v20, v21
v_smfmac_f32_16x16x64_bf16 v[28:31], v[238:241], v[68:75], v172 abid:1
s_mul_i32 s60, s60, 4128768
ds_read_u16 v79, v79
v_cvt_pk_bf16_f32 v99, v22, v23
v_smfmac_f32_16x16x64_bf16 v[32:35], v[206:209], v[60:67], v169
s_mul_i32 s61, s56, 18432
ds_read_b128 v[20:23], v2 offset:1216
v_cvt_pk_bf16_f32 v100, v24, v25
v_smfmac_f32_16x16x64_bf16 v[32:35], v[242:245], v[68:75], v173
s_add_u32 s60, s60, s57
ds_read_u16 v80, v80
v_cvt_pk_bf16_f32 v101, v26, v27
v_smfmac_f32_16x16x64_bf16 v[36:39], v[210:213], v[60:67], v169 abid:1
s_add_u32 s45, s60, s61
ds_read_b128 v[24:27], v2 offset:1280
v_cvt_pk_bf16_f32 v102, v28, v29
v_smfmac_f32_16x16x64_bf16 v[36:39], v[246:249], v[68:75], v173 abid:1
ds_read_u16 v81, v81
v_cvt_pk_bf16_f32 v103, v30, v31
v_smfmac_f32_16x16x64_bf16 v[40:43], v[214:217], v[60:67], v177 abid:1
s_cmp_lt_u32 s56, 224
ds_read_b128 v[28:31], v2 offset:1344
v_cvt_pk_bf16_f32 v104, v32, v33
v_smfmac_f32_16x16x64_bf16 v[40:43], v[250:253], v[68:75], v178
s_waitcnt lgkmcnt(10)
v_cvt_pk_bf16_f32 v105, v34, v35
s_cbranch_scc1 L_loopck
s_mov_b32 s41, 0
s_mov_b32 s15, 3
s_mov_b32 s12, 7
s_mov_b32 s92, 4
s_mov_b32 s87, 4
s_mov_b32 s59, -1
.p2align 3
L_loopnk:
v_smfmac_f32_16x16x64_bf16 v[8:11], a[0:3], v[44:51], v138
ds_read_b128 v[32:35], v2 offset:1408
v_cvt_pk_bf16_f32 v106, v36, v37
v_smfmac_f32_16x16x64_bf16 v[8:11], a[36:39], v[52:59], v142
s_waitcnt lgkmcnt(9)
v_cvt_pk_bf16_f32 v107, v38, v39
v_smfmac_f32_16x16x64_bf16 v[12:15], a[4:7], v[44:51], v138 abid:1
ds_read_b128 v[36:39], v2 offset:1472
v_cvt_pk_bf16_f32 v112, v40, v41
v_smfmac_f32_16x16x64_bf16 v[12:15], a[40:43], v[52:59], v142 abid:1
s_waitcnt lgkmcnt(8)
ds_read_b128 v[60:63], v0 offset:4096
v_cvt_pk_bf16_f32 v113, v42, v43
v_smfmac_f32_16x16x64_bf16 v[16:19], a[8:11], v[44:51], v139
s_cmp_eq_u32 s4, 129920
ds_read_b128 v[40:43], v2 offset:1536
v_cndmask_b32_dpp v108, v96, v92, vcc quad_perm:[1,0,3,2] row_mask:0xf bank_mask:0xf
v_smfmac_f32_16x16x64_bf16 v[16:19], a[44:47], v[52:59], v143
s_waitcnt lgkmcnt(8)
ds_read_u16 v82, v82
v_cndmask_b32_dpp v109, v97, v93, vcc quad_perm:[1,0,3,2] row_mask:0xf bank_mask:0xf
v_smfmac_f32_16x16x64_bf16 v[20:23], a[12:15], v[44:51], v139 abid:1
s_cselect_b32 s43, -129920, s5
ds_read_u16 v84, v84
v_cndmask_b32_dpp v110, v98, v94, vcc quad_perm:[1,0,3,2] row_mask:0xf bank_mask:0xf
v_smfmac_f32_16x16x64_bf16 v[20:23], a[48:51], v[52:59], v143 abid:1
s_waitcnt lgkmcnt(8)
ds_read_b128 v[64:67], v1 offset:4096
v_cndmask_b32_dpp v111, v99, v95, vcc quad_perm:[1,0,3,2] row_mask:0xf bank_mask:0xf
v_smfmac_f32_16x16x64_bf16 v[24:27], a[16:19], v[44:51], v140
s_add_u32 s4, s4, s43
ds_read_b128 v[68:71], v0 offset:6144
v_add_u32_sdwa v87, s42, v123 dst_sel:DWORD dst_unused:UNUSED_PAD src0_sel:DWORD src1_sel:WORD_1
v_smfmac_f32_16x16x64_bf16 v[24:27], a[52:55], v[52:59], v144
buffer_store_dwordx4 v[108:111], v4, s[20:23], s46 offen offset:0 sc1
s_mov_b64 vcc, s[82:83]
s_waitcnt lgkmcnt(8)
ds_read_b128 v[72:75], v1 offset:6144
v_cndmask_b32_dpp v96, v92, v96, vcc quad_perm:[1,0,3,2] row_mask:0xf bank_mask:0xf
v_cndmask_b32_dpp v97, v93, v97, vcc quad_perm:[1,0,3,2] row_mask:0xf bank_mask:0xf
v_smfmac_f32_16x16x64_bf16 v[28:31], a[20:23], v[44:51], v140 abid:1
s_add_u32 s41, s41, 1
ds_read_u16 v83, v83
v_cndmask_b32_dpp v98, v94, v98, vcc quad_perm:[1,0,3,2] row_mask:0xf bank_mask:0xf
v_smfmac_f32_16x16x64_bf16 v[28:31], a[56:59], v[52:59], v144 abid:1
s_waitcnt lgkmcnt(9)
ds_read_b128 v[114:117], v2 offset:64
v_cndmask_b32_dpp v99, v95, v99, vcc quad_perm:[1,0,3,2] row_mask:0xf bank_mask:0xf
v_smfmac_f32_16x16x64_bf16 v[32:35], a[24:27], v[44:51], v141
ds_read_u16 v85, v85
v_add_u32_sdwa v88, s42, v124 dst_sel:DWORD dst_unused:UNUSED_PAD src0_sel:DWORD src1_sel:WORD_0
v_smfmac_f32_16x16x64_bf16 v[32:35], a[60:63], v[52:59], v145
s_waitcnt lgkmcnt(10)
ds_read_u16 v86, v86
v_add_u32_sdwa v89, s42, v124 dst_sel:DWORD dst_unused:UNUSED_PAD src0_sel:DWORD src1_sel:WORD_1
v_smfmac_f32_16x16x64_bf16 v[36:39], a[28:31], v[44:51], v141 abid:1
ds_read_u16 v87, v87
v_add_u32_sdwa v90, s42, v125 dst_sel:DWORD dst_unused:UNUSED_PAD src0_sel:DWORD src1_sel:WORD_0
v_smfmac_f32_16x16x64_bf16 v[36:39], a[64:67], v[52:59], v145 abid:1
s_waitcnt lgkmcnt(10)
ds_read_u16 v88, v88
v_add_u32_sdwa v91, s42, v125 dst_sel:DWORD dst_unused:UNUSED_PAD src0_sel:DWORD src1_sel:WORD_1
v_smfmac_f32_16x16x64_bf16 v[40:43], a[32:35], v[44:51], v174
buffer_store_dwordx4 v[96:99], v4, s[20:23], s46 offen offset:1152 sc1
s_mov_b64 vcc, s[80:81]
ds_read_u16 v89, v89
v_cndmask_b32_dpp v92, v104, v100, vcc quad_perm:[1,0,3,2] row_mask:0xf bank_mask:0xf
v_cndmask_b32_dpp v93, v105, v101, vcc quad_perm:[1,0,3,2] row_mask:0xf bank_mask:0xf
v_smfmac_f32_16x16x64_bf16 v[40:43], a[68:71], v[52:59], v174 abid:1
s_waitcnt lgkmcnt(9)
ds_read_u16 v90, v90
v_cndmask_b32_dpp v94, v106, v102, vcc quad_perm:[1,0,3,2] row_mask:0xf bank_mask:0xf
v_smfmac_f32_16x16x64_bf16 v[8:11], a[72:75], v[60:67], v146
s_waitcnt lgkmcnt(8)
ds_read_u16 v91, v91
v_cndmask_b32_dpp v95, v107, v103, vcc quad_perm:[1,0,3,2] row_mask:0xf bank_mask:0xf
v_smfmac_f32_16x16x64_bf16 v[8:11], a[108:111], v[68:75], v150
s_waitcnt lgkmcnt(7)
ds_bpermute_b32 v112, v6, v112
v_smfmac_f32_16x16x64_bf16 v[8:11], v[114:117], v[76:83], v179
ds_bpermute_b32 v113, v6, v113
v_smfmac_f32_16x16x64_bf16 v[12:15], v[114:117], v[76:83], v179 abid:1
ds_read_b128 v[114:117], v2 offset:128
v_add_u32_sdwa v76, s42, v126 dst_sel:DWORD dst_unused:UNUSED_PAD src0_sel:DWORD src1_sel:WORD_0
v_smfmac_f32_16x16x64_bf16 v[12:15], a[76:79], v[60:67], v146 abid:1
ds_read_u16 v76, v76
v_add_u32_sdwa v77, s42, v126 dst_sel:DWORD dst_unused:UNUSED_PAD src0_sel:DWORD src1_sel:WORD_1
v_smfmac_f32_16x16x64_bf16 v[12:15], a[112:115], v[68:75], v150 abid:1
buffer_store_dwordx4 v[92:95], v4, s[20:23], s46 offen offset:128 sc1
s_mov_b64 vcc, s[82:83]
ds_read_u16 v77, v77
v_cndmask_b32_dpp v104, v100, v104, vcc quad_perm:[1,0,3,2] row_mask:0xf bank_mask:0xf
v_cndmask_b32_dpp v105, v101, v105, vcc quad_perm:[1,0,3,2] row_mask:0xf bank_mask:0xf
v_smfmac_f32_16x16x64_bf16 v[24:27], a[88:91], v[60:67], v148
ds_read_b128 v[44:47], v0 offset:8192
v_add_u32_sdwa v78, s42, v127 dst_sel:DWORD dst_unused:UNUSED_PAD src0_sel:DWORD src1_sel:WORD_0
v_smfmac_f32_16x16x64_bf16 v[24:27], a[124:127], v[68:75], v152
ds_read_u16 v78, v78
v_cndmask_b32_dpp v106, v102, v106, vcc quad_perm:[1,0,3,2] row_mask:0xf bank_mask:0xf
v_smfmac_f32_16x16x64_bf16 v[28:31], a[92:95], v[60:67], v148 abid:1
ds_read_b128 v[48:51], v1 offset:8192
v_cndmask_b32_dpp v107, v103, v107, vcc quad_perm:[1,0,3,2] row_mask:0xf bank_mask:0xf
v_smfmac_f32_16x16x64_bf16 v[28:31], a[128:131], v[68:75], v152 abid:1
ds_read_b128 v[52:55], v0 offset:10240
v_add_u32_sdwa v79, s42, v127 dst_sel:DWORD dst_unused:UNUSED_PAD src0_sel:DWORD src1_sel:WORD_1
v_smfmac_f32_16x16x64_bf16 v[32:35], a[96:99], v[60:67], v149
ds_read_u16 v79, v79
v_add_u32_sdwa v80, s42, v128 dst_sel:DWORD dst_unused:UNUSED_PAD src0_sel:DWORD src1_sel:WORD_0
v_smfmac_f32_16x16x64_bf16 v[32:35], a[132:135], v[68:75], v153
ds_read_u16 v80, v80
v_add_u32_sdwa v81, s42, v128 dst_sel:DWORD dst_unused:UNUSED_PAD src0_sel:DWORD src1_sel:WORD_1
v_smfmac_f32_16x16x64_bf16 v[16:19], a[80:83], v[60:67], v147
buffer_store_dwordx4 v[104:107], v4, s[20:23], s46 offen offset:1280 sc1
s_mov_b64 vcc, s[80:81]
ds_read_b128 v[56:59], v1 offset:10240
v_add_u32_sdwa v82, s42, v129 dst_sel:DWORD dst_unused:UNUSED_PAD src0_sel:DWORD src1_sel:WORD_0
v_add_u32_sdwa v83, s42, v129 dst_sel:DWORD dst_unused:UNUSED_PAD src0_sel:DWORD src1_sel:WORD_1
v_smfmac_f32_16x16x64_bf16 v[16:19], a[116:119], v[68:75], v151
s_waitcnt lgkmcnt(9)
ds_read_b128 v[92:95], v0 offset:12288
v_add_u32_sdwa v100, s42, v130 dst_sel:DWORD dst_unused:UNUSED_PAD src0_sel:DWORD src1_sel:WORD_0
v_smfmac_f32_16x16x64_bf16 v[16:19], v[114:117], v[84:91], v180 abid:1
ds_read_u16 v81, v81
v_add_u32_sdwa v101, s42, v130 dst_sel:DWORD dst_unused:UNUSED_PAD src0_sel:DWORD src1_sel:WORD_1
v_smfmac_f32_16x16x64_bf16 v[12:15], v[114:117], v[84:91], v180
ds_read_b128 v[96:99], v1 offset:12288
v_add_u32_sdwa v102, s42, v131 dst_sel:DWORD dst_unused:UNUSED_PAD src0_sel:DWORD src1_sel:WORD_0
v_smfmac_f32_16x16x64_bf16 v[20:23], v[114:117], v[84:91], v181
ds_read_u16 v82, v82
v_add_u32_sdwa v103, s42, v131 dst_sel:DWORD dst_unused:UNUSED_PAD src0_sel:DWORD src1_sel:WORD_1
v_smfmac_f32_16x16x64_bf16 v[20:23], a[84:87], v[60:67], v147 abid:1
ds_read_u16 v100, v100
v_add_u32_sdwa v104, s42, v132 dst_sel:DWORD dst_unused:UNUSED_PAD src0_sel:DWORD src1_sel:WORD_0
v_smfmac_f32_16x16x64_bf16 v[20:23], a[120:123], v[68:75], v151 abid:1
ds_read_u16 v83, v83
v_add_u32_sdwa v105, s42, v132 dst_sel:DWORD dst_unused:UNUSED_PAD src0_sel:DWORD src1_sel:WORD_1
v_smfmac_f32_16x16x64_bf16 v[36:39], a[100:103], v[60:67], v149 abid:1
buffer_store_dwordx2 v[112:113], v5, s[20:23], s46 offen
ds_read_b128 v[114:117], v2 offset:192
v_add_u32_sdwa v106, s42, v133 dst_sel:DWORD dst_unused:UNUSED_PAD src0_sel:DWORD src1_sel:WORD_0
v_smfmac_f32_16x16x64_bf16 v[36:39], a[136:139], v[68:75], v153 abid:1
s_mov_b32 s22, 75497472
ds_read_u16 v101, v101
v_add_u32_sdwa v107, s42, v133 dst_sel:DWORD dst_unused:UNUSED_PAD src0_sel:DWORD src1_sel:WORD_1
v_smfmac_f32_16x16x64_bf16 v[40:43], a[104:107], v[60:67], v175
s_mov_b32 s46, s48
ds_read_u16 v102, v102
v_add_u32_sdwa v84, s42, v134 dst_sel:DWORD dst_unused:UNUSED_PAD src0_sel:DWORD src1_sel:WORD_0
v_smfmac_f32_16x16x64_bf16 v[40:43], a[140:143], v[68:75], v175 abid:1
s_waitcnt lgkmcnt(13)
ds_read_u16 v103, v103
v_add_u32_sdwa v85, s42, v134 dst_sel:DWORD dst_unused:UNUSED_PAD src0_sel:DWORD src1_sel:WORD_1
v_smfmac_f32_16x16x64_bf16 v[8:11], a[144:147], v[44:51], v154
s_waitcnt lgkmcnt(10)
ds_read_u16 v104, v104
v_add_u32_sdwa v86, s42, v135 dst_sel:DWORD dst_unused:UNUSED_PAD src0_sel:DWORD src1_sel:WORD_0
v_smfmac_f32_16x16x64_bf16 v[8:11], a[180:183], v[52:59], v158
s_waitcnt lgkmcnt(8)
ds_read_u16 v105, v105
v_add_u32_sdwa v87, s42, v135 dst_sel:DWORD dst_unused:UNUSED_PAD src0_sel:DWORD src1_sel:WORD_1
v_smfmac_f32_16x16x64_bf16 v[8:11], a[216:219], v[92:99], v162
s_mov_b32 s48, s49
ds_read_u16 v106, v106
v_add_u32_sdwa v88, s42, v136 dst_sel:DWORD dst_unused:UNUSED_PAD src0_sel:DWORD src1_sel:WORD_0
v_smfmac_f32_16x16x64_bf16 v[24:27], a[160:163], v[44:51], v156
s_mov_b32 s49, s50
s_add_u32 s50, s50, 4718592
v_add_u32_sdwa v89, s42, v136 dst_sel:DWORD dst_unused:UNUSED_PAD src0_sel:DWORD src1_sel:WORD_1
v_smfmac_f32_16x16x64_bf16 v[24:27], a[196:199], v[52:59], v160
ds_read_u16 v107, v107
v_add_u32_sdwa v90, s42, v137 dst_sel:DWORD dst_unused:UNUSED_PAD src0_sel:DWORD src1_sel:WORD_0
v_smfmac_f32_16x16x64_bf16 v[24:27], a[232:235], v[92:99], v164
s_waitcnt lgkmcnt(7)
ds_read_u16 v84, v84
v_add_u32_sdwa v91, s42, v137 dst_sel:DWORD dst_unused:UNUSED_PAD src0_sel:DWORD src1_sel:WORD_1
v_smfmac_f32_16x16x64_bf16 v[24:27], v[114:117], v[76:83], v182
ds_read_u16 v85, v85
v_smfmac_f32_16x16x64_bf16 v[20:23], v[114:117], v[76:83], v181 abid:1
ds_read_u16 v86, v86
v_smfmac_f32_16x16x64_bf16 v[28:31], v[114:117], v[76:83], v182 abid:1
ds_read_b128 v[114:117], v2 offset:256
v_add_u32_sdwa v76, s4, v118 dst_sel:DWORD dst_unused:UNUSED_PAD src0_sel:DWORD src1_sel:WORD_0
v_smfmac_f32_16x16x64_bf16 v[28:31], a[164:167], v[44:51], v156 abid:1
ds_read_u16 v87, v87
v_add_u32_sdwa v77, s4, v118 dst_sel:DWORD dst_unused:UNUSED_PAD src0_sel:DWORD src1_sel:WORD_1
v_smfmac_f32_16x16x64_bf16 v[28:31], a[200:203], v[52:59], v160 abid:1
ds_read_u16 v88, v88
v_add_u32_sdwa v78, s4, v119 dst_sel:DWORD dst_unused:UNUSED_PAD src0_sel:DWORD src1_sel:WORD_0
v_smfmac_f32_16x16x64_bf16 v[28:31], a[236:239], v[92:99], v164 abid:1
ds_read_b128 v[60:63], v0 offset:14336
v_add_u32_sdwa v79, s4, v119 dst_sel:DWORD dst_unused:UNUSED_PAD src0_sel:DWORD src1_sel:WORD_1
v_smfmac_f32_16x16x64_bf16 v[12:15], a[148:151], v[44:51], v154 abid:1
ds_read_u16 v89, v89
v_add_u32_sdwa v80, s4, v120 dst_sel:DWORD dst_unused:UNUSED_PAD src0_sel:DWORD src1_sel:WORD_0
v_smfmac_f32_16x16x64_bf16 v[12:15], a[184:187], v[52:59], v158 abid:1
ds_read_b128 v[64:67], v1 offset:14336
v_add_u32_sdwa v81, s4, v120 dst_sel:DWORD dst_unused:UNUSED_PAD src0_sel:DWORD src1_sel:WORD_1
v_smfmac_f32_16x16x64_bf16 v[12:15], a[220:223], v[92:99], v162 abid:1
v_add_u32_sdwa v82, s4, v121 dst_sel:DWORD dst_unused:UNUSED_PAD src0_sel:DWORD src1_sel:WORD_0
v_smfmac_f32_16x16x64_bf16 v[32:35], a[168:171], v[44:51], v157
ds_read_b128 v[68:71], v0 offset:16384
v_add_u32_sdwa v83, s4, v121 dst_sel:DWORD dst_unused:UNUSED_PAD src0_sel:DWORD src1_sel:WORD_1
v_smfmac_f32_16x16x64_bf16 v[32:35], a[204:207], v[52:59], v161
ds_read_u16 v90, v90
v_smfmac_f32_16x16x64_bf16 v[32:35], a[240:243], v[92:99], v165
s_waitcnt lgkmcnt(7)
ds_read_b128 v[72:75], v1 offset:16384
v_add_u32 v0, s43, v0
v_smfmac_f32_16x16x64_bf16 v[32:35], v[114:117], v[100:107], v183 abid:1
ds_read_u16 v91, v91
v_add_u32 v1, s43, v1
v_smfmac_f32_16x16x64_bf16 v[28:31], v[114:117], v[100:107], v183
v_smfmac_f32_16x16x64_bf16 v[36:39], v[114:117], v[100:107], v184
ds_read_b128 v[114:117], v2 offset:320
v_smfmac_f32_16x16x64_bf16 v[36:39], a[172:175], v[44:51], v157 abid:1
v_smfmac_f32_16x16x64_bf16 v[36:39], a[208:211], v[52:59], v161 abid:1
v_smfmac_f32_16x16x64_bf16 v[36:39], a[244:247], v[92:99], v165 abid:1
v_smfmac_f32_16x16x64_bf16 v[16:19], a[152:155], v[44:51], v155
v_smfmac_f32_16x16x64_bf16 v[16:19], a[188:191], v[52:59], v159
v_smfmac_f32_16x16x64_bf16 v[16:19], a[224:227], v[92:99], v163
v_smfmac_f32_16x16x64_bf16 v[20:23], a[156:159], v[44:51], v155 abid:1
v_smfmac_f32_16x16x64_bf16 v[20:23], a[192:195], v[52:59], v159 abid:1
v_smfmac_f32_16x16x64_bf16 v[20:23], a[228:231], v[92:99], v163 abid:1
v_smfmac_f32_16x16x64_bf16 v[40:43], a[176:179], v[44:51], v176
s_bitcmp1_b32 s92, s41
v_smfmac_f32_16x16x64_bf16 v[40:43], a[212:215], v[52:59], v176 abid:1
s_cbranch_scc1 L_loopnk_w
L_loopnk_wb:
v_smfmac_f32_16x16x64_bf16 v[40:43], a[248:251], v[92:99], v177
s_waitcnt lgkmcnt(0)
v_smfmac_f32_16x16x64_bf16 v[40:43], v[114:117], v[84:91], v185
v_smfmac_f32_16x16x64_bf16 v[36:39], v[114:117], v[84:91], v184 abid:1
s_waitcnt vmcnt(20)
s_barrier
L_loopnk_p3:
v_smfmac_f32_16x16x64_bf16 v[8:11], a[252:255], v[60:67], v166
s_mov_b32 s42, s4
v_smfmac_f32_16x16x64_bf16 v[8:11], v[218:221], v[68:75], v170
ds_read_b128 v[44:47], v0 offset:0
v_add_u32_sdwa v84, s42, v122 dst_sel:DWORD dst_unused:UNUSED_PAD src0_sel:DWORD src1_sel:WORD_0
v_smfmac_f32_16x16x64_bf16 v[12:15], v[186:189], v[60:67], v166 abid:1
ds_read_b128 v[48:51], v1 offset:0
v_add_u32_sdwa v85, s42, v122 dst_sel:DWORD dst_unused:UNUSED_PAD src0_sel:DWORD src1_sel:WORD_1
v_smfmac_f32_16x16x64_bf16 v[12:15], v[222:225], v[68:75], v170 abid:1
ds_read_b128 v[52:55], v0 offset:2048
v_add_u32_sdwa v86, s42, v123 dst_sel:DWORD dst_unused:UNUSED_PAD src0_sel:DWORD src1_sel:WORD_0
v_smfmac_f32_16x16x64_bf16 v[16:19], v[190:193], v[60:67], v167
ds_read_b128 v[56:59], v1 offset:2048
v_cvt_pk_bf16_f32 v92, v8, v9
v_smfmac_f32_16x16x64_bf16 v[16:19], v[226:229], v[68:75], v171
ds_read_u16 v76, v76
v_cvt_pk_bf16_f32 v93, v10, v11
v_smfmac_f32_16x16x64_bf16 v[20:23], v[194:197], v[60:67], v167 abid:1
ds_read_b128 v[8:11], v2 offset:1024
v_cvt_pk_bf16_f32 v94, v12, v13
v_smfmac_f32_16x16x64_bf16 v[20:23], v[230:233], v[68:75], v171 abid:1
ds_read_u16 v77, v77
v_cvt_pk_bf16_f32 v95, v14, v15
v_smfmac_f32_16x16x64_bf16 v[24:27], v[198:201], v[60:67], v168
ds_read_b128 v[12:15], v2 offset:1088
v_cvt_pk_bf16_f32 v96, v16, v17
v_smfmac_f32_16x16x64_bf16 v[24:27], v[234:237], v[68:75], v172
ds_read_u16 v78, v78
v_cvt_pk_bf16_f32 v97, v18, v19
v_smfmac_f32_16x16x64_bf16 v[28:31], v[202:205], v[60:67], v168 abid:1
ds_read_b128 v[16:19], v2 offset:1152
v_cvt_pk_bf16_f32 v98, v20, v21
v_smfmac_f32_16x16x64_bf16 v[28:31], v[238:241], v[68:75], v172 abid:1
ds_read_u16 v79, v79
v_cvt_pk_bf16_f32 v99, v22, v23
v_smfmac_f32_16x16x64_bf16 v[32:35], v[206:209], v[60:67], v169
ds_read_b128 v[20:23], v2 offset:1216
v_cvt_pk_bf16_f32 v100, v24, v25
v_smfmac_f32_16x16x64_bf16 v[32:35], v[242:245], v[68:75], v173
ds_read_u16 v80, v80
v_cvt_pk_bf16_f32 v101, v26, v27
v_smfmac_f32_16x16x64_bf16 v[36:39], v[210:213], v[60:67], v169 abid:1
ds_read_b128 v[24:27], v2 offset:1280
v_cvt_pk_bf16_f32 v102, v28, v29
v_smfmac_f32_16x16x64_bf16 v[36:39], v[246:249], v[68:75], v173 abid:1
ds_read_u16 v81, v81
v_cvt_pk_bf16_f32 v103, v30, v31
v_smfmac_f32_16x16x64_bf16 v[40:43], v[214:217], v[60:67], v177 abid:1
s_bitcmp1_b32 s12, s41
ds_read_b128 v[28:31], v2 offset:1344
v_cvt_pk_bf16_f32 v104, v32, v33
v_smfmac_f32_16x16x64_bf16 v[40:43], v[250:253], v[68:75], v178
s_waitcnt lgkmcnt(10)
v_cvt_pk_bf16_f32 v105, v34, v35
s_cbranch_scc1 L_loopnk
s_cmp_eq_u32 s41, s59
s_cbranch_scc1 L_loopck
s_cmp_lt_u32 s41, s15
s_cbranch_scc1 L_loopk
s_nop 7
v_cvt_pk_bf16_f32 v106, v36, v37
v_cvt_pk_bf16_f32 v107, v38, v39
v_cvt_pk_bf16_f32 v112, v40, v41
v_cvt_pk_bf16_f32 v113, v42, v43
s_nop 1
v_cndmask_b32_dpp v108, v96, v92, vcc quad_perm:[1,0,3,2] row_mask:0xf bank_mask:0xf
s_nop 1
v_cndmask_b32_dpp v109, v97, v93, vcc quad_perm:[1,0,3,2] row_mask:0xf bank_mask:0xf
s_nop 1
v_cndmask_b32_dpp v110, v98, v94, vcc quad_perm:[1,0,3,2] row_mask:0xf bank_mask:0xf
s_nop 1
v_cndmask_b32_dpp v111, v99, v95, vcc quad_perm:[1,0,3,2] row_mask:0xf bank_mask:0xf
s_waitcnt lgkmcnt(0)
buffer_store_dwordx4 v[108:111], v4, s[20:23], s46 offen offset:0 sc1
s_nop 1
s_mov_b64 vcc, s[82:83]
s_nop 1
v_cndmask_b32_dpp v96, v92, v96, vcc quad_perm:[1,0,3,2] row_mask:0xf bank_mask:0xf
s_nop 1
v_cndmask_b32_dpp v97, v93, v97, vcc quad_perm:[1,0,3,2] row_mask:0xf bank_mask:0xf
s_nop 1
v_cndmask_b32_dpp v98, v94, v98, vcc quad_perm:[1,0,3,2] row_mask:0xf bank_mask:0xf
s_nop 1
v_cndmask_b32_dpp v99, v95, v99, vcc quad_perm:[1,0,3,2] row_mask:0xf bank_mask:0xf
s_waitcnt lgkmcnt(0)
buffer_store_dwordx4 v[96:99], v4, s[20:23], s46 offen offset:1152 sc1
s_nop 1
s_mov_b64 vcc, s[80:81]
s_nop 1
v_cndmask_b32_dpp v92, v104, v100, vcc quad_perm:[1,0,3,2] row_mask:0xf bank_mask:0xf
s_nop 1
v_cndmask_b32_dpp v93, v105, v101, vcc quad_perm:[1,0,3,2] row_mask:0xf bank_mask:0xf
s_nop 1
v_cndmask_b32_dpp v94, v106, v102, vcc quad_perm:[1,0,3,2] row_mask:0xf bank_mask:0xf
s_nop 1
v_cndmask_b32_dpp v95, v107, v103, vcc quad_perm:[1,0,3,2] row_mask:0xf bank_mask:0xf
s_nop 1
ds_bpermute_b32 v112, v6, v112
s_nop 1
ds_bpermute_b32 v113, v6, v113
s_waitcnt lgkmcnt(0)
buffer_store_dwordx4 v[92:95], v4, s[20:23], s46 offen offset:128 sc1
s_nop 1
s_mov_b64 vcc, s[82:83]
s_nop 1
v_cndmask_b32_dpp v104, v100, v104, vcc quad_perm:[1,0,3,2] row_mask:0xf bank_mask:0xf
s_nop 1
v_cndmask_b32_dpp v105, v101, v105, vcc quad_perm:[1,0,3,2] row_mask:0xf bank_mask:0xf
s_nop 1
v_cndmask_b32_dpp v106, v102, v106, vcc quad_perm:[1,0,3,2] row_mask:0xf bank_mask:0xf
s_nop 1
v_cndmask_b32_dpp v107, v103, v107, vcc quad_perm:[1,0,3,2] row_mask:0xf bank_mask:0xf
s_waitcnt lgkmcnt(0)
buffer_store_dwordx4 v[104:107], v4, s[20:23], s46 offen offset:1280 sc1
s_nop 1
s_mov_b64 vcc, s[80:81]
s_waitcnt lgkmcnt(0)
buffer_store_dwordx2 v[112:113], v5, s[20:23], s46 offen
s_nop 1
s_branch L_fin
L_loopk_w:
s_bitcmp1_b32 s87, s41
s_waitcnt vmcnt(15)
s_cbranch_scc0 L_loopk_wb
s_waitcnt vmcnt(10)
s_branch L_loopk_wb
L_loopnk_w:
s_bitcmp1_b32 s87, s41
s_waitcnt vmcnt(15)
s_cbranch_scc0 L_loopnk_wb
s_waitcnt vmcnt(10)
s_branch L_loopnk_wb
L_slow:
s_waitcnt vmcnt(0) lgkmcnt(0)
s_mov_b32 s87, 0
L_sm:
s_lshl_b32 s86, s2, 1
s_add_u32 s86, s86, s87
s_add_u32 s86, s86, 1
s_mul_i32 s86, s86, 393216
s_mov_b32 s84, 0
L_st:
s_and_b32 s48, s84, 3
s_lshr_b32 s49, s84, 2
s_sub_u32 s50, s84, 36
s_lshl_b32 s51, s40, 4
s_lshl_b32 s52, s50, 1
s_lshl_b32 s53, s48, 8
s_cmp_lt_u32 s84, 36
s_cselect_b32 s52, s49, s52
s_cselect_b32 s53, s53, 1024
s_cselect_b32 s54, 8, 73728
s_cselect_b32 s55, 32, 8
s_cselect_b32 s56, 16, 32
s_cselect_b32 s57, 128, 64
s_mul_i32 s52, s52, 73728
s_mul_i32 s58, s40, 18432
v_and_b32 v58, 1, v7
v_bfe_u32 v59, v7, 1, 1
v_bfe_u32 v60, v7, 2, 2
v_bfe_u32 v62, v7, 4, 1
v_lshrrev_b32 v63, 5, v7
v_lshl_add_u32 v50, v58, 2, s52
v_mad_u32_u24 v50, v59, s54, v50
v_mad_u32_u24 v50, v60, s55, v50
v_mad_u32_u24 v50, v62, s56, v50
v_mad_u32_u24 v50, v63, s57, v50
v_add_u32 v50, s53, v50
v_add_u32 v50, s58, v50
v_add_u32 v62, 4608, v50
v_add_u32 v63, 9216, v50
v_add_u32 v64, 13824, v50
buffer_load_dword v8, v50, s[28:31], 0 offen offset:0
buffer_load_dword v9, v50, s[28:31], 0 offen offset:1152
buffer_load_dword v10, v50, s[28:31], 0 offen offset:2304
buffer_load_dword v11, v50, s[28:31], 0 offen offset:3456
buffer_load_dword v12, v62, s[28:31], 0 offen offset:0
buffer_load_dword v13, v62, s[28:31], 0 offen offset:1152
buffer_load_dword v14, v62, s[28:31], 0 offen offset:2304
buffer_load_dword v15, v62, s[28:31], 0 offen offset:3456
buffer_load_dword v16, v63, s[28:31], 0 offen offset:0
buffer_load_dword v17, v63, s[28:31], 0 offen offset:1152
buffer_load_dword v18, v63, s[28:31], 0 offen offset:2304
buffer_load_dword v19, v63, s[28:31], 0 offen offset:3456
buffer_load_dword v20, v64, s[28:31], 0 offen offset:0
buffer_load_dword v21, v64, s[28:31], 0 offen offset:1152
buffer_load_dword v22, v64, s[28:31], 0 offen offset:2304
buffer_load_dword v23, v64, s[28:31], 0 offen offset:3456
s_mul_i32 s52, s48, 9
s_add_u32 s52, s52, s49
s_mul_i32 s53, s52, 9
s_mul_i32 s54, s50, 18
s_add_u32 s54, s54, 8
s_lshl_b32 s55, s52, 2
s_add_u32 s55, s55, s40
s_lshl_b32 s56, s50, 2
s_add_u32 s56, s56, s40
s_cmp_eq_u32 s84, 40
s_cselect_b32 s57, 0x100000, 9
s_cmp_lt_u32 s84, 36
s_cselect_b32 s53, s53, s54
s_cselect_b32 s54, 2, 81
s_cselect_b32 s57, 1, s57
s_cselect_b32 s55, s55, s56
s_mov_b32 s56, 331776
s_cselect_b32 s56, s56, 368640
s_mov_b32 s58, 373760
s_cselect_b32 s58, s58, 382976
s_cselect_b32 s59, 16, 4
s_cselect_b32 s60, 4, 64
s_cselect_b32 s61, 12, 11
s_cselect_b32 s62, 1, 0x8001
v_lshrrev_b32 v61, 4, v7
v_lshlrev_b32 v62, 1, v58
v_lshl_add_u32 v60, v60, 2, v62
v_add_u32 v62, v60, v59
v_mul_u32_u24 v51, s54, v61
v_add_lshl_u32 v51, v51, s53, 6
v_add3_u32 v51, v51, v62, s51
v_lshl_add_u32 v51, v51, 4, s86
s_lshl_b32 s57, s57, 10
v_add_u32 v66, s57, v51
s_lshl_b32 s52, s55, 8
s_add_u32 s52, s52, s56
s_add_u32 s52, s52, s86
v_mul_u32_u24 v52, s59, v62
v_mad_u32_u24 v52, v61, s60, v52
v_add_u32 v52, s52, v52
v_mov_b32 v55, 0x05040100
v_mov_b32 v62, 0x03020706
v_cmp_eq_u32 vcc, 1, v59
v_mov_b32 v68, 0xf0a0500
v_mov_b32 v69, 0x8f8a8580
v_mov_b32 v70, 0x1f1a1510
v_mov_b32 v71, 0x9f9a9590
v_mov_b32 v72, 0x2f2a2520
v_mov_b32 v73, 0xafaaa5a0
v_mov_b32 v74, 0x3f3a3530
v_mov_b32 v75, 0xbfbab5b0
v_cndmask_b32 v55, v55, v62, vcc
s_mov_b32 s64, 0x5040500
s_mov_b32 s65, 0x5040501
s_mov_b32 s66, 0x5040502
s_mov_b32 s67, 0x5040503
s_mov_b32 s68, 0x7060700
s_mov_b32 s69, 0x7060701
s_mov_b32 s70, 0x7060702
s_mov_b32 s71, 0x7060703
s_mov_b32 s72, 0x05060102
s_cmp_lg_u32 s87, 0
s_waitcnt vmcnt(12)
v_perm_b32 v24, v8, v68, s64
v_perm_b32 v25, v9, v68, s65
v_perm_b32 v26, v10, v68, s66
v_perm_b32 v27, v11, v68, s67
v_max3_f32 v28, |v24|, |v25|, |v26|
v_med3_f32 v29, |v24|, |v25|, |v26|
v_min3_f32 v30, |v24|, |v25|, |v26|
v_med3_f32 v32, v28, v29, |v27|
v_med3_f32 v33, v29, v30, |v27|
v_max_f32 v31, v28, |v27|
v_cmp_eq_u32_sdwa vcc, v33, v32 src0_sel:WORD_1 src1_sel:WORD_1
s_cbranch_scc0 L_rb0g
v_min_f32 v30, v30, |v27|
v_cndmask_b32 v31, 0, v33, vcc
v_cmp_eq_u32_sdwa vcc, v30, v32 src0_sel:WORD_1 src1_sel:WORD_1
s_nop 1
v_cndmask_b32 v32, 0, v30, vcc
L_rb0g:
v_perm_b32 v36, v31, v32, s72
v_bfi_b32 v44, 3, v32, v31
v_perm_b32 v24, v8, v69, s68
v_perm_b32 v25, v9, v69, s69
v_perm_b32 v26, v10, v69, s70
v_perm_b32 v27, v11, v69, s71
v_max3_f32 v28, |v24|, |v25|, |v26|
v_med3_f32 v29, |v24|, |v25|, |v26|
v_min3_f32 v30, |v24|, |v25|, |v26|
v_med3_f32 v32, v28, v29, |v27|
v_med3_f32 v33, v29, v30, |v27|
v_max_f32 v31, v28, |v27|
v_cmp_eq_u32_sdwa vcc, v33, v32 src0_sel:WORD_1 src1_sel:WORD_1
s_cbranch_scc0 L_rb1g
v_min_f32 v30, v30, |v27|
v_cndmask_b32 v31, 0, v33, vcc
v_cmp_eq_u32_sdwa vcc, v30, v32 src0_sel:WORD_1 src1_sel:WORD_1
s_nop 1
v_cndmask_b32 v32, 0, v30, vcc
L_rb1g:
v_perm_b32 v40, v31, v32, s72
v_bfi_b32 v46, 3, v32, v31
s_waitcnt vmcnt(8)
v_perm_b32 v24, v12, v70, s64
v_perm_b32 v25, v13, v70, s65
v_perm_b32 v26, v14, v70, s66
v_perm_b32 v27, v15, v70, s67
v_max3_f32 v28, |v24|, |v25|, |v26|
v_med3_f32 v29, |v24|, |v25|, |v26|
v_min3_f32 v30, |v24|, |v25|, |v26|
v_med3_f32 v32, v28, v29, |v27|
v_med3_f32 v33, v29, v30, |v27|
v_max_f32 v31, v28, |v27|
v_cmp_eq_u32_sdwa vcc, v33, v32 src0_sel:WORD_1 src1_sel:WORD_1
s_cbranch_scc0 L_rb2g
v_min_f32 v30, v30, |v27|
v_cndmask_b32 v31, 0, v33, vcc
v_cmp_eq_u32_sdwa vcc, v30, v32 src0_sel:WORD_1 src1_sel:WORD_1
s_nop 1
v_cndmask_b32 v32, 0, v30, vcc
L_rb2g:
v_perm_b32 v37, v31, v32, s72
v_bfi_b32 v31, 3, v32, v31
v_lshlrev_b32 v31, 4, v31
v_bfi_b32 v44, 15, v44, v31
v_perm_b32 v24, v12, v71, s68
v_perm_b32 v25, v13, v71, s69
v_perm_b32 v26, v14, v71, s70
v_perm_b32 v27, v15, v71, s71
v_max3_f32 v28, |v24|, |v25|, |v26|
v_med3_f32 v29, |v24|, |v25|, |v26|
v_min3_f32 v30, |v24|, |v25|, |v26|
v_med3_f32 v32, v28, v29, |v27|
v_med3_f32 v33, v29, v30, |v27|
v_max_f32 v31, v28, |v27|
v_cmp_eq_u32_sdwa vcc, v33, v32 src0_sel:WORD_1 src1_sel:WORD_1
s_cbranch_scc0 L_rb3g
v_min_f32 v30, v30, |v27|
v_cndmask_b32 v31, 0, v33, vcc
v_cmp_eq_u32_sdwa vcc, v30, v32 src0_sel:WORD_1 src1_sel:WORD_1
s_nop 1
v_cndmask_b32 v32, 0, v30, vcc
L_rb3g:
v_perm_b32 v41, v31, v32, s72
v_bfi_b32 v31, 3, v32, v31
v_lshlrev_b32 v31, 4, v31
v_bfi_b32 v46, 15, v46, v31
s_waitcnt vmcnt(4)
v_perm_b32 v24, v16, v72, s64
v_perm_b32 v25, v17, v72, s65
v_perm_b32 v26, v18, v72, s66
v_perm_b32 v27, v19, v72, s67
v_max3_f32 v28, |v24|, |v25|, |v26|
v_med3_f32 v29, |v24|, |v25|, |v26|
v_min3_f32 v30, |v24|, |v25|, |v26|
v_med3_f32 v32, v28, v29, |v27|
v_med3_f32 v33, v29, v30, |v27|
v_max_f32 v31, v28, |v27|
v_cmp_eq_u32_sdwa vcc, v33, v32 src0_sel:WORD_1 src1_sel:WORD_1
s_cbranch_scc0 L_rb4g
v_min_f32 v30, v30, |v27|
v_cndmask_b32 v31, 0, v33, vcc
v_cmp_eq_u32_sdwa vcc, v30, v32 src0_sel:WORD_1 src1_sel:WORD_1
s_nop 1
v_cndmask_b32 v32, 0, v30, vcc
L_rb4g:
v_perm_b32 v38, v31, v32, s72
v_bfi_b32 v45, 3, v32, v31
v_perm_b32 v24, v16, v73, s68
v_perm_b32 v25, v17, v73, s69
v_perm_b32 v26, v18, v73, s70
v_perm_b32 v27, v19, v73, s71
v_max3_f32 v28, |v24|, |v25|, |v26|
v_med3_f32 v29, |v24|, |v25|, |v26|
v_min3_f32 v30, |v24|, |v25|, |v26|
v_med3_f32 v32, v28, v29, |v27|
v_med3_f32 v33, v29, v30, |v27|
v_max_f32 v31, v28, |v27|
v_cmp_eq_u32_sdwa vcc, v33, v32 src0_sel:WORD_1 src1_sel:WORD_1
s_cbranch_scc0 L_rb5g
v_min_f32 v30, v30, |v27|
v_cndmask_b32 v31, 0, v33, vcc
v_cmp_eq_u32_sdwa vcc, v30, v32 src0_sel:WORD_1 src1_sel:WORD_1
s_nop 1
v_cndmask_b32 v32, 0, v30, vcc
L_rb5g:
v_perm_b32 v42, v31, v32, s72
v_bfi_b32 v47, 3, v32, v31
s_waitcnt vmcnt(0)
v_perm_b32 v24, v20, v74, s64
v_perm_b32 v25, v21, v74, s65
v_perm_b32 v26, v22, v74, s66
v_perm_b32 v27, v23, v74, s67
v_max3_f32 v28, |v24|, |v25|, |v26|
v_med3_f32 v29, |v24|, |v25|, |v26|
v_min3_f32 v30, |v24|, |v25|, |v26|
v_med3_f32 v32, v28, v29, |v27|
v_med3_f32 v33, v29, v30, |v27|
v_max_f32 v31, v28, |v27|
v_cmp_eq_u32_sdwa vcc, v33, v32 src0_sel:WORD_1 src1_sel:WORD_1
s_cbranch_scc0 L_rb6g
v_min_f32 v30, v30, |v27|
v_cndmask_b32 v31, 0, v33, vcc
v_cmp_eq_u32_sdwa vcc, v30, v32 src0_sel:WORD_1 src1_sel:WORD_1
s_nop 1
v_cndmask_b32 v32, 0, v30, vcc
L_rb6g:
v_perm_b32 v39, v31, v32, s72
v_bfi_b32 v31, 3, v32, v31
v_lshlrev_b32 v31, 4, v31
v_bfi_b32 v45, 15, v45, v31
v_perm_b32 v24, v20, v75, s68
v_perm_b32 v25, v21, v75, s69
v_perm_b32 v26, v22, v75, s70
v_perm_b32 v27, v23, v75, s71
v_max3_f32 v28, |v24|, |v25|, |v26|
v_med3_f32 v29, |v24|, |v25|, |v26|
v_min3_f32 v30, |v24|, |v25|, |v26|
v_med3_f32 v32, v28, v29, |v27|
v_med3_f32 v33, v29, v30, |v27|
v_max_f32 v31, v28, |v27|
v_cmp_eq_u32_sdwa vcc, v33, v32 src0_sel:WORD_1 src1_sel:WORD_1
s_cbranch_scc0 L_rb7g
v_min_f32 v30, v30, |v27|
v_cndmask_b32 v31, 0, v33, vcc
v_cmp_eq_u32_sdwa vcc, v30, v32 src0_sel:WORD_1 src1_sel:WORD_1
s_nop 1
v_cndmask_b32 v32, 0, v30, vcc
L_rb7g:
v_perm_b32 v43, v31, v32, s72
v_bfi_b32 v31, 3, v32, v31
v_lshlrev_b32 v31, 4, v31
v_bfi_b32 v47, 15, v47, v31
s_mov_b32 vcc_lo, 0x33333333
s_mov_b32 vcc_hi, 0x33333333
v_cndmask_b32_dpp v24, v40, v36, vcc quad_perm:[2,3,0,1] row_mask:0xf bank_mask:0xf
v_cndmask_b32_dpp v25, v41, v37, vcc quad_perm:[2,3,0,1] row_mask:0xf bank_mask:0xf
v_cndmask_b32_dpp v26, v42, v38, vcc quad_perm:[2,3,0,1] row_mask:0xf bank_mask:0xf
v_cndmask_b32_dpp v27, v43, v39, vcc quad_perm:[2,3,0,1] row_mask:0xf bank_mask:0xf
s_not_b64 vcc, vcc
buffer_store_dwordx4 v[24:27], v51, s[24:27], 0 offen sc1
v_cndmask_b32_dpp v40, v36, v40, vcc quad_perm:[2,3,0,1] row_mask:0xf bank_mask:0xf
v_cndmask_b32_dpp v41, v37, v41, vcc quad_perm:[2,3,0,1] row_mask:0xf bank_mask:0xf
v_cndmask_b32_dpp v42, v38, v42, vcc quad_perm:[2,3,0,1] row_mask:0xf bank_mask:0xf
v_cndmask_b32_dpp v43, v39, v43, vcc quad_perm:[2,3,0,1] row_mask:0xf bank_mask:0xf
s_mov_b32 s52, 0x0c0c0400
s_mov_b32 s53, 0x04000c0c
buffer_store_dwordx4 v[40:43], v66, s[24:27], 0 offen sc1
v_perm_b32 v48, v45, v44, s52
v_perm_b32 v49, v47, v46, s53
v_or_b32 v48, v48, v49
s_nop 1
v_mov_b32_dpp v49, v48 quad_perm:[2,3,0,1] row_mask:0xf bank_mask:0xf
v_perm_b32 v48, v49, v48, v55
buffer_store_dword v48, v52, s[24:27], 0 offen sc1
s_waitcnt vmcnt(0)
s_add_u32 s84, s84, 1
s_cmp_lt_u32 s84, 41
s_cbranch_scc1 L_st
s_add_u32 s87, s87, 1
s_cmp_lt_u32 s87, 2
s_cbranch_scc1 L_sm
v_lshrrev_b32 v72, 3, v7
v_and_b32 v73, 7, v7
v_xor_b32 v73, v73, v72
v_mul_u32_u24 v72, 1152, v72
s_and_b32 s47, s40, 1
s_mul_i32 s47, s47, 9216
s_lshr_b32 s3, s40, 1
s_lshl_b32 s3, s3, 7
s_add_u32 s47, s47, s3
v_lshl_add_u32 v72, v73, 4, v72
v_add_u32 v3, s47, v72
s_lshl_b32 s44, s40, 10
s_mul_i32 s45, s2, 18432
s_mov_b32 s46, s45
s_lshr_b32 s47, s40, 1
s_lshl_b32 s3, s47, 11
s_sub_u32 s8, 15488, s3
s_lshl_b32 s3, s47, 7
s_add_u32 s7, s45, 128
s_sub_u32 s7, s7, s3
s_sub_u32 s10, s47, 1
s_sub_u32 s11, 0, s47
s_mov_b32 s9, s44
s_mov_b32 s13, 4718592
s_mov_b32 s15, 16
s_mov_b32 s14, s13
s_mov_b32 s22, 75497472
s_mov_b32 s18, 75497472
s_mov_b32 s41, 0
L_stile:
s_barrier
s_add_u32 m0, s44, 0
s_nop 0
buffer_load_dwordx4 v3, s[16:19], s45 offen offset:0 nt lds
s_add_u32 m0, s44, 3840
s_nop 0
buffer_load_dwordx4 v3, s[16:19], s45 offen offset:256 nt lds
s_add_u32 m0, s44, 7680
s_nop 0
buffer_load_dwordx4 v3, s[16:19], s45 offen offset:512 nt lds
s_add_u32 m0, s44, 11520
s_nop 0
buffer_load_dwordx4 v3, s[16:19], s45 offen offset:768 nt lds
s_add_u32 m0, s44, s8
s_mov_b64 exec, s[10:11]
buffer_load_dwordx4 v3, s[16:19], s7 offen offset:896 nt lds
s_mov_b64 exec, -1
ds_read_b128 v[8:11], v2 offset:1024
ds_read_b128 v[12:15], v2 offset:1088
ds_read_b128 v[16:19], v2 offset:1152
ds_read_b128 v[20:23], v2 offset:1216
ds_read_b128 v[24:27], v2 offset:1280
ds_read_b128 v[28:31], v2 offset:1344
ds_read_b128 v[32:35], v2 offset:1408
ds_read_b128 v[36:39], v2 offset:1472
ds_read_b128 v[40:43], v2 offset:1536
s_mov_b32 s87, 0
L_spass:
s_lshl_b32 s86, s2, 1
s_add_u32 s86, s86, s87
s_add_u32 s86, s86, 1
s_mul_i32 s86, s86, 393216
s_mul_i32 s47, s40, 82944
s_add_u32 s47, s47, s86
v_lshl_add_u32 v104, v7, 4, s47
s_mul_i32 s47, s40, 9216
s_add_u32 s47, s47, s86
s_add_u32 s47, s47, 331776
v_lshl_add_u32 v105, v7, 4, s47
s_lshl_b32 s47, s40, 6
s_add_u32 s47, s47, s86
s_add_u32 s47, s47, 368640
v_and_b32 v106, 15, v7
v_lshl_add_u32 v106, v106, 2, s47
v_lshrrev_b32 v107, 4, v7
v_lshl_add_u32 v106, v107, 8, v106
buffer_load_dword v174, v106, s[24:27], 0 offen offset:0 sc1
buffer_load_dword v175, v106, s[24:27], 0 offen offset:1024 sc1
buffer_load_dword v176, v106, s[24:27], 0 offen offset:2048 sc1
buffer_load_dword v177, v106, s[24:27], 0 offen offset:3072 sc1
s_mov_b32 s99, 4096
buffer_load_dword v178, v106, s[24:27], s99 offen offset:0 sc1
s_mov_b32 s98, 0
buffer_load_dwordx4 v[138:141], v105, s[24:27], s98 offen sc1
s_mov_b32 s99, 0
buffer_load_dwordx4 a[0:3], v104, s[24:27], s99 offen offset:0 sc1
buffer_load_dwordx4 a[4:7], v104, s[24:27], s99 offen offset:1024 sc1
buffer_load_dwordx4 a[8:11], v104, s[24:27], s99 offen offset:2048 sc1
buffer_load_dwordx4 a[12:15], v104, s[24:27], s99 offen offset:3072 sc1
s_mov_b32 s99, 4096
buffer_load_dwordx4 a[16:19], v104, s[24:27], s99 offen offset:0 sc1
buffer_load_dwordx4 a[20:23], v104, s[24:27], s99 offen offset:1024 sc1
buffer_load_dwordx4 a[24:27], v104, s[24:27], s99 offen offset:2048 sc1
buffer_load_dwordx4 a[28:31], v104, s[24:27], s99 offen offset:3072 sc1
s_mov_b32 s99, 8192
buffer_load_dwordx4 a[32:35], v104, s[24:27], s99 offen offset:0 sc1
s_mov_b32 s98, 1024
buffer_load_dwordx4 v[142:145], v105, s[24:27], s98 offen sc1
buffer_load_dwordx4 a[36:39], v104, s[24:27], s99 offen offset:1024 sc1
buffer_load_dwordx4 a[40:43], v104, s[24:27], s99 offen offset:2048 sc1
buffer_load_dwordx4 a[44:47], v104, s[24:27], s99 offen offset:3072 sc1
s_mov_b32 s99, 12288
buffer_load_dwordx4 a[48:51], v104, s[24:27], s99 offen offset:0 sc1
buffer_load_dwordx4 a[52:55], v104, s[24:27], s99 offen offset:1024 sc1
buffer_load_dwordx4 a[56:59], v104, s[24:27], s99 offen offset:2048 sc1
buffer_load_dwordx4 a[60:63], v104, s[24:27], s99 offen offset:3072 sc1
s_mov_b32 s99, 16384
buffer_load_dwordx4 a[64:67], v104, s[24:27], s99 offen offset:0 sc1
buffer_load_dwordx4 a[68:71], v104, s[24:27], s99 offen offset:1024 sc1
s_mov_b32 s98, 2048
buffer_load_dwordx4 v[146:149], v105, s[24:27], s98 offen sc1
buffer_load_dwordx4 a[72:75], v104, s[24:27], s99 offen offset:2048 sc1
buffer_load_dwordx4 a[76:79], v104, s[24:27], s99 offen offset:3072 sc1
s_mov_b32 s99, 20480
buffer_load_dwordx4 a[80:83], v104, s[24:27], s99 offen offset:0 sc1
buffer_load_dwordx4 a[84:87], v104, s[24:27], s99 offen offset:1024 sc1
buffer_load_dwordx4 a[88:91], v104, s[24:27], s99 offen offset:2048 sc1
buffer_load_dwordx4 a[92:95], v104, s[24:27], s99 offen offset:3072 sc1
s_mov_b32 s99, 24576
buffer_load_dwordx4 a[96:99], v104, s[24:27], s99 offen offset:0 sc1
buffer_load_dwordx4 a[100:103], v104, s[24:27], s99 offen offset:1024 sc1
buffer_load_dwordx4 a[104:107], v104, s[24:27], s99 offen offset:2048 sc1
s_mov_b32 s98, 3072
buffer_load_dwordx4 v[150:153], v105, s[24:27], s98 offen sc1
buffer_load_dwordx4 a[108:111], v104, s[24:27], s99 offen offset:3072 sc1
s_mov_b32 s99, 28672
buffer_load_dwordx4 a[112:115], v104, s[24:27], s99 offen offset:0 sc1
buffer_load_dwordx4 a[116:119], v104, s[24:27], s99 offen offset:1024 sc1
buffer_load_dwordx4 a[120:123], v104, s[24:27], s99 offen offset:2048 sc1
buffer_load_dwordx4 a[124:127], v104, s[24:27], s99 offen offset:3072 sc1
s_mov_b32 s99, 32768
buffer_load_dwordx4 a[128:131], v104, s[24:27], s99 offen offset:0 sc1
buffer_load_dwordx4 a[132:135], v104, s[24:27], s99 offen offset:1024 sc1
buffer_load_dwordx4 a[136:139], v104, s[24:27], s99 offen offset:2048 sc1
buffer_load_dwordx4 a[140:143], v104, s[24:27], s99 offen offset:3072 sc1
s_mov_b32 s98, 4096
buffer_load_dwordx4 v[154:157], v105, s[24:27], s98 offen sc1
s_mov_b32 s99, 36864
buffer_load_dwordx4 a[144:147], v104, s[24:27], s99 offen offset:0 sc1
buffer_load_dwordx4 a[148:151], v104, s[24:27], s99 offen offset:1024 sc1
buffer_load_dwordx4 a[152:155], v104, s[24:27], s99 offen offset:2048 sc1
buffer_load_dwordx4 a[156:159], v104, s[24:27], s99 offen offset:3072 sc1
s_mov_b32 s99, 40960
buffer_load_dwordx4 a[160:163], v104, s[24:27], s99 offen offset:0 sc1
buffer_load_dwordx4 a[164:167], v104, s[24:27], s99 offen offset:1024 sc1
buffer_load_dwordx4 a[168:171], v104, s[24:27], s99 offen offset:2048 sc1
buffer_load_dwordx4 a[172:175], v104, s[24:27], s99 offen offset:3072 sc1
s_mov_b32 s99, 45056
buffer_load_dwordx4 a[176:179], v104, s[24:27], s99 offen offset:0 sc1
s_mov_b32 s98, 5120
buffer_load_dwordx4 v[158:161], v105, s[24:27], s98 offen sc1
buffer_load_dwordx4 a[180:183], v104, s[24:27], s99 offen offset:1024 sc1
buffer_load_dwordx4 a[184:187], v104, s[24:27], s99 offen offset:2048 sc1
buffer_load_dwordx4 a[188:191], v104, s[24:27], s99 offen offset:3072 sc1
s_mov_b32 s99, 49152
buffer_load_dwordx4 a[192:195], v104, s[24:27], s99 offen offset:0 sc1
buffer_load_dwordx4 a[196:199], v104, s[24:27], s99 offen offset:1024 sc1
buffer_load_dwordx4 a[200:203], v104, s[24:27], s99 offen offset:2048 sc1
buffer_load_dwordx4 a[204:207], v104, s[24:27], s99 offen offset:3072 sc1
s_mov_b32 s99, 53248
buffer_load_dwordx4 a[208:211], v104, s[24:27], s99 offen offset:0 sc1
buffer_load_dwordx4 a[212:215], v104, s[24:27], s99 offen offset:1024 sc1
s_mov_b32 s98, 6144
buffer_load_dwordx4 v[162:165], v105, s[24:27], s98 offen sc1
buffer_load_dwordx4 a[216:219], v104, s[24:27], s99 offen offset:2048 sc1
buffer_load_dwordx4 a[220:223], v104, s[24:27], s99 offen offset:3072 sc1
s_mov_b32 s99, 57344
buffer_load_dwordx4 a[224:227], v104, s[24:27], s99 offen offset:0 sc1
buffer_load_dwordx4 a[228:231], v104, s[24:27], s99 offen offset:1024 sc1
buffer_load_dwordx4 a[232:235], v104, s[24:27], s99 offen offset:2048 sc1
buffer_load_dwordx4 a[236:239], v104, s[24:27], s99 offen offset:3072 sc1
s_mov_b32 s99, 61440
buffer_load_dwordx4 a[240:243], v104, s[24:27], s99 offen offset:0 sc1
buffer_load_dwordx4 a[244:247], v104, s[24:27], s99 offen offset:1024 sc1
buffer_load_dwordx4 a[248:251], v104, s[24:27], s99 offen offset:2048 sc1
s_mov_b32 s98, 7168
buffer_load_dwordx4 v[166:169], v105, s[24:27], s98 offen sc1
buffer_load_dwordx4 a[252:255], v104, s[24:27], s99 offen offset:3072 sc1
s_mov_b32 s99, 65536
buffer_load_dwordx4 v[186:189], v104, s[24:27], s99 offen offset:0 sc1
buffer_load_dwordx4 v[190:193], v104, s[24:27], s99 offen offset:1024 sc1
buffer_load_dwordx4 v[194:197], v104, s[24:27], s99 offen offset:2048 sc1
buffer_load_dwordx4 v[198:201], v104, s[24:27], s99 offen offset:3072 sc1
s_mov_b32 s99, 69632
buffer_load_dwordx4 v[202:205], v104, s[24:27], s99 offen offset:0 sc1
buffer_load_dwordx4 v[206:209], v104, s[24:27], s99 offen offset:1024 sc1
buffer_load_dwordx4 v[210:213], v104, s[24:27], s99 offen offset:2048 sc1
buffer_load_dwordx4 v[214:217], v104, s[24:27], s99 offen offset:3072 sc1
s_mov_b32 s98, 8192
buffer_load_dwordx4 v[170:173], v105, s[24:27], s98 offen sc1
s_mov_b32 s99, 73728
buffer_load_dwordx4 v[218:221], v104, s[24:27], s99 offen offset:0 sc1
buffer_load_dwordx4 v[222:225], v104, s[24:27], s99 offen offset:1024 sc1
buffer_load_dwordx4 v[226:229], v104, s[24:27], s99 offen offset:2048 sc1
buffer_load_dwordx4 v[230:233], v104, s[24:27], s99 offen offset:3072 sc1
s_mov_b32 s99, 77824
buffer_load_dwordx4 v[234:237], v104, s[24:27], s99 offen offset:0 sc1
buffer_load_dwordx4 v[238:241], v104, s[24:27], s99 offen offset:1024 sc1
buffer_load_dwordx4 v[242:245], v104, s[24:27], s99 offen offset:2048 sc1
buffer_load_dwordx4 v[246:249], v104, s[24:27], s99 offen offset:3072 sc1
s_mov_b32 s99, 81920
buffer_load_dwordx4 v[250:253], v104, s[24:27], s99 offen offset:0 sc1
s_waitcnt vmcnt(0)
s_barrier
ds_read_b128 v[44:47], v0 offset:0
ds_read_b128 v[48:51], v1 offset:0
s_waitcnt lgkmcnt(0)
v_smfmac_f32_16x16x64_bf16 v[8:11], a[0:3], v[44:51], v138
v_smfmac_f32_16x16x64_bf16 v[12:15], a[4:7], v[44:51], v138 abid:1
v_smfmac_f32_16x16x64_bf16 v[16:19], a[8:11], v[44:51], v139
v_smfmac_f32_16x16x64_bf16 v[20:23], a[12:15], v[44:51], v139 abid:1
v_smfmac_f32_16x16x64_bf16 v[24:27], a[16:19], v[44:51], v140
v_smfmac_f32_16x16x64_bf16 v[28:31], a[20:23], v[44:51], v140 abid:1
v_smfmac_f32_16x16x64_bf16 v[32:35], a[24:27], v[44:51], v141
v_smfmac_f32_16x16x64_bf16 v[36:39], a[28:31], v[44:51], v141 abid:1
v_smfmac_f32_16x16x64_bf16 v[40:43], a[32:35], v[44:51], v174
s_nop 7
ds_read_b128 v[44:47], v0 offset:2048
ds_read_b128 v[48:51], v1 offset:2048
s_waitcnt lgkmcnt(0)
v_smfmac_f32_16x16x64_bf16 v[8:11], a[36:39], v[44:51], v142
v_smfmac_f32_16x16x64_bf16 v[12:15], a[40:43], v[44:51], v142 abid:1
v_smfmac_f32_16x16x64_bf16 v[16:19], a[44:47], v[44:51], v143
v_smfmac_f32_16x16x64_bf16 v[20:23], a[48:51], v[44:51], v143 abid:1
v_smfmac_f32_16x16x64_bf16 v[24:27], a[52:55], v[44:51], v144
v_smfmac_f32_16x16x64_bf16 v[28:31], a[56:59], v[44:51], v144 abid:1
v_smfmac_f32_16x16x64_bf16 v[32:35], a[60:63], v[44:51], v145
v_smfmac_f32_16x16x64_bf16 v[36:39], a[64:67], v[44:51], v145 abid:1
v_smfmac_f32_16x16x64_bf16 v[40:43], a[68:71], v[44:51], v174 abid:1
s_nop 7
ds_read_b128 v[44:47], v0 offset:4096
ds_read_b128 v[48:51], v1 offset:4096
s_waitcnt lgkmcnt(0)
v_smfmac_f32_16x16x64_bf16 v[8:11], a[72:75], v[44:51], v146
v_smfmac_f32_16x16x64_bf16 v[12:15], a[76:79], v[44:51], v146 abid:1
v_smfmac_f32_16x16x64_bf16 v[16:19], a[80:83], v[44:51], v147
v_smfmac_f32_16x16x64_bf16 v[20:23], a[84:87], v[44:51], v147 abid:1
v_smfmac_f32_16x16x64_bf16 v[24:27], a[88:91], v[44:51], v148
v_smfmac_f32_16x16x64_bf16 v[28:31], a[92:95], v[44:51], v148 abid:1
v_smfmac_f32_16x16x64_bf16 v[32:35], a[96:99], v[44:51], v149
v_smfmac_f32_16x16x64_bf16 v[36:39], a[100:103], v[44:51], v149 abid:1
v_smfmac_f32_16x16x64_bf16 v[40:43], a[104:107], v[44:51], v175
s_nop 7
ds_read_b128 v[44:47], v0 offset:6144
ds_read_b128 v[48:51], v1 offset:6144
s_waitcnt lgkmcnt(0)
v_smfmac_f32_16x16x64_bf16 v[8:11], a[108:111], v[44:51], v150
v_smfmac_f32_16x16x64_bf16 v[12:15], a[112:115], v[44:51], v150 abid:1
v_smfmac_f32_16x16x64_bf16 v[16:19], a[116:119], v[44:51], v151
v_smfmac_f32_16x16x64_bf16 v[20:23], a[120:123], v[44:51], v151 abid:1
v_smfmac_f32_16x16x64_bf16 v[24:27], a[124:127], v[44:51], v152
v_smfmac_f32_16x16x64_bf16 v[28:31], a[128:131], v[44:51], v152 abid:1
v_smfmac_f32_16x16x64_bf16 v[32:35], a[132:135], v[44:51], v153
v_smfmac_f32_16x16x64_bf16 v[36:39], a[136:139], v[44:51], v153 abid:1
v_smfmac_f32_16x16x64_bf16 v[40:43], a[140:143], v[44:51], v175 abid:1
s_nop 7
ds_read_b128 v[44:47], v0 offset:8192
ds_read_b128 v[48:51], v1 offset:8192
s_waitcnt lgkmcnt(0)
v_smfmac_f32_16x16x64_bf16 v[8:11], a[144:147], v[44:51], v154
v_smfmac_f32_16x16x64_bf16 v[12:15], a[148:151], v[44:51], v154 abid:1
v_smfmac_f32_16x16x64_bf16 v[16:19], a[152:155], v[44:51], v155
v_smfmac_f32_16x16x64_bf16 v[20:23], a[156:159], v[44:51], v155 abid:1
v_smfmac_f32_16x16x64_bf16 v[24:27], a[160:163], v[44:51], v156
v_smfmac_f32_16x16x64_bf16 v[28:31], a[164:167], v[44:51], v156 abid:1
v_smfmac_f32_16x16x64_bf16 v[32:35], a[168:171], v[44:51], v157
v_smfmac_f32_16x16x64_bf16 v[36:39], a[172:175], v[44:51], v157 abid:1
v_smfmac_f32_16x16x64_bf16 v[40:43], a[176:179], v[44:51], v176
s_nop 7
ds_read_b128 v[44:47], v0 offset:10240
ds_read_b128 v[48:51], v1 offset:10240
s_waitcnt lgkmcnt(0)
v_smfmac_f32_16x16x64_bf16 v[8:11], a[180:183], v[44:51], v158
v_smfmac_f32_16x16x64_bf16 v[12:15], a[184:187], v[44:51], v158 abid:1
v_smfmac_f32_16x16x64_bf16 v[16:19], a[188:191], v[44:51], v159
v_smfmac_f32_16x16x64_bf16 v[20:23], a[192:195], v[44:51], v159 abid:1
v_smfmac_f32_16x16x64_bf16 v[24:27], a[196:199], v[44:51], v160
v_smfmac_f32_16x16x64_bf16 v[28:31], a[200:203], v[44:51], v160 abid:1
v_smfmac_f32_16x16x64_bf16 v[32:35], a[204:207], v[44:51], v161
v_smfmac_f32_16x16x64_bf16 v[36:39], a[208:211], v[44:51], v161 abid:1
v_smfmac_f32_16x16x64_bf16 v[40:43], a[212:215], v[44:51], v176 abid:1
s_nop 7
ds_read_b128 v[44:47], v0 offset:12288
ds_read_b128 v[48:51], v1 offset:12288
s_waitcnt lgkmcnt(0)
v_smfmac_f32_16x16x64_bf16 v[8:11], a[216:219], v[44:51], v162
v_smfmac_f32_16x16x64_bf16 v[12:15], a[220:223], v[44:51], v162 abid:1
v_smfmac_f32_16x16x64_bf16 v[16:19], a[224:227], v[44:51], v163
v_smfmac_f32_16x16x64_bf16 v[20:23], a[228:231], v[44:51], v163 abid:1
v_smfmac_f32_16x16x64_bf16 v[24:27], a[232:235], v[44:51], v164
v_smfmac_f32_16x16x64_bf16 v[28:31], a[236:239], v[44:51], v164 abid:1
v_smfmac_f32_16x16x64_bf16 v[32:35], a[240:243], v[44:51], v165
v_smfmac_f32_16x16x64_bf16 v[36:39], a[244:247], v[44:51], v165 abid:1
v_smfmac_f32_16x16x64_bf16 v[40:43], a[248:251], v[44:51], v177
s_nop 7
ds_read_b128 v[44:47], v0 offset:14336
ds_read_b128 v[48:51], v1 offset:14336
s_waitcnt lgkmcnt(0)
v_smfmac_f32_16x16x64_bf16 v[8:11], a[252:255], v[44:51], v166
v_smfmac_f32_16x16x64_bf16 v[12:15], v[186:189], v[44:51], v166 abid:1
v_smfmac_f32_16x16x64_bf16 v[16:19], v[190:193], v[44:51], v167
v_smfmac_f32_16x16x64_bf16 v[20:23], v[194:197], v[44:51], v167 abid:1
v_smfmac_f32_16x16x64_bf16 v[24:27], v[198:201], v[44:51], v168
v_smfmac_f32_16x16x64_bf16 v[28:31], v[202:205], v[44:51], v168 abid:1
v_smfmac_f32_16x16x64_bf16 v[32:35], v[206:209], v[44:51], v169
v_smfmac_f32_16x16x64_bf16 v[36:39], v[210:213], v[44:51], v169 abid:1
v_smfmac_f32_16x16x64_bf16 v[40:43], v[214:217], v[44:51], v177 abid:1
s_nop 7
ds_read_b128 v[44:47], v0 offset:16384
ds_read_b128 v[48:51], v1 offset:16384
s_waitcnt lgkmcnt(0)
v_smfmac_f32_16x16x64_bf16 v[8:11], v[218:221], v[44:51], v170
v_smfmac_f32_16x16x64_bf16 v[12:15], v[222:225], v[44:51], v170 abid:1
v_smfmac_f32_16x16x64_bf16 v[16:19], v[226:229], v[44:51], v171
v_smfmac_f32_16x16x64_bf16 v[20:23], v[230:233], v[44:51], v171 abid:1
v_smfmac_f32_16x16x64_bf16 v[24:27], v[234:237], v[44:51], v172
v_smfmac_f32_16x16x64_bf16 v[28:31], v[238:241], v[44:51], v172 abid:1
v_smfmac_f32_16x16x64_bf16 v[32:35], v[242:245], v[44:51], v173
v_smfmac_f32_16x16x64_bf16 v[36:39], v[246:249], v[44:51], v173 abid:1
v_smfmac_f32_16x16x64_bf16 v[40:43], v[250:253], v[44:51], v178
s_nop 7
s_add_u32 s87, s87, 1
s_cmp_lt_u32 s87, 2
s_cbranch_scc1 L_spass
v_cvt_pk_bf16_f32 v92, v8, v9
v_cvt_pk_bf16_f32 v93, v10, v11
v_cvt_pk_bf16_f32 v94, v12, v13
v_cvt_pk_bf16_f32 v95, v14, v15
v_cvt_pk_bf16_f32 v96, v16, v17
v_cvt_pk_bf16_f32 v97, v18, v19
v_cvt_pk_bf16_f32 v98, v20, v21
v_cvt_pk_bf16_f32 v99, v22, v23
v_cvt_pk_bf16_f32 v100, v24, v25
v_cvt_pk_bf16_f32 v101, v26, v27
v_cvt_pk_bf16_f32 v102, v28, v29
v_cvt_pk_bf16_f32 v103, v30, v31
v_cvt_pk_bf16_f32 v104, v32, v33
v_cvt_pk_bf16_f32 v105, v34, v35
s_mov_b64 vcc, s[80:81]
s_nop 7
v_cvt_pk_bf16_f32 v106, v36, v37
v_cvt_pk_bf16_f32 v107, v38, v39
v_cvt_pk_bf16_f32 v112, v40, v41
v_cvt_pk_bf16_f32 v113, v42, v43
s_nop 1
v_cndmask_b32_dpp v108, v96, v92, vcc quad_perm:[1,0,3,2] row_mask:0xf bank_mask:0xf
s_nop 1
v_cndmask_b32_dpp v109, v97, v93, vcc quad_perm:[1,0,3,2] row_mask:0xf bank_mask:0xf
s_nop 1
v_cndmask_b32_dpp v110, v98, v94, vcc quad_perm:[1,0,3,2] row_mask:0xf bank_mask:0xf
s_nop 1
v_cndmask_b32_dpp v111, v99, v95, vcc quad_perm:[1,0,3,2] row_mask:0xf bank_mask:0xf
s_waitcnt lgkmcnt(0)
buffer_store_dwordx4 v[108:111], v4, s[20:23], s46 offen offset:0 sc1
s_nop 1
s_mov_b64 vcc, s[82:83]
s_nop 1
v_cndmask_b32_dpp v96, v92, v96, vcc quad_perm:[1,0,3,2] row_mask:0xf bank_mask:0xf
s_nop 1
v_cndmask_b32_dpp v97, v93, v97, vcc quad_perm:[1,0,3,2] row_mask:0xf bank_mask:0xf
s_nop 1
v_cndmask_b32_dpp v98, v94, v98, vcc quad_perm:[1,0,3,2] row_mask:0xf bank_mask:0xf
s_nop 1
v_cndmask_b32_dpp v99, v95, v99, vcc quad_perm:[1,0,3,2] row_mask:0xf bank_mask:0xf
s_waitcnt lgkmcnt(0)
buffer_store_dwordx4 v[96:99], v4, s[20:23], s46 offen offset:1152 sc1
s_nop 1
s_mov_b64 vcc, s[80:81]
s_nop 1
v_cndmask_b32_dpp v92, v104, v100, vcc quad_perm:[1,0,3,2] row_mask:0xf bank_mask:0xf
s_nop 1
v_cndmask_b32_dpp v93, v105, v101, vcc quad_perm:[1,0,3,2] row_mask:0xf bank_mask:0xf
s_nop 1
v_cndmask_b32_dpp v94, v106, v102, vcc quad_perm:[1,0,3,2] row_mask:0xf bank_mask:0xf
s_nop 1
v_cndmask_b32_dpp v95, v107, v103, vcc quad_perm:[1,0,3,2] row_mask:0xf bank_mask:0xf
s_nop 1
ds_bpermute_b32 v112, v6, v112
s_nop 1
ds_bpermute_b32 v113, v6, v113
s_waitcnt lgkmcnt(0)
buffer_store_dwordx4 v[92:95], v4, s[20:23], s46 offen offset:128 sc1
s_nop 1
s_mov_b64 vcc, s[82:83]
s_nop 1
v_cndmask_b32_dpp v104, v100, v104, vcc quad_perm:[1,0,3,2] row_mask:0xf bank_mask:0xf
s_nop 1
v_cndmask_b32_dpp v105, v101, v105, vcc quad_perm:[1,0,3,2] row_mask:0xf bank_mask:0xf
s_nop 1
v_cndmask_b32_dpp v106, v102, v106, vcc quad_perm:[1,0,3,2] row_mask:0xf bank_mask:0xf
s_nop 1
v_cndmask_b32_dpp v107, v103, v107, vcc quad_perm:[1,0,3,2] row_mask:0xf bank_mask:0xf
s_waitcnt lgkmcnt(0)
buffer_store_dwordx4 v[104:107], v4, s[20:23], s46 offen offset:1280 sc1
s_nop 1
s_mov_b64 vcc, s[80:81]
s_waitcnt lgkmcnt(0)
buffer_store_dwordx2 v[112:113], v5, s[20:23], s46 offen
s_nop 1
s_add_u32 s45, s45, s13
s_add_u32 s7, s7, s13
s_add_u32 s46, s46, s13
s_mov_b32 s13, 4718592
s_add_u32 s41, s41, 1
s_cmp_lt_u32 s41, s15
s_cbranch_scc1 L_stile
s_branch L_fin
.section .rodata,"a"
.p2align 6
.amdhsa_kernel standalone__structured_sparse_n_m__ragged_kernel
  .amdhsa_next_free_vgpr 512
  .amdhsa_next_free_sgpr 102
  .amdhsa_accum_offset 256
  .amdhsa_group_segment_fixed_size 0
  .amdhsa_float_denorm_mode_32 3
  .amdhsa_kernarg_size 48
  .amdhsa_user_sgpr_count 2
  .amdhsa_user_sgpr_kernarg_segment_ptr 1
  .amdhsa_system_sgpr_workgroup_id_x 1
.end_amdhsa_kernel
```

```asm
; @launch grid=(256,1,1) block=(256,1,1) lds=163840
.amdgcn_target "amdgcn-amd-amdhsa--gfx950"
.text
.globl standalone__structured_sparse_n_m__ragged_kernel
.p2align 8
.type standalone__structured_sparse_n_m__ragged_kernel,@function
standalone__structured_sparse_n_m__ragged_kernel:
s_load_dwordx8 s[4:11], s[0:1], 0
s_load_dwordx4 s[12:15], s[0:1], 32
s_cmp_ge_u32 s2, 256
s_cbranch_scc1 L_end_standalone__structured_sparse_n_m__ragged_kernel
v_lshlrev_b32 v3, 7, v0
s_getpc_b64 s[96:97]
v_min_u32 v2, L_slow-standalone__structured_sparse_n_m__ragged_kernel, v3
global_load_dword v120, v2, s[96:97]
v_lshrrev_b32 v1, 6, v0
v_and_b32 v7, 63, v0
v_readfirstlane_b32 s40, v1
s_mov_b32 s86, 0
s_lshr_b32 s84, s2, 3
s_mul_i32 s84, s84, 2
s_and_b32 s47, s2, 7
s_add_u32 s84, s84, s47
s_cmp_lt_u32 s47, 2
s_cselect_b32 s84, s84, 63
s_cmp_lt_u32 s84, 41
s_cbranch_scc1 L_prod
s_mov_b32 s85, 0x800020
s_mov_b32 s47, 0x800020
s_bitcmp1_b32 s2, 3
s_cselect_b32 s85, s85, 0x230003c
s_cselect_b32 s47, s47, 0x230003c
s_bitcmp1_b32 s2, 4
s_cselect_b32 s85, s47, s85
v_lshrrev_b32 v72, 3, v7
v_and_b32 v73, 7, v7
v_xor_b32 v73, v73, v72
v_mul_u32_u24 v72, 1152, v72
s_and_b32 s47, s40, 1
s_mul_i32 s47, s47, 9216
s_lshr_b32 s3, s40, 1
s_lshl_b32 s3, s3, 7
s_add_u32 s47, s47, s3
v_lshl_add_u32 v72, v73, 4, v72
v_add_u32 v3, s47, v72
s_lshl_b32 s44, s40, 10
s_mul_i32 s45, s2, 18432
s_mov_b32 s46, s45
s_waitcnt lgkmcnt(0)
s_mov_b32 s30, 663552
s_mov_b32 s31, 0x20000
s_mov_b32 s28, s6
s_and_b32 s29, s7, 0xffff
s_mov_b32 s18, 75497472
s_mov_b32 s19, 0x20000
s_mov_b32 s16, s4
s_and_b32 s17, s5, 0xffff
s_mov_b32 s26, 301989888
s_mov_b32 s27, 0x20000
s_mov_b32 s24, s14
s_and_b32 s25, s15, 0xffff
s_mov_b32 s34, 1152
s_mov_b32 s35, 0x20000
s_mov_b32 s32, s8
s_and_b32 s33, s9, 0xffff
s_mov_b32 s22, 0
s_mov_b32 s23, 0x20000
s_mov_b32 s20, s10
s_and_b32 s21, s11, 0xffff
s_mov_b32 s38, 256
s_mov_b32 s39, 0x20000
s_mov_b32 s36, s12
s_and_b32 s37, s13, 0xffff
L_cons3:
s_lshr_b32 s47, s40, 1
s_lshl_b32 s3, s47, 11
s_sub_u32 s8, 15488, s3
s_lshl_b32 s3, s47, 7
s_add_u32 s7, s45, 128
s_sub_u32 s7, s7, s3
s_sub_u32 s10, s47, 1
s_sub_u32 s11, 0, s47
s_mov_b32 s9, s44
s_mov_b32 s13, 4718592
s_mov_b32 s15, 16
s_mov_b32 s14, s13
s_bfe_u32 s88, s85, 0x40014
L_pf:
s_add_u32 m0, s44, 0
s_nop 0
buffer_load_dwordx4 v3, s[16:19], s45 offen offset:0 nt lds
s_add_u32 m0, s44, 3840
s_nop 0
buffer_load_dwordx4 v3, s[16:19], s45 offen offset:256 nt lds
s_add_u32 m0, s44, 7680
s_nop 0
buffer_load_dwordx4 v3, s[16:19], s45 offen offset:512 nt lds
s_add_u32 m0, s44, 11520
s_nop 0
buffer_load_dwordx4 v3, s[16:19], s45 offen offset:768 nt lds
s_add_u32 m0, s44, s8
s_mov_b64 exec, s[10:11]
buffer_load_dwordx4 v3, s[16:19], s7 offen offset:896 nt lds
s_mov_b64 exec, -1
s_add_u32 s7, s7, s13
s_add_u32 s44, s44, 18560
s_add_u32 s45, s45, s13
s_mov_b32 s13, 4718592
s_sub_u32 s88, s88, 1
s_cmp_lg_u32 s88, 0
s_cbranch_scc1 L_pf
L_pf_e:
s_branch L_rest
L_prod:
s_and_b32 s48, s84, 3
s_lshr_b32 s49, s84, 2
s_sub_u32 s50, s84, 36
s_lshl_b32 s51, s40, 4
s_lshl_b32 s52, s50, 1
s_lshl_b32 s53, s48, 8
s_cmp_lt_u32 s84, 36
s_cselect_b32 s52, s49, s52
s_cselect_b32 s53, s53, 1024
s_cselect_b32 s54, 8, 73728
s_cselect_b32 s55, 32, 8
s_cselect_b32 s56, 16, 32
s_cselect_b32 s57, 128, 64
s_mul_i32 s52, s52, 73728
s_mul_i32 s58, s40, 18432
v_and_b32 v58, 1, v7
v_bfe_u32 v59, v7, 1, 1
v_bfe_u32 v60, v7, 2, 2
v_bfe_u32 v62, v7, 4, 1
v_lshrrev_b32 v63, 5, v7
v_lshl_add_u32 v50, v58, 2, s52
v_mad_u32_u24 v50, v59, s54, v50
v_mad_u32_u24 v50, v60, s55, v50
v_mad_u32_u24 v50, v62, s56, v50
v_mad_u32_u24 v50, v63, s57, v50
v_add_u32 v50, s53, v50
v_add_u32 v50, s58, v50
v_add_u32 v62, 4608, v50
v_add_u32 v63, 9216, v50
v_add_u32 v64, 13824, v50
s_waitcnt lgkmcnt(0)
s_mov_b32 s30, 663552
s_mov_b32 s31, 0x20000
s_mov_b32 s28, s6
s_and_b32 s29, s7, 0xffff
buffer_load_dword v8, v50, s[28:31], 0 offen offset:0
buffer_load_dword v9, v50, s[28:31], 0 offen offset:1152
buffer_load_dword v10, v50, s[28:31], 0 offen offset:2304
buffer_load_dword v11, v50, s[28:31], 0 offen offset:3456
buffer_load_dword v12, v62, s[28:31], 0 offen offset:0
buffer_load_dword v13, v62, s[28:31], 0 offen offset:1152
buffer_load_dword v14, v62, s[28:31], 0 offen offset:2304
buffer_load_dword v15, v62, s[28:31], 0 offen offset:3456
buffer_load_dword v16, v63, s[28:31], 0 offen offset:0
buffer_load_dword v17, v63, s[28:31], 0 offen offset:1152
buffer_load_dword v18, v63, s[28:31], 0 offen offset:2304
buffer_load_dword v19, v63, s[28:31], 0 offen offset:3456
buffer_load_dword v20, v64, s[28:31], 0 offen offset:0
buffer_load_dword v21, v64, s[28:31], 0 offen offset:1152
buffer_load_dword v22, v64, s[28:31], 0 offen offset:2304
buffer_load_dword v23, v64, s[28:31], 0 offen offset:3456
s_mov_b32 s18, 75497472
s_mov_b32 s19, 0x20000
s_mov_b32 s16, s4
s_and_b32 s17, s5, 0xffff
s_mov_b32 s26, 301989888
s_mov_b32 s27, 0x20000
s_mov_b32 s24, s14
s_and_b32 s25, s15, 0xffff
s_mov_b32 s34, 1152
s_mov_b32 s35, 0x20000
s_mov_b32 s32, s8
s_and_b32 s33, s9, 0xffff
s_mov_b32 s22, 0
s_mov_b32 s23, 0x20000
s_mov_b32 s20, s10
s_and_b32 s21, s11, 0xffff
s_mov_b32 s38, 256
s_mov_b32 s39, 0x20000
s_mov_b32 s36, s12
s_and_b32 s37, s13, 0xffff
s_mul_i32 s52, s48, 9
s_add_u32 s52, s52, s49
s_mul_i32 s53, s52, 9
s_mul_i32 s54, s50, 18
s_add_u32 s54, s54, 8
s_lshl_b32 s55, s52, 2
s_add_u32 s55, s55, s40
s_lshl_b32 s56, s50, 2
s_add_u32 s56, s56, s40
s_cmp_eq_u32 s84, 40
s_cselect_b32 s57, 0x100000, 9
s_cmp_lt_u32 s84, 36
s_cselect_b32 s53, s53, s54
s_cselect_b32 s54, 2, 81
s_cselect_b32 s57, 1, s57
s_cselect_b32 s55, s55, s56
s_mov_b32 s56, 331776
s_cselect_b32 s56, s56, 368640
s_mov_b32 s58, 373760
s_cselect_b32 s58, s58, 382976
s_cselect_b32 s59, 16, 4
s_cselect_b32 s60, 4, 64
s_cselect_b32 s61, 12, 11
s_cselect_b32 s62, 1, 0x8001
v_lshrrev_b32 v61, 4, v7
v_lshlrev_b32 v62, 1, v58
v_lshl_add_u32 v60, v60, 2, v62
v_add_u32 v62, v60, v59
v_mul_u32_u24 v51, s54, v61
v_add_lshl_u32 v51, v51, s53, 6
v_add3_u32 v51, v51, v62, s51
v_lshl_add_u32 v51, v51, 4, s86
s_lshl_b32 s57, s57, 10
v_add_u32 v66, s57, v51
s_lshl_b32 s52, s55, 8
s_add_u32 s52, s52, s56
s_add_u32 s52, s52, s86
v_mul_u32_u24 v52, s59, v62
v_mad_u32_u24 v52, v61, s60, v52
v_add_u32 v52, s52, v52
s_lshr_b32 s52, s55, 2
s_lshl_b32 s52, s52, 8
s_add_u32 s58, s58, s52
s_add_u32 s58, s58, s51
s_lshl_b32 s52, s51, 1
s_add_u32 s52, s52, s62
v_lshl_add_u32 v62, v61, 1, v59
v_lshlrev_b32 v62, s61, v62
v_lshl_add_u32 v53, v60, 7, v62
v_add_u32 v53, s52, v53
v_and_b32 v62, 12, v7
v_mad_u32_u24 v62, v62, 3, v7
v_lshl_add_u32 v65, v62, 2, s58
s_lshl_b32 s52, s84, 2
s_add_u32 s52, s52, s40
s_lshl_b32 s52, s52, 7
s_add_u32 s52, s52, 268435456
v_writelane_b32 v65, s52, 16
s_mov_b32 s75, 0
s_mov_b32 s73, 0x05060100
s_mov_b32 s74, 0xffff
v_mov_b32 v55, 0x05040100
v_mov_b32 v62, 0x03020706
v_cmp_eq_u32 vcc, 1, v59
v_mov_b32 v68, 0xf0a0500
v_mov_b32 v69, 0x8f8a8580
v_mov_b32 v70, 0x1f1a1510
v_mov_b32 v71, 0x9f9a9590
v_mov_b32 v72, 0x2f2a2520
v_mov_b32 v73, 0xafaaa5a0
v_mov_b32 v74, 0x3f3a3530
v_mov_b32 v75, 0xbfbab5b0
v_cndmask_b32 v55, v55, v62, vcc
v_mov_b64 v[76:77], 0
v_mov_b64 v[78:79], 0
v_mov_b64 v[80:81], 0
v_mov_b32 v82, 0
s_mov_b32 s64, 0x5040500
s_mov_b32 s65, 0x5040501
s_mov_b32 s66, 0x5040502
s_mov_b32 s67, 0x5040503
s_mov_b32 s68, 0x7060700
s_mov_b32 s69, 0x7060701
s_mov_b32 s70, 0x7060702
s_mov_b32 s71, 0x7060703
s_mov_b32 s72, 0x05060102
s_waitcnt vmcnt(12)
v_perm_b32 v24, v8, v68, s64
v_perm_b32 v25, v9, v68, s65
v_perm_b32 v26, v10, v68, s66
v_perm_b32 v27, v11, v68, s67
v_max3_f32 v28, |v24|, |v25|, |v26|
v_med3_f32 v29, |v24|, |v25|, |v26|
v_min3_f32 v30, |v24|, |v25|, |v26|
v_med3_f32 v32, v28, v29, |v27|
v_med3_f32 v33, v29, v30, |v27|
v_max_f32 v31, v28, |v27|
v_perm_b32 v36, v31, v32, s72
v_bfi_b32 v44, 3, v32, v31
v_cmpx_eq_u32_sdwa vcc, v33, v32 src0_sel:WORD_1 src1_sel:WORD_1
v_mov_b32 v76, v33
v_min_f32 v77, v30, |v27|
s_mov_b64 exec, -1
v_perm_b32 v24, v8, v69, s68
v_perm_b32 v25, v9, v69, s69
v_perm_b32 v26, v10, v69, s70
v_perm_b32 v27, v11, v69, s71
v_max3_f32 v28, |v24|, |v25|, |v26|
v_med3_f32 v29, |v24|, |v25|, |v26|
v_min3_f32 v30, |v24|, |v25|, |v26|
v_med3_f32 v32, v28, v29, |v27|
v_med3_f32 v33, v29, v30, |v27|
v_max_f32 v31, v28, |v27|
v_perm_b32 v40, v31, v32, s72
v_bfi_b32 v46, 3, v32, v31
v_cmpx_eq_u32_sdwa vcc, v33, v32 src0_sel:WORD_1 src1_sel:WORD_1
v_mov_b64 v[78:79], v[76:77]
v_mov_b32 v76, v33
v_min_f32 v77, v30, |v27|
s_mov_b64 exec, -1
s_waitcnt vmcnt(8)
v_perm_b32 v24, v12, v70, s64
v_perm_b32 v25, v13, v70, s65
v_perm_b32 v26, v14, v70, s66
v_perm_b32 v27, v15, v70, s67
v_max3_f32 v28, |v24|, |v25|, |v26|
v_med3_f32 v29, |v24|, |v25|, |v26|
v_min3_f32 v30, |v24|, |v25|, |v26|
v_med3_f32 v32, v28, v29, |v27|
v_med3_f32 v33, v29, v30, |v27|
v_max_f32 v31, v28, |v27|
v_perm_b32 v37, v31, v32, s72
v_bfi_b32 v31, 3, v32, v31
v_lshlrev_b32 v31, 4, v31
v_bfi_b32 v44, 15, v44, v31
v_cmpx_eq_u32_sdwa vcc, v33, v32 src0_sel:WORD_1 src1_sel:WORD_1
v_mov_b64 v[80:81], v[78:79]
v_mov_b64 v[78:79], v[76:77]
v_mov_b32 v76, v33
v_min_f32 v77, v30, |v27|
s_mov_b64 exec, -1
v_perm_b32 v24, v12, v71, s68
v_perm_b32 v25, v13, v71, s69
v_perm_b32 v26, v14, v71, s70
v_perm_b32 v27, v15, v71, s71
v_max3_f32 v28, |v24|, |v25|, |v26|
v_med3_f32 v29, |v24|, |v25|, |v26|
v_min3_f32 v30, |v24|, |v25|, |v26|
v_med3_f32 v32, v28, v29, |v27|
v_med3_f32 v33, v29, v30, |v27|
v_max_f32 v31, v28, |v27|
v_perm_b32 v41, v31, v32, s72
v_bfi_b32 v31, 3, v32, v31
v_lshlrev_b32 v31, 4, v31
v_bfi_b32 v46, 15, v46, v31
v_cmpx_eq_u32_sdwa vcc, v33, v32 src0_sel:WORD_1 src1_sel:WORD_1
v_or_b32 v82, v82, v80
v_mov_b64 v[80:81], v[78:79]
v_mov_b64 v[78:79], v[76:77]
v_mov_b32 v76, v33
v_min_f32 v77, v30, |v27|
s_mov_b64 exec, -1
s_waitcnt vmcnt(4)
v_perm_b32 v24, v16, v72, s64
v_perm_b32 v25, v17, v72, s65
v_perm_b32 v26, v18, v72, s66
v_perm_b32 v27, v19, v72, s67
v_max3_f32 v28, |v24|, |v25|, |v26|
v_med3_f32 v29, |v24|, |v25|, |v26|
v_min3_f32 v30, |v24|, |v25|, |v26|
v_med3_f32 v32, v28, v29, |v27|
v_med3_f32 v33, v29, v30, |v27|
v_max_f32 v31, v28, |v27|
v_perm_b32 v38, v31, v32, s72
v_bfi_b32 v45, 3, v32, v31
v_cmpx_eq_u32_sdwa vcc, v33, v32 src0_sel:WORD_1 src1_sel:WORD_1
v_or_b32 v82, v82, v80
v_mov_b64 v[80:81], v[78:79]
v_mov_b64 v[78:79], v[76:77]
v_mov_b32 v76, v33
v_min_f32 v77, v30, |v27|
s_mov_b64 exec, -1
v_perm_b32 v24, v16, v73, s68
v_perm_b32 v25, v17, v73, s69
v_perm_b32 v26, v18, v73, s70
v_perm_b32 v27, v19, v73, s71
v_max3_f32 v28, |v24|, |v25|, |v26|
v_med3_f32 v29, |v24|, |v25|, |v26|
v_min3_f32 v30, |v24|, |v25|, |v26|
v_med3_f32 v32, v28, v29, |v27|
v_med3_f32 v33, v29, v30, |v27|
v_max_f32 v31, v28, |v27|
v_perm_b32 v42, v31, v32, s72
v_bfi_b32 v47, 3, v32, v31
v_cmpx_eq_u32_sdwa vcc, v33, v32 src0_sel:WORD_1 src1_sel:WORD_1
v_or_b32 v82, v82, v80
v_mov_b64 v[80:81], v[78:79]
v_mov_b64 v[78:79], v[76:77]
v_mov_b32 v76, v33
v_min_f32 v77, v30, |v27|
s_mov_b64 exec, -1
s_waitcnt vmcnt(0)
v_perm_b32 v24, v20, v74, s64
v_perm_b32 v25, v21, v74, s65
v_perm_b32 v26, v22, v74, s66
v_perm_b32 v27, v23, v74, s67
v_max3_f32 v28, |v24|, |v25|, |v26|
v_med3_f32 v29, |v24|, |v25|, |v26|
v_min3_f32 v30, |v24|, |v25|, |v26|
v_med3_f32 v32, v28, v29, |v27|
v_med3_f32 v33, v29, v30, |v27|
v_max_f32 v31, v28, |v27|
v_perm_b32 v39, v31, v32, s72
v_bfi_b32 v31, 3, v32, v31
v_lshlrev_b32 v31, 4, v31
v_bfi_b32 v45, 15, v45, v31
v_cmpx_eq_u32_sdwa vcc, v33, v32 src0_sel:WORD_1 src1_sel:WORD_1
v_or_b32 v82, v82, v80
v_mov_b64 v[80:81], v[78:79]
v_mov_b64 v[78:79], v[76:77]
v_mov_b32 v76, v33
v_min_f32 v77, v30, |v27|
s_mov_b64 exec, -1
v_perm_b32 v24, v20, v75, s68
v_perm_b32 v25, v21, v75, s69
v_perm_b32 v26, v22, v75, s70
v_perm_b32 v27, v23, v75, s71
v_max3_f32 v28, |v24|, |v25|, |v26|
v_med3_f32 v29, |v24|, |v25|, |v26|
v_min3_f32 v30, |v24|, |v25|, |v26|
v_med3_f32 v32, v28, v29, |v27|
v_med3_f32 v33, v29, v30, |v27|
v_max_f32 v31, v28, |v27|
v_perm_b32 v43, v31, v32, s72
v_bfi_b32 v31, 3, v32, v31
v_lshlrev_b32 v31, 4, v31
v_bfi_b32 v47, 15, v47, v31
v_cmpx_eq_u32_sdwa vcc, v33, v32 src0_sel:WORD_1 src1_sel:WORD_1
v_or_b32 v82, v82, v80
v_mov_b64 v[80:81], v[78:79]
v_mov_b64 v[78:79], v[76:77]
v_mov_b32 v76, v33
v_min_f32 v77, v30, |v27|
s_mov_b64 exec, -1
s_mov_b32 vcc_lo, 0x33333333
s_mov_b32 vcc_hi, 0x33333333
v_cndmask_b32_dpp v24, v40, v36, vcc quad_perm:[2,3,0,1] row_mask:0xf bank_mask:0xf
v_cndmask_b32_dpp v25, v41, v37, vcc quad_perm:[2,3,0,1] row_mask:0xf bank_mask:0xf
v_cndmask_b32_dpp v26, v42, v38, vcc quad_perm:[2,3,0,1] row_mask:0xf bank_mask:0xf
v_cndmask_b32_dpp v27, v43, v39, vcc quad_perm:[2,3,0,1] row_mask:0xf bank_mask:0xf
s_not_b64 vcc, vcc
buffer_store_dwordx4 v[24:27], v51, s[24:27], 0 offen sc1
v_cndmask_b32_dpp v40, v36, v40, vcc quad_perm:[2,3,0,1] row_mask:0xf bank_mask:0xf
v_cndmask_b32_dpp v41, v37, v41, vcc quad_perm:[2,3,0,1] row_mask:0xf bank_mask:0xf
v_cndmask_b32_dpp v42, v38, v42, vcc quad_perm:[2,3,0,1] row_mask:0xf bank_mask:0xf
v_cndmask_b32_dpp v43, v39, v43, vcc quad_perm:[2,3,0,1] row_mask:0xf bank_mask:0xf
s_mov_b32 s52, 0x0c0c0400
s_mov_b32 s53, 0x04000c0c
buffer_store_dwordx4 v[40:43], v66, s[24:27], 0 offen sc1
v_perm_b32 v48, v45, v44, s52
v_perm_b32 v49, v47, v46, s53
v_or_b32 v48, v48, v49
s_nop 1
v_mov_b32_dpp v49, v48 quad_perm:[2,3,0,1] row_mask:0xf bank_mask:0xf
v_perm_b32 v48, v49, v48, v55
buffer_store_dword v48, v52, s[24:27], 0 offen sc1
v_cmp_lt_u32 s[50:51], s74, v82
L_emit:
v_cmp_lt_u32 vcc, s74, v76
v_cmp_eq_u32_sdwa s[48:49], v77, v76 src0_sel:WORD_1 src1_sel:WORD_1
v_perm_b32 v63, v76, v53, s73
v_bfe_u32 v62, v76, 2, 4
v_and_b32 v64, 0x80, v76
v_lshl_add_u32 v63, v62, 1, v63
v_mbcnt_lo_u32_b32 v62, vcc_lo, 0
v_mbcnt_hi_u32_b32 v62, vcc_hi, v62
v_add_u32 v63, v64, v63
v_add_u32 v62, s75, v62
s_bcnt1_i32_b64 s52, vcc
s_add_u32 s75, s75, s52
v_cmp_gt_u32 s[52:53], 15, v62
v_and_b32 v64, 12, v62
v_mad_u32_u24 v62, v64, 3, v62
v_lshl_add_u32 v62, v62, 2, s58
s_and_b64 s[48:49], s[48:49], vcc
s_and_b64 exec, s[52:53], vcc
s_cbranch_execz L_emit1
buffer_store_dword v63, v62, s[24:27], 0 offen sc1
L_emit1:
s_mov_b64 exec, s[48:49]
v_mov_b32 v76, v77
v_mov_b32 v77, 0
s_not_b64 exec, exec
v_mov_b64 v[76:77], v[78:79]
v_mov_b64 v[78:79], v[80:81]
v_mov_b64 v[80:81], 0
s_mov_b64 exec, -1
v_or3_b32 v62, v76, v78, v80
v_cmp_lt_u32 vcc, s74, v62
s_cmp_lg_u64 s[50:51], 0
s_cselect_b32 s52, 99, s75
s_cmp_gt_u32 s52, 15
s_cselect_b32 s52, -1, 0
s_min_u32 s53, s75, 15
s_cbranch_vccnz L_emit
s_lshl_b32 s53, -1, s53
v_mov_b32 v62, s52
s_and_b32 exec_lo, s53, 131071
s_mov_b32 exec_hi, 0
buffer_store_dword v62, v65, s[24:27], 0 offen sc1
s_mov_b64 exec, -1
s_waitcnt vmcnt(0)
s_mov_b32 s85, 0x230003c
s_barrier
s_cmp_lg_u32 s40, 0
s_cbranch_scc1 L_cons2
v_mov_b32 v8, 1
s_mov_b64 exec, 1
buffer_atomic_add v8, off, s[36:39], 0 offset:128 sc0 sc1
v_mov_b32 v9, 1
s_waitcnt vmcnt(0)
v_readfirstlane_b32 s47, v8
s_nop 3
s_cmp_lg_u32 s47, 40
s_cbranch_scc1 L_notlast
buffer_store_dword v9, off, s[36:39], 0 sc1
L_notlast:
s_mov_b64 exec, -1
L_cons2:
v_lshrrev_b32 v72, 3, v7
v_and_b32 v73, 7, v7
v_xor_b32 v73, v73, v72
v_mul_u32_u24 v72, 1152, v72
s_and_b32 s47, s40, 1
s_mul_i32 s47, s47, 9216
s_lshr_b32 s3, s40, 1
s_lshl_b32 s3, s3, 7
s_add_u32 s47, s47, s3
v_lshl_add_u32 v72, v73, 4, v72
v_add_u32 v3, s47, v72
s_lshl_b32 s44, s40, 10
s_mul_i32 s45, s2, 18432
s_mov_b32 s46, s45
s_barrier
s_branch L_cons3
L_rest:
s_mov_b32 s92, 0x80
s_mov_b32 s47, 0x80
s_bitcmp1_b32 s2, 3
s_cselect_b32 s92, s92, 0x88
s_cselect_b32 s47, s47, 0x88
s_bitcmp1_b32 s2, 4
s_cselect_b32 s92, s47, s92
s_mov_b32 s3, 0x88
s_cmp_lt_u32 s84, 41
s_cselect_b32 s92, s3, s92
s_mov_b32 s87, 0x80
s_mov_b32 s3, 0x80
s_cmp_lt_u32 s84, 41
s_cselect_b32 s87, s3, s87
v_and_b32 v80, 3, v7
v_bfe_u32 v81, v7, 2, 2
v_bfe_u32 v82, v7, 4, 1
v_lshlrev_b32 v81, 3, v81
v_lshl_add_u32 v81, v80, 5, v81
v_lshl_add_u32 v81, v82, 7, v81
s_lshl_b32 s47, s40, 8
v_add_u32 v81, s47, v81
s_lshl_b32 s47, s40, 5
s_add_u32 s47, s47, 1024
v_lshl_add_u32 v80, v80, 3, s47
v_cmp_gt_u32 vcc, 32, v7
s_nop 1
v_cndmask_b32 v80, v80, v81, vcc
buffer_load_dwordx2 v[110:111], v80, s[32:35], 0 offen
v_and_b32 v72, 15, v7
v_lshrrev_b32 v73, 4, v7
v_and_b32 v74, 7, v7
v_xor_b32 v74, v74, v73
v_lshlrev_b32 v74, 4, v74
v_lshl_add_u32 v0, v72, 7, v74
v_xor_b32 v1, 64, v0
s_mul_i32 s93, s40, 3584
s_add_u32 s93, s93, 148480
v_lshl_add_u32 v2, v73, 4, s93
v_and_b32 v74, 14, v7
v_mul_u32_u24 v4, 1152, v74
v_and_b32 v74, 1, v7
v_lshl_add_u32 v4, v74, 4, v4
v_lshl_add_u32 v4, v73, 5, v4
s_lshl_b32 s47, s40, 8
v_add_u32 v4, s47, v4
s_lshl_b32 s47, s40, 5
s_add_u32 s47, s47, 1024
v_lshrrev_b32 v72, 2, v7
v_and_b32 v73, 3, v7
v_lshl_add_u32 v6, v73, 4, v72
v_lshlrev_b32 v6, 2, v6
v_mul_u32_u24 v5, 1152, v72
v_lshl_add_u32 v5, v73, 3, v5
v_add_u32 v5, s47, v5
s_mov_b32 s80, 0x55555555
s_mov_b32 s81, 0x55555555
s_mov_b32 s82, 0xaaaaaaaa
s_mov_b32 s83, 0xaaaaaaaa
v_lshl_add_u32 v109, v7, 4, s93
v_lshl_add_u32 v89, v7, 2, s93
v_mov_b32 v76, 0
v_mov_b32 v77, 0
v_mov_b32 v78, 0
v_mov_b32 v79, 0
v_mov_b32 v90, 0xdddddddd
ds_write_b128 v109, v[76:79]
ds_write_b32 v89, v90 offset:1792
ds_write_b32 v89, v90 offset:2048
ds_write_b32 v89, v90 offset:2304
ds_write_b32 v89, v90 offset:2560
ds_write_b32 v89, v90 offset:2816
ds_write_b32 v89, v90 offset:3072
ds_write_b32 v89, v90 offset:3328
s_lshl_b32 s47, s40, 2
s_add_u32 s47, s47, 163072
v_mov_b32 v88, s47
ds_write_b32 v88, v76
s_mul_i32 s47, s40, 2304
s_add_u32 s47, s47, 373760
v_and_b32 v73, 60, v7
v_mad_u32_u24 v73, v73, 3, v7
v_lshl_add_u32 v72, v73, 4, s47
s_mov_b32 s47, 380672
v_lshl_add_u32 v73, v73, 4, s47
v_lshrrev_b32 v74, 2, v7
v_cmp_gt_u32 vcc, 36, v7
v_lshlrev_b32 v90, 11, v74
v_subrev_u32 v74, 9, v74
v_lshlrev_b32 v74, 12, v74
v_cndmask_b32 v72, v73, v72, vcc
v_cndmask_b32 v90, v74, v90, vcc
s_lshl_b32 s47, s40, 12
s_add_u32 s47, s47, 0x8001
v_mov_b32 v88, 1
v_mov_b32 v94, 0xf001
v_mov_b32 v95, s47
v_cndmask_b32 v94, v94, v88, vcc
v_cndmask_b32 v95, v95, v88, vcc
v_cndmask_b32 v96, 0, 28, vcc
v_cndmask_b32 v97, 32, 0, vcc
v_add_u32 v97, s93, v97
v_cmp_gt_u32 vcc, 56, v7
v_mov_b32 v73, 0x40000000
s_lshr_b32 s47, s2, 3
s_lshl_b32 s47, s47, 2
s_add_u32 s47, s47, s40
s_mul_i32 s47, s47, 3072
v_cndmask_b32 v72, v73, v72, vcc
v_lshl_add_u32 v93, v7, 4, s47
s_mul_i32 s47, s40, 82944
s_add_u32 s47, s47, s86
v_lshl_add_u32 v112, v7, 4, s47
s_mul_i32 s47, s40, 9216
s_add_u32 s47, s47, s86
s_add_u32 s47, s47, 331776
v_lshl_add_u32 v113, v7, 4, s47
s_lshl_b32 s47, s40, 6
s_add_u32 s47, s47, s86
s_add_u32 s47, s47, 368640
v_and_b32 v106, 15, v7
v_lshl_add_u32 v106, v106, 2, s47
v_lshrrev_b32 v107, 4, v7
v_lshl_add_u32 v106, v107, 8, v106
v_and_b32 v74, 15, v7
v_and_b32 v73, 7, v7
v_lshlrev_b32 v100, 1, v73
v_lshlrev_b32 v100, v100, v88
v_lshlrev_b32 v73, 4, v73
v_lshl_add_u32 v92, v74, 7, v73
v_lshl_or_b32 v92, v92, 16, v92
v_lshrrev_b32 v98, 5, v7
v_bfe_u32 v99, v7, 3, 2
v_lshl_add_u32 v99, v99, 6, s93
v_lshl_add_u32 v101, v7, 1, s93
v_lshrrev_b32 v102, 4, v7
v_lshl_add_u32 v102, v102, 3, s93
v_lshrrev_b32 v103, 1, v7
v_lshlrev_b32 v103, 5, v103
s_mov_b32 s89, 0
s_cmp_lg_u32 s40, 0
s_cbranch_scc1 L_ready
s_mov_b64 exec, 1
s_mov_b32 s3, 20000
L_poll:
buffer_load_dword v8, off, s[36:39], 0 sc1
s_sub_u32 s3, s3, 1
s_cbranch_scc1 L_giveup
s_waitcnt vmcnt(0)
v_readfirstlane_b32 s47, v8
s_nop 3
s_cmp_eq_u32 s47, 0
s_cbranch_scc1 L_poll
L_polled:
s_mov_b64 exec, -1
L_ready:
s_waitcnt lgkmcnt(0)
s_barrier
buffer_load_dwordx4 v[8:11], v72, s[24:27], 0 offen offset:0 sc1
buffer_load_dwordx4 v[12:15], v72, s[24:27], 0 offen offset:64 sc1
buffer_load_dwordx4 v[16:19], v72, s[24:27], 0 offen offset:128 sc1
buffer_load_dwordx4 v[20:23], v72, s[24:27], 0 offen offset:192 sc1
buffer_load_dwordx4 v[76:79], v93, s[24:27], 0 offen offset:0 sc1
buffer_load_dwordx4 v[80:83], v93, s[24:27], 0 offen offset:1024 sc1
buffer_load_dwordx4 v[84:87], v93, s[24:27], 0 offen offset:2048 sc1
buffer_load_dword v174, v106, s[24:27], 0 offen offset:0 sc1
buffer_load_dword v175, v106, s[24:27], 0 offen offset:1024 sc1
buffer_load_dword v176, v106, s[24:27], 0 offen offset:2048 sc1
buffer_load_dword v177, v106, s[24:27], 0 offen offset:3072 sc1
s_mov_b32 s99, 4096
buffer_load_dword v178, v106, s[24:27], s99 offen offset:0 sc1
s_mov_b32 s98, 0
buffer_load_dwordx4 v[138:141], v113, s[24:27], s98 offen sc1
s_mov_b32 s99, 0
buffer_load_dwordx4 a[0:3], v112, s[24:27], s99 offen offset:0 sc1
buffer_load_dwordx4 a[4:7], v112, s[24:27], s99 offen offset:1024 sc1
buffer_load_dwordx4 a[8:11], v112, s[24:27], s99 offen offset:2048 sc1
s_waitcnt vmcnt(12)
v_cmp_ne_u32 s[90:91], 0, v23
v_cmp_ne_u32 s[78:79], 0, v16
v_and_b32 v73, v94, v8
v_lshrrev_b32 v72, 10, v8
v_cmp_eq_u32 s[48:49], v73, v95
v_and_or_b32 v24, v72, v96, v97
s_mov_b64 exec, s[48:49]
ds_add_rtn_u32 v40, v24, v88
s_mov_b64 exec, -1
v_and_b32 v73, v94, v9
v_lshrrev_b32 v72, 10, v9
v_cmp_eq_u32 s[50:51], v73, v95
v_and_or_b32 v25, v72, v96, v97
s_mov_b64 exec, s[50:51]
ds_add_rtn_u32 v41, v25, v88
s_mov_b64 exec, -1
buffer_load_dwordx4 a[12:15], v112, s[24:27], s99 offen offset:3072 sc1
v_and_b32 v73, v94, v10
v_lshrrev_b32 v72, 10, v10
v_cmp_eq_u32 s[52:53], v73, v95
v_and_or_b32 v26, v72, v96, v97
s_mov_b64 exec, s[52:53]
ds_add_rtn_u32 v42, v26, v88
s_mov_b64 exec, -1
v_and_b32 v73, v94, v11
v_lshrrev_b32 v72, 10, v11
v_cmp_eq_u32 s[54:55], v73, v95
v_and_or_b32 v27, v72, v96, v97
s_mov_b64 exec, s[54:55]
ds_add_rtn_u32 v43, v27, v88
s_mov_b64 exec, -1
s_mov_b32 s99, 4096
buffer_load_dwordx4 a[16:19], v112, s[24:27], s99 offen offset:0 sc1
v_and_b32 v73, v94, v12
v_lshrrev_b32 v72, 10, v12
v_cmp_eq_u32 s[56:57], v73, v95
v_and_or_b32 v28, v72, v96, v97
s_mov_b64 exec, s[56:57]
ds_add_rtn_u32 v44, v28, v88
s_mov_b64 exec, -1
v_and_b32 v73, v94, v13
v_lshrrev_b32 v72, 10, v13
v_cmp_eq_u32 s[58:59], v73, v95
v_and_or_b32 v29, v72, v96, v97
s_mov_b64 exec, s[58:59]
ds_add_rtn_u32 v45, v29, v88
s_mov_b64 exec, -1
buffer_load_dwordx4 a[20:23], v112, s[24:27], s99 offen offset:1024 sc1
v_and_b32 v73, v94, v14
v_lshrrev_b32 v72, 10, v14
v_cmp_eq_u32 s[60:61], v73, v95
v_and_or_b32 v30, v72, v96, v97
s_mov_b64 exec, s[60:61]
ds_add_rtn_u32 v46, v30, v88
s_mov_b64 exec, -1
v_and_b32 v73, v94, v15
v_lshrrev_b32 v72, 10, v15
v_cmp_eq_u32 s[62:63], v73, v95
v_and_or_b32 v31, v72, v96, v97
s_mov_b64 exec, s[62:63]
ds_add_rtn_u32 v47, v31, v88
s_mov_b64 exec, -1
buffer_load_dwordx4 a[24:27], v112, s[24:27], s99 offen offset:2048 sc1
s_cmp_lg_u64 s[78:79], 0
s_cbranch_scc1 L_more1
L_more1b:
ds_read_b32 v72, v89
v_mov_b32 v73, 0
buffer_load_dwordx4 a[28:31], v112, s[24:27], s99 offen offset:3072 sc1
s_mov_b32 s99, 8192
buffer_load_dwordx4 a[32:35], v112, s[24:27], s99 offen offset:0 sc1
s_waitcnt lgkmcnt(0)
s_mov_b64 vcc, s[80:81]
v_cndmask_b32_dpp v73, v72, v73, vcc quad_perm:[0,0,2,2] row_mask:0xf bank_mask:0xf
v_add_u32 v91, v103, v73
v_add_u32 v73, v72, v73
v_cmp_lt_u32 vcc, 32, v73
s_or_b32 s90, s90, s91
s_and_b32 s47, vcc_lo, 0x1ff
s_or_b32 s47, s47, s90
s_cbranch_scc1 L_greedy
L_greedyb:
s_mov_b32 s98, 1024
buffer_load_dwordx4 v[142:145], v113, s[24:27], s98 offen sc1
ds_bpermute_b32 v56, v24, v91
ds_bpermute_b32 v57, v25, v91
ds_bpermute_b32 v58, v26, v91
ds_bpermute_b32 v59, v27, v91
ds_bpermute_b32 v60, v28, v91
ds_bpermute_b32 v61, v29, v91
ds_bpermute_b32 v62, v30, v91
ds_bpermute_b32 v63, v31, v91
buffer_load_dwordx4 a[36:39], v112, s[24:27], s99 offen offset:1024 sc1
buffer_load_dwordx4 a[40:43], v112, s[24:27], s99 offen offset:2048 sc1
s_waitcnt lgkmcnt(7)
v_add_u32 v73, v40, v56
v_and_b32 v72, 0x87e, v8
v_lshl_add_u32 v73, v73, 1, s93
v_add_u32 v72, v90, v72
s_andn2_b64 exec, s[48:49], s[90:91]
ds_write_b16_d16_hi v73, v8 offset:64
ds_write_b16 v73, v72 offset:384
ds_write_b16 v73, v8 offset:704
s_mov_b64 exec, -1
buffer_load_dwordx4 a[44:47], v112, s[24:27], s99 offen offset:3072 sc1
s_waitcnt lgkmcnt(9)
v_add_u32 v73, v41, v57
v_and_b32 v72, 0x87e, v9
v_lshl_add_u32 v73, v73, 1, s93
v_add_u32 v72, v90, v72
s_andn2_b64 exec, s[50:51], s[90:91]
ds_write_b16_d16_hi v73, v9 offset:64
ds_write_b16 v73, v72 offset:384
ds_write_b16 v73, v9 offset:704
s_mov_b64 exec, -1
s_mov_b32 s99, 12288
buffer_load_dwordx4 a[48:51], v112, s[24:27], s99 offen offset:0 sc1
s_waitcnt lgkmcnt(11)
v_add_u32 v73, v42, v58
v_and_b32 v72, 0x87e, v10
v_lshl_add_u32 v73, v73, 1, s93
v_add_u32 v72, v90, v72
s_andn2_b64 exec, s[52:53], s[90:91]
ds_write_b16_d16_hi v73, v10 offset:64
ds_write_b16 v73, v72 offset:384
ds_write_b16 v73, v10 offset:704
s_mov_b64 exec, -1
buffer_load_dwordx4 a[52:55], v112, s[24:27], s99 offen offset:1024 sc1
s_waitcnt lgkmcnt(13)
v_add_u32 v73, v43, v59
v_and_b32 v72, 0x87e, v11
v_lshl_add_u32 v73, v73, 1, s93
v_add_u32 v72, v90, v72
s_andn2_b64 exec, s[54:55], s[90:91]
ds_write_b16_d16_hi v73, v11 offset:64
ds_write_b16 v73, v72 offset:384
ds_write_b16 v73, v11 offset:704
s_mov_b64 exec, -1
s_waitcnt lgkmcnt(15)
v_add_u32 v73, v44, v60
v_and_b32 v72, 0x87e, v12
v_lshl_add_u32 v73, v73, 1, s93
v_add_u32 v72, v90, v72
s_andn2_b64 exec, s[56:57], s[90:91]
ds_write_b16_d16_hi v73, v12 offset:64
ds_write_b16 v73, v72 offset:384
ds_write_b16 v73, v12 offset:704
s_mov_b64 exec, -1
buffer_load_dwordx4 a[56:59], v112, s[24:27], s99 offen offset:2048 sc1
s_waitcnt lgkmcnt(15)
v_add_u32 v73, v45, v61
v_and_b32 v72, 0x87e, v13
v_lshl_add_u32 v73, v73, 1, s93
v_add_u32 v72, v90, v72
s_andn2_b64 exec, s[58:59], s[90:91]
ds_write_b16_d16_hi v73, v13 offset:64
ds_write_b16 v73, v72 offset:384
ds_write_b16 v73, v13 offset:704
s_mov_b64 exec, -1
buffer_load_dwordx4 a[60:63], v112, s[24:27], s99 offen offset:3072 sc1
s_waitcnt lgkmcnt(15)
v_add_u32 v73, v46, v62
v_and_b32 v72, 0x87e, v14
v_lshl_add_u32 v73, v73, 1, s93
v_add_u32 v72, v90, v72
s_andn2_b64 exec, s[60:61], s[90:91]
ds_write_b16_d16_hi v73, v14 offset:64
ds_write_b16 v73, v72 offset:384
ds_write_b16 v73, v14 offset:704
s_mov_b64 exec, -1
s_waitcnt lgkmcnt(15)
v_add_u32 v73, v47, v63
v_and_b32 v72, 0x87e, v15
v_lshl_add_u32 v73, v73, 1, s93
v_add_u32 v72, v90, v72
s_andn2_b64 exec, s[62:63], s[90:91]
ds_write_b16_d16_hi v73, v15 offset:64
ds_write_b16 v73, v72 offset:384
ds_write_b16 v73, v15 offset:704
s_mov_b64 exec, -1
s_mov_b32 s99, 16384
buffer_load_dwordx4 a[64:67], v112, s[24:27], s99 offen offset:0 sc1
s_cmp_lg_u64 s[78:79], 0
s_cbranch_scc1 L_more2
L_more2b:
ds_read_u16 v8, v101 offset:704
ds_read_u16 v9, v101 offset:832
ds_read_u16 v10, v101 offset:960
ds_read2_b64 v[118:121], v102 offset0:48 offset1:52
ds_read2_b64 v[122:125], v102 offset0:56 offset1:60
ds_read2_b64 v[126:129], v102 offset0:64 offset1:68
ds_read2_b64 v[130:133], v102 offset0:72 offset1:76
ds_read2_b64 v[134:137], v102 offset0:80 offset1:84
buffer_load_dwordx4 a[68:71], v112, s[24:27], s99 offen offset:1024 sc1
s_mov_b32 s98, 2048
buffer_load_dwordx4 v[146:149], v113, s[24:27], s98 offen sc1
buffer_load_dwordx4 a[72:75], v112, s[24:27], s99 offen offset:2048 sc1
s_waitcnt lgkmcnt(5)
v_lshrrev_b32 v72, 12, v8
v_cmp_ne_u32 vcc, 0, v8
v_min_u32 v72, 8, v72
v_add3_u32 v72, v72, v98, 0
v_lshlrev_b32 v73, 4, v72
v_lshrrev_b32 v72, 1, v72
v_lshlrev_b32 v73, v73, v100
v_lshl_add_u32 v72, v72, 8, v99
v_bfe_u32 v74, v8, 7, 4
v_lshl_add_u32 v72, v74, 2, v72
s_mov_b64 exec, vcc
ds_xor_b32 v72, v73 offset:1792
s_mov_b64 exec, -1
buffer_load_dwordx4 a[76:79], v112, s[24:27], s99 offen offset:3072 sc1
v_lshrrev_b32 v72, 12, v9
v_cmp_ne_u32 vcc, 0, v9
v_min_u32 v72, 8, v72
v_add3_u32 v72, v72, v98, 2
v_lshlrev_b32 v73, 4, v72
v_lshrrev_b32 v72, 1, v72
v_lshlrev_b32 v73, v73, v100
v_lshl_add_u32 v72, v72, 8, v99
v_bfe_u32 v74, v9, 7, 4
v_lshl_add_u32 v72, v74, 2, v72
s_mov_b64 exec, vcc
ds_xor_b32 v72, v73 offset:1792
s_mov_b64 exec, -1
s_mov_b32 s99, 20480
buffer_load_dwordx4 a[80:83], v112, s[24:27], s99 offen offset:0 sc1
v_lshrrev_b32 v72, 12, v10
v_cmp_ne_u32 vcc, 0, v10
v_min_u32 v72, 8, v72
v_add3_u32 v72, v72, v98, 4
v_lshlrev_b32 v73, 4, v72
v_lshrrev_b32 v72, 1, v72
v_lshlrev_b32 v73, v73, v100
v_lshl_add_u32 v72, v72, 8, v99
v_bfe_u32 v74, v10, 7, 4
v_lshl_add_u32 v72, v74, 2, v72
s_mov_b64 exec, vcc
s_mov_b32 exec_hi, 0
ds_xor_b32 v72, v73 offset:1792
s_mov_b64 exec, -1
buffer_load_dwordx4 a[84:87], v112, s[24:27], s99 offen offset:1024 sc1
ds_read_b32 v179, v89 offset:1792
ds_read_b32 v180, v89 offset:2048
ds_read_b32 v181, v89 offset:2304
ds_read_b32 v182, v89 offset:2560
ds_read_b32 v183, v89 offset:2816
ds_read_b32 v184, v89 offset:3072
ds_read_b32 v185, v89 offset:3328
s_waitcnt lgkmcnt(10)
v_xor_b32 v118, v92, v118
v_xor_b32 v119, v92, v119
v_xor_b32 v120, v92, v120
v_xor_b32 v121, v92, v121
buffer_load_dwordx4 a[88:91], v112, s[24:27], s99 offen offset:2048 sc1
v_xor_b32 v122, v92, v122
v_xor_b32 v123, v92, v123
v_xor_b32 v124, v92, v124
v_xor_b32 v125, v92, v125
v_xor_b32 v126, v92, v126
v_xor_b32 v127, v92, v127
v_xor_b32 v128, v92, v128
v_xor_b32 v129, v92, v129
v_xor_b32 v130, v92, v130
v_xor_b32 v131, v92, v131
v_xor_b32 v132, v92, v132
v_xor_b32 v133, v92, v133
buffer_load_dwordx4 a[92:95], v112, s[24:27], s99 offen offset:3072 sc1
v_xor_b32 v134, v92, v134
v_xor_b32 v135, v92, v135
v_xor_b32 v136, v92, v136
v_xor_b32 v137, v92, v137
v_lshlrev_b32 v114, 16, v110
v_and_b32 v115, 0xffff0000, v110
v_lshlrev_b32 v116, 16, v111
v_and_b32 v117, 0xffff0000, v111
s_mov_b32 exec_hi, 15
ds_write_b128 v109, v[114:117] offset:1024
s_mov_b64 exec, -1
s_mov_b32 s41, 2
s_mov_b32 s42, 0
s_mov_b32 s4, 37120
s_mov_b32 s22, 75497472
s_mov_b32 s5, 18560
s_mov_b32 s6, 4718592
s_mov_b64 vcc, s[80:81]
s_andn2_b32 s12, 63, s85
s_mov_b32 s59, 6
s_add_u32 s48, s46, 9437184
s_add_u32 s49, s48, 4718592
s_add_u32 s50, s49, 4718592
s_sub_u32 s58, s7, s45
s_lshr_b32 s47, s2, 5
s_mul_i32 s57, s47, 589824
s_add_u32 s57, s57, 47185920
s_lshl_b32 s47, s47, 7
s_add_u32 s47, s47, 268435456
s_add_u32 s32, s24, s47
s_addc_u32 s33, s25, 0
s_cmp_eq_u32 s40, 0
s_cselect_b32 s34, 4, 0
s_cselect_b64 s[62:63], 1, 0
s_waitcnt lgkmcnt(0)
v_mov_b32 v114, 163072
s_barrier
ds_read_b32 v114, v114
ds_read_b128 v[44:47], v0 offset:0
ds_read_b128 v[48:51], v1 offset:0
s_waitcnt vmcnt(18)
ds_read_b128 v[76:79], v2 offset:1024
ds_read_b128 v[80:83], v2 offset:1088
ds_read_b128 v[84:87], v2 offset:1152
ds_read_b128 v[88:91], v2 offset:1216
ds_read_b128 v[92:95], v2 offset:1280
ds_read_b128 v[96:99], v2 offset:1344
ds_read_b128 v[100:103], v2 offset:1408
ds_read_b128 v[104:107], v2 offset:1472
ds_read_b128 v[108:111], v2 offset:1536
s_mov_b32 s99, 24576
buffer_load_dwordx4 a[96:99], v112, s[24:27], s99 offen offset:0 sc1
ds_read_b128 v[8:11], v2 offset:1024
ds_read_b128 v[12:15], v2 offset:1088
ds_read_b128 v[16:19], v2 offset:1152
ds_read_b128 v[20:23], v2 offset:1216
ds_read_b128 v[24:27], v2 offset:1280
ds_read_b128 v[28:31], v2 offset:1344
ds_read_b128 v[32:35], v2 offset:1408
ds_read_b128 v[36:39], v2 offset:1472
ds_read_b128 v[40:43], v2 offset:1536
buffer_load_dwordx4 a[100:103], v112, s[24:27], s99 offen offset:1024 sc1
s_waitcnt lgkmcnt(15)
v_readfirstlane_b32 s47, v114
v_add_u32_sdwa v60, s42, v118 dst_sel:DWORD dst_unused:UNUSED_PAD src0_sel:DWORD src1_sel:WORD_0
s_nop 2
s_cmp_lg_u32 s47, 0
s_cbranch_scc1 L_slow
v_smfmac_f32_16x16x64_bf16 v[76:79], a[0:3], v[44:51], v138
ds_read_b128 v[52:55], v0 offset:18560
ds_read_b128 v[56:59], v1 offset:18560
ds_read_u16 v68, v60 offset:18560
ds_read_u16 v60, v60
v_add_u32_sdwa v61, s42, v118 dst_sel:DWORD dst_unused:UNUSED_PAD src0_sel:DWORD src1_sel:WORD_1
v_smfmac_f32_16x16x64_bf16 v[80:83], a[4:7], v[44:51], v138 abid:1
ds_read_u16 v69, v61 offset:18560
ds_read_u16 v61, v61
v_add_u32_sdwa v62, s42, v119 dst_sel:DWORD dst_unused:UNUSED_PAD src0_sel:DWORD src1_sel:WORD_0
v_smfmac_f32_16x16x64_bf16 v[84:87], a[8:11], v[44:51], v139
buffer_load_dwordx4 a[104:107], v112, s[24:27], s99 offen offset:2048 sc1
ds_read_u16 v70, v62 offset:18560
ds_read_u16 v62, v62
v_add_u32_sdwa v63, s42, v119 dst_sel:DWORD dst_unused:UNUSED_PAD src0_sel:DWORD src1_sel:WORD_1
s_waitcnt lgkmcnt(15)
v_smfmac_f32_16x16x64_bf16 v[88:91], a[12:15], v[44:51], v139 abid:1
ds_read_u16 v71, v63 offset:18560
ds_read_u16 v63, v63
v_add_u32_sdwa v64, s42, v120 dst_sel:DWORD dst_unused:UNUSED_PAD src0_sel:DWORD src1_sel:WORD_0
v_smfmac_f32_16x16x64_bf16 v[92:95], a[16:19], v[44:51], v140
s_mov_b32 s98, 3072
buffer_load_dwordx4 v[150:153], v113, s[24:27], s98 offen sc1
ds_read_u16 v72, v64 offset:18560
ds_read_u16 v64, v64
v_add_u32_sdwa v65, s42, v120 dst_sel:DWORD dst_unused:UNUSED_PAD src0_sel:DWORD src1_sel:WORD_1
v_smfmac_f32_16x16x64_bf16 v[96:99], a[20:23], v[44:51], v140 abid:1
ds_read_u16 v73, v65 offset:18560
ds_read_u16 v65, v65
v_add_u32_sdwa v66, s42, v121 dst_sel:DWORD dst_unused:UNUSED_PAD src0_sel:DWORD src1_sel:WORD_0
v_smfmac_f32_16x16x64_bf16 v[100:103], a[24:27], v[44:51], v141
buffer_load_dwordx4 a[108:111], v112, s[24:27], s99 offen offset:3072 sc1
ds_read_u16 v74, v66 offset:18560
ds_read_u16 v66, v66
v_add_u32_sdwa v67, s42, v121 dst_sel:DWORD dst_unused:UNUSED_PAD src0_sel:DWORD src1_sel:WORD_1
v_smfmac_f32_16x16x64_bf16 v[104:107], a[28:31], v[44:51], v141 abid:1
ds_read_u16 v75, v67 offset:18560
ds_read_u16 v67, v67
s_waitcnt vmcnt(18)
v_smfmac_f32_16x16x64_bf16 v[108:111], a[32:35], v[44:51], v174
ds_read_b128 v[114:117], v2 offset:64
s_waitcnt lgkmcnt(15)
v_smfmac_f32_16x16x64_bf16 v[8:11], a[0:3], v[52:59], v138
s_mov_b32 s99, 28672
buffer_load_dwordx4 a[112:115], v112, s[24:27], s99 offen offset:0 sc1
ds_read_b128 v[44:47], v0 offset:2048
v_smfmac_f32_16x16x64_bf16 v[12:15], a[4:7], v[52:59], v138 abid:1
ds_read_b128 v[48:51], v1 offset:2048
v_smfmac_f32_16x16x64_bf16 v[16:19], a[8:11], v[52:59], v139
buffer_load_dwordx4 a[116:119], v112, s[24:27], s99 offen offset:1024 sc1
v_smfmac_f32_16x16x64_bf16 v[20:23], a[12:15], v[52:59], v139 abid:1
v_smfmac_f32_16x16x64_bf16 v[24:27], a[16:19], v[52:59], v140
buffer_load_dwordx4 a[120:123], v112, s[24:27], s99 offen offset:2048 sc1
v_smfmac_f32_16x16x64_bf16 v[28:31], a[20:23], v[52:59], v140 abid:1
v_smfmac_f32_16x16x64_bf16 v[32:35], a[24:27], v[52:59], v141
v_smfmac_f32_16x16x64_bf16 v[36:39], a[28:31], v[52:59], v141 abid:1
buffer_load_dwordx4 a[124:127], v112, s[24:27], s99 offen offset:3072 sc1
v_smfmac_f32_16x16x64_bf16 v[40:43], a[32:35], v[52:59], v174
s_waitcnt lgkmcnt(2)
v_smfmac_f32_16x16x64_bf16 v[8:11], v[114:117], v[68:75], v179
s_mov_b32 s99, 32768
buffer_load_dwordx4 a[128:131], v112, s[24:27], s99 offen offset:0 sc1
v_smfmac_f32_16x16x64_bf16 v[12:15], v[114:117], v[68:75], v179 abid:1
v_smfmac_f32_16x16x64_bf16 v[76:79], v[114:117], v[60:67], v179
buffer_load_dwordx4 a[132:135], v112, s[24:27], s99 offen offset:1024 sc1
v_smfmac_f32_16x16x64_bf16 v[80:83], v[114:117], v[60:67], v179 abid:1
v_add_u32_sdwa v60, s42, v122 dst_sel:DWORD dst_unused:UNUSED_PAD src0_sel:DWORD src1_sel:WORD_0
s_waitcnt lgkmcnt(0)
v_smfmac_f32_16x16x64_bf16 v[76:79], a[36:39], v[44:51], v142
ds_read_b128 v[52:55], v0 offset:20608
ds_read_b128 v[56:59], v1 offset:20608
ds_read_u16 v68, v60 offset:18560
ds_read_u16 v60, v60
v_add_u32_sdwa v61, s42, v122 dst_sel:DWORD dst_unused:UNUSED_PAD src0_sel:DWORD src1_sel:WORD_1
v_smfmac_f32_16x16x64_bf16 v[80:83], a[40:43], v[44:51], v142 abid:1
buffer_load_dwordx4 a[136:139], v112, s[24:27], s99 offen offset:2048 sc1
ds_read_u16 v69, v61 offset:18560
ds_read_u16 v61, v61
v_add_u32_sdwa v62, s42, v123 dst_sel:DWORD dst_unused:UNUSED_PAD src0_sel:DWORD src1_sel:WORD_0
v_smfmac_f32_16x16x64_bf16 v[84:87], a[44:47], v[44:51], v143
ds_read_u16 v70, v62 offset:18560
ds_read_u16 v62, v62
v_add_u32_sdwa v63, s42, v123 dst_sel:DWORD dst_unused:UNUSED_PAD src0_sel:DWORD src1_sel:WORD_1
s_waitcnt vmcnt(18)
v_smfmac_f32_16x16x64_bf16 v[88:91], a[48:51], v[44:51], v143 abid:1
buffer_load_dwordx4 a[140:143], v112, s[24:27], s99 offen offset:3072 sc1
ds_read_u16 v71, v63 offset:18560
ds_read_u16 v63, v63
v_add_u32_sdwa v64, s42, v124 dst_sel:DWORD dst_unused:UNUSED_PAD src0_sel:DWORD src1_sel:WORD_0
v_smfmac_f32_16x16x64_bf16 v[92:95], a[52:55], v[44:51], v144
ds_read_u16 v72, v64 offset:18560
ds_read_u16 v64, v64
v_add_u32_sdwa v65, s42, v124 dst_sel:DWORD dst_unused:UNUSED_PAD src0_sel:DWORD src1_sel:WORD_1
v_smfmac_f32_16x16x64_bf16 v[96:99], a[56:59], v[44:51], v144 abid:1
s_mov_b32 s98, 4096
buffer_load_dwordx4 v[154:157], v113, s[24:27], s98 offen sc1
ds_read_u16 v73, v65 offset:18560
ds_read_u16 v65, v65
v_add_u32_sdwa v66, s42, v125 dst_sel:DWORD dst_unused:UNUSED_PAD src0_sel:DWORD src1_sel:WORD_0
v_smfmac_f32_16x16x64_bf16 v[100:103], a[60:63], v[44:51], v145
ds_read_u16 v74, v66 offset:18560
ds_read_u16 v66, v66
v_add_u32_sdwa v67, s42, v125 dst_sel:DWORD dst_unused:UNUSED_PAD src0_sel:DWORD src1_sel:WORD_1
v_smfmac_f32_16x16x64_bf16 v[104:107], a[64:67], v[44:51], v145 abid:1
ds_read_u16 v75, v67 offset:18560
ds_read_u16 v67, v67
v_smfmac_f32_16x16x64_bf16 v[108:111], a[68:71], v[44:51], v174 abid:1
s_mov_b32 s99, 36864
buffer_load_dwordx4 a[144:147], v112, s[24:27], s99 offen offset:0 sc1
ds_read_b128 v[114:117], v2 offset:128
s_waitcnt lgkmcnt(15)
v_smfmac_f32_16x16x64_bf16 v[8:11], a[36:39], v[52:59], v142
ds_read_b128 v[44:47], v0 offset:4096
v_smfmac_f32_16x16x64_bf16 v[12:15], a[40:43], v[52:59], v142 abid:1
buffer_load_dwordx4 a[148:151], v112, s[24:27], s99 offen offset:1024 sc1
ds_read_b128 v[48:51], v1 offset:4096
v_smfmac_f32_16x16x64_bf16 v[16:19], a[44:47], v[52:59], v143
v_smfmac_f32_16x16x64_bf16 v[20:23], a[48:51], v[52:59], v143 abid:1
buffer_load_dwordx4 a[152:155], v112, s[24:27], s99 offen offset:2048 sc1
v_smfmac_f32_16x16x64_bf16 v[24:27], a[52:55], v[52:59], v144
v_smfmac_f32_16x16x64_bf16 v[28:31], a[56:59], v[52:59], v144 abid:1
v_smfmac_f32_16x16x64_bf16 v[32:35], a[60:63], v[52:59], v145
buffer_load_dwordx4 a[156:159], v112, s[24:27], s99 offen offset:3072 sc1
v_smfmac_f32_16x16x64_bf16 v[36:39], a[64:67], v[52:59], v145 abid:1
v_smfmac_f32_16x16x64_bf16 v[40:43], a[68:71], v[52:59], v174 abid:1
s_mov_b32 s99, 40960
buffer_load_dwordx4 a[160:163], v112, s[24:27], s99 offen offset:0 sc1
s_waitcnt lgkmcnt(2)
v_smfmac_f32_16x16x64_bf16 v[12:15], v[114:117], v[68:75], v180
v_smfmac_f32_16x16x64_bf16 v[16:19], v[114:117], v[68:75], v180 abid:1
buffer_load_dwordx4 a[164:167], v112, s[24:27], s99 offen offset:1024 sc1
v_smfmac_f32_16x16x64_bf16 v[20:23], v[114:117], v[68:75], v181
v_smfmac_f32_16x16x64_bf16 v[80:83], v[114:117], v[60:67], v180
v_smfmac_f32_16x16x64_bf16 v[84:87], v[114:117], v[60:67], v180 abid:1
buffer_load_dwordx4 a[168:171], v112, s[24:27], s99 offen offset:2048 sc1
v_smfmac_f32_16x16x64_bf16 v[88:91], v[114:117], v[60:67], v181
v_add_u32_sdwa v60, s42, v126 dst_sel:DWORD dst_unused:UNUSED_PAD src0_sel:DWORD src1_sel:WORD_0
s_waitcnt lgkmcnt(0)
s_waitcnt vmcnt(18)
v_smfmac_f32_16x16x64_bf16 v[76:79], a[72:75], v[44:51], v146
buffer_load_dwordx4 a[172:175], v112, s[24:27], s99 offen offset:3072 sc1
ds_read_b128 v[52:55], v0 offset:22656
ds_read_b128 v[56:59], v1 offset:22656
ds_read_u16 v68, v60 offset:18560
ds_read_u16 v60, v60
v_add_u32_sdwa v61, s42, v126 dst_sel:DWORD dst_unused:UNUSED_PAD src0_sel:DWORD src1_sel:WORD_1
v_smfmac_f32_16x16x64_bf16 v[80:83], a[76:79], v[44:51], v146 abid:1
ds_read_u16 v69, v61 offset:18560
ds_read_u16 v61, v61
v_add_u32_sdwa v62, s42, v127 dst_sel:DWORD dst_unused:UNUSED_PAD src0_sel:DWORD src1_sel:WORD_0
v_smfmac_f32_16x16x64_bf16 v[84:87], a[80:83], v[44:51], v147
s_mov_b32 s99, 45056
buffer_load_dwordx4 a[176:179], v112, s[24:27], s99 offen offset:0 sc1
ds_read_u16 v70, v62 offset:18560
ds_read_u16 v62, v62
v_add_u32_sdwa v63, s42, v127 dst_sel:DWORD dst_unused:UNUSED_PAD src0_sel:DWORD src1_sel:WORD_1
v_smfmac_f32_16x16x64_bf16 v[88:91], a[84:87], v[44:51], v147 abid:1
ds_read_u16 v71, v63 offset:18560
ds_read_u16 v63, v63
v_add_u32_sdwa v64, s42, v128 dst_sel:DWORD dst_unused:UNUSED_PAD src0_sel:DWORD src1_sel:WORD_0
v_smfmac_f32_16x16x64_bf16 v[92:95], a[88:91], v[44:51], v148
ds_read_u16 v72, v64 offset:18560
ds_read_u16 v64, v64
v_add_u32_sdwa v65, s42, v128 dst_sel:DWORD dst_unused:UNUSED_PAD src0_sel:DWORD src1_sel:WORD_1
v_smfmac_f32_16x16x64_bf16 v[96:99], a[92:95], v[44:51], v148 abid:1
s_mov_b32 s98, 5120
buffer_load_dwordx4 v[158:161], v113, s[24:27], s98 offen sc1
ds_read_u16 v73, v65 offset:18560
ds_read_u16 v65, v65
v_add_u32_sdwa v66, s42, v129 dst_sel:DWORD dst_unused:UNUSED_PAD src0_sel:DWORD src1_sel:WORD_0
v_smfmac_f32_16x16x64_bf16 v[100:103], a[96:99], v[44:51], v149
ds_read_u16 v74, v66 offset:18560
ds_read_u16 v66, v66
v_add_u32_sdwa v67, s42, v129 dst_sel:DWORD dst_unused:UNUSED_PAD src0_sel:DWORD src1_sel:WORD_1
v_smfmac_f32_16x16x64_bf16 v[104:107], a[100:103], v[44:51], v149 abid:1
buffer_load_dwordx4 a[180:183], v112, s[24:27], s99 offen offset:1024 sc1
ds_read_u16 v75, v67 offset:18560
ds_read_u16 v67, v67
v_smfmac_f32_16x16x64_bf16 v[108:111], a[104:107], v[44:51], v175
ds_read_b128 v[114:117], v2 offset:192
s_waitcnt lgkmcnt(15)
v_smfmac_f32_16x16x64_bf16 v[8:11], a[72:75], v[52:59], v146
buffer_load_dwordx4 a[184:187], v112, s[24:27], s99 offen offset:2048 sc1
ds_read_b128 v[44:47], v0 offset:6144
v_smfmac_f32_16x16x64_bf16 v[12:15], a[76:79], v[52:59], v146 abid:1
ds_read_b128 v[48:51], v1 offset:6144
v_smfmac_f32_16x16x64_bf16 v[16:19], a[80:83], v[52:59], v147
v_smfmac_f32_16x16x64_bf16 v[20:23], a[84:87], v[52:59], v147 abid:1
buffer_load_dwordx4 a[188:191], v112, s[24:27], s99 offen offset:3072 sc1
v_smfmac_f32_16x16x64_bf16 v[24:27], a[88:91], v[52:59], v148
v_smfmac_f32_16x16x64_bf16 v[28:31], a[92:95], v[52:59], v148 abid:1
s_mov_b32 s99, 49152
buffer_load_dwordx4 a[192:195], v112, s[24:27], s99 offen offset:0 sc1
v_smfmac_f32_16x16x64_bf16 v[32:35], a[96:99], v[52:59], v149
v_smfmac_f32_16x16x64_bf16 v[36:39], a[100:103], v[52:59], v149 abid:1
buffer_load_dwordx4 a[196:199], v112, s[24:27], s99 offen offset:1024 sc1
v_smfmac_f32_16x16x64_bf16 v[40:43], a[104:107], v[52:59], v175
s_waitcnt lgkmcnt(2)
v_smfmac_f32_16x16x64_bf16 v[20:23], v[114:117], v[68:75], v181 abid:1
v_smfmac_f32_16x16x64_bf16 v[24:27], v[114:117], v[68:75], v182
buffer_load_dwordx4 a[200:203], v112, s[24:27], s99 offen offset:2048 sc1
v_smfmac_f32_16x16x64_bf16 v[28:31], v[114:117], v[68:75], v182 abid:1
v_smfmac_f32_16x16x64_bf16 v[88:91], v[114:117], v[60:67], v181 abid:1
buffer_load_dwordx4 a[204:207], v112, s[24:27], s99 offen offset:3072 sc1
v_smfmac_f32_16x16x64_bf16 v[92:95], v[114:117], v[60:67], v182
v_smfmac_f32_16x16x64_bf16 v[96:99], v[114:117], v[60:67], v182 abid:1
s_mov_b32 s99, 53248
buffer_load_dwordx4 a[208:211], v112, s[24:27], s99 offen offset:0 sc1
v_add_u32_sdwa v60, s42, v130 dst_sel:DWORD dst_unused:UNUSED_PAD src0_sel:DWORD src1_sel:WORD_0
s_waitcnt lgkmcnt(0)
s_waitcnt vmcnt(18)
v_smfmac_f32_16x16x64_bf16 v[76:79], a[108:111], v[44:51], v150
ds_read_b128 v[52:55], v0 offset:24704
ds_read_b128 v[56:59], v1 offset:24704
ds_read_u16 v68, v60 offset:18560
ds_read_u16 v60, v60
v_add_u32_sdwa v61, s42, v130 dst_sel:DWORD dst_unused:UNUSED_PAD src0_sel:DWORD src1_sel:WORD_1
v_smfmac_f32_16x16x64_bf16 v[80:83], a[112:115], v[44:51], v150 abid:1
ds_read_u16 v69, v61 offset:18560
ds_read_u16 v61, v61
v_add_u32_sdwa v62, s42, v131 dst_sel:DWORD dst_unused:UNUSED_PAD src0_sel:DWORD src1_sel:WORD_0
v_smfmac_f32_16x16x64_bf16 v[84:87], a[116:119], v[44:51], v151
buffer_load_dwordx4 a[212:215], v112, s[24:27], s99 offen offset:1024 sc1
ds_read_u16 v70, v62 offset:18560
ds_read_u16 v62, v62
v_add_u32_sdwa v63, s42, v131 dst_sel:DWORD dst_unused:UNUSED_PAD src0_sel:DWORD src1_sel:WORD_1
v_smfmac_f32_16x16x64_bf16 v[88:91], a[120:123], v[44:51], v151 abid:1
ds_read_u16 v71, v63 offset:18560
ds_read_u16 v63, v63
v_add_u32_sdwa v64, s42, v132 dst_sel:DWORD dst_unused:UNUSED_PAD src0_sel:DWORD src1_sel:WORD_0
v_smfmac_f32_16x16x64_bf16 v[92:95], a[124:127], v[44:51], v152
s_mov_b32 s98, 6144
buffer_load_dwordx4 v[162:165], v113, s[24:27], s98 offen sc1
ds_read_u16 v72, v64 offset:18560
ds_read_u16 v64, v64
v_add_u32_sdwa v65, s42, v132 dst_sel:DWORD dst_unused:UNUSED_PAD src0_sel:DWORD src1_sel:WORD_1
v_smfmac_f32_16x16x64_bf16 v[96:99], a[128:131], v[44:51], v152 abid:1
ds_read_u16 v73, v65 offset:18560
ds_read_u16 v65, v65
v_add_u32_sdwa v66, s42, v133 dst_sel:DWORD dst_unused:UNUSED_PAD src0_sel:DWORD src1_sel:WORD_0
v_smfmac_f32_16x16x64_bf16 v[100:103], a[132:135], v[44:51], v153
buffer_load_dwordx4 a[216:219], v112, s[24:27], s99 offen offset:2048 sc1
ds_read_u16 v74, v66 offset:18560
ds_read_u16 v66, v66
v_add_u32_sdwa v67, s42, v133 dst_sel:DWORD dst_unused:UNUSED_PAD src0_sel:DWORD src1_sel:WORD_1
v_smfmac_f32_16x16x64_bf16 v[104:107], a[136:139], v[44:51], v153 abid:1
ds_read_u16 v75, v67 offset:18560
ds_read_u16 v67, v67
v_smfmac_f32_16x16x64_bf16 v[108:111], a[140:143], v[44:51], v175 abid:1
ds_read_b128 v[114:117], v2 offset:256
s_waitcnt lgkmcnt(15)
v_smfmac_f32_16x16x64_bf16 v[8:11], a[108:111], v[52:59], v150
buffer_load_dwordx4 a[220:223], v112, s[24:27], s99 offen offset:3072 sc1
ds_read_b128 v[44:47], v0 offset:8192
v_smfmac_f32_16x16x64_bf16 v[12:15], a[112:115], v[52:59], v150 abid:1
ds_read_b128 v[48:51], v1 offset:8192
v_smfmac_f32_16x16x64_bf16 v[16:19], a[116:119], v[52:59], v151
s_mov_b32 s99, 57344
buffer_load_dwordx4 a[224:227], v112, s[24:27], s99 offen offset:0 sc1
v_smfmac_f32_16x16x64_bf16 v[20:23], a[120:123], v[52:59], v151 abid:1
v_smfmac_f32_16x16x64_bf16 v[24:27], a[124:127], v[52:59], v152
buffer_load_dwordx4 a[228:231], v112, s[24:27], s99 offen offset:1024 sc1
v_smfmac_f32_16x16x64_bf16 v[28:31], a[128:131], v[52:59], v152 abid:1
v_smfmac_f32_16x16x64_bf16 v[32:35], a[132:135], v[52:59], v153
v_smfmac_f32_16x16x64_bf16 v[36:39], a[136:139], v[52:59], v153 abid:1
buffer_load_dwordx4 a[232:235], v112, s[24:27], s99 offen offset:2048 sc1
v_smfmac_f32_16x16x64_bf16 v[40:43], a[140:143], v[52:59], v175 abid:1
s_waitcnt lgkmcnt(2)
v_smfmac_f32_16x16x64_bf16 v[28:31], v[114:117], v[68:75], v183
buffer_load_dwordx4 a[236:239], v112, s[24:27], s99 offen offset:3072 sc1
v_smfmac_f32_16x16x64_bf16 v[32:35], v[114:117], v[68:75], v183 abid:1
v_smfmac_f32_16x16x64_bf16 v[36:39], v[114:117], v[68:75], v184
s_mov_b32 s99, 61440
buffer_load_dwordx4 a[240:243], v112, s[24:27], s99 offen offset:0 sc1
v_smfmac_f32_16x16x64_bf16 v[96:99], v[114:117], v[60:67], v183
v_smfmac_f32_16x16x64_bf16 v[100:103], v[114:117], v[60:67], v183 abid:1
v_smfmac_f32_16x16x64_bf16 v[104:107], v[114:117], v[60:67], v184
buffer_load_dwordx4 a[244:247], v112, s[24:27], s99 offen offset:1024 sc1
v_add_u32_sdwa v60, s42, v134 dst_sel:DWORD dst_unused:UNUSED_PAD src0_sel:DWORD src1_sel:WORD_0
s_waitcnt lgkmcnt(0)
s_waitcnt vmcnt(18)
v_smfmac_f32_16x16x64_bf16 v[76:79], a[144:147], v[44:51], v154
ds_read_b128 v[52:55], v0 offset:26752
ds_read_b128 v[56:59], v1 offset:26752
ds_read_u16 v68, v60 offset:18560
ds_read_u16 v60, v60
v_add_u32_sdwa v61, s42, v134 dst_sel:DWORD dst_unused:UNUSED_PAD src0_sel:DWORD src1_sel:WORD_1
v_smfmac_f32_16x16x64_bf16 v[80:83], a[148:151], v[44:51], v154 abid:1
buffer_load_dwordx4 a[248:251], v112, s[24:27], s99 offen offset:2048 sc1
ds_read_u16 v69, v61 offset:18560
ds_read_u16 v61, v61
v_add_u32_sdwa v62, s42, v135 dst_sel:DWORD dst_unused:UNUSED_PAD src0_sel:DWORD src1_sel:WORD_0
v_smfmac_f32_16x16x64_bf16 v[84:87], a[152:155], v[44:51], v155
ds_read_u16 v70, v62 offset:18560
ds_read_u16 v62, v62
v_add_u32_sdwa v63, s42, v135 dst_sel:DWORD dst_unused:UNUSED_PAD src0_sel:DWORD src1_sel:WORD_1
v_smfmac_f32_16x16x64_bf16 v[88:91], a[156:159], v[44:51], v155 abid:1
s_mov_b32 s98, 7168
buffer_load_dwordx4 v[166:169], v113, s[24:27], s98 offen sc1
ds_read_u16 v71, v63 offset:18560
ds_read_u16 v63, v63
v_add_u32_sdwa v64, s42, v136 dst_sel:DWORD dst_unused:UNUSED_PAD src0_sel:DWORD src1_sel:WORD_0
v_smfmac_f32_16x16x64_bf16 v[92:95], a[160:163], v[44:51], v156
ds_read_u16 v72, v64 offset:18560
ds_read_u16 v64, v64
v_add_u32_sdwa v65, s42, v136 dst_sel:DWORD dst_unused:UNUSED_PAD src0_sel:DWORD src1_sel:WORD_1
v_smfmac_f32_16x16x64_bf16 v[96:99], a[164:167], v[44:51], v156 abid:1
ds_read_u16 v73, v65 offset:18560
ds_read_u16 v65, v65
v_add_u32_sdwa v66, s42, v137 dst_sel:DWORD dst_unused:UNUSED_PAD src0_sel:DWORD src1_sel:WORD_0
v_smfmac_f32_16x16x64_bf16 v[100:103], a[168:171], v[44:51], v157
s_mov_b32 s98, 8192
buffer_load_dwordx4 v[170:173], v113, s[24:27], s98 offen sc1
ds_read_u16 v74, v66 offset:18560
ds_read_u16 v66, v66
v_add_u32_sdwa v67, s42, v137 dst_sel:DWORD dst_unused:UNUSED_PAD src0_sel:DWORD src1_sel:WORD_1
v_smfmac_f32_16x16x64_bf16 v[104:107], a[172:175], v[44:51], v157 abid:1
ds_read_u16 v75, v67 offset:18560
ds_read_u16 v67, v67
v_smfmac_f32_16x16x64_bf16 v[108:111], a[176:179], v[44:51], v176
s_mov_b32 s99, 69632
buffer_load_dwordx4 v[214:217], v112, s[24:27], s99 offen offset:3072 sc1
ds_read_b128 v[114:117], v2 offset:320
s_waitcnt lgkmcnt(15)
v_smfmac_f32_16x16x64_bf16 v[8:11], a[144:147], v[52:59], v154
ds_read_b128 v[44:47], v0 offset:10240
v_smfmac_f32_16x16x64_bf16 v[12:15], a[148:151], v[52:59], v154 abid:1
s_mov_b32 s99, 81920
buffer_load_dwordx4 v[250:253], v112, s[24:27], s99 offen offset:0 sc1
ds_read_b128 v[48:51], v1 offset:10240
v_smfmac_f32_16x16x64_bf16 v[16:19], a[152:155], v[52:59], v155
v_smfmac_f32_16x16x64_bf16 v[20:23], a[156:159], v[52:59], v155 abid:1
v_smfmac_f32_16x16x64_bf16 v[24:27], a[160:163], v[52:59], v156
s_mov_b32 s99, 61440
buffer_load_dwordx4 a[252:255], v112, s[24:27], s99 offen offset:3072 sc1
v_smfmac_f32_16x16x64_bf16 v[28:31], a[164:167], v[52:59], v156 abid:1
v_smfmac_f32_16x16x64_bf16 v[32:35], a[168:171], v[52:59], v157
s_mov_b32 s99, 73728
buffer_load_dwordx4 v[218:221], v112, s[24:27], s99 offen offset:0 sc1
v_smfmac_f32_16x16x64_bf16 v[36:39], a[172:175], v[52:59], v157 abid:1
v_smfmac_f32_16x16x64_bf16 v[40:43], a[176:179], v[52:59], v176
s_mov_b32 s99, 65536
buffer_load_dwordx4 v[186:189], v112, s[24:27], s99 offen offset:0 sc1
s_waitcnt lgkmcnt(2)
v_smfmac_f32_16x16x64_bf16 v[36:39], v[114:117], v[68:75], v184 abid:1
v_smfmac_f32_16x16x64_bf16 v[40:43], v[114:117], v[68:75], v185
v_smfmac_f32_16x16x64_bf16 v[104:107], v[114:117], v[60:67], v184 abid:1
s_mov_b32 s99, 73728
buffer_load_dwordx4 v[222:225], v112, s[24:27], s99 offen offset:1024 sc1
v_smfmac_f32_16x16x64_bf16 v[108:111], v[114:117], v[60:67], v185
s_waitcnt lgkmcnt(0)
s_waitcnt vmcnt(18)
v_smfmac_f32_16x16x64_bf16 v[76:79], a[180:183], v[44:51], v158
s_mov_b32 s99, 65536
buffer_load_dwordx4 v[190:193], v112, s[24:27], s99 offen offset:1024 sc1
ds_read_b128 v[52:55], v0 offset:28800
ds_read_b128 v[56:59], v1 offset:28800
v_smfmac_f32_16x16x64_bf16 v[80:83], a[184:187], v[44:51], v158 abid:1
v_smfmac_f32_16x16x64_bf16 v[84:87], a[188:191], v[44:51], v159
s_mov_b32 s99, 73728
buffer_load_dwordx4 v[226:229], v112, s[24:27], s99 offen offset:2048 sc1
ds_read_b128 v[60:63], v0 offset:32896
v_smfmac_f32_16x16x64_bf16 v[88:91], a[192:195], v[44:51], v159 abid:1
ds_read_b128 v[64:67], v1 offset:32896
v_smfmac_f32_16x16x64_bf16 v[92:95], a[196:199], v[44:51], v160
v_smfmac_f32_16x16x64_bf16 v[96:99], a[200:203], v[44:51], v160 abid:1
s_mov_b32 s99, 65536
buffer_load_dwordx4 v[194:197], v112, s[24:27], s99 offen offset:2048 sc1
v_smfmac_f32_16x16x64_bf16 v[100:103], a[204:207], v[44:51], v161
v_smfmac_f32_16x16x64_bf16 v[104:107], a[208:211], v[44:51], v161 abid:1
s_mov_b32 s99, 73728
buffer_load_dwordx4 v[230:233], v112, s[24:27], s99 offen offset:3072 sc1
v_smfmac_f32_16x16x64_bf16 v[108:111], a[212:215], v[44:51], v176 abid:1
s_waitcnt lgkmcnt(2)
v_smfmac_f32_16x16x64_bf16 v[8:11], a[180:183], v[52:59], v158
s_mov_b32 s99, 65536
buffer_load_dwordx4 v[198:201], v112, s[24:27], s99 offen offset:3072 sc1
ds_read_b128 v[44:47], v0 offset:12288
v_smfmac_f32_16x16x64_bf16 v[12:15], a[184:187], v[52:59], v158 abid:1
ds_read_b128 v[48:51], v1 offset:12288
v_smfmac_f32_16x16x64_bf16 v[16:19], a[188:191], v[52:59], v159
v_smfmac_f32_16x16x64_bf16 v[20:23], a[192:195], v[52:59], v159 abid:1
s_mov_b32 s99, 77824
buffer_load_dwordx4 v[234:237], v112, s[24:27], s99 offen offset:0 sc1
v_smfmac_f32_16x16x64_bf16 v[24:27], a[196:199], v[52:59], v160
v_smfmac_f32_16x16x64_bf16 v[28:31], a[200:203], v[52:59], v160 abid:1
s_mov_b32 s99, 69632
buffer_load_dwordx4 v[202:205], v112, s[24:27], s99 offen offset:0 sc1
v_smfmac_f32_16x16x64_bf16 v[32:35], a[204:207], v[52:59], v161
v_smfmac_f32_16x16x64_bf16 v[36:39], a[208:211], v[52:59], v161 abid:1
s_mov_b32 s99, 77824
buffer_load_dwordx4 v[238:241], v112, s[24:27], s99 offen offset:1024 sc1
v_smfmac_f32_16x16x64_bf16 v[40:43], a[212:215], v[52:59], v176 abid:1
s_waitcnt lgkmcnt(0)
s_waitcnt vmcnt(18)
v_smfmac_f32_16x16x64_bf16 v[76:79], a[216:219], v[44:51], v162
ds_read_b128 v[52:55], v0 offset:30848
ds_read_b128 v[56:59], v1 offset:30848
v_smfmac_f32_16x16x64_bf16 v[80:83], a[220:223], v[44:51], v162 abid:1
s_mov_b32 s99, 69632
buffer_load_dwordx4 v[206:209], v112, s[24:27], s99 offen offset:1024 sc1
v_smfmac_f32_16x16x64_bf16 v[84:87], a[224:227], v[44:51], v163
ds_read_b128 v[68:71], v0 offset:34944
v_smfmac_f32_16x16x64_bf16 v[88:91], a[228:231], v[44:51], v163 abid:1
s_mov_b32 s99, 77824
buffer_load_dwordx4 v[242:245], v112, s[24:27], s99 offen offset:2048 sc1
ds_read_b128 v[72:75], v1 offset:34944
v_smfmac_f32_16x16x64_bf16 v[92:95], a[232:235], v[44:51], v164
v_smfmac_f32_16x16x64_bf16 v[96:99], a[236:239], v[44:51], v164 abid:1
s_mov_b32 s99, 69632
buffer_load_dwordx4 v[210:213], v112, s[24:27], s99 offen offset:2048 sc1
v_smfmac_f32_16x16x64_bf16 v[100:103], a[240:243], v[44:51], v165
s_waitcnt vmcnt(18)
v_smfmac_f32_16x16x64_bf16 v[104:107], a[244:247], v[44:51], v165 abid:1
v_smfmac_f32_16x16x64_bf16 v[108:111], a[248:251], v[44:51], v177
s_mov_b32 s99, 77824
buffer_load_dwordx4 v[246:249], v112, s[24:27], s99 offen offset:3072 sc1
s_waitcnt lgkmcnt(2)
v_smfmac_f32_16x16x64_bf16 v[8:11], a[216:219], v[52:59], v162
ds_read_b128 v[44:47], v0 offset:14336
v_smfmac_f32_16x16x64_bf16 v[12:15], a[220:223], v[52:59], v162 abid:1
ds_read_b128 v[48:51], v1 offset:14336
v_smfmac_f32_16x16x64_bf16 v[16:19], a[224:227], v[52:59], v163
v_smfmac_f32_16x16x64_bf16 v[20:23], a[228:231], v[52:59], v163 abid:1
v_smfmac_f32_16x16x64_bf16 v[24:27], a[232:235], v[52:59], v164
v_smfmac_f32_16x16x64_bf16 v[28:31], a[236:239], v[52:59], v164 abid:1
v_smfmac_f32_16x16x64_bf16 v[32:35], a[240:243], v[52:59], v165
v_smfmac_f32_16x16x64_bf16 v[36:39], a[244:247], v[52:59], v165 abid:1
v_smfmac_f32_16x16x64_bf16 v[40:43], a[248:251], v[52:59], v177
ds_read_b128 v[52:55], v0 offset:16384
ds_read_b128 v[56:59], v1 offset:16384
s_waitcnt lgkmcnt(2)
s_waitcnt vmcnt(17)
v_smfmac_f32_16x16x64_bf16 v[108:111], v[214:217], v[44:51], v177 abid:1
s_waitcnt lgkmcnt(0)
s_waitcnt vmcnt(16)
v_smfmac_f32_16x16x64_bf16 v[108:111], v[250:253], v[52:59], v178
v_add_u32 v0, 37120, v0
v_add_u32 v1, 37120, v1
s_waitcnt vmcnt(15)
v_smfmac_f32_16x16x64_bf16 v[76:79], a[252:255], v[44:51], v166
s_waitcnt vmcnt(14)
v_smfmac_f32_16x16x64_bf16 v[76:79], v[218:221], v[52:59], v170
s_nop 1
v_cvt_pk_bf16_f32 v108, v108, v109
v_cvt_pk_bf16_f32 v109, v110, v111
ds_bpermute_b32 v108, v6, v108
ds_bpermute_b32 v109, v6, v109
s_waitcnt vmcnt(13)
v_smfmac_f32_16x16x64_bf16 v[80:83], v[186:189], v[44:51], v166 abid:1
s_waitcnt vmcnt(12)
v_smfmac_f32_16x16x64_bf16 v[80:83], v[222:225], v[52:59], v170 abid:1
v_cvt_pk_bf16_f32 v76, v76, v77
v_cvt_pk_bf16_f32 v77, v78, v79
s_waitcnt vmcnt(11)
v_smfmac_f32_16x16x64_bf16 v[84:87], v[190:193], v[44:51], v167
s_waitcnt vmcnt(10)
v_smfmac_f32_16x16x64_bf16 v[84:87], v[226:229], v[52:59], v171
s_nop 1
v_cvt_pk_bf16_f32 v78, v80, v81
v_cvt_pk_bf16_f32 v79, v82, v83
s_waitcnt lgkmcnt(0)
buffer_store_dwordx2 v[108:109], v5, s[20:23], s46 offen
s_waitcnt vmcnt(10)
v_smfmac_f32_16x16x64_bf16 v[88:91], v[194:197], v[44:51], v167 abid:1
s_waitcnt vmcnt(9)
v_smfmac_f32_16x16x64_bf16 v[88:91], v[230:233], v[52:59], v171 abid:1
v_cvt_pk_bf16_f32 v80, v84, v85
v_cvt_pk_bf16_f32 v81, v86, v87
s_waitcnt vmcnt(8)
v_smfmac_f32_16x16x64_bf16 v[92:95], v[198:201], v[44:51], v168
s_waitcnt vmcnt(7)
v_smfmac_f32_16x16x64_bf16 v[92:95], v[234:237], v[52:59], v172
s_nop 1
v_cvt_pk_bf16_f32 v82, v88, v89
v_cvt_pk_bf16_f32 v83, v90, v91
v_cndmask_b32_dpp v114, v80, v76, vcc quad_perm:[1,0,3,2] row_mask:0xf bank_mask:0xf
v_cndmask_b32_dpp v115, v81, v77, vcc quad_perm:[1,0,3,2] row_mask:0xf bank_mask:0xf
v_cndmask_b32_dpp v116, v82, v78, vcc quad_perm:[1,0,3,2] row_mask:0xf bank_mask:0xf
v_cndmask_b32_dpp v117, v83, v79, vcc quad_perm:[1,0,3,2] row_mask:0xf bank_mask:0xf
buffer_store_dwordx4 v[114:117], v4, s[20:23], s46 offen offset:0 sc1
s_mov_b64 vcc, s[82:83]
s_waitcnt vmcnt(7)
v_smfmac_f32_16x16x64_bf16 v[96:99], v[202:205], v[44:51], v168 abid:1
s_waitcnt vmcnt(6)
v_smfmac_f32_16x16x64_bf16 v[96:99], v[238:241], v[52:59], v172 abid:1
v_cvt_pk_bf16_f32 v84, v92, v93
v_cvt_pk_bf16_f32 v85, v94, v95
v_cndmask_b32_dpp v80, v76, v80, vcc quad_perm:[1,0,3,2] row_mask:0xf bank_mask:0xf
v_cndmask_b32_dpp v81, v77, v81, vcc quad_perm:[1,0,3,2] row_mask:0xf bank_mask:0xf
v_cndmask_b32_dpp v82, v78, v82, vcc quad_perm:[1,0,3,2] row_mask:0xf bank_mask:0xf
v_cndmask_b32_dpp v83, v79, v83, vcc quad_perm:[1,0,3,2] row_mask:0xf bank_mask:0xf
buffer_store_dwordx4 v[80:83], v4, s[20:23], s46 offen offset:1152 sc1
s_mov_b64 vcc, s[80:81]
s_waitcnt vmcnt(6)
v_smfmac_f32_16x16x64_bf16 v[100:103], v[206:209], v[44:51], v169
s_waitcnt vmcnt(5)
v_smfmac_f32_16x16x64_bf16 v[100:103], v[242:245], v[52:59], v173
v_cvt_pk_bf16_f32 v86, v96, v97
v_cvt_pk_bf16_f32 v87, v98, v99
v_add_u32_sdwa v76, s4, v118 dst_sel:DWORD dst_unused:UNUSED_PAD src0_sel:DWORD src1_sel:WORD_0
v_add_u32_sdwa v77, s4, v118 dst_sel:DWORD dst_unused:UNUSED_PAD src0_sel:DWORD src1_sel:WORD_1
v_add_u32_sdwa v78, s4, v119 dst_sel:DWORD dst_unused:UNUSED_PAD src0_sel:DWORD src1_sel:WORD_0
v_add_u32_sdwa v79, s4, v119 dst_sel:DWORD dst_unused:UNUSED_PAD src0_sel:DWORD src1_sel:WORD_1
s_waitcnt vmcnt(4)
v_smfmac_f32_16x16x64_bf16 v[104:107], v[210:213], v[44:51], v169 abid:1
s_waitcnt vmcnt(3)
v_smfmac_f32_16x16x64_bf16 v[104:107], v[246:249], v[52:59], v173 abid:1
v_cvt_pk_bf16_f32 v88, v100, v101
v_cvt_pk_bf16_f32 v89, v102, v103
v_add_u32_sdwa v80, s4, v120 dst_sel:DWORD dst_unused:UNUSED_PAD src0_sel:DWORD src1_sel:WORD_0
v_add_u32_sdwa v81, s4, v120 dst_sel:DWORD dst_unused:UNUSED_PAD src0_sel:DWORD src1_sel:WORD_1
v_add_u32_sdwa v82, s4, v121 dst_sel:DWORD dst_unused:UNUSED_PAD src0_sel:DWORD src1_sel:WORD_0
v_add_u32_sdwa v83, s4, v121 dst_sel:DWORD dst_unused:UNUSED_PAD src0_sel:DWORD src1_sel:WORD_1
s_nop 1
v_cvt_pk_bf16_f32 v90, v104, v105
v_cvt_pk_bf16_f32 v91, v106, v107
v_cndmask_b32_dpp v92, v88, v84, vcc quad_perm:[1,0,3,2] row_mask:0xf bank_mask:0xf
v_cndmask_b32_dpp v93, v89, v85, vcc quad_perm:[1,0,3,2] row_mask:0xf bank_mask:0xf
v_cndmask_b32_dpp v94, v90, v86, vcc quad_perm:[1,0,3,2] row_mask:0xf bank_mask:0xf
v_cndmask_b32_dpp v95, v91, v87, vcc quad_perm:[1,0,3,2] row_mask:0xf bank_mask:0xf
buffer_store_dwordx4 v[92:95], v4, s[20:23], s46 offen offset:128 sc1
s_mov_b64 vcc, s[82:83]
v_cndmask_b32_dpp v88, v84, v88, vcc quad_perm:[1,0,3,2] row_mask:0xf bank_mask:0xf
v_cndmask_b32_dpp v89, v85, v89, vcc quad_perm:[1,0,3,2] row_mask:0xf bank_mask:0xf
v_cndmask_b32_dpp v90, v86, v90, vcc quad_perm:[1,0,3,2] row_mask:0xf bank_mask:0xf
v_cndmask_b32_dpp v91, v87, v91, vcc quad_perm:[1,0,3,2] row_mask:0xf bank_mask:0xf
buffer_store_dwordx4 v[88:91], v4, s[20:23], s46 offen offset:1280 sc1
s_mov_b64 vcc, s[80:81]
s_bfe_u32 s88, s85, 0x40018
s_cbranch_scc0 L_pf2_e
L_pf2:
s_add_u32 m0, s44, 0
s_nop 0
buffer_load_dwordx4 v3, s[16:19], s45 offen offset:0 nt lds
s_add_u32 m0, s44, 3840
s_nop 0
buffer_load_dwordx4 v3, s[16:19], s45 offen offset:256 nt lds
s_add_u32 m0, s44, 7680
s_nop 0
buffer_load_dwordx4 v3, s[16:19], s45 offen offset:512 nt lds
s_add_u32 m0, s44, 11520
s_nop 0
buffer_load_dwordx4 v3, s[16:19], s45 offen offset:768 nt lds
s_add_u32 m0, s44, s8
s_mov_b64 exec, s[10:11]
buffer_load_dwordx4 v3, s[16:19], s7 offen offset:896 nt lds
s_mov_b64 exec, -1
s_add_u32 s7, s7, s13
s_add_u32 s44, s44, 18560
s_add_u32 s45, s45, s13
s_mov_b32 s13, 4718592
s_sub_u32 s88, s88, 1
s_cmp_lg_u32 s88, 0
s_cbranch_scc1 L_pf2
L_pf2_e:
s_cmp_ge_u32 s44, 148480
s_cselect_b32 s44, s9, s44
s_add_u32 s46, s46, 4718592
s_waitcnt lgkmcnt(0)
s_barrier
s_cmp_lg_u32 s89, 0
s_cbranch_scc1 L_loopnk_p3
s_branch L_loopn_p3
.p2align 6
L_loop:
v_smfmac_f32_16x16x64_bf16 v[8:11], a[0:3], v[44:51], v138
ds_read_b128 v[32:35], v2 offset:1408
v_cvt_pk_bf16_f32 v106, v36, v37
v_smfmac_f32_16x16x64_bf16 v[8:11], a[36:39], v[52:59], v142
s_waitcnt lgkmcnt(9)
v_cvt_pk_bf16_f32 v107, v38, v39
v_smfmac_f32_16x16x64_bf16 v[12:15], a[4:7], v[44:51], v138 abid:1
ds_read_b128 v[36:39], v2 offset:1472
v_cvt_pk_bf16_f32 v112, v40, v41
v_smfmac_f32_16x16x64_bf16 v[12:15], a[40:43], v[52:59], v142 abid:1
s_waitcnt lgkmcnt(8)
ds_read_b128 v[60:63], v0 offset:4096
v_cvt_pk_bf16_f32 v113, v42, v43
v_smfmac_f32_16x16x64_bf16 v[16:19], a[8:11], v[44:51], v139
s_cmp_eq_u32 s4, 129920
ds_read_b128 v[40:43], v2 offset:1536
v_cndmask_b32_dpp v108, v96, v92, vcc quad_perm:[1,0,3,2] row_mask:0xf bank_mask:0xf
v_smfmac_f32_16x16x64_bf16 v[16:19], a[44:47], v[52:59], v143
s_waitcnt lgkmcnt(8)
ds_read_u16 v82, v82
v_cndmask_b32_dpp v109, v97, v93, vcc quad_perm:[1,0,3,2] row_mask:0xf bank_mask:0xf
v_smfmac_f32_16x16x64_bf16 v[20:23], a[12:15], v[44:51], v139 abid:1
s_cselect_b32 s43, -129920, s5
ds_read_u16 v84, v84
v_cndmask_b32_dpp v110, v98, v94, vcc quad_perm:[1,0,3,2] row_mask:0xf bank_mask:0xf
v_smfmac_f32_16x16x64_bf16 v[20:23], a[48:51], v[52:59], v143 abid:1
s_waitcnt lgkmcnt(8)
ds_read_b128 v[64:67], v1 offset:4096
v_cndmask_b32_dpp v111, v99, v95, vcc quad_perm:[1,0,3,2] row_mask:0xf bank_mask:0xf
v_smfmac_f32_16x16x64_bf16 v[24:27], a[16:19], v[44:51], v140
s_add_u32 s4, s4, s43
ds_read_b128 v[68:71], v0 offset:6144
v_add_u32_sdwa v87, s42, v123 dst_sel:DWORD dst_unused:UNUSED_PAD src0_sel:DWORD src1_sel:WORD_1
v_smfmac_f32_16x16x64_bf16 v[24:27], a[52:55], v[52:59], v144
buffer_store_dwordx4 v[108:111], v4, s[20:23], s46 offen offset:0 sc1
s_mov_b64 vcc, s[82:83]
s_waitcnt lgkmcnt(8)
ds_read_b128 v[72:75], v1 offset:6144
v_cndmask_b32_dpp v96, v92, v96, vcc quad_perm:[1,0,3,2] row_mask:0xf bank_mask:0xf
v_cndmask_b32_dpp v97, v93, v97, vcc quad_perm:[1,0,3,2] row_mask:0xf bank_mask:0xf
v_smfmac_f32_16x16x64_bf16 v[28:31], a[20:23], v[44:51], v140 abid:1
s_add_u32 s41, s41, 1
ds_read_u16 v83, v83
v_cndmask_b32_dpp v98, v94, v98, vcc quad_perm:[1,0,3,2] row_mask:0xf bank_mask:0xf
v_smfmac_f32_16x16x64_bf16 v[28:31], a[56:59], v[52:59], v144 abid:1
s_waitcnt lgkmcnt(9)
ds_read_b128 v[114:117], v2 offset:64
v_cndmask_b32_dpp v99, v95, v99, vcc quad_perm:[1,0,3,2] row_mask:0xf bank_mask:0xf
v_smfmac_f32_16x16x64_bf16 v[32:35], a[24:27], v[44:51], v141
ds_read_u16 v85, v85
v_add_u32_sdwa v88, s42, v124 dst_sel:DWORD dst_unused:UNUSED_PAD src0_sel:DWORD src1_sel:WORD_0
v_smfmac_f32_16x16x64_bf16 v[32:35], a[60:63], v[52:59], v145
s_waitcnt lgkmcnt(10)
ds_read_u16 v86, v86
v_add_u32_sdwa v89, s42, v124 dst_sel:DWORD dst_unused:UNUSED_PAD src0_sel:DWORD src1_sel:WORD_1
v_smfmac_f32_16x16x64_bf16 v[36:39], a[28:31], v[44:51], v141 abid:1
ds_read_u16 v87, v87
v_add_u32_sdwa v90, s42, v125 dst_sel:DWORD dst_unused:UNUSED_PAD src0_sel:DWORD src1_sel:WORD_0
v_smfmac_f32_16x16x64_bf16 v[36:39], a[64:67], v[52:59], v145 abid:1
s_waitcnt lgkmcnt(10)
ds_read_u16 v88, v88
v_add_u32_sdwa v91, s42, v125 dst_sel:DWORD dst_unused:UNUSED_PAD src0_sel:DWORD src1_sel:WORD_1
v_smfmac_f32_16x16x64_bf16 v[40:43], a[32:35], v[44:51], v174
buffer_store_dwordx4 v[96:99], v4, s[20:23], s46 offen offset:1152 sc1
s_mov_b64 vcc, s[80:81]
ds_read_u16 v89, v89
v_cndmask_b32_dpp v92, v104, v100, vcc quad_perm:[1,0,3,2] row_mask:0xf bank_mask:0xf
v_cndmask_b32_dpp v93, v105, v101, vcc quad_perm:[1,0,3,2] row_mask:0xf bank_mask:0xf
v_smfmac_f32_16x16x64_bf16 v[40:43], a[68:71], v[52:59], v174 abid:1
s_waitcnt lgkmcnt(9)
ds_read_u16 v90, v90
v_cndmask_b32_dpp v94, v106, v102, vcc quad_perm:[1,0,3,2] row_mask:0xf bank_mask:0xf
v_smfmac_f32_16x16x64_bf16 v[8:11], a[72:75], v[60:67], v146
s_waitcnt lgkmcnt(8)
ds_read_u16 v91, v91
v_cndmask_b32_dpp v95, v107, v103, vcc quad_perm:[1,0,3,2] row_mask:0xf bank_mask:0xf
v_smfmac_f32_16x16x64_bf16 v[8:11], a[108:111], v[68:75], v150
s_waitcnt lgkmcnt(7)
ds_bpermute_b32 v112, v6, v112
v_smfmac_f32_16x16x64_bf16 v[8:11], v[114:117], v[76:83], v179
s_waitcnt vmcnt(2)
ds_bpermute_b32 v113, v6, v113
v_smfmac_f32_16x16x64_bf16 v[12:15], v[114:117], v[76:83], v179 abid:1
ds_read_b128 v[114:117], v2 offset:128
v_add_u32_sdwa v76, s42, v126 dst_sel:DWORD dst_unused:UNUSED_PAD src0_sel:DWORD src1_sel:WORD_0
v_smfmac_f32_16x16x64_bf16 v[12:15], a[76:79], v[60:67], v146 abid:1
ds_read_u16 v76, v76
v_add_u32_sdwa v77, s42, v126 dst_sel:DWORD dst_unused:UNUSED_PAD src0_sel:DWORD src1_sel:WORD_1
v_smfmac_f32_16x16x64_bf16 v[12:15], a[112:115], v[68:75], v150 abid:1
buffer_store_dwordx4 v[92:95], v4, s[20:23], s46 offen offset:128 sc1
s_mov_b64 vcc, s[82:83]
ds_read_u16 v77, v77
v_cndmask_b32_dpp v104, v100, v104, vcc quad_perm:[1,0,3,2] row_mask:0xf bank_mask:0xf
v_add_u32_sdwa v78, s42, v127 dst_sel:DWORD dst_unused:UNUSED_PAD src0_sel:DWORD src1_sel:WORD_0
v_smfmac_f32_16x16x64_bf16 v[24:27], a[88:91], v[60:67], v148
ds_read_u16 v78, v78
v_cndmask_b32_dpp v105, v101, v105, vcc quad_perm:[1,0,3,2] row_mask:0xf bank_mask:0xf
v_smfmac_f32_16x16x64_bf16 v[24:27], a[124:127], v[68:75], v152
ds_read_b128 v[44:47], v0 offset:8192
v_cndmask_b32_dpp v106, v102, v106, vcc quad_perm:[1,0,3,2] row_mask:0xf bank_mask:0xf
v_smfmac_f32_16x16x64_bf16 v[28:31], a[92:95], v[60:67], v148 abid:1
ds_read_b128 v[48:51], v1 offset:8192
v_add_u32_sdwa v79, s42, v127 dst_sel:DWORD dst_unused:UNUSED_PAD src0_sel:DWORD src1_sel:WORD_1
v_smfmac_f32_16x16x64_bf16 v[28:31], a[128:131], v[68:75], v152 abid:1
ds_read_u16 v79, v79
v_cndmask_b32_dpp v107, v103, v107, vcc quad_perm:[1,0,3,2] row_mask:0xf bank_mask:0xf
v_smfmac_f32_16x16x64_bf16 v[32:35], a[96:99], v[60:67], v149
ds_read_b128 v[52:55], v0 offset:10240
v_add_u32_sdwa v80, s42, v128 dst_sel:DWORD dst_unused:UNUSED_PAD src0_sel:DWORD src1_sel:WORD_0
v_smfmac_f32_16x16x64_bf16 v[32:35], a[132:135], v[68:75], v153
ds_read_u16 v80, v80
v_add_u32_sdwa v81, s42, v128 dst_sel:DWORD dst_unused:UNUSED_PAD src0_sel:DWORD src1_sel:WORD_1
v_smfmac_f32_16x16x64_bf16 v[16:19], a[80:83], v[60:67], v147
buffer_store_dwordx4 v[104:107], v4, s[20:23], s46 offen offset:1280 sc1
s_mov_b64 vcc, s[80:81]
ds_read_b128 v[56:59], v1 offset:10240
v_add_u32_sdwa v82, s42, v129 dst_sel:DWORD dst_unused:UNUSED_PAD src0_sel:DWORD src1_sel:WORD_0
v_add_u32_sdwa v83, s42, v129 dst_sel:DWORD dst_unused:UNUSED_PAD src0_sel:DWORD src1_sel:WORD_1
v_smfmac_f32_16x16x64_bf16 v[16:19], a[116:119], v[68:75], v151
s_waitcnt lgkmcnt(9)
ds_read_b128 v[92:95], v0 offset:12288
v_add_u32_sdwa v100, s42, v130 dst_sel:DWORD dst_unused:UNUSED_PAD src0_sel:DWORD src1_sel:WORD_0
v_smfmac_f32_16x16x64_bf16 v[16:19], v[114:117], v[84:91], v180 abid:1
ds_read_u16 v81, v81
v_add_u32_sdwa v101, s42, v130 dst_sel:DWORD dst_unused:UNUSED_PAD src0_sel:DWORD src1_sel:WORD_1
v_smfmac_f32_16x16x64_bf16 v[20:23], v[114:117], v[84:91], v181
ds_read_b128 v[96:99], v1 offset:12288
v_add_u32_sdwa v102, s42, v131 dst_sel:DWORD dst_unused:UNUSED_PAD src0_sel:DWORD src1_sel:WORD_0
v_smfmac_f32_16x16x64_bf16 v[20:23], a[84:87], v[60:67], v147 abid:1
ds_read_u16 v100, v100
v_add_u32_sdwa v103, s42, v131 dst_sel:DWORD dst_unused:UNUSED_PAD src0_sel:DWORD src1_sel:WORD_1
v_smfmac_f32_16x16x64_bf16 v[20:23], a[120:123], v[68:75], v151 abid:1
ds_read_u16 v82, v82
v_add_u32_sdwa v104, s42, v132 dst_sel:DWORD dst_unused:UNUSED_PAD src0_sel:DWORD src1_sel:WORD_0
v_smfmac_f32_16x16x64_bf16 v[36:39], a[100:103], v[60:67], v149 abid:1
ds_read_u16 v101, v101
v_add_u32_sdwa v105, s42, v132 dst_sel:DWORD dst_unused:UNUSED_PAD src0_sel:DWORD src1_sel:WORD_1
v_smfmac_f32_16x16x64_bf16 v[36:39], a[136:139], v[68:75], v153 abid:1
buffer_store_dwordx2 v[112:113], v5, s[20:23], s46 offen
ds_read_u16 v83, v83
v_add_u32_sdwa v106, s42, v133 dst_sel:DWORD dst_unused:UNUSED_PAD src0_sel:DWORD src1_sel:WORD_0
v_smfmac_f32_16x16x64_bf16 v[40:43], a[104:107], v[60:67], v175
s_mov_b32 s22, 75497472
ds_read_b128 v[114:117], v2 offset:192
v_add_u32_sdwa v107, s42, v133 dst_sel:DWORD dst_unused:UNUSED_PAD src0_sel:DWORD src1_sel:WORD_1
v_smfmac_f32_16x16x64_bf16 v[40:43], a[140:143], v[68:75], v175 abid:1
s_waitcnt lgkmcnt(12)
ds_read_u16 v102, v102
v_add_u32_sdwa v84, s42, v134 dst_sel:DWORD dst_unused:UNUSED_PAD src0_sel:DWORD src1_sel:WORD_0
v_smfmac_f32_16x16x64_bf16 v[8:11], a[144:147], v[44:51], v154
s_waitcnt lgkmcnt(9)
ds_read_u16 v103, v103
v_add_u32_sdwa v85, s42, v134 dst_sel:DWORD dst_unused:UNUSED_PAD src0_sel:DWORD src1_sel:WORD_1
v_smfmac_f32_16x16x64_bf16 v[8:11], a[180:183], v[52:59], v158
s_waitcnt lgkmcnt(7)
ds_read_u16 v104, v104
v_add_u32_sdwa v86, s42, v135 dst_sel:DWORD dst_unused:UNUSED_PAD src0_sel:DWORD src1_sel:WORD_0
v_smfmac_f32_16x16x64_bf16 v[8:11], a[216:219], v[92:99], v162
s_mov_b32 s46, s48
ds_read_u16 v105, v105
v_add_u32_sdwa v87, s42, v135 dst_sel:DWORD dst_unused:UNUSED_PAD src0_sel:DWORD src1_sel:WORD_1
v_smfmac_f32_16x16x64_bf16 v[24:27], a[160:163], v[44:51], v156
s_add_u32 m0, s44, 0
ds_read_u16 v106, v106
v_add_u32_sdwa v88, s42, v136 dst_sel:DWORD dst_unused:UNUSED_PAD src0_sel:DWORD src1_sel:WORD_0
v_smfmac_f32_16x16x64_bf16 v[24:27], a[196:199], v[52:59], v160
buffer_load_dwordx4 v3, s[16:19], s45 offen offset:0 nt lds
v_add_u32_sdwa v89, s42, v136 dst_sel:DWORD dst_unused:UNUSED_PAD src0_sel:DWORD src1_sel:WORD_1
v_smfmac_f32_16x16x64_bf16 v[24:27], a[232:235], v[92:99], v164
s_waitcnt lgkmcnt(5)
ds_read_u16 v107, v107
v_add_u32_sdwa v90, s42, v137 dst_sel:DWORD dst_unused:UNUSED_PAD src0_sel:DWORD src1_sel:WORD_0
v_smfmac_f32_16x16x64_bf16 v[24:27], v[114:117], v[76:83], v182
s_mov_b32 s48, s49
ds_read_u16 v84, v84
v_add_u32_sdwa v91, s42, v137 dst_sel:DWORD dst_unused:UNUSED_PAD src0_sel:DWORD src1_sel:WORD_1
v_smfmac_f32_16x16x64_bf16 v[28:31], v[114:117], v[76:83], v182 abid:1
s_mov_b32 s49, s50
ds_read_b128 v[114:117], v2 offset:256
v_add_u32_sdwa v76, s4, v118 dst_sel:DWORD dst_unused:UNUSED_PAD src0_sel:DWORD src1_sel:WORD_0
v_smfmac_f32_16x16x64_bf16 v[28:31], a[164:167], v[44:51], v156 abid:1
s_add_u32 s50, s50, 4718592
ds_read_u16 v85, v85
v_add_u32_sdwa v77, s4, v118 dst_sel:DWORD dst_unused:UNUSED_PAD src0_sel:DWORD src1_sel:WORD_1
v_smfmac_f32_16x16x64_bf16 v[28:31], a[200:203], v[52:59], v160 abid:1
ds_read_u16 v86, v86
v_add_u32_sdwa v78, s4, v119 dst_sel:DWORD dst_unused:UNUSED_PAD src0_sel:DWORD src1_sel:WORD_0
v_smfmac_f32_16x16x64_bf16 v[28:31], a[236:239], v[92:99], v164 abid:1
ds_read_u16 v87, v87
v_add_u32_sdwa v79, s4, v119 dst_sel:DWORD dst_unused:UNUSED_PAD src0_sel:DWORD src1_sel:WORD_1
v_smfmac_f32_16x16x64_bf16 v[12:15], a[148:151], v[44:51], v154 abid:1
s_add_u32 m0, s44, 3840
ds_read_u16 v88, v88
v_add_u32_sdwa v80, s4, v120 dst_sel:DWORD dst_unused:UNUSED_PAD src0_sel:DWORD src1_sel:WORD_0
v_smfmac_f32_16x16x64_bf16 v[12:15], a[184:187], v[52:59], v158 abid:1
buffer_load_dwordx4 v3, s[16:19], s45 offen offset:256 nt lds
v_add_u32_sdwa v81, s4, v120 dst_sel:DWORD dst_unused:UNUSED_PAD src0_sel:DWORD src1_sel:WORD_1
v_smfmac_f32_16x16x64_bf16 v[12:15], a[220:223], v[92:99], v162 abid:1
ds_read_b128 v[60:63], v0 offset:14336
v_add_u32_sdwa v82, s4, v121 dst_sel:DWORD dst_unused:UNUSED_PAD src0_sel:DWORD src1_sel:WORD_0
v_smfmac_f32_16x16x64_bf16 v[32:35], a[168:171], v[44:51], v157
ds_read_u16 v89, v89
v_add_u32_sdwa v83, s4, v121 dst_sel:DWORD dst_unused:UNUSED_PAD src0_sel:DWORD src1_sel:WORD_1
v_smfmac_f32_16x16x64_bf16 v[32:35], a[204:207], v[52:59], v161
ds_read_b128 v[64:67], v1 offset:14336
v_smfmac_f32_16x16x64_bf16 v[32:35], a[240:243], v[92:99], v165
s_waitcnt lgkmcnt(7)
ds_read_b128 v[68:71], v0 offset:16384
v_smfmac_f32_16x16x64_bf16 v[32:35], v[114:117], v[100:107], v183 abid:1
ds_read_u16 v90, v90
v_smfmac_f32_16x16x64_bf16 v[36:39], v[114:117], v[100:107], v184
ds_read_b128 v[72:75], v1 offset:16384
v_add_u32 v0, s43, v0
v_smfmac_f32_16x16x64_bf16 v[36:39], a[172:175], v[44:51], v157 abid:1
s_add_u32 m0, s44, 7680
ds_read_u16 v91, v91
v_add_u32 v1, s43, v1
v_smfmac_f32_16x16x64_bf16 v[36:39], a[208:211], v[52:59], v161 abid:1
buffer_load_dwordx4 v3, s[16:19], s45 offen offset:512 nt lds
v_smfmac_f32_16x16x64_bf16 v[36:39], a[244:247], v[92:99], v165 abid:1
ds_read_b128 v[114:117], v2 offset:320
v_smfmac_f32_16x16x64_bf16 v[16:19], a[152:155], v[44:51], v155
s_add_u32 m0, s44, 11520
v_smfmac_f32_16x16x64_bf16 v[16:19], a[188:191], v[52:59], v159
buffer_load_dwordx4 v3, s[16:19], s45 offen offset:768 nt lds
v_smfmac_f32_16x16x64_bf16 v[16:19], a[224:227], v[92:99], v163
v_smfmac_f32_16x16x64_bf16 v[20:23], a[156:159], v[44:51], v155 abid:1
s_add_u32 m0, s44, s8
v_smfmac_f32_16x16x64_bf16 v[20:23], a[192:195], v[52:59], v159 abid:1
s_mov_b64 exec, s[10:11]
buffer_load_dwordx4 v3, s[16:19], s7 offen offset:896 nt lds
s_mov_b64 exec, -1
v_smfmac_f32_16x16x64_bf16 v[20:23], a[228:231], v[92:99], v163 abid:1
s_add_u32 s45, s45, 4718592
s_add_u32 s7, s7, 4718592
s_add_u32 s44, s44, s5
v_smfmac_f32_16x16x64_bf16 v[40:43], a[176:179], v[44:51], v176
s_cmp_ge_u32 s44, 148480
s_cselect_b32 s44, s9, s44
s_bitcmp1_b32 s92, s41
v_smfmac_f32_16x16x64_bf16 v[40:43], a[212:215], v[52:59], v176 abid:1
s_cbranch_scc1 L_loop_w
L_loop_wb:
v_smfmac_f32_16x16x64_bf16 v[40:43], a[248:251], v[92:99], v177
s_waitcnt lgkmcnt(0)
v_smfmac_f32_16x16x64_bf16 v[40:43], v[114:117], v[84:91], v185
s_waitcnt vmcnt(20)
s_barrier
v_smfmac_f32_16x16x64_bf16 v[8:11], a[252:255], v[60:67], v166
s_mov_b32 s42, s4
v_smfmac_f32_16x16x64_bf16 v[8:11], v[218:221], v[68:75], v170
ds_read_b128 v[44:47], v0 offset:0
v_add_u32_sdwa v84, s42, v122 dst_sel:DWORD dst_unused:UNUSED_PAD src0_sel:DWORD src1_sel:WORD_0
v_smfmac_f32_16x16x64_bf16 v[12:15], v[186:189], v[60:67], v166 abid:1
ds_read_b128 v[48:51], v1 offset:0
v_add_u32_sdwa v85, s42, v122 dst_sel:DWORD dst_unused:UNUSED_PAD src0_sel:DWORD src1_sel:WORD_1
v_smfmac_f32_16x16x64_bf16 v[12:15], v[222:225], v[68:75], v170 abid:1
ds_read_b128 v[52:55], v0 offset:2048
v_add_u32_sdwa v86, s42, v123 dst_sel:DWORD dst_unused:UNUSED_PAD src0_sel:DWORD src1_sel:WORD_0
v_smfmac_f32_16x16x64_bf16 v[16:19], v[190:193], v[60:67], v167
ds_read_b128 v[56:59], v1 offset:2048
v_cvt_pk_bf16_f32 v92, v8, v9
v_smfmac_f32_16x16x64_bf16 v[16:19], v[226:229], v[68:75], v171
ds_read_u16 v76, v76
v_cvt_pk_bf16_f32 v93, v10, v11
v_smfmac_f32_16x16x64_bf16 v[20:23], v[194:197], v[60:67], v167 abid:1
ds_read_b128 v[8:11], v2 offset:1024
v_cvt_pk_bf16_f32 v94, v12, v13
v_smfmac_f32_16x16x64_bf16 v[20:23], v[230:233], v[68:75], v171 abid:1
ds_read_u16 v77, v77
v_cvt_pk_bf16_f32 v95, v14, v15
v_smfmac_f32_16x16x64_bf16 v[24:27], v[198:201], v[60:67], v168
ds_read_b128 v[12:15], v2 offset:1088
v_cvt_pk_bf16_f32 v96, v16, v17
v_smfmac_f32_16x16x64_bf16 v[24:27], v[234:237], v[68:75], v172
ds_read_u16 v78, v78
v_cvt_pk_bf16_f32 v97, v18, v19
v_smfmac_f32_16x16x64_bf16 v[28:31], v[202:205], v[60:67], v168 abid:1
ds_read_b128 v[16:19], v2 offset:1152
v_cvt_pk_bf16_f32 v98, v20, v21
v_smfmac_f32_16x16x64_bf16 v[28:31], v[238:241], v[68:75], v172 abid:1
ds_read_u16 v79, v79
v_cvt_pk_bf16_f32 v99, v22, v23
v_smfmac_f32_16x16x64_bf16 v[32:35], v[206:209], v[60:67], v169
ds_read_b128 v[20:23], v2 offset:1216
v_cvt_pk_bf16_f32 v100, v24, v25
v_smfmac_f32_16x16x64_bf16 v[32:35], v[242:245], v[68:75], v173
ds_read_u16 v80, v80
v_cvt_pk_bf16_f32 v101, v26, v27
v_smfmac_f32_16x16x64_bf16 v[36:39], v[210:213], v[60:67], v169 abid:1
ds_read_b128 v[24:27], v2 offset:1280
v_cvt_pk_bf16_f32 v102, v28, v29
v_smfmac_f32_16x16x64_bf16 v[36:39], v[246:249], v[68:75], v173 abid:1
ds_read_u16 v81, v81
v_cvt_pk_bf16_f32 v103, v30, v31
v_smfmac_f32_16x16x64_bf16 v[40:43], v[214:217], v[60:67], v177 abid:1
s_bitcmp1_b32 s85, s41
ds_read_b128 v[28:31], v2 offset:1344
v_cvt_pk_bf16_f32 v104, v32, v33
v_smfmac_f32_16x16x64_bf16 v[40:43], v[250:253], v[68:75], v178
s_waitcnt lgkmcnt(10)
v_cvt_pk_bf16_f32 v105, v34, v35
s_cbranch_scc1 L_loop
s_cmp_lg_u32 s41, 6
s_cbranch_scc1 L_loopn
.p2align 3
L_loopc:
v_smfmac_f32_16x16x64_bf16 v[8:11], a[0:3], v[44:51], v138
ds_read_b128 v[32:35], v2 offset:1408
v_cvt_pk_bf16_f32 v106, v36, v37
v_mov_b32 v7, 1
v_smfmac_f32_16x16x64_bf16 v[8:11], a[36:39], v[52:59], v142
s_waitcnt lgkmcnt(9)
buffer_atomic_add v7, v6, s[32:35], 0 offen sc0 sc1
v_cvt_pk_bf16_f32 v107, v38, v39
v_smfmac_f32_16x16x64_bf16 v[12:15], a[4:7], v[44:51], v138 abid:1
ds_read_b128 v[36:39], v2 offset:1472
v_cvt_pk_bf16_f32 v112, v40, v41
v_smfmac_f32_16x16x64_bf16 v[12:15], a[40:43], v[52:59], v142 abid:1
s_waitcnt lgkmcnt(8)
ds_read_b128 v[60:63], v0 offset:4096
v_cvt_pk_bf16_f32 v113, v42, v43
v_smfmac_f32_16x16x64_bf16 v[16:19], a[8:11], v[44:51], v139
s_cmp_eq_u32 s4, 129920
ds_read_b128 v[40:43], v2 offset:1536
v_cndmask_b32_dpp v108, v96, v92, vcc quad_perm:[1,0,3,2] row_mask:0xf bank_mask:0xf
v_smfmac_f32_16x16x64_bf16 v[16:19], a[44:47], v[52:59], v143
s_waitcnt lgkmcnt(8)
ds_read_u16 v82, v82
v_cndmask_b32_dpp v109, v97, v93, vcc quad_perm:[1,0,3,2] row_mask:0xf bank_mask:0xf
v_smfmac_f32_16x16x64_bf16 v[20:23], a[12:15], v[44:51], v139 abid:1
s_cselect_b32 s43, -129920, s5
ds_read_u16 v84, v84
v_cndmask_b32_dpp v110, v98, v94, vcc quad_perm:[1,0,3,2] row_mask:0xf bank_mask:0xf
v_smfmac_f32_16x16x64_bf16 v[20:23], a[48:51], v[52:59], v143 abid:1
s_waitcnt lgkmcnt(8)
ds_read_b128 v[64:67], v1 offset:4096
v_cndmask_b32_dpp v111, v99, v95, vcc quad_perm:[1,0,3,2] row_mask:0xf bank_mask:0xf
v_smfmac_f32_16x16x64_bf16 v[24:27], a[16:19], v[44:51], v140
s_add_u32 s4, s4, s43
ds_read_b128 v[68:71], v0 offset:6144
v_add_u32_sdwa v87, s42, v123 dst_sel:DWORD dst_unused:UNUSED_PAD src0_sel:DWORD src1_sel:WORD_1
v_smfmac_f32_16x16x64_bf16 v[24:27], a[52:55], v[52:59], v144
buffer_store_dwordx4 v[108:111], v4, s[20:23], s46 offen offset:0 sc1
s_mov_b64 vcc, s[82:83]
s_waitcnt lgkmcnt(8)
ds_read_b128 v[72:75], v1 offset:6144
v_cndmask_b32_dpp v96, v92, v96, vcc quad_perm:[1,0,3,2] row_mask:0xf bank_mask:0xf
v_cndmask_b32_dpp v97, v93, v97, vcc quad_perm:[1,0,3,2] row_mask:0xf bank_mask:0xf
v_smfmac_f32_16x16x64_bf16 v[28:31], a[20:23], v[44:51], v140 abid:1
s_add_u32 s7, s45, s58
ds_read_u16 v83, v83
v_cndmask_b32_dpp v98, v94, v98, vcc quad_perm:[1,0,3,2] row_mask:0xf bank_mask:0xf
v_smfmac_f32_16x16x64_bf16 v[28:31], a[56:59], v[52:59], v144 abid:1
s_waitcnt lgkmcnt(9)
ds_read_b128 v[114:117], v2 offset:64
v_cndmask_b32_dpp v99, v95, v99, vcc quad_perm:[1,0,3,2] row_mask:0xf bank_mask:0xf
v_smfmac_f32_16x16x64_bf16 v[32:35], a[24:27], v[44:51], v141
ds_read_u16 v85, v85
v_add_u32_sdwa v88, s42, v124 dst_sel:DWORD dst_unused:UNUSED_PAD src0_sel:DWORD src1_sel:WORD_0
v_smfmac_f32_16x16x64_bf16 v[32:35], a[60:63], v[52:59], v145
s_waitcnt lgkmcnt(10)
ds_read_u16 v86, v86
v_add_u32_sdwa v89, s42, v124 dst_sel:DWORD dst_unused:UNUSED_PAD src0_sel:DWORD src1_sel:WORD_1
v_smfmac_f32_16x16x64_bf16 v[36:39], a[28:31], v[44:51], v141 abid:1
ds_read_u16 v87, v87
v_add_u32_sdwa v90, s42, v125 dst_sel:DWORD dst_unused:UNUSED_PAD src0_sel:DWORD src1_sel:WORD_0
v_smfmac_f32_16x16x64_bf16 v[36:39], a[64:67], v[52:59], v145 abid:1
s_waitcnt lgkmcnt(10)
ds_read_u16 v88, v88
v_add_u32_sdwa v91, s42, v125 dst_sel:DWORD dst_unused:UNUSED_PAD src0_sel:DWORD src1_sel:WORD_1
v_smfmac_f32_16x16x64_bf16 v[40:43], a[32:35], v[44:51], v174
buffer_store_dwordx4 v[96:99], v4, s[20:23], s46 offen offset:1152 sc1
s_mov_b64 vcc, s[80:81]
ds_read_u16 v89, v89
v_cndmask_b32_dpp v92, v104, v100, vcc quad_perm:[1,0,3,2] row_mask:0xf bank_mask:0xf
v_cndmask_b32_dpp v93, v105, v101, vcc quad_perm:[1,0,3,2] row_mask:0xf bank_mask:0xf
v_smfmac_f32_16x16x64_bf16 v[40:43], a[68:71], v[52:59], v174 abid:1
s_waitcnt lgkmcnt(9)
ds_read_u16 v90, v90
v_cndmask_b32_dpp v94, v106, v102, vcc quad_perm:[1,0,3,2] row_mask:0xf bank_mask:0xf
v_smfmac_f32_16x16x64_bf16 v[8:11], a[72:75], v[60:67], v146
s_waitcnt lgkmcnt(8)
ds_read_u16 v91, v91
v_cndmask_b32_dpp v95, v107, v103, vcc quad_perm:[1,0,3,2] row_mask:0xf bank_mask:0xf
v_smfmac_f32_16x16x64_bf16 v[8:11], a[108:111], v[68:75], v150
s_waitcnt lgkmcnt(7)
ds_bpermute_b32 v112, v6, v112
v_smfmac_f32_16x16x64_bf16 v[8:11], v[114:117], v[76:83], v179
ds_bpermute_b32 v113, v6, v113
v_smfmac_f32_16x16x64_bf16 v[12:15], v[114:117], v[76:83], v179 abid:1
ds_read_b128 v[114:117], v2 offset:128
v_add_u32_sdwa v76, s42, v126 dst_sel:DWORD dst_unused:UNUSED_PAD src0_sel:DWORD src1_sel:WORD_0
v_smfmac_f32_16x16x64_bf16 v[12:15], a[76:79], v[60:67], v146 abid:1
ds_read_u16 v76, v76
v_add_u32_sdwa v77, s42, v126 dst_sel:DWORD dst_unused:UNUSED_PAD src0_sel:DWORD src1_sel:WORD_1
v_smfmac_f32_16x16x64_bf16 v[12:15], a[112:115], v[68:75], v150 abid:1
buffer_store_dwordx4 v[92:95], v4, s[20:23], s46 offen offset:128 sc1
s_mov_b64 vcc, s[82:83]
ds_read_u16 v77, v77
v_cndmask_b32_dpp v104, v100, v104, vcc quad_perm:[1,0,3,2] row_mask:0xf bank_mask:0xf
v_add_u32_sdwa v78, s42, v127 dst_sel:DWORD dst_unused:UNUSED_PAD src0_sel:DWORD src1_sel:WORD_0
v_smfmac_f32_16x16x64_bf16 v[24:27], a[88:91], v[60:67], v148
ds_read_u16 v78, v78
v_cndmask_b32_dpp v105, v101, v105, vcc quad_perm:[1,0,3,2] row_mask:0xf bank_mask:0xf
v_smfmac_f32_16x16x64_bf16 v[24:27], a[124:127], v[68:75], v152
ds_read_b128 v[44:47], v0 offset:8192
v_cndmask_b32_dpp v106, v102, v106, vcc quad_perm:[1,0,3,2] row_mask:0xf bank_mask:0xf
v_smfmac_f32_16x16x64_bf16 v[28:31], a[92:95], v[60:67], v148 abid:1
ds_read_b128 v[48:51], v1 offset:8192
v_add_u32_sdwa v79, s42, v127 dst_sel:DWORD dst_unused:UNUSED_PAD src0_sel:DWORD src1_sel:WORD_1
v_smfmac_f32_16x16x64_bf16 v[28:31], a[128:131], v[68:75], v152 abid:1
ds_read_u16 v79, v79
v_cndmask_b32_dpp v107, v103, v107, vcc quad_perm:[1,0,3,2] row_mask:0xf bank_mask:0xf
v_smfmac_f32_16x16x64_bf16 v[32:35], a[96:99], v[60:67], v149
ds_read_b128 v[52:55], v0 offset:10240
v_add_u32_sdwa v80, s42, v128 dst_sel:DWORD dst_unused:UNUSED_PAD src0_sel:DWORD src1_sel:WORD_0
v_smfmac_f32_16x16x64_bf16 v[32:35], a[132:135], v[68:75], v153
ds_read_u16 v80, v80
v_add_u32_sdwa v81, s42, v128 dst_sel:DWORD dst_unused:UNUSED_PAD src0_sel:DWORD src1_sel:WORD_1
v_smfmac_f32_16x16x64_bf16 v[16:19], a[80:83], v[60:67], v147
buffer_store_dwordx4 v[104:107], v4, s[20:23], s46 offen offset:1280 sc1
s_mov_b64 vcc, s[80:81]
ds_read_b128 v[56:59], v1 offset:10240
v_add_u32_sdwa v82, s42, v129 dst_sel:DWORD dst_unused:UNUSED_PAD src0_sel:DWORD src1_sel:WORD_0
v_add_u32_sdwa v83, s42, v129 dst_sel:DWORD dst_unused:UNUSED_PAD src0_sel:DWORD src1_sel:WORD_1
v_smfmac_f32_16x16x64_bf16 v[16:19], a[116:119], v[68:75], v151
s_waitcnt lgkmcnt(9)
ds_read_b128 v[92:95], v0 offset:12288
v_add_u32_sdwa v100, s42, v130 dst_sel:DWORD dst_unused:UNUSED_PAD src0_sel:DWORD src1_sel:WORD_0
v_smfmac_f32_16x16x64_bf16 v[16:19], v[114:117], v[84:91], v180 abid:1
ds_read_u16 v81, v81
v_add_u32_sdwa v101, s42, v130 dst_sel:DWORD dst_unused:UNUSED_PAD src0_sel:DWORD src1_sel:WORD_1
v_smfmac_f32_16x16x64_bf16 v[20:23], v[114:117], v[84:91], v181
ds_read_b128 v[96:99], v1 offset:12288
v_add_u32_sdwa v102, s42, v131 dst_sel:DWORD dst_unused:UNUSED_PAD src0_sel:DWORD src1_sel:WORD_0
v_smfmac_f32_16x16x64_bf16 v[20:23], a[84:87], v[60:67], v147 abid:1
ds_read_u16 v100, v100
v_add_u32_sdwa v103, s42, v131 dst_sel:DWORD dst_unused:UNUSED_PAD src0_sel:DWORD src1_sel:WORD_1
v_smfmac_f32_16x16x64_bf16 v[20:23], a[120:123], v[68:75], v151 abid:1
ds_read_u16 v82, v82
v_add_u32_sdwa v104, s42, v132 dst_sel:DWORD dst_unused:UNUSED_PAD src0_sel:DWORD src1_sel:WORD_0
v_smfmac_f32_16x16x64_bf16 v[36:39], a[100:103], v[60:67], v149 abid:1
ds_read_u16 v101, v101
v_add_u32_sdwa v105, s42, v132 dst_sel:DWORD dst_unused:UNUSED_PAD src0_sel:DWORD src1_sel:WORD_1
v_smfmac_f32_16x16x64_bf16 v[36:39], a[136:139], v[68:75], v153 abid:1
buffer_store_dwordx2 v[112:113], v5, s[20:23], s46 offen
ds_read_u16 v83, v83
v_add_u32_sdwa v106, s42, v133 dst_sel:DWORD dst_unused:UNUSED_PAD src0_sel:DWORD src1_sel:WORD_0
v_smfmac_f32_16x16x64_bf16 v[40:43], a[104:107], v[60:67], v175
s_mov_b32 s46, s48
ds_read_b128 v[114:117], v2 offset:192
v_add_u32_sdwa v107, s42, v133 dst_sel:DWORD dst_unused:UNUSED_PAD src0_sel:DWORD src1_sel:WORD_1
v_smfmac_f32_16x16x64_bf16 v[40:43], a[140:143], v[68:75], v175 abid:1
s_waitcnt lgkmcnt(12)
ds_read_u16 v102, v102
v_add_u32_sdwa v84, s42, v134 dst_sel:DWORD dst_unused:UNUSED_PAD src0_sel:DWORD src1_sel:WORD_0
v_smfmac_f32_16x16x64_bf16 v[8:11], a[144:147], v[44:51], v154
s_waitcnt lgkmcnt(9)
ds_read_u16 v103, v103
v_add_u32_sdwa v85, s42, v134 dst_sel:DWORD dst_unused:UNUSED_PAD src0_sel:DWORD src1_sel:WORD_1
v_smfmac_f32_16x16x64_bf16 v[8:11], a[180:183], v[52:59], v158
s_waitcnt lgkmcnt(7)
ds_read_u16 v104, v104
v_add_u32_sdwa v86, s42, v135 dst_sel:DWORD dst_unused:UNUSED_PAD src0_sel:DWORD src1_sel:WORD_0
v_smfmac_f32_16x16x64_bf16 v[8:11], a[216:219], v[92:99], v162
s_mov_b32 s48, s49
ds_read_u16 v105, v105
v_add_u32_sdwa v87, s42, v135 dst_sel:DWORD dst_unused:UNUSED_PAD src0_sel:DWORD src1_sel:WORD_1
v_smfmac_f32_16x16x64_bf16 v[24:27], a[160:163], v[44:51], v156
s_add_u32 m0, s44, 0
ds_read_u16 v106, v106
v_add_u32_sdwa v88, s42, v136 dst_sel:DWORD dst_unused:UNUSED_PAD src0_sel:DWORD src1_sel:WORD_0
v_smfmac_f32_16x16x64_bf16 v[24:27], a[196:199], v[52:59], v160
buffer_load_dwordx4 v3, s[16:19], s45 offen offset:0 nt lds
v_add_u32_sdwa v89, s42, v136 dst_sel:DWORD dst_unused:UNUSED_PAD src0_sel:DWORD src1_sel:WORD_1
v_smfmac_f32_16x16x64_bf16 v[24:27], a[232:235], v[92:99], v164
s_waitcnt lgkmcnt(5)
ds_read_u16 v107, v107
v_add_u32_sdwa v90, s42, v137 dst_sel:DWORD dst_unused:UNUSED_PAD src0_sel:DWORD src1_sel:WORD_0
v_smfmac_f32_16x16x64_bf16 v[24:27], v[114:117], v[76:83], v182
s_waitcnt vmcnt(6)
ds_read_u16 v84, v84
v_add_u32_sdwa v91, s42, v137 dst_sel:DWORD dst_unused:UNUSED_PAD src0_sel:DWORD src1_sel:WORD_1
v_smfmac_f32_16x16x64_bf16 v[28:31], v[114:117], v[76:83], v182 abid:1
s_mov_b32 s49, s50
ds_read_b128 v[114:117], v2 offset:256
v_add_u32_sdwa v76, s4, v118 dst_sel:DWORD dst_unused:UNUSED_PAD src0_sel:DWORD src1_sel:WORD_0
v_smfmac_f32_16x16x64_bf16 v[28:31], a[164:167], v[44:51], v156 abid:1
s_mov_b32 s50, s45
ds_read_u16 v85, v85
v_add_u32_sdwa v77, s4, v118 dst_sel:DWORD dst_unused:UNUSED_PAD src0_sel:DWORD src1_sel:WORD_1
v_smfmac_f32_16x16x64_bf16 v[28:31], a[200:203], v[52:59], v160 abid:1
ds_read_u16 v86, v86
v_add_u32_sdwa v78, s4, v119 dst_sel:DWORD dst_unused:UNUSED_PAD src0_sel:DWORD src1_sel:WORD_0
v_smfmac_f32_16x16x64_bf16 v[28:31], a[236:239], v[92:99], v164 abid:1
ds_read_u16 v87, v87
v_add_u32_sdwa v79, s4, v119 dst_sel:DWORD dst_unused:UNUSED_PAD src0_sel:DWORD src1_sel:WORD_1
v_smfmac_f32_16x16x64_bf16 v[12:15], a[148:151], v[44:51], v154 abid:1
s_add_u32 m0, s44, 3840
ds_read_u16 v88, v88
v_add_u32_sdwa v80, s4, v120 dst_sel:DWORD dst_unused:UNUSED_PAD src0_sel:DWORD src1_sel:WORD_0
v_smfmac_f32_16x16x64_bf16 v[12:15], a[184:187], v[52:59], v158 abid:1
buffer_load_dwordx4 v3, s[16:19], s45 offen offset:256 nt lds
v_add_u32_sdwa v81, s4, v120 dst_sel:DWORD dst_unused:UNUSED_PAD src0_sel:DWORD src1_sel:WORD_1
v_smfmac_f32_16x16x64_bf16 v[12:15], a[220:223], v[92:99], v162 abid:1
ds_read_b128 v[60:63], v0 offset:14336
v_add_u32_sdwa v82, s4, v121 dst_sel:DWORD dst_unused:UNUSED_PAD src0_sel:DWORD src1_sel:WORD_0
v_smfmac_f32_16x16x64_bf16 v[32:35], a[168:171], v[44:51], v157
ds_read_u16 v89, v89
v_add_u32_sdwa v83, s4, v121 dst_sel:DWORD dst_unused:UNUSED_PAD src0_sel:DWORD src1_sel:WORD_1
v_smfmac_f32_16x16x64_bf16 v[32:35], a[204:207], v[52:59], v161
ds_read_b128 v[64:67], v1 offset:14336
v_smfmac_f32_16x16x64_bf16 v[32:35], a[240:243], v[92:99], v165
s_waitcnt lgkmcnt(7)
ds_read_b128 v[68:71], v0 offset:16384
v_smfmac_f32_16x16x64_bf16 v[32:35], v[114:117], v[100:107], v183 abid:1
ds_read_u16 v90, v90
v_smfmac_f32_16x16x64_bf16 v[36:39], v[114:117], v[100:107], v184
ds_read_b128 v[72:75], v1 offset:16384
v_add_u32 v0, s43, v0
v_smfmac_f32_16x16x64_bf16 v[36:39], a[172:175], v[44:51], v157 abid:1
s_add_u32 m0, s44, 7680
ds_read_u16 v91, v91
v_add_u32 v1, s43, v1
v_smfmac_f32_16x16x64_bf16 v[36:39], a[208:211], v[52:59], v161 abid:1
buffer_load_dwordx4 v3, s[16:19], s45 offen offset:512 nt lds
v_smfmac_f32_16x16x64_bf16 v[36:39], a[244:247], v[92:99], v165 abid:1
ds_read_b128 v[114:117], v2 offset:320
v_smfmac_f32_16x16x64_bf16 v[16:19], a[152:155], v[44:51], v155
s_add_u32 m0, s44, 11520
v_smfmac_f32_16x16x64_bf16 v[16:19], a[188:191], v[52:59], v159
buffer_load_dwordx4 v3, s[16:19], s45 offen offset:768 nt lds
v_smfmac_f32_16x16x64_bf16 v[16:19], a[224:227], v[92:99], v163
s_mov_b64 exec, s[62:63]
ds_write_b32 v0, v7 offset:18432
s_mov_b64 exec, -1
v_smfmac_f32_16x16x64_bf16 v[20:23], a[156:159], v[44:51], v155 abid:1
s_add_u32 m0, s44, s8
v_smfmac_f32_16x16x64_bf16 v[20:23], a[192:195], v[52:59], v159 abid:1
s_mov_b64 exec, s[10:11]
buffer_load_dwordx4 v3, s[16:19], s7 offen offset:896 nt lds
s_mov_b64 exec, -1
v_smfmac_f32_16x16x64_bf16 v[20:23], a[228:231], v[92:99], v163 abid:1
s_add_u32 s44, s44, s5
s_cmp_ge_u32 s44, 148480
s_cselect_b32 s44, s9, s44
v_smfmac_f32_16x16x64_bf16 v[40:43], a[176:179], v[44:51], v176
v_smfmac_f32_16x16x64_bf16 v[40:43], a[212:215], v[52:59], v176 abid:1
v_smfmac_f32_16x16x64_bf16 v[40:43], a[248:251], v[92:99], v177
s_waitcnt lgkmcnt(0)
v_smfmac_f32_16x16x64_bf16 v[40:43], v[114:117], v[84:91], v185
s_barrier
v_smfmac_f32_16x16x64_bf16 v[8:11], a[252:255], v[60:67], v166
s_mov_b32 s42, s4
ds_read_b32 v7, v0 offset:18432
v_smfmac_f32_16x16x64_bf16 v[8:11], v[218:221], v[68:75], v170
ds_read_b128 v[44:47], v0 offset:0
v_add_u32_sdwa v84, s42, v122 dst_sel:DWORD dst_unused:UNUSED_PAD src0_sel:DWORD src1_sel:WORD_0
v_smfmac_f32_16x16x64_bf16 v[12:15], v[186:189], v[60:67], v166 abid:1
ds_read_b128 v[48:51], v1 offset:0
v_add_u32_sdwa v85, s42, v122 dst_sel:DWORD dst_unused:UNUSED_PAD src0_sel:DWORD src1_sel:WORD_1
v_smfmac_f32_16x16x64_bf16 v[12:15], v[222:225], v[68:75], v170 abid:1
ds_read_b128 v[52:55], v0 offset:2048
v_add_u32_sdwa v86, s42, v123 dst_sel:DWORD dst_unused:UNUSED_PAD src0_sel:DWORD src1_sel:WORD_0
v_smfmac_f32_16x16x64_bf16 v[16:19], v[190:193], v[60:67], v167
ds_read_b128 v[56:59], v1 offset:2048
v_cvt_pk_bf16_f32 v92, v8, v9
v_smfmac_f32_16x16x64_bf16 v[16:19], v[226:229], v[68:75], v171
ds_read_u16 v76, v76
v_cvt_pk_bf16_f32 v93, v10, v11
v_smfmac_f32_16x16x64_bf16 v[20:23], v[194:197], v[60:67], v167 abid:1
ds_read_b128 v[8:11], v2 offset:1024
v_cvt_pk_bf16_f32 v94, v12, v13
v_smfmac_f32_16x16x64_bf16 v[20:23], v[230:233], v[68:75], v171 abid:1
ds_read_u16 v77, v77
v_cvt_pk_bf16_f32 v95, v14, v15
v_smfmac_f32_16x16x64_bf16 v[24:27], v[198:201], v[60:67], v168
ds_read_b128 v[12:15], v2 offset:1088
v_cvt_pk_bf16_f32 v96, v16, v17
v_smfmac_f32_16x16x64_bf16 v[24:27], v[234:237], v[68:75], v172
s_waitcnt lgkmcnt(8)
ds_read_u16 v78, v78
v_cvt_pk_bf16_f32 v97, v18, v19
v_readfirstlane_b32 s56, v7
v_smfmac_f32_16x16x64_bf16 v[28:31], v[202:205], v[60:67], v168 abid:1
s_lshr_b32 s60, s56, 5
ds_read_b128 v[16:19], v2 offset:1152
v_cvt_pk_bf16_f32 v98, v20, v21
v_smfmac_f32_16x16x64_bf16 v[28:31], v[238:241], v[68:75], v172 abid:1
s_mul_i32 s60, s60, 4128768
ds_read_u16 v79, v79
v_cvt_pk_bf16_f32 v99, v22, v23
v_smfmac_f32_16x16x64_bf16 v[32:35], v[206:209], v[60:67], v169
s_mul_i32 s61, s56, 18432
ds_read_b128 v[20:23], v2 offset:1216
v_cvt_pk_bf16_f32 v100, v24, v25
v_smfmac_f32_16x16x64_bf16 v[32:35], v[242:245], v[68:75], v173
s_add_u32 s60, s60, s57
ds_read_u16 v80, v80
v_cvt_pk_bf16_f32 v101, v26, v27
v_smfmac_f32_16x16x64_bf16 v[36:39], v[210:213], v[60:67], v169 abid:1
s_add_u32 s45, s60, s61
ds_read_b128 v[24:27], v2 offset:1280
v_cvt_pk_bf16_f32 v102, v28, v29
v_smfmac_f32_16x16x64_bf16 v[36:39], v[246:249], v[68:75], v173 abid:1
ds_read_u16 v81, v81
v_cvt_pk_bf16_f32 v103, v30, v31
v_smfmac_f32_16x16x64_bf16 v[40:43], v[214:217], v[60:67], v177 abid:1
s_cmp_lt_u32 s56, 192
ds_read_b128 v[28:31], v2 offset:1344
v_cvt_pk_bf16_f32 v104, v32, v33
v_smfmac_f32_16x16x64_bf16 v[40:43], v[250:253], v[68:75], v178
s_waitcnt lgkmcnt(10)
v_cvt_pk_bf16_f32 v105, v34, v35
s_cbranch_scc1 L_loopc
s_mov_b32 s41, 0
s_mov_b32 s15, 3
s_mov_b32 s12, 7
s_mov_b32 s92, 4
s_mov_b32 s87, 4
s_mov_b32 s59, -1
.p2align 3
L_loopn:
v_smfmac_f32_16x16x64_bf16 v[8:11], a[0:3], v[44:51], v138
ds_read_b128 v[32:35], v2 offset:1408
v_cvt_pk_bf16_f32 v106, v36, v37
v_smfmac_f32_16x16x64_bf16 v[8:11], a[36:39], v[52:59], v142
s_waitcnt lgkmcnt(9)
v_cvt_pk_bf16_f32 v107, v38, v39
v_smfmac_f32_16x16x64_bf16 v[12:15], a[4:7], v[44:51], v138 abid:1
ds_read_b128 v[36:39], v2 offset:1472
v_cvt_pk_bf16_f32 v112, v40, v41
v_smfmac_f32_16x16x64_bf16 v[12:15], a[40:43], v[52:59], v142 abid:1
s_waitcnt lgkmcnt(8)
ds_read_b128 v[60:63], v0 offset:4096
v_cvt_pk_bf16_f32 v113, v42, v43
v_smfmac_f32_16x16x64_bf16 v[16:19], a[8:11], v[44:51], v139
s_cmp_eq_u32 s4, 129920
ds_read_b128 v[40:43], v2 offset:1536
v_cndmask_b32_dpp v108, v96, v92, vcc quad_perm:[1,0,3,2] row_mask:0xf bank_mask:0xf
v_smfmac_f32_16x16x64_bf16 v[16:19], a[44:47], v[52:59], v143
s_waitcnt lgkmcnt(8)
ds_read_u16 v82, v82
v_cndmask_b32_dpp v109, v97, v93, vcc quad_perm:[1,0,3,2] row_mask:0xf bank_mask:0xf
v_smfmac_f32_16x16x64_bf16 v[20:23], a[12:15], v[44:51], v139 abid:1
s_cselect_b32 s43, -129920, s5
ds_read_u16 v84, v84
v_cndmask_b32_dpp v110, v98, v94, vcc quad_perm:[1,0,3,2] row_mask:0xf bank_mask:0xf
v_smfmac_f32_16x16x64_bf16 v[20:23], a[48:51], v[52:59], v143 abid:1
s_waitcnt lgkmcnt(8)
ds_read_b128 v[64:67], v1 offset:4096
v_cndmask_b32_dpp v111, v99, v95, vcc quad_perm:[1,0,3,2] row_mask:0xf bank_mask:0xf
v_smfmac_f32_16x16x64_bf16 v[24:27], a[16:19], v[44:51], v140
s_add_u32 s4, s4, s43
ds_read_b128 v[68:71], v0 offset:6144
v_add_u32_sdwa v87, s42, v123 dst_sel:DWORD dst_unused:UNUSED_PAD src0_sel:DWORD src1_sel:WORD_1
v_smfmac_f32_16x16x64_bf16 v[24:27], a[52:55], v[52:59], v144
buffer_store_dwordx4 v[108:111], v4, s[20:23], s46 offen offset:0 sc1
s_mov_b64 vcc, s[82:83]
s_waitcnt lgkmcnt(8)
ds_read_b128 v[72:75], v1 offset:6144
v_cndmask_b32_dpp v96, v92, v96, vcc quad_perm:[1,0,3,2] row_mask:0xf bank_mask:0xf
v_cndmask_b32_dpp v97, v93, v97, vcc quad_perm:[1,0,3,2] row_mask:0xf bank_mask:0xf
v_smfmac_f32_16x16x64_bf16 v[28:31], a[20:23], v[44:51], v140 abid:1
s_add_u32 s41, s41, 1
ds_read_u16 v83, v83
v_cndmask_b32_dpp v98, v94, v98, vcc quad_perm:[1,0,3,2] row_mask:0xf bank_mask:0xf
v_smfmac_f32_16x16x64_bf16 v[28:31], a[56:59], v[52:59], v144 abid:1
s_waitcnt lgkmcnt(9)
ds_read_b128 v[114:117], v2 offset:64
v_cndmask_b32_dpp v99, v95, v99, vcc quad_perm:[1,0,3,2] row_mask:0xf bank_mask:0xf
v_smfmac_f32_16x16x64_bf16 v[32:35], a[24:27], v[44:51], v141
ds_read_u16 v85, v85
v_add_u32_sdwa v88, s42, v124 dst_sel:DWORD dst_unused:UNUSED_PAD src0_sel:DWORD src1_sel:WORD_0
v_smfmac_f32_16x16x64_bf16 v[32:35], a[60:63], v[52:59], v145
s_waitcnt lgkmcnt(10)
ds_read_u16 v86, v86
v_add_u32_sdwa v89, s42, v124 dst_sel:DWORD dst_unused:UNUSED_PAD src0_sel:DWORD src1_sel:WORD_1
v_smfmac_f32_16x16x64_bf16 v[36:39], a[28:31], v[44:51], v141 abid:1
ds_read_u16 v87, v87
v_add_u32_sdwa v90, s42, v125 dst_sel:DWORD dst_unused:UNUSED_PAD src0_sel:DWORD src1_sel:WORD_0
v_smfmac_f32_16x16x64_bf16 v[36:39], a[64:67], v[52:59], v145 abid:1
s_waitcnt lgkmcnt(10)
ds_read_u16 v88, v88
v_add_u32_sdwa v91, s42, v125 dst_sel:DWORD dst_unused:UNUSED_PAD src0_sel:DWORD src1_sel:WORD_1
v_smfmac_f32_16x16x64_bf16 v[40:43], a[32:35], v[44:51], v174
buffer_store_dwordx4 v[96:99], v4, s[20:23], s46 offen offset:1152 sc1
s_mov_b64 vcc, s[80:81]
ds_read_u16 v89, v89
v_cndmask_b32_dpp v92, v104, v100, vcc quad_perm:[1,0,3,2] row_mask:0xf bank_mask:0xf
v_cndmask_b32_dpp v93, v105, v101, vcc quad_perm:[1,0,3,2] row_mask:0xf bank_mask:0xf
v_smfmac_f32_16x16x64_bf16 v[40:43], a[68:71], v[52:59], v174 abid:1
s_waitcnt lgkmcnt(9)
ds_read_u16 v90, v90
v_cndmask_b32_dpp v94, v106, v102, vcc quad_perm:[1,0,3,2] row_mask:0xf bank_mask:0xf
v_smfmac_f32_16x16x64_bf16 v[8:11], a[72:75], v[60:67], v146
s_waitcnt lgkmcnt(8)
ds_read_u16 v91, v91
v_cndmask_b32_dpp v95, v107, v103, vcc quad_perm:[1,0,3,2] row_mask:0xf bank_mask:0xf
v_smfmac_f32_16x16x64_bf16 v[8:11], a[108:111], v[68:75], v150
s_waitcnt lgkmcnt(7)
ds_bpermute_b32 v112, v6, v112
v_smfmac_f32_16x16x64_bf16 v[8:11], v[114:117], v[76:83], v179
ds_bpermute_b32 v113, v6, v113
v_smfmac_f32_16x16x64_bf16 v[12:15], v[114:117], v[76:83], v179 abid:1
ds_read_b128 v[114:117], v2 offset:128
v_add_u32_sdwa v76, s42, v126 dst_sel:DWORD dst_unused:UNUSED_PAD src0_sel:DWORD src1_sel:WORD_0
v_smfmac_f32_16x16x64_bf16 v[12:15], a[76:79], v[60:67], v146 abid:1
ds_read_u16 v76, v76
v_add_u32_sdwa v77, s42, v126 dst_sel:DWORD dst_unused:UNUSED_PAD src0_sel:DWORD src1_sel:WORD_1
v_smfmac_f32_16x16x64_bf16 v[12:15], a[112:115], v[68:75], v150 abid:1
buffer_store_dwordx4 v[92:95], v4, s[20:23], s46 offen offset:128 sc1
s_mov_b64 vcc, s[82:83]
ds_read_u16 v77, v77
v_cndmask_b32_dpp v104, v100, v104, vcc quad_perm:[1,0,3,2] row_mask:0xf bank_mask:0xf
v_add_u32_sdwa v78, s42, v127 dst_sel:DWORD dst_unused:UNUSED_PAD src0_sel:DWORD src1_sel:WORD_0
v_smfmac_f32_16x16x64_bf16 v[24:27], a[88:91], v[60:67], v148
ds_read_u16 v78, v78
v_cndmask_b32_dpp v105, v101, v105, vcc quad_perm:[1,0,3,2] row_mask:0xf bank_mask:0xf
v_smfmac_f32_16x16x64_bf16 v[24:27], a[124:127], v[68:75], v152
ds_read_b128 v[44:47], v0 offset:8192
v_cndmask_b32_dpp v106, v102, v106, vcc quad_perm:[1,0,3,2] row_mask:0xf bank_mask:0xf
v_smfmac_f32_16x16x64_bf16 v[28:31], a[92:95], v[60:67], v148 abid:1
ds_read_b128 v[48:51], v1 offset:8192
v_add_u32_sdwa v79, s42, v127 dst_sel:DWORD dst_unused:UNUSED_PAD src0_sel:DWORD src1_sel:WORD_1
v_smfmac_f32_16x16x64_bf16 v[28:31], a[128:131], v[68:75], v152 abid:1
ds_read_u16 v79, v79
v_cndmask_b32_dpp v107, v103, v107, vcc quad_perm:[1,0,3,2] row_mask:0xf bank_mask:0xf
v_smfmac_f32_16x16x64_bf16 v[32:35], a[96:99], v[60:67], v149
ds_read_b128 v[52:55], v0 offset:10240
v_add_u32_sdwa v80, s42, v128 dst_sel:DWORD dst_unused:UNUSED_PAD src0_sel:DWORD src1_sel:WORD_0
v_smfmac_f32_16x16x64_bf16 v[32:35], a[132:135], v[68:75], v153
ds_read_u16 v80, v80
v_add_u32_sdwa v81, s42, v128 dst_sel:DWORD dst_unused:UNUSED_PAD src0_sel:DWORD src1_sel:WORD_1
v_smfmac_f32_16x16x64_bf16 v[16:19], a[80:83], v[60:67], v147
buffer_store_dwordx4 v[104:107], v4, s[20:23], s46 offen offset:1280 sc1
s_mov_b64 vcc, s[80:81]
ds_read_b128 v[56:59], v1 offset:10240
v_add_u32_sdwa v82, s42, v129 dst_sel:DWORD dst_unused:UNUSED_PAD src0_sel:DWORD src1_sel:WORD_0
v_add_u32_sdwa v83, s42, v129 dst_sel:DWORD dst_unused:UNUSED_PAD src0_sel:DWORD src1_sel:WORD_1
v_smfmac_f32_16x16x64_bf16 v[16:19], a[116:119], v[68:75], v151
s_waitcnt lgkmcnt(9)
ds_read_b128 v[92:95], v0 offset:12288
v_add_u32_sdwa v100, s42, v130 dst_sel:DWORD dst_unused:UNUSED_PAD src0_sel:DWORD src1_sel:WORD_0
v_smfmac_f32_16x16x64_bf16 v[16:19], v[114:117], v[84:91], v180 abid:1
ds_read_u16 v81, v81
v_add_u32_sdwa v101, s42, v130 dst_sel:DWORD dst_unused:UNUSED_PAD src0_sel:DWORD src1_sel:WORD_1
v_smfmac_f32_16x16x64_bf16 v[20:23], v[114:117], v[84:91], v181
ds_read_b128 v[96:99], v1 offset:12288
v_add_u32_sdwa v102, s42, v131 dst_sel:DWORD dst_unused:UNUSED_PAD src0_sel:DWORD src1_sel:WORD_0
v_smfmac_f32_16x16x64_bf16 v[20:23], a[84:87], v[60:67], v147 abid:1
ds_read_u16 v100, v100
v_add_u32_sdwa v103, s42, v131 dst_sel:DWORD dst_unused:UNUSED_PAD src0_sel:DWORD src1_sel:WORD_1
v_smfmac_f32_16x16x64_bf16 v[20:23], a[120:123], v[68:75], v151 abid:1
ds_read_u16 v82, v82
v_add_u32_sdwa v104, s42, v132 dst_sel:DWORD dst_unused:UNUSED_PAD src0_sel:DWORD src1_sel:WORD_0
v_smfmac_f32_16x16x64_bf16 v[36:39], a[100:103], v[60:67], v149 abid:1
ds_read_u16 v101, v101
v_add_u32_sdwa v105, s42, v132 dst_sel:DWORD dst_unused:UNUSED_PAD src0_sel:DWORD src1_sel:WORD_1
v_smfmac_f32_16x16x64_bf16 v[36:39], a[136:139], v[68:75], v153 abid:1
buffer_store_dwordx2 v[112:113], v5, s[20:23], s46 offen
ds_read_u16 v83, v83
v_add_u32_sdwa v106, s42, v133 dst_sel:DWORD dst_unused:UNUSED_PAD src0_sel:DWORD src1_sel:WORD_0
v_smfmac_f32_16x16x64_bf16 v[40:43], a[104:107], v[60:67], v175
s_mov_b32 s22, 75497472
ds_read_b128 v[114:117], v2 offset:192
v_add_u32_sdwa v107, s42, v133 dst_sel:DWORD dst_unused:UNUSED_PAD src0_sel:DWORD src1_sel:WORD_1
v_smfmac_f32_16x16x64_bf16 v[40:43], a[140:143], v[68:75], v175 abid:1
s_waitcnt lgkmcnt(12)
ds_read_u16 v102, v102
v_add_u32_sdwa v84, s42, v134 dst_sel:DWORD dst_unused:UNUSED_PAD src0_sel:DWORD src1_sel:WORD_0
v_smfmac_f32_16x16x64_bf16 v[8:11], a[144:147], v[44:51], v154
s_waitcnt lgkmcnt(9)
ds_read_u16 v103, v103
v_add_u32_sdwa v85, s42, v134 dst_sel:DWORD dst_unused:UNUSED_PAD src0_sel:DWORD src1_sel:WORD_1
v_smfmac_f32_16x16x64_bf16 v[8:11], a[180:183], v[52:59], v158
s_waitcnt lgkmcnt(7)
ds_read_u16 v104, v104
v_add_u32_sdwa v86, s42, v135 dst_sel:DWORD dst_unused:UNUSED_PAD src0_sel:DWORD src1_sel:WORD_0
v_smfmac_f32_16x16x64_bf16 v[8:11], a[216:219], v[92:99], v162
s_mov_b32 s46, s48
ds_read_u16 v105, v105
v_add_u32_sdwa v87, s42, v135 dst_sel:DWORD dst_unused:UNUSED_PAD src0_sel:DWORD src1_sel:WORD_1
v_smfmac_f32_16x16x64_bf16 v[24:27], a[160:163], v[44:51], v156
s_mov_b32 s48, s49
ds_read_u16 v106, v106
v_add_u32_sdwa v88, s42, v136 dst_sel:DWORD dst_unused:UNUSED_PAD src0_sel:DWORD src1_sel:WORD_0
v_smfmac_f32_16x16x64_bf16 v[24:27], a[196:199], v[52:59], v160
s_mov_b32 s49, s50
s_add_u32 s50, s50, 4718592
v_add_u32_sdwa v89, s42, v136 dst_sel:DWORD dst_unused:UNUSED_PAD src0_sel:DWORD src1_sel:WORD_1
v_smfmac_f32_16x16x64_bf16 v[24:27], a[232:235], v[92:99], v164
s_waitcnt lgkmcnt(5)
ds_read_u16 v107, v107
v_add_u32_sdwa v90, s42, v137 dst_sel:DWORD dst_unused:UNUSED_PAD src0_sel:DWORD src1_sel:WORD_0
v_smfmac_f32_16x16x64_bf16 v[24:27], v[114:117], v[76:83], v182
ds_read_u16 v84, v84
v_add_u32_sdwa v91, s42, v137 dst_sel:DWORD dst_unused:UNUSED_PAD src0_sel:DWORD src1_sel:WORD_1
v_smfmac_f32_16x16x64_bf16 v[28:31], v[114:117], v[76:83], v182 abid:1
ds_read_b128 v[114:117], v2 offset:256
v_add_u32_sdwa v76, s4, v118 dst_sel:DWORD dst_unused:UNUSED_PAD src0_sel:DWORD src1_sel:WORD_0
v_smfmac_f32_16x16x64_bf16 v[28:31], a[164:167], v[44:51], v156 abid:1
ds_read_u16 v85, v85
v_add_u32_sdwa v77, s4, v118 dst_sel:DWORD dst_unused:UNUSED_PAD src0_sel:DWORD src1_sel:WORD_1
v_smfmac_f32_16x16x64_bf16 v[28:31], a[200:203], v[52:59], v160 abid:1
ds_read_u16 v86, v86
v_add_u32_sdwa v78, s4, v119 dst_sel:DWORD dst_unused:UNUSED_PAD src0_sel:DWORD src1_sel:WORD_0
v_smfmac_f32_16x16x64_bf16 v[28:31], a[236:239], v[92:99], v164 abid:1
ds_read_u16 v87, v87
v_add_u32_sdwa v79, s4, v119 dst_sel:DWORD dst_unused:UNUSED_PAD src0_sel:DWORD src1_sel:WORD_1
v_smfmac_f32_16x16x64_bf16 v[12:15], a[148:151], v[44:51], v154 abid:1
ds_read_u16 v88, v88
v_add_u32_sdwa v80, s4, v120 dst_sel:DWORD dst_unused:UNUSED_PAD src0_sel:DWORD src1_sel:WORD_0
v_smfmac_f32_16x16x64_bf16 v[12:15], a[184:187], v[52:59], v158 abid:1
v_add_u32_sdwa v81, s4, v120 dst_sel:DWORD dst_unused:UNUSED_PAD src0_sel:DWORD src1_sel:WORD_1
v_smfmac_f32_16x16x64_bf16 v[12:15], a[220:223], v[92:99], v162 abid:1
ds_read_b128 v[60:63], v0 offset:14336
v_add_u32_sdwa v82, s4, v121 dst_sel:DWORD dst_unused:UNUSED_PAD src0_sel:DWORD src1_sel:WORD_0
v_smfmac_f32_16x16x64_bf16 v[32:35], a[168:171], v[44:51], v157
ds_read_u16 v89, v89
v_add_u32_sdwa v83, s4, v121 dst_sel:DWORD dst_unused:UNUSED_PAD src0_sel:DWORD src1_sel:WORD_1
v_smfmac_f32_16x16x64_bf16 v[32:35], a[204:207], v[52:59], v161
ds_read_b128 v[64:67], v1 offset:14336
v_smfmac_f32_16x16x64_bf16 v[32:35], a[240:243], v[92:99], v165
s_waitcnt lgkmcnt(7)
ds_read_b128 v[68:71], v0 offset:16384
v_smfmac_f32_16x16x64_bf16 v[32:35], v[114:117], v[100:107], v183 abid:1
ds_read_u16 v90, v90
v_smfmac_f32_16x16x64_bf16 v[36:39], v[114:117], v[100:107], v184
ds_read_b128 v[72:75], v1 offset:16384
v_add_u32 v0, s43, v0
v_smfmac_f32_16x16x64_bf16 v[36:39], a[172:175], v[44:51], v157 abid:1
ds_read_u16 v91, v91
v_add_u32 v1, s43, v1
v_smfmac_f32_16x16x64_bf16 v[36:39], a[208:211], v[52:59], v161 abid:1
v_smfmac_f32_16x16x64_bf16 v[36:39], a[244:247], v[92:99], v165 abid:1
ds_read_b128 v[114:117], v2 offset:320
v_smfmac_f32_16x16x64_bf16 v[16:19], a[152:155], v[44:51], v155
v_smfmac_f32_16x16x64_bf16 v[16:19], a[188:191], v[52:59], v159
v_smfmac_f32_16x16x64_bf16 v[16:19], a[224:227], v[92:99], v163
v_smfmac_f32_16x16x64_bf16 v[20:23], a[156:159], v[44:51], v155 abid:1
v_smfmac_f32_16x16x64_bf16 v[20:23], a[192:195], v[52:59], v159 abid:1
v_smfmac_f32_16x16x64_bf16 v[20:23], a[228:231], v[92:99], v163 abid:1
v_smfmac_f32_16x16x64_bf16 v[40:43], a[176:179], v[44:51], v176
s_bitcmp1_b32 s92, s41
v_smfmac_f32_16x16x64_bf16 v[40:43], a[212:215], v[52:59], v176 abid:1
s_cbranch_scc1 L_loopn_w
L_loopn_wb:
v_smfmac_f32_16x16x64_bf16 v[40:43], a[248:251], v[92:99], v177
s_waitcnt lgkmcnt(0)
v_smfmac_f32_16x16x64_bf16 v[40:43], v[114:117], v[84:91], v185
s_waitcnt vmcnt(20)
s_barrier
L_loopn_p3:
v_smfmac_f32_16x16x64_bf16 v[8:11], a[252:255], v[60:67], v166
s_mov_b32 s42, s4
v_smfmac_f32_16x16x64_bf16 v[8:11], v[218:221], v[68:75], v170
ds_read_b128 v[44:47], v0 offset:0
v_add_u32_sdwa v84, s42, v122 dst_sel:DWORD dst_unused:UNUSED_PAD src0_sel:DWORD src1_sel:WORD_0
v_smfmac_f32_16x16x64_bf16 v[12:15], v[186:189], v[60:67], v166 abid:1
ds_read_b128 v[48:51], v1 offset:0
v_add_u32_sdwa v85, s42, v122 dst_sel:DWORD dst_unused:UNUSED_PAD src0_sel:DWORD src1_sel:WORD_1
v_smfmac_f32_16x16x64_bf16 v[12:15], v[222:225], v[68:75], v170 abid:1
ds_read_b128 v[52:55], v0 offset:2048
v_add_u32_sdwa v86, s42, v123 dst_sel:DWORD dst_unused:UNUSED_PAD src0_sel:DWORD src1_sel:WORD_0
v_smfmac_f32_16x16x64_bf16 v[16:19], v[190:193], v[60:67], v167
ds_read_b128 v[56:59], v1 offset:2048
v_cvt_pk_bf16_f32 v92, v8, v9
v_smfmac_f32_16x16x64_bf16 v[16:19], v[226:229], v[68:75], v171
ds_read_u16 v76, v76
v_cvt_pk_bf16_f32 v93, v10, v11
v_smfmac_f32_16x16x64_bf16 v[20:23], v[194:197], v[60:67], v167 abid:1
ds_read_b128 v[8:11], v2 offset:1024
v_cvt_pk_bf16_f32 v94, v12, v13
v_smfmac_f32_16x16x64_bf16 v[20:23], v[230:233], v[68:75], v171 abid:1
ds_read_u16 v77, v77
v_cvt_pk_bf16_f32 v95, v14, v15
v_smfmac_f32_16x16x64_bf16 v[24:27], v[198:201], v[60:67], v168
ds_read_b128 v[12:15], v2 offset:1088
v_cvt_pk_bf16_f32 v96, v16, v17
v_smfmac_f32_16x16x64_bf16 v[24:27], v[234:237], v[68:75], v172
ds_read_u16 v78, v78
v_cvt_pk_bf16_f32 v97, v18, v19
v_smfmac_f32_16x16x64_bf16 v[28:31], v[202:205], v[60:67], v168 abid:1
ds_read_b128 v[16:19], v2 offset:1152
v_cvt_pk_bf16_f32 v98, v20, v21
v_smfmac_f32_16x16x64_bf16 v[28:31], v[238:241], v[68:75], v172 abid:1
ds_read_u16 v79, v79
v_cvt_pk_bf16_f32 v99, v22, v23
v_smfmac_f32_16x16x64_bf16 v[32:35], v[206:209], v[60:67], v169
ds_read_b128 v[20:23], v2 offset:1216
v_cvt_pk_bf16_f32 v100, v24, v25
v_smfmac_f32_16x16x64_bf16 v[32:35], v[242:245], v[68:75], v173
ds_read_u16 v80, v80
v_cvt_pk_bf16_f32 v101, v26, v27
v_smfmac_f32_16x16x64_bf16 v[36:39], v[210:213], v[60:67], v169 abid:1
ds_read_b128 v[24:27], v2 offset:1280
v_cvt_pk_bf16_f32 v102, v28, v29
v_smfmac_f32_16x16x64_bf16 v[36:39], v[246:249], v[68:75], v173 abid:1
ds_read_u16 v81, v81
v_cvt_pk_bf16_f32 v103, v30, v31
v_smfmac_f32_16x16x64_bf16 v[40:43], v[214:217], v[60:67], v177 abid:1
s_bitcmp1_b32 s12, s41
ds_read_b128 v[28:31], v2 offset:1344
v_cvt_pk_bf16_f32 v104, v32, v33
v_smfmac_f32_16x16x64_bf16 v[40:43], v[250:253], v[68:75], v178
s_waitcnt lgkmcnt(10)
v_cvt_pk_bf16_f32 v105, v34, v35
s_cbranch_scc1 L_loopn
s_cmp_eq_u32 s41, s59
s_cbranch_scc1 L_loopc
s_cmp_lt_u32 s41, s15
s_cbranch_scc1 L_loop
s_nop 0
v_cndmask_b32_dpp v108, v96, v92, vcc quad_perm:[1,0,3,2] row_mask:0xf bank_mask:0xf
v_cndmask_b32_dpp v109, v97, v93, vcc quad_perm:[1,0,3,2] row_mask:0xf bank_mask:0xf
v_cndmask_b32_dpp v110, v98, v94, vcc quad_perm:[1,0,3,2] row_mask:0xf bank_mask:0xf
v_cndmask_b32_dpp v111, v99, v95, vcc quad_perm:[1,0,3,2] row_mask:0xf bank_mask:0xf
buffer_store_dwordx4 v[108:111], v4, s[20:23], s46 offen offset:0 sc1
s_mov_b64 vcc, s[82:83]
v_cvt_pk_bf16_f32 v112, v40, v41
v_cvt_pk_bf16_f32 v113, v42, v43
ds_bpermute_b32 v112, v6, v112
ds_bpermute_b32 v113, v6, v113
v_cndmask_b32_dpp v96, v92, v96, vcc quad_perm:[1,0,3,2] row_mask:0xf bank_mask:0xf
v_cndmask_b32_dpp v97, v93, v97, vcc quad_perm:[1,0,3,2] row_mask:0xf bank_mask:0xf
v_cndmask_b32_dpp v98, v94, v98, vcc quad_perm:[1,0,3,2] row_mask:0xf bank_mask:0xf
v_cndmask_b32_dpp v99, v95, v99, vcc quad_perm:[1,0,3,2] row_mask:0xf bank_mask:0xf
buffer_store_dwordx4 v[96:99], v4, s[20:23], s46 offen offset:1152 sc1
s_mov_b64 vcc, s[80:81]
v_cvt_pk_bf16_f32 v106, v36, v37
v_cvt_pk_bf16_f32 v107, v38, v39
v_cndmask_b32_dpp v92, v104, v100, vcc quad_perm:[1,0,3,2] row_mask:0xf bank_mask:0xf
v_cndmask_b32_dpp v93, v105, v101, vcc quad_perm:[1,0,3,2] row_mask:0xf bank_mask:0xf
v_cndmask_b32_dpp v94, v106, v102, vcc quad_perm:[1,0,3,2] row_mask:0xf bank_mask:0xf
v_cndmask_b32_dpp v95, v107, v103, vcc quad_perm:[1,0,3,2] row_mask:0xf bank_mask:0xf
buffer_store_dwordx4 v[92:95], v4, s[20:23], s46 offen offset:128 sc1
s_mov_b64 vcc, s[82:83]
v_cndmask_b32_dpp v104, v100, v104, vcc quad_perm:[1,0,3,2] row_mask:0xf bank_mask:0xf
v_cndmask_b32_dpp v105, v101, v105, vcc quad_perm:[1,0,3,2] row_mask:0xf bank_mask:0xf
v_cndmask_b32_dpp v106, v102, v106, vcc quad_perm:[1,0,3,2] row_mask:0xf bank_mask:0xf
v_cndmask_b32_dpp v107, v103, v107, vcc quad_perm:[1,0,3,2] row_mask:0xf bank_mask:0xf
buffer_store_dwordx4 v[104:107], v4, s[20:23], s46 offen offset:1280 sc1
s_mov_b64 vcc, s[80:81]
s_waitcnt lgkmcnt(0)
buffer_store_dwordx2 v[112:113], v5, s[20:23], s46 offen
L_fin:
L_end_standalone__structured_sparse_n_m__ragged_kernel:
s_endpgm
L_more1:
v_and_b32 v73, v94, v16
v_lshrrev_b32 v72, 10, v16
v_cmp_eq_u32 s[64:65], v73, v95
v_and_or_b32 v32, v72, v96, v97
s_mov_b64 exec, s[64:65]
ds_add_rtn_u32 v48, v32, v88
s_mov_b64 exec, -1
v_and_b32 v73, v94, v17
v_lshrrev_b32 v72, 10, v17
v_cmp_eq_u32 s[66:67], v73, v95
v_and_or_b32 v33, v72, v96, v97
s_mov_b64 exec, s[66:67]
ds_add_rtn_u32 v49, v33, v88
s_mov_b64 exec, -1
v_and_b32 v73, v94, v18
v_lshrrev_b32 v72, 10, v18
v_cmp_eq_u32 s[68:69], v73, v95
v_and_or_b32 v34, v72, v96, v97
s_mov_b64 exec, s[68:69]
ds_add_rtn_u32 v50, v34, v88
s_mov_b64 exec, -1
v_and_b32 v73, v94, v19
v_lshrrev_b32 v72, 10, v19
v_cmp_eq_u32 s[70:71], v73, v95
v_and_or_b32 v35, v72, v96, v97
s_mov_b64 exec, s[70:71]
ds_add_rtn_u32 v51, v35, v88
s_mov_b64 exec, -1
v_and_b32 v73, v94, v20
v_lshrrev_b32 v72, 10, v20
v_cmp_eq_u32 s[72:73], v73, v95
v_and_or_b32 v36, v72, v96, v97
s_mov_b64 exec, s[72:73]
ds_add_rtn_u32 v52, v36, v88
s_mov_b64 exec, -1
v_and_b32 v73, v94, v21
v_lshrrev_b32 v72, 10, v21
v_cmp_eq_u32 s[74:75], v73, v95
v_and_or_b32 v37, v72, v96, v97
s_mov_b64 exec, s[74:75]
ds_add_rtn_u32 v53, v37, v88
s_mov_b64 exec, -1
v_and_b32 v73, v94, v22
v_lshrrev_b32 v72, 10, v22
v_cmp_eq_u32 s[76:77], v73, v95
v_and_or_b32 v38, v72, v96, v97
s_mov_b64 exec, s[76:77]
ds_add_rtn_u32 v54, v38, v88
s_mov_b64 exec, -1
s_branch L_more1b
L_greedy:
s_mov_b32 s47, 0
s_mov_b32 s89, 1
v_readlane_b32 s3, v72, 0
s_max_u32 s47, s47, 0
v_writelane_b32 v91, s47, 0
s_nop 1
s_add_u32 s47, s47, s3
s_cmp_gt_u32 s47, 32
s_cselect_b32 s90, 1, s90
v_readlane_b32 s3, v72, 1
s_max_u32 s47, s47, 0
v_writelane_b32 v91, s47, 1
s_nop 1
s_add_u32 s47, s47, s3
s_cmp_gt_u32 s47, 64
s_cselect_b32 s90, 1, s90
v_readlane_b32 s3, v72, 2
s_max_u32 s47, s47, 32
v_writelane_b32 v91, s47, 2
s_nop 1
s_add_u32 s47, s47, s3
s_cmp_gt_u32 s47, 64
s_cselect_b32 s90, 1, s90
v_readlane_b32 s3, v72, 3
s_max_u32 s47, s47, 32
v_writelane_b32 v91, s47, 3
s_nop 1
s_add_u32 s47, s47, s3
s_cmp_gt_u32 s47, 96
s_cselect_b32 s90, 1, s90
v_readlane_b32 s3, v72, 4
s_max_u32 s47, s47, 64
v_writelane_b32 v91, s47, 4
s_nop 1
s_add_u32 s47, s47, s3
s_cmp_gt_u32 s47, 96
s_cselect_b32 s90, 1, s90
v_readlane_b32 s3, v72, 5
s_max_u32 s47, s47, 64
v_writelane_b32 v91, s47, 5
s_nop 1
s_add_u32 s47, s47, s3
s_cmp_gt_u32 s47, 128
s_cselect_b32 s90, 1, s90
v_readlane_b32 s3, v72, 6
s_max_u32 s47, s47, 96
v_writelane_b32 v91, s47, 6
s_nop 1
s_add_u32 s47, s47, s3
s_cmp_gt_u32 s47, 128
s_cselect_b32 s90, 1, s90
v_readlane_b32 s3, v72, 7
s_max_u32 s47, s47, 96
v_writelane_b32 v91, s47, 7
s_nop 1
s_add_u32 s47, s47, s3
s_cmp_gt_u32 s47, 160
s_cselect_b32 s90, 1, s90
v_readlane_b32 s3, v72, 8
s_max_u32 s47, s47, 128
v_writelane_b32 v91, s47, 8
s_nop 1
s_add_u32 s47, s47, s3
s_cmp_gt_u32 s47, 160
s_cselect_b32 s90, 1, s90
s_cmp_lg_u32 s90, 0
s_cselect_b64 s[90:91], -1, 0
v_mov_b32 v73, 163072
s_mov_b64 exec, s[90:91]
ds_write_b32 v73, v88
s_mov_b64 exec, -1
s_branch L_greedyb
L_more2:
ds_bpermute_b32 v64, v32, v91
ds_bpermute_b32 v65, v33, v91
ds_bpermute_b32 v66, v34, v91
ds_bpermute_b32 v67, v35, v91
ds_bpermute_b32 v68, v36, v91
ds_bpermute_b32 v69, v37, v91
ds_bpermute_b32 v70, v38, v91
s_waitcnt lgkmcnt(0)
v_add_u32 v73, v48, v64
v_and_b32 v72, 0x87e, v16
v_lshl_add_u32 v73, v73, 1, s93
v_add_u32 v72, v90, v72
s_andn2_b64 exec, s[64:65], s[90:91]
ds_write_b16_d16_hi v73, v16 offset:64
ds_write_b16 v73, v72 offset:384
ds_write_b16 v73, v16 offset:704
s_mov_b64 exec, -1
v_add_u32 v73, v49, v65
v_and_b32 v72, 0x87e, v17
v_lshl_add_u32 v73, v73, 1, s93
v_add_u32 v72, v90, v72
s_andn2_b64 exec, s[66:67], s[90:91]
ds_write_b16_d16_hi v73, v17 offset:64
ds_write_b16 v73, v72 offset:384
ds_write_b16 v73, v17 offset:704
s_mov_b64 exec, -1
v_add_u32 v73, v50, v66
v_and_b32 v72, 0x87e, v18
v_lshl_add_u32 v73, v73, 1, s93
v_add_u32 v72, v90, v72
s_andn2_b64 exec, s[68:69], s[90:91]
ds_write_b16_d16_hi v73, v18 offset:64
ds_write_b16 v73, v72 offset:384
ds_write_b16 v73, v18 offset:704
s_mov_b64 exec, -1
v_add_u32 v73, v51, v67
v_and_b32 v72, 0x87e, v19
v_lshl_add_u32 v73, v73, 1, s93
v_add_u32 v72, v90, v72
s_andn2_b64 exec, s[70:71], s[90:91]
ds_write_b16_d16_hi v73, v19 offset:64
ds_write_b16 v73, v72 offset:384
ds_write_b16 v73, v19 offset:704
s_mov_b64 exec, -1
v_add_u32 v73, v52, v68
v_and_b32 v72, 0x87e, v20
v_lshl_add_u32 v73, v73, 1, s93
v_add_u32 v72, v90, v72
s_andn2_b64 exec, s[72:73], s[90:91]
ds_write_b16_d16_hi v73, v20 offset:64
ds_write_b16 v73, v72 offset:384
ds_write_b16 v73, v20 offset:704
s_mov_b64 exec, -1
v_add_u32 v73, v53, v69
v_and_b32 v72, 0x87e, v21
v_lshl_add_u32 v73, v73, 1, s93
v_add_u32 v72, v90, v72
s_andn2_b64 exec, s[74:75], s[90:91]
ds_write_b16_d16_hi v73, v21 offset:64
ds_write_b16 v73, v72 offset:384
ds_write_b16 v73, v21 offset:704
s_mov_b64 exec, -1
v_add_u32 v73, v54, v70
v_and_b32 v72, 0x87e, v22
v_lshl_add_u32 v73, v73, 1, s93
v_add_u32 v72, v90, v72
s_andn2_b64 exec, s[76:77], s[90:91]
ds_write_b16_d16_hi v73, v22 offset:64
ds_write_b16 v73, v72 offset:384
ds_write_b16 v73, v22 offset:704
s_mov_b64 exec, -1
s_branch L_more2b
L_giveup:
s_waitcnt vmcnt(0)
v_mov_b32 v8, 163072
v_mov_b32 v9, 1
ds_write_b32 v8, v9
s_branch L_polled
L_loop_w:
s_bitcmp1_b32 s87, s41
s_waitcnt vmcnt(15)
s_cbranch_scc0 L_loop_wb
s_waitcnt vmcnt(10)
s_branch L_loop_wb
L_loopn_w:
s_bitcmp1_b32 s87, s41
s_waitcnt vmcnt(15)
s_cbranch_scc0 L_loopn_wb
s_waitcnt vmcnt(10)
s_branch L_loopn_wb
L_linked:
.p2align 6
L_loopk:
v_smfmac_f32_16x16x64_bf16 v[8:11], a[0:3], v[44:51], v138
ds_read_b128 v[32:35], v2 offset:1408
v_cvt_pk_bf16_f32 v106, v36, v37
v_smfmac_f32_16x16x64_bf16 v[8:11], a[36:39], v[52:59], v142
s_waitcnt lgkmcnt(9)
v_cvt_pk_bf16_f32 v107, v38, v39
v_smfmac_f32_16x16x64_bf16 v[12:15], a[4:7], v[44:51], v138 abid:1
ds_read_b128 v[36:39], v2 offset:1472
v_cvt_pk_bf16_f32 v112, v40, v41
v_smfmac_f32_16x16x64_bf16 v[12:15], a[40:43], v[52:59], v142 abid:1
s_waitcnt lgkmcnt(8)
ds_read_b128 v[60:63], v0 offset:4096
v_cvt_pk_bf16_f32 v113, v42, v43
v_smfmac_f32_16x16x64_bf16 v[16:19], a[8:11], v[44:51], v139
s_cmp_eq_u32 s4, 129920
ds_read_b128 v[40:43], v2 offset:1536
v_cndmask_b32_dpp v108, v96, v92, vcc quad_perm:[1,0,3,2] row_mask:0xf bank_mask:0xf
v_smfmac_f32_16x16x64_bf16 v[16:19], a[44:47], v[52:59], v143
s_waitcnt lgkmcnt(8)
ds_read_u16 v82, v82
v_cndmask_b32_dpp v109, v97, v93, vcc quad_perm:[1,0,3,2] row_mask:0xf bank_mask:0xf
v_smfmac_f32_16x16x64_bf16 v[20:23], a[12:15], v[44:51], v139 abid:1
s_cselect_b32 s43, -129920, s5
ds_read_u16 v84, v84
v_cndmask_b32_dpp v110, v98, v94, vcc quad_perm:[1,0,3,2] row_mask:0xf bank_mask:0xf
v_smfmac_f32_16x16x64_bf16 v[20:23], a[48:51], v[52:59], v143 abid:1
s_waitcnt lgkmcnt(8)
ds_read_b128 v[64:67], v1 offset:4096
v_cndmask_b32_dpp v111, v99, v95, vcc quad_perm:[1,0,3,2] row_mask:0xf bank_mask:0xf
v_smfmac_f32_16x16x64_bf16 v[24:27], a[16:19], v[44:51], v140
s_add_u32 s4, s4, s43
ds_read_b128 v[68:71], v0 offset:6144
v_add_u32_sdwa v87, s42, v123 dst_sel:DWORD dst_unused:UNUSED_PAD src0_sel:DWORD src1_sel:WORD_1
v_smfmac_f32_16x16x64_bf16 v[24:27], a[52:55], v[52:59], v144
buffer_store_dwordx4 v[108:111], v4, s[20:23], s46 offen offset:0 sc1
s_mov_b64 vcc, s[82:83]
s_waitcnt lgkmcnt(8)
ds_read_b128 v[72:75], v1 offset:6144
v_cndmask_b32_dpp v96, v92, v96, vcc quad_perm:[1,0,3,2] row_mask:0xf bank_mask:0xf
v_cndmask_b32_dpp v97, v93, v97, vcc quad_perm:[1,0,3,2] row_mask:0xf bank_mask:0xf
v_smfmac_f32_16x16x64_bf16 v[28:31], a[20:23], v[44:51], v140 abid:1
s_add_u32 s41, s41, 1
ds_read_u16 v83, v83
v_cndmask_b32_dpp v98, v94, v98, vcc quad_perm:[1,0,3,2] row_mask:0xf bank_mask:0xf
v_smfmac_f32_16x16x64_bf16 v[28:31], a[56:59], v[52:59], v144 abid:1
s_waitcnt lgkmcnt(9)
ds_read_b128 v[114:117], v2 offset:64
v_cndmask_b32_dpp v99, v95, v99, vcc quad_perm:[1,0,3,2] row_mask:0xf bank_mask:0xf
v_smfmac_f32_16x16x64_bf16 v[32:35], a[24:27], v[44:51], v141
ds_read_u16 v85, v85
v_add_u32_sdwa v88, s42, v124 dst_sel:DWORD dst_unused:UNUSED_PAD src0_sel:DWORD src1_sel:WORD_0
v_smfmac_f32_16x16x64_bf16 v[32:35], a[60:63], v[52:59], v145
s_waitcnt lgkmcnt(10)
ds_read_u16 v86, v86
v_add_u32_sdwa v89, s42, v124 dst_sel:DWORD dst_unused:UNUSED_PAD src0_sel:DWORD src1_sel:WORD_1
v_smfmac_f32_16x16x64_bf16 v[36:39], a[28:31], v[44:51], v141 abid:1
ds_read_u16 v87, v87
v_add_u32_sdwa v90, s42, v125 dst_sel:DWORD dst_unused:UNUSED_PAD src0_sel:DWORD src1_sel:WORD_0
v_smfmac_f32_16x16x64_bf16 v[36:39], a[64:67], v[52:59], v145 abid:1
s_waitcnt lgkmcnt(10)
ds_read_u16 v88, v88
v_add_u32_sdwa v91, s42, v125 dst_sel:DWORD dst_unused:UNUSED_PAD src0_sel:DWORD src1_sel:WORD_1
v_smfmac_f32_16x16x64_bf16 v[40:43], a[32:35], v[44:51], v174
buffer_store_dwordx4 v[96:99], v4, s[20:23], s46 offen offset:1152 sc1
s_mov_b64 vcc, s[80:81]
ds_read_u16 v89, v89
v_cndmask_b32_dpp v92, v104, v100, vcc quad_perm:[1,0,3,2] row_mask:0xf bank_mask:0xf
v_cndmask_b32_dpp v93, v105, v101, vcc quad_perm:[1,0,3,2] row_mask:0xf bank_mask:0xf
v_smfmac_f32_16x16x64_bf16 v[40:43], a[68:71], v[52:59], v174 abid:1
s_waitcnt lgkmcnt(9)
ds_read_u16 v90, v90
v_cndmask_b32_dpp v94, v106, v102, vcc quad_perm:[1,0,3,2] row_mask:0xf bank_mask:0xf
v_smfmac_f32_16x16x64_bf16 v[8:11], a[72:75], v[60:67], v146
s_waitcnt lgkmcnt(8)
ds_read_u16 v91, v91
v_cndmask_b32_dpp v95, v107, v103, vcc quad_perm:[1,0,3,2] row_mask:0xf bank_mask:0xf
v_smfmac_f32_16x16x64_bf16 v[8:11], a[108:111], v[68:75], v150
s_waitcnt lgkmcnt(7)
ds_bpermute_b32 v112, v6, v112
v_smfmac_f32_16x16x64_bf16 v[8:11], v[114:117], v[76:83], v179
s_waitcnt vmcnt(2)
ds_bpermute_b32 v113, v6, v113
v_smfmac_f32_16x16x64_bf16 v[12:15], v[114:117], v[76:83], v179 abid:1
ds_read_b128 v[114:117], v2 offset:128
v_add_u32_sdwa v76, s42, v126 dst_sel:DWORD dst_unused:UNUSED_PAD src0_sel:DWORD src1_sel:WORD_0
v_smfmac_f32_16x16x64_bf16 v[12:15], a[76:79], v[60:67], v146 abid:1
ds_read_u16 v76, v76
v_add_u32_sdwa v77, s42, v126 dst_sel:DWORD dst_unused:UNUSED_PAD src0_sel:DWORD src1_sel:WORD_1
v_smfmac_f32_16x16x64_bf16 v[12:15], a[112:115], v[68:75], v150 abid:1
buffer_store_dwordx4 v[92:95], v4, s[20:23], s46 offen offset:128 sc1
s_mov_b64 vcc, s[82:83]
ds_read_u16 v77, v77
v_cndmask_b32_dpp v104, v100, v104, vcc quad_perm:[1,0,3,2] row_mask:0xf bank_mask:0xf
v_cndmask_b32_dpp v105, v101, v105, vcc quad_perm:[1,0,3,2] row_mask:0xf bank_mask:0xf
v_smfmac_f32_16x16x64_bf16 v[24:27], a[88:91], v[60:67], v148
ds_read_b128 v[44:47], v0 offset:8192
v_add_u32_sdwa v78, s42, v127 dst_sel:DWORD dst_unused:UNUSED_PAD src0_sel:DWORD src1_sel:WORD_0
v_smfmac_f32_16x16x64_bf16 v[24:27], a[124:127], v[68:75], v152
ds_read_u16 v78, v78
v_cndmask_b32_dpp v106, v102, v106, vcc quad_perm:[1,0,3,2] row_mask:0xf bank_mask:0xf
v_smfmac_f32_16x16x64_bf16 v[28:31], a[92:95], v[60:67], v148 abid:1
ds_read_b128 v[48:51], v1 offset:8192
v_cndmask_b32_dpp v107, v103, v107, vcc quad_perm:[1,0,3,2] row_mask:0xf bank_mask:0xf
v_smfmac_f32_16x16x64_bf16 v[28:31], a[128:131], v[68:75], v152 abid:1
ds_read_b128 v[52:55], v0 offset:10240
v_add_u32_sdwa v79, s42, v127 dst_sel:DWORD dst_unused:UNUSED_PAD src0_sel:DWORD src1_sel:WORD_1
v_smfmac_f32_16x16x64_bf16 v[32:35], a[96:99], v[60:67], v149
ds_read_u16 v79, v79
v_add_u32_sdwa v80, s42, v128 dst_sel:DWORD dst_unused:UNUSED_PAD src0_sel:DWORD src1_sel:WORD_0
v_smfmac_f32_16x16x64_bf16 v[32:35], a[132:135], v[68:75], v153
ds_read_u16 v80, v80
v_add_u32_sdwa v81, s42, v128 dst_sel:DWORD dst_unused:UNUSED_PAD src0_sel:DWORD src1_sel:WORD_1
v_smfmac_f32_16x16x64_bf16 v[16:19], a[80:83], v[60:67], v147
buffer_store_dwordx4 v[104:107], v4, s[20:23], s46 offen offset:1280 sc1
s_mov_b64 vcc, s[80:81]
ds_read_b128 v[56:59], v1 offset:10240
v_add_u32_sdwa v82, s42, v129 dst_sel:DWORD dst_unused:UNUSED_PAD src0_sel:DWORD src1_sel:WORD_0
v_add_u32_sdwa v83, s42, v129 dst_sel:DWORD dst_unused:UNUSED_PAD src0_sel:DWORD src1_sel:WORD_1
v_smfmac_f32_16x16x64_bf16 v[16:19], a[116:119], v[68:75], v151
s_waitcnt lgkmcnt(9)
ds_read_b128 v[92:95], v0 offset:12288
v_add_u32_sdwa v100, s42, v130 dst_sel:DWORD dst_unused:UNUSED_PAD src0_sel:DWORD src1_sel:WORD_0
v_smfmac_f32_16x16x64_bf16 v[16:19], v[114:117], v[84:91], v180 abid:1
ds_read_u16 v81, v81
v_add_u32_sdwa v101, s42, v130 dst_sel:DWORD dst_unused:UNUSED_PAD src0_sel:DWORD src1_sel:WORD_1
v_smfmac_f32_16x16x64_bf16 v[12:15], v[114:117], v[84:91], v180
ds_read_b128 v[96:99], v1 offset:12288
v_add_u32_sdwa v102, s42, v131 dst_sel:DWORD dst_unused:UNUSED_PAD src0_sel:DWORD src1_sel:WORD_0
v_smfmac_f32_16x16x64_bf16 v[20:23], v[114:117], v[84:91], v181
ds_read_u16 v82, v82
v_add_u32_sdwa v103, s42, v131 dst_sel:DWORD dst_unused:UNUSED_PAD src0_sel:DWORD src1_sel:WORD_1
v_smfmac_f32_16x16x64_bf16 v[20:23], a[84:87], v[60:67], v147 abid:1
ds_read_u16 v100, v100
v_add_u32_sdwa v104, s42, v132 dst_sel:DWORD dst_unused:UNUSED_PAD src0_sel:DWORD src1_sel:WORD_0
v_smfmac_f32_16x16x64_bf16 v[20:23], a[120:123], v[68:75], v151 abid:1
ds_read_u16 v83, v83
v_add_u32_sdwa v105, s42, v132 dst_sel:DWORD dst_unused:UNUSED_PAD src0_sel:DWORD src1_sel:WORD_1
v_smfmac_f32_16x16x64_bf16 v[36:39], a[100:103], v[60:67], v149 abid:1
buffer_store_dwordx2 v[112:113], v5, s[20:23], s46 offen
ds_read_b128 v[114:117], v2 offset:192
v_add_u32_sdwa v106, s42, v133 dst_sel:DWORD dst_unused:UNUSED_PAD src0_sel:DWORD src1_sel:WORD_0
v_smfmac_f32_16x16x64_bf16 v[36:39], a[136:139], v[68:75], v153 abid:1
s_mov_b32 s22, 75497472
ds_read_u16 v101, v101
v_add_u32_sdwa v107, s42, v133 dst_sel:DWORD dst_unused:UNUSED_PAD src0_sel:DWORD src1_sel:WORD_1
v_smfmac_f32_16x16x64_bf16 v[40:43], a[104:107], v[60:67], v175
s_mov_b32 s46, s48
ds_read_u16 v102, v102
v_add_u32_sdwa v84, s42, v134 dst_sel:DWORD dst_unused:UNUSED_PAD src0_sel:DWORD src1_sel:WORD_0
v_smfmac_f32_16x16x64_bf16 v[40:43], a[140:143], v[68:75], v175 abid:1
s_waitcnt lgkmcnt(13)
ds_read_u16 v103, v103
v_add_u32_sdwa v85, s42, v134 dst_sel:DWORD dst_unused:UNUSED_PAD src0_sel:DWORD src1_sel:WORD_1
v_smfmac_f32_16x16x64_bf16 v[8:11], a[144:147], v[44:51], v154
s_waitcnt lgkmcnt(10)
ds_read_u16 v104, v104
v_add_u32_sdwa v86, s42, v135 dst_sel:DWORD dst_unused:UNUSED_PAD src0_sel:DWORD src1_sel:WORD_0
v_smfmac_f32_16x16x64_bf16 v[8:11], a[180:183], v[52:59], v158
s_waitcnt lgkmcnt(8)
ds_read_u16 v105, v105
v_add_u32_sdwa v87, s42, v135 dst_sel:DWORD dst_unused:UNUSED_PAD src0_sel:DWORD src1_sel:WORD_1
v_smfmac_f32_16x16x64_bf16 v[8:11], a[216:219], v[92:99], v162
s_add_u32 m0, s44, 0
ds_read_u16 v106, v106
v_add_u32_sdwa v88, s42, v136 dst_sel:DWORD dst_unused:UNUSED_PAD src0_sel:DWORD src1_sel:WORD_0
v_smfmac_f32_16x16x64_bf16 v[24:27], a[160:163], v[44:51], v156
buffer_load_dwordx4 v3, s[16:19], s45 offen offset:0 nt lds
v_add_u32_sdwa v89, s42, v136 dst_sel:DWORD dst_unused:UNUSED_PAD src0_sel:DWORD src1_sel:WORD_1
v_smfmac_f32_16x16x64_bf16 v[24:27], a[196:199], v[52:59], v160
s_mov_b32 s48, s49
ds_read_u16 v107, v107
v_add_u32_sdwa v90, s42, v137 dst_sel:DWORD dst_unused:UNUSED_PAD src0_sel:DWORD src1_sel:WORD_0
v_smfmac_f32_16x16x64_bf16 v[24:27], a[232:235], v[92:99], v164
s_waitcnt lgkmcnt(7)
ds_read_u16 v84, v84
v_add_u32_sdwa v91, s42, v137 dst_sel:DWORD dst_unused:UNUSED_PAD src0_sel:DWORD src1_sel:WORD_1
v_smfmac_f32_16x16x64_bf16 v[24:27], v[114:117], v[76:83], v182
s_mov_b32 s49, s50
ds_read_u16 v85, v85
v_smfmac_f32_16x16x64_bf16 v[20:23], v[114:117], v[76:83], v181 abid:1
s_add_u32 s50, s50, 4718592
ds_read_u16 v86, v86
v_smfmac_f32_16x16x64_bf16 v[28:31], v[114:117], v[76:83], v182 abid:1
ds_read_b128 v[114:117], v2 offset:256
v_add_u32_sdwa v76, s4, v118 dst_sel:DWORD dst_unused:UNUSED_PAD src0_sel:DWORD src1_sel:WORD_0
v_smfmac_f32_16x16x64_bf16 v[28:31], a[164:167], v[44:51], v156 abid:1
ds_read_u16 v87, v87
v_add_u32_sdwa v77, s4, v118 dst_sel:DWORD dst_unused:UNUSED_PAD src0_sel:DWORD src1_sel:WORD_1
v_smfmac_f32_16x16x64_bf16 v[28:31], a[200:203], v[52:59], v160 abid:1
ds_read_u16 v88, v88
v_add_u32_sdwa v78, s4, v119 dst_sel:DWORD dst_unused:UNUSED_PAD src0_sel:DWORD src1_sel:WORD_0
v_smfmac_f32_16x16x64_bf16 v[28:31], a[236:239], v[92:99], v164 abid:1
ds_read_b128 v[60:63], v0 offset:14336
v_add_u32_sdwa v79, s4, v119 dst_sel:DWORD dst_unused:UNUSED_PAD src0_sel:DWORD src1_sel:WORD_1
v_smfmac_f32_16x16x64_bf16 v[12:15], a[148:151], v[44:51], v154 abid:1
ds_read_u16 v89, v89
v_add_u32_sdwa v80, s4, v120 dst_sel:DWORD dst_unused:UNUSED_PAD src0_sel:DWORD src1_sel:WORD_0
v_smfmac_f32_16x16x64_bf16 v[12:15], a[184:187], v[52:59], v158 abid:1
s_add_u32 m0, s44, 3840
ds_read_b128 v[64:67], v1 offset:14336
v_add_u32_sdwa v81, s4, v120 dst_sel:DWORD dst_unused:UNUSED_PAD src0_sel:DWORD src1_sel:WORD_1
v_smfmac_f32_16x16x64_bf16 v[12:15], a[220:223], v[92:99], v162 abid:1
buffer_load_dwordx4 v3, s[16:19], s45 offen offset:256 nt lds
v_add_u32_sdwa v82, s4, v121 dst_sel:DWORD dst_unused:UNUSED_PAD src0_sel:DWORD src1_sel:WORD_0
v_smfmac_f32_16x16x64_bf16 v[32:35], a[168:171], v[44:51], v157
ds_read_b128 v[68:71], v0 offset:16384
v_add_u32_sdwa v83, s4, v121 dst_sel:DWORD dst_unused:UNUSED_PAD src0_sel:DWORD src1_sel:WORD_1
v_smfmac_f32_16x16x64_bf16 v[32:35], a[204:207], v[52:59], v161
ds_read_u16 v90, v90
v_smfmac_f32_16x16x64_bf16 v[32:35], a[240:243], v[92:99], v165
s_waitcnt lgkmcnt(7)
ds_read_b128 v[72:75], v1 offset:16384
v_add_u32 v0, s43, v0
v_smfmac_f32_16x16x64_bf16 v[32:35], v[114:117], v[100:107], v183 abid:1
ds_read_u16 v91, v91
v_add_u32 v1, s43, v1
v_smfmac_f32_16x16x64_bf16 v[28:31], v[114:117], v[100:107], v183
v_smfmac_f32_16x16x64_bf16 v[36:39], v[114:117], v[100:107], v184
ds_read_b128 v[114:117], v2 offset:320
v_smfmac_f32_16x16x64_bf16 v[36:39], a[172:175], v[44:51], v157 abid:1
s_add_u32 m0, s44, 7680
v_smfmac_f32_16x16x64_bf16 v[36:39], a[208:211], v[52:59], v161 abid:1
buffer_load_dwordx4 v3, s[16:19], s45 offen offset:512 nt lds
v_smfmac_f32_16x16x64_bf16 v[36:39], a[244:247], v[92:99], v165 abid:1
v_smfmac_f32_16x16x64_bf16 v[16:19], a[152:155], v[44:51], v155
s_add_u32 m0, s44, 11520
v_smfmac_f32_16x16x64_bf16 v[16:19], a[188:191], v[52:59], v159
buffer_load_dwordx4 v3, s[16:19], s45 offen offset:768 nt lds
v_smfmac_f32_16x16x64_bf16 v[16:19], a[224:227], v[92:99], v163
v_smfmac_f32_16x16x64_bf16 v[20:23], a[156:159], v[44:51], v155 abid:1
s_add_u32 m0, s44, s8
v_smfmac_f32_16x16x64_bf16 v[20:23], a[192:195], v[52:59], v159 abid:1
s_mov_b64 exec, s[10:11]
buffer_load_dwordx4 v3, s[16:19], s7 offen offset:896 nt lds
s_mov_b64 exec, -1
v_smfmac_f32_16x16x64_bf16 v[20:23], a[228:231], v[92:99], v163 abid:1
s_add_u32 s45, s45, 4718592
s_add_u32 s7, s7, 4718592
s_add_u32 s44, s44, s5
v_smfmac_f32_16x16x64_bf16 v[40:43], a[176:179], v[44:51], v176
s_cmp_ge_u32 s44, 148480
s_cselect_b32 s44, s9, s44
s_bitcmp1_b32 s92, s41
v_smfmac_f32_16x16x64_bf16 v[40:43], a[212:215], v[52:59], v176 abid:1
s_cbranch_scc1 L_loopk_w
L_loopk_wb:
v_smfmac_f32_16x16x64_bf16 v[40:43], a[248:251], v[92:99], v177
s_waitcnt lgkmcnt(0)
v_smfmac_f32_16x16x64_bf16 v[40:43], v[114:117], v[84:91], v185
v_smfmac_f32_16x16x64_bf16 v[36:39], v[114:117], v[84:91], v184 abid:1
s_waitcnt vmcnt(20)
s_barrier
v_smfmac_f32_16x16x64_bf16 v[8:11], a[252:255], v[60:67], v166
s_mov_b32 s42, s4
v_smfmac_f32_16x16x64_bf16 v[8:11], v[218:221], v[68:75], v170
ds_read_b128 v[44:47], v0 offset:0
v_add_u32_sdwa v84, s42, v122 dst_sel:DWORD dst_unused:UNUSED_PAD src0_sel:DWORD src1_sel:WORD_0
v_smfmac_f32_16x16x64_bf16 v[12:15], v[186:189], v[60:67], v166 abid:1
ds_read_b128 v[48:51], v1 offset:0
v_add_u32_sdwa v85, s42, v122 dst_sel:DWORD dst_unused:UNUSED_PAD src0_sel:DWORD src1_sel:WORD_1
v_smfmac_f32_16x16x64_bf16 v[12:15], v[222:225], v[68:75], v170 abid:1
ds_read_b128 v[52:55], v0 offset:2048
v_add_u32_sdwa v86, s42, v123 dst_sel:DWORD dst_unused:UNUSED_PAD src0_sel:DWORD src1_sel:WORD_0
v_smfmac_f32_16x16x64_bf16 v[16:19], v[190:193], v[60:67], v167
ds_read_b128 v[56:59], v1 offset:2048
v_cvt_pk_bf16_f32 v92, v8, v9
v_smfmac_f32_16x16x64_bf16 v[16:19], v[226:229], v[68:75], v171
ds_read_u16 v76, v76
v_cvt_pk_bf16_f32 v93, v10, v11
v_smfmac_f32_16x16x64_bf16 v[20:23], v[194:197], v[60:67], v167 abid:1
ds_read_b128 v[8:11], v2 offset:1024
v_cvt_pk_bf16_f32 v94, v12, v13
v_smfmac_f32_16x16x64_bf16 v[20:23], v[230:233], v[68:75], v171 abid:1
ds_read_u16 v77, v77
v_cvt_pk_bf16_f32 v95, v14, v15
v_smfmac_f32_16x16x64_bf16 v[24:27], v[198:201], v[60:67], v168
ds_read_b128 v[12:15], v2 offset:1088
v_cvt_pk_bf16_f32 v96, v16, v17
v_smfmac_f32_16x16x64_bf16 v[24:27], v[234:237], v[68:75], v172
ds_read_u16 v78, v78
v_cvt_pk_bf16_f32 v97, v18, v19
v_smfmac_f32_16x16x64_bf16 v[28:31], v[202:205], v[60:67], v168 abid:1
ds_read_b128 v[16:19], v2 offset:1152
v_cvt_pk_bf16_f32 v98, v20, v21
v_smfmac_f32_16x16x64_bf16 v[28:31], v[238:241], v[68:75], v172 abid:1
ds_read_u16 v79, v79
v_cvt_pk_bf16_f32 v99, v22, v23
v_smfmac_f32_16x16x64_bf16 v[32:35], v[206:209], v[60:67], v169
ds_read_b128 v[20:23], v2 offset:1216
v_cvt_pk_bf16_f32 v100, v24, v25
v_smfmac_f32_16x16x64_bf16 v[32:35], v[242:245], v[68:75], v173
ds_read_u16 v80, v80
v_cvt_pk_bf16_f32 v101, v26, v27
v_smfmac_f32_16x16x64_bf16 v[36:39], v[210:213], v[60:67], v169 abid:1
ds_read_b128 v[24:27], v2 offset:1280
v_cvt_pk_bf16_f32 v102, v28, v29
v_smfmac_f32_16x16x64_bf16 v[36:39], v[246:249], v[68:75], v173 abid:1
ds_read_u16 v81, v81
v_cvt_pk_bf16_f32 v103, v30, v31
v_smfmac_f32_16x16x64_bf16 v[40:43], v[214:217], v[60:67], v177 abid:1
s_bitcmp1_b32 s85, s41
ds_read_b128 v[28:31], v2 offset:1344
v_cvt_pk_bf16_f32 v104, v32, v33
v_smfmac_f32_16x16x64_bf16 v[40:43], v[250:253], v[68:75], v178
s_waitcnt lgkmcnt(10)
v_cvt_pk_bf16_f32 v105, v34, v35
s_cbranch_scc1 L_loopk
s_cmp_lg_u32 s41, 6
s_cbranch_scc1 L_loopnk
.p2align 3
L_loopck:
v_smfmac_f32_16x16x64_bf16 v[8:11], a[0:3], v[44:51], v138
ds_read_b128 v[32:35], v2 offset:1408
v_cvt_pk_bf16_f32 v106, v36, v37
v_mov_b32 v7, 1
v_smfmac_f32_16x16x64_bf16 v[8:11], a[36:39], v[52:59], v142
s_waitcnt lgkmcnt(9)
buffer_atomic_add v7, v6, s[32:35], 0 offen sc0 sc1
v_cvt_pk_bf16_f32 v107, v38, v39
v_smfmac_f32_16x16x64_bf16 v[12:15], a[4:7], v[44:51], v138 abid:1
ds_read_b128 v[36:39], v2 offset:1472
v_cvt_pk_bf16_f32 v112, v40, v41
v_smfmac_f32_16x16x64_bf16 v[12:15], a[40:43], v[52:59], v142 abid:1
s_waitcnt lgkmcnt(8)
ds_read_b128 v[60:63], v0 offset:4096
v_cvt_pk_bf16_f32 v113, v42, v43
v_smfmac_f32_16x16x64_bf16 v[16:19], a[8:11], v[44:51], v139
s_cmp_eq_u32 s4, 129920
ds_read_b128 v[40:43], v2 offset:1536
v_cndmask_b32_dpp v108, v96, v92, vcc quad_perm:[1,0,3,2] row_mask:0xf bank_mask:0xf
v_smfmac_f32_16x16x64_bf16 v[16:19], a[44:47], v[52:59], v143
s_waitcnt lgkmcnt(8)
ds_read_u16 v82, v82
v_cndmask_b32_dpp v109, v97, v93, vcc quad_perm:[1,0,3,2] row_mask:0xf bank_mask:0xf
v_smfmac_f32_16x16x64_bf16 v[20:23], a[12:15], v[44:51], v139 abid:1
s_cselect_b32 s43, -129920, s5
ds_read_u16 v84, v84
v_cndmask_b32_dpp v110, v98, v94, vcc quad_perm:[1,0,3,2] row_mask:0xf bank_mask:0xf
v_smfmac_f32_16x16x64_bf16 v[20:23], a[48:51], v[52:59], v143 abid:1
s_waitcnt lgkmcnt(8)
ds_read_b128 v[64:67], v1 offset:4096
v_cndmask_b32_dpp v111, v99, v95, vcc quad_perm:[1,0,3,2] row_mask:0xf bank_mask:0xf
v_smfmac_f32_16x16x64_bf16 v[24:27], a[16:19], v[44:51], v140
s_add_u32 s4, s4, s43
ds_read_b128 v[68:71], v0 offset:6144
v_add_u32_sdwa v87, s42, v123 dst_sel:DWORD dst_unused:UNUSED_PAD src0_sel:DWORD src1_sel:WORD_1
v_smfmac_f32_16x16x64_bf16 v[24:27], a[52:55], v[52:59], v144
buffer_store_dwordx4 v[108:111], v4, s[20:23], s46 offen offset:0 sc1
s_mov_b64 vcc, s[82:83]
s_waitcnt lgkmcnt(8)
ds_read_b128 v[72:75], v1 offset:6144
v_cndmask_b32_dpp v96, v92, v96, vcc quad_perm:[1,0,3,2] row_mask:0xf bank_mask:0xf
v_cndmask_b32_dpp v97, v93, v97, vcc quad_perm:[1,0,3,2] row_mask:0xf bank_mask:0xf
v_smfmac_f32_16x16x64_bf16 v[28:31], a[20:23], v[44:51], v140 abid:1
s_add_u32 s7, s45, s58
ds_read_u16 v83, v83
v_cndmask_b32_dpp v98, v94, v98, vcc quad_perm:[1,0,3,2] row_mask:0xf bank_mask:0xf
v_smfmac_f32_16x16x64_bf16 v[28:31], a[56:59], v[52:59], v144 abid:1
s_waitcnt lgkmcnt(9)
ds_read_b128 v[114:117], v2 offset:64
v_cndmask_b32_dpp v99, v95, v99, vcc quad_perm:[1,0,3,2] row_mask:0xf bank_mask:0xf
v_smfmac_f32_16x16x64_bf16 v[32:35], a[24:27], v[44:51], v141
ds_read_u16 v85, v85
v_add_u32_sdwa v88, s42, v124 dst_sel:DWORD dst_unused:UNUSED_PAD src0_sel:DWORD src1_sel:WORD_0
v_smfmac_f32_16x16x64_bf16 v[32:35], a[60:63], v[52:59], v145
s_waitcnt lgkmcnt(10)
ds_read_u16 v86, v86
v_add_u32_sdwa v89, s42, v124 dst_sel:DWORD dst_unused:UNUSED_PAD src0_sel:DWORD src1_sel:WORD_1
v_smfmac_f32_16x16x64_bf16 v[36:39], a[28:31], v[44:51], v141 abid:1
ds_read_u16 v87, v87
v_add_u32_sdwa v90, s42, v125 dst_sel:DWORD dst_unused:UNUSED_PAD src0_sel:DWORD src1_sel:WORD_0
v_smfmac_f32_16x16x64_bf16 v[36:39], a[64:67], v[52:59], v145 abid:1
s_waitcnt lgkmcnt(10)
ds_read_u16 v88, v88
v_add_u32_sdwa v91, s42, v125 dst_sel:DWORD dst_unused:UNUSED_PAD src0_sel:DWORD src1_sel:WORD_1
v_smfmac_f32_16x16x64_bf16 v[40:43], a[32:35], v[44:51], v174
buffer_store_dwordx4 v[96:99], v4, s[20:23], s46 offen offset:1152 sc1
s_mov_b64 vcc, s[80:81]
ds_read_u16 v89, v89
v_cndmask_b32_dpp v92, v104, v100, vcc quad_perm:[1,0,3,2] row_mask:0xf bank_mask:0xf
v_cndmask_b32_dpp v93, v105, v101, vcc quad_perm:[1,0,3,2] row_mask:0xf bank_mask:0xf
v_smfmac_f32_16x16x64_bf16 v[40:43], a[68:71], v[52:59], v174 abid:1
s_waitcnt lgkmcnt(9)
ds_read_u16 v90, v90
v_cndmask_b32_dpp v94, v106, v102, vcc quad_perm:[1,0,3,2] row_mask:0xf bank_mask:0xf
v_smfmac_f32_16x16x64_bf16 v[8:11], a[72:75], v[60:67], v146
s_waitcnt lgkmcnt(8)
ds_read_u16 v91, v91
v_cndmask_b32_dpp v95, v107, v103, vcc quad_perm:[1,0,3,2] row_mask:0xf bank_mask:0xf
v_smfmac_f32_16x16x64_bf16 v[8:11], a[108:111], v[68:75], v150
s_waitcnt lgkmcnt(7)
ds_bpermute_b32 v112, v6, v112
v_smfmac_f32_16x16x64_bf16 v[8:11], v[114:117], v[76:83], v179
ds_bpermute_b32 v113, v6, v113
v_smfmac_f32_16x16x64_bf16 v[12:15], v[114:117], v[76:83], v179 abid:1
ds_read_b128 v[114:117], v2 offset:128
v_add_u32_sdwa v76, s42, v126 dst_sel:DWORD dst_unused:UNUSED_PAD src0_sel:DWORD src1_sel:WORD_0
v_smfmac_f32_16x16x64_bf16 v[12:15], a[76:79], v[60:67], v146 abid:1
ds_read_u16 v76, v76
v_add_u32_sdwa v77, s42, v126 dst_sel:DWORD dst_unused:UNUSED_PAD src0_sel:DWORD src1_sel:WORD_1
v_smfmac_f32_16x16x64_bf16 v[12:15], a[112:115], v[68:75], v150 abid:1
buffer_store_dwordx4 v[92:95], v4, s[20:23], s46 offen offset:128 sc1
s_mov_b64 vcc, s[82:83]
ds_read_u16 v77, v77
v_cndmask_b32_dpp v104, v100, v104, vcc quad_perm:[1,0,3,2] row_mask:0xf bank_mask:0xf
v_cndmask_b32_dpp v105, v101, v105, vcc quad_perm:[1,0,3,2] row_mask:0xf bank_mask:0xf
v_smfmac_f32_16x16x64_bf16 v[24:27], a[88:91], v[60:67], v148
ds_read_b128 v[44:47], v0 offset:8192
v_add_u32_sdwa v78, s42, v127 dst_sel:DWORD dst_unused:UNUSED_PAD src0_sel:DWORD src1_sel:WORD_0
v_smfmac_f32_16x16x64_bf16 v[24:27], a[124:127], v[68:75], v152
ds_read_u16 v78, v78
v_cndmask_b32_dpp v106, v102, v106, vcc quad_perm:[1,0,3,2] row_mask:0xf bank_mask:0xf
v_smfmac_f32_16x16x64_bf16 v[28:31], a[92:95], v[60:67], v148 abid:1
ds_read_b128 v[48:51], v1 offset:8192
v_cndmask_b32_dpp v107, v103, v107, vcc quad_perm:[1,0,3,2] row_mask:0xf bank_mask:0xf
v_smfmac_f32_16x16x64_bf16 v[28:31], a[128:131], v[68:75], v152 abid:1
ds_read_b128 v[52:55], v0 offset:10240
v_add_u32_sdwa v79, s42, v127 dst_sel:DWORD dst_unused:UNUSED_PAD src0_sel:DWORD src1_sel:WORD_1
v_smfmac_f32_16x16x64_bf16 v[32:35], a[96:99], v[60:67], v149
ds_read_u16 v79, v79
v_add_u32_sdwa v80, s42, v128 dst_sel:DWORD dst_unused:UNUSED_PAD src0_sel:DWORD src1_sel:WORD_0
v_smfmac_f32_16x16x64_bf16 v[32:35], a[132:135], v[68:75], v153
ds_read_u16 v80, v80
v_add_u32_sdwa v81, s42, v128 dst_sel:DWORD dst_unused:UNUSED_PAD src0_sel:DWORD src1_sel:WORD_1
v_smfmac_f32_16x16x64_bf16 v[16:19], a[80:83], v[60:67], v147
buffer_store_dwordx4 v[104:107], v4, s[20:23], s46 offen offset:1280 sc1
s_mov_b64 vcc, s[80:81]
ds_read_b128 v[56:59], v1 offset:10240
v_add_u32_sdwa v82, s42, v129 dst_sel:DWORD dst_unused:UNUSED_PAD src0_sel:DWORD src1_sel:WORD_0
v_add_u32_sdwa v83, s42, v129 dst_sel:DWORD dst_unused:UNUSED_PAD src0_sel:DWORD src1_sel:WORD_1
v_smfmac_f32_16x16x64_bf16 v[16:19], a[116:119], v[68:75], v151
s_waitcnt lgkmcnt(9)
ds_read_b128 v[92:95], v0 offset:12288
v_add_u32_sdwa v100, s42, v130 dst_sel:DWORD dst_unused:UNUSED_PAD src0_sel:DWORD src1_sel:WORD_0
v_smfmac_f32_16x16x64_bf16 v[16:19], v[114:117], v[84:91], v180 abid:1
ds_read_u16 v81, v81
v_add_u32_sdwa v101, s42, v130 dst_sel:DWORD dst_unused:UNUSED_PAD src0_sel:DWORD src1_sel:WORD_1
v_smfmac_f32_16x16x64_bf16 v[12:15], v[114:117], v[84:91], v180
ds_read_b128 v[96:99], v1 offset:12288
v_add_u32_sdwa v102, s42, v131 dst_sel:DWORD dst_unused:UNUSED_PAD src0_sel:DWORD src1_sel:WORD_0
v_smfmac_f32_16x16x64_bf16 v[20:23], v[114:117], v[84:91], v181
ds_read_u16 v82, v82
v_add_u32_sdwa v103, s42, v131 dst_sel:DWORD dst_unused:UNUSED_PAD src0_sel:DWORD src1_sel:WORD_1
v_smfmac_f32_16x16x64_bf16 v[20:23], a[84:87], v[60:67], v147 abid:1
ds_read_u16 v100, v100
v_add_u32_sdwa v104, s42, v132 dst_sel:DWORD dst_unused:UNUSED_PAD src0_sel:DWORD src1_sel:WORD_0
v_smfmac_f32_16x16x64_bf16 v[20:23], a[120:123], v[68:75], v151 abid:1
ds_read_u16 v83, v83
v_add_u32_sdwa v105, s42, v132 dst_sel:DWORD dst_unused:UNUSED_PAD src0_sel:DWORD src1_sel:WORD_1
v_smfmac_f32_16x16x64_bf16 v[36:39], a[100:103], v[60:67], v149 abid:1
buffer_store_dwordx2 v[112:113], v5, s[20:23], s46 offen
ds_read_b128 v[114:117], v2 offset:192
v_add_u32_sdwa v106, s42, v133 dst_sel:DWORD dst_unused:UNUSED_PAD src0_sel:DWORD src1_sel:WORD_0
v_smfmac_f32_16x16x64_bf16 v[36:39], a[136:139], v[68:75], v153 abid:1
s_mov_b32 s46, s48
ds_read_u16 v101, v101
v_add_u32_sdwa v107, s42, v133 dst_sel:DWORD dst_unused:UNUSED_PAD src0_sel:DWORD src1_sel:WORD_1
v_smfmac_f32_16x16x64_bf16 v[40:43], a[104:107], v[60:67], v175
s_mov_b32 s48, s49
ds_read_u16 v102, v102
v_add_u32_sdwa v84, s42, v134 dst_sel:DWORD dst_unused:UNUSED_PAD src0_sel:DWORD src1_sel:WORD_0
v_smfmac_f32_16x16x64_bf16 v[40:43], a[140:143], v[68:75], v175 abid:1
s_waitcnt lgkmcnt(13)
ds_read_u16 v103, v103
v_add_u32_sdwa v85, s42, v134 dst_sel:DWORD dst_unused:UNUSED_PAD src0_sel:DWORD src1_sel:WORD_1
v_smfmac_f32_16x16x64_bf16 v[8:11], a[144:147], v[44:51], v154
s_waitcnt lgkmcnt(10)
ds_read_u16 v104, v104
v_add_u32_sdwa v86, s42, v135 dst_sel:DWORD dst_unused:UNUSED_PAD src0_sel:DWORD src1_sel:WORD_0
v_smfmac_f32_16x16x64_bf16 v[8:11], a[180:183], v[52:59], v158
s_waitcnt lgkmcnt(8)
ds_read_u16 v105, v105
v_add_u32_sdwa v87, s42, v135 dst_sel:DWORD dst_unused:UNUSED_PAD src0_sel:DWORD src1_sel:WORD_1
v_smfmac_f32_16x16x64_bf16 v[8:11], a[216:219], v[92:99], v162
s_add_u32 m0, s44, 0
ds_read_u16 v106, v106
v_add_u32_sdwa v88, s42, v136 dst_sel:DWORD dst_unused:UNUSED_PAD src0_sel:DWORD src1_sel:WORD_0
v_smfmac_f32_16x16x64_bf16 v[24:27], a[160:163], v[44:51], v156
buffer_load_dwordx4 v3, s[16:19], s45 offen offset:0 nt lds
v_add_u32_sdwa v89, s42, v136 dst_sel:DWORD dst_unused:UNUSED_PAD src0_sel:DWORD src1_sel:WORD_1
v_smfmac_f32_16x16x64_bf16 v[24:27], a[196:199], v[52:59], v160
s_mov_b32 s49, s50
ds_read_u16 v107, v107
v_add_u32_sdwa v90, s42, v137 dst_sel:DWORD dst_unused:UNUSED_PAD src0_sel:DWORD src1_sel:WORD_0
v_smfmac_f32_16x16x64_bf16 v[24:27], a[232:235], v[92:99], v164
s_waitcnt lgkmcnt(7)
s_waitcnt vmcnt(6)
ds_read_u16 v84, v84
v_add_u32_sdwa v91, s42, v137 dst_sel:DWORD dst_unused:UNUSED_PAD src0_sel:DWORD src1_sel:WORD_1
v_smfmac_f32_16x16x64_bf16 v[24:27], v[114:117], v[76:83], v182
s_mov_b32 s50, s45
ds_read_u16 v85, v85
v_smfmac_f32_16x16x64_bf16 v[20:23], v[114:117], v[76:83], v181 abid:1
ds_read_u16 v86, v86
v_smfmac_f32_16x16x64_bf16 v[28:31], v[114:117], v[76:83], v182 abid:1
ds_read_b128 v[114:117], v2 offset:256
v_add_u32_sdwa v76, s4, v118 dst_sel:DWORD dst_unused:UNUSED_PAD src0_sel:DWORD src1_sel:WORD_0
v_smfmac_f32_16x16x64_bf16 v[28:31], a[164:167], v[44:51], v156 abid:1
ds_read_u16 v87, v87
v_add_u32_sdwa v77, s4, v118 dst_sel:DWORD dst_unused:UNUSED_PAD src0_sel:DWORD src1_sel:WORD_1
v_smfmac_f32_16x16x64_bf16 v[28:31], a[200:203], v[52:59], v160 abid:1
ds_read_u16 v88, v88
v_add_u32_sdwa v78, s4, v119 dst_sel:DWORD dst_unused:UNUSED_PAD src0_sel:DWORD src1_sel:WORD_0
v_smfmac_f32_16x16x64_bf16 v[28:31], a[236:239], v[92:99], v164 abid:1
ds_read_b128 v[60:63], v0 offset:14336
v_add_u32_sdwa v79, s4, v119 dst_sel:DWORD dst_unused:UNUSED_PAD src0_sel:DWORD src1_sel:WORD_1
v_smfmac_f32_16x16x64_bf16 v[12:15], a[148:151], v[44:51], v154 abid:1
ds_read_u16 v89, v89
v_add_u32_sdwa v80, s4, v120 dst_sel:DWORD dst_unused:UNUSED_PAD src0_sel:DWORD src1_sel:WORD_0
v_smfmac_f32_16x16x64_bf16 v[12:15], a[184:187], v[52:59], v158 abid:1
s_add_u32 m0, s44, 3840
ds_read_b128 v[64:67], v1 offset:14336
v_add_u32_sdwa v81, s4, v120 dst_sel:DWORD dst_unused:UNUSED_PAD src0_sel:DWORD src1_sel:WORD_1
v_smfmac_f32_16x16x64_bf16 v[12:15], a[220:223], v[92:99], v162 abid:1
buffer_load_dwordx4 v3, s[16:19], s45 offen offset:256 nt lds
v_add_u32_sdwa v82, s4, v121 dst_sel:DWORD dst_unused:UNUSED_PAD src0_sel:DWORD src1_sel:WORD_0
v_smfmac_f32_16x16x64_bf16 v[32:35], a[168:171], v[44:51], v157
ds_read_b128 v[68:71], v0 offset:16384
v_add_u32_sdwa v83, s4, v121 dst_sel:DWORD dst_unused:UNUSED_PAD src0_sel:DWORD src1_sel:WORD_1
v_smfmac_f32_16x16x64_bf16 v[32:35], a[204:207], v[52:59], v161
ds_read_u16 v90, v90
v_smfmac_f32_16x16x64_bf16 v[32:35], a[240:243], v[92:99], v165
s_waitcnt lgkmcnt(7)
ds_read_b128 v[72:75], v1 offset:16384
v_add_u32 v0, s43, v0
v_smfmac_f32_16x16x64_bf16 v[32:35], v[114:117], v[100:107], v183 abid:1
ds_read_u16 v91, v91
v_add_u32 v1, s43, v1
v_smfmac_f32_16x16x64_bf16 v[28:31], v[114:117], v[100:107], v183
v_smfmac_f32_16x16x64_bf16 v[36:39], v[114:117], v[100:107], v184
ds_read_b128 v[114:117], v2 offset:320
v_smfmac_f32_16x16x64_bf16 v[36:39], a[172:175], v[44:51], v157 abid:1
s_add_u32 m0, s44, 7680
v_smfmac_f32_16x16x64_bf16 v[36:39], a[208:211], v[52:59], v161 abid:1
buffer_load_dwordx4 v3, s[16:19], s45 offen offset:512 nt lds
v_smfmac_f32_16x16x64_bf16 v[36:39], a[244:247], v[92:99], v165 abid:1
v_smfmac_f32_16x16x64_bf16 v[16:19], a[152:155], v[44:51], v155
s_add_u32 m0, s44, 11520
v_smfmac_f32_16x16x64_bf16 v[16:19], a[188:191], v[52:59], v159
buffer_load_dwordx4 v3, s[16:19], s45 offen offset:768 nt lds
v_smfmac_f32_16x16x64_bf16 v[16:19], a[224:227], v[92:99], v163
s_mov_b64 exec, s[62:63]
ds_write_b32 v0, v7 offset:18432
s_mov_b64 exec, -1
v_smfmac_f32_16x16x64_bf16 v[20:23], a[156:159], v[44:51], v155 abid:1
s_add_u32 m0, s44, s8
v_smfmac_f32_16x16x64_bf16 v[20:23], a[192:195], v[52:59], v159 abid:1
s_mov_b64 exec, s[10:11]
buffer_load_dwordx4 v3, s[16:19], s7 offen offset:896 nt lds
s_mov_b64 exec, -1
v_smfmac_f32_16x16x64_bf16 v[20:23], a[228:231], v[92:99], v163 abid:1
s_add_u32 s44, s44, s5
s_cmp_ge_u32 s44, 148480
s_cselect_b32 s44, s9, s44
v_smfmac_f32_16x16x64_bf16 v[40:43], a[176:179], v[44:51], v176
v_smfmac_f32_16x16x64_bf16 v[40:43], a[212:215], v[52:59], v176 abid:1
v_smfmac_f32_16x16x64_bf16 v[40:43], a[248:251], v[92:99], v177
s_waitcnt lgkmcnt(0)
v_smfmac_f32_16x16x64_bf16 v[40:43], v[114:117], v[84:91], v185
v_smfmac_f32_16x16x64_bf16 v[36:39], v[114:117], v[84:91], v184 abid:1
s_barrier
v_smfmac_f32_16x16x64_bf16 v[8:11], a[252:255], v[60:67], v166
s_mov_b32 s42, s4
ds_read_b32 v7, v0 offset:18432
v_smfmac_f32_16x16x64_bf16 v[8:11], v[218:221], v[68:75], v170
ds_read_b128 v[44:47], v0 offset:0
v_add_u32_sdwa v84, s42, v122 dst_sel:DWORD dst_unused:UNUSED_PAD src0_sel:DWORD src1_sel:WORD_0
v_smfmac_f32_16x16x64_bf16 v[12:15], v[186:189], v[60:67], v166 abid:1
ds_read_b128 v[48:51], v1 offset:0
v_add_u32_sdwa v85, s42, v122 dst_sel:DWORD dst_unused:UNUSED_PAD src0_sel:DWORD src1_sel:WORD_1
v_smfmac_f32_16x16x64_bf16 v[12:15], v[222:225], v[68:75], v170 abid:1
ds_read_b128 v[52:55], v0 offset:2048
v_add_u32_sdwa v86, s42, v123 dst_sel:DWORD dst_unused:UNUSED_PAD src0_sel:DWORD src1_sel:WORD_0
v_smfmac_f32_16x16x64_bf16 v[16:19], v[190:193], v[60:67], v167
ds_read_b128 v[56:59], v1 offset:2048
v_cvt_pk_bf16_f32 v92, v8, v9
v_smfmac_f32_16x16x64_bf16 v[16:19], v[226:229], v[68:75], v171
ds_read_u16 v76, v76
v_cvt_pk_bf16_f32 v93, v10, v11
v_smfmac_f32_16x16x64_bf16 v[20:23], v[194:197], v[60:67], v167 abid:1
ds_read_b128 v[8:11], v2 offset:1024
v_cvt_pk_bf16_f32 v94, v12, v13
v_smfmac_f32_16x16x64_bf16 v[20:23], v[230:233], v[68:75], v171 abid:1
ds_read_u16 v77, v77
v_cvt_pk_bf16_f32 v95, v14, v15
v_smfmac_f32_16x16x64_bf16 v[24:27], v[198:201], v[60:67], v168
ds_read_b128 v[12:15], v2 offset:1088
v_cvt_pk_bf16_f32 v96, v16, v17
v_smfmac_f32_16x16x64_bf16 v[24:27], v[234:237], v[68:75], v172
s_waitcnt lgkmcnt(8)
ds_read_u16 v78, v78
v_cvt_pk_bf16_f32 v97, v18, v19
v_readfirstlane_b32 s56, v7
v_smfmac_f32_16x16x64_bf16 v[28:31], v[202:205], v[60:67], v168 abid:1
s_lshr_b32 s60, s56, 5
ds_read_b128 v[16:19], v2 offset:1152
v_cvt_pk_bf16_f32 v98, v20, v21
v_smfmac_f32_16x16x64_bf16 v[28:31], v[238:241], v[68:75], v172 abid:1
s_mul_i32 s60, s60, 4128768
ds_read_u16 v79, v79
v_cvt_pk_bf16_f32 v99, v22, v23
v_smfmac_f32_16x16x64_bf16 v[32:35], v[206:209], v[60:67], v169
s_mul_i32 s61, s56, 18432
ds_read_b128 v[20:23], v2 offset:1216
v_cvt_pk_bf16_f32 v100, v24, v25
v_smfmac_f32_16x16x64_bf16 v[32:35], v[242:245], v[68:75], v173
s_add_u32 s60, s60, s57
ds_read_u16 v80, v80
v_cvt_pk_bf16_f32 v101, v26, v27
v_smfmac_f32_16x16x64_bf16 v[36:39], v[210:213], v[60:67], v169 abid:1
s_add_u32 s45, s60, s61
ds_read_b128 v[24:27], v2 offset:1280
v_cvt_pk_bf16_f32 v102, v28, v29
v_smfmac_f32_16x16x64_bf16 v[36:39], v[246:249], v[68:75], v173 abid:1
ds_read_u16 v81, v81
v_cvt_pk_bf16_f32 v103, v30, v31
v_smfmac_f32_16x16x64_bf16 v[40:43], v[214:217], v[60:67], v177 abid:1
s_cmp_lt_u32 s56, 192
ds_read_b128 v[28:31], v2 offset:1344
v_cvt_pk_bf16_f32 v104, v32, v33
v_smfmac_f32_16x16x64_bf16 v[40:43], v[250:253], v[68:75], v178
s_waitcnt lgkmcnt(10)
v_cvt_pk_bf16_f32 v105, v34, v35
s_cbranch_scc1 L_loopck
s_mov_b32 s41, 0
s_mov_b32 s15, 3
s_mov_b32 s12, 7
s_mov_b32 s92, 4
s_mov_b32 s87, 4
s_mov_b32 s59, -1
.p2align 3
L_loopnk:
v_smfmac_f32_16x16x64_bf16 v[8:11], a[0:3], v[44:51], v138
ds_read_b128 v[32:35], v2 offset:1408
v_cvt_pk_bf16_f32 v106, v36, v37
v_smfmac_f32_16x16x64_bf16 v[8:11], a[36:39], v[52:59], v142
s_waitcnt lgkmcnt(9)
v_cvt_pk_bf16_f32 v107, v38, v39
v_smfmac_f32_16x16x64_bf16 v[12:15], a[4:7], v[44:51], v138 abid:1
ds_read_b128 v[36:39], v2 offset:1472
v_cvt_pk_bf16_f32 v112, v40, v41
v_smfmac_f32_16x16x64_bf16 v[12:15], a[40:43], v[52:59], v142 abid:1
s_waitcnt lgkmcnt(8)
ds_read_b128 v[60:63], v0 offset:4096
v_cvt_pk_bf16_f32 v113, v42, v43
v_smfmac_f32_16x16x64_bf16 v[16:19], a[8:11], v[44:51], v139
s_cmp_eq_u32 s4, 129920
ds_read_b128 v[40:43], v2 offset:1536
v_cndmask_b32_dpp v108, v96, v92, vcc quad_perm:[1,0,3,2] row_mask:0xf bank_mask:0xf
v_smfmac_f32_16x16x64_bf16 v[16:19], a[44:47], v[52:59], v143
s_waitcnt lgkmcnt(8)
ds_read_u16 v82, v82
v_cndmask_b32_dpp v109, v97, v93, vcc quad_perm:[1,0,3,2] row_mask:0xf bank_mask:0xf
v_smfmac_f32_16x16x64_bf16 v[20:23], a[12:15], v[44:51], v139 abid:1
s_cselect_b32 s43, -129920, s5
ds_read_u16 v84, v84
v_cndmask_b32_dpp v110, v98, v94, vcc quad_perm:[1,0,3,2] row_mask:0xf bank_mask:0xf
v_smfmac_f32_16x16x64_bf16 v[20:23], a[48:51], v[52:59], v143 abid:1
s_waitcnt lgkmcnt(8)
ds_read_b128 v[64:67], v1 offset:4096
v_cndmask_b32_dpp v111, v99, v95, vcc quad_perm:[1,0,3,2] row_mask:0xf bank_mask:0xf
v_smfmac_f32_16x16x64_bf16 v[24:27], a[16:19], v[44:51], v140
s_add_u32 s4, s4, s43
ds_read_b128 v[68:71], v0 offset:6144
v_add_u32_sdwa v87, s42, v123 dst_sel:DWORD dst_unused:UNUSED_PAD src0_sel:DWORD src1_sel:WORD_1
v_smfmac_f32_16x16x64_bf16 v[24:27], a[52:55], v[52:59], v144
buffer_store_dwordx4 v[108:111], v4, s[20:23], s46 offen offset:0 sc1
s_mov_b64 vcc, s[82:83]
s_waitcnt lgkmcnt(8)
ds_read_b128 v[72:75], v1 offset:6144
v_cndmask_b32_dpp v96, v92, v96, vcc quad_perm:[1,0,3,2] row_mask:0xf bank_mask:0xf
v_cndmask_b32_dpp v97, v93, v97, vcc quad_perm:[1,0,3,2] row_mask:0xf bank_mask:0xf
v_smfmac_f32_16x16x64_bf16 v[28:31], a[20:23], v[44:51], v140 abid:1
s_add_u32 s41, s41, 1
ds_read_u16 v83, v83
v_cndmask_b32_dpp v98, v94, v98, vcc quad_perm:[1,0,3,2] row_mask:0xf bank_mask:0xf
v_smfmac_f32_16x16x64_bf16 v[28:31], a[56:59], v[52:59], v144 abid:1
s_waitcnt lgkmcnt(9)
ds_read_b128 v[114:117], v2 offset:64
v_cndmask_b32_dpp v99, v95, v99, vcc quad_perm:[1,0,3,2] row_mask:0xf bank_mask:0xf
v_smfmac_f32_16x16x64_bf16 v[32:35], a[24:27], v[44:51], v141
ds_read_u16 v85, v85
v_add_u32_sdwa v88, s42, v124 dst_sel:DWORD dst_unused:UNUSED_PAD src0_sel:DWORD src1_sel:WORD_0
v_smfmac_f32_16x16x64_bf16 v[32:35], a[60:63], v[52:59], v145
s_waitcnt lgkmcnt(10)
ds_read_u16 v86, v86
v_add_u32_sdwa v89, s42, v124 dst_sel:DWORD dst_unused:UNUSED_PAD src0_sel:DWORD src1_sel:WORD_1
v_smfmac_f32_16x16x64_bf16 v[36:39], a[28:31], v[44:51], v141 abid:1
ds_read_u16 v87, v87
v_add_u32_sdwa v90, s42, v125 dst_sel:DWORD dst_unused:UNUSED_PAD src0_sel:DWORD src1_sel:WORD_0
v_smfmac_f32_16x16x64_bf16 v[36:39], a[64:67], v[52:59], v145 abid:1
s_waitcnt lgkmcnt(10)
ds_read_u16 v88, v88
v_add_u32_sdwa v91, s42, v125 dst_sel:DWORD dst_unused:UNUSED_PAD src0_sel:DWORD src1_sel:WORD_1
v_smfmac_f32_16x16x64_bf16 v[40:43], a[32:35], v[44:51], v174
buffer_store_dwordx4 v[96:99], v4, s[20:23], s46 offen offset:1152 sc1
s_mov_b64 vcc, s[80:81]
ds_read_u16 v89, v89
v_cndmask_b32_dpp v92, v104, v100, vcc quad_perm:[1,0,3,2] row_mask:0xf bank_mask:0xf
v_cndmask_b32_dpp v93, v105, v101, vcc quad_perm:[1,0,3,2] row_mask:0xf bank_mask:0xf
v_smfmac_f32_16x16x64_bf16 v[40:43], a[68:71], v[52:59], v174 abid:1
s_waitcnt lgkmcnt(9)
ds_read_u16 v90, v90
v_cndmask_b32_dpp v94, v106, v102, vcc quad_perm:[1,0,3,2] row_mask:0xf bank_mask:0xf
v_smfmac_f32_16x16x64_bf16 v[8:11], a[72:75], v[60:67], v146
s_waitcnt lgkmcnt(8)
ds_read_u16 v91, v91
v_cndmask_b32_dpp v95, v107, v103, vcc quad_perm:[1,0,3,2] row_mask:0xf bank_mask:0xf
v_smfmac_f32_16x16x64_bf16 v[8:11], a[108:111], v[68:75], v150
s_waitcnt lgkmcnt(7)
ds_bpermute_b32 v112, v6, v112
v_smfmac_f32_16x16x64_bf16 v[8:11], v[114:117], v[76:83], v179
ds_bpermute_b32 v113, v6, v113
v_smfmac_f32_16x16x64_bf16 v[12:15], v[114:117], v[76:83], v179 abid:1
ds_read_b128 v[114:117], v2 offset:128
v_add_u32_sdwa v76, s42, v126 dst_sel:DWORD dst_unused:UNUSED_PAD src0_sel:DWORD src1_sel:WORD_0
v_smfmac_f32_16x16x64_bf16 v[12:15], a[76:79], v[60:67], v146 abid:1
ds_read_u16 v76, v76
v_add_u32_sdwa v77, s42, v126 dst_sel:DWORD dst_unused:UNUSED_PAD src0_sel:DWORD src1_sel:WORD_1
v_smfmac_f32_16x16x64_bf16 v[12:15], a[112:115], v[68:75], v150 abid:1
buffer_store_dwordx4 v[92:95], v4, s[20:23], s46 offen offset:128 sc1
s_mov_b64 vcc, s[82:83]
ds_read_u16 v77, v77
v_cndmask_b32_dpp v104, v100, v104, vcc quad_perm:[1,0,3,2] row_mask:0xf bank_mask:0xf
v_cndmask_b32_dpp v105, v101, v105, vcc quad_perm:[1,0,3,2] row_mask:0xf bank_mask:0xf
v_smfmac_f32_16x16x64_bf16 v[24:27], a[88:91], v[60:67], v148
ds_read_b128 v[44:47], v0 offset:8192
v_add_u32_sdwa v78, s42, v127 dst_sel:DWORD dst_unused:UNUSED_PAD src0_sel:DWORD src1_sel:WORD_0
v_smfmac_f32_16x16x64_bf16 v[24:27], a[124:127], v[68:75], v152
ds_read_u16 v78, v78
v_cndmask_b32_dpp v106, v102, v106, vcc quad_perm:[1,0,3,2] row_mask:0xf bank_mask:0xf
v_smfmac_f32_16x16x64_bf16 v[28:31], a[92:95], v[60:67], v148 abid:1
ds_read_b128 v[48:51], v1 offset:8192
v_cndmask_b32_dpp v107, v103, v107, vcc quad_perm:[1,0,3,2] row_mask:0xf bank_mask:0xf
v_smfmac_f32_16x16x64_bf16 v[28:31], a[128:131], v[68:75], v152 abid:1
ds_read_b128 v[52:55], v0 offset:10240
v_add_u32_sdwa v79, s42, v127 dst_sel:DWORD dst_unused:UNUSED_PAD src0_sel:DWORD src1_sel:WORD_1
v_smfmac_f32_16x16x64_bf16 v[32:35], a[96:99], v[60:67], v149
ds_read_u16 v79, v79
v_add_u32_sdwa v80, s42, v128 dst_sel:DWORD dst_unused:UNUSED_PAD src0_sel:DWORD src1_sel:WORD_0
v_smfmac_f32_16x16x64_bf16 v[32:35], a[132:135], v[68:75], v153
ds_read_u16 v80, v80
v_add_u32_sdwa v81, s42, v128 dst_sel:DWORD dst_unused:UNUSED_PAD src0_sel:DWORD src1_sel:WORD_1
v_smfmac_f32_16x16x64_bf16 v[16:19], a[80:83], v[60:67], v147
buffer_store_dwordx4 v[104:107], v4, s[20:23], s46 offen offset:1280 sc1
s_mov_b64 vcc, s[80:81]
ds_read_b128 v[56:59], v1 offset:10240
v_add_u32_sdwa v82, s42, v129 dst_sel:DWORD dst_unused:UNUSED_PAD src0_sel:DWORD src1_sel:WORD_0
v_add_u32_sdwa v83, s42, v129 dst_sel:DWORD dst_unused:UNUSED_PAD src0_sel:DWORD src1_sel:WORD_1
v_smfmac_f32_16x16x64_bf16 v[16:19], a[116:119], v[68:75], v151
s_waitcnt lgkmcnt(9)
ds_read_b128 v[92:95], v0 offset:12288
v_add_u32_sdwa v100, s42, v130 dst_sel:DWORD dst_unused:UNUSED_PAD src0_sel:DWORD src1_sel:WORD_0
v_smfmac_f32_16x16x64_bf16 v[16:19], v[114:117], v[84:91], v180 abid:1
ds_read_u16 v81, v81
v_add_u32_sdwa v101, s42, v130 dst_sel:DWORD dst_unused:UNUSED_PAD src0_sel:DWORD src1_sel:WORD_1
v_smfmac_f32_16x16x64_bf16 v[12:15], v[114:117], v[84:91], v180
ds_read_b128 v[96:99], v1 offset:12288
v_add_u32_sdwa v102, s42, v131 dst_sel:DWORD dst_unused:UNUSED_PAD src0_sel:DWORD src1_sel:WORD_0
v_smfmac_f32_16x16x64_bf16 v[20:23], v[114:117], v[84:91], v181
ds_read_u16 v82, v82
v_add_u32_sdwa v103, s42, v131 dst_sel:DWORD dst_unused:UNUSED_PAD src0_sel:DWORD src1_sel:WORD_1
v_smfmac_f32_16x16x64_bf16 v[20:23], a[84:87], v[60:67], v147 abid:1
ds_read_u16 v100, v100
v_add_u32_sdwa v104, s42, v132 dst_sel:DWORD dst_unused:UNUSED_PAD src0_sel:DWORD src1_sel:WORD_0
v_smfmac_f32_16x16x64_bf16 v[20:23], a[120:123], v[68:75], v151 abid:1
ds_read_u16 v83, v83
v_add_u32_sdwa v105, s42, v132 dst_sel:DWORD dst_unused:UNUSED_PAD src0_sel:DWORD src1_sel:WORD_1
v_smfmac_f32_16x16x64_bf16 v[36:39], a[100:103], v[60:67], v149 abid:1
buffer_store_dwordx2 v[112:113], v5, s[20:23], s46 offen
ds_read_b128 v[114:117], v2 offset:192
v_add_u32_sdwa v106, s42, v133 dst_sel:DWORD dst_unused:UNUSED_PAD src0_sel:DWORD src1_sel:WORD_0
v_smfmac_f32_16x16x64_bf16 v[36:39], a[136:139], v[68:75], v153 abid:1
s_mov_b32 s22, 75497472
ds_read_u16 v101, v101
v_add_u32_sdwa v107, s42, v133 dst_sel:DWORD dst_unused:UNUSED_PAD src0_sel:DWORD src1_sel:WORD_1
v_smfmac_f32_16x16x64_bf16 v[40:43], a[104:107], v[60:67], v175
s_mov_b32 s46, s48
ds_read_u16 v102, v102
v_add_u32_sdwa v84, s42, v134 dst_sel:DWORD dst_unused:UNUSED_PAD src0_sel:DWORD src1_sel:WORD_0
v_smfmac_f32_16x16x64_bf16 v[40:43], a[140:143], v[68:75], v175 abid:1
s_waitcnt lgkmcnt(13)
ds_read_u16 v103, v103
v_add_u32_sdwa v85, s42, v134 dst_sel:DWORD dst_unused:UNUSED_PAD src0_sel:DWORD src1_sel:WORD_1
v_smfmac_f32_16x16x64_bf16 v[8:11], a[144:147], v[44:51], v154
s_waitcnt lgkmcnt(10)
ds_read_u16 v104, v104
v_add_u32_sdwa v86, s42, v135 dst_sel:DWORD dst_unused:UNUSED_PAD src0_sel:DWORD src1_sel:WORD_0
v_smfmac_f32_16x16x64_bf16 v[8:11], a[180:183], v[52:59], v158
s_waitcnt lgkmcnt(8)
ds_read_u16 v105, v105
v_add_u32_sdwa v87, s42, v135 dst_sel:DWORD dst_unused:UNUSED_PAD src0_sel:DWORD src1_sel:WORD_1
v_smfmac_f32_16x16x64_bf16 v[8:11], a[216:219], v[92:99], v162
s_mov_b32 s48, s49
ds_read_u16 v106, v106
v_add_u32_sdwa v88, s42, v136 dst_sel:DWORD dst_unused:UNUSED_PAD src0_sel:DWORD src1_sel:WORD_0
v_smfmac_f32_16x16x64_bf16 v[24:27], a[160:163], v[44:51], v156
s_mov_b32 s49, s50
s_add_u32 s50, s50, 4718592
v_add_u32_sdwa v89, s42, v136 dst_sel:DWORD dst_unused:UNUSED_PAD src0_sel:DWORD src1_sel:WORD_1
v_smfmac_f32_16x16x64_bf16 v[24:27], a[196:199], v[52:59], v160
ds_read_u16 v107, v107
v_add_u32_sdwa v90, s42, v137 dst_sel:DWORD dst_unused:UNUSED_PAD src0_sel:DWORD src1_sel:WORD_0
v_smfmac_f32_16x16x64_bf16 v[24:27], a[232:235], v[92:99], v164
s_waitcnt lgkmcnt(7)
ds_read_u16 v84, v84
v_add_u32_sdwa v91, s42, v137 dst_sel:DWORD dst_unused:UNUSED_PAD src0_sel:DWORD src1_sel:WORD_1
v_smfmac_f32_16x16x64_bf16 v[24:27], v[114:117], v[76:83], v182
ds_read_u16 v85, v85
v_smfmac_f32_16x16x64_bf16 v[20:23], v[114:117], v[76:83], v181 abid:1
ds_read_u16 v86, v86
v_smfmac_f32_16x16x64_bf16 v[28:31], v[114:117], v[76:83], v182 abid:1
ds_read_b128 v[114:117], v2 offset:256
v_add_u32_sdwa v76, s4, v118 dst_sel:DWORD dst_unused:UNUSED_PAD src0_sel:DWORD src1_sel:WORD_0
v_smfmac_f32_16x16x64_bf16 v[28:31], a[164:167], v[44:51], v156 abid:1
ds_read_u16 v87, v87
v_add_u32_sdwa v77, s4, v118 dst_sel:DWORD dst_unused:UNUSED_PAD src0_sel:DWORD src1_sel:WORD_1
v_smfmac_f32_16x16x64_bf16 v[28:31], a[200:203], v[52:59], v160 abid:1
ds_read_u16 v88, v88
v_add_u32_sdwa v78, s4, v119 dst_sel:DWORD dst_unused:UNUSED_PAD src0_sel:DWORD src1_sel:WORD_0
v_smfmac_f32_16x16x64_bf16 v[28:31], a[236:239], v[92:99], v164 abid:1
ds_read_b128 v[60:63], v0 offset:14336
v_add_u32_sdwa v79, s4, v119 dst_sel:DWORD dst_unused:UNUSED_PAD src0_sel:DWORD src1_sel:WORD_1
v_smfmac_f32_16x16x64_bf16 v[12:15], a[148:151], v[44:51], v154 abid:1
ds_read_u16 v89, v89
v_add_u32_sdwa v80, s4, v120 dst_sel:DWORD dst_unused:UNUSED_PAD src0_sel:DWORD src1_sel:WORD_0
v_smfmac_f32_16x16x64_bf16 v[12:15], a[184:187], v[52:59], v158 abid:1
ds_read_b128 v[64:67], v1 offset:14336
v_add_u32_sdwa v81, s4, v120 dst_sel:DWORD dst_unused:UNUSED_PAD src0_sel:DWORD src1_sel:WORD_1
v_smfmac_f32_16x16x64_bf16 v[12:15], a[220:223], v[92:99], v162 abid:1
v_add_u32_sdwa v82, s4, v121 dst_sel:DWORD dst_unused:UNUSED_PAD src0_sel:DWORD src1_sel:WORD_0
v_smfmac_f32_16x16x64_bf16 v[32:35], a[168:171], v[44:51], v157
ds_read_b128 v[68:71], v0 offset:16384
v_add_u32_sdwa v83, s4, v121 dst_sel:DWORD dst_unused:UNUSED_PAD src0_sel:DWORD src1_sel:WORD_1
v_smfmac_f32_16x16x64_bf16 v[32:35], a[204:207], v[52:59], v161
ds_read_u16 v90, v90
v_smfmac_f32_16x16x64_bf16 v[32:35], a[240:243], v[92:99], v165
s_waitcnt lgkmcnt(7)
ds_read_b128 v[72:75], v1 offset:16384
v_add_u32 v0, s43, v0
v_smfmac_f32_16x16x64_bf16 v[32:35], v[114:117], v[100:107], v183 abid:1
ds_read_u16 v91, v91
v_add_u32 v1, s43, v1
v_smfmac_f32_16x16x64_bf16 v[28:31], v[114:117], v[100:107], v183
v_smfmac_f32_16x16x64_bf16 v[36:39], v[114:117], v[100:107], v184
ds_read_b128 v[114:117], v2 offset:320
v_smfmac_f32_16x16x64_bf16 v[36:39], a[172:175], v[44:51], v157 abid:1
v_smfmac_f32_16x16x64_bf16 v[36:39], a[208:211], v[52:59], v161 abid:1
v_smfmac_f32_16x16x64_bf16 v[36:39], a[244:247], v[92:99], v165 abid:1
v_smfmac_f32_16x16x64_bf16 v[16:19], a[152:155], v[44:51], v155
v_smfmac_f32_16x16x64_bf16 v[16:19], a[188:191], v[52:59], v159
v_smfmac_f32_16x16x64_bf16 v[16:19], a[224:227], v[92:99], v163
v_smfmac_f32_16x16x64_bf16 v[20:23], a[156:159], v[44:51], v155 abid:1
v_smfmac_f32_16x16x64_bf16 v[20:23], a[192:195], v[52:59], v159 abid:1
v_smfmac_f32_16x16x64_bf16 v[20:23], a[228:231], v[92:99], v163 abid:1
v_smfmac_f32_16x16x64_bf16 v[40:43], a[176:179], v[44:51], v176
s_bitcmp1_b32 s92, s41
v_smfmac_f32_16x16x64_bf16 v[40:43], a[212:215], v[52:59], v176 abid:1
s_cbranch_scc1 L_loopnk_w
L_loopnk_wb:
v_smfmac_f32_16x16x64_bf16 v[40:43], a[248:251], v[92:99], v177
s_waitcnt lgkmcnt(0)
v_smfmac_f32_16x16x64_bf16 v[40:43], v[114:117], v[84:91], v185
v_smfmac_f32_16x16x64_bf16 v[36:39], v[114:117], v[84:91], v184 abid:1
s_waitcnt vmcnt(20)
s_barrier
L_loopnk_p3:
v_smfmac_f32_16x16x64_bf16 v[8:11], a[252:255], v[60:67], v166
s_mov_b32 s42, s4
v_smfmac_f32_16x16x64_bf16 v[8:11], v[218:221], v[68:75], v170
ds_read_b128 v[44:47], v0 offset:0
v_add_u32_sdwa v84, s42, v122 dst_sel:DWORD dst_unused:UNUSED_PAD src0_sel:DWORD src1_sel:WORD_0
v_smfmac_f32_16x16x64_bf16 v[12:15], v[186:189], v[60:67], v166 abid:1
ds_read_b128 v[48:51], v1 offset:0
v_add_u32_sdwa v85, s42, v122 dst_sel:DWORD dst_unused:UNUSED_PAD src0_sel:DWORD src1_sel:WORD_1
v_smfmac_f32_16x16x64_bf16 v[12:15], v[222:225], v[68:75], v170 abid:1
ds_read_b128 v[52:55], v0 offset:2048
v_add_u32_sdwa v86, s42, v123 dst_sel:DWORD dst_unused:UNUSED_PAD src0_sel:DWORD src1_sel:WORD_0
v_smfmac_f32_16x16x64_bf16 v[16:19], v[190:193], v[60:67], v167
ds_read_b128 v[56:59], v1 offset:2048
v_cvt_pk_bf16_f32 v92, v8, v9
v_smfmac_f32_16x16x64_bf16 v[16:19], v[226:229], v[68:75], v171
ds_read_u16 v76, v76
v_cvt_pk_bf16_f32 v93, v10, v11
v_smfmac_f32_16x16x64_bf16 v[20:23], v[194:197], v[60:67], v167 abid:1
ds_read_b128 v[8:11], v2 offset:1024
v_cvt_pk_bf16_f32 v94, v12, v13
v_smfmac_f32_16x16x64_bf16 v[20:23], v[230:233], v[68:75], v171 abid:1
ds_read_u16 v77, v77
v_cvt_pk_bf16_f32 v95, v14, v15
v_smfmac_f32_16x16x64_bf16 v[24:27], v[198:201], v[60:67], v168
ds_read_b128 v[12:15], v2 offset:1088
v_cvt_pk_bf16_f32 v96, v16, v17
v_smfmac_f32_16x16x64_bf16 v[24:27], v[234:237], v[68:75], v172
ds_read_u16 v78, v78
v_cvt_pk_bf16_f32 v97, v18, v19
v_smfmac_f32_16x16x64_bf16 v[28:31], v[202:205], v[60:67], v168 abid:1
ds_read_b128 v[16:19], v2 offset:1152
v_cvt_pk_bf16_f32 v98, v20, v21
v_smfmac_f32_16x16x64_bf16 v[28:31], v[238:241], v[68:75], v172 abid:1
ds_read_u16 v79, v79
v_cvt_pk_bf16_f32 v99, v22, v23
v_smfmac_f32_16x16x64_bf16 v[32:35], v[206:209], v[60:67], v169
ds_read_b128 v[20:23], v2 offset:1216
v_cvt_pk_bf16_f32 v100, v24, v25
v_smfmac_f32_16x16x64_bf16 v[32:35], v[242:245], v[68:75], v173
ds_read_u16 v80, v80
v_cvt_pk_bf16_f32 v101, v26, v27
v_smfmac_f32_16x16x64_bf16 v[36:39], v[210:213], v[60:67], v169 abid:1
ds_read_b128 v[24:27], v2 offset:1280
v_cvt_pk_bf16_f32 v102, v28, v29
v_smfmac_f32_16x16x64_bf16 v[36:39], v[246:249], v[68:75], v173 abid:1
ds_read_u16 v81, v81
v_cvt_pk_bf16_f32 v103, v30, v31
v_smfmac_f32_16x16x64_bf16 v[40:43], v[214:217], v[60:67], v177 abid:1
s_bitcmp1_b32 s12, s41
ds_read_b128 v[28:31], v2 offset:1344
v_cvt_pk_bf16_f32 v104, v32, v33
v_smfmac_f32_16x16x64_bf16 v[40:43], v[250:253], v[68:75], v178
s_waitcnt lgkmcnt(10)
v_cvt_pk_bf16_f32 v105, v34, v35
s_cbranch_scc1 L_loopnk
s_cmp_eq_u32 s41, s59
s_cbranch_scc1 L_loopck
s_cmp_lt_u32 s41, s15
s_cbranch_scc1 L_loopk
s_nop 0
v_cndmask_b32_dpp v108, v96, v92, vcc quad_perm:[1,0,3,2] row_mask:0xf bank_mask:0xf
v_cndmask_b32_dpp v109, v97, v93, vcc quad_perm:[1,0,3,2] row_mask:0xf bank_mask:0xf
v_cndmask_b32_dpp v110, v98, v94, vcc quad_perm:[1,0,3,2] row_mask:0xf bank_mask:0xf
v_cndmask_b32_dpp v111, v99, v95, vcc quad_perm:[1,0,3,2] row_mask:0xf bank_mask:0xf
buffer_store_dwordx4 v[108:111], v4, s[20:23], s46 offen offset:0 sc1
s_mov_b64 vcc, s[82:83]
v_cvt_pk_bf16_f32 v112, v40, v41
v_cvt_pk_bf16_f32 v113, v42, v43
ds_bpermute_b32 v112, v6, v112
ds_bpermute_b32 v113, v6, v113
v_cndmask_b32_dpp v96, v92, v96, vcc quad_perm:[1,0,3,2] row_mask:0xf bank_mask:0xf
v_cndmask_b32_dpp v97, v93, v97, vcc quad_perm:[1,0,3,2] row_mask:0xf bank_mask:0xf
v_cndmask_b32_dpp v98, v94, v98, vcc quad_perm:[1,0,3,2] row_mask:0xf bank_mask:0xf
v_cndmask_b32_dpp v99, v95, v99, vcc quad_perm:[1,0,3,2] row_mask:0xf bank_mask:0xf
buffer_store_dwordx4 v[96:99], v4, s[20:23], s46 offen offset:1152 sc1
s_mov_b64 vcc, s[80:81]
v_cvt_pk_bf16_f32 v106, v36, v37
v_cvt_pk_bf16_f32 v107, v38, v39
v_cndmask_b32_dpp v92, v104, v100, vcc quad_perm:[1,0,3,2] row_mask:0xf bank_mask:0xf
v_cndmask_b32_dpp v93, v105, v101, vcc quad_perm:[1,0,3,2] row_mask:0xf bank_mask:0xf
v_cndmask_b32_dpp v94, v106, v102, vcc quad_perm:[1,0,3,2] row_mask:0xf bank_mask:0xf
v_cndmask_b32_dpp v95, v107, v103, vcc quad_perm:[1,0,3,2] row_mask:0xf bank_mask:0xf
buffer_store_dwordx4 v[92:95], v4, s[20:23], s46 offen offset:128 sc1
s_mov_b64 vcc, s[82:83]
v_cndmask_b32_dpp v104, v100, v104, vcc quad_perm:[1,0,3,2] row_mask:0xf bank_mask:0xf
v_cndmask_b32_dpp v105, v101, v105, vcc quad_perm:[1,0,3,2] row_mask:0xf bank_mask:0xf
v_cndmask_b32_dpp v106, v102, v106, vcc quad_perm:[1,0,3,2] row_mask:0xf bank_mask:0xf
v_cndmask_b32_dpp v107, v103, v107, vcc quad_perm:[1,0,3,2] row_mask:0xf bank_mask:0xf
buffer_store_dwordx4 v[104:107], v4, s[20:23], s46 offen offset:1280 sc1
s_mov_b64 vcc, s[80:81]
s_waitcnt lgkmcnt(0)
buffer_store_dwordx2 v[112:113], v5, s[20:23], s46 offen
s_branch L_fin
L_loopk_w:
s_bitcmp1_b32 s87, s41
s_waitcnt vmcnt(15)
s_cbranch_scc0 L_loopk_wb
s_waitcnt vmcnt(10)
s_branch L_loopk_wb
L_loopnk_w:
s_bitcmp1_b32 s87, s41
s_waitcnt vmcnt(15)
s_cbranch_scc0 L_loopnk_wb
s_waitcnt vmcnt(10)
s_branch L_loopnk_wb
L_slow:
s_waitcnt vmcnt(0) lgkmcnt(0)
s_mov_b32 s87, 0
L_sm:
s_lshl_b32 s86, s2, 1
s_add_u32 s86, s86, s87
s_add_u32 s86, s86, 1
s_mul_i32 s86, s86, 393216
s_mov_b32 s84, 0
L_st:
s_and_b32 s48, s84, 3
s_lshr_b32 s49, s84, 2
s_sub_u32 s50, s84, 36
s_lshl_b32 s51, s40, 4
s_lshl_b32 s52, s50, 1
s_lshl_b32 s53, s48, 8
s_cmp_lt_u32 s84, 36
s_cselect_b32 s52, s49, s52
s_cselect_b32 s53, s53, 1024
s_cselect_b32 s54, 8, 73728
s_cselect_b32 s55, 32, 8
s_cselect_b32 s56, 16, 32
s_cselect_b32 s57, 128, 64
s_mul_i32 s52, s52, 73728
s_mul_i32 s58, s40, 18432
v_and_b32 v58, 1, v7
v_bfe_u32 v59, v7, 1, 1
v_bfe_u32 v60, v7, 2, 2
v_bfe_u32 v62, v7, 4, 1
v_lshrrev_b32 v63, 5, v7
v_lshl_add_u32 v50, v58, 2, s52
v_mad_u32_u24 v50, v59, s54, v50
v_mad_u32_u24 v50, v60, s55, v50
v_mad_u32_u24 v50, v62, s56, v50
v_mad_u32_u24 v50, v63, s57, v50
v_add_u32 v50, s53, v50
v_add_u32 v50, s58, v50
v_add_u32 v62, 4608, v50
v_add_u32 v63, 9216, v50
v_add_u32 v64, 13824, v50
buffer_load_dword v8, v50, s[28:31], 0 offen offset:0
buffer_load_dword v9, v50, s[28:31], 0 offen offset:1152
buffer_load_dword v10, v50, s[28:31], 0 offen offset:2304
buffer_load_dword v11, v50, s[28:31], 0 offen offset:3456
buffer_load_dword v12, v62, s[28:31], 0 offen offset:0
buffer_load_dword v13, v62, s[28:31], 0 offen offset:1152
buffer_load_dword v14, v62, s[28:31], 0 offen offset:2304
buffer_load_dword v15, v62, s[28:31], 0 offen offset:3456
buffer_load_dword v16, v63, s[28:31], 0 offen offset:0
buffer_load_dword v17, v63, s[28:31], 0 offen offset:1152
buffer_load_dword v18, v63, s[28:31], 0 offen offset:2304
buffer_load_dword v19, v63, s[28:31], 0 offen offset:3456
buffer_load_dword v20, v64, s[28:31], 0 offen offset:0
buffer_load_dword v21, v64, s[28:31], 0 offen offset:1152
buffer_load_dword v22, v64, s[28:31], 0 offen offset:2304
buffer_load_dword v23, v64, s[28:31], 0 offen offset:3456
s_mul_i32 s52, s48, 9
s_add_u32 s52, s52, s49
s_mul_i32 s53, s52, 9
s_mul_i32 s54, s50, 18
s_add_u32 s54, s54, 8
s_lshl_b32 s55, s52, 2
s_add_u32 s55, s55, s40
s_lshl_b32 s56, s50, 2
s_add_u32 s56, s56, s40
s_cmp_eq_u32 s84, 40
s_cselect_b32 s57, 0x100000, 9
s_cmp_lt_u32 s84, 36
s_cselect_b32 s53, s53, s54
s_cselect_b32 s54, 2, 81
s_cselect_b32 s57, 1, s57
s_cselect_b32 s55, s55, s56
s_mov_b32 s56, 331776
s_cselect_b32 s56, s56, 368640
s_mov_b32 s58, 373760
s_cselect_b32 s58, s58, 382976
s_cselect_b32 s59, 16, 4
s_cselect_b32 s60, 4, 64
s_cselect_b32 s61, 12, 11
s_cselect_b32 s62, 1, 0x8001
v_lshrrev_b32 v61, 4, v7
v_lshlrev_b32 v62, 1, v58
v_lshl_add_u32 v60, v60, 2, v62
v_add_u32 v62, v60, v59
v_mul_u32_u24 v51, s54, v61
v_add_lshl_u32 v51, v51, s53, 6
v_add3_u32 v51, v51, v62, s51
v_lshl_add_u32 v51, v51, 4, s86
s_lshl_b32 s57, s57, 10
v_add_u32 v66, s57, v51
s_lshl_b32 s52, s55, 8
s_add_u32 s52, s52, s56
s_add_u32 s52, s52, s86
v_mul_u32_u24 v52, s59, v62
v_mad_u32_u24 v52, v61, s60, v52
v_add_u32 v52, s52, v52
v_mov_b32 v55, 0x05040100
v_mov_b32 v62, 0x03020706
v_cmp_eq_u32 vcc, 1, v59
v_mov_b32 v68, 0xf0a0500
v_mov_b32 v69, 0x8f8a8580
v_mov_b32 v70, 0x1f1a1510
v_mov_b32 v71, 0x9f9a9590
v_mov_b32 v72, 0x2f2a2520
v_mov_b32 v73, 0xafaaa5a0
v_mov_b32 v74, 0x3f3a3530
v_mov_b32 v75, 0xbfbab5b0
v_cndmask_b32 v55, v55, v62, vcc
s_mov_b32 s64, 0x5040500
s_mov_b32 s65, 0x5040501
s_mov_b32 s66, 0x5040502
s_mov_b32 s67, 0x5040503
s_mov_b32 s68, 0x7060700
s_mov_b32 s69, 0x7060701
s_mov_b32 s70, 0x7060702
s_mov_b32 s71, 0x7060703
s_mov_b32 s72, 0x05060102
s_cmp_lg_u32 s87, 0
s_waitcnt vmcnt(12)
v_perm_b32 v24, v8, v68, s64
v_perm_b32 v25, v9, v68, s65
v_perm_b32 v26, v10, v68, s66
v_perm_b32 v27, v11, v68, s67
v_max3_f32 v28, |v24|, |v25|, |v26|
v_med3_f32 v29, |v24|, |v25|, |v26|
v_min3_f32 v30, |v24|, |v25|, |v26|
v_med3_f32 v32, v28, v29, |v27|
v_med3_f32 v33, v29, v30, |v27|
v_max_f32 v31, v28, |v27|
v_cmp_eq_u32_sdwa vcc, v33, v32 src0_sel:WORD_1 src1_sel:WORD_1
s_cbranch_scc0 L_rb0g
v_min_f32 v30, v30, |v27|
v_cndmask_b32 v31, 0, v33, vcc
v_cmp_eq_u32_sdwa vcc, v30, v32 src0_sel:WORD_1 src1_sel:WORD_1
s_nop 1
v_cndmask_b32 v32, 0, v30, vcc
L_rb0g:
v_perm_b32 v36, v31, v32, s72
v_bfi_b32 v44, 3, v32, v31
v_perm_b32 v24, v8, v69, s68
v_perm_b32 v25, v9, v69, s69
v_perm_b32 v26, v10, v69, s70
v_perm_b32 v27, v11, v69, s71
v_max3_f32 v28, |v24|, |v25|, |v26|
v_med3_f32 v29, |v24|, |v25|, |v26|
v_min3_f32 v30, |v24|, |v25|, |v26|
v_med3_f32 v32, v28, v29, |v27|
v_med3_f32 v33, v29, v30, |v27|
v_max_f32 v31, v28, |v27|
v_cmp_eq_u32_sdwa vcc, v33, v32 src0_sel:WORD_1 src1_sel:WORD_1
s_cbranch_scc0 L_rb1g
v_min_f32 v30, v30, |v27|
v_cndmask_b32 v31, 0, v33, vcc
v_cmp_eq_u32_sdwa vcc, v30, v32 src0_sel:WORD_1 src1_sel:WORD_1
s_nop 1
v_cndmask_b32 v32, 0, v30, vcc
L_rb1g:
v_perm_b32 v40, v31, v32, s72
v_bfi_b32 v46, 3, v32, v31
s_waitcnt vmcnt(8)
v_perm_b32 v24, v12, v70, s64
v_perm_b32 v25, v13, v70, s65
v_perm_b32 v26, v14, v70, s66
v_perm_b32 v27, v15, v70, s67
v_max3_f32 v28, |v24|, |v25|, |v26|
v_med3_f32 v29, |v24|, |v25|, |v26|
v_min3_f32 v30, |v24|, |v25|, |v26|
v_med3_f32 v32, v28, v29, |v27|
v_med3_f32 v33, v29, v30, |v27|
v_max_f32 v31, v28, |v27|
v_cmp_eq_u32_sdwa vcc, v33, v32 src0_sel:WORD_1 src1_sel:WORD_1
s_cbranch_scc0 L_rb2g
v_min_f32 v30, v30, |v27|
v_cndmask_b32 v31, 0, v33, vcc
v_cmp_eq_u32_sdwa vcc, v30, v32 src0_sel:WORD_1 src1_sel:WORD_1
s_nop 1
v_cndmask_b32 v32, 0, v30, vcc
L_rb2g:
v_perm_b32 v37, v31, v32, s72
v_bfi_b32 v31, 3, v32, v31
v_lshlrev_b32 v31, 4, v31
v_bfi_b32 v44, 15, v44, v31
v_perm_b32 v24, v12, v71, s68
v_perm_b32 v25, v13, v71, s69
v_perm_b32 v26, v14, v71, s70
v_perm_b32 v27, v15, v71, s71
v_max3_f32 v28, |v24|, |v25|, |v26|
v_med3_f32 v29, |v24|, |v25|, |v26|
v_min3_f32 v30, |v24|, |v25|, |v26|
v_med3_f32 v32, v28, v29, |v27|
v_med3_f32 v33, v29, v30, |v27|
v_max_f32 v31, v28, |v27|
v_cmp_eq_u32_sdwa vcc, v33, v32 src0_sel:WORD_1 src1_sel:WORD_1
s_cbranch_scc0 L_rb3g
v_min_f32 v30, v30, |v27|
v_cndmask_b32 v31, 0, v33, vcc
v_cmp_eq_u32_sdwa vcc, v30, v32 src0_sel:WORD_1 src1_sel:WORD_1
s_nop 1
v_cndmask_b32 v32, 0, v30, vcc
L_rb3g:
v_perm_b32 v41, v31, v32, s72
v_bfi_b32 v31, 3, v32, v31
v_lshlrev_b32 v31, 4, v31
v_bfi_b32 v46, 15, v46, v31
s_waitcnt vmcnt(4)
v_perm_b32 v24, v16, v72, s64
v_perm_b32 v25, v17, v72, s65
v_perm_b32 v26, v18, v72, s66
v_perm_b32 v27, v19, v72, s67
v_max3_f32 v28, |v24|, |v25|, |v26|
v_med3_f32 v29, |v24|, |v25|, |v26|
v_min3_f32 v30, |v24|, |v25|, |v26|
v_med3_f32 v32, v28, v29, |v27|
v_med3_f32 v33, v29, v30, |v27|
v_max_f32 v31, v28, |v27|
v_cmp_eq_u32_sdwa vcc, v33, v32 src0_sel:WORD_1 src1_sel:WORD_1
s_cbranch_scc0 L_rb4g
v_min_f32 v30, v30, |v27|
v_cndmask_b32 v31, 0, v33, vcc
v_cmp_eq_u32_sdwa vcc, v30, v32 src0_sel:WORD_1 src1_sel:WORD_1
s_nop 1
v_cndmask_b32 v32, 0, v30, vcc
L_rb4g:
v_perm_b32 v38, v31, v32, s72
v_bfi_b32 v45, 3, v32, v31
v_perm_b32 v24, v16, v73, s68
v_perm_b32 v25, v17, v73, s69
v_perm_b32 v26, v18, v73, s70
v_perm_b32 v27, v19, v73, s71
v_max3_f32 v28, |v24|, |v25|, |v26|
v_med3_f32 v29, |v24|, |v25|, |v26|
v_min3_f32 v30, |v24|, |v25|, |v26|
v_med3_f32 v32, v28, v29, |v27|
v_med3_f32 v33, v29, v30, |v27|
v_max_f32 v31, v28, |v27|
v_cmp_eq_u32_sdwa vcc, v33, v32 src0_sel:WORD_1 src1_sel:WORD_1
s_cbranch_scc0 L_rb5g
v_min_f32 v30, v30, |v27|
v_cndmask_b32 v31, 0, v33, vcc
v_cmp_eq_u32_sdwa vcc, v30, v32 src0_sel:WORD_1 src1_sel:WORD_1
s_nop 1
v_cndmask_b32 v32, 0, v30, vcc
L_rb5g:
v_perm_b32 v42, v31, v32, s72
v_bfi_b32 v47, 3, v32, v31
s_waitcnt vmcnt(0)
v_perm_b32 v24, v20, v74, s64
v_perm_b32 v25, v21, v74, s65
v_perm_b32 v26, v22, v74, s66
v_perm_b32 v27, v23, v74, s67
v_max3_f32 v28, |v24|, |v25|, |v26|
v_med3_f32 v29, |v24|, |v25|, |v26|
v_min3_f32 v30, |v24|, |v25|, |v26|
v_med3_f32 v32, v28, v29, |v27|
v_med3_f32 v33, v29, v30, |v27|
v_max_f32 v31, v28, |v27|
v_cmp_eq_u32_sdwa vcc, v33, v32 src0_sel:WORD_1 src1_sel:WORD_1
s_cbranch_scc0 L_rb6g
v_min_f32 v30, v30, |v27|
v_cndmask_b32 v31, 0, v33, vcc
v_cmp_eq_u32_sdwa vcc, v30, v32 src0_sel:WORD_1 src1_sel:WORD_1
s_nop 1
v_cndmask_b32 v32, 0, v30, vcc
L_rb6g:
v_perm_b32 v39, v31, v32, s72
v_bfi_b32 v31, 3, v32, v31
v_lshlrev_b32 v31, 4, v31
v_bfi_b32 v45, 15, v45, v31
v_perm_b32 v24, v20, v75, s68
v_perm_b32 v25, v21, v75, s69
v_perm_b32 v26, v22, v75, s70
v_perm_b32 v27, v23, v75, s71
v_max3_f32 v28, |v24|, |v25|, |v26|
v_med3_f32 v29, |v24|, |v25|, |v26|
v_min3_f32 v30, |v24|, |v25|, |v26|
v_med3_f32 v32, v28, v29, |v27|
v_med3_f32 v33, v29, v30, |v27|
v_max_f32 v31, v28, |v27|
v_cmp_eq_u32_sdwa vcc, v33, v32 src0_sel:WORD_1 src1_sel:WORD_1
s_cbranch_scc0 L_rb7g
v_min_f32 v30, v30, |v27|
v_cndmask_b32 v31, 0, v33, vcc
v_cmp_eq_u32_sdwa vcc, v30, v32 src0_sel:WORD_1 src1_sel:WORD_1
s_nop 1
v_cndmask_b32 v32, 0, v30, vcc
L_rb7g:
v_perm_b32 v43, v31, v32, s72
v_bfi_b32 v31, 3, v32, v31
v_lshlrev_b32 v31, 4, v31
v_bfi_b32 v47, 15, v47, v31
s_mov_b32 vcc_lo, 0x33333333
s_mov_b32 vcc_hi, 0x33333333
v_cndmask_b32_dpp v24, v40, v36, vcc quad_perm:[2,3,0,1] row_mask:0xf bank_mask:0xf
v_cndmask_b32_dpp v25, v41, v37, vcc quad_perm:[2,3,0,1] row_mask:0xf bank_mask:0xf
v_cndmask_b32_dpp v26, v42, v38, vcc quad_perm:[2,3,0,1] row_mask:0xf bank_mask:0xf
v_cndmask_b32_dpp v27, v43, v39, vcc quad_perm:[2,3,0,1] row_mask:0xf bank_mask:0xf
s_not_b64 vcc, vcc
buffer_store_dwordx4 v[24:27], v51, s[24:27], 0 offen sc1
v_cndmask_b32_dpp v40, v36, v40, vcc quad_perm:[2,3,0,1] row_mask:0xf bank_mask:0xf
v_cndmask_b32_dpp v41, v37, v41, vcc quad_perm:[2,3,0,1] row_mask:0xf bank_mask:0xf
v_cndmask_b32_dpp v42, v38, v42, vcc quad_perm:[2,3,0,1] row_mask:0xf bank_mask:0xf
v_cndmask_b32_dpp v43, v39, v43, vcc quad_perm:[2,3,0,1] row_mask:0xf bank_mask:0xf
s_mov_b32 s52, 0x0c0c0400
s_mov_b32 s53, 0x04000c0c
buffer_store_dwordx4 v[40:43], v66, s[24:27], 0 offen sc1
v_perm_b32 v48, v45, v44, s52
v_perm_b32 v49, v47, v46, s53
v_or_b32 v48, v48, v49
s_nop 1
v_mov_b32_dpp v49, v48 quad_perm:[2,3,0,1] row_mask:0xf bank_mask:0xf
v_perm_b32 v48, v49, v48, v55
buffer_store_dword v48, v52, s[24:27], 0 offen sc1
s_waitcnt vmcnt(0)
s_add_u32 s84, s84, 1
s_cmp_lt_u32 s84, 41
s_cbranch_scc1 L_st
s_add_u32 s87, s87, 1
s_cmp_lt_u32 s87, 2
s_cbranch_scc1 L_sm
v_lshrrev_b32 v72, 3, v7
v_and_b32 v73, 7, v7
v_xor_b32 v73, v73, v72
v_mul_u32_u24 v72, 1152, v72
s_and_b32 s47, s40, 1
s_mul_i32 s47, s47, 9216
s_lshr_b32 s3, s40, 1
s_lshl_b32 s3, s3, 7
s_add_u32 s47, s47, s3
v_lshl_add_u32 v72, v73, 4, v72
v_add_u32 v3, s47, v72
s_lshl_b32 s44, s40, 10
s_mul_i32 s45, s2, 18432
s_mov_b32 s46, s45
s_lshr_b32 s47, s40, 1
s_lshl_b32 s3, s47, 11
s_sub_u32 s8, 15488, s3
s_lshl_b32 s3, s47, 7
s_add_u32 s7, s45, 128
s_sub_u32 s7, s7, s3
s_sub_u32 s10, s47, 1
s_sub_u32 s11, 0, s47
s_mov_b32 s9, s44
s_mov_b32 s13, 4718592
s_mov_b32 s15, 16
s_mov_b32 s14, s13
s_mov_b32 s22, 75497472
s_mov_b32 s18, 75497472
s_mov_b32 s41, 0
L_stile:
s_barrier
s_add_u32 m0, s44, 0
s_nop 0
buffer_load_dwordx4 v3, s[16:19], s45 offen offset:0 nt lds
s_add_u32 m0, s44, 3840
s_nop 0
buffer_load_dwordx4 v3, s[16:19], s45 offen offset:256 nt lds
s_add_u32 m0, s44, 7680
s_nop 0
buffer_load_dwordx4 v3, s[16:19], s45 offen offset:512 nt lds
s_add_u32 m0, s44, 11520
s_nop 0
buffer_load_dwordx4 v3, s[16:19], s45 offen offset:768 nt lds
s_add_u32 m0, s44, s8
s_mov_b64 exec, s[10:11]
buffer_load_dwordx4 v3, s[16:19], s7 offen offset:896 nt lds
s_mov_b64 exec, -1
ds_read_b128 v[8:11], v2 offset:1024
ds_read_b128 v[12:15], v2 offset:1088
ds_read_b128 v[16:19], v2 offset:1152
ds_read_b128 v[20:23], v2 offset:1216
ds_read_b128 v[24:27], v2 offset:1280
ds_read_b128 v[28:31], v2 offset:1344
ds_read_b128 v[32:35], v2 offset:1408
ds_read_b128 v[36:39], v2 offset:1472
ds_read_b128 v[40:43], v2 offset:1536
s_mov_b32 s87, 0
L_spass:
s_lshl_b32 s86, s2, 1
s_add_u32 s86, s86, s87
s_add_u32 s86, s86, 1
s_mul_i32 s86, s86, 393216
s_mul_i32 s47, s40, 82944
s_add_u32 s47, s47, s86
v_lshl_add_u32 v104, v7, 4, s47
s_mul_i32 s47, s40, 9216
s_add_u32 s47, s47, s86
s_add_u32 s47, s47, 331776
v_lshl_add_u32 v105, v7, 4, s47
s_lshl_b32 s47, s40, 6
s_add_u32 s47, s47, s86
s_add_u32 s47, s47, 368640
v_and_b32 v106, 15, v7
v_lshl_add_u32 v106, v106, 2, s47
v_lshrrev_b32 v107, 4, v7
v_lshl_add_u32 v106, v107, 8, v106
buffer_load_dword v174, v106, s[24:27], 0 offen offset:0 sc1
buffer_load_dword v175, v106, s[24:27], 0 offen offset:1024 sc1
buffer_load_dword v176, v106, s[24:27], 0 offen offset:2048 sc1
buffer_load_dword v177, v106, s[24:27], 0 offen offset:3072 sc1
s_mov_b32 s99, 4096
buffer_load_dword v178, v106, s[24:27], s99 offen offset:0 sc1
s_mov_b32 s98, 0
buffer_load_dwordx4 v[138:141], v105, s[24:27], s98 offen sc1
s_mov_b32 s99, 0
buffer_load_dwordx4 a[0:3], v104, s[24:27], s99 offen offset:0 sc1
buffer_load_dwordx4 a[4:7], v104, s[24:27], s99 offen offset:1024 sc1
buffer_load_dwordx4 a[8:11], v104, s[24:27], s99 offen offset:2048 sc1
buffer_load_dwordx4 a[12:15], v104, s[24:27], s99 offen offset:3072 sc1
s_mov_b32 s99, 4096
buffer_load_dwordx4 a[16:19], v104, s[24:27], s99 offen offset:0 sc1
buffer_load_dwordx4 a[20:23], v104, s[24:27], s99 offen offset:1024 sc1
buffer_load_dwordx4 a[24:27], v104, s[24:27], s99 offen offset:2048 sc1
buffer_load_dwordx4 a[28:31], v104, s[24:27], s99 offen offset:3072 sc1
s_mov_b32 s99, 8192
buffer_load_dwordx4 a[32:35], v104, s[24:27], s99 offen offset:0 sc1
s_mov_b32 s98, 1024
buffer_load_dwordx4 v[142:145], v105, s[24:27], s98 offen sc1
buffer_load_dwordx4 a[36:39], v104, s[24:27], s99 offen offset:1024 sc1
buffer_load_dwordx4 a[40:43], v104, s[24:27], s99 offen offset:2048 sc1
buffer_load_dwordx4 a[44:47], v104, s[24:27], s99 offen offset:3072 sc1
s_mov_b32 s99, 12288
buffer_load_dwordx4 a[48:51], v104, s[24:27], s99 offen offset:0 sc1
buffer_load_dwordx4 a[52:55], v104, s[24:27], s99 offen offset:1024 sc1
buffer_load_dwordx4 a[56:59], v104, s[24:27], s99 offen offset:2048 sc1
buffer_load_dwordx4 a[60:63], v104, s[24:27], s99 offen offset:3072 sc1
s_mov_b32 s99, 16384
buffer_load_dwordx4 a[64:67], v104, s[24:27], s99 offen offset:0 sc1
buffer_load_dwordx4 a[68:71], v104, s[24:27], s99 offen offset:1024 sc1
s_mov_b32 s98, 2048
buffer_load_dwordx4 v[146:149], v105, s[24:27], s98 offen sc1
buffer_load_dwordx4 a[72:75], v104, s[24:27], s99 offen offset:2048 sc1
buffer_load_dwordx4 a[76:79], v104, s[24:27], s99 offen offset:3072 sc1
s_mov_b32 s99, 20480
buffer_load_dwordx4 a[80:83], v104, s[24:27], s99 offen offset:0 sc1
buffer_load_dwordx4 a[84:87], v104, s[24:27], s99 offen offset:1024 sc1
buffer_load_dwordx4 a[88:91], v104, s[24:27], s99 offen offset:2048 sc1
buffer_load_dwordx4 a[92:95], v104, s[24:27], s99 offen offset:3072 sc1
s_mov_b32 s99, 24576
buffer_load_dwordx4 a[96:99], v104, s[24:27], s99 offen offset:0 sc1
buffer_load_dwordx4 a[100:103], v104, s[24:27], s99 offen offset:1024 sc1
buffer_load_dwordx4 a[104:107], v104, s[24:27], s99 offen offset:2048 sc1
s_mov_b32 s98, 3072
buffer_load_dwordx4 v[150:153], v105, s[24:27], s98 offen sc1
buffer_load_dwordx4 a[108:111], v104, s[24:27], s99 offen offset:3072 sc1
s_mov_b32 s99, 28672
buffer_load_dwordx4 a[112:115], v104, s[24:27], s99 offen offset:0 sc1
buffer_load_dwordx4 a[116:119], v104, s[24:27], s99 offen offset:1024 sc1
buffer_load_dwordx4 a[120:123], v104, s[24:27], s99 offen offset:2048 sc1
buffer_load_dwordx4 a[124:127], v104, s[24:27], s99 offen offset:3072 sc1
s_mov_b32 s99, 32768
buffer_load_dwordx4 a[128:131], v104, s[24:27], s99 offen offset:0 sc1
buffer_load_dwordx4 a[132:135], v104, s[24:27], s99 offen offset:1024 sc1
buffer_load_dwordx4 a[136:139], v104, s[24:27], s99 offen offset:2048 sc1
buffer_load_dwordx4 a[140:143], v104, s[24:27], s99 offen offset:3072 sc1
s_mov_b32 s98, 4096
buffer_load_dwordx4 v[154:157], v105, s[24:27], s98 offen sc1
s_mov_b32 s99, 36864
buffer_load_dwordx4 a[144:147], v104, s[24:27], s99 offen offset:0 sc1
buffer_load_dwordx4 a[148:151], v104, s[24:27], s99 offen offset:1024 sc1
buffer_load_dwordx4 a[152:155], v104, s[24:27], s99 offen offset:2048 sc1
buffer_load_dwordx4 a[156:159], v104, s[24:27], s99 offen offset:3072 sc1
s_mov_b32 s99, 40960
buffer_load_dwordx4 a[160:163], v104, s[24:27], s99 offen offset:0 sc1
buffer_load_dwordx4 a[164:167], v104, s[24:27], s99 offen offset:1024 sc1
buffer_load_dwordx4 a[168:171], v104, s[24:27], s99 offen offset:2048 sc1
buffer_load_dwordx4 a[172:175], v104, s[24:27], s99 offen offset:3072 sc1
s_mov_b32 s99, 45056
buffer_load_dwordx4 a[176:179], v104, s[24:27], s99 offen offset:0 sc1
s_mov_b32 s98, 5120
buffer_load_dwordx4 v[158:161], v105, s[24:27], s98 offen sc1
buffer_load_dwordx4 a[180:183], v104, s[24:27], s99 offen offset:1024 sc1
buffer_load_dwordx4 a[184:187], v104, s[24:27], s99 offen offset:2048 sc1
buffer_load_dwordx4 a[188:191], v104, s[24:27], s99 offen offset:3072 sc1
s_mov_b32 s99, 49152
buffer_load_dwordx4 a[192:195], v104, s[24:27], s99 offen offset:0 sc1
buffer_load_dwordx4 a[196:199], v104, s[24:27], s99 offen offset:1024 sc1
buffer_load_dwordx4 a[200:203], v104, s[24:27], s99 offen offset:2048 sc1
buffer_load_dwordx4 a[204:207], v104, s[24:27], s99 offen offset:3072 sc1
s_mov_b32 s99, 53248
buffer_load_dwordx4 a[208:211], v104, s[24:27], s99 offen offset:0 sc1
buffer_load_dwordx4 a[212:215], v104, s[24:27], s99 offen offset:1024 sc1
s_mov_b32 s98, 6144
buffer_load_dwordx4 v[162:165], v105, s[24:27], s98 offen sc1
buffer_load_dwordx4 a[216:219], v104, s[24:27], s99 offen offset:2048 sc1
buffer_load_dwordx4 a[220:223], v104, s[24:27], s99 offen offset:3072 sc1
s_mov_b32 s99, 57344
buffer_load_dwordx4 a[224:227], v104, s[24:27], s99 offen offset:0 sc1
buffer_load_dwordx4 a[228:231], v104, s[24:27], s99 offen offset:1024 sc1
buffer_load_dwordx4 a[232:235], v104, s[24:27], s99 offen offset:2048 sc1
buffer_load_dwordx4 a[236:239], v104, s[24:27], s99 offen offset:3072 sc1
s_mov_b32 s99, 61440
buffer_load_dwordx4 a[240:243], v104, s[24:27], s99 offen offset:0 sc1
buffer_load_dwordx4 a[244:247], v104, s[24:27], s99 offen offset:1024 sc1
buffer_load_dwordx4 a[248:251], v104, s[24:27], s99 offen offset:2048 sc1
s_mov_b32 s98, 7168
buffer_load_dwordx4 v[166:169], v105, s[24:27], s98 offen sc1
buffer_load_dwordx4 a[252:255], v104, s[24:27], s99 offen offset:3072 sc1
s_mov_b32 s99, 65536
buffer_load_dwordx4 v[186:189], v104, s[24:27], s99 offen offset:0 sc1
buffer_load_dwordx4 v[190:193], v104, s[24:27], s99 offen offset:1024 sc1
buffer_load_dwordx4 v[194:197], v104, s[24:27], s99 offen offset:2048 sc1
buffer_load_dwordx4 v[198:201], v104, s[24:27], s99 offen offset:3072 sc1
s_mov_b32 s99, 69632
buffer_load_dwordx4 v[202:205], v104, s[24:27], s99 offen offset:0 sc1
buffer_load_dwordx4 v[206:209], v104, s[24:27], s99 offen offset:1024 sc1
buffer_load_dwordx4 v[210:213], v104, s[24:27], s99 offen offset:2048 sc1
buffer_load_dwordx4 v[214:217], v104, s[24:27], s99 offen offset:3072 sc1
s_mov_b32 s98, 8192
buffer_load_dwordx4 v[170:173], v105, s[24:27], s98 offen sc1
s_mov_b32 s99, 73728
buffer_load_dwordx4 v[218:221], v104, s[24:27], s99 offen offset:0 sc1
buffer_load_dwordx4 v[222:225], v104, s[24:27], s99 offen offset:1024 sc1
buffer_load_dwordx4 v[226:229], v104, s[24:27], s99 offen offset:2048 sc1
buffer_load_dwordx4 v[230:233], v104, s[24:27], s99 offen offset:3072 sc1
s_mov_b32 s99, 77824
buffer_load_dwordx4 v[234:237], v104, s[24:27], s99 offen offset:0 sc1
buffer_load_dwordx4 v[238:241], v104, s[24:27], s99 offen offset:1024 sc1
buffer_load_dwordx4 v[242:245], v104, s[24:27], s99 offen offset:2048 sc1
buffer_load_dwordx4 v[246:249], v104, s[24:27], s99 offen offset:3072 sc1
s_mov_b32 s99, 81920
buffer_load_dwordx4 v[250:253], v104, s[24:27], s99 offen offset:0 sc1
s_waitcnt vmcnt(0)
s_barrier
ds_read_b128 v[44:47], v0 offset:0
ds_read_b128 v[48:51], v1 offset:0
s_waitcnt lgkmcnt(0)
v_smfmac_f32_16x16x64_bf16 v[8:11], a[0:3], v[44:51], v138
v_smfmac_f32_16x16x64_bf16 v[12:15], a[4:7], v[44:51], v138 abid:1
v_smfmac_f32_16x16x64_bf16 v[16:19], a[8:11], v[44:51], v139
v_smfmac_f32_16x16x64_bf16 v[20:23], a[12:15], v[44:51], v139 abid:1
v_smfmac_f32_16x16x64_bf16 v[24:27], a[16:19], v[44:51], v140
v_smfmac_f32_16x16x64_bf16 v[28:31], a[20:23], v[44:51], v140 abid:1
v_smfmac_f32_16x16x64_bf16 v[32:35], a[24:27], v[44:51], v141
v_smfmac_f32_16x16x64_bf16 v[36:39], a[28:31], v[44:51], v141 abid:1
v_smfmac_f32_16x16x64_bf16 v[40:43], a[32:35], v[44:51], v174
s_nop 7
ds_read_b128 v[44:47], v0 offset:2048
ds_read_b128 v[48:51], v1 offset:2048
s_waitcnt lgkmcnt(0)
v_smfmac_f32_16x16x64_bf16 v[8:11], a[36:39], v[44:51], v142
v_smfmac_f32_16x16x64_bf16 v[12:15], a[40:43], v[44:51], v142 abid:1
v_smfmac_f32_16x16x64_bf16 v[16:19], a[44:47], v[44:51], v143
v_smfmac_f32_16x16x64_bf16 v[20:23], a[48:51], v[44:51], v143 abid:1
v_smfmac_f32_16x16x64_bf16 v[24:27], a[52:55], v[44:51], v144
v_smfmac_f32_16x16x64_bf16 v[28:31], a[56:59], v[44:51], v144 abid:1
v_smfmac_f32_16x16x64_bf16 v[32:35], a[60:63], v[44:51], v145
v_smfmac_f32_16x16x64_bf16 v[36:39], a[64:67], v[44:51], v145 abid:1
v_smfmac_f32_16x16x64_bf16 v[40:43], a[68:71], v[44:51], v174 abid:1
s_nop 7
ds_read_b128 v[44:47], v0 offset:4096
ds_read_b128 v[48:51], v1 offset:4096
s_waitcnt lgkmcnt(0)
v_smfmac_f32_16x16x64_bf16 v[8:11], a[72:75], v[44:51], v146
v_smfmac_f32_16x16x64_bf16 v[12:15], a[76:79], v[44:51], v146 abid:1
v_smfmac_f32_16x16x64_bf16 v[16:19], a[80:83], v[44:51], v147
v_smfmac_f32_16x16x64_bf16 v[20:23], a[84:87], v[44:51], v147 abid:1
v_smfmac_f32_16x16x64_bf16 v[24:27], a[88:91], v[44:51], v148
v_smfmac_f32_16x16x64_bf16 v[28:31], a[92:95], v[44:51], v148 abid:1
v_smfmac_f32_16x16x64_bf16 v[32:35], a[96:99], v[44:51], v149
v_smfmac_f32_16x16x64_bf16 v[36:39], a[100:103], v[44:51], v149 abid:1
v_smfmac_f32_16x16x64_bf16 v[40:43], a[104:107], v[44:51], v175
s_nop 7
ds_read_b128 v[44:47], v0 offset:6144
ds_read_b128 v[48:51], v1 offset:6144
s_waitcnt lgkmcnt(0)
v_smfmac_f32_16x16x64_bf16 v[8:11], a[108:111], v[44:51], v150
v_smfmac_f32_16x16x64_bf16 v[12:15], a[112:115], v[44:51], v150 abid:1
v_smfmac_f32_16x16x64_bf16 v[16:19], a[116:119], v[44:51], v151
v_smfmac_f32_16x16x64_bf16 v[20:23], a[120:123], v[44:51], v151 abid:1
v_smfmac_f32_16x16x64_bf16 v[24:27], a[124:127], v[44:51], v152
v_smfmac_f32_16x16x64_bf16 v[28:31], a[128:131], v[44:51], v152 abid:1
v_smfmac_f32_16x16x64_bf16 v[32:35], a[132:135], v[44:51], v153
v_smfmac_f32_16x16x64_bf16 v[36:39], a[136:139], v[44:51], v153 abid:1
v_smfmac_f32_16x16x64_bf16 v[40:43], a[140:143], v[44:51], v175 abid:1
s_nop 7
ds_read_b128 v[44:47], v0 offset:8192
ds_read_b128 v[48:51], v1 offset:8192
s_waitcnt lgkmcnt(0)
v_smfmac_f32_16x16x64_bf16 v[8:11], a[144:147], v[44:51], v154
v_smfmac_f32_16x16x64_bf16 v[12:15], a[148:151], v[44:51], v154 abid:1
v_smfmac_f32_16x16x64_bf16 v[16:19], a[152:155], v[44:51], v155
v_smfmac_f32_16x16x64_bf16 v[20:23], a[156:159], v[44:51], v155 abid:1
v_smfmac_f32_16x16x64_bf16 v[24:27], a[160:163], v[44:51], v156
v_smfmac_f32_16x16x64_bf16 v[28:31], a[164:167], v[44:51], v156 abid:1
v_smfmac_f32_16x16x64_bf16 v[32:35], a[168:171], v[44:51], v157
v_smfmac_f32_16x16x64_bf16 v[36:39], a[172:175], v[44:51], v157 abid:1
v_smfmac_f32_16x16x64_bf16 v[40:43], a[176:179], v[44:51], v176
s_nop 7
ds_read_b128 v[44:47], v0 offset:10240
ds_read_b128 v[48:51], v1 offset:10240
s_waitcnt lgkmcnt(0)
v_smfmac_f32_16x16x64_bf16 v[8:11], a[180:183], v[44:51], v158
v_smfmac_f32_16x16x64_bf16 v[12:15], a[184:187], v[44:51], v158 abid:1
v_smfmac_f32_16x16x64_bf16 v[16:19], a[188:191], v[44:51], v159
v_smfmac_f32_16x16x64_bf16 v[20:23], a[192:195], v[44:51], v159 abid:1
v_smfmac_f32_16x16x64_bf16 v[24:27], a[196:199], v[44:51], v160
v_smfmac_f32_16x16x64_bf16 v[28:31], a[200:203], v[44:51], v160 abid:1
v_smfmac_f32_16x16x64_bf16 v[32:35], a[204:207], v[44:51], v161
v_smfmac_f32_16x16x64_bf16 v[36:39], a[208:211], v[44:51], v161 abid:1
v_smfmac_f32_16x16x64_bf16 v[40:43], a[212:215], v[44:51], v176 abid:1
s_nop 7
ds_read_b128 v[44:47], v0 offset:12288
ds_read_b128 v[48:51], v1 offset:12288
s_waitcnt lgkmcnt(0)
v_smfmac_f32_16x16x64_bf16 v[8:11], a[216:219], v[44:51], v162
v_smfmac_f32_16x16x64_bf16 v[12:15], a[220:223], v[44:51], v162 abid:1
v_smfmac_f32_16x16x64_bf16 v[16:19], a[224:227], v[44:51], v163
v_smfmac_f32_16x16x64_bf16 v[20:23], a[228:231], v[44:51], v163 abid:1
v_smfmac_f32_16x16x64_bf16 v[24:27], a[232:235], v[44:51], v164
v_smfmac_f32_16x16x64_bf16 v[28:31], a[236:239], v[44:51], v164 abid:1
v_smfmac_f32_16x16x64_bf16 v[32:35], a[240:243], v[44:51], v165
v_smfmac_f32_16x16x64_bf16 v[36:39], a[244:247], v[44:51], v165 abid:1
v_smfmac_f32_16x16x64_bf16 v[40:43], a[248:251], v[44:51], v177
s_nop 7
ds_read_b128 v[44:47], v0 offset:14336
ds_read_b128 v[48:51], v1 offset:14336
s_waitcnt lgkmcnt(0)
v_smfmac_f32_16x16x64_bf16 v[8:11], a[252:255], v[44:51], v166
v_smfmac_f32_16x16x64_bf16 v[12:15], v[186:189], v[44:51], v166 abid:1
v_smfmac_f32_16x16x64_bf16 v[16:19], v[190:193], v[44:51], v167
v_smfmac_f32_16x16x64_bf16 v[20:23], v[194:197], v[44:51], v167 abid:1
v_smfmac_f32_16x16x64_bf16 v[24:27], v[198:201], v[44:51], v168
v_smfmac_f32_16x16x64_bf16 v[28:31], v[202:205], v[44:51], v168 abid:1
v_smfmac_f32_16x16x64_bf16 v[32:35], v[206:209], v[44:51], v169
v_smfmac_f32_16x16x64_bf16 v[36:39], v[210:213], v[44:51], v169 abid:1
v_smfmac_f32_16x16x64_bf16 v[40:43], v[214:217], v[44:51], v177 abid:1
s_nop 7
ds_read_b128 v[44:47], v0 offset:16384
ds_read_b128 v[48:51], v1 offset:16384
s_waitcnt lgkmcnt(0)
v_smfmac_f32_16x16x64_bf16 v[8:11], v[218:221], v[44:51], v170
v_smfmac_f32_16x16x64_bf16 v[12:15], v[222:225], v[44:51], v170 abid:1
v_smfmac_f32_16x16x64_bf16 v[16:19], v[226:229], v[44:51], v171
v_smfmac_f32_16x16x64_bf16 v[20:23], v[230:233], v[44:51], v171 abid:1
v_smfmac_f32_16x16x64_bf16 v[24:27], v[234:237], v[44:51], v172
v_smfmac_f32_16x16x64_bf16 v[28:31], v[238:241], v[44:51], v172 abid:1
v_smfmac_f32_16x16x64_bf16 v[32:35], v[242:245], v[44:51], v173
v_smfmac_f32_16x16x64_bf16 v[36:39], v[246:249], v[44:51], v173 abid:1
v_smfmac_f32_16x16x64_bf16 v[40:43], v[250:253], v[44:51], v178
s_nop 7
s_add_u32 s87, s87, 1
s_cmp_lt_u32 s87, 2
s_cbranch_scc1 L_spass
v_cvt_pk_bf16_f32 v92, v8, v9
v_cvt_pk_bf16_f32 v93, v10, v11
v_cvt_pk_bf16_f32 v94, v12, v13
v_cvt_pk_bf16_f32 v95, v14, v15
v_cvt_pk_bf16_f32 v96, v16, v17
v_cvt_pk_bf16_f32 v97, v18, v19
v_cvt_pk_bf16_f32 v98, v20, v21
v_cvt_pk_bf16_f32 v99, v22, v23
v_cvt_pk_bf16_f32 v100, v24, v25
v_cvt_pk_bf16_f32 v101, v26, v27
v_cvt_pk_bf16_f32 v102, v28, v29
v_cvt_pk_bf16_f32 v103, v30, v31
v_cvt_pk_bf16_f32 v104, v32, v33
v_cvt_pk_bf16_f32 v105, v34, v35
s_mov_b64 vcc, s[80:81]
s_nop 0
v_cndmask_b32_dpp v108, v96, v92, vcc quad_perm:[1,0,3,2] row_mask:0xf bank_mask:0xf
v_cndmask_b32_dpp v109, v97, v93, vcc quad_perm:[1,0,3,2] row_mask:0xf bank_mask:0xf
v_cndmask_b32_dpp v110, v98, v94, vcc quad_perm:[1,0,3,2] row_mask:0xf bank_mask:0xf
v_cndmask_b32_dpp v111, v99, v95, vcc quad_perm:[1,0,3,2] row_mask:0xf bank_mask:0xf
buffer_store_dwordx4 v[108:111], v4, s[20:23], s46 offen offset:0 sc1
s_mov_b64 vcc, s[82:83]
v_cvt_pk_bf16_f32 v112, v40, v41
v_cvt_pk_bf16_f32 v113, v42, v43
ds_bpermute_b32 v112, v6, v112
ds_bpermute_b32 v113, v6, v113
v_cndmask_b32_dpp v96, v92, v96, vcc quad_perm:[1,0,3,2] row_mask:0xf bank_mask:0xf
v_cndmask_b32_dpp v97, v93, v97, vcc quad_perm:[1,0,3,2] row_mask:0xf bank_mask:0xf
v_cndmask_b32_dpp v98, v94, v98, vcc quad_perm:[1,0,3,2] row_mask:0xf bank_mask:0xf
v_cndmask_b32_dpp v99, v95, v99, vcc quad_perm:[1,0,3,2] row_mask:0xf bank_mask:0xf
buffer_store_dwordx4 v[96:99], v4, s[20:23], s46 offen offset:1152 sc1
s_mov_b64 vcc, s[80:81]
v_cvt_pk_bf16_f32 v106, v36, v37
v_cvt_pk_bf16_f32 v107, v38, v39
v_cndmask_b32_dpp v92, v104, v100, vcc quad_perm:[1,0,3,2] row_mask:0xf bank_mask:0xf
v_cndmask_b32_dpp v93, v105, v101, vcc quad_perm:[1,0,3,2] row_mask:0xf bank_mask:0xf
v_cndmask_b32_dpp v94, v106, v102, vcc quad_perm:[1,0,3,2] row_mask:0xf bank_mask:0xf
v_cndmask_b32_dpp v95, v107, v103, vcc quad_perm:[1,0,3,2] row_mask:0xf bank_mask:0xf
buffer_store_dwordx4 v[92:95], v4, s[20:23], s46 offen offset:128 sc1
s_mov_b64 vcc, s[82:83]
v_cndmask_b32_dpp v104, v100, v104, vcc quad_perm:[1,0,3,2] row_mask:0xf bank_mask:0xf
v_cndmask_b32_dpp v105, v101, v105, vcc quad_perm:[1,0,3,2] row_mask:0xf bank_mask:0xf
v_cndmask_b32_dpp v106, v102, v106, vcc quad_perm:[1,0,3,2] row_mask:0xf bank_mask:0xf
v_cndmask_b32_dpp v107, v103, v107, vcc quad_perm:[1,0,3,2] row_mask:0xf bank_mask:0xf
buffer_store_dwordx4 v[104:107], v4, s[20:23], s46 offen offset:1280 sc1
s_mov_b64 vcc, s[80:81]
s_waitcnt lgkmcnt(0)
buffer_store_dwordx2 v[112:113], v5, s[20:23], s46 offen
s_add_u32 s45, s45, s13
s_add_u32 s7, s7, s13
s_add_u32 s46, s46, s13
s_mov_b32 s13, 4718592
s_add_u32 s41, s41, 1
s_cmp_lt_u32 s41, s15
s_cbranch_scc1 L_stile
s_branch L_fin
.section .rodata,"a"
.p2align 6
.amdhsa_kernel standalone__structured_sparse_n_m__ragged_kernel
  .amdhsa_next_free_vgpr 512
  .amdhsa_next_free_sgpr 102
  .amdhsa_accum_offset 256
  .amdhsa_group_segment_fixed_size 0
  .amdhsa_float_denorm_mode_32 3
  .amdhsa_kernarg_size 48
  .amdhsa_user_sgpr_count 2
  .amdhsa_user_sgpr_kernarg_segment_ptr 1
  .amdhsa_system_sgpr_workgroup_id_x 1
.end_amdhsa_kernel
```

```asm
; @launch grid=(256,1,1) block=(256,1,1) lds=163840
.amdgcn_target "amdgcn-amd-amdhsa--gfx950"
.text
.globl standalone__structured_sparse_n_m__ragged_kernel
.p2align 8
.type standalone__structured_sparse_n_m__ragged_kernel,@function
standalone__structured_sparse_n_m__ragged_kernel:
s_load_dwordx8 s[4:11], s[0:1], 0
s_load_dwordx4 s[12:15], s[0:1], 32
s_cmp_ge_u32 s2, 256
s_cbranch_scc1 L_end_standalone__structured_sparse_n_m__ragged_kernel
v_lshlrev_b32 v3, 7, v0
s_getpc_b64 s[96:97]
v_min_u32 v2, L_slow-standalone__structured_sparse_n_m__ragged_kernel, v3
global_load_dword v120, v2, s[96:97]
v_lshrrev_b32 v1, 6, v0
v_and_b32 v7, 63, v0
v_readfirstlane_b32 s40, v1
s_mov_b32 s86, 0
s_bfe_u32 s84, s2, 0x20003
s_mul_i32 s84, s84, 2
s_and_b32 s47, s2, 7
s_add_u32 s84, s84, s47
s_lshr_b32 s3, s2, 5
s_lshl3_add_u32 s84, s84, s3
s_cmp_lt_u32 s47, 2
s_cselect_b32 s84, s84, 63
s_cmp_lt_u32 s84, 41
s_cbranch_scc1 L_prod
s_mov_b32 s85, 0x800020
s_mov_b32 s47, 0x800020
s_bitcmp1_b32 s2, 3
s_cselect_b32 s85, s85, 0x230003c
s_cselect_b32 s47, s47, 0x230003c
s_bitcmp1_b32 s2, 4
s_cselect_b32 s85, s47, s85
v_lshrrev_b32 v72, 3, v7
v_and_b32 v73, 7, v7
v_xor_b32 v73, v73, v72
v_mul_u32_u24 v72, 1152, v72
s_and_b32 s47, s40, 1
s_mul_i32 s47, s47, 9216
s_lshr_b32 s3, s40, 1
s_lshl_b32 s3, s3, 7
s_add_u32 s47, s47, s3
v_lshl_add_u32 v72, v73, 4, v72
v_add_u32 v3, s47, v72
s_lshl_b32 s44, s40, 10
s_mul_i32 s45, s2, 18432
s_mov_b32 s46, s45
s_waitcnt lgkmcnt(0)
s_mov_b32 s30, 663552
s_mov_b32 s31, 0x20000
s_mov_b32 s28, s6
s_and_b32 s29, s7, 0xffff
s_mov_b32 s18, 75497472
s_mov_b32 s19, 0x20000
s_mov_b32 s16, s4
s_and_b32 s17, s5, 0xffff
s_mov_b32 s26, 301989888
s_mov_b32 s27, 0x20000
s_mov_b32 s24, s14
s_and_b32 s25, s15, 0xffff
s_mov_b32 s34, 1152
s_mov_b32 s35, 0x20000
s_mov_b32 s32, s8
s_and_b32 s33, s9, 0xffff
s_mov_b32 s22, 0
s_mov_b32 s23, 0x20000
s_mov_b32 s20, s10
s_and_b32 s21, s11, 0xffff
s_mov_b32 s38, 256
s_mov_b32 s39, 0x20000
s_mov_b32 s36, s12
s_and_b32 s37, s13, 0xffff
L_cons3:
s_lshr_b32 s47, s40, 1
s_lshl_b32 s3, s47, 11
s_sub_u32 s8, 15488, s3
s_lshl_b32 s3, s47, 7
s_add_u32 s7, s45, 128
s_sub_u32 s7, s7, s3
s_sub_u32 s10, s47, 1
s_sub_u32 s11, 0, s47
s_mov_b32 s9, s44
s_mov_b32 s13, 4718592
s_mov_b32 s15, 16
s_mov_b32 s14, s13
s_bfe_u32 s88, s85, 0x40014
L_pf:
s_add_u32 m0, s44, 0
s_nop 0
buffer_load_dwordx4 v3, s[16:19], s45 offen offset:0 nt lds
s_add_u32 m0, s44, 3840
s_nop 0
buffer_load_dwordx4 v3, s[16:19], s45 offen offset:256 nt lds
s_add_u32 m0, s44, 7680
s_nop 0
buffer_load_dwordx4 v3, s[16:19], s45 offen offset:512 nt lds
s_add_u32 m0, s44, 11520
s_nop 0
buffer_load_dwordx4 v3, s[16:19], s45 offen offset:768 nt lds
s_add_u32 m0, s44, s8
s_mov_b64 exec, s[10:11]
buffer_load_dwordx4 v3, s[16:19], s7 offen offset:896 nt lds
s_mov_b64 exec, -1
s_add_u32 s7, s7, s13
s_add_u32 s44, s44, 18560
s_add_u32 s45, s45, s13
s_mov_b32 s13, 4718592
s_sub_u32 s88, s88, 1
s_cmp_lg_u32 s88, 0
s_cbranch_scc1 L_pf
L_pf_e:
s_branch L_rest
L_prod:
s_and_b32 s48, s84, 3
s_lshr_b32 s49, s84, 2
s_sub_u32 s50, s84, 36
s_lshl_b32 s51, s40, 4
s_lshl_b32 s52, s50, 1
s_lshl_b32 s53, s48, 8
s_cmp_lt_u32 s84, 36
s_cselect_b32 s52, s49, s52
s_cselect_b32 s53, s53, 1024
s_cselect_b32 s54, 8, 73728
s_cselect_b32 s55, 32, 8
s_cselect_b32 s56, 16, 32
s_cselect_b32 s57, 128, 64
s_mul_i32 s52, s52, 73728
s_mul_i32 s58, s40, 18432
v_and_b32 v58, 1, v7
v_bfe_u32 v59, v7, 1, 1
v_bfe_u32 v60, v7, 2, 2
v_bfe_u32 v62, v7, 4, 1
v_lshrrev_b32 v63, 5, v7
v_lshl_add_u32 v50, v58, 2, s52
v_mad_u32_u24 v50, v59, s54, v50
v_mad_u32_u24 v50, v60, s55, v50
v_mad_u32_u24 v50, v62, s56, v50
v_mad_u32_u24 v50, v63, s57, v50
v_add_u32 v50, s53, v50
v_add_u32 v50, s58, v50
v_add_u32 v62, 4608, v50
v_add_u32 v63, 9216, v50
v_add_u32 v64, 13824, v50
s_waitcnt lgkmcnt(0)
s_mov_b32 s30, 663552
s_mov_b32 s31, 0x20000
s_mov_b32 s28, s6
s_and_b32 s29, s7, 0xffff
buffer_load_dword v8, v50, s[28:31], 0 offen offset:0
buffer_load_dword v9, v50, s[28:31], 0 offen offset:1152
buffer_load_dword v10, v50, s[28:31], 0 offen offset:2304
buffer_load_dword v11, v50, s[28:31], 0 offen offset:3456
buffer_load_dword v12, v62, s[28:31], 0 offen offset:0
buffer_load_dword v13, v62, s[28:31], 0 offen offset:1152
buffer_load_dword v14, v62, s[28:31], 0 offen offset:2304
buffer_load_dword v15, v62, s[28:31], 0 offen offset:3456
buffer_load_dword v16, v63, s[28:31], 0 offen offset:0
buffer_load_dword v17, v63, s[28:31], 0 offen offset:1152
buffer_load_dword v18, v63, s[28:31], 0 offen offset:2304
buffer_load_dword v19, v63, s[28:31], 0 offen offset:3456
buffer_load_dword v20, v64, s[28:31], 0 offen offset:0
buffer_load_dword v21, v64, s[28:31], 0 offen offset:1152
buffer_load_dword v22, v64, s[28:31], 0 offen offset:2304
buffer_load_dword v23, v64, s[28:31], 0 offen offset:3456
s_mov_b32 s18, 75497472
s_mov_b32 s19, 0x20000
s_mov_b32 s16, s4
s_and_b32 s17, s5, 0xffff
s_mov_b32 s26, 301989888
s_mov_b32 s27, 0x20000
s_mov_b32 s24, s14
s_and_b32 s25, s15, 0xffff
s_mov_b32 s34, 1152
s_mov_b32 s35, 0x20000
s_mov_b32 s32, s8
s_and_b32 s33, s9, 0xffff
s_mov_b32 s22, 0
s_mov_b32 s23, 0x20000
s_mov_b32 s20, s10
s_and_b32 s21, s11, 0xffff
s_mov_b32 s38, 256
s_mov_b32 s39, 0x20000
s_mov_b32 s36, s12
s_and_b32 s37, s13, 0xffff
s_mul_i32 s52, s48, 9
s_add_u32 s52, s52, s49
s_mul_i32 s53, s52, 9
s_mul_i32 s54, s50, 18
s_add_u32 s54, s54, 8
s_lshl_b32 s55, s52, 2
s_add_u32 s55, s55, s40
s_lshl_b32 s56, s50, 2
s_add_u32 s56, s56, s40
s_cmp_eq_u32 s84, 40
s_cselect_b32 s57, 0x100000, 9
s_cmp_lt_u32 s84, 36
s_cselect_b32 s53, s53, s54
s_cselect_b32 s54, 2, 81
s_cselect_b32 s57, 1, s57
s_cselect_b32 s55, s55, s56
s_mov_b32 s56, 331776
s_cselect_b32 s56, s56, 368640
s_mov_b32 s58, 373760
s_cselect_b32 s58, s58, 382976
s_cselect_b32 s59, 16, 4
s_cselect_b32 s60, 4, 64
s_cselect_b32 s61, 12, 11
s_cselect_b32 s62, 1, 0x8001
v_lshrrev_b32 v61, 4, v7
v_lshlrev_b32 v62, 1, v58
v_lshl_add_u32 v60, v60, 2, v62
v_add_u32 v62, v60, v59
v_mul_u32_u24 v51, s54, v61
v_add_lshl_u32 v51, v51, s53, 6
v_add3_u32 v51, v51, v62, s51
v_lshl_add_u32 v51, v51, 4, s86
s_lshl_b32 s57, s57, 10
v_add_u32 v66, s57, v51
s_lshl_b32 s52, s55, 8
s_add_u32 s52, s52, s56
s_add_u32 s52, s52, s86
v_mul_u32_u24 v52, s59, v62
v_mad_u32_u24 v52, v61, s60, v52
v_add_u32 v52, s52, v52
s_lshr_b32 s52, s55, 2
s_lshl_b32 s52, s52, 8
s_add_u32 s58, s58, s52
s_add_u32 s58, s58, s51
s_lshl_b32 s52, s51, 1
s_add_u32 s52, s52, s62
v_lshl_add_u32 v62, v61, 1, v59
v_lshlrev_b32 v62, s61, v62
v_lshl_add_u32 v53, v60, 7, v62
v_add_u32 v53, s52, v53
v_and_b32 v62, 12, v7
v_mad_u32_u24 v62, v62, 3, v7
v_lshl_add_u32 v65, v62, 2, s58
s_lshl_b32 s52, s84, 2
s_add_u32 s52, s52, s40
s_lshl_b32 s52, s52, 7
s_add_u32 s52, s52, 268435456
v_writelane_b32 v65, s52, 16
s_mov_b32 s75, 0
s_mov_b32 s73, 0x05060100
s_mov_b32 s74, 0xffff
v_mov_b32 v55, 0x05040100
v_mov_b32 v62, 0x03020706
v_cmp_eq_u32 vcc, 1, v59
v_mov_b32 v68, 0xf0a0500
v_mov_b32 v69, 0x8f8a8580
v_mov_b32 v70, 0x1f1a1510
v_mov_b32 v71, 0x9f9a9590
v_mov_b32 v72, 0x2f2a2520
v_mov_b32 v73, 0xafaaa5a0
v_mov_b32 v74, 0x3f3a3530
v_mov_b32 v75, 0xbfbab5b0
v_cndmask_b32 v55, v55, v62, vcc
v_mov_b64 v[76:77], 0
v_mov_b64 v[78:79], 0
v_mov_b64 v[80:81], 0
v_mov_b32 v82, 0
s_mov_b32 s64, 0x5040500
s_mov_b32 s65, 0x5040501
s_mov_b32 s66, 0x5040502
s_mov_b32 s67, 0x5040503
s_mov_b32 s68, 0x7060700
s_mov_b32 s69, 0x7060701
s_mov_b32 s70, 0x7060702
s_mov_b32 s71, 0x7060703
s_mov_b32 s72, 0x05060102
s_waitcnt vmcnt(12)
v_perm_b32 v24, v8, v68, s64
v_perm_b32 v25, v9, v68, s65
v_perm_b32 v26, v10, v68, s66
v_perm_b32 v27, v11, v68, s67
v_max3_f32 v28, |v24|, |v25|, |v26|
v_med3_f32 v29, |v24|, |v25|, |v26|
v_min3_f32 v30, |v24|, |v25|, |v26|
v_med3_f32 v32, v28, v29, |v27|
v_med3_f32 v33, v29, v30, |v27|
v_max_f32 v31, v28, |v27|
v_perm_b32 v36, v31, v32, s72
v_bfi_b32 v44, 3, v32, v31
v_cmpx_eq_u32_sdwa vcc, v33, v32 src0_sel:WORD_1 src1_sel:WORD_1
v_mov_b32 v76, v33
v_min_f32 v77, v30, |v27|
s_mov_b64 exec, -1
v_perm_b32 v24, v8, v69, s68
v_perm_b32 v25, v9, v69, s69
v_perm_b32 v26, v10, v69, s70
v_perm_b32 v27, v11, v69, s71
v_max3_f32 v28, |v24|, |v25|, |v26|
v_med3_f32 v29, |v24|, |v25|, |v26|
v_min3_f32 v30, |v24|, |v25|, |v26|
v_med3_f32 v32, v28, v29, |v27|
v_med3_f32 v33, v29, v30, |v27|
v_max_f32 v31, v28, |v27|
v_perm_b32 v40, v31, v32, s72
v_bfi_b32 v46, 3, v32, v31
v_cmpx_eq_u32_sdwa vcc, v33, v32 src0_sel:WORD_1 src1_sel:WORD_1
v_mov_b64 v[78:79], v[76:77]
v_mov_b32 v76, v33
v_min_f32 v77, v30, |v27|
s_mov_b64 exec, -1
s_waitcnt vmcnt(8)
v_perm_b32 v24, v12, v70, s64
v_perm_b32 v25, v13, v70, s65
v_perm_b32 v26, v14, v70, s66
v_perm_b32 v27, v15, v70, s67
v_max3_f32 v28, |v24|, |v25|, |v26|
v_med3_f32 v29, |v24|, |v25|, |v26|
v_min3_f32 v30, |v24|, |v25|, |v26|
v_med3_f32 v32, v28, v29, |v27|
v_med3_f32 v33, v29, v30, |v27|
v_max_f32 v31, v28, |v27|
v_perm_b32 v37, v31, v32, s72
v_bfi_b32 v31, 3, v32, v31
v_lshlrev_b32 v31, 4, v31
v_bfi_b32 v44, 15, v44, v31
v_cmpx_eq_u32_sdwa vcc, v33, v32 src0_sel:WORD_1 src1_sel:WORD_1
v_mov_b64 v[80:81], v[78:79]
v_mov_b64 v[78:79], v[76:77]
v_mov_b32 v76, v33
v_min_f32 v77, v30, |v27|
s_mov_b64 exec, -1
v_perm_b32 v24, v12, v71, s68
v_perm_b32 v25, v13, v71, s69
v_perm_b32 v26, v14, v71, s70
v_perm_b32 v27, v15, v71, s71
v_max3_f32 v28, |v24|, |v25|, |v26|
v_med3_f32 v29, |v24|, |v25|, |v26|
v_min3_f32 v30, |v24|, |v25|, |v26|
v_med3_f32 v32, v28, v29, |v27|
v_med3_f32 v33, v29, v30, |v27|
v_max_f32 v31, v28, |v27|
v_perm_b32 v41, v31, v32, s72
v_bfi_b32 v31, 3, v32, v31
v_lshlrev_b32 v31, 4, v31
v_bfi_b32 v46, 15, v46, v31
v_cmpx_eq_u32_sdwa vcc, v33, v32 src0_sel:WORD_1 src1_sel:WORD_1
v_or_b32 v82, v82, v80
v_mov_b64 v[80:81], v[78:79]
v_mov_b64 v[78:79], v[76:77]
v_mov_b32 v76, v33
v_min_f32 v77, v30, |v27|
s_mov_b64 exec, -1
s_waitcnt vmcnt(4)
v_perm_b32 v24, v16, v72, s64
v_perm_b32 v25, v17, v72, s65
v_perm_b32 v26, v18, v72, s66
v_perm_b32 v27, v19, v72, s67
v_max3_f32 v28, |v24|, |v25|, |v26|
v_med3_f32 v29, |v24|, |v25|, |v26|
v_min3_f32 v30, |v24|, |v25|, |v26|
v_med3_f32 v32, v28, v29, |v27|
v_med3_f32 v33, v29, v30, |v27|
v_max_f32 v31, v28, |v27|
v_perm_b32 v38, v31, v32, s72
v_bfi_b32 v45, 3, v32, v31
v_cmpx_eq_u32_sdwa vcc, v33, v32 src0_sel:WORD_1 src1_sel:WORD_1
v_or_b32 v82, v82, v80
v_mov_b64 v[80:81], v[78:79]
v_mov_b64 v[78:79], v[76:77]
v_mov_b32 v76, v33
v_min_f32 v77, v30, |v27|
s_mov_b64 exec, -1
v_perm_b32 v24, v16, v73, s68
v_perm_b32 v25, v17, v73, s69
v_perm_b32 v26, v18, v73, s70
v_perm_b32 v27, v19, v73, s71
v_max3_f32 v28, |v24|, |v25|, |v26|
v_med3_f32 v29, |v24|, |v25|, |v26|
v_min3_f32 v30, |v24|, |v25|, |v26|
v_med3_f32 v32, v28, v29, |v27|
v_med3_f32 v33, v29, v30, |v27|
v_max_f32 v31, v28, |v27|
v_perm_b32 v42, v31, v32, s72
v_bfi_b32 v47, 3, v32, v31
v_cmpx_eq_u32_sdwa vcc, v33, v32 src0_sel:WORD_1 src1_sel:WORD_1
v_or_b32 v82, v82, v80
v_mov_b64 v[80:81], v[78:79]
v_mov_b64 v[78:79], v[76:77]
v_mov_b32 v76, v33
v_min_f32 v77, v30, |v27|
s_mov_b64 exec, -1
s_waitcnt vmcnt(0)
v_perm_b32 v24, v20, v74, s64
v_perm_b32 v25, v21, v74, s65
v_perm_b32 v26, v22, v74, s66
v_perm_b32 v27, v23, v74, s67
v_max3_f32 v28, |v24|, |v25|, |v26|
v_med3_f32 v29, |v24|, |v25|, |v26|
v_min3_f32 v30, |v24|, |v25|, |v26|
v_med3_f32 v32, v28, v29, |v27|
v_med3_f32 v33, v29, v30, |v27|
v_max_f32 v31, v28, |v27|
v_perm_b32 v39, v31, v32, s72
v_bfi_b32 v31, 3, v32, v31
v_lshlrev_b32 v31, 4, v31
v_bfi_b32 v45, 15, v45, v31
v_cmpx_eq_u32_sdwa vcc, v33, v32 src0_sel:WORD_1 src1_sel:WORD_1
v_or_b32 v82, v82, v80
v_mov_b64 v[80:81], v[78:79]
v_mov_b64 v[78:79], v[76:77]
v_mov_b32 v76, v33
v_min_f32 v77, v30, |v27|
s_mov_b64 exec, -1
v_perm_b32 v24, v20, v75, s68
v_perm_b32 v25, v21, v75, s69
v_perm_b32 v26, v22, v75, s70
v_perm_b32 v27, v23, v75, s71
v_max3_f32 v28, |v24|, |v25|, |v26|
v_med3_f32 v29, |v24|, |v25|, |v26|
v_min3_f32 v30, |v24|, |v25|, |v26|
v_med3_f32 v32, v28, v29, |v27|
v_med3_f32 v33, v29, v30, |v27|
v_max_f32 v31, v28, |v27|
v_perm_b32 v43, v31, v32, s72
v_bfi_b32 v31, 3, v32, v31
v_lshlrev_b32 v31, 4, v31
v_bfi_b32 v47, 15, v47, v31
v_cmpx_eq_u32_sdwa vcc, v33, v32 src0_sel:WORD_1 src1_sel:WORD_1
v_or_b32 v82, v82, v80
v_mov_b64 v[80:81], v[78:79]
v_mov_b64 v[78:79], v[76:77]
v_mov_b32 v76, v33
v_min_f32 v77, v30, |v27|
s_mov_b64 exec, -1
s_mov_b32 vcc_lo, 0x33333333
s_mov_b32 vcc_hi, 0x33333333
v_cndmask_b32_dpp v24, v40, v36, vcc quad_perm:[2,3,0,1] row_mask:0xf bank_mask:0xf
v_cndmask_b32_dpp v25, v41, v37, vcc quad_perm:[2,3,0,1] row_mask:0xf bank_mask:0xf
v_cndmask_b32_dpp v26, v42, v38, vcc quad_perm:[2,3,0,1] row_mask:0xf bank_mask:0xf
v_cndmask_b32_dpp v27, v43, v39, vcc quad_perm:[2,3,0,1] row_mask:0xf bank_mask:0xf
s_not_b64 vcc, vcc
buffer_store_dwordx4 v[24:27], v51, s[24:27], 0 offen sc1
v_cndmask_b32_dpp v40, v36, v40, vcc quad_perm:[2,3,0,1] row_mask:0xf bank_mask:0xf
v_cndmask_b32_dpp v41, v37, v41, vcc quad_perm:[2,3,0,1] row_mask:0xf bank_mask:0xf
v_cndmask_b32_dpp v42, v38, v42, vcc quad_perm:[2,3,0,1] row_mask:0xf bank_mask:0xf
v_cndmask_b32_dpp v43, v39, v43, vcc quad_perm:[2,3,0,1] row_mask:0xf bank_mask:0xf
s_mov_b32 s52, 0x0c0c0400
s_mov_b32 s53, 0x04000c0c
buffer_store_dwordx4 v[40:43], v66, s[24:27], 0 offen sc1
v_perm_b32 v48, v45, v44, s52
v_perm_b32 v49, v47, v46, s53
v_or_b32 v48, v48, v49
s_nop 1
v_mov_b32_dpp v49, v48 quad_perm:[2,3,0,1] row_mask:0xf bank_mask:0xf
v_perm_b32 v48, v49, v48, v55
buffer_store_dword v48, v52, s[24:27], 0 offen sc1
v_cmp_lt_u32 s[50:51], s74, v82
L_emit:
v_cmp_lt_u32 vcc, s74, v76
v_cmp_eq_u32_sdwa s[48:49], v77, v76 src0_sel:WORD_1 src1_sel:WORD_1
v_perm_b32 v63, v76, v53, s73
v_bfe_u32 v62, v76, 2, 4
v_and_b32 v64, 0x80, v76
v_lshl_add_u32 v63, v62, 1, v63
v_mbcnt_lo_u32_b32 v62, vcc_lo, 0
v_mbcnt_hi_u32_b32 v62, vcc_hi, v62
v_add_u32 v63, v64, v63
v_add_u32 v62, s75, v62
s_bcnt1_i32_b64 s52, vcc
s_add_u32 s75, s75, s52
v_cmp_gt_u32 s[52:53], 15, v62
v_and_b32 v64, 12, v62
v_mad_u32_u24 v62, v64, 3, v62
v_lshl_add_u32 v62, v62, 2, s58
s_and_b64 s[48:49], s[48:49], vcc
s_and_b64 exec, s[52:53], vcc
s_cbranch_execz L_emit1
buffer_store_dword v63, v62, s[24:27], 0 offen sc1
L_emit1:
s_mov_b64 exec, s[48:49]
v_mov_b32 v76, v77
v_mov_b32 v77, 0
s_not_b64 exec, exec
v_mov_b64 v[76:77], v[78:79]
v_mov_b64 v[78:79], v[80:81]
v_mov_b64 v[80:81], 0
s_mov_b64 exec, -1
v_or3_b32 v62, v76, v78, v80
v_cmp_lt_u32 vcc, s74, v62
s_cmp_lg_u64 s[50:51], 0
s_cselect_b32 s52, 99, s75
s_cmp_gt_u32 s52, 15
s_cselect_b32 s52, -1, 0
s_min_u32 s53, s75, 15
s_cbranch_vccnz L_emit
s_lshl_b32 s53, -1, s53
v_mov_b32 v62, s52
s_and_b32 exec_lo, s53, 131071
s_mov_b32 exec_hi, 0
buffer_store_dword v62, v65, s[24:27], 0 offen sc1
s_mov_b64 exec, -1
s_waitcnt vmcnt(0)
s_mov_b32 s85, 0x230003c
s_barrier
s_cmp_lg_u32 s40, 0
s_cbranch_scc1 L_cons2
v_mov_b32 v8, 1
s_mov_b64 exec, 1
buffer_atomic_add v8, off, s[36:39], 0 offset:128 sc0 sc1
v_mov_b32 v9, 1
s_waitcnt vmcnt(0)
v_readfirstlane_b32 s47, v8
s_nop 3
s_cmp_lg_u32 s47, 40
s_cbranch_scc1 L_notlast
buffer_store_dword v9, off, s[36:39], 0 sc1
L_notlast:
s_mov_b64 exec, -1
L_cons2:
v_lshrrev_b32 v72, 3, v7
v_and_b32 v73, 7, v7
v_xor_b32 v73, v73, v72
v_mul_u32_u24 v72, 1152, v72
s_and_b32 s47, s40, 1
s_mul_i32 s47, s47, 9216
s_lshr_b32 s3, s40, 1
s_lshl_b32 s3, s3, 7
s_add_u32 s47, s47, s3
v_lshl_add_u32 v72, v73, 4, v72
v_add_u32 v3, s47, v72
s_lshl_b32 s44, s40, 10
s_mul_i32 s45, s2, 18432
s_mov_b32 s46, s45
s_barrier
s_branch L_cons3
L_rest:
s_mov_b32 s92, 0x80
s_mov_b32 s47, 0x80
s_bitcmp1_b32 s2, 3
s_cselect_b32 s92, s92, 0x88
s_cselect_b32 s47, s47, 0x88
s_bitcmp1_b32 s2, 4
s_cselect_b32 s92, s47, s92
s_mov_b32 s3, 0x88
s_cmp_lt_u32 s84, 41
s_cselect_b32 s92, s3, s92
s_mov_b32 s87, 0x80
s_mov_b32 s3, 0x80
s_cmp_lt_u32 s84, 41
s_cselect_b32 s87, s3, s87
v_and_b32 v80, 3, v7
v_bfe_u32 v81, v7, 2, 2
v_bfe_u32 v82, v7, 4, 1
v_lshlrev_b32 v81, 3, v81
v_lshl_add_u32 v81, v80, 5, v81
v_lshl_add_u32 v81, v82, 7, v81
s_lshl_b32 s47, s40, 8
v_add_u32 v81, s47, v81
s_lshl_b32 s47, s40, 5
s_add_u32 s47, s47, 1024
v_lshl_add_u32 v80, v80, 3, s47
v_cmp_gt_u32 vcc, 32, v7
s_nop 1
v_cndmask_b32 v80, v80, v81, vcc
buffer_load_dwordx2 v[110:111], v80, s[32:35], 0 offen
v_and_b32 v72, 15, v7
v_lshrrev_b32 v73, 4, v7
v_and_b32 v74, 7, v7
v_xor_b32 v74, v74, v73
v_lshlrev_b32 v74, 4, v74
v_lshl_add_u32 v0, v72, 7, v74
v_xor_b32 v1, 64, v0
s_mul_i32 s93, s40, 3584
s_add_u32 s93, s93, 148480
v_lshl_add_u32 v2, v73, 4, s93
v_and_b32 v74, 14, v7
v_mul_u32_u24 v4, 1152, v74
v_and_b32 v74, 1, v7
v_lshl_add_u32 v4, v74, 4, v4
v_lshl_add_u32 v4, v73, 5, v4
s_lshl_b32 s47, s40, 8
v_add_u32 v4, s47, v4
s_lshl_b32 s47, s40, 5
s_add_u32 s47, s47, 1024
v_lshrrev_b32 v72, 2, v7
v_and_b32 v73, 3, v7
v_lshl_add_u32 v6, v73, 4, v72
v_lshlrev_b32 v6, 2, v6
v_mul_u32_u24 v5, 1152, v72
v_lshl_add_u32 v5, v73, 3, v5
v_add_u32 v5, s47, v5
s_mov_b32 s80, 0x55555555
s_mov_b32 s81, 0x55555555
s_mov_b32 s82, 0xaaaaaaaa
s_mov_b32 s83, 0xaaaaaaaa
v_lshl_add_u32 v109, v7, 4, s93
v_lshl_add_u32 v89, v7, 2, s93
v_mov_b32 v76, 0
v_mov_b32 v77, 0
v_mov_b32 v78, 0
v_mov_b32 v79, 0
v_mov_b32 v90, 0xdddddddd
ds_write_b128 v109, v[76:79]
ds_write_b32 v89, v90 offset:1792
ds_write_b32 v89, v90 offset:2048
ds_write_b32 v89, v90 offset:2304
ds_write_b32 v89, v90 offset:2560
ds_write_b32 v89, v90 offset:2816
ds_write_b32 v89, v90 offset:3072
ds_write_b32 v89, v90 offset:3328
s_lshl_b32 s47, s40, 2
s_add_u32 s47, s47, 163072
v_mov_b32 v88, s47
ds_write_b32 v88, v76
s_mul_i32 s47, s40, 2304
s_add_u32 s47, s47, 373760
v_and_b32 v73, 60, v7
v_mad_u32_u24 v73, v73, 3, v7
v_lshl_add_u32 v72, v73, 4, s47
s_mov_b32 s47, 380672
v_lshl_add_u32 v73, v73, 4, s47
v_lshrrev_b32 v74, 2, v7
v_cmp_gt_u32 vcc, 36, v7
v_lshlrev_b32 v90, 11, v74
v_subrev_u32 v74, 9, v74
v_lshlrev_b32 v74, 12, v74
v_cndmask_b32 v72, v73, v72, vcc
v_cndmask_b32 v90, v74, v90, vcc
s_lshl_b32 s47, s40, 12
s_add_u32 s47, s47, 0x8001
v_mov_b32 v88, 1
v_mov_b32 v94, 0xf001
v_mov_b32 v95, s47
v_cndmask_b32 v94, v94, v88, vcc
v_cndmask_b32 v95, v95, v88, vcc
v_cndmask_b32 v96, 0, 28, vcc
v_cndmask_b32 v97, 32, 0, vcc
v_add_u32 v97, s93, v97
v_cmp_gt_u32 vcc, 56, v7
v_mov_b32 v73, 0x40000000
s_lshr_b32 s47, s2, 3
s_lshl_b32 s47, s47, 2
s_add_u32 s47, s47, s40
s_mul_i32 s47, s47, 3072
v_cndmask_b32 v72, v73, v72, vcc
v_lshl_add_u32 v93, v7, 4, s47
s_mul_i32 s47, s40, 82944
s_add_u32 s47, s47, s86
v_lshl_add_u32 v112, v7, 4, s47
s_mul_i32 s47, s40, 9216
s_add_u32 s47, s47, s86
s_add_u32 s47, s47, 331776
v_lshl_add_u32 v113, v7, 4, s47
s_lshl_b32 s47, s40, 6
s_add_u32 s47, s47, s86
s_add_u32 s47, s47, 368640
v_and_b32 v106, 15, v7
v_lshl_add_u32 v106, v106, 2, s47
v_lshrrev_b32 v107, 4, v7
v_lshl_add_u32 v106, v107, 8, v106
v_and_b32 v74, 15, v7
v_and_b32 v73, 7, v7
v_lshlrev_b32 v100, 1, v73
v_lshlrev_b32 v100, v100, v88
v_lshlrev_b32 v73, 4, v73
v_lshl_add_u32 v92, v74, 7, v73
v_lshl_or_b32 v92, v92, 16, v92
v_lshrrev_b32 v98, 5, v7
v_bfe_u32 v99, v7, 3, 2
v_lshl_add_u32 v99, v99, 6, s93
v_lshl_add_u32 v101, v7, 1, s93
v_lshrrev_b32 v102, 4, v7
v_lshl_add_u32 v102, v102, 3, s93
v_lshrrev_b32 v103, 1, v7
v_lshlrev_b32 v103, 5, v103
s_mov_b32 s89, 0
s_cmp_lg_u32 s40, 0
s_cbranch_scc1 L_ready
s_mov_b64 exec, 1
s_mov_b32 s3, 20000
L_poll:
buffer_load_dword v8, off, s[36:39], 0 sc1
s_sub_u32 s3, s3, 1
s_cbranch_scc1 L_giveup
s_waitcnt vmcnt(0)
v_readfirstlane_b32 s47, v8
s_nop 3
s_cmp_eq_u32 s47, 0
s_cbranch_scc1 L_poll
L_polled:
s_mov_b64 exec, -1
L_ready:
s_waitcnt lgkmcnt(0)
s_barrier
buffer_load_dwordx4 v[8:11], v72, s[24:27], 0 offen offset:0 sc1
buffer_load_dwordx4 v[12:15], v72, s[24:27], 0 offen offset:64 sc1
buffer_load_dwordx4 v[16:19], v72, s[24:27], 0 offen offset:128 sc1
buffer_load_dwordx4 v[20:23], v72, s[24:27], 0 offen offset:192 sc1
buffer_load_dwordx4 v[76:79], v93, s[24:27], 0 offen offset:0 sc1
buffer_load_dwordx4 v[80:83], v93, s[24:27], 0 offen offset:1024 sc1
buffer_load_dwordx4 v[84:87], v93, s[24:27], 0 offen offset:2048 sc1
buffer_load_dword v174, v106, s[24:27], 0 offen offset:0 sc1
buffer_load_dword v175, v106, s[24:27], 0 offen offset:1024 sc1
buffer_load_dword v176, v106, s[24:27], 0 offen offset:2048 sc1
buffer_load_dword v177, v106, s[24:27], 0 offen offset:3072 sc1
s_mov_b32 s99, 4096
buffer_load_dword v178, v106, s[24:27], s99 offen offset:0 sc1
s_mov_b32 s98, 0
buffer_load_dwordx4 v[138:141], v113, s[24:27], s98 offen sc1
s_mov_b32 s99, 0
buffer_load_dwordx4 a[0:3], v112, s[24:27], s99 offen offset:0 sc1
buffer_load_dwordx4 a[4:7], v112, s[24:27], s99 offen offset:1024 sc1
buffer_load_dwordx4 a[8:11], v112, s[24:27], s99 offen offset:2048 sc1
s_waitcnt vmcnt(12)
v_cmp_ne_u32 s[90:91], 0, v23
v_cmp_ne_u32 s[78:79], 0, v16
v_and_b32 v73, v94, v8
v_lshrrev_b32 v72, 10, v8
v_cmp_eq_u32 s[48:49], v73, v95
v_and_or_b32 v24, v72, v96, v97
s_mov_b64 exec, s[48:49]
ds_add_rtn_u32 v40, v24, v88
s_mov_b64 exec, -1
v_and_b32 v73, v94, v9
v_lshrrev_b32 v72, 10, v9
v_cmp_eq_u32 s[50:51], v73, v95
v_and_or_b32 v25, v72, v96, v97
s_mov_b64 exec, s[50:51]
ds_add_rtn_u32 v41, v25, v88
s_mov_b64 exec, -1
buffer_load_dwordx4 a[12:15], v112, s[24:27], s99 offen offset:3072 sc1
v_and_b32 v73, v94, v10
v_lshrrev_b32 v72, 10, v10
v_cmp_eq_u32 s[52:53], v73, v95
v_and_or_b32 v26, v72, v96, v97
s_mov_b64 exec, s[52:53]
ds_add_rtn_u32 v42, v26, v88
s_mov_b64 exec, -1
v_and_b32 v73, v94, v11
v_lshrrev_b32 v72, 10, v11
v_cmp_eq_u32 s[54:55], v73, v95
v_and_or_b32 v27, v72, v96, v97
s_mov_b64 exec, s[54:55]
ds_add_rtn_u32 v43, v27, v88
s_mov_b64 exec, -1
s_mov_b32 s99, 4096
buffer_load_dwordx4 a[16:19], v112, s[24:27], s99 offen offset:0 sc1
v_and_b32 v73, v94, v12
v_lshrrev_b32 v72, 10, v12
v_cmp_eq_u32 s[56:57], v73, v95
v_and_or_b32 v28, v72, v96, v97
s_mov_b64 exec, s[56:57]
ds_add_rtn_u32 v44, v28, v88
s_mov_b64 exec, -1
v_and_b32 v73, v94, v13
v_lshrrev_b32 v72, 10, v13
v_cmp_eq_u32 s[58:59], v73, v95
v_and_or_b32 v29, v72, v96, v97
s_mov_b64 exec, s[58:59]
ds_add_rtn_u32 v45, v29, v88
s_mov_b64 exec, -1
buffer_load_dwordx4 a[20:23], v112, s[24:27], s99 offen offset:1024 sc1
v_and_b32 v73, v94, v14
v_lshrrev_b32 v72, 10, v14
v_cmp_eq_u32 s[60:61], v73, v95
v_and_or_b32 v30, v72, v96, v97
s_mov_b64 exec, s[60:61]
ds_add_rtn_u32 v46, v30, v88
s_mov_b64 exec, -1
v_and_b32 v73, v94, v15
v_lshrrev_b32 v72, 10, v15
v_cmp_eq_u32 s[62:63], v73, v95
v_and_or_b32 v31, v72, v96, v97
s_mov_b64 exec, s[62:63]
ds_add_rtn_u32 v47, v31, v88
s_mov_b64 exec, -1
buffer_load_dwordx4 a[24:27], v112, s[24:27], s99 offen offset:2048 sc1
s_cmp_lg_u64 s[78:79], 0
s_cbranch_scc1 L_more1
L_more1b:
ds_read_b32 v72, v89
v_mov_b32 v73, 0
buffer_load_dwordx4 a[28:31], v112, s[24:27], s99 offen offset:3072 sc1
s_mov_b32 s99, 8192
buffer_load_dwordx4 a[32:35], v112, s[24:27], s99 offen offset:0 sc1
s_waitcnt lgkmcnt(0)
s_mov_b64 vcc, s[80:81]
v_cndmask_b32_dpp v73, v72, v73, vcc quad_perm:[0,0,2,2] row_mask:0xf bank_mask:0xf
v_add_u32 v91, v103, v73
v_add_u32 v73, v72, v73
v_cmp_lt_u32 vcc, 32, v73
s_or_b32 s90, s90, s91
s_and_b32 s47, vcc_lo, 0x1ff
s_or_b32 s47, s47, s90
s_cbranch_scc1 L_greedy
L_greedyb:
s_mov_b32 s98, 1024
buffer_load_dwordx4 v[142:145], v113, s[24:27], s98 offen sc1
ds_bpermute_b32 v56, v24, v91
ds_bpermute_b32 v57, v25, v91
ds_bpermute_b32 v58, v26, v91
ds_bpermute_b32 v59, v27, v91
ds_bpermute_b32 v60, v28, v91
ds_bpermute_b32 v61, v29, v91
ds_bpermute_b32 v62, v30, v91
ds_bpermute_b32 v63, v31, v91
buffer_load_dwordx4 a[36:39], v112, s[24:27], s99 offen offset:1024 sc1
buffer_load_dwordx4 a[40:43], v112, s[24:27], s99 offen offset:2048 sc1
s_waitcnt lgkmcnt(7)
v_add_u32 v73, v40, v56
v_and_b32 v72, 0x87e, v8
v_lshl_add_u32 v73, v73, 1, s93
v_add_u32 v72, v90, v72
s_andn2_b64 exec, s[48:49], s[90:91]
ds_write_b16_d16_hi v73, v8 offset:64
ds_write_b16 v73, v72 offset:384
ds_write_b16 v73, v8 offset:704
s_mov_b64 exec, -1
buffer_load_dwordx4 a[44:47], v112, s[24:27], s99 offen offset:3072 sc1
s_waitcnt lgkmcnt(9)
v_add_u32 v73, v41, v57
v_and_b32 v72, 0x87e, v9
v_lshl_add_u32 v73, v73, 1, s93
v_add_u32 v72, v90, v72
s_andn2_b64 exec, s[50:51], s[90:91]
ds_write_b16_d16_hi v73, v9 offset:64
ds_write_b16 v73, v72 offset:384
ds_write_b16 v73, v9 offset:704
s_mov_b64 exec, -1
s_mov_b32 s99, 12288
buffer_load_dwordx4 a[48:51], v112, s[24:27], s99 offen offset:0 sc1
s_waitcnt lgkmcnt(11)
v_add_u32 v73, v42, v58
v_and_b32 v72, 0x87e, v10
v_lshl_add_u32 v73, v73, 1, s93
v_add_u32 v72, v90, v72
s_andn2_b64 exec, s[52:53], s[90:91]
ds_write_b16_d16_hi v73, v10 offset:64
ds_write_b16 v73, v72 offset:384
ds_write_b16 v73, v10 offset:704
s_mov_b64 exec, -1
buffer_load_dwordx4 a[52:55], v112, s[24:27], s99 offen offset:1024 sc1
s_waitcnt lgkmcnt(13)
v_add_u32 v73, v43, v59
v_and_b32 v72, 0x87e, v11
v_lshl_add_u32 v73, v73, 1, s93
v_add_u32 v72, v90, v72
s_andn2_b64 exec, s[54:55], s[90:91]
ds_write_b16_d16_hi v73, v11 offset:64
ds_write_b16 v73, v72 offset:384
ds_write_b16 v73, v11 offset:704
s_mov_b64 exec, -1
s_waitcnt lgkmcnt(15)
v_add_u32 v73, v44, v60
v_and_b32 v72, 0x87e, v12
v_lshl_add_u32 v73, v73, 1, s93
v_add_u32 v72, v90, v72
s_andn2_b64 exec, s[56:57], s[90:91]
ds_write_b16_d16_hi v73, v12 offset:64
ds_write_b16 v73, v72 offset:384
ds_write_b16 v73, v12 offset:704
s_mov_b64 exec, -1
buffer_load_dwordx4 a[56:59], v112, s[24:27], s99 offen offset:2048 sc1
s_waitcnt lgkmcnt(15)
v_add_u32 v73, v45, v61
v_and_b32 v72, 0x87e, v13
v_lshl_add_u32 v73, v73, 1, s93
v_add_u32 v72, v90, v72
s_andn2_b64 exec, s[58:59], s[90:91]
ds_write_b16_d16_hi v73, v13 offset:64
ds_write_b16 v73, v72 offset:384
ds_write_b16 v73, v13 offset:704
s_mov_b64 exec, -1
buffer_load_dwordx4 a[60:63], v112, s[24:27], s99 offen offset:3072 sc1
s_waitcnt lgkmcnt(15)
v_add_u32 v73, v46, v62
v_and_b32 v72, 0x87e, v14
v_lshl_add_u32 v73, v73, 1, s93
v_add_u32 v72, v90, v72
s_andn2_b64 exec, s[60:61], s[90:91]
ds_write_b16_d16_hi v73, v14 offset:64
ds_write_b16 v73, v72 offset:384
ds_write_b16 v73, v14 offset:704
s_mov_b64 exec, -1
s_waitcnt lgkmcnt(15)
v_add_u32 v73, v47, v63
v_and_b32 v72, 0x87e, v15
v_lshl_add_u32 v73, v73, 1, s93
v_add_u32 v72, v90, v72
s_andn2_b64 exec, s[62:63], s[90:91]
ds_write_b16_d16_hi v73, v15 offset:64
ds_write_b16 v73, v72 offset:384
ds_write_b16 v73, v15 offset:704
s_mov_b64 exec, -1
s_mov_b32 s99, 16384
buffer_load_dwordx4 a[64:67], v112, s[24:27], s99 offen offset:0 sc1
s_cmp_lg_u64 s[78:79], 0
s_cbranch_scc1 L_more2
L_more2b:
ds_read_u16 v8, v101 offset:704
ds_read_u16 v9, v101 offset:832
ds_read_u16 v10, v101 offset:960
ds_read2_b64 v[118:121], v102 offset0:48 offset1:52
ds_read2_b64 v[122:125], v102 offset0:56 offset1:60
ds_read2_b64 v[126:129], v102 offset0:64 offset1:68
ds_read2_b64 v[130:133], v102 offset0:72 offset1:76
ds_read2_b64 v[134:137], v102 offset0:80 offset1:84
buffer_load_dwordx4 a[68:71], v112, s[24:27], s99 offen offset:1024 sc1
s_mov_b32 s98, 2048
buffer_load_dwordx4 v[146:149], v113, s[24:27], s98 offen sc1
buffer_load_dwordx4 a[72:75], v112, s[24:27], s99 offen offset:2048 sc1
s_waitcnt lgkmcnt(5)
v_lshrrev_b32 v72, 12, v8
v_cmp_ne_u32 vcc, 0, v8
v_min_u32 v72, 8, v72
v_add3_u32 v72, v72, v98, 0
v_lshlrev_b32 v73, 4, v72
v_lshrrev_b32 v72, 1, v72
v_lshlrev_b32 v73, v73, v100
v_lshl_add_u32 v72, v72, 8, v99
v_bfe_u32 v74, v8, 7, 4
v_lshl_add_u32 v72, v74, 2, v72
s_mov_b64 exec, vcc
ds_xor_b32 v72, v73 offset:1792
s_mov_b64 exec, -1
buffer_load_dwordx4 a[76:79], v112, s[24:27], s99 offen offset:3072 sc1
v_lshrrev_b32 v72, 12, v9
v_cmp_ne_u32 vcc, 0, v9
v_min_u32 v72, 8, v72
v_add3_u32 v72, v72, v98, 2
v_lshlrev_b32 v73, 4, v72
v_lshrrev_b32 v72, 1, v72
v_lshlrev_b32 v73, v73, v100
v_lshl_add_u32 v72, v72, 8, v99
v_bfe_u32 v74, v9, 7, 4
v_lshl_add_u32 v72, v74, 2, v72
s_mov_b64 exec, vcc
ds_xor_b32 v72, v73 offset:1792
s_mov_b64 exec, -1
s_mov_b32 s99, 20480
buffer_load_dwordx4 a[80:83], v112, s[24:27], s99 offen offset:0 sc1
v_lshrrev_b32 v72, 12, v10
v_cmp_ne_u32 vcc, 0, v10
v_min_u32 v72, 8, v72
v_add3_u32 v72, v72, v98, 4
v_lshlrev_b32 v73, 4, v72
v_lshrrev_b32 v72, 1, v72
v_lshlrev_b32 v73, v73, v100
v_lshl_add_u32 v72, v72, 8, v99
v_bfe_u32 v74, v10, 7, 4
v_lshl_add_u32 v72, v74, 2, v72
s_mov_b64 exec, vcc
s_mov_b32 exec_hi, 0
ds_xor_b32 v72, v73 offset:1792
s_mov_b64 exec, -1
buffer_load_dwordx4 a[84:87], v112, s[24:27], s99 offen offset:1024 sc1
ds_read_b32 v179, v89 offset:1792
ds_read_b32 v180, v89 offset:2048
ds_read_b32 v181, v89 offset:2304
ds_read_b32 v182, v89 offset:2560
ds_read_b32 v183, v89 offset:2816
ds_read_b32 v184, v89 offset:3072
ds_read_b32 v185, v89 offset:3328
s_waitcnt lgkmcnt(10)
v_xor_b32 v118, v92, v118
v_xor_b32 v119, v92, v119
v_xor_b32 v120, v92, v120
v_xor_b32 v121, v92, v121
buffer_load_dwordx4 a[88:91], v112, s[24:27], s99 offen offset:2048 sc1
v_xor_b32 v122, v92, v122
v_xor_b32 v123, v92, v123
v_xor_b32 v124, v92, v124
v_xor_b32 v125, v92, v125
v_xor_b32 v126, v92, v126
v_xor_b32 v127, v92, v127
v_xor_b32 v128, v92, v128
v_xor_b32 v129, v92, v129
v_xor_b32 v130, v92, v130
v_xor_b32 v131, v92, v131
v_xor_b32 v132, v92, v132
v_xor_b32 v133, v92, v133
buffer_load_dwordx4 a[92:95], v112, s[24:27], s99 offen offset:3072 sc1
v_xor_b32 v134, v92, v134
v_xor_b32 v135, v92, v135
v_xor_b32 v136, v92, v136
v_xor_b32 v137, v92, v137
v_lshlrev_b32 v114, 16, v110
v_and_b32 v115, 0xffff0000, v110
v_lshlrev_b32 v116, 16, v111
v_and_b32 v117, 0xffff0000, v111
s_mov_b32 exec_hi, 15
ds_write_b128 v109, v[114:117] offset:1024
s_mov_b64 exec, -1
s_mov_b32 s41, 2
s_mov_b32 s42, 0
s_mov_b32 s4, 37120
s_mov_b32 s22, 75497472
s_mov_b32 s5, 18560
s_mov_b32 s6, 4718592
s_mov_b64 vcc, s[80:81]
s_andn2_b32 s12, 63, s85
s_mov_b32 s59, 6
s_add_u32 s48, s46, 9437184
s_add_u32 s49, s48, 4718592
s_add_u32 s50, s49, 4718592
s_sub_u32 s58, s7, s45
s_lshr_b32 s47, s2, 6
s_mul_i32 s57, s47, 1179648
s_add_u32 s57, s57, 47185920
s_lshl_b32 s47, s47, 7
s_add_u32 s47, s47, 268435456
s_add_u32 s32, s24, s47
s_addc_u32 s33, s25, 0
s_cmp_eq_u32 s40, 0
s_cselect_b32 s34, 4, 0
s_cselect_b64 s[62:63], 1, 0
s_waitcnt lgkmcnt(0)
v_mov_b32 v114, 163072
s_barrier
ds_read_b32 v114, v114
ds_read_b128 v[44:47], v0 offset:0
ds_read_b128 v[48:51], v1 offset:0
s_waitcnt vmcnt(18)
ds_read_b128 v[76:79], v2 offset:1024
ds_read_b128 v[80:83], v2 offset:1088
ds_read_b128 v[84:87], v2 offset:1152
ds_read_b128 v[88:91], v2 offset:1216
ds_read_b128 v[92:95], v2 offset:1280
ds_read_b128 v[96:99], v2 offset:1344
ds_read_b128 v[100:103], v2 offset:1408
ds_read_b128 v[104:107], v2 offset:1472
ds_read_b128 v[108:111], v2 offset:1536
s_mov_b32 s99, 24576
buffer_load_dwordx4 a[96:99], v112, s[24:27], s99 offen offset:0 sc1
ds_read_b128 v[8:11], v2 offset:1024
ds_read_b128 v[12:15], v2 offset:1088
ds_read_b128 v[16:19], v2 offset:1152
ds_read_b128 v[20:23], v2 offset:1216
ds_read_b128 v[24:27], v2 offset:1280
ds_read_b128 v[28:31], v2 offset:1344
ds_read_b128 v[32:35], v2 offset:1408
ds_read_b128 v[36:39], v2 offset:1472
ds_read_b128 v[40:43], v2 offset:1536
buffer_load_dwordx4 a[100:103], v112, s[24:27], s99 offen offset:1024 sc1
s_waitcnt lgkmcnt(15)
v_readfirstlane_b32 s47, v114
v_add_u32_sdwa v60, s42, v118 dst_sel:DWORD dst_unused:UNUSED_PAD src0_sel:DWORD src1_sel:WORD_0
s_nop 2
s_cmp_lg_u32 s47, 0
s_cbranch_scc1 L_slow
v_smfmac_f32_16x16x64_bf16 v[76:79], a[0:3], v[44:51], v138
ds_read_b128 v[52:55], v0 offset:18560
ds_read_b128 v[56:59], v1 offset:18560
ds_read_u16 v68, v60 offset:18560
ds_read_u16 v60, v60
v_add_u32_sdwa v61, s42, v118 dst_sel:DWORD dst_unused:UNUSED_PAD src0_sel:DWORD src1_sel:WORD_1
v_smfmac_f32_16x16x64_bf16 v[80:83], a[4:7], v[44:51], v138 abid:1
ds_read_u16 v69, v61 offset:18560
ds_read_u16 v61, v61
v_add_u32_sdwa v62, s42, v119 dst_sel:DWORD dst_unused:UNUSED_PAD src0_sel:DWORD src1_sel:WORD_0
v_smfmac_f32_16x16x64_bf16 v[84:87], a[8:11], v[44:51], v139
buffer_load_dwordx4 a[104:107], v112, s[24:27], s99 offen offset:2048 sc1
ds_read_u16 v70, v62 offset:18560
ds_read_u16 v62, v62
v_add_u32_sdwa v63, s42, v119 dst_sel:DWORD dst_unused:UNUSED_PAD src0_sel:DWORD src1_sel:WORD_1
s_waitcnt lgkmcnt(15)
v_smfmac_f32_16x16x64_bf16 v[88:91], a[12:15], v[44:51], v139 abid:1
ds_read_u16 v71, v63 offset:18560
ds_read_u16 v63, v63
v_add_u32_sdwa v64, s42, v120 dst_sel:DWORD dst_unused:UNUSED_PAD src0_sel:DWORD src1_sel:WORD_0
v_smfmac_f32_16x16x64_bf16 v[92:95], a[16:19], v[44:51], v140
s_mov_b32 s98, 3072
buffer_load_dwordx4 v[150:153], v113, s[24:27], s98 offen sc1
ds_read_u16 v72, v64 offset:18560
ds_read_u16 v64, v64
v_add_u32_sdwa v65, s42, v120 dst_sel:DWORD dst_unused:UNUSED_PAD src0_sel:DWORD src1_sel:WORD_1
v_smfmac_f32_16x16x64_bf16 v[96:99], a[20:23], v[44:51], v140 abid:1
ds_read_u16 v73, v65 offset:18560
ds_read_u16 v65, v65
v_add_u32_sdwa v66, s42, v121 dst_sel:DWORD dst_unused:UNUSED_PAD src0_sel:DWORD src1_sel:WORD_0
v_smfmac_f32_16x16x64_bf16 v[100:103], a[24:27], v[44:51], v141
buffer_load_dwordx4 a[108:111], v112, s[24:27], s99 offen offset:3072 sc1
ds_read_u16 v74, v66 offset:18560
ds_read_u16 v66, v66
v_add_u32_sdwa v67, s42, v121 dst_sel:DWORD dst_unused:UNUSED_PAD src0_sel:DWORD src1_sel:WORD_1
v_smfmac_f32_16x16x64_bf16 v[104:107], a[28:31], v[44:51], v141 abid:1
ds_read_u16 v75, v67 offset:18560
ds_read_u16 v67, v67
s_waitcnt vmcnt(18)
v_smfmac_f32_16x16x64_bf16 v[108:111], a[32:35], v[44:51], v174
ds_read_b128 v[114:117], v2 offset:64
s_waitcnt lgkmcnt(15)
v_smfmac_f32_16x16x64_bf16 v[8:11], a[0:3], v[52:59], v138
s_mov_b32 s99, 28672
buffer_load_dwordx4 a[112:115], v112, s[24:27], s99 offen offset:0 sc1
ds_read_b128 v[44:47], v0 offset:2048
v_smfmac_f32_16x16x64_bf16 v[12:15], a[4:7], v[52:59], v138 abid:1
ds_read_b128 v[48:51], v1 offset:2048
v_smfmac_f32_16x16x64_bf16 v[16:19], a[8:11], v[52:59], v139
buffer_load_dwordx4 a[116:119], v112, s[24:27], s99 offen offset:1024 sc1
v_smfmac_f32_16x16x64_bf16 v[20:23], a[12:15], v[52:59], v139 abid:1
v_smfmac_f32_16x16x64_bf16 v[24:27], a[16:19], v[52:59], v140
buffer_load_dwordx4 a[120:123], v112, s[24:27], s99 offen offset:2048 sc1
v_smfmac_f32_16x16x64_bf16 v[28:31], a[20:23], v[52:59], v140 abid:1
v_smfmac_f32_16x16x64_bf16 v[32:35], a[24:27], v[52:59], v141
v_smfmac_f32_16x16x64_bf16 v[36:39], a[28:31], v[52:59], v141 abid:1
buffer_load_dwordx4 a[124:127], v112, s[24:27], s99 offen offset:3072 sc1
v_smfmac_f32_16x16x64_bf16 v[40:43], a[32:35], v[52:59], v174
s_waitcnt lgkmcnt(2)
v_smfmac_f32_16x16x64_bf16 v[8:11], v[114:117], v[68:75], v179
s_mov_b32 s99, 32768
buffer_load_dwordx4 a[128:131], v112, s[24:27], s99 offen offset:0 sc1
v_smfmac_f32_16x16x64_bf16 v[12:15], v[114:117], v[68:75], v179 abid:1
v_smfmac_f32_16x16x64_bf16 v[76:79], v[114:117], v[60:67], v179
buffer_load_dwordx4 a[132:135], v112, s[24:27], s99 offen offset:1024 sc1
v_smfmac_f32_16x16x64_bf16 v[80:83], v[114:117], v[60:67], v179 abid:1
v_add_u32_sdwa v60, s42, v122 dst_sel:DWORD dst_unused:UNUSED_PAD src0_sel:DWORD src1_sel:WORD_0
s_waitcnt lgkmcnt(0)
v_smfmac_f32_16x16x64_bf16 v[76:79], a[36:39], v[44:51], v142
ds_read_b128 v[52:55], v0 offset:20608
ds_read_b128 v[56:59], v1 offset:20608
ds_read_u16 v68, v60 offset:18560
ds_read_u16 v60, v60
v_add_u32_sdwa v61, s42, v122 dst_sel:DWORD dst_unused:UNUSED_PAD src0_sel:DWORD src1_sel:WORD_1
v_smfmac_f32_16x16x64_bf16 v[80:83], a[40:43], v[44:51], v142 abid:1
buffer_load_dwordx4 a[136:139], v112, s[24:27], s99 offen offset:2048 sc1
ds_read_u16 v69, v61 offset:18560
ds_read_u16 v61, v61
v_add_u32_sdwa v62, s42, v123 dst_sel:DWORD dst_unused:UNUSED_PAD src0_sel:DWORD src1_sel:WORD_0
v_smfmac_f32_16x16x64_bf16 v[84:87], a[44:47], v[44:51], v143
ds_read_u16 v70, v62 offset:18560
ds_read_u16 v62, v62
v_add_u32_sdwa v63, s42, v123 dst_sel:DWORD dst_unused:UNUSED_PAD src0_sel:DWORD src1_sel:WORD_1
s_waitcnt vmcnt(18)
v_smfmac_f32_16x16x64_bf16 v[88:91], a[48:51], v[44:51], v143 abid:1
buffer_load_dwordx4 a[140:143], v112, s[24:27], s99 offen offset:3072 sc1
ds_read_u16 v71, v63 offset:18560
ds_read_u16 v63, v63
v_add_u32_sdwa v64, s42, v124 dst_sel:DWORD dst_unused:UNUSED_PAD src0_sel:DWORD src1_sel:WORD_0
v_smfmac_f32_16x16x64_bf16 v[92:95], a[52:55], v[44:51], v144
ds_read_u16 v72, v64 offset:18560
ds_read_u16 v64, v64
v_add_u32_sdwa v65, s42, v124 dst_sel:DWORD dst_unused:UNUSED_PAD src0_sel:DWORD src1_sel:WORD_1
v_smfmac_f32_16x16x64_bf16 v[96:99], a[56:59], v[44:51], v144 abid:1
s_mov_b32 s98, 4096
buffer_load_dwordx4 v[154:157], v113, s[24:27], s98 offen sc1
ds_read_u16 v73, v65 offset:18560
ds_read_u16 v65, v65
v_add_u32_sdwa v66, s42, v125 dst_sel:DWORD dst_unused:UNUSED_PAD src0_sel:DWORD src1_sel:WORD_0
v_smfmac_f32_16x16x64_bf16 v[100:103], a[60:63], v[44:51], v145
ds_read_u16 v74, v66 offset:18560
ds_read_u16 v66, v66
v_add_u32_sdwa v67, s42, v125 dst_sel:DWORD dst_unused:UNUSED_PAD src0_sel:DWORD src1_sel:WORD_1
v_smfmac_f32_16x16x64_bf16 v[104:107], a[64:67], v[44:51], v145 abid:1
ds_read_u16 v75, v67 offset:18560
ds_read_u16 v67, v67
v_smfmac_f32_16x16x64_bf16 v[108:111], a[68:71], v[44:51], v174 abid:1
s_mov_b32 s99, 36864
buffer_load_dwordx4 a[144:147], v112, s[24:27], s99 offen offset:0 sc1
ds_read_b128 v[114:117], v2 offset:128
s_waitcnt lgkmcnt(15)
v_smfmac_f32_16x16x64_bf16 v[8:11], a[36:39], v[52:59], v142
ds_read_b128 v[44:47], v0 offset:4096
v_smfmac_f32_16x16x64_bf16 v[12:15], a[40:43], v[52:59], v142 abid:1
buffer_load_dwordx4 a[148:151], v112, s[24:27], s99 offen offset:1024 sc1
ds_read_b128 v[48:51], v1 offset:4096
v_smfmac_f32_16x16x64_bf16 v[16:19], a[44:47], v[52:59], v143
v_smfmac_f32_16x16x64_bf16 v[20:23], a[48:51], v[52:59], v143 abid:1
buffer_load_dwordx4 a[152:155], v112, s[24:27], s99 offen offset:2048 sc1
v_smfmac_f32_16x16x64_bf16 v[24:27], a[52:55], v[52:59], v144
v_smfmac_f32_16x16x64_bf16 v[28:31], a[56:59], v[52:59], v144 abid:1
v_smfmac_f32_16x16x64_bf16 v[32:35], a[60:63], v[52:59], v145
buffer_load_dwordx4 a[156:159], v112, s[24:27], s99 offen offset:3072 sc1
v_smfmac_f32_16x16x64_bf16 v[36:39], a[64:67], v[52:59], v145 abid:1
v_smfmac_f32_16x16x64_bf16 v[40:43], a[68:71], v[52:59], v174 abid:1
s_mov_b32 s99, 40960
buffer_load_dwordx4 a[160:163], v112, s[24:27], s99 offen offset:0 sc1
s_waitcnt lgkmcnt(2)
v_smfmac_f32_16x16x64_bf16 v[12:15], v[114:117], v[68:75], v180
v_smfmac_f32_16x16x64_bf16 v[16:19], v[114:117], v[68:75], v180 abid:1
buffer_load_dwordx4 a[164:167], v112, s[24:27], s99 offen offset:1024 sc1
v_smfmac_f32_16x16x64_bf16 v[20:23], v[114:117], v[68:75], v181
v_smfmac_f32_16x16x64_bf16 v[80:83], v[114:117], v[60:67], v180
v_smfmac_f32_16x16x64_bf16 v[84:87], v[114:117], v[60:67], v180 abid:1
buffer_load_dwordx4 a[168:171], v112, s[24:27], s99 offen offset:2048 sc1
v_smfmac_f32_16x16x64_bf16 v[88:91], v[114:117], v[60:67], v181
v_add_u32_sdwa v60, s42, v126 dst_sel:DWORD dst_unused:UNUSED_PAD src0_sel:DWORD src1_sel:WORD_0
s_waitcnt lgkmcnt(0)
s_waitcnt vmcnt(18)
v_smfmac_f32_16x16x64_bf16 v[76:79], a[72:75], v[44:51], v146
buffer_load_dwordx4 a[172:175], v112, s[24:27], s99 offen offset:3072 sc1
ds_read_b128 v[52:55], v0 offset:22656
ds_read_b128 v[56:59], v1 offset:22656
ds_read_u16 v68, v60 offset:18560
ds_read_u16 v60, v60
v_add_u32_sdwa v61, s42, v126 dst_sel:DWORD dst_unused:UNUSED_PAD src0_sel:DWORD src1_sel:WORD_1
v_smfmac_f32_16x16x64_bf16 v[80:83], a[76:79], v[44:51], v146 abid:1
ds_read_u16 v69, v61 offset:18560
ds_read_u16 v61, v61
v_add_u32_sdwa v62, s42, v127 dst_sel:DWORD dst_unused:UNUSED_PAD src0_sel:DWORD src1_sel:WORD_0
v_smfmac_f32_16x16x64_bf16 v[84:87], a[80:83], v[44:51], v147
s_mov_b32 s99, 45056
buffer_load_dwordx4 a[176:179], v112, s[24:27], s99 offen offset:0 sc1
ds_read_u16 v70, v62 offset:18560
ds_read_u16 v62, v62
v_add_u32_sdwa v63, s42, v127 dst_sel:DWORD dst_unused:UNUSED_PAD src0_sel:DWORD src1_sel:WORD_1
v_smfmac_f32_16x16x64_bf16 v[88:91], a[84:87], v[44:51], v147 abid:1
ds_read_u16 v71, v63 offset:18560
ds_read_u16 v63, v63
v_add_u32_sdwa v64, s42, v128 dst_sel:DWORD dst_unused:UNUSED_PAD src0_sel:DWORD src1_sel:WORD_0
v_smfmac_f32_16x16x64_bf16 v[92:95], a[88:91], v[44:51], v148
ds_read_u16 v72, v64 offset:18560
ds_read_u16 v64, v64
v_add_u32_sdwa v65, s42, v128 dst_sel:DWORD dst_unused:UNUSED_PAD src0_sel:DWORD src1_sel:WORD_1
v_smfmac_f32_16x16x64_bf16 v[96:99], a[92:95], v[44:51], v148 abid:1
s_mov_b32 s98, 5120
buffer_load_dwordx4 v[158:161], v113, s[24:27], s98 offen sc1
ds_read_u16 v73, v65 offset:18560
ds_read_u16 v65, v65
v_add_u32_sdwa v66, s42, v129 dst_sel:DWORD dst_unused:UNUSED_PAD src0_sel:DWORD src1_sel:WORD_0
v_smfmac_f32_16x16x64_bf16 v[100:103], a[96:99], v[44:51], v149
ds_read_u16 v74, v66 offset:18560
ds_read_u16 v66, v66
v_add_u32_sdwa v67, s42, v129 dst_sel:DWORD dst_unused:UNUSED_PAD src0_sel:DWORD src1_sel:WORD_1
v_smfmac_f32_16x16x64_bf16 v[104:107], a[100:103], v[44:51], v149 abid:1
buffer_load_dwordx4 a[180:183], v112, s[24:27], s99 offen offset:1024 sc1
ds_read_u16 v75, v67 offset:18560
ds_read_u16 v67, v67
v_smfmac_f32_16x16x64_bf16 v[108:111], a[104:107], v[44:51], v175
ds_read_b128 v[114:117], v2 offset:192
s_waitcnt lgkmcnt(15)
v_smfmac_f32_16x16x64_bf16 v[8:11], a[72:75], v[52:59], v146
buffer_load_dwordx4 a[184:187], v112, s[24:27], s99 offen offset:2048 sc1
ds_read_b128 v[44:47], v0 offset:6144
v_smfmac_f32_16x16x64_bf16 v[12:15], a[76:79], v[52:59], v146 abid:1
ds_read_b128 v[48:51], v1 offset:6144
v_smfmac_f32_16x16x64_bf16 v[16:19], a[80:83], v[52:59], v147
v_smfmac_f32_16x16x64_bf16 v[20:23], a[84:87], v[52:59], v147 abid:1
buffer_load_dwordx4 a[188:191], v112, s[24:27], s99 offen offset:3072 sc1
v_smfmac_f32_16x16x64_bf16 v[24:27], a[88:91], v[52:59], v148
v_smfmac_f32_16x16x64_bf16 v[28:31], a[92:95], v[52:59], v148 abid:1
s_mov_b32 s99, 49152
buffer_load_dwordx4 a[192:195], v112, s[24:27], s99 offen offset:0 sc1
v_smfmac_f32_16x16x64_bf16 v[32:35], a[96:99], v[52:59], v149
v_smfmac_f32_16x16x64_bf16 v[36:39], a[100:103], v[52:59], v149 abid:1
buffer_load_dwordx4 a[196:199], v112, s[24:27], s99 offen offset:1024 sc1
v_smfmac_f32_16x16x64_bf16 v[40:43], a[104:107], v[52:59], v175
s_waitcnt lgkmcnt(2)
v_smfmac_f32_16x16x64_bf16 v[20:23], v[114:117], v[68:75], v181 abid:1
v_smfmac_f32_16x16x64_bf16 v[24:27], v[114:117], v[68:75], v182
buffer_load_dwordx4 a[200:203], v112, s[24:27], s99 offen offset:2048 sc1
v_smfmac_f32_16x16x64_bf16 v[28:31], v[114:117], v[68:75], v182 abid:1
v_smfmac_f32_16x16x64_bf16 v[88:91], v[114:117], v[60:67], v181 abid:1
buffer_load_dwordx4 a[204:207], v112, s[24:27], s99 offen offset:3072 sc1
v_smfmac_f32_16x16x64_bf16 v[92:95], v[114:117], v[60:67], v182
v_smfmac_f32_16x16x64_bf16 v[96:99], v[114:117], v[60:67], v182 abid:1
s_mov_b32 s99, 53248
buffer_load_dwordx4 a[208:211], v112, s[24:27], s99 offen offset:0 sc1
v_add_u32_sdwa v60, s42, v130 dst_sel:DWORD dst_unused:UNUSED_PAD src0_sel:DWORD src1_sel:WORD_0
s_waitcnt lgkmcnt(0)
s_waitcnt vmcnt(18)
v_smfmac_f32_16x16x64_bf16 v[76:79], a[108:111], v[44:51], v150
ds_read_b128 v[52:55], v0 offset:24704
ds_read_b128 v[56:59], v1 offset:24704
ds_read_u16 v68, v60 offset:18560
ds_read_u16 v60, v60
v_add_u32_sdwa v61, s42, v130 dst_sel:DWORD dst_unused:UNUSED_PAD src0_sel:DWORD src1_sel:WORD_1
v_smfmac_f32_16x16x64_bf16 v[80:83], a[112:115], v[44:51], v150 abid:1
ds_read_u16 v69, v61 offset:18560
ds_read_u16 v61, v61
v_add_u32_sdwa v62, s42, v131 dst_sel:DWORD dst_unused:UNUSED_PAD src0_sel:DWORD src1_sel:WORD_0
v_smfmac_f32_16x16x64_bf16 v[84:87], a[116:119], v[44:51], v151
buffer_load_dwordx4 a[212:215], v112, s[24:27], s99 offen offset:1024 sc1
ds_read_u16 v70, v62 offset:18560
ds_read_u16 v62, v62
v_add_u32_sdwa v63, s42, v131 dst_sel:DWORD dst_unused:UNUSED_PAD src0_sel:DWORD src1_sel:WORD_1
v_smfmac_f32_16x16x64_bf16 v[88:91], a[120:123], v[44:51], v151 abid:1
ds_read_u16 v71, v63 offset:18560
ds_read_u16 v63, v63
v_add_u32_sdwa v64, s42, v132 dst_sel:DWORD dst_unused:UNUSED_PAD src0_sel:DWORD src1_sel:WORD_0
v_smfmac_f32_16x16x64_bf16 v[92:95], a[124:127], v[44:51], v152
s_mov_b32 s98, 6144
buffer_load_dwordx4 v[162:165], v113, s[24:27], s98 offen sc1
ds_read_u16 v72, v64 offset:18560
ds_read_u16 v64, v64
v_add_u32_sdwa v65, s42, v132 dst_sel:DWORD dst_unused:UNUSED_PAD src0_sel:DWORD src1_sel:WORD_1
v_smfmac_f32_16x16x64_bf16 v[96:99], a[128:131], v[44:51], v152 abid:1
ds_read_u16 v73, v65 offset:18560
ds_read_u16 v65, v65
v_add_u32_sdwa v66, s42, v133 dst_sel:DWORD dst_unused:UNUSED_PAD src0_sel:DWORD src1_sel:WORD_0
v_smfmac_f32_16x16x64_bf16 v[100:103], a[132:135], v[44:51], v153
buffer_load_dwordx4 a[216:219], v112, s[24:27], s99 offen offset:2048 sc1
ds_read_u16 v74, v66 offset:18560
ds_read_u16 v66, v66
v_add_u32_sdwa v67, s42, v133 dst_sel:DWORD dst_unused:UNUSED_PAD src0_sel:DWORD src1_sel:WORD_1
v_smfmac_f32_16x16x64_bf16 v[104:107], a[136:139], v[44:51], v153 abid:1
ds_read_u16 v75, v67 offset:18560
ds_read_u16 v67, v67
v_smfmac_f32_16x16x64_bf16 v[108:111], a[140:143], v[44:51], v175 abid:1
ds_read_b128 v[114:117], v2 offset:256
s_waitcnt lgkmcnt(15)
v_smfmac_f32_16x16x64_bf16 v[8:11], a[108:111], v[52:59], v150
buffer_load_dwordx4 a[220:223], v112, s[24:27], s99 offen offset:3072 sc1
ds_read_b128 v[44:47], v0 offset:8192
v_smfmac_f32_16x16x64_bf16 v[12:15], a[112:115], v[52:59], v150 abid:1
ds_read_b128 v[48:51], v1 offset:8192
v_smfmac_f32_16x16x64_bf16 v[16:19], a[116:119], v[52:59], v151
s_mov_b32 s99, 57344
buffer_load_dwordx4 a[224:227], v112, s[24:27], s99 offen offset:0 sc1
v_smfmac_f32_16x16x64_bf16 v[20:23], a[120:123], v[52:59], v151 abid:1
v_smfmac_f32_16x16x64_bf16 v[24:27], a[124:127], v[52:59], v152
buffer_load_dwordx4 a[228:231], v112, s[24:27], s99 offen offset:1024 sc1
v_smfmac_f32_16x16x64_bf16 v[28:31], a[128:131], v[52:59], v152 abid:1
v_smfmac_f32_16x16x64_bf16 v[32:35], a[132:135], v[52:59], v153
v_smfmac_f32_16x16x64_bf16 v[36:39], a[136:139], v[52:59], v153 abid:1
buffer_load_dwordx4 a[232:235], v112, s[24:27], s99 offen offset:2048 sc1
v_smfmac_f32_16x16x64_bf16 v[40:43], a[140:143], v[52:59], v175 abid:1
s_waitcnt lgkmcnt(2)
v_smfmac_f32_16x16x64_bf16 v[28:31], v[114:117], v[68:75], v183
buffer_load_dwordx4 a[236:239], v112, s[24:27], s99 offen offset:3072 sc1
v_smfmac_f32_16x16x64_bf16 v[32:35], v[114:117], v[68:75], v183 abid:1
v_smfmac_f32_16x16x64_bf16 v[36:39], v[114:117], v[68:75], v184
s_mov_b32 s99, 61440
buffer_load_dwordx4 a[240:243], v112, s[24:27], s99 offen offset:0 sc1
v_smfmac_f32_16x16x64_bf16 v[96:99], v[114:117], v[60:67], v183
v_smfmac_f32_16x16x64_bf16 v[100:103], v[114:117], v[60:67], v183 abid:1
v_smfmac_f32_16x16x64_bf16 v[104:107], v[114:117], v[60:67], v184
buffer_load_dwordx4 a[244:247], v112, s[24:27], s99 offen offset:1024 sc1
v_add_u32_sdwa v60, s42, v134 dst_sel:DWORD dst_unused:UNUSED_PAD src0_sel:DWORD src1_sel:WORD_0
s_waitcnt lgkmcnt(0)
s_waitcnt vmcnt(18)
v_smfmac_f32_16x16x64_bf16 v[76:79], a[144:147], v[44:51], v154
ds_read_b128 v[52:55], v0 offset:26752
ds_read_b128 v[56:59], v1 offset:26752
ds_read_u16 v68, v60 offset:18560
ds_read_u16 v60, v60
v_add_u32_sdwa v61, s42, v134 dst_sel:DWORD dst_unused:UNUSED_PAD src0_sel:DWORD src1_sel:WORD_1
v_smfmac_f32_16x16x64_bf16 v[80:83], a[148:151], v[44:51], v154 abid:1
buffer_load_dwordx4 a[248:251], v112, s[24:27], s99 offen offset:2048 sc1
ds_read_u16 v69, v61 offset:18560
ds_read_u16 v61, v61
v_add_u32_sdwa v62, s42, v135 dst_sel:DWORD dst_unused:UNUSED_PAD src0_sel:DWORD src1_sel:WORD_0
v_smfmac_f32_16x16x64_bf16 v[84:87], a[152:155], v[44:51], v155
ds_read_u16 v70, v62 offset:18560
ds_read_u16 v62, v62
v_add_u32_sdwa v63, s42, v135 dst_sel:DWORD dst_unused:UNUSED_PAD src0_sel:DWORD src1_sel:WORD_1
v_smfmac_f32_16x16x64_bf16 v[88:91], a[156:159], v[44:51], v155 abid:1
s_mov_b32 s98, 7168
buffer_load_dwordx4 v[166:169], v113, s[24:27], s98 offen sc1
ds_read_u16 v71, v63 offset:18560
ds_read_u16 v63, v63
v_add_u32_sdwa v64, s42, v136 dst_sel:DWORD dst_unused:UNUSED_PAD src0_sel:DWORD src1_sel:WORD_0
v_smfmac_f32_16x16x64_bf16 v[92:95], a[160:163], v[44:51], v156
ds_read_u16 v72, v64 offset:18560
ds_read_u16 v64, v64
v_add_u32_sdwa v65, s42, v136 dst_sel:DWORD dst_unused:UNUSED_PAD src0_sel:DWORD src1_sel:WORD_1
v_smfmac_f32_16x16x64_bf16 v[96:99], a[164:167], v[44:51], v156 abid:1
ds_read_u16 v73, v65 offset:18560
ds_read_u16 v65, v65
v_add_u32_sdwa v66, s42, v137 dst_sel:DWORD dst_unused:UNUSED_PAD src0_sel:DWORD src1_sel:WORD_0
v_smfmac_f32_16x16x64_bf16 v[100:103], a[168:171], v[44:51], v157
s_mov_b32 s98, 8192
buffer_load_dwordx4 v[170:173], v113, s[24:27], s98 offen sc1
ds_read_u16 v74, v66 offset:18560
ds_read_u16 v66, v66
v_add_u32_sdwa v67, s42, v137 dst_sel:DWORD dst_unused:UNUSED_PAD src0_sel:DWORD src1_sel:WORD_1
v_smfmac_f32_16x16x64_bf16 v[104:107], a[172:175], v[44:51], v157 abid:1
ds_read_u16 v75, v67 offset:18560
ds_read_u16 v67, v67
v_smfmac_f32_16x16x64_bf16 v[108:111], a[176:179], v[44:51], v176
s_mov_b32 s99, 69632
buffer_load_dwordx4 v[214:217], v112, s[24:27], s99 offen offset:3072 sc1
ds_read_b128 v[114:117], v2 offset:320
s_waitcnt lgkmcnt(15)
v_smfmac_f32_16x16x64_bf16 v[8:11], a[144:147], v[52:59], v154
ds_read_b128 v[44:47], v0 offset:10240
v_smfmac_f32_16x16x64_bf16 v[12:15], a[148:151], v[52:59], v154 abid:1
s_mov_b32 s99, 81920
buffer_load_dwordx4 v[250:253], v112, s[24:27], s99 offen offset:0 sc1
ds_read_b128 v[48:51], v1 offset:10240
v_smfmac_f32_16x16x64_bf16 v[16:19], a[152:155], v[52:59], v155
v_smfmac_f32_16x16x64_bf16 v[20:23], a[156:159], v[52:59], v155 abid:1
v_smfmac_f32_16x16x64_bf16 v[24:27], a[160:163], v[52:59], v156
s_mov_b32 s99, 61440
buffer_load_dwordx4 a[252:255], v112, s[24:27], s99 offen offset:3072 sc1
v_smfmac_f32_16x16x64_bf16 v[28:31], a[164:167], v[52:59], v156 abid:1
v_smfmac_f32_16x16x64_bf16 v[32:35], a[168:171], v[52:59], v157
s_mov_b32 s99, 73728
buffer_load_dwordx4 v[218:221], v112, s[24:27], s99 offen offset:0 sc1
v_smfmac_f32_16x16x64_bf16 v[36:39], a[172:175], v[52:59], v157 abid:1
v_smfmac_f32_16x16x64_bf16 v[40:43], a[176:179], v[52:59], v176
s_mov_b32 s99, 65536
buffer_load_dwordx4 v[186:189], v112, s[24:27], s99 offen offset:0 sc1
s_waitcnt lgkmcnt(2)
v_smfmac_f32_16x16x64_bf16 v[36:39], v[114:117], v[68:75], v184 abid:1
v_smfmac_f32_16x16x64_bf16 v[40:43], v[114:117], v[68:75], v185
v_smfmac_f32_16x16x64_bf16 v[104:107], v[114:117], v[60:67], v184 abid:1
s_mov_b32 s99, 73728
buffer_load_dwordx4 v[222:225], v112, s[24:27], s99 offen offset:1024 sc1
v_smfmac_f32_16x16x64_bf16 v[108:111], v[114:117], v[60:67], v185
s_waitcnt lgkmcnt(0)
s_waitcnt vmcnt(18)
v_smfmac_f32_16x16x64_bf16 v[76:79], a[180:183], v[44:51], v158
s_mov_b32 s99, 65536
buffer_load_dwordx4 v[190:193], v112, s[24:27], s99 offen offset:1024 sc1
ds_read_b128 v[52:55], v0 offset:28800
ds_read_b128 v[56:59], v1 offset:28800
v_smfmac_f32_16x16x64_bf16 v[80:83], a[184:187], v[44:51], v158 abid:1
v_smfmac_f32_16x16x64_bf16 v[84:87], a[188:191], v[44:51], v159
s_mov_b32 s99, 73728
buffer_load_dwordx4 v[226:229], v112, s[24:27], s99 offen offset:2048 sc1
ds_read_b128 v[60:63], v0 offset:32896
v_smfmac_f32_16x16x64_bf16 v[88:91], a[192:195], v[44:51], v159 abid:1
ds_read_b128 v[64:67], v1 offset:32896
v_smfmac_f32_16x16x64_bf16 v[92:95], a[196:199], v[44:51], v160
v_smfmac_f32_16x16x64_bf16 v[96:99], a[200:203], v[44:51], v160 abid:1
s_mov_b32 s99, 65536
buffer_load_dwordx4 v[194:197], v112, s[24:27], s99 offen offset:2048 sc1
v_smfmac_f32_16x16x64_bf16 v[100:103], a[204:207], v[44:51], v161
v_smfmac_f32_16x16x64_bf16 v[104:107], a[208:211], v[44:51], v161 abid:1
s_mov_b32 s99, 73728
buffer_load_dwordx4 v[230:233], v112, s[24:27], s99 offen offset:3072 sc1
v_smfmac_f32_16x16x64_bf16 v[108:111], a[212:215], v[44:51], v176 abid:1
s_waitcnt lgkmcnt(2)
v_smfmac_f32_16x16x64_bf16 v[8:11], a[180:183], v[52:59], v158
s_mov_b32 s99, 65536
buffer_load_dwordx4 v[198:201], v112, s[24:27], s99 offen offset:3072 sc1
ds_read_b128 v[44:47], v0 offset:12288
v_smfmac_f32_16x16x64_bf16 v[12:15], a[184:187], v[52:59], v158 abid:1
ds_read_b128 v[48:51], v1 offset:12288
v_smfmac_f32_16x16x64_bf16 v[16:19], a[188:191], v[52:59], v159
v_smfmac_f32_16x16x64_bf16 v[20:23], a[192:195], v[52:59], v159 abid:1
s_mov_b32 s99, 77824
buffer_load_dwordx4 v[234:237], v112, s[24:27], s99 offen offset:0 sc1
v_smfmac_f32_16x16x64_bf16 v[24:27], a[196:199], v[52:59], v160
v_smfmac_f32_16x16x64_bf16 v[28:31], a[200:203], v[52:59], v160 abid:1
s_mov_b32 s99, 69632
buffer_load_dwordx4 v[202:205], v112, s[24:27], s99 offen offset:0 sc1
v_smfmac_f32_16x16x64_bf16 v[32:35], a[204:207], v[52:59], v161
v_smfmac_f32_16x16x64_bf16 v[36:39], a[208:211], v[52:59], v161 abid:1
s_mov_b32 s99, 77824
buffer_load_dwordx4 v[238:241], v112, s[24:27], s99 offen offset:1024 sc1
v_smfmac_f32_16x16x64_bf16 v[40:43], a[212:215], v[52:59], v176 abid:1
s_waitcnt lgkmcnt(0)
s_waitcnt vmcnt(18)
v_smfmac_f32_16x16x64_bf16 v[76:79], a[216:219], v[44:51], v162
ds_read_b128 v[52:55], v0 offset:30848
ds_read_b128 v[56:59], v1 offset:30848
v_smfmac_f32_16x16x64_bf16 v[80:83], a[220:223], v[44:51], v162 abid:1
s_mov_b32 s99, 69632
buffer_load_dwordx4 v[206:209], v112, s[24:27], s99 offen offset:1024 sc1
v_smfmac_f32_16x16x64_bf16 v[84:87], a[224:227], v[44:51], v163
ds_read_b128 v[68:71], v0 offset:34944
v_smfmac_f32_16x16x64_bf16 v[88:91], a[228:231], v[44:51], v163 abid:1
s_mov_b32 s99, 77824
buffer_load_dwordx4 v[242:245], v112, s[24:27], s99 offen offset:2048 sc1
ds_read_b128 v[72:75], v1 offset:34944
v_smfmac_f32_16x16x64_bf16 v[92:95], a[232:235], v[44:51], v164
v_smfmac_f32_16x16x64_bf16 v[96:99], a[236:239], v[44:51], v164 abid:1
s_mov_b32 s99, 69632
buffer_load_dwordx4 v[210:213], v112, s[24:27], s99 offen offset:2048 sc1
v_smfmac_f32_16x16x64_bf16 v[100:103], a[240:243], v[44:51], v165
s_waitcnt vmcnt(18)
v_smfmac_f32_16x16x64_bf16 v[104:107], a[244:247], v[44:51], v165 abid:1
v_smfmac_f32_16x16x64_bf16 v[108:111], a[248:251], v[44:51], v177
s_mov_b32 s99, 77824
buffer_load_dwordx4 v[246:249], v112, s[24:27], s99 offen offset:3072 sc1
s_waitcnt lgkmcnt(2)
v_smfmac_f32_16x16x64_bf16 v[8:11], a[216:219], v[52:59], v162
ds_read_b128 v[44:47], v0 offset:14336
v_smfmac_f32_16x16x64_bf16 v[12:15], a[220:223], v[52:59], v162 abid:1
ds_read_b128 v[48:51], v1 offset:14336
v_smfmac_f32_16x16x64_bf16 v[16:19], a[224:227], v[52:59], v163
v_smfmac_f32_16x16x64_bf16 v[20:23], a[228:231], v[52:59], v163 abid:1
v_smfmac_f32_16x16x64_bf16 v[24:27], a[232:235], v[52:59], v164
v_smfmac_f32_16x16x64_bf16 v[28:31], a[236:239], v[52:59], v164 abid:1
v_smfmac_f32_16x16x64_bf16 v[32:35], a[240:243], v[52:59], v165
v_smfmac_f32_16x16x64_bf16 v[36:39], a[244:247], v[52:59], v165 abid:1
v_smfmac_f32_16x16x64_bf16 v[40:43], a[248:251], v[52:59], v177
ds_read_b128 v[52:55], v0 offset:16384
ds_read_b128 v[56:59], v1 offset:16384
s_waitcnt lgkmcnt(2)
s_waitcnt vmcnt(17)
v_smfmac_f32_16x16x64_bf16 v[108:111], v[214:217], v[44:51], v177 abid:1
s_waitcnt lgkmcnt(0)
s_waitcnt vmcnt(16)
v_smfmac_f32_16x16x64_bf16 v[108:111], v[250:253], v[52:59], v178
v_add_u32 v0, 37120, v0
v_add_u32 v1, 37120, v1
s_waitcnt vmcnt(15)
v_smfmac_f32_16x16x64_bf16 v[76:79], a[252:255], v[44:51], v166
s_waitcnt vmcnt(14)
v_smfmac_f32_16x16x64_bf16 v[76:79], v[218:221], v[52:59], v170
s_nop 1
v_cvt_pk_bf16_f32 v108, v108, v109
v_cvt_pk_bf16_f32 v109, v110, v111
ds_bpermute_b32 v108, v6, v108
ds_bpermute_b32 v109, v6, v109
s_waitcnt vmcnt(13)
v_smfmac_f32_16x16x64_bf16 v[80:83], v[186:189], v[44:51], v166 abid:1
s_waitcnt vmcnt(12)
v_smfmac_f32_16x16x64_bf16 v[80:83], v[222:225], v[52:59], v170 abid:1
v_cvt_pk_bf16_f32 v76, v76, v77
v_cvt_pk_bf16_f32 v77, v78, v79
s_waitcnt vmcnt(11)
v_smfmac_f32_16x16x64_bf16 v[84:87], v[190:193], v[44:51], v167
s_waitcnt vmcnt(10)
v_smfmac_f32_16x16x64_bf16 v[84:87], v[226:229], v[52:59], v171
s_nop 1
v_cvt_pk_bf16_f32 v78, v80, v81
v_cvt_pk_bf16_f32 v79, v82, v83
s_waitcnt lgkmcnt(0)
buffer_store_dwordx2 v[108:109], v5, s[20:23], s46 offen
s_waitcnt vmcnt(10)
v_smfmac_f32_16x16x64_bf16 v[88:91], v[194:197], v[44:51], v167 abid:1
s_waitcnt vmcnt(9)
v_smfmac_f32_16x16x64_bf16 v[88:91], v[230:233], v[52:59], v171 abid:1
v_cvt_pk_bf16_f32 v80, v84, v85
v_cvt_pk_bf16_f32 v81, v86, v87
s_waitcnt vmcnt(8)
v_smfmac_f32_16x16x64_bf16 v[92:95], v[198:201], v[44:51], v168
s_waitcnt vmcnt(7)
v_smfmac_f32_16x16x64_bf16 v[92:95], v[234:237], v[52:59], v172
s_nop 1
v_cvt_pk_bf16_f32 v82, v88, v89
v_cvt_pk_bf16_f32 v83, v90, v91
v_cndmask_b32_dpp v114, v80, v76, vcc quad_perm:[1,0,3,2] row_mask:0xf bank_mask:0xf
v_cndmask_b32_dpp v115, v81, v77, vcc quad_perm:[1,0,3,2] row_mask:0xf bank_mask:0xf
v_cndmask_b32_dpp v116, v82, v78, vcc quad_perm:[1,0,3,2] row_mask:0xf bank_mask:0xf
v_cndmask_b32_dpp v117, v83, v79, vcc quad_perm:[1,0,3,2] row_mask:0xf bank_mask:0xf
buffer_store_dwordx4 v[114:117], v4, s[20:23], s46 offen offset:0 sc1
s_mov_b64 vcc, s[82:83]
s_waitcnt vmcnt(7)
v_smfmac_f32_16x16x64_bf16 v[96:99], v[202:205], v[44:51], v168 abid:1
s_waitcnt vmcnt(6)
v_smfmac_f32_16x16x64_bf16 v[96:99], v[238:241], v[52:59], v172 abid:1
v_cvt_pk_bf16_f32 v84, v92, v93
v_cvt_pk_bf16_f32 v85, v94, v95
v_cndmask_b32_dpp v80, v76, v80, vcc quad_perm:[1,0,3,2] row_mask:0xf bank_mask:0xf
v_cndmask_b32_dpp v81, v77, v81, vcc quad_perm:[1,0,3,2] row_mask:0xf bank_mask:0xf
v_cndmask_b32_dpp v82, v78, v82, vcc quad_perm:[1,0,3,2] row_mask:0xf bank_mask:0xf
v_cndmask_b32_dpp v83, v79, v83, vcc quad_perm:[1,0,3,2] row_mask:0xf bank_mask:0xf
buffer_store_dwordx4 v[80:83], v4, s[20:23], s46 offen offset:1152 sc1
s_mov_b64 vcc, s[80:81]
s_waitcnt vmcnt(6)
v_smfmac_f32_16x16x64_bf16 v[100:103], v[206:209], v[44:51], v169
s_waitcnt vmcnt(5)
v_smfmac_f32_16x16x64_bf16 v[100:103], v[242:245], v[52:59], v173
v_cvt_pk_bf16_f32 v86, v96, v97
v_cvt_pk_bf16_f32 v87, v98, v99
v_add_u32_sdwa v76, s4, v118 dst_sel:DWORD dst_unused:UNUSED_PAD src0_sel:DWORD src1_sel:WORD_0
v_add_u32_sdwa v77, s4, v118 dst_sel:DWORD dst_unused:UNUSED_PAD src0_sel:DWORD src1_sel:WORD_1
v_add_u32_sdwa v78, s4, v119 dst_sel:DWORD dst_unused:UNUSED_PAD src0_sel:DWORD src1_sel:WORD_0
v_add_u32_sdwa v79, s4, v119 dst_sel:DWORD dst_unused:UNUSED_PAD src0_sel:DWORD src1_sel:WORD_1
s_waitcnt vmcnt(4)
v_smfmac_f32_16x16x64_bf16 v[104:107], v[210:213], v[44:51], v169 abid:1
s_waitcnt vmcnt(3)
v_smfmac_f32_16x16x64_bf16 v[104:107], v[246:249], v[52:59], v173 abid:1
v_cvt_pk_bf16_f32 v88, v100, v101
v_cvt_pk_bf16_f32 v89, v102, v103
v_add_u32_sdwa v80, s4, v120 dst_sel:DWORD dst_unused:UNUSED_PAD src0_sel:DWORD src1_sel:WORD_0
v_add_u32_sdwa v81, s4, v120 dst_sel:DWORD dst_unused:UNUSED_PAD src0_sel:DWORD src1_sel:WORD_1
v_add_u32_sdwa v82, s4, v121 dst_sel:DWORD dst_unused:UNUSED_PAD src0_sel:DWORD src1_sel:WORD_0
v_add_u32_sdwa v83, s4, v121 dst_sel:DWORD dst_unused:UNUSED_PAD src0_sel:DWORD src1_sel:WORD_1
s_nop 1
v_cvt_pk_bf16_f32 v90, v104, v105
v_cvt_pk_bf16_f32 v91, v106, v107
v_cndmask_b32_dpp v92, v88, v84, vcc quad_perm:[1,0,3,2] row_mask:0xf bank_mask:0xf
v_cndmask_b32_dpp v93, v89, v85, vcc quad_perm:[1,0,3,2] row_mask:0xf bank_mask:0xf
v_cndmask_b32_dpp v94, v90, v86, vcc quad_perm:[1,0,3,2] row_mask:0xf bank_mask:0xf
v_cndmask_b32_dpp v95, v91, v87, vcc quad_perm:[1,0,3,2] row_mask:0xf bank_mask:0xf
buffer_store_dwordx4 v[92:95], v4, s[20:23], s46 offen offset:128 sc1
s_mov_b64 vcc, s[82:83]
v_cndmask_b32_dpp v88, v84, v88, vcc quad_perm:[1,0,3,2] row_mask:0xf bank_mask:0xf
v_cndmask_b32_dpp v89, v85, v89, vcc quad_perm:[1,0,3,2] row_mask:0xf bank_mask:0xf
v_cndmask_b32_dpp v90, v86, v90, vcc quad_perm:[1,0,3,2] row_mask:0xf bank_mask:0xf
v_cndmask_b32_dpp v91, v87, v91, vcc quad_perm:[1,0,3,2] row_mask:0xf bank_mask:0xf
buffer_store_dwordx4 v[88:91], v4, s[20:23], s46 offen offset:1280 sc1
s_mov_b64 vcc, s[80:81]
s_bfe_u32 s88, s85, 0x40018
s_cbranch_scc0 L_pf2_e
L_pf2:
s_add_u32 m0, s44, 0
s_nop 0
buffer_load_dwordx4 v3, s[16:19], s45 offen offset:0 nt lds
s_add_u32 m0, s44, 3840
s_nop 0
buffer_load_dwordx4 v3, s[16:19], s45 offen offset:256 nt lds
s_add_u32 m0, s44, 7680
s_nop 0
buffer_load_dwordx4 v3, s[16:19], s45 offen offset:512 nt lds
s_add_u32 m0, s44, 11520
s_nop 0
buffer_load_dwordx4 v3, s[16:19], s45 offen offset:768 nt lds
s_add_u32 m0, s44, s8
s_mov_b64 exec, s[10:11]
buffer_load_dwordx4 v3, s[16:19], s7 offen offset:896 nt lds
s_mov_b64 exec, -1
s_add_u32 s7, s7, s13
s_add_u32 s44, s44, 18560
s_add_u32 s45, s45, s13
s_mov_b32 s13, 4718592
s_sub_u32 s88, s88, 1
s_cmp_lg_u32 s88, 0
s_cbranch_scc1 L_pf2
L_pf2_e:
s_cmp_ge_u32 s44, 148480
s_cselect_b32 s44, s9, s44
s_add_u32 s46, s46, 4718592
s_waitcnt lgkmcnt(0)
s_barrier
s_cmp_lg_u32 s89, 0
s_cbranch_scc1 L_loopnk_p3
s_branch L_loopn_p3
.p2align 6
L_loop:
v_smfmac_f32_16x16x64_bf16 v[8:11], a[0:3], v[44:51], v138
ds_read_b128 v[32:35], v2 offset:1408
v_cvt_pk_bf16_f32 v106, v36, v37
v_smfmac_f32_16x16x64_bf16 v[8:11], a[36:39], v[52:59], v142
s_waitcnt lgkmcnt(9)
v_cvt_pk_bf16_f32 v107, v38, v39
v_smfmac_f32_16x16x64_bf16 v[12:15], a[4:7], v[44:51], v138 abid:1
ds_read_b128 v[36:39], v2 offset:1472
v_cvt_pk_bf16_f32 v112, v40, v41
v_smfmac_f32_16x16x64_bf16 v[12:15], a[40:43], v[52:59], v142 abid:1
s_waitcnt lgkmcnt(8)
ds_read_b128 v[60:63], v0 offset:4096
v_cvt_pk_bf16_f32 v113, v42, v43
v_smfmac_f32_16x16x64_bf16 v[16:19], a[8:11], v[44:51], v139
s_cmp_eq_u32 s4, 129920
ds_read_b128 v[40:43], v2 offset:1536
v_cndmask_b32_dpp v108, v96, v92, vcc quad_perm:[1,0,3,2] row_mask:0xf bank_mask:0xf
v_smfmac_f32_16x16x64_bf16 v[16:19], a[44:47], v[52:59], v143
s_waitcnt lgkmcnt(8)
ds_read_u16 v82, v82
v_cndmask_b32_dpp v109, v97, v93, vcc quad_perm:[1,0,3,2] row_mask:0xf bank_mask:0xf
v_smfmac_f32_16x16x64_bf16 v[20:23], a[12:15], v[44:51], v139 abid:1
s_cselect_b32 s43, -129920, s5
ds_read_u16 v84, v84
v_cndmask_b32_dpp v110, v98, v94, vcc quad_perm:[1,0,3,2] row_mask:0xf bank_mask:0xf
v_smfmac_f32_16x16x64_bf16 v[20:23], a[48:51], v[52:59], v143 abid:1
s_waitcnt lgkmcnt(8)
ds_read_b128 v[64:67], v1 offset:4096
v_cndmask_b32_dpp v111, v99, v95, vcc quad_perm:[1,0,3,2] row_mask:0xf bank_mask:0xf
v_smfmac_f32_16x16x64_bf16 v[24:27], a[16:19], v[44:51], v140
s_add_u32 s4, s4, s43
ds_read_b128 v[68:71], v0 offset:6144
v_add_u32_sdwa v87, s42, v123 dst_sel:DWORD dst_unused:UNUSED_PAD src0_sel:DWORD src1_sel:WORD_1
v_smfmac_f32_16x16x64_bf16 v[24:27], a[52:55], v[52:59], v144
buffer_store_dwordx4 v[108:111], v4, s[20:23], s46 offen offset:0 sc1
s_mov_b64 vcc, s[82:83]
s_waitcnt lgkmcnt(8)
ds_read_b128 v[72:75], v1 offset:6144
v_cndmask_b32_dpp v96, v92, v96, vcc quad_perm:[1,0,3,2] row_mask:0xf bank_mask:0xf
v_cndmask_b32_dpp v97, v93, v97, vcc quad_perm:[1,0,3,2] row_mask:0xf bank_mask:0xf
v_smfmac_f32_16x16x64_bf16 v[28:31], a[20:23], v[44:51], v140 abid:1
s_add_u32 s41, s41, 1
ds_read_u16 v83, v83
v_cndmask_b32_dpp v98, v94, v98, vcc quad_perm:[1,0,3,2] row_mask:0xf bank_mask:0xf
v_smfmac_f32_16x16x64_bf16 v[28:31], a[56:59], v[52:59], v144 abid:1
s_waitcnt lgkmcnt(9)
ds_read_b128 v[114:117], v2 offset:64
v_cndmask_b32_dpp v99, v95, v99, vcc quad_perm:[1,0,3,2] row_mask:0xf bank_mask:0xf
v_smfmac_f32_16x16x64_bf16 v[32:35], a[24:27], v[44:51], v141
ds_read_u16 v85, v85
v_add_u32_sdwa v88, s42, v124 dst_sel:DWORD dst_unused:UNUSED_PAD src0_sel:DWORD src1_sel:WORD_0
v_smfmac_f32_16x16x64_bf16 v[32:35], a[60:63], v[52:59], v145
s_waitcnt lgkmcnt(10)
ds_read_u16 v86, v86
v_add_u32_sdwa v89, s42, v124 dst_sel:DWORD dst_unused:UNUSED_PAD src0_sel:DWORD src1_sel:WORD_1
v_smfmac_f32_16x16x64_bf16 v[36:39], a[28:31], v[44:51], v141 abid:1
ds_read_u16 v87, v87
v_add_u32_sdwa v90, s42, v125 dst_sel:DWORD dst_unused:UNUSED_PAD src0_sel:DWORD src1_sel:WORD_0
v_smfmac_f32_16x16x64_bf16 v[36:39], a[64:67], v[52:59], v145 abid:1
s_waitcnt lgkmcnt(10)
ds_read_u16 v88, v88
v_add_u32_sdwa v91, s42, v125 dst_sel:DWORD dst_unused:UNUSED_PAD src0_sel:DWORD src1_sel:WORD_1
v_smfmac_f32_16x16x64_bf16 v[40:43], a[32:35], v[44:51], v174
buffer_store_dwordx4 v[96:99], v4, s[20:23], s46 offen offset:1152 sc1
s_mov_b64 vcc, s[80:81]
ds_read_u16 v89, v89
v_cndmask_b32_dpp v92, v104, v100, vcc quad_perm:[1,0,3,2] row_mask:0xf bank_mask:0xf
v_cndmask_b32_dpp v93, v105, v101, vcc quad_perm:[1,0,3,2] row_mask:0xf bank_mask:0xf
v_smfmac_f32_16x16x64_bf16 v[40:43], a[68:71], v[52:59], v174 abid:1
s_waitcnt lgkmcnt(9)
ds_read_u16 v90, v90
v_cndmask_b32_dpp v94, v106, v102, vcc quad_perm:[1,0,3,2] row_mask:0xf bank_mask:0xf
v_smfmac_f32_16x16x64_bf16 v[8:11], a[72:75], v[60:67], v146
s_waitcnt lgkmcnt(8)
ds_read_u16 v91, v91
v_cndmask_b32_dpp v95, v107, v103, vcc quad_perm:[1,0,3,2] row_mask:0xf bank_mask:0xf
v_smfmac_f32_16x16x64_bf16 v[8:11], a[108:111], v[68:75], v150
s_waitcnt lgkmcnt(7)
ds_bpermute_b32 v112, v6, v112
v_smfmac_f32_16x16x64_bf16 v[8:11], v[114:117], v[76:83], v179
s_waitcnt vmcnt(2)
ds_bpermute_b32 v113, v6, v113
v_smfmac_f32_16x16x64_bf16 v[12:15], v[114:117], v[76:83], v179 abid:1
ds_read_b128 v[114:117], v2 offset:128
v_add_u32_sdwa v76, s42, v126 dst_sel:DWORD dst_unused:UNUSED_PAD src0_sel:DWORD src1_sel:WORD_0
v_smfmac_f32_16x16x64_bf16 v[12:15], a[76:79], v[60:67], v146 abid:1
ds_read_u16 v76, v76
v_add_u32_sdwa v77, s42, v126 dst_sel:DWORD dst_unused:UNUSED_PAD src0_sel:DWORD src1_sel:WORD_1
v_smfmac_f32_16x16x64_bf16 v[12:15], a[112:115], v[68:75], v150 abid:1
buffer_store_dwordx4 v[92:95], v4, s[20:23], s46 offen offset:128 sc1
s_mov_b64 vcc, s[82:83]
ds_read_u16 v77, v77
v_cndmask_b32_dpp v104, v100, v104, vcc quad_perm:[1,0,3,2] row_mask:0xf bank_mask:0xf
v_add_u32_sdwa v78, s42, v127 dst_sel:DWORD dst_unused:UNUSED_PAD src0_sel:DWORD src1_sel:WORD_0
v_smfmac_f32_16x16x64_bf16 v[24:27], a[88:91], v[60:67], v148
ds_read_u16 v78, v78
v_cndmask_b32_dpp v105, v101, v105, vcc quad_perm:[1,0,3,2] row_mask:0xf bank_mask:0xf
v_smfmac_f32_16x16x64_bf16 v[24:27], a[124:127], v[68:75], v152
ds_read_b128 v[44:47], v0 offset:8192
v_cndmask_b32_dpp v106, v102, v106, vcc quad_perm:[1,0,3,2] row_mask:0xf bank_mask:0xf
v_smfmac_f32_16x16x64_bf16 v[28:31], a[92:95], v[60:67], v148 abid:1
ds_read_b128 v[48:51], v1 offset:8192
v_add_u32_sdwa v79, s42, v127 dst_sel:DWORD dst_unused:UNUSED_PAD src0_sel:DWORD src1_sel:WORD_1
v_smfmac_f32_16x16x64_bf16 v[28:31], a[128:131], v[68:75], v152 abid:1
ds_read_u16 v79, v79
v_cndmask_b32_dpp v107, v103, v107, vcc quad_perm:[1,0,3,2] row_mask:0xf bank_mask:0xf
v_smfmac_f32_16x16x64_bf16 v[32:35], a[96:99], v[60:67], v149
ds_read_b128 v[52:55], v0 offset:10240
v_add_u32_sdwa v80, s42, v128 dst_sel:DWORD dst_unused:UNUSED_PAD src0_sel:DWORD src1_sel:WORD_0
v_smfmac_f32_16x16x64_bf16 v[32:35], a[132:135], v[68:75], v153
ds_read_u16 v80, v80
v_add_u32_sdwa v81, s42, v128 dst_sel:DWORD dst_unused:UNUSED_PAD src0_sel:DWORD src1_sel:WORD_1
v_smfmac_f32_16x16x64_bf16 v[16:19], a[80:83], v[60:67], v147
buffer_store_dwordx4 v[104:107], v4, s[20:23], s46 offen offset:1280 sc1
s_mov_b64 vcc, s[80:81]
ds_read_b128 v[56:59], v1 offset:10240
v_add_u32_sdwa v82, s42, v129 dst_sel:DWORD dst_unused:UNUSED_PAD src0_sel:DWORD src1_sel:WORD_0
v_add_u32_sdwa v83, s42, v129 dst_sel:DWORD dst_unused:UNUSED_PAD src0_sel:DWORD src1_sel:WORD_1
v_smfmac_f32_16x16x64_bf16 v[16:19], a[116:119], v[68:75], v151
s_waitcnt lgkmcnt(9)
ds_read_b128 v[92:95], v0 offset:12288
v_add_u32_sdwa v100, s42, v130 dst_sel:DWORD dst_unused:UNUSED_PAD src0_sel:DWORD src1_sel:WORD_0
v_smfmac_f32_16x16x64_bf16 v[16:19], v[114:117], v[84:91], v180 abid:1
ds_read_u16 v81, v81
v_add_u32_sdwa v101, s42, v130 dst_sel:DWORD dst_unused:UNUSED_PAD src0_sel:DWORD src1_sel:WORD_1
v_smfmac_f32_16x16x64_bf16 v[20:23], v[114:117], v[84:91], v181
ds_read_b128 v[96:99], v1 offset:12288
v_add_u32_sdwa v102, s42, v131 dst_sel:DWORD dst_unused:UNUSED_PAD src0_sel:DWORD src1_sel:WORD_0
v_smfmac_f32_16x16x64_bf16 v[20:23], a[84:87], v[60:67], v147 abid:1
ds_read_u16 v100, v100
v_add_u32_sdwa v103, s42, v131 dst_sel:DWORD dst_unused:UNUSED_PAD src0_sel:DWORD src1_sel:WORD_1
v_smfmac_f32_16x16x64_bf16 v[20:23], a[120:123], v[68:75], v151 abid:1
ds_read_u16 v82, v82
v_add_u32_sdwa v104, s42, v132 dst_sel:DWORD dst_unused:UNUSED_PAD src0_sel:DWORD src1_sel:WORD_0
v_smfmac_f32_16x16x64_bf16 v[36:39], a[100:103], v[60:67], v149 abid:1
ds_read_u16 v101, v101
v_add_u32_sdwa v105, s42, v132 dst_sel:DWORD dst_unused:UNUSED_PAD src0_sel:DWORD src1_sel:WORD_1
v_smfmac_f32_16x16x64_bf16 v[36:39], a[136:139], v[68:75], v153 abid:1
buffer_store_dwordx2 v[112:113], v5, s[20:23], s46 offen
ds_read_u16 v83, v83
v_add_u32_sdwa v106, s42, v133 dst_sel:DWORD dst_unused:UNUSED_PAD src0_sel:DWORD src1_sel:WORD_0
v_smfmac_f32_16x16x64_bf16 v[40:43], a[104:107], v[60:67], v175
s_mov_b32 s22, 75497472
ds_read_b128 v[114:117], v2 offset:192
v_add_u32_sdwa v107, s42, v133 dst_sel:DWORD dst_unused:UNUSED_PAD src0_sel:DWORD src1_sel:WORD_1
v_smfmac_f32_16x16x64_bf16 v[40:43], a[140:143], v[68:75], v175 abid:1
s_waitcnt lgkmcnt(12)
ds_read_u16 v102, v102
v_add_u32_sdwa v84, s42, v134 dst_sel:DWORD dst_unused:UNUSED_PAD src0_sel:DWORD src1_sel:WORD_0
v_smfmac_f32_16x16x64_bf16 v[8:11], a[144:147], v[44:51], v154
s_waitcnt lgkmcnt(9)
ds_read_u16 v103, v103
v_add_u32_sdwa v85, s42, v134 dst_sel:DWORD dst_unused:UNUSED_PAD src0_sel:DWORD src1_sel:WORD_1
v_smfmac_f32_16x16x64_bf16 v[8:11], a[180:183], v[52:59], v158
s_waitcnt lgkmcnt(7)
ds_read_u16 v104, v104
v_add_u32_sdwa v86, s42, v135 dst_sel:DWORD dst_unused:UNUSED_PAD src0_sel:DWORD src1_sel:WORD_0
v_smfmac_f32_16x16x64_bf16 v[8:11], a[216:219], v[92:99], v162
s_mov_b32 s46, s48
ds_read_u16 v105, v105
v_add_u32_sdwa v87, s42, v135 dst_sel:DWORD dst_unused:UNUSED_PAD src0_sel:DWORD src1_sel:WORD_1
v_smfmac_f32_16x16x64_bf16 v[24:27], a[160:163], v[44:51], v156
s_add_u32 m0, s44, 0
ds_read_u16 v106, v106
v_add_u32_sdwa v88, s42, v136 dst_sel:DWORD dst_unused:UNUSED_PAD src0_sel:DWORD src1_sel:WORD_0
v_smfmac_f32_16x16x64_bf16 v[24:27], a[196:199], v[52:59], v160
buffer_load_dwordx4 v3, s[16:19], s45 offen offset:0 nt lds
v_add_u32_sdwa v89, s42, v136 dst_sel:DWORD dst_unused:UNUSED_PAD src0_sel:DWORD src1_sel:WORD_1
v_smfmac_f32_16x16x64_bf16 v[24:27], a[232:235], v[92:99], v164
s_waitcnt lgkmcnt(5)
ds_read_u16 v107, v107
v_add_u32_sdwa v90, s42, v137 dst_sel:DWORD dst_unused:UNUSED_PAD src0_sel:DWORD src1_sel:WORD_0
v_smfmac_f32_16x16x64_bf16 v[24:27], v[114:117], v[76:83], v182
s_mov_b32 s48, s49
ds_read_u16 v84, v84
v_add_u32_sdwa v91, s42, v137 dst_sel:DWORD dst_unused:UNUSED_PAD src0_sel:DWORD src1_sel:WORD_1
v_smfmac_f32_16x16x64_bf16 v[28:31], v[114:117], v[76:83], v182 abid:1
s_mov_b32 s49, s50
ds_read_b128 v[114:117], v2 offset:256
v_add_u32_sdwa v76, s4, v118 dst_sel:DWORD dst_unused:UNUSED_PAD src0_sel:DWORD src1_sel:WORD_0
v_smfmac_f32_16x16x64_bf16 v[28:31], a[164:167], v[44:51], v156 abid:1
s_add_u32 s50, s50, 4718592
ds_read_u16 v85, v85
v_add_u32_sdwa v77, s4, v118 dst_sel:DWORD dst_unused:UNUSED_PAD src0_sel:DWORD src1_sel:WORD_1
v_smfmac_f32_16x16x64_bf16 v[28:31], a[200:203], v[52:59], v160 abid:1
ds_read_u16 v86, v86
v_add_u32_sdwa v78, s4, v119 dst_sel:DWORD dst_unused:UNUSED_PAD src0_sel:DWORD src1_sel:WORD_0
v_smfmac_f32_16x16x64_bf16 v[28:31], a[236:239], v[92:99], v164 abid:1
ds_read_u16 v87, v87
v_add_u32_sdwa v79, s4, v119 dst_sel:DWORD dst_unused:UNUSED_PAD src0_sel:DWORD src1_sel:WORD_1
v_smfmac_f32_16x16x64_bf16 v[12:15], a[148:151], v[44:51], v154 abid:1
s_add_u32 m0, s44, 3840
ds_read_u16 v88, v88
v_add_u32_sdwa v80, s4, v120 dst_sel:DWORD dst_unused:UNUSED_PAD src0_sel:DWORD src1_sel:WORD_0
v_smfmac_f32_16x16x64_bf16 v[12:15], a[184:187], v[52:59], v158 abid:1
buffer_load_dwordx4 v3, s[16:19], s45 offen offset:256 nt lds
v_add_u32_sdwa v81, s4, v120 dst_sel:DWORD dst_unused:UNUSED_PAD src0_sel:DWORD src1_sel:WORD_1
v_smfmac_f32_16x16x64_bf16 v[12:15], a[220:223], v[92:99], v162 abid:1
ds_read_b128 v[60:63], v0 offset:14336
v_add_u32_sdwa v82, s4, v121 dst_sel:DWORD dst_unused:UNUSED_PAD src0_sel:DWORD src1_sel:WORD_0
v_smfmac_f32_16x16x64_bf16 v[32:35], a[168:171], v[44:51], v157
ds_read_u16 v89, v89
v_add_u32_sdwa v83, s4, v121 dst_sel:DWORD dst_unused:UNUSED_PAD src0_sel:DWORD src1_sel:WORD_1
v_smfmac_f32_16x16x64_bf16 v[32:35], a[204:207], v[52:59], v161
ds_read_b128 v[64:67], v1 offset:14336
v_smfmac_f32_16x16x64_bf16 v[32:35], a[240:243], v[92:99], v165
s_waitcnt lgkmcnt(7)
ds_read_b128 v[68:71], v0 offset:16384
v_smfmac_f32_16x16x64_bf16 v[32:35], v[114:117], v[100:107], v183 abid:1
ds_read_u16 v90, v90
v_smfmac_f32_16x16x64_bf16 v[36:39], v[114:117], v[100:107], v184
ds_read_b128 v[72:75], v1 offset:16384
v_add_u32 v0, s43, v0
v_smfmac_f32_16x16x64_bf16 v[36:39], a[172:175], v[44:51], v157 abid:1
s_add_u32 m0, s44, 7680
ds_read_u16 v91, v91
v_add_u32 v1, s43, v1
v_smfmac_f32_16x16x64_bf16 v[36:39], a[208:211], v[52:59], v161 abid:1
buffer_load_dwordx4 v3, s[16:19], s45 offen offset:512 nt lds
v_smfmac_f32_16x16x64_bf16 v[36:39], a[244:247], v[92:99], v165 abid:1
ds_read_b128 v[114:117], v2 offset:320
v_smfmac_f32_16x16x64_bf16 v[16:19], a[152:155], v[44:51], v155
s_add_u32 m0, s44, 11520
v_smfmac_f32_16x16x64_bf16 v[16:19], a[188:191], v[52:59], v159
buffer_load_dwordx4 v3, s[16:19], s45 offen offset:768 nt lds
v_smfmac_f32_16x16x64_bf16 v[16:19], a[224:227], v[92:99], v163
v_smfmac_f32_16x16x64_bf16 v[20:23], a[156:159], v[44:51], v155 abid:1
s_add_u32 m0, s44, s8
v_smfmac_f32_16x16x64_bf16 v[20:23], a[192:195], v[52:59], v159 abid:1
s_mov_b64 exec, s[10:11]
buffer_load_dwordx4 v3, s[16:19], s7 offen offset:896 nt lds
s_mov_b64 exec, -1
v_smfmac_f32_16x16x64_bf16 v[20:23], a[228:231], v[92:99], v163 abid:1
s_add_u32 s45, s45, 4718592
s_add_u32 s7, s7, 4718592
s_add_u32 s44, s44, s5
v_smfmac_f32_16x16x64_bf16 v[40:43], a[176:179], v[44:51], v176
s_cmp_ge_u32 s44, 148480
s_cselect_b32 s44, s9, s44
s_bitcmp1_b32 s92, s41
v_smfmac_f32_16x16x64_bf16 v[40:43], a[212:215], v[52:59], v176 abid:1
s_cbranch_scc1 L_loop_w
L_loop_wb:
v_smfmac_f32_16x16x64_bf16 v[40:43], a[248:251], v[92:99], v177
s_waitcnt lgkmcnt(0)
v_smfmac_f32_16x16x64_bf16 v[40:43], v[114:117], v[84:91], v185
s_waitcnt vmcnt(20)
s_barrier
v_smfmac_f32_16x16x64_bf16 v[8:11], a[252:255], v[60:67], v166
s_mov_b32 s42, s4
v_smfmac_f32_16x16x64_bf16 v[8:11], v[218:221], v[68:75], v170
ds_read_b128 v[44:47], v0 offset:0
v_add_u32_sdwa v84, s42, v122 dst_sel:DWORD dst_unused:UNUSED_PAD src0_sel:DWORD src1_sel:WORD_0
v_smfmac_f32_16x16x64_bf16 v[12:15], v[186:189], v[60:67], v166 abid:1
ds_read_b128 v[48:51], v1 offset:0
v_add_u32_sdwa v85, s42, v122 dst_sel:DWORD dst_unused:UNUSED_PAD src0_sel:DWORD src1_sel:WORD_1
v_smfmac_f32_16x16x64_bf16 v[12:15], v[222:225], v[68:75], v170 abid:1
ds_read_b128 v[52:55], v0 offset:2048
v_add_u32_sdwa v86, s42, v123 dst_sel:DWORD dst_unused:UNUSED_PAD src0_sel:DWORD src1_sel:WORD_0
v_smfmac_f32_16x16x64_bf16 v[16:19], v[190:193], v[60:67], v167
ds_read_b128 v[56:59], v1 offset:2048
v_cvt_pk_bf16_f32 v92, v8, v9
v_smfmac_f32_16x16x64_bf16 v[16:19], v[226:229], v[68:75], v171
ds_read_u16 v76, v76
v_cvt_pk_bf16_f32 v93, v10, v11
v_smfmac_f32_16x16x64_bf16 v[20:23], v[194:197], v[60:67], v167 abid:1
ds_read_b128 v[8:11], v2 offset:1024
v_cvt_pk_bf16_f32 v94, v12, v13
v_smfmac_f32_16x16x64_bf16 v[20:23], v[230:233], v[68:75], v171 abid:1
ds_read_u16 v77, v77
v_cvt_pk_bf16_f32 v95, v14, v15
v_smfmac_f32_16x16x64_bf16 v[24:27], v[198:201], v[60:67], v168
ds_read_b128 v[12:15], v2 offset:1088
v_cvt_pk_bf16_f32 v96, v16, v17
v_smfmac_f32_16x16x64_bf16 v[24:27], v[234:237], v[68:75], v172
ds_read_u16 v78, v78
v_cvt_pk_bf16_f32 v97, v18, v19
v_smfmac_f32_16x16x64_bf16 v[28:31], v[202:205], v[60:67], v168 abid:1
ds_read_b128 v[16:19], v2 offset:1152
v_cvt_pk_bf16_f32 v98, v20, v21
v_smfmac_f32_16x16x64_bf16 v[28:31], v[238:241], v[68:75], v172 abid:1
ds_read_u16 v79, v79
v_cvt_pk_bf16_f32 v99, v22, v23
v_smfmac_f32_16x16x64_bf16 v[32:35], v[206:209], v[60:67], v169
ds_read_b128 v[20:23], v2 offset:1216
v_cvt_pk_bf16_f32 v100, v24, v25
v_smfmac_f32_16x16x64_bf16 v[32:35], v[242:245], v[68:75], v173
ds_read_u16 v80, v80
v_cvt_pk_bf16_f32 v101, v26, v27
v_smfmac_f32_16x16x64_bf16 v[36:39], v[210:213], v[60:67], v169 abid:1
ds_read_b128 v[24:27], v2 offset:1280
v_cvt_pk_bf16_f32 v102, v28, v29
v_smfmac_f32_16x16x64_bf16 v[36:39], v[246:249], v[68:75], v173 abid:1
ds_read_u16 v81, v81
v_cvt_pk_bf16_f32 v103, v30, v31
v_smfmac_f32_16x16x64_bf16 v[40:43], v[214:217], v[60:67], v177 abid:1
s_bitcmp1_b32 s85, s41
ds_read_b128 v[28:31], v2 offset:1344
v_cvt_pk_bf16_f32 v104, v32, v33
v_smfmac_f32_16x16x64_bf16 v[40:43], v[250:253], v[68:75], v178
s_waitcnt lgkmcnt(10)
v_cvt_pk_bf16_f32 v105, v34, v35
s_cbranch_scc1 L_loop
s_cmp_lg_u32 s41, 6
s_cbranch_scc1 L_loopn
.p2align 3
L_loopc:
v_smfmac_f32_16x16x64_bf16 v[8:11], a[0:3], v[44:51], v138
ds_read_b128 v[32:35], v2 offset:1408
v_cvt_pk_bf16_f32 v106, v36, v37
v_mov_b32 v7, 1
v_smfmac_f32_16x16x64_bf16 v[8:11], a[36:39], v[52:59], v142
s_waitcnt lgkmcnt(9)
buffer_atomic_add v7, v6, s[32:35], 0 offen sc0 sc1
v_cvt_pk_bf16_f32 v107, v38, v39
v_smfmac_f32_16x16x64_bf16 v[12:15], a[4:7], v[44:51], v138 abid:1
ds_read_b128 v[36:39], v2 offset:1472
v_cvt_pk_bf16_f32 v112, v40, v41
v_smfmac_f32_16x16x64_bf16 v[12:15], a[40:43], v[52:59], v142 abid:1
s_waitcnt lgkmcnt(8)
ds_read_b128 v[60:63], v0 offset:4096
v_cvt_pk_bf16_f32 v113, v42, v43
v_smfmac_f32_16x16x64_bf16 v[16:19], a[8:11], v[44:51], v139
s_cmp_eq_u32 s4, 129920
ds_read_b128 v[40:43], v2 offset:1536
v_cndmask_b32_dpp v108, v96, v92, vcc quad_perm:[1,0,3,2] row_mask:0xf bank_mask:0xf
v_smfmac_f32_16x16x64_bf16 v[16:19], a[44:47], v[52:59], v143
s_waitcnt lgkmcnt(8)
ds_read_u16 v82, v82
v_cndmask_b32_dpp v109, v97, v93, vcc quad_perm:[1,0,3,2] row_mask:0xf bank_mask:0xf
v_smfmac_f32_16x16x64_bf16 v[20:23], a[12:15], v[44:51], v139 abid:1
s_cselect_b32 s43, -129920, s5
ds_read_u16 v84, v84
v_cndmask_b32_dpp v110, v98, v94, vcc quad_perm:[1,0,3,2] row_mask:0xf bank_mask:0xf
v_smfmac_f32_16x16x64_bf16 v[20:23], a[48:51], v[52:59], v143 abid:1
s_waitcnt lgkmcnt(8)
ds_read_b128 v[64:67], v1 offset:4096
v_cndmask_b32_dpp v111, v99, v95, vcc quad_perm:[1,0,3,2] row_mask:0xf bank_mask:0xf
v_smfmac_f32_16x16x64_bf16 v[24:27], a[16:19], v[44:51], v140
s_add_u32 s4, s4, s43
ds_read_b128 v[68:71], v0 offset:6144
v_add_u32_sdwa v87, s42, v123 dst_sel:DWORD dst_unused:UNUSED_PAD src0_sel:DWORD src1_sel:WORD_1
v_smfmac_f32_16x16x64_bf16 v[24:27], a[52:55], v[52:59], v144
buffer_store_dwordx4 v[108:111], v4, s[20:23], s46 offen offset:0 sc1
s_mov_b64 vcc, s[82:83]
s_waitcnt lgkmcnt(8)
ds_read_b128 v[72:75], v1 offset:6144
v_cndmask_b32_dpp v96, v92, v96, vcc quad_perm:[1,0,3,2] row_mask:0xf bank_mask:0xf
v_cndmask_b32_dpp v97, v93, v97, vcc quad_perm:[1,0,3,2] row_mask:0xf bank_mask:0xf
v_smfmac_f32_16x16x64_bf16 v[28:31], a[20:23], v[44:51], v140 abid:1
s_add_u32 s7, s45, s58
ds_read_u16 v83, v83
v_cndmask_b32_dpp v98, v94, v98, vcc quad_perm:[1,0,3,2] row_mask:0xf bank_mask:0xf
v_smfmac_f32_16x16x64_bf16 v[28:31], a[56:59], v[52:59], v144 abid:1
s_waitcnt lgkmcnt(9)
ds_read_b128 v[114:117], v2 offset:64
v_cndmask_b32_dpp v99, v95, v99, vcc quad_perm:[1,0,3,2] row_mask:0xf bank_mask:0xf
v_smfmac_f32_16x16x64_bf16 v[32:35], a[24:27], v[44:51], v141
ds_read_u16 v85, v85
v_add_u32_sdwa v88, s42, v124 dst_sel:DWORD dst_unused:UNUSED_PAD src0_sel:DWORD src1_sel:WORD_0
v_smfmac_f32_16x16x64_bf16 v[32:35], a[60:63], v[52:59], v145
s_waitcnt lgkmcnt(10)
ds_read_u16 v86, v86
v_add_u32_sdwa v89, s42, v124 dst_sel:DWORD dst_unused:UNUSED_PAD src0_sel:DWORD src1_sel:WORD_1
v_smfmac_f32_16x16x64_bf16 v[36:39], a[28:31], v[44:51], v141 abid:1
ds_read_u16 v87, v87
v_add_u32_sdwa v90, s42, v125 dst_sel:DWORD dst_unused:UNUSED_PAD src0_sel:DWORD src1_sel:WORD_0
v_smfmac_f32_16x16x64_bf16 v[36:39], a[64:67], v[52:59], v145 abid:1
s_waitcnt lgkmcnt(10)
ds_read_u16 v88, v88
v_add_u32_sdwa v91, s42, v125 dst_sel:DWORD dst_unused:UNUSED_PAD src0_sel:DWORD src1_sel:WORD_1
v_smfmac_f32_16x16x64_bf16 v[40:43], a[32:35], v[44:51], v174
buffer_store_dwordx4 v[96:99], v4, s[20:23], s46 offen offset:1152 sc1
s_mov_b64 vcc, s[80:81]
ds_read_u16 v89, v89
v_cndmask_b32_dpp v92, v104, v100, vcc quad_perm:[1,0,3,2] row_mask:0xf bank_mask:0xf
v_cndmask_b32_dpp v93, v105, v101, vcc quad_perm:[1,0,3,2] row_mask:0xf bank_mask:0xf
v_smfmac_f32_16x16x64_bf16 v[40:43], a[68:71], v[52:59], v174 abid:1
s_waitcnt lgkmcnt(9)
ds_read_u16 v90, v90
v_cndmask_b32_dpp v94, v106, v102, vcc quad_perm:[1,0,3,2] row_mask:0xf bank_mask:0xf
v_smfmac_f32_16x16x64_bf16 v[8:11], a[72:75], v[60:67], v146
s_waitcnt lgkmcnt(8)
ds_read_u16 v91, v91
v_cndmask_b32_dpp v95, v107, v103, vcc quad_perm:[1,0,3,2] row_mask:0xf bank_mask:0xf
v_smfmac_f32_16x16x64_bf16 v[8:11], a[108:111], v[68:75], v150
s_waitcnt lgkmcnt(7)
ds_bpermute_b32 v112, v6, v112
v_smfmac_f32_16x16x64_bf16 v[8:11], v[114:117], v[76:83], v179
ds_bpermute_b32 v113, v6, v113
v_smfmac_f32_16x16x64_bf16 v[12:15], v[114:117], v[76:83], v179 abid:1
ds_read_b128 v[114:117], v2 offset:128
v_add_u32_sdwa v76, s42, v126 dst_sel:DWORD dst_unused:UNUSED_PAD src0_sel:DWORD src1_sel:WORD_0
v_smfmac_f32_16x16x64_bf16 v[12:15], a[76:79], v[60:67], v146 abid:1
ds_read_u16 v76, v76
v_add_u32_sdwa v77, s42, v126 dst_sel:DWORD dst_unused:UNUSED_PAD src0_sel:DWORD src1_sel:WORD_1
v_smfmac_f32_16x16x64_bf16 v[12:15], a[112:115], v[68:75], v150 abid:1
buffer_store_dwordx4 v[92:95], v4, s[20:23], s46 offen offset:128 sc1
s_mov_b64 vcc, s[82:83]
ds_read_u16 v77, v77
v_cndmask_b32_dpp v104, v100, v104, vcc quad_perm:[1,0,3,2] row_mask:0xf bank_mask:0xf
v_add_u32_sdwa v78, s42, v127 dst_sel:DWORD dst_unused:UNUSED_PAD src0_sel:DWORD src1_sel:WORD_0
v_smfmac_f32_16x16x64_bf16 v[24:27], a[88:91], v[60:67], v148
ds_read_u16 v78, v78
v_cndmask_b32_dpp v105, v101, v105, vcc quad_perm:[1,0,3,2] row_mask:0xf bank_mask:0xf
v_smfmac_f32_16x16x64_bf16 v[24:27], a[124:127], v[68:75], v152
ds_read_b128 v[44:47], v0 offset:8192
v_cndmask_b32_dpp v106, v102, v106, vcc quad_perm:[1,0,3,2] row_mask:0xf bank_mask:0xf
v_smfmac_f32_16x16x64_bf16 v[28:31], a[92:95], v[60:67], v148 abid:1
ds_read_b128 v[48:51], v1 offset:8192
v_add_u32_sdwa v79, s42, v127 dst_sel:DWORD dst_unused:UNUSED_PAD src0_sel:DWORD src1_sel:WORD_1
v_smfmac_f32_16x16x64_bf16 v[28:31], a[128:131], v[68:75], v152 abid:1
ds_read_u16 v79, v79
v_cndmask_b32_dpp v107, v103, v107, vcc quad_perm:[1,0,3,2] row_mask:0xf bank_mask:0xf
v_smfmac_f32_16x16x64_bf16 v[32:35], a[96:99], v[60:67], v149
ds_read_b128 v[52:55], v0 offset:10240
v_add_u32_sdwa v80, s42, v128 dst_sel:DWORD dst_unused:UNUSED_PAD src0_sel:DWORD src1_sel:WORD_0
v_smfmac_f32_16x16x64_bf16 v[32:35], a[132:135], v[68:75], v153
ds_read_u16 v80, v80
v_add_u32_sdwa v81, s42, v128 dst_sel:DWORD dst_unused:UNUSED_PAD src0_sel:DWORD src1_sel:WORD_1
v_smfmac_f32_16x16x64_bf16 v[16:19], a[80:83], v[60:67], v147
buffer_store_dwordx4 v[104:107], v4, s[20:23], s46 offen offset:1280 sc1
s_mov_b64 vcc, s[80:81]
ds_read_b128 v[56:59], v1 offset:10240
v_add_u32_sdwa v82, s42, v129 dst_sel:DWORD dst_unused:UNUSED_PAD src0_sel:DWORD src1_sel:WORD_0
v_add_u32_sdwa v83, s42, v129 dst_sel:DWORD dst_unused:UNUSED_PAD src0_sel:DWORD src1_sel:WORD_1
v_smfmac_f32_16x16x64_bf16 v[16:19], a[116:119], v[68:75], v151
s_waitcnt lgkmcnt(9)
ds_read_b128 v[92:95], v0 offset:12288
v_add_u32_sdwa v100, s42, v130 dst_sel:DWORD dst_unused:UNUSED_PAD src0_sel:DWORD src1_sel:WORD_0
v_smfmac_f32_16x16x64_bf16 v[16:19], v[114:117], v[84:91], v180 abid:1
ds_read_u16 v81, v81
v_add_u32_sdwa v101, s42, v130 dst_sel:DWORD dst_unused:UNUSED_PAD src0_sel:DWORD src1_sel:WORD_1
v_smfmac_f32_16x16x64_bf16 v[20:23], v[114:117], v[84:91], v181
ds_read_b128 v[96:99], v1 offset:12288
v_add_u32_sdwa v102, s42, v131 dst_sel:DWORD dst_unused:UNUSED_PAD src0_sel:DWORD src1_sel:WORD_0
v_smfmac_f32_16x16x64_bf16 v[20:23], a[84:87], v[60:67], v147 abid:1
ds_read_u16 v100, v100
v_add_u32_sdwa v103, s42, v131 dst_sel:DWORD dst_unused:UNUSED_PAD src0_sel:DWORD src1_sel:WORD_1
v_smfmac_f32_16x16x64_bf16 v[20:23], a[120:123], v[68:75], v151 abid:1
ds_read_u16 v82, v82
v_add_u32_sdwa v104, s42, v132 dst_sel:DWORD dst_unused:UNUSED_PAD src0_sel:DWORD src1_sel:WORD_0
v_smfmac_f32_16x16x64_bf16 v[36:39], a[100:103], v[60:67], v149 abid:1
ds_read_u16 v101, v101
v_add_u32_sdwa v105, s42, v132 dst_sel:DWORD dst_unused:UNUSED_PAD src0_sel:DWORD src1_sel:WORD_1
v_smfmac_f32_16x16x64_bf16 v[36:39], a[136:139], v[68:75], v153 abid:1
buffer_store_dwordx2 v[112:113], v5, s[20:23], s46 offen
ds_read_u16 v83, v83
v_add_u32_sdwa v106, s42, v133 dst_sel:DWORD dst_unused:UNUSED_PAD src0_sel:DWORD src1_sel:WORD_0
v_smfmac_f32_16x16x64_bf16 v[40:43], a[104:107], v[60:67], v175
s_mov_b32 s46, s48
ds_read_b128 v[114:117], v2 offset:192
v_add_u32_sdwa v107, s42, v133 dst_sel:DWORD dst_unused:UNUSED_PAD src0_sel:DWORD src1_sel:WORD_1
v_smfmac_f32_16x16x64_bf16 v[40:43], a[140:143], v[68:75], v175 abid:1
s_waitcnt lgkmcnt(12)
ds_read_u16 v102, v102
v_add_u32_sdwa v84, s42, v134 dst_sel:DWORD dst_unused:UNUSED_PAD src0_sel:DWORD src1_sel:WORD_0
v_smfmac_f32_16x16x64_bf16 v[8:11], a[144:147], v[44:51], v154
s_waitcnt lgkmcnt(9)
ds_read_u16 v103, v103
v_add_u32_sdwa v85, s42, v134 dst_sel:DWORD dst_unused:UNUSED_PAD src0_sel:DWORD src1_sel:WORD_1
v_smfmac_f32_16x16x64_bf16 v[8:11], a[180:183], v[52:59], v158
s_waitcnt lgkmcnt(7)
ds_read_u16 v104, v104
v_add_u32_sdwa v86, s42, v135 dst_sel:DWORD dst_unused:UNUSED_PAD src0_sel:DWORD src1_sel:WORD_0
v_smfmac_f32_16x16x64_bf16 v[8:11], a[216:219], v[92:99], v162
s_mov_b32 s48, s49
ds_read_u16 v105, v105
v_add_u32_sdwa v87, s42, v135 dst_sel:DWORD dst_unused:UNUSED_PAD src0_sel:DWORD src1_sel:WORD_1
v_smfmac_f32_16x16x64_bf16 v[24:27], a[160:163], v[44:51], v156
s_add_u32 m0, s44, 0
ds_read_u16 v106, v106
v_add_u32_sdwa v88, s42, v136 dst_sel:DWORD dst_unused:UNUSED_PAD src0_sel:DWORD src1_sel:WORD_0
v_smfmac_f32_16x16x64_bf16 v[24:27], a[196:199], v[52:59], v160
buffer_load_dwordx4 v3, s[16:19], s45 offen offset:0 nt lds
v_add_u32_sdwa v89, s42, v136 dst_sel:DWORD dst_unused:UNUSED_PAD src0_sel:DWORD src1_sel:WORD_1
v_smfmac_f32_16x16x64_bf16 v[24:27], a[232:235], v[92:99], v164
s_waitcnt lgkmcnt(5)
ds_read_u16 v107, v107
v_add_u32_sdwa v90, s42, v137 dst_sel:DWORD dst_unused:UNUSED_PAD src0_sel:DWORD src1_sel:WORD_0
v_smfmac_f32_16x16x64_bf16 v[24:27], v[114:117], v[76:83], v182
s_waitcnt vmcnt(6)
ds_read_u16 v84, v84
v_add_u32_sdwa v91, s42, v137 dst_sel:DWORD dst_unused:UNUSED_PAD src0_sel:DWORD src1_sel:WORD_1
v_smfmac_f32_16x16x64_bf16 v[28:31], v[114:117], v[76:83], v182 abid:1
s_mov_b32 s49, s50
ds_read_b128 v[114:117], v2 offset:256
v_add_u32_sdwa v76, s4, v118 dst_sel:DWORD dst_unused:UNUSED_PAD src0_sel:DWORD src1_sel:WORD_0
v_smfmac_f32_16x16x64_bf16 v[28:31], a[164:167], v[44:51], v156 abid:1
s_mov_b32 s50, s45
ds_read_u16 v85, v85
v_add_u32_sdwa v77, s4, v118 dst_sel:DWORD dst_unused:UNUSED_PAD src0_sel:DWORD src1_sel:WORD_1
v_smfmac_f32_16x16x64_bf16 v[28:31], a[200:203], v[52:59], v160 abid:1
ds_read_u16 v86, v86
v_add_u32_sdwa v78, s4, v119 dst_sel:DWORD dst_unused:UNUSED_PAD src0_sel:DWORD src1_sel:WORD_0
v_smfmac_f32_16x16x64_bf16 v[28:31], a[236:239], v[92:99], v164 abid:1
ds_read_u16 v87, v87
v_add_u32_sdwa v79, s4, v119 dst_sel:DWORD dst_unused:UNUSED_PAD src0_sel:DWORD src1_sel:WORD_1
v_smfmac_f32_16x16x64_bf16 v[12:15], a[148:151], v[44:51], v154 abid:1
s_add_u32 m0, s44, 3840
ds_read_u16 v88, v88
v_add_u32_sdwa v80, s4, v120 dst_sel:DWORD dst_unused:UNUSED_PAD src0_sel:DWORD src1_sel:WORD_0
v_smfmac_f32_16x16x64_bf16 v[12:15], a[184:187], v[52:59], v158 abid:1
buffer_load_dwordx4 v3, s[16:19], s45 offen offset:256 nt lds
v_add_u32_sdwa v81, s4, v120 dst_sel:DWORD dst_unused:UNUSED_PAD src0_sel:DWORD src1_sel:WORD_1
v_smfmac_f32_16x16x64_bf16 v[12:15], a[220:223], v[92:99], v162 abid:1
ds_read_b128 v[60:63], v0 offset:14336
v_add_u32_sdwa v82, s4, v121 dst_sel:DWORD dst_unused:UNUSED_PAD src0_sel:DWORD src1_sel:WORD_0
v_smfmac_f32_16x16x64_bf16 v[32:35], a[168:171], v[44:51], v157
ds_read_u16 v89, v89
v_add_u32_sdwa v83, s4, v121 dst_sel:DWORD dst_unused:UNUSED_PAD src0_sel:DWORD src1_sel:WORD_1
v_smfmac_f32_16x16x64_bf16 v[32:35], a[204:207], v[52:59], v161
ds_read_b128 v[64:67], v1 offset:14336
v_smfmac_f32_16x16x64_bf16 v[32:35], a[240:243], v[92:99], v165
s_waitcnt lgkmcnt(7)
ds_read_b128 v[68:71], v0 offset:16384
v_smfmac_f32_16x16x64_bf16 v[32:35], v[114:117], v[100:107], v183 abid:1
ds_read_u16 v90, v90
v_smfmac_f32_16x16x64_bf16 v[36:39], v[114:117], v[100:107], v184
ds_read_b128 v[72:75], v1 offset:16384
v_add_u32 v0, s43, v0
v_smfmac_f32_16x16x64_bf16 v[36:39], a[172:175], v[44:51], v157 abid:1
s_add_u32 m0, s44, 7680
ds_read_u16 v91, v91
v_add_u32 v1, s43, v1
v_smfmac_f32_16x16x64_bf16 v[36:39], a[208:211], v[52:59], v161 abid:1
buffer_load_dwordx4 v3, s[16:19], s45 offen offset:512 nt lds
v_smfmac_f32_16x16x64_bf16 v[36:39], a[244:247], v[92:99], v165 abid:1
ds_read_b128 v[114:117], v2 offset:320
v_smfmac_f32_16x16x64_bf16 v[16:19], a[152:155], v[44:51], v155
s_add_u32 m0, s44, 11520
v_smfmac_f32_16x16x64_bf16 v[16:19], a[188:191], v[52:59], v159
buffer_load_dwordx4 v3, s[16:19], s45 offen offset:768 nt lds
v_smfmac_f32_16x16x64_bf16 v[16:19], a[224:227], v[92:99], v163
s_mov_b64 exec, s[62:63]
ds_write_b32 v0, v7 offset:18432
s_mov_b64 exec, -1
v_smfmac_f32_16x16x64_bf16 v[20:23], a[156:159], v[44:51], v155 abid:1
s_add_u32 m0, s44, s8
v_smfmac_f32_16x16x64_bf16 v[20:23], a[192:195], v[52:59], v159 abid:1
s_mov_b64 exec, s[10:11]
buffer_load_dwordx4 v3, s[16:19], s7 offen offset:896 nt lds
s_mov_b64 exec, -1
v_smfmac_f32_16x16x64_bf16 v[20:23], a[228:231], v[92:99], v163 abid:1
s_add_u32 s44, s44, s5
s_cmp_ge_u32 s44, 148480
s_cselect_b32 s44, s9, s44
v_smfmac_f32_16x16x64_bf16 v[40:43], a[176:179], v[44:51], v176
v_smfmac_f32_16x16x64_bf16 v[40:43], a[212:215], v[52:59], v176 abid:1
v_smfmac_f32_16x16x64_bf16 v[40:43], a[248:251], v[92:99], v177
s_waitcnt lgkmcnt(0)
v_smfmac_f32_16x16x64_bf16 v[40:43], v[114:117], v[84:91], v185
s_barrier
v_smfmac_f32_16x16x64_bf16 v[8:11], a[252:255], v[60:67], v166
s_mov_b32 s42, s4
ds_read_b32 v7, v0 offset:18432
v_smfmac_f32_16x16x64_bf16 v[8:11], v[218:221], v[68:75], v170
ds_read_b128 v[44:47], v0 offset:0
v_add_u32_sdwa v84, s42, v122 dst_sel:DWORD dst_unused:UNUSED_PAD src0_sel:DWORD src1_sel:WORD_0
v_smfmac_f32_16x16x64_bf16 v[12:15], v[186:189], v[60:67], v166 abid:1
ds_read_b128 v[48:51], v1 offset:0
v_add_u32_sdwa v85, s42, v122 dst_sel:DWORD dst_unused:UNUSED_PAD src0_sel:DWORD src1_sel:WORD_1
v_smfmac_f32_16x16x64_bf16 v[12:15], v[222:225], v[68:75], v170 abid:1
ds_read_b128 v[52:55], v0 offset:2048
v_add_u32_sdwa v86, s42, v123 dst_sel:DWORD dst_unused:UNUSED_PAD src0_sel:DWORD src1_sel:WORD_0
v_smfmac_f32_16x16x64_bf16 v[16:19], v[190:193], v[60:67], v167
ds_read_b128 v[56:59], v1 offset:2048
v_cvt_pk_bf16_f32 v92, v8, v9
v_smfmac_f32_16x16x64_bf16 v[16:19], v[226:229], v[68:75], v171
ds_read_u16 v76, v76
v_cvt_pk_bf16_f32 v93, v10, v11
v_smfmac_f32_16x16x64_bf16 v[20:23], v[194:197], v[60:67], v167 abid:1
ds_read_b128 v[8:11], v2 offset:1024
v_cvt_pk_bf16_f32 v94, v12, v13
v_smfmac_f32_16x16x64_bf16 v[20:23], v[230:233], v[68:75], v171 abid:1
ds_read_u16 v77, v77
v_cvt_pk_bf16_f32 v95, v14, v15
v_smfmac_f32_16x16x64_bf16 v[24:27], v[198:201], v[60:67], v168
ds_read_b128 v[12:15], v2 offset:1088
v_cvt_pk_bf16_f32 v96, v16, v17
v_smfmac_f32_16x16x64_bf16 v[24:27], v[234:237], v[68:75], v172
s_waitcnt lgkmcnt(8)
ds_read_u16 v78, v78
v_cvt_pk_bf16_f32 v97, v18, v19
v_readfirstlane_b32 s56, v7
v_smfmac_f32_16x16x64_bf16 v[28:31], v[202:205], v[60:67], v168 abid:1
s_lshr_b32 s60, s56, 6
ds_read_b128 v[16:19], v2 offset:1152
v_cvt_pk_bf16_f32 v98, v20, v21
v_smfmac_f32_16x16x64_bf16 v[28:31], v[238:241], v[68:75], v172 abid:1
s_mul_i32 s60, s60, 3538944
ds_read_u16 v79, v79
v_cvt_pk_bf16_f32 v99, v22, v23
v_smfmac_f32_16x16x64_bf16 v[32:35], v[206:209], v[60:67], v169
s_mul_i32 s61, s56, 18432
ds_read_b128 v[20:23], v2 offset:1216
v_cvt_pk_bf16_f32 v100, v24, v25
v_smfmac_f32_16x16x64_bf16 v[32:35], v[242:245], v[68:75], v173
s_add_u32 s60, s60, s57
ds_read_u16 v80, v80
v_cvt_pk_bf16_f32 v101, v26, v27
v_smfmac_f32_16x16x64_bf16 v[36:39], v[210:213], v[60:67], v169 abid:1
s_add_u32 s45, s60, s61
ds_read_b128 v[24:27], v2 offset:1280
v_cvt_pk_bf16_f32 v102, v28, v29
v_smfmac_f32_16x16x64_bf16 v[36:39], v[246:249], v[68:75], v173 abid:1
ds_read_u16 v81, v81
v_cvt_pk_bf16_f32 v103, v30, v31
v_smfmac_f32_16x16x64_bf16 v[40:43], v[214:217], v[60:67], v177 abid:1
s_cmp_lt_u32 s56, 384
ds_read_b128 v[28:31], v2 offset:1344
v_cvt_pk_bf16_f32 v104, v32, v33
v_smfmac_f32_16x16x64_bf16 v[40:43], v[250:253], v[68:75], v178
s_waitcnt lgkmcnt(10)
v_cvt_pk_bf16_f32 v105, v34, v35
s_cbranch_scc1 L_loopc
s_mov_b32 s41, 0
s_mov_b32 s15, 3
s_mov_b32 s12, 7
s_mov_b32 s92, 4
s_mov_b32 s87, 4
s_mov_b32 s59, -1
.p2align 3
L_loopn:
v_smfmac_f32_16x16x64_bf16 v[8:11], a[0:3], v[44:51], v138
ds_read_b128 v[32:35], v2 offset:1408
v_cvt_pk_bf16_f32 v106, v36, v37
v_smfmac_f32_16x16x64_bf16 v[8:11], a[36:39], v[52:59], v142
s_waitcnt lgkmcnt(9)
v_cvt_pk_bf16_f32 v107, v38, v39
v_smfmac_f32_16x16x64_bf16 v[12:15], a[4:7], v[44:51], v138 abid:1
ds_read_b128 v[36:39], v2 offset:1472
v_cvt_pk_bf16_f32 v112, v40, v41
v_smfmac_f32_16x16x64_bf16 v[12:15], a[40:43], v[52:59], v142 abid:1
s_waitcnt lgkmcnt(8)
ds_read_b128 v[60:63], v0 offset:4096
v_cvt_pk_bf16_f32 v113, v42, v43
v_smfmac_f32_16x16x64_bf16 v[16:19], a[8:11], v[44:51], v139
s_cmp_eq_u32 s4, 129920
ds_read_b128 v[40:43], v2 offset:1536
v_cndmask_b32_dpp v108, v96, v92, vcc quad_perm:[1,0,3,2] row_mask:0xf bank_mask:0xf
v_smfmac_f32_16x16x64_bf16 v[16:19], a[44:47], v[52:59], v143
s_waitcnt lgkmcnt(8)
ds_read_u16 v82, v82
v_cndmask_b32_dpp v109, v97, v93, vcc quad_perm:[1,0,3,2] row_mask:0xf bank_mask:0xf
v_smfmac_f32_16x16x64_bf16 v[20:23], a[12:15], v[44:51], v139 abid:1
s_cselect_b32 s43, -129920, s5
ds_read_u16 v84, v84
v_cndmask_b32_dpp v110, v98, v94, vcc quad_perm:[1,0,3,2] row_mask:0xf bank_mask:0xf
v_smfmac_f32_16x16x64_bf16 v[20:23], a[48:51], v[52:59], v143 abid:1
s_waitcnt lgkmcnt(8)
ds_read_b128 v[64:67], v1 offset:4096
v_cndmask_b32_dpp v111, v99, v95, vcc quad_perm:[1,0,3,2] row_mask:0xf bank_mask:0xf
v_smfmac_f32_16x16x64_bf16 v[24:27], a[16:19], v[44:51], v140
s_add_u32 s4, s4, s43
ds_read_b128 v[68:71], v0 offset:6144
v_add_u32_sdwa v87, s42, v123 dst_sel:DWORD dst_unused:UNUSED_PAD src0_sel:DWORD src1_sel:WORD_1
v_smfmac_f32_16x16x64_bf16 v[24:27], a[52:55], v[52:59], v144
buffer_store_dwordx4 v[108:111], v4, s[20:23], s46 offen offset:0 sc1
s_mov_b64 vcc, s[82:83]
s_waitcnt lgkmcnt(8)
ds_read_b128 v[72:75], v1 offset:6144
v_cndmask_b32_dpp v96, v92, v96, vcc quad_perm:[1,0,3,2] row_mask:0xf bank_mask:0xf
v_cndmask_b32_dpp v97, v93, v97, vcc quad_perm:[1,0,3,2] row_mask:0xf bank_mask:0xf
v_smfmac_f32_16x16x64_bf16 v[28:31], a[20:23], v[44:51], v140 abid:1
s_add_u32 s41, s41, 1
ds_read_u16 v83, v83
v_cndmask_b32_dpp v98, v94, v98, vcc quad_perm:[1,0,3,2] row_mask:0xf bank_mask:0xf
v_smfmac_f32_16x16x64_bf16 v[28:31], a[56:59], v[52:59], v144 abid:1
s_waitcnt lgkmcnt(9)
ds_read_b128 v[114:117], v2 offset:64
v_cndmask_b32_dpp v99, v95, v99, vcc quad_perm:[1,0,3,2] row_mask:0xf bank_mask:0xf
v_smfmac_f32_16x16x64_bf16 v[32:35], a[24:27], v[44:51], v141
ds_read_u16 v85, v85
v_add_u32_sdwa v88, s42, v124 dst_sel:DWORD dst_unused:UNUSED_PAD src0_sel:DWORD src1_sel:WORD_0
v_smfmac_f32_16x16x64_bf16 v[32:35], a[60:63], v[52:59], v145
s_waitcnt lgkmcnt(10)
ds_read_u16 v86, v86
v_add_u32_sdwa v89, s42, v124 dst_sel:DWORD dst_unused:UNUSED_PAD src0_sel:DWORD src1_sel:WORD_1
v_smfmac_f32_16x16x64_bf16 v[36:39], a[28:31], v[44:51], v141 abid:1
ds_read_u16 v87, v87
v_add_u32_sdwa v90, s42, v125 dst_sel:DWORD dst_unused:UNUSED_PAD src0_sel:DWORD src1_sel:WORD_0
v_smfmac_f32_16x16x64_bf16 v[36:39], a[64:67], v[52:59], v145 abid:1
s_waitcnt lgkmcnt(10)
ds_read_u16 v88, v88
v_add_u32_sdwa v91, s42, v125 dst_sel:DWORD dst_unused:UNUSED_PAD src0_sel:DWORD src1_sel:WORD_1
v_smfmac_f32_16x16x64_bf16 v[40:43], a[32:35], v[44:51], v174
buffer_store_dwordx4 v[96:99], v4, s[20:23], s46 offen offset:1152 sc1
s_mov_b64 vcc, s[80:81]
ds_read_u16 v89, v89
v_cndmask_b32_dpp v92, v104, v100, vcc quad_perm:[1,0,3,2] row_mask:0xf bank_mask:0xf
v_cndmask_b32_dpp v93, v105, v101, vcc quad_perm:[1,0,3,2] row_mask:0xf bank_mask:0xf
v_smfmac_f32_16x16x64_bf16 v[40:43], a[68:71], v[52:59], v174 abid:1
s_waitcnt lgkmcnt(9)
ds_read_u16 v90, v90
v_cndmask_b32_dpp v94, v106, v102, vcc quad_perm:[1,0,3,2] row_mask:0xf bank_mask:0xf
v_smfmac_f32_16x16x64_bf16 v[8:11], a[72:75], v[60:67], v146
s_waitcnt lgkmcnt(8)
ds_read_u16 v91, v91
v_cndmask_b32_dpp v95, v107, v103, vcc quad_perm:[1,0,3,2] row_mask:0xf bank_mask:0xf
v_smfmac_f32_16x16x64_bf16 v[8:11], a[108:111], v[68:75], v150
s_waitcnt lgkmcnt(7)
ds_bpermute_b32 v112, v6, v112
v_smfmac_f32_16x16x64_bf16 v[8:11], v[114:117], v[76:83], v179
ds_bpermute_b32 v113, v6, v113
v_smfmac_f32_16x16x64_bf16 v[12:15], v[114:117], v[76:83], v179 abid:1
ds_read_b128 v[114:117], v2 offset:128
v_add_u32_sdwa v76, s42, v126 dst_sel:DWORD dst_unused:UNUSED_PAD src0_sel:DWORD src1_sel:WORD_0
v_smfmac_f32_16x16x64_bf16 v[12:15], a[76:79], v[60:67], v146 abid:1
ds_read_u16 v76, v76
v_add_u32_sdwa v77, s42, v126 dst_sel:DWORD dst_unused:UNUSED_PAD src0_sel:DWORD src1_sel:WORD_1
v_smfmac_f32_16x16x64_bf16 v[12:15], a[112:115], v[68:75], v150 abid:1
buffer_store_dwordx4 v[92:95], v4, s[20:23], s46 offen offset:128 sc1
s_mov_b64 vcc, s[82:83]
ds_read_u16 v77, v77
v_cndmask_b32_dpp v104, v100, v104, vcc quad_perm:[1,0,3,2] row_mask:0xf bank_mask:0xf
v_add_u32_sdwa v78, s42, v127 dst_sel:DWORD dst_unused:UNUSED_PAD src0_sel:DWORD src1_sel:WORD_0
v_smfmac_f32_16x16x64_bf16 v[24:27], a[88:91], v[60:67], v148
ds_read_u16 v78, v78
v_cndmask_b32_dpp v105, v101, v105, vcc quad_perm:[1,0,3,2] row_mask:0xf bank_mask:0xf
v_smfmac_f32_16x16x64_bf16 v[24:27], a[124:127], v[68:75], v152
ds_read_b128 v[44:47], v0 offset:8192
v_cndmask_b32_dpp v106, v102, v106, vcc quad_perm:[1,0,3,2] row_mask:0xf bank_mask:0xf
v_smfmac_f32_16x16x64_bf16 v[28:31], a[92:95], v[60:67], v148 abid:1
ds_read_b128 v[48:51], v1 offset:8192
v_add_u32_sdwa v79, s42, v127 dst_sel:DWORD dst_unused:UNUSED_PAD src0_sel:DWORD src1_sel:WORD_1
v_smfmac_f32_16x16x64_bf16 v[28:31], a[128:131], v[68:75], v152 abid:1
ds_read_u16 v79, v79
v_cndmask_b32_dpp v107, v103, v107, vcc quad_perm:[1,0,3,2] row_mask:0xf bank_mask:0xf
v_smfmac_f32_16x16x64_bf16 v[32:35], a[96:99], v[60:67], v149
ds_read_b128 v[52:55], v0 offset:10240
v_add_u32_sdwa v80, s42, v128 dst_sel:DWORD dst_unused:UNUSED_PAD src0_sel:DWORD src1_sel:WORD_0
v_smfmac_f32_16x16x64_bf16 v[32:35], a[132:135], v[68:75], v153
ds_read_u16 v80, v80
v_add_u32_sdwa v81, s42, v128 dst_sel:DWORD dst_unused:UNUSED_PAD src0_sel:DWORD src1_sel:WORD_1
v_smfmac_f32_16x16x64_bf16 v[16:19], a[80:83], v[60:67], v147
buffer_store_dwordx4 v[104:107], v4, s[20:23], s46 offen offset:1280 sc1
s_mov_b64 vcc, s[80:81]
ds_read_b128 v[56:59], v1 offset:10240
v_add_u32_sdwa v82, s42, v129 dst_sel:DWORD dst_unused:UNUSED_PAD src0_sel:DWORD src1_sel:WORD_0
v_add_u32_sdwa v83, s42, v129 dst_sel:DWORD dst_unused:UNUSED_PAD src0_sel:DWORD src1_sel:WORD_1
v_smfmac_f32_16x16x64_bf16 v[16:19], a[116:119], v[68:75], v151
s_waitcnt lgkmcnt(9)
ds_read_b128 v[92:95], v0 offset:12288
v_add_u32_sdwa v100, s42, v130 dst_sel:DWORD dst_unused:UNUSED_PAD src0_sel:DWORD src1_sel:WORD_0
v_smfmac_f32_16x16x64_bf16 v[16:19], v[114:117], v[84:91], v180 abid:1
ds_read_u16 v81, v81
v_add_u32_sdwa v101, s42, v130 dst_sel:DWORD dst_unused:UNUSED_PAD src0_sel:DWORD src1_sel:WORD_1
v_smfmac_f32_16x16x64_bf16 v[20:23], v[114:117], v[84:91], v181
ds_read_b128 v[96:99], v1 offset:12288
v_add_u32_sdwa v102, s42, v131 dst_sel:DWORD dst_unused:UNUSED_PAD src0_sel:DWORD src1_sel:WORD_0
v_smfmac_f32_16x16x64_bf16 v[20:23], a[84:87], v[60:67], v147 abid:1
ds_read_u16 v100, v100
v_add_u32_sdwa v103, s42, v131 dst_sel:DWORD dst_unused:UNUSED_PAD src0_sel:DWORD src1_sel:WORD_1
v_smfmac_f32_16x16x64_bf16 v[20:23], a[120:123], v[68:75], v151 abid:1
ds_read_u16 v82, v82
v_add_u32_sdwa v104, s42, v132 dst_sel:DWORD dst_unused:UNUSED_PAD src0_sel:DWORD src1_sel:WORD_0
v_smfmac_f32_16x16x64_bf16 v[36:39], a[100:103], v[60:67], v149 abid:1
ds_read_u16 v101, v101
v_add_u32_sdwa v105, s42, v132 dst_sel:DWORD dst_unused:UNUSED_PAD src0_sel:DWORD src1_sel:WORD_1
v_smfmac_f32_16x16x64_bf16 v[36:39], a[136:139], v[68:75], v153 abid:1
buffer_store_dwordx2 v[112:113], v5, s[20:23], s46 offen
ds_read_u16 v83, v83
v_add_u32_sdwa v106, s42, v133 dst_sel:DWORD dst_unused:UNUSED_PAD src0_sel:DWORD src1_sel:WORD_0
v_smfmac_f32_16x16x64_bf16 v[40:43], a[104:107], v[60:67], v175
s_mov_b32 s22, 75497472
ds_read_b128 v[114:117], v2 offset:192
v_add_u32_sdwa v107, s42, v133 dst_sel:DWORD dst_unused:UNUSED_PAD src0_sel:DWORD src1_sel:WORD_1
v_smfmac_f32_16x16x64_bf16 v[40:43], a[140:143], v[68:75], v175 abid:1
s_waitcnt lgkmcnt(12)
ds_read_u16 v102, v102
v_add_u32_sdwa v84, s42, v134 dst_sel:DWORD dst_unused:UNUSED_PAD src0_sel:DWORD src1_sel:WORD_0
v_smfmac_f32_16x16x64_bf16 v[8:11], a[144:147], v[44:51], v154
s_waitcnt lgkmcnt(9)
ds_read_u16 v103, v103
v_add_u32_sdwa v85, s42, v134 dst_sel:DWORD dst_unused:UNUSED_PAD src0_sel:DWORD src1_sel:WORD_1
v_smfmac_f32_16x16x64_bf16 v[8:11], a[180:183], v[52:59], v158
s_waitcnt lgkmcnt(7)
ds_read_u16 v104, v104
v_add_u32_sdwa v86, s42, v135 dst_sel:DWORD dst_unused:UNUSED_PAD src0_sel:DWORD src1_sel:WORD_0
v_smfmac_f32_16x16x64_bf16 v[8:11], a[216:219], v[92:99], v162
s_mov_b32 s46, s48
ds_read_u16 v105, v105
v_add_u32_sdwa v87, s42, v135 dst_sel:DWORD dst_unused:UNUSED_PAD src0_sel:DWORD src1_sel:WORD_1
v_smfmac_f32_16x16x64_bf16 v[24:27], a[160:163], v[44:51], v156
s_mov_b32 s48, s49
ds_read_u16 v106, v106
v_add_u32_sdwa v88, s42, v136 dst_sel:DWORD dst_unused:UNUSED_PAD src0_sel:DWORD src1_sel:WORD_0
v_smfmac_f32_16x16x64_bf16 v[24:27], a[196:199], v[52:59], v160
s_mov_b32 s49, s50
s_add_u32 s50, s50, 4718592
v_add_u32_sdwa v89, s42, v136 dst_sel:DWORD dst_unused:UNUSED_PAD src0_sel:DWORD src1_sel:WORD_1
v_smfmac_f32_16x16x64_bf16 v[24:27], a[232:235], v[92:99], v164
s_waitcnt lgkmcnt(5)
ds_read_u16 v107, v107
v_add_u32_sdwa v90, s42, v137 dst_sel:DWORD dst_unused:UNUSED_PAD src0_sel:DWORD src1_sel:WORD_0
v_smfmac_f32_16x16x64_bf16 v[24:27], v[114:117], v[76:83], v182
ds_read_u16 v84, v84
v_add_u32_sdwa v91, s42, v137 dst_sel:DWORD dst_unused:UNUSED_PAD src0_sel:DWORD src1_sel:WORD_1
v_smfmac_f32_16x16x64_bf16 v[28:31], v[114:117], v[76:83], v182 abid:1
ds_read_b128 v[114:117], v2 offset:256
v_add_u32_sdwa v76, s4, v118 dst_sel:DWORD dst_unused:UNUSED_PAD src0_sel:DWORD src1_sel:WORD_0
v_smfmac_f32_16x16x64_bf16 v[28:31], a[164:167], v[44:51], v156 abid:1
ds_read_u16 v85, v85
v_add_u32_sdwa v77, s4, v118 dst_sel:DWORD dst_unused:UNUSED_PAD src0_sel:DWORD src1_sel:WORD_1
v_smfmac_f32_16x16x64_bf16 v[28:31], a[200:203], v[52:59], v160 abid:1
ds_read_u16 v86, v86
v_add_u32_sdwa v78, s4, v119 dst_sel:DWORD dst_unused:UNUSED_PAD src0_sel:DWORD src1_sel:WORD_0
v_smfmac_f32_16x16x64_bf16 v[28:31], a[236:239], v[92:99], v164 abid:1
ds_read_u16 v87, v87
v_add_u32_sdwa v79, s4, v119 dst_sel:DWORD dst_unused:UNUSED_PAD src0_sel:DWORD src1_sel:WORD_1
v_smfmac_f32_16x16x64_bf16 v[12:15], a[148:151], v[44:51], v154 abid:1
ds_read_u16 v88, v88
v_add_u32_sdwa v80, s4, v120 dst_sel:DWORD dst_unused:UNUSED_PAD src0_sel:DWORD src1_sel:WORD_0
v_smfmac_f32_16x16x64_bf16 v[12:15], a[184:187], v[52:59], v158 abid:1
v_add_u32_sdwa v81, s4, v120 dst_sel:DWORD dst_unused:UNUSED_PAD src0_sel:DWORD src1_sel:WORD_1
v_smfmac_f32_16x16x64_bf16 v[12:15], a[220:223], v[92:99], v162 abid:1
ds_read_b128 v[60:63], v0 offset:14336
v_add_u32_sdwa v82, s4, v121 dst_sel:DWORD dst_unused:UNUSED_PAD src0_sel:DWORD src1_sel:WORD_0
v_smfmac_f32_16x16x64_bf16 v[32:35], a[168:171], v[44:51], v157
ds_read_u16 v89, v89
v_add_u32_sdwa v83, s4, v121 dst_sel:DWORD dst_unused:UNUSED_PAD src0_sel:DWORD src1_sel:WORD_1
v_smfmac_f32_16x16x64_bf16 v[32:35], a[204:207], v[52:59], v161
ds_read_b128 v[64:67], v1 offset:14336
v_smfmac_f32_16x16x64_bf16 v[32:35], a[240:243], v[92:99], v165
s_waitcnt lgkmcnt(7)
ds_read_b128 v[68:71], v0 offset:16384
v_smfmac_f32_16x16x64_bf16 v[32:35], v[114:117], v[100:107], v183 abid:1
ds_read_u16 v90, v90
v_smfmac_f32_16x16x64_bf16 v[36:39], v[114:117], v[100:107], v184
ds_read_b128 v[72:75], v1 offset:16384
v_add_u32 v0, s43, v0
v_smfmac_f32_16x16x64_bf16 v[36:39], a[172:175], v[44:51], v157 abid:1
ds_read_u16 v91, v91
v_add_u32 v1, s43, v1
v_smfmac_f32_16x16x64_bf16 v[36:39], a[208:211], v[52:59], v161 abid:1
v_smfmac_f32_16x16x64_bf16 v[36:39], a[244:247], v[92:99], v165 abid:1
ds_read_b128 v[114:117], v2 offset:320
v_smfmac_f32_16x16x64_bf16 v[16:19], a[152:155], v[44:51], v155
v_smfmac_f32_16x16x64_bf16 v[16:19], a[188:191], v[52:59], v159
v_smfmac_f32_16x16x64_bf16 v[16:19], a[224:227], v[92:99], v163
v_smfmac_f32_16x16x64_bf16 v[20:23], a[156:159], v[44:51], v155 abid:1
v_smfmac_f32_16x16x64_bf16 v[20:23], a[192:195], v[52:59], v159 abid:1
v_smfmac_f32_16x16x64_bf16 v[20:23], a[228:231], v[92:99], v163 abid:1
v_smfmac_f32_16x16x64_bf16 v[40:43], a[176:179], v[44:51], v176
s_bitcmp1_b32 s92, s41
v_smfmac_f32_16x16x64_bf16 v[40:43], a[212:215], v[52:59], v176 abid:1
s_cbranch_scc1 L_loopn_w
L_loopn_wb:
v_smfmac_f32_16x16x64_bf16 v[40:43], a[248:251], v[92:99], v177
s_waitcnt lgkmcnt(0)
v_smfmac_f32_16x16x64_bf16 v[40:43], v[114:117], v[84:91], v185
s_waitcnt vmcnt(20)
s_barrier
L_loopn_p3:
v_smfmac_f32_16x16x64_bf16 v[8:11], a[252:255], v[60:67], v166
s_mov_b32 s42, s4
v_smfmac_f32_16x16x64_bf16 v[8:11], v[218:221], v[68:75], v170
ds_read_b128 v[44:47], v0 offset:0
v_add_u32_sdwa v84, s42, v122 dst_sel:DWORD dst_unused:UNUSED_PAD src0_sel:DWORD src1_sel:WORD_0
v_smfmac_f32_16x16x64_bf16 v[12:15], v[186:189], v[60:67], v166 abid:1
ds_read_b128 v[48:51], v1 offset:0
v_add_u32_sdwa v85, s42, v122 dst_sel:DWORD dst_unused:UNUSED_PAD src0_sel:DWORD src1_sel:WORD_1
v_smfmac_f32_16x16x64_bf16 v[12:15], v[222:225], v[68:75], v170 abid:1
ds_read_b128 v[52:55], v0 offset:2048
v_add_u32_sdwa v86, s42, v123 dst_sel:DWORD dst_unused:UNUSED_PAD src0_sel:DWORD src1_sel:WORD_0
v_smfmac_f32_16x16x64_bf16 v[16:19], v[190:193], v[60:67], v167
ds_read_b128 v[56:59], v1 offset:2048
v_cvt_pk_bf16_f32 v92, v8, v9
v_smfmac_f32_16x16x64_bf16 v[16:19], v[226:229], v[68:75], v171
ds_read_u16 v76, v76
v_cvt_pk_bf16_f32 v93, v10, v11
v_smfmac_f32_16x16x64_bf16 v[20:23], v[194:197], v[60:67], v167 abid:1
ds_read_b128 v[8:11], v2 offset:1024
v_cvt_pk_bf16_f32 v94, v12, v13
v_smfmac_f32_16x16x64_bf16 v[20:23], v[230:233], v[68:75], v171 abid:1
ds_read_u16 v77, v77
v_cvt_pk_bf16_f32 v95, v14, v15
v_smfmac_f32_16x16x64_bf16 v[24:27], v[198:201], v[60:67], v168
ds_read_b128 v[12:15], v2 offset:1088
v_cvt_pk_bf16_f32 v96, v16, v17
v_smfmac_f32_16x16x64_bf16 v[24:27], v[234:237], v[68:75], v172
ds_read_u16 v78, v78
v_cvt_pk_bf16_f32 v97, v18, v19
v_smfmac_f32_16x16x64_bf16 v[28:31], v[202:205], v[60:67], v168 abid:1
ds_read_b128 v[16:19], v2 offset:1152
v_cvt_pk_bf16_f32 v98, v20, v21
v_smfmac_f32_16x16x64_bf16 v[28:31], v[238:241], v[68:75], v172 abid:1
ds_read_u16 v79, v79
v_cvt_pk_bf16_f32 v99, v22, v23
v_smfmac_f32_16x16x64_bf16 v[32:35], v[206:209], v[60:67], v169
ds_read_b128 v[20:23], v2 offset:1216
v_cvt_pk_bf16_f32 v100, v24, v25
v_smfmac_f32_16x16x64_bf16 v[32:35], v[242:245], v[68:75], v173
ds_read_u16 v80, v80
v_cvt_pk_bf16_f32 v101, v26, v27
v_smfmac_f32_16x16x64_bf16 v[36:39], v[210:213], v[60:67], v169 abid:1
ds_read_b128 v[24:27], v2 offset:1280
v_cvt_pk_bf16_f32 v102, v28, v29
v_smfmac_f32_16x16x64_bf16 v[36:39], v[246:249], v[68:75], v173 abid:1
ds_read_u16 v81, v81
v_cvt_pk_bf16_f32 v103, v30, v31
v_smfmac_f32_16x16x64_bf16 v[40:43], v[214:217], v[60:67], v177 abid:1
s_bitcmp1_b32 s12, s41
ds_read_b128 v[28:31], v2 offset:1344
v_cvt_pk_bf16_f32 v104, v32, v33
v_smfmac_f32_16x16x64_bf16 v[40:43], v[250:253], v[68:75], v178
s_waitcnt lgkmcnt(10)
v_cvt_pk_bf16_f32 v105, v34, v35
s_cbranch_scc1 L_loopn
s_cmp_eq_u32 s41, s59
s_cbranch_scc1 L_loopc
s_cmp_lt_u32 s41, s15
s_cbranch_scc1 L_loop
s_nop 0
v_cndmask_b32_dpp v108, v96, v92, vcc quad_perm:[1,0,3,2] row_mask:0xf bank_mask:0xf
v_cndmask_b32_dpp v109, v97, v93, vcc quad_perm:[1,0,3,2] row_mask:0xf bank_mask:0xf
v_cndmask_b32_dpp v110, v98, v94, vcc quad_perm:[1,0,3,2] row_mask:0xf bank_mask:0xf
v_cndmask_b32_dpp v111, v99, v95, vcc quad_perm:[1,0,3,2] row_mask:0xf bank_mask:0xf
buffer_store_dwordx4 v[108:111], v4, s[20:23], s46 offen offset:0 sc1
s_mov_b64 vcc, s[82:83]
v_cvt_pk_bf16_f32 v112, v40, v41
v_cvt_pk_bf16_f32 v113, v42, v43
ds_bpermute_b32 v112, v6, v112
ds_bpermute_b32 v113, v6, v113
v_cndmask_b32_dpp v96, v92, v96, vcc quad_perm:[1,0,3,2] row_mask:0xf bank_mask:0xf
v_cndmask_b32_dpp v97, v93, v97, vcc quad_perm:[1,0,3,2] row_mask:0xf bank_mask:0xf
v_cndmask_b32_dpp v98, v94, v98, vcc quad_perm:[1,0,3,2] row_mask:0xf bank_mask:0xf
v_cndmask_b32_dpp v99, v95, v99, vcc quad_perm:[1,0,3,2] row_mask:0xf bank_mask:0xf
buffer_store_dwordx4 v[96:99], v4, s[20:23], s46 offen offset:1152 sc1
s_mov_b64 vcc, s[80:81]
v_cvt_pk_bf16_f32 v106, v36, v37
v_cvt_pk_bf16_f32 v107, v38, v39
v_cndmask_b32_dpp v92, v104, v100, vcc quad_perm:[1,0,3,2] row_mask:0xf bank_mask:0xf
v_cndmask_b32_dpp v93, v105, v101, vcc quad_perm:[1,0,3,2] row_mask:0xf bank_mask:0xf
v_cndmask_b32_dpp v94, v106, v102, vcc quad_perm:[1,0,3,2] row_mask:0xf bank_mask:0xf
v_cndmask_b32_dpp v95, v107, v103, vcc quad_perm:[1,0,3,2] row_mask:0xf bank_mask:0xf
buffer_store_dwordx4 v[92:95], v4, s[20:23], s46 offen offset:128 sc1
s_mov_b64 vcc, s[82:83]
v_cndmask_b32_dpp v104, v100, v104, vcc quad_perm:[1,0,3,2] row_mask:0xf bank_mask:0xf
v_cndmask_b32_dpp v105, v101, v105, vcc quad_perm:[1,0,3,2] row_mask:0xf bank_mask:0xf
v_cndmask_b32_dpp v106, v102, v106, vcc quad_perm:[1,0,3,2] row_mask:0xf bank_mask:0xf
v_cndmask_b32_dpp v107, v103, v107, vcc quad_perm:[1,0,3,2] row_mask:0xf bank_mask:0xf
buffer_store_dwordx4 v[104:107], v4, s[20:23], s46 offen offset:1280 sc1
s_mov_b64 vcc, s[80:81]
s_waitcnt lgkmcnt(0)
buffer_store_dwordx2 v[112:113], v5, s[20:23], s46 offen
L_fin:
L_end_standalone__structured_sparse_n_m__ragged_kernel:
s_endpgm
L_more1:
v_and_b32 v73, v94, v16
v_lshrrev_b32 v72, 10, v16
v_cmp_eq_u32 s[64:65], v73, v95
v_and_or_b32 v32, v72, v96, v97
s_mov_b64 exec, s[64:65]
ds_add_rtn_u32 v48, v32, v88
s_mov_b64 exec, -1
v_and_b32 v73, v94, v17
v_lshrrev_b32 v72, 10, v17
v_cmp_eq_u32 s[66:67], v73, v95
v_and_or_b32 v33, v72, v96, v97
s_mov_b64 exec, s[66:67]
ds_add_rtn_u32 v49, v33, v88
s_mov_b64 exec, -1
v_and_b32 v73, v94, v18
v_lshrrev_b32 v72, 10, v18
v_cmp_eq_u32 s[68:69], v73, v95
v_and_or_b32 v34, v72, v96, v97
s_mov_b64 exec, s[68:69]
ds_add_rtn_u32 v50, v34, v88
s_mov_b64 exec, -1
v_and_b32 v73, v94, v19
v_lshrrev_b32 v72, 10, v19
v_cmp_eq_u32 s[70:71], v73, v95
v_and_or_b32 v35, v72, v96, v97
s_mov_b64 exec, s[70:71]
ds_add_rtn_u32 v51, v35, v88
s_mov_b64 exec, -1
v_and_b32 v73, v94, v20
v_lshrrev_b32 v72, 10, v20
v_cmp_eq_u32 s[72:73], v73, v95
v_and_or_b32 v36, v72, v96, v97
s_mov_b64 exec, s[72:73]
ds_add_rtn_u32 v52, v36, v88
s_mov_b64 exec, -1
v_and_b32 v73, v94, v21
v_lshrrev_b32 v72, 10, v21
v_cmp_eq_u32 s[74:75], v73, v95
v_and_or_b32 v37, v72, v96, v97
s_mov_b64 exec, s[74:75]
ds_add_rtn_u32 v53, v37, v88
s_mov_b64 exec, -1
v_and_b32 v73, v94, v22
v_lshrrev_b32 v72, 10, v22
v_cmp_eq_u32 s[76:77], v73, v95
v_and_or_b32 v38, v72, v96, v97
s_mov_b64 exec, s[76:77]
ds_add_rtn_u32 v54, v38, v88
s_mov_b64 exec, -1
s_branch L_more1b
L_greedy:
s_mov_b32 s47, 0
s_mov_b32 s89, 1
v_readlane_b32 s3, v72, 0
s_max_u32 s47, s47, 0
v_writelane_b32 v91, s47, 0
s_nop 1
s_add_u32 s47, s47, s3
s_cmp_gt_u32 s47, 32
s_cselect_b32 s90, 1, s90
v_readlane_b32 s3, v72, 1
s_max_u32 s47, s47, 0
v_writelane_b32 v91, s47, 1
s_nop 1
s_add_u32 s47, s47, s3
s_cmp_gt_u32 s47, 64
s_cselect_b32 s90, 1, s90
v_readlane_b32 s3, v72, 2
s_max_u32 s47, s47, 32
v_writelane_b32 v91, s47, 2
s_nop 1
s_add_u32 s47, s47, s3
s_cmp_gt_u32 s47, 64
s_cselect_b32 s90, 1, s90
v_readlane_b32 s3, v72, 3
s_max_u32 s47, s47, 32
v_writelane_b32 v91, s47, 3
s_nop 1
s_add_u32 s47, s47, s3
s_cmp_gt_u32 s47, 96
s_cselect_b32 s90, 1, s90
v_readlane_b32 s3, v72, 4
s_max_u32 s47, s47, 64
v_writelane_b32 v91, s47, 4
s_nop 1
s_add_u32 s47, s47, s3
s_cmp_gt_u32 s47, 96
s_cselect_b32 s90, 1, s90
v_readlane_b32 s3, v72, 5
s_max_u32 s47, s47, 64
v_writelane_b32 v91, s47, 5
s_nop 1
s_add_u32 s47, s47, s3
s_cmp_gt_u32 s47, 128
s_cselect_b32 s90, 1, s90
v_readlane_b32 s3, v72, 6
s_max_u32 s47, s47, 96
v_writelane_b32 v91, s47, 6
s_nop 1
s_add_u32 s47, s47, s3
s_cmp_gt_u32 s47, 128
s_cselect_b32 s90, 1, s90
v_readlane_b32 s3, v72, 7
s_max_u32 s47, s47, 96
v_writelane_b32 v91, s47, 7
s_nop 1
s_add_u32 s47, s47, s3
s_cmp_gt_u32 s47, 160
s_cselect_b32 s90, 1, s90
v_readlane_b32 s3, v72, 8
s_max_u32 s47, s47, 128
v_writelane_b32 v91, s47, 8
s_nop 1
s_add_u32 s47, s47, s3
s_cmp_gt_u32 s47, 160
s_cselect_b32 s90, 1, s90
s_cmp_lg_u32 s90, 0
s_cselect_b64 s[90:91], -1, 0
v_mov_b32 v73, 163072
s_mov_b64 exec, s[90:91]
ds_write_b32 v73, v88
s_mov_b64 exec, -1
s_branch L_greedyb
L_more2:
ds_bpermute_b32 v64, v32, v91
ds_bpermute_b32 v65, v33, v91
ds_bpermute_b32 v66, v34, v91
ds_bpermute_b32 v67, v35, v91
ds_bpermute_b32 v68, v36, v91
ds_bpermute_b32 v69, v37, v91
ds_bpermute_b32 v70, v38, v91
s_waitcnt lgkmcnt(0)
v_add_u32 v73, v48, v64
v_and_b32 v72, 0x87e, v16
v_lshl_add_u32 v73, v73, 1, s93
v_add_u32 v72, v90, v72
s_andn2_b64 exec, s[64:65], s[90:91]
ds_write_b16_d16_hi v73, v16 offset:64
ds_write_b16 v73, v72 offset:384
ds_write_b16 v73, v16 offset:704
s_mov_b64 exec, -1
v_add_u32 v73, v49, v65
v_and_b32 v72, 0x87e, v17
v_lshl_add_u32 v73, v73, 1, s93
v_add_u32 v72, v90, v72
s_andn2_b64 exec, s[66:67], s[90:91]
ds_write_b16_d16_hi v73, v17 offset:64
ds_write_b16 v73, v72 offset:384
ds_write_b16 v73, v17 offset:704
s_mov_b64 exec, -1
v_add_u32 v73, v50, v66
v_and_b32 v72, 0x87e, v18
v_lshl_add_u32 v73, v73, 1, s93
v_add_u32 v72, v90, v72
s_andn2_b64 exec, s[68:69], s[90:91]
ds_write_b16_d16_hi v73, v18 offset:64
ds_write_b16 v73, v72 offset:384
ds_write_b16 v73, v18 offset:704
s_mov_b64 exec, -1
v_add_u32 v73, v51, v67
v_and_b32 v72, 0x87e, v19
v_lshl_add_u32 v73, v73, 1, s93
v_add_u32 v72, v90, v72
s_andn2_b64 exec, s[70:71], s[90:91]
ds_write_b16_d16_hi v73, v19 offset:64
ds_write_b16 v73, v72 offset:384
ds_write_b16 v73, v19 offset:704
s_mov_b64 exec, -1
v_add_u32 v73, v52, v68
v_and_b32 v72, 0x87e, v20
v_lshl_add_u32 v73, v73, 1, s93
v_add_u32 v72, v90, v72
s_andn2_b64 exec, s[72:73], s[90:91]
ds_write_b16_d16_hi v73, v20 offset:64
ds_write_b16 v73, v72 offset:384
ds_write_b16 v73, v20 offset:704
s_mov_b64 exec, -1
v_add_u32 v73, v53, v69
v_and_b32 v72, 0x87e, v21
v_lshl_add_u32 v73, v73, 1, s93
v_add_u32 v72, v90, v72
s_andn2_b64 exec, s[74:75], s[90:91]
ds_write_b16_d16_hi v73, v21 offset:64
ds_write_b16 v73, v72 offset:384
ds_write_b16 v73, v21 offset:704
s_mov_b64 exec, -1
v_add_u32 v73, v54, v70
v_and_b32 v72, 0x87e, v22
v_lshl_add_u32 v73, v73, 1, s93
v_add_u32 v72, v90, v72
s_andn2_b64 exec, s[76:77], s[90:91]
ds_write_b16_d16_hi v73, v22 offset:64
ds_write_b16 v73, v72 offset:384
ds_write_b16 v73, v22 offset:704
s_mov_b64 exec, -1
s_branch L_more2b
L_giveup:
s_waitcnt vmcnt(0)
v_mov_b32 v8, 163072
v_mov_b32 v9, 1
ds_write_b32 v8, v9
s_branch L_polled
L_loop_w:
s_bitcmp1_b32 s87, s41
s_waitcnt vmcnt(15)
s_cbranch_scc0 L_loop_wb
s_waitcnt vmcnt(10)
s_branch L_loop_wb
L_loopn_w:
s_bitcmp1_b32 s87, s41
s_waitcnt vmcnt(15)
s_cbranch_scc0 L_loopn_wb
s_waitcnt vmcnt(10)
s_branch L_loopn_wb
L_linked:
.p2align 6
L_loopk:
v_smfmac_f32_16x16x64_bf16 v[8:11], a[0:3], v[44:51], v138
ds_read_b128 v[32:35], v2 offset:1408
v_cvt_pk_bf16_f32 v106, v36, v37
v_smfmac_f32_16x16x64_bf16 v[8:11], a[36:39], v[52:59], v142
s_waitcnt lgkmcnt(9)
v_cvt_pk_bf16_f32 v107, v38, v39
v_smfmac_f32_16x16x64_bf16 v[12:15], a[4:7], v[44:51], v138 abid:1
ds_read_b128 v[36:39], v2 offset:1472
v_cvt_pk_bf16_f32 v112, v40, v41
v_smfmac_f32_16x16x64_bf16 v[12:15], a[40:43], v[52:59], v142 abid:1
s_waitcnt lgkmcnt(8)
ds_read_b128 v[60:63], v0 offset:4096
v_cvt_pk_bf16_f32 v113, v42, v43
v_smfmac_f32_16x16x64_bf16 v[16:19], a[8:11], v[44:51], v139
s_cmp_eq_u32 s4, 129920
ds_read_b128 v[40:43], v2 offset:1536
v_cndmask_b32_dpp v108, v96, v92, vcc quad_perm:[1,0,3,2] row_mask:0xf bank_mask:0xf
v_smfmac_f32_16x16x64_bf16 v[16:19], a[44:47], v[52:59], v143
s_waitcnt lgkmcnt(8)
ds_read_u16 v82, v82
v_cndmask_b32_dpp v109, v97, v93, vcc quad_perm:[1,0,3,2] row_mask:0xf bank_mask:0xf
v_smfmac_f32_16x16x64_bf16 v[20:23], a[12:15], v[44:51], v139 abid:1
s_cselect_b32 s43, -129920, s5
ds_read_u16 v84, v84
v_cndmask_b32_dpp v110, v98, v94, vcc quad_perm:[1,0,3,2] row_mask:0xf bank_mask:0xf
v_smfmac_f32_16x16x64_bf16 v[20:23], a[48:51], v[52:59], v143 abid:1
s_waitcnt lgkmcnt(8)
ds_read_b128 v[64:67], v1 offset:4096
v_cndmask_b32_dpp v111, v99, v95, vcc quad_perm:[1,0,3,2] row_mask:0xf bank_mask:0xf
v_smfmac_f32_16x16x64_bf16 v[24:27], a[16:19], v[44:51], v140
s_add_u32 s4, s4, s43
ds_read_b128 v[68:71], v0 offset:6144
v_add_u32_sdwa v87, s42, v123 dst_sel:DWORD dst_unused:UNUSED_PAD src0_sel:DWORD src1_sel:WORD_1
v_smfmac_f32_16x16x64_bf16 v[24:27], a[52:55], v[52:59], v144
buffer_store_dwordx4 v[108:111], v4, s[20:23], s46 offen offset:0 sc1
s_mov_b64 vcc, s[82:83]
s_waitcnt lgkmcnt(8)
ds_read_b128 v[72:75], v1 offset:6144
v_cndmask_b32_dpp v96, v92, v96, vcc quad_perm:[1,0,3,2] row_mask:0xf bank_mask:0xf
v_cndmask_b32_dpp v97, v93, v97, vcc quad_perm:[1,0,3,2] row_mask:0xf bank_mask:0xf
v_smfmac_f32_16x16x64_bf16 v[28:31], a[20:23], v[44:51], v140 abid:1
s_add_u32 s41, s41, 1
ds_read_u16 v83, v83
v_cndmask_b32_dpp v98, v94, v98, vcc quad_perm:[1,0,3,2] row_mask:0xf bank_mask:0xf
v_smfmac_f32_16x16x64_bf16 v[28:31], a[56:59], v[52:59], v144 abid:1
s_waitcnt lgkmcnt(9)
ds_read_b128 v[114:117], v2 offset:64
v_cndmask_b32_dpp v99, v95, v99, vcc quad_perm:[1,0,3,2] row_mask:0xf bank_mask:0xf
v_smfmac_f32_16x16x64_bf16 v[32:35], a[24:27], v[44:51], v141
ds_read_u16 v85, v85
v_add_u32_sdwa v88, s42, v124 dst_sel:DWORD dst_unused:UNUSED_PAD src0_sel:DWORD src1_sel:WORD_0
v_smfmac_f32_16x16x64_bf16 v[32:35], a[60:63], v[52:59], v145
s_waitcnt lgkmcnt(10)
ds_read_u16 v86, v86
v_add_u32_sdwa v89, s42, v124 dst_sel:DWORD dst_unused:UNUSED_PAD src0_sel:DWORD src1_sel:WORD_1
v_smfmac_f32_16x16x64_bf16 v[36:39], a[28:31], v[44:51], v141 abid:1
ds_read_u16 v87, v87
v_add_u32_sdwa v90, s42, v125 dst_sel:DWORD dst_unused:UNUSED_PAD src0_sel:DWORD src1_sel:WORD_0
v_smfmac_f32_16x16x64_bf16 v[36:39], a[64:67], v[52:59], v145 abid:1
s_waitcnt lgkmcnt(10)
ds_read_u16 v88, v88
v_add_u32_sdwa v91, s42, v125 dst_sel:DWORD dst_unused:UNUSED_PAD src0_sel:DWORD src1_sel:WORD_1
v_smfmac_f32_16x16x64_bf16 v[40:43], a[32:35], v[44:51], v174
buffer_store_dwordx4 v[96:99], v4, s[20:23], s46 offen offset:1152 sc1
s_mov_b64 vcc, s[80:81]
ds_read_u16 v89, v89
v_cndmask_b32_dpp v92, v104, v100, vcc quad_perm:[1,0,3,2] row_mask:0xf bank_mask:0xf
v_cndmask_b32_dpp v93, v105, v101, vcc quad_perm:[1,0,3,2] row_mask:0xf bank_mask:0xf
v_smfmac_f32_16x16x64_bf16 v[40:43], a[68:71], v[52:59], v174 abid:1
s_waitcnt lgkmcnt(9)
ds_read_u16 v90, v90
v_cndmask_b32_dpp v94, v106, v102, vcc quad_perm:[1,0,3,2] row_mask:0xf bank_mask:0xf
v_smfmac_f32_16x16x64_bf16 v[8:11], a[72:75], v[60:67], v146
s_waitcnt lgkmcnt(8)
ds_read_u16 v91, v91
v_cndmask_b32_dpp v95, v107, v103, vcc quad_perm:[1,0,3,2] row_mask:0xf bank_mask:0xf
v_smfmac_f32_16x16x64_bf16 v[8:11], a[108:111], v[68:75], v150
s_waitcnt lgkmcnt(7)
ds_bpermute_b32 v112, v6, v112
v_smfmac_f32_16x16x64_bf16 v[8:11], v[114:117], v[76:83], v179
s_waitcnt vmcnt(2)
ds_bpermute_b32 v113, v6, v113
v_smfmac_f32_16x16x64_bf16 v[12:15], v[114:117], v[76:83], v179 abid:1
ds_read_b128 v[114:117], v2 offset:128
v_add_u32_sdwa v76, s42, v126 dst_sel:DWORD dst_unused:UNUSED_PAD src0_sel:DWORD src1_sel:WORD_0
v_smfmac_f32_16x16x64_bf16 v[12:15], a[76:79], v[60:67], v146 abid:1
ds_read_u16 v76, v76
v_add_u32_sdwa v77, s42, v126 dst_sel:DWORD dst_unused:UNUSED_PAD src0_sel:DWORD src1_sel:WORD_1
v_smfmac_f32_16x16x64_bf16 v[12:15], a[112:115], v[68:75], v150 abid:1
buffer_store_dwordx4 v[92:95], v4, s[20:23], s46 offen offset:128 sc1
s_mov_b64 vcc, s[82:83]
ds_read_u16 v77, v77
v_cndmask_b32_dpp v104, v100, v104, vcc quad_perm:[1,0,3,2] row_mask:0xf bank_mask:0xf
v_cndmask_b32_dpp v105, v101, v105, vcc quad_perm:[1,0,3,2] row_mask:0xf bank_mask:0xf
v_smfmac_f32_16x16x64_bf16 v[24:27], a[88:91], v[60:67], v148
ds_read_b128 v[44:47], v0 offset:8192
v_add_u32_sdwa v78, s42, v127 dst_sel:DWORD dst_unused:UNUSED_PAD src0_sel:DWORD src1_sel:WORD_0
v_smfmac_f32_16x16x64_bf16 v[24:27], a[124:127], v[68:75], v152
ds_read_u16 v78, v78
v_cndmask_b32_dpp v106, v102, v106, vcc quad_perm:[1,0,3,2] row_mask:0xf bank_mask:0xf
v_smfmac_f32_16x16x64_bf16 v[28:31], a[92:95], v[60:67], v148 abid:1
ds_read_b128 v[48:51], v1 offset:8192
v_cndmask_b32_dpp v107, v103, v107, vcc quad_perm:[1,0,3,2] row_mask:0xf bank_mask:0xf
v_smfmac_f32_16x16x64_bf16 v[28:31], a[128:131], v[68:75], v152 abid:1
ds_read_b128 v[52:55], v0 offset:10240
v_add_u32_sdwa v79, s42, v127 dst_sel:DWORD dst_unused:UNUSED_PAD src0_sel:DWORD src1_sel:WORD_1
v_smfmac_f32_16x16x64_bf16 v[32:35], a[96:99], v[60:67], v149
ds_read_u16 v79, v79
v_add_u32_sdwa v80, s42, v128 dst_sel:DWORD dst_unused:UNUSED_PAD src0_sel:DWORD src1_sel:WORD_0
v_smfmac_f32_16x16x64_bf16 v[32:35], a[132:135], v[68:75], v153
ds_read_u16 v80, v80
v_add_u32_sdwa v81, s42, v128 dst_sel:DWORD dst_unused:UNUSED_PAD src0_sel:DWORD src1_sel:WORD_1
v_smfmac_f32_16x16x64_bf16 v[16:19], a[80:83], v[60:67], v147
buffer_store_dwordx4 v[104:107], v4, s[20:23], s46 offen offset:1280 sc1
s_mov_b64 vcc, s[80:81]
ds_read_b128 v[56:59], v1 offset:10240
v_add_u32_sdwa v82, s42, v129 dst_sel:DWORD dst_unused:UNUSED_PAD src0_sel:DWORD src1_sel:WORD_0
v_add_u32_sdwa v83, s42, v129 dst_sel:DWORD dst_unused:UNUSED_PAD src0_sel:DWORD src1_sel:WORD_1
v_smfmac_f32_16x16x64_bf16 v[16:19], a[116:119], v[68:75], v151
s_waitcnt lgkmcnt(9)
ds_read_b128 v[92:95], v0 offset:12288
v_add_u32_sdwa v100, s42, v130 dst_sel:DWORD dst_unused:UNUSED_PAD src0_sel:DWORD src1_sel:WORD_0
v_smfmac_f32_16x16x64_bf16 v[16:19], v[114:117], v[84:91], v180 abid:1
ds_read_u16 v81, v81
v_add_u32_sdwa v101, s42, v130 dst_sel:DWORD dst_unused:UNUSED_PAD src0_sel:DWORD src1_sel:WORD_1
v_smfmac_f32_16x16x64_bf16 v[12:15], v[114:117], v[84:91], v180
ds_read_b128 v[96:99], v1 offset:12288
v_add_u32_sdwa v102, s42, v131 dst_sel:DWORD dst_unused:UNUSED_PAD src0_sel:DWORD src1_sel:WORD_0
v_smfmac_f32_16x16x64_bf16 v[20:23], v[114:117], v[84:91], v181
ds_read_u16 v82, v82
v_add_u32_sdwa v103, s42, v131 dst_sel:DWORD dst_unused:UNUSED_PAD src0_sel:DWORD src1_sel:WORD_1
v_smfmac_f32_16x16x64_bf16 v[20:23], a[84:87], v[60:67], v147 abid:1
ds_read_u16 v100, v100
v_add_u32_sdwa v104, s42, v132 dst_sel:DWORD dst_unused:UNUSED_PAD src0_sel:DWORD src1_sel:WORD_0
v_smfmac_f32_16x16x64_bf16 v[20:23], a[120:123], v[68:75], v151 abid:1
ds_read_u16 v83, v83
v_add_u32_sdwa v105, s42, v132 dst_sel:DWORD dst_unused:UNUSED_PAD src0_sel:DWORD src1_sel:WORD_1
v_smfmac_f32_16x16x64_bf16 v[36:39], a[100:103], v[60:67], v149 abid:1
buffer_store_dwordx2 v[112:113], v5, s[20:23], s46 offen
ds_read_b128 v[114:117], v2 offset:192
v_add_u32_sdwa v106, s42, v133 dst_sel:DWORD dst_unused:UNUSED_PAD src0_sel:DWORD src1_sel:WORD_0
v_smfmac_f32_16x16x64_bf16 v[36:39], a[136:139], v[68:75], v153 abid:1
s_mov_b32 s22, 75497472
ds_read_u16 v101, v101
v_add_u32_sdwa v107, s42, v133 dst_sel:DWORD dst_unused:UNUSED_PAD src0_sel:DWORD src1_sel:WORD_1
v_smfmac_f32_16x16x64_bf16 v[40:43], a[104:107], v[60:67], v175
s_mov_b32 s46, s48
ds_read_u16 v102, v102
v_add_u32_sdwa v84, s42, v134 dst_sel:DWORD dst_unused:UNUSED_PAD src0_sel:DWORD src1_sel:WORD_0
v_smfmac_f32_16x16x64_bf16 v[40:43], a[140:143], v[68:75], v175 abid:1
s_waitcnt lgkmcnt(13)
ds_read_u16 v103, v103
v_add_u32_sdwa v85, s42, v134 dst_sel:DWORD dst_unused:UNUSED_PAD src0_sel:DWORD src1_sel:WORD_1
v_smfmac_f32_16x16x64_bf16 v[8:11], a[144:147], v[44:51], v154
s_waitcnt lgkmcnt(10)
ds_read_u16 v104, v104
v_add_u32_sdwa v86, s42, v135 dst_sel:DWORD dst_unused:UNUSED_PAD src0_sel:DWORD src1_sel:WORD_0
v_smfmac_f32_16x16x64_bf16 v[8:11], a[180:183], v[52:59], v158
s_waitcnt lgkmcnt(8)
ds_read_u16 v105, v105
v_add_u32_sdwa v87, s42, v135 dst_sel:DWORD dst_unused:UNUSED_PAD src0_sel:DWORD src1_sel:WORD_1
v_smfmac_f32_16x16x64_bf16 v[8:11], a[216:219], v[92:99], v162
s_add_u32 m0, s44, 0
ds_read_u16 v106, v106
v_add_u32_sdwa v88, s42, v136 dst_sel:DWORD dst_unused:UNUSED_PAD src0_sel:DWORD src1_sel:WORD_0
v_smfmac_f32_16x16x64_bf16 v[24:27], a[160:163], v[44:51], v156
buffer_load_dwordx4 v3, s[16:19], s45 offen offset:0 nt lds
v_add_u32_sdwa v89, s42, v136 dst_sel:DWORD dst_unused:UNUSED_PAD src0_sel:DWORD src1_sel:WORD_1
v_smfmac_f32_16x16x64_bf16 v[24:27], a[196:199], v[52:59], v160
s_mov_b32 s48, s49
ds_read_u16 v107, v107
v_add_u32_sdwa v90, s42, v137 dst_sel:DWORD dst_unused:UNUSED_PAD src0_sel:DWORD src1_sel:WORD_0
v_smfmac_f32_16x16x64_bf16 v[24:27], a[232:235], v[92:99], v164
s_waitcnt lgkmcnt(7)
ds_read_u16 v84, v84
v_add_u32_sdwa v91, s42, v137 dst_sel:DWORD dst_unused:UNUSED_PAD src0_sel:DWORD src1_sel:WORD_1
v_smfmac_f32_16x16x64_bf16 v[24:27], v[114:117], v[76:83], v182
s_mov_b32 s49, s50
ds_read_u16 v85, v85
v_smfmac_f32_16x16x64_bf16 v[20:23], v[114:117], v[76:83], v181 abid:1
s_add_u32 s50, s50, 4718592
ds_read_u16 v86, v86
v_smfmac_f32_16x16x64_bf16 v[28:31], v[114:117], v[76:83], v182 abid:1
ds_read_b128 v[114:117], v2 offset:256
v_add_u32_sdwa v76, s4, v118 dst_sel:DWORD dst_unused:UNUSED_PAD src0_sel:DWORD src1_sel:WORD_0
v_smfmac_f32_16x16x64_bf16 v[28:31], a[164:167], v[44:51], v156 abid:1
ds_read_u16 v87, v87
v_add_u32_sdwa v77, s4, v118 dst_sel:DWORD dst_unused:UNUSED_PAD src0_sel:DWORD src1_sel:WORD_1
v_smfmac_f32_16x16x64_bf16 v[28:31], a[200:203], v[52:59], v160 abid:1
ds_read_u16 v88, v88
v_add_u32_sdwa v78, s4, v119 dst_sel:DWORD dst_unused:UNUSED_PAD src0_sel:DWORD src1_sel:WORD_0
v_smfmac_f32_16x16x64_bf16 v[28:31], a[236:239], v[92:99], v164 abid:1
ds_read_b128 v[60:63], v0 offset:14336
v_add_u32_sdwa v79, s4, v119 dst_sel:DWORD dst_unused:UNUSED_PAD src0_sel:DWORD src1_sel:WORD_1
v_smfmac_f32_16x16x64_bf16 v[12:15], a[148:151], v[44:51], v154 abid:1
ds_read_u16 v89, v89
v_add_u32_sdwa v80, s4, v120 dst_sel:DWORD dst_unused:UNUSED_PAD src0_sel:DWORD src1_sel:WORD_0
v_smfmac_f32_16x16x64_bf16 v[12:15], a[184:187], v[52:59], v158 abid:1
s_add_u32 m0, s44, 3840
ds_read_b128 v[64:67], v1 offset:14336
v_add_u32_sdwa v81, s4, v120 dst_sel:DWORD dst_unused:UNUSED_PAD src0_sel:DWORD src1_sel:WORD_1
v_smfmac_f32_16x16x64_bf16 v[12:15], a[220:223], v[92:99], v162 abid:1
buffer_load_dwordx4 v3, s[16:19], s45 offen offset:256 nt lds
v_add_u32_sdwa v82, s4, v121 dst_sel:DWORD dst_unused:UNUSED_PAD src0_sel:DWORD src1_sel:WORD_0
v_smfmac_f32_16x16x64_bf16 v[32:35], a[168:171], v[44:51], v157
ds_read_b128 v[68:71], v0 offset:16384
v_add_u32_sdwa v83, s4, v121 dst_sel:DWORD dst_unused:UNUSED_PAD src0_sel:DWORD src1_sel:WORD_1
v_smfmac_f32_16x16x64_bf16 v[32:35], a[204:207], v[52:59], v161
ds_read_u16 v90, v90
v_smfmac_f32_16x16x64_bf16 v[32:35], a[240:243], v[92:99], v165
s_waitcnt lgkmcnt(7)
ds_read_b128 v[72:75], v1 offset:16384
v_add_u32 v0, s43, v0
v_smfmac_f32_16x16x64_bf16 v[32:35], v[114:117], v[100:107], v183 abid:1
ds_read_u16 v91, v91
v_add_u32 v1, s43, v1
v_smfmac_f32_16x16x64_bf16 v[28:31], v[114:117], v[100:107], v183
v_smfmac_f32_16x16x64_bf16 v[36:39], v[114:117], v[100:107], v184
ds_read_b128 v[114:117], v2 offset:320
v_smfmac_f32_16x16x64_bf16 v[36:39], a[172:175], v[44:51], v157 abid:1
s_add_u32 m0, s44, 7680
v_smfmac_f32_16x16x64_bf16 v[36:39], a[208:211], v[52:59], v161 abid:1
buffer_load_dwordx4 v3, s[16:19], s45 offen offset:512 nt lds
v_smfmac_f32_16x16x64_bf16 v[36:39], a[244:247], v[92:99], v165 abid:1
v_smfmac_f32_16x16x64_bf16 v[16:19], a[152:155], v[44:51], v155
s_add_u32 m0, s44, 11520
v_smfmac_f32_16x16x64_bf16 v[16:19], a[188:191], v[52:59], v159
buffer_load_dwordx4 v3, s[16:19], s45 offen offset:768 nt lds
v_smfmac_f32_16x16x64_bf16 v[16:19], a[224:227], v[92:99], v163
v_smfmac_f32_16x16x64_bf16 v[20:23], a[156:159], v[44:51], v155 abid:1
s_add_u32 m0, s44, s8
v_smfmac_f32_16x16x64_bf16 v[20:23], a[192:195], v[52:59], v159 abid:1
s_mov_b64 exec, s[10:11]
buffer_load_dwordx4 v3, s[16:19], s7 offen offset:896 nt lds
s_mov_b64 exec, -1
v_smfmac_f32_16x16x64_bf16 v[20:23], a[228:231], v[92:99], v163 abid:1
s_add_u32 s45, s45, 4718592
s_add_u32 s7, s7, 4718592
s_add_u32 s44, s44, s5
v_smfmac_f32_16x16x64_bf16 v[40:43], a[176:179], v[44:51], v176
s_cmp_ge_u32 s44, 148480
s_cselect_b32 s44, s9, s44
s_bitcmp1_b32 s92, s41
v_smfmac_f32_16x16x64_bf16 v[40:43], a[212:215], v[52:59], v176 abid:1
s_cbranch_scc1 L_loopk_w
L_loopk_wb:
v_smfmac_f32_16x16x64_bf16 v[40:43], a[248:251], v[92:99], v177
s_waitcnt lgkmcnt(0)
v_smfmac_f32_16x16x64_bf16 v[40:43], v[114:117], v[84:91], v185
v_smfmac_f32_16x16x64_bf16 v[36:39], v[114:117], v[84:91], v184 abid:1
s_waitcnt vmcnt(20)
s_barrier
v_smfmac_f32_16x16x64_bf16 v[8:11], a[252:255], v[60:67], v166
s_mov_b32 s42, s4
v_smfmac_f32_16x16x64_bf16 v[8:11], v[218:221], v[68:75], v170
ds_read_b128 v[44:47], v0 offset:0
v_add_u32_sdwa v84, s42, v122 dst_sel:DWORD dst_unused:UNUSED_PAD src0_sel:DWORD src1_sel:WORD_0
v_smfmac_f32_16x16x64_bf16 v[12:15], v[186:189], v[60:67], v166 abid:1
ds_read_b128 v[48:51], v1 offset:0
v_add_u32_sdwa v85, s42, v122 dst_sel:DWORD dst_unused:UNUSED_PAD src0_sel:DWORD src1_sel:WORD_1
v_smfmac_f32_16x16x64_bf16 v[12:15], v[222:225], v[68:75], v170 abid:1
ds_read_b128 v[52:55], v0 offset:2048
v_add_u32_sdwa v86, s42, v123 dst_sel:DWORD dst_unused:UNUSED_PAD src0_sel:DWORD src1_sel:WORD_0
v_smfmac_f32_16x16x64_bf16 v[16:19], v[190:193], v[60:67], v167
ds_read_b128 v[56:59], v1 offset:2048
v_cvt_pk_bf16_f32 v92, v8, v9
v_smfmac_f32_16x16x64_bf16 v[16:19], v[226:229], v[68:75], v171
ds_read_u16 v76, v76
v_cvt_pk_bf16_f32 v93, v10, v11
v_smfmac_f32_16x16x64_bf16 v[20:23], v[194:197], v[60:67], v167 abid:1
ds_read_b128 v[8:11], v2 offset:1024
v_cvt_pk_bf16_f32 v94, v12, v13
v_smfmac_f32_16x16x64_bf16 v[20:23], v[230:233], v[68:75], v171 abid:1
ds_read_u16 v77, v77
v_cvt_pk_bf16_f32 v95, v14, v15
v_smfmac_f32_16x16x64_bf16 v[24:27], v[198:201], v[60:67], v168
ds_read_b128 v[12:15], v2 offset:1088
v_cvt_pk_bf16_f32 v96, v16, v17
v_smfmac_f32_16x16x64_bf16 v[24:27], v[234:237], v[68:75], v172
ds_read_u16 v78, v78
v_cvt_pk_bf16_f32 v97, v18, v19
v_smfmac_f32_16x16x64_bf16 v[28:31], v[202:205], v[60:67], v168 abid:1
ds_read_b128 v[16:19], v2 offset:1152
v_cvt_pk_bf16_f32 v98, v20, v21
v_smfmac_f32_16x16x64_bf16 v[28:31], v[238:241], v[68:75], v172 abid:1
ds_read_u16 v79, v79
v_cvt_pk_bf16_f32 v99, v22, v23
v_smfmac_f32_16x16x64_bf16 v[32:35], v[206:209], v[60:67], v169
ds_read_b128 v[20:23], v2 offset:1216
v_cvt_pk_bf16_f32 v100, v24, v25
v_smfmac_f32_16x16x64_bf16 v[32:35], v[242:245], v[68:75], v173
ds_read_u16 v80, v80
v_cvt_pk_bf16_f32 v101, v26, v27
v_smfmac_f32_16x16x64_bf16 v[36:39], v[210:213], v[60:67], v169 abid:1
ds_read_b128 v[24:27], v2 offset:1280
v_cvt_pk_bf16_f32 v102, v28, v29
v_smfmac_f32_16x16x64_bf16 v[36:39], v[246:249], v[68:75], v173 abid:1
ds_read_u16 v81, v81
v_cvt_pk_bf16_f32 v103, v30, v31
v_smfmac_f32_16x16x64_bf16 v[40:43], v[214:217], v[60:67], v177 abid:1
s_bitcmp1_b32 s85, s41
ds_read_b128 v[28:31], v2 offset:1344
v_cvt_pk_bf16_f32 v104, v32, v33
v_smfmac_f32_16x16x64_bf16 v[40:43], v[250:253], v[68:75], v178
s_waitcnt lgkmcnt(10)
v_cvt_pk_bf16_f32 v105, v34, v35
s_cbranch_scc1 L_loopk
s_cmp_lg_u32 s41, 6
s_cbranch_scc1 L_loopnk
.p2align 3
L_loopck:
v_smfmac_f32_16x16x64_bf16 v[8:11], a[0:3], v[44:51], v138
ds_read_b128 v[32:35], v2 offset:1408
v_cvt_pk_bf16_f32 v106, v36, v37
v_mov_b32 v7, 1
v_smfmac_f32_16x16x64_bf16 v[8:11], a[36:39], v[52:59], v142
s_waitcnt lgkmcnt(9)
buffer_atomic_add v7, v6, s[32:35], 0 offen sc0 sc1
v_cvt_pk_bf16_f32 v107, v38, v39
v_smfmac_f32_16x16x64_bf16 v[12:15], a[4:7], v[44:51], v138 abid:1
ds_read_b128 v[36:39], v2 offset:1472
v_cvt_pk_bf16_f32 v112, v40, v41
v_smfmac_f32_16x16x64_bf16 v[12:15], a[40:43], v[52:59], v142 abid:1
s_waitcnt lgkmcnt(8)
ds_read_b128 v[60:63], v0 offset:4096
v_cvt_pk_bf16_f32 v113, v42, v43
v_smfmac_f32_16x16x64_bf16 v[16:19], a[8:11], v[44:51], v139
s_cmp_eq_u32 s4, 129920
ds_read_b128 v[40:43], v2 offset:1536
v_cndmask_b32_dpp v108, v96, v92, vcc quad_perm:[1,0,3,2] row_mask:0xf bank_mask:0xf
v_smfmac_f32_16x16x64_bf16 v[16:19], a[44:47], v[52:59], v143
s_waitcnt lgkmcnt(8)
ds_read_u16 v82, v82
v_cndmask_b32_dpp v109, v97, v93, vcc quad_perm:[1,0,3,2] row_mask:0xf bank_mask:0xf
v_smfmac_f32_16x16x64_bf16 v[20:23], a[12:15], v[44:51], v139 abid:1
s_cselect_b32 s43, -129920, s5
ds_read_u16 v84, v84
v_cndmask_b32_dpp v110, v98, v94, vcc quad_perm:[1,0,3,2] row_mask:0xf bank_mask:0xf
v_smfmac_f32_16x16x64_bf16 v[20:23], a[48:51], v[52:59], v143 abid:1
s_waitcnt lgkmcnt(8)
ds_read_b128 v[64:67], v1 offset:4096
v_cndmask_b32_dpp v111, v99, v95, vcc quad_perm:[1,0,3,2] row_mask:0xf bank_mask:0xf
v_smfmac_f32_16x16x64_bf16 v[24:27], a[16:19], v[44:51], v140
s_add_u32 s4, s4, s43
ds_read_b128 v[68:71], v0 offset:6144
v_add_u32_sdwa v87, s42, v123 dst_sel:DWORD dst_unused:UNUSED_PAD src0_sel:DWORD src1_sel:WORD_1
v_smfmac_f32_16x16x64_bf16 v[24:27], a[52:55], v[52:59], v144
buffer_store_dwordx4 v[108:111], v4, s[20:23], s46 offen offset:0 sc1
s_mov_b64 vcc, s[82:83]
s_waitcnt lgkmcnt(8)
ds_read_b128 v[72:75], v1 offset:6144
v_cndmask_b32_dpp v96, v92, v96, vcc quad_perm:[1,0,3,2] row_mask:0xf bank_mask:0xf
v_cndmask_b32_dpp v97, v93, v97, vcc quad_perm:[1,0,3,2] row_mask:0xf bank_mask:0xf
v_smfmac_f32_16x16x64_bf16 v[28:31], a[20:23], v[44:51], v140 abid:1
s_add_u32 s7, s45, s58
ds_read_u16 v83, v83
v_cndmask_b32_dpp v98, v94, v98, vcc quad_perm:[1,0,3,2] row_mask:0xf bank_mask:0xf
v_smfmac_f32_16x16x64_bf16 v[28:31], a[56:59], v[52:59], v144 abid:1
s_waitcnt lgkmcnt(9)
ds_read_b128 v[114:117], v2 offset:64
v_cndmask_b32_dpp v99, v95, v99, vcc quad_perm:[1,0,3,2] row_mask:0xf bank_mask:0xf
v_smfmac_f32_16x16x64_bf16 v[32:35], a[24:27], v[44:51], v141
ds_read_u16 v85, v85
v_add_u32_sdwa v88, s42, v124 dst_sel:DWORD dst_unused:UNUSED_PAD src0_sel:DWORD src1_sel:WORD_0
v_smfmac_f32_16x16x64_bf16 v[32:35], a[60:63], v[52:59], v145
s_waitcnt lgkmcnt(10)
ds_read_u16 v86, v86
v_add_u32_sdwa v89, s42, v124 dst_sel:DWORD dst_unused:UNUSED_PAD src0_sel:DWORD src1_sel:WORD_1
v_smfmac_f32_16x16x64_bf16 v[36:39], a[28:31], v[44:51], v141 abid:1
ds_read_u16 v87, v87
v_add_u32_sdwa v90, s42, v125 dst_sel:DWORD dst_unused:UNUSED_PAD src0_sel:DWORD src1_sel:WORD_0
v_smfmac_f32_16x16x64_bf16 v[36:39], a[64:67], v[52:59], v145 abid:1
s_waitcnt lgkmcnt(10)
ds_read_u16 v88, v88
v_add_u32_sdwa v91, s42, v125 dst_sel:DWORD dst_unused:UNUSED_PAD src0_sel:DWORD src1_sel:WORD_1
v_smfmac_f32_16x16x64_bf16 v[40:43], a[32:35], v[44:51], v174
buffer_store_dwordx4 v[96:99], v4, s[20:23], s46 offen offset:1152 sc1
s_mov_b64 vcc, s[80:81]
ds_read_u16 v89, v89
v_cndmask_b32_dpp v92, v104, v100, vcc quad_perm:[1,0,3,2] row_mask:0xf bank_mask:0xf
v_cndmask_b32_dpp v93, v105, v101, vcc quad_perm:[1,0,3,2] row_mask:0xf bank_mask:0xf
v_smfmac_f32_16x16x64_bf16 v[40:43], a[68:71], v[52:59], v174 abid:1
s_waitcnt lgkmcnt(9)
ds_read_u16 v90, v90
v_cndmask_b32_dpp v94, v106, v102, vcc quad_perm:[1,0,3,2] row_mask:0xf bank_mask:0xf
v_smfmac_f32_16x16x64_bf16 v[8:11], a[72:75], v[60:67], v146
s_waitcnt lgkmcnt(8)
ds_read_u16 v91, v91
v_cndmask_b32_dpp v95, v107, v103, vcc quad_perm:[1,0,3,2] row_mask:0xf bank_mask:0xf
v_smfmac_f32_16x16x64_bf16 v[8:11], a[108:111], v[68:75], v150
s_waitcnt lgkmcnt(7)
ds_bpermute_b32 v112, v6, v112
v_smfmac_f32_16x16x64_bf16 v[8:11], v[114:117], v[76:83], v179
ds_bpermute_b32 v113, v6, v113
v_smfmac_f32_16x16x64_bf16 v[12:15], v[114:117], v[76:83], v179 abid:1
ds_read_b128 v[114:117], v2 offset:128
v_add_u32_sdwa v76, s42, v126 dst_sel:DWORD dst_unused:UNUSED_PAD src0_sel:DWORD src1_sel:WORD_0
v_smfmac_f32_16x16x64_bf16 v[12:15], a[76:79], v[60:67], v146 abid:1
ds_read_u16 v76, v76
v_add_u32_sdwa v77, s42, v126 dst_sel:DWORD dst_unused:UNUSED_PAD src0_sel:DWORD src1_sel:WORD_1
v_smfmac_f32_16x16x64_bf16 v[12:15], a[112:115], v[68:75], v150 abid:1
buffer_store_dwordx4 v[92:95], v4, s[20:23], s46 offen offset:128 sc1
s_mov_b64 vcc, s[82:83]
ds_read_u16 v77, v77
v_cndmask_b32_dpp v104, v100, v104, vcc quad_perm:[1,0,3,2] row_mask:0xf bank_mask:0xf
v_cndmask_b32_dpp v105, v101, v105, vcc quad_perm:[1,0,3,2] row_mask:0xf bank_mask:0xf
v_smfmac_f32_16x16x64_bf16 v[24:27], a[88:91], v[60:67], v148
ds_read_b128 v[44:47], v0 offset:8192
v_add_u32_sdwa v78, s42, v127 dst_sel:DWORD dst_unused:UNUSED_PAD src0_sel:DWORD src1_sel:WORD_0
v_smfmac_f32_16x16x64_bf16 v[24:27], a[124:127], v[68:75], v152
ds_read_u16 v78, v78
v_cndmask_b32_dpp v106, v102, v106, vcc quad_perm:[1,0,3,2] row_mask:0xf bank_mask:0xf
v_smfmac_f32_16x16x64_bf16 v[28:31], a[92:95], v[60:67], v148 abid:1
ds_read_b128 v[48:51], v1 offset:8192
v_cndmask_b32_dpp v107, v103, v107, vcc quad_perm:[1,0,3,2] row_mask:0xf bank_mask:0xf
v_smfmac_f32_16x16x64_bf16 v[28:31], a[128:131], v[68:75], v152 abid:1
ds_read_b128 v[52:55], v0 offset:10240
v_add_u32_sdwa v79, s42, v127 dst_sel:DWORD dst_unused:UNUSED_PAD src0_sel:DWORD src1_sel:WORD_1
v_smfmac_f32_16x16x64_bf16 v[32:35], a[96:99], v[60:67], v149
ds_read_u16 v79, v79
v_add_u32_sdwa v80, s42, v128 dst_sel:DWORD dst_unused:UNUSED_PAD src0_sel:DWORD src1_sel:WORD_0
v_smfmac_f32_16x16x64_bf16 v[32:35], a[132:135], v[68:75], v153
ds_read_u16 v80, v80
v_add_u32_sdwa v81, s42, v128 dst_sel:DWORD dst_unused:UNUSED_PAD src0_sel:DWORD src1_sel:WORD_1
v_smfmac_f32_16x16x64_bf16 v[16:19], a[80:83], v[60:67], v147
buffer_store_dwordx4 v[104:107], v4, s[20:23], s46 offen offset:1280 sc1
s_mov_b64 vcc, s[80:81]
ds_read_b128 v[56:59], v1 offset:10240
v_add_u32_sdwa v82, s42, v129 dst_sel:DWORD dst_unused:UNUSED_PAD src0_sel:DWORD src1_sel:WORD_0
v_add_u32_sdwa v83, s42, v129 dst_sel:DWORD dst_unused:UNUSED_PAD src0_sel:DWORD src1_sel:WORD_1
v_smfmac_f32_16x16x64_bf16 v[16:19], a[116:119], v[68:75], v151
s_waitcnt lgkmcnt(9)
ds_read_b128 v[92:95], v0 offset:12288
v_add_u32_sdwa v100, s42, v130 dst_sel:DWORD dst_unused:UNUSED_PAD src0_sel:DWORD src1_sel:WORD_0
v_smfmac_f32_16x16x64_bf16 v[16:19], v[114:117], v[84:91], v180 abid:1
ds_read_u16 v81, v81
v_add_u32_sdwa v101, s42, v130 dst_sel:DWORD dst_unused:UNUSED_PAD src0_sel:DWORD src1_sel:WORD_1
v_smfmac_f32_16x16x64_bf16 v[12:15], v[114:117], v[84:91], v180
ds_read_b128 v[96:99], v1 offset:12288
v_add_u32_sdwa v102, s42, v131 dst_sel:DWORD dst_unused:UNUSED_PAD src0_sel:DWORD src1_sel:WORD_0
v_smfmac_f32_16x16x64_bf16 v[20:23], v[114:117], v[84:91], v181
ds_read_u16 v82, v82
v_add_u32_sdwa v103, s42, v131 dst_sel:DWORD dst_unused:UNUSED_PAD src0_sel:DWORD src1_sel:WORD_1
v_smfmac_f32_16x16x64_bf16 v[20:23], a[84:87], v[60:67], v147 abid:1
ds_read_u16 v100, v100
v_add_u32_sdwa v104, s42, v132 dst_sel:DWORD dst_unused:UNUSED_PAD src0_sel:DWORD src1_sel:WORD_0
v_smfmac_f32_16x16x64_bf16 v[20:23], a[120:123], v[68:75], v151 abid:1
ds_read_u16 v83, v83
v_add_u32_sdwa v105, s42, v132 dst_sel:DWORD dst_unused:UNUSED_PAD src0_sel:DWORD src1_sel:WORD_1
v_smfmac_f32_16x16x64_bf16 v[36:39], a[100:103], v[60:67], v149 abid:1
buffer_store_dwordx2 v[112:113], v5, s[20:23], s46 offen
ds_read_b128 v[114:117], v2 offset:192
v_add_u32_sdwa v106, s42, v133 dst_sel:DWORD dst_unused:UNUSED_PAD src0_sel:DWORD src1_sel:WORD_0
v_smfmac_f32_16x16x64_bf16 v[36:39], a[136:139], v[68:75], v153 abid:1
s_mov_b32 s46, s48
ds_read_u16 v101, v101
v_add_u32_sdwa v107, s42, v133 dst_sel:DWORD dst_unused:UNUSED_PAD src0_sel:DWORD src1_sel:WORD_1
v_smfmac_f32_16x16x64_bf16 v[40:43], a[104:107], v[60:67], v175
s_mov_b32 s48, s49
ds_read_u16 v102, v102
v_add_u32_sdwa v84, s42, v134 dst_sel:DWORD dst_unused:UNUSED_PAD src0_sel:DWORD src1_sel:WORD_0
v_smfmac_f32_16x16x64_bf16 v[40:43], a[140:143], v[68:75], v175 abid:1
s_waitcnt lgkmcnt(13)
ds_read_u16 v103, v103
v_add_u32_sdwa v85, s42, v134 dst_sel:DWORD dst_unused:UNUSED_PAD src0_sel:DWORD src1_sel:WORD_1
v_smfmac_f32_16x16x64_bf16 v[8:11], a[144:147], v[44:51], v154
s_waitcnt lgkmcnt(10)
ds_read_u16 v104, v104
v_add_u32_sdwa v86, s42, v135 dst_sel:DWORD dst_unused:UNUSED_PAD src0_sel:DWORD src1_sel:WORD_0
v_smfmac_f32_16x16x64_bf16 v[8:11], a[180:183], v[52:59], v158
s_waitcnt lgkmcnt(8)
ds_read_u16 v105, v105
v_add_u32_sdwa v87, s42, v135 dst_sel:DWORD dst_unused:UNUSED_PAD src0_sel:DWORD src1_sel:WORD_1
v_smfmac_f32_16x16x64_bf16 v[8:11], a[216:219], v[92:99], v162
s_add_u32 m0, s44, 0
ds_read_u16 v106, v106
v_add_u32_sdwa v88, s42, v136 dst_sel:DWORD dst_unused:UNUSED_PAD src0_sel:DWORD src1_sel:WORD_0
v_smfmac_f32_16x16x64_bf16 v[24:27], a[160:163], v[44:51], v156
buffer_load_dwordx4 v3, s[16:19], s45 offen offset:0 nt lds
v_add_u32_sdwa v89, s42, v136 dst_sel:DWORD dst_unused:UNUSED_PAD src0_sel:DWORD src1_sel:WORD_1
v_smfmac_f32_16x16x64_bf16 v[24:27], a[196:199], v[52:59], v160
s_mov_b32 s49, s50
ds_read_u16 v107, v107
v_add_u32_sdwa v90, s42, v137 dst_sel:DWORD dst_unused:UNUSED_PAD src0_sel:DWORD src1_sel:WORD_0
v_smfmac_f32_16x16x64_bf16 v[24:27], a[232:235], v[92:99], v164
s_waitcnt lgkmcnt(7)
s_waitcnt vmcnt(6)
ds_read_u16 v84, v84
v_add_u32_sdwa v91, s42, v137 dst_sel:DWORD dst_unused:UNUSED_PAD src0_sel:DWORD src1_sel:WORD_1
v_smfmac_f32_16x16x64_bf16 v[24:27], v[114:117], v[76:83], v182
s_mov_b32 s50, s45
ds_read_u16 v85, v85
v_smfmac_f32_16x16x64_bf16 v[20:23], v[114:117], v[76:83], v181 abid:1
ds_read_u16 v86, v86
v_smfmac_f32_16x16x64_bf16 v[28:31], v[114:117], v[76:83], v182 abid:1
ds_read_b128 v[114:117], v2 offset:256
v_add_u32_sdwa v76, s4, v118 dst_sel:DWORD dst_unused:UNUSED_PAD src0_sel:DWORD src1_sel:WORD_0
v_smfmac_f32_16x16x64_bf16 v[28:31], a[164:167], v[44:51], v156 abid:1
ds_read_u16 v87, v87
v_add_u32_sdwa v77, s4, v118 dst_sel:DWORD dst_unused:UNUSED_PAD src0_sel:DWORD src1_sel:WORD_1
v_smfmac_f32_16x16x64_bf16 v[28:31], a[200:203], v[52:59], v160 abid:1
ds_read_u16 v88, v88
v_add_u32_sdwa v78, s4, v119 dst_sel:DWORD dst_unused:UNUSED_PAD src0_sel:DWORD src1_sel:WORD_0
v_smfmac_f32_16x16x64_bf16 v[28:31], a[236:239], v[92:99], v164 abid:1
ds_read_b128 v[60:63], v0 offset:14336
v_add_u32_sdwa v79, s4, v119 dst_sel:DWORD dst_unused:UNUSED_PAD src0_sel:DWORD src1_sel:WORD_1
v_smfmac_f32_16x16x64_bf16 v[12:15], a[148:151], v[44:51], v154 abid:1
ds_read_u16 v89, v89
v_add_u32_sdwa v80, s4, v120 dst_sel:DWORD dst_unused:UNUSED_PAD src0_sel:DWORD src1_sel:WORD_0
v_smfmac_f32_16x16x64_bf16 v[12:15], a[184:187], v[52:59], v158 abid:1
s_add_u32 m0, s44, 3840
ds_read_b128 v[64:67], v1 offset:14336
v_add_u32_sdwa v81, s4, v120 dst_sel:DWORD dst_unused:UNUSED_PAD src0_sel:DWORD src1_sel:WORD_1
v_smfmac_f32_16x16x64_bf16 v[12:15], a[220:223], v[92:99], v162 abid:1
buffer_load_dwordx4 v3, s[16:19], s45 offen offset:256 nt lds
v_add_u32_sdwa v82, s4, v121 dst_sel:DWORD dst_unused:UNUSED_PAD src0_sel:DWORD src1_sel:WORD_0
v_smfmac_f32_16x16x64_bf16 v[32:35], a[168:171], v[44:51], v157
ds_read_b128 v[68:71], v0 offset:16384
v_add_u32_sdwa v83, s4, v121 dst_sel:DWORD dst_unused:UNUSED_PAD src0_sel:DWORD src1_sel:WORD_1
v_smfmac_f32_16x16x64_bf16 v[32:35], a[204:207], v[52:59], v161
ds_read_u16 v90, v90
v_smfmac_f32_16x16x64_bf16 v[32:35], a[240:243], v[92:99], v165
s_waitcnt lgkmcnt(7)
ds_read_b128 v[72:75], v1 offset:16384
v_add_u32 v0, s43, v0
v_smfmac_f32_16x16x64_bf16 v[32:35], v[114:117], v[100:107], v183 abid:1
ds_read_u16 v91, v91
v_add_u32 v1, s43, v1
v_smfmac_f32_16x16x64_bf16 v[28:31], v[114:117], v[100:107], v183
v_smfmac_f32_16x16x64_bf16 v[36:39], v[114:117], v[100:107], v184
ds_read_b128 v[114:117], v2 offset:320
v_smfmac_f32_16x16x64_bf16 v[36:39], a[172:175], v[44:51], v157 abid:1
s_add_u32 m0, s44, 7680
v_smfmac_f32_16x16x64_bf16 v[36:39], a[208:211], v[52:59], v161 abid:1
buffer_load_dwordx4 v3, s[16:19], s45 offen offset:512 nt lds
v_smfmac_f32_16x16x64_bf16 v[36:39], a[244:247], v[92:99], v165 abid:1
v_smfmac_f32_16x16x64_bf16 v[16:19], a[152:155], v[44:51], v155
s_add_u32 m0, s44, 11520
v_smfmac_f32_16x16x64_bf16 v[16:19], a[188:191], v[52:59], v159
buffer_load_dwordx4 v3, s[16:19], s45 offen offset:768 nt lds
v_smfmac_f32_16x16x64_bf16 v[16:19], a[224:227], v[92:99], v163
s_mov_b64 exec, s[62:63]
ds_write_b32 v0, v7 offset:18432
s_mov_b64 exec, -1
v_smfmac_f32_16x16x64_bf16 v[20:23], a[156:159], v[44:51], v155 abid:1
s_add_u32 m0, s44, s8
v_smfmac_f32_16x16x64_bf16 v[20:23], a[192:195], v[52:59], v159 abid:1
s_mov_b64 exec, s[10:11]
buffer_load_dwordx4 v3, s[16:19], s7 offen offset:896 nt lds
s_mov_b64 exec, -1
v_smfmac_f32_16x16x64_bf16 v[20:23], a[228:231], v[92:99], v163 abid:1
s_add_u32 s44, s44, s5
s_cmp_ge_u32 s44, 148480
s_cselect_b32 s44, s9, s44
v_smfmac_f32_16x16x64_bf16 v[40:43], a[176:179], v[44:51], v176
v_smfmac_f32_16x16x64_bf16 v[40:43], a[212:215], v[52:59], v176 abid:1
v_smfmac_f32_16x16x64_bf16 v[40:43], a[248:251], v[92:99], v177
s_waitcnt lgkmcnt(0)
v_smfmac_f32_16x16x64_bf16 v[40:43], v[114:117], v[84:91], v185
v_smfmac_f32_16x16x64_bf16 v[36:39], v[114:117], v[84:91], v184 abid:1
s_barrier
v_smfmac_f32_16x16x64_bf16 v[8:11], a[252:255], v[60:67], v166
s_mov_b32 s42, s4
ds_read_b32 v7, v0 offset:18432
v_smfmac_f32_16x16x64_bf16 v[8:11], v[218:221], v[68:75], v170
ds_read_b128 v[44:47], v0 offset:0
v_add_u32_sdwa v84, s42, v122 dst_sel:DWORD dst_unused:UNUSED_PAD src0_sel:DWORD src1_sel:WORD_0
v_smfmac_f32_16x16x64_bf16 v[12:15], v[186:189], v[60:67], v166 abid:1
ds_read_b128 v[48:51], v1 offset:0
v_add_u32_sdwa v85, s42, v122 dst_sel:DWORD dst_unused:UNUSED_PAD src0_sel:DWORD src1_sel:WORD_1
v_smfmac_f32_16x16x64_bf16 v[12:15], v[222:225], v[68:75], v170 abid:1
ds_read_b128 v[52:55], v0 offset:2048
v_add_u32_sdwa v86, s42, v123 dst_sel:DWORD dst_unused:UNUSED_PAD src0_sel:DWORD src1_sel:WORD_0
v_smfmac_f32_16x16x64_bf16 v[16:19], v[190:193], v[60:67], v167
ds_read_b128 v[56:59], v1 offset:2048
v_cvt_pk_bf16_f32 v92, v8, v9
v_smfmac_f32_16x16x64_bf16 v[16:19], v[226:229], v[68:75], v171
ds_read_u16 v76, v76
v_cvt_pk_bf16_f32 v93, v10, v11
v_smfmac_f32_16x16x64_bf16 v[20:23], v[194:197], v[60:67], v167 abid:1
ds_read_b128 v[8:11], v2 offset:1024
v_cvt_pk_bf16_f32 v94, v12, v13
v_smfmac_f32_16x16x64_bf16 v[20:23], v[230:233], v[68:75], v171 abid:1
ds_read_u16 v77, v77
v_cvt_pk_bf16_f32 v95, v14, v15
v_smfmac_f32_16x16x64_bf16 v[24:27], v[198:201], v[60:67], v168
ds_read_b128 v[12:15], v2 offset:1088
v_cvt_pk_bf16_f32 v96, v16, v17
v_smfmac_f32_16x16x64_bf16 v[24:27], v[234:237], v[68:75], v172
s_waitcnt lgkmcnt(8)
ds_read_u16 v78, v78
v_cvt_pk_bf16_f32 v97, v18, v19
v_readfirstlane_b32 s56, v7
v_smfmac_f32_16x16x64_bf16 v[28:31], v[202:205], v[60:67], v168 abid:1
s_lshr_b32 s60, s56, 6
ds_read_b128 v[16:19], v2 offset:1152
v_cvt_pk_bf16_f32 v98, v20, v21
v_smfmac_f32_16x16x64_bf16 v[28:31], v[238:241], v[68:75], v172 abid:1
s_mul_i32 s60, s60, 3538944
ds_read_u16 v79, v79
v_cvt_pk_bf16_f32 v99, v22, v23
v_smfmac_f32_16x16x64_bf16 v[32:35], v[206:209], v[60:67], v169
s_mul_i32 s61, s56, 18432
ds_read_b128 v[20:23], v2 offset:1216
v_cvt_pk_bf16_f32 v100, v24, v25
v_smfmac_f32_16x16x64_bf16 v[32:35], v[242:245], v[68:75], v173
s_add_u32 s60, s60, s57
ds_read_u16 v80, v80
v_cvt_pk_bf16_f32 v101, v26, v27
v_smfmac_f32_16x16x64_bf16 v[36:39], v[210:213], v[60:67], v169 abid:1
s_add_u32 s45, s60, s61
ds_read_b128 v[24:27], v2 offset:1280
v_cvt_pk_bf16_f32 v102, v28, v29
v_smfmac_f32_16x16x64_bf16 v[36:39], v[246:249], v[68:75], v173 abid:1
ds_read_u16 v81, v81
v_cvt_pk_bf16_f32 v103, v30, v31
v_smfmac_f32_16x16x64_bf16 v[40:43], v[214:217], v[60:67], v177 abid:1
s_cmp_lt_u32 s56, 384
ds_read_b128 v[28:31], v2 offset:1344
v_cvt_pk_bf16_f32 v104, v32, v33
v_smfmac_f32_16x16x64_bf16 v[40:43], v[250:253], v[68:75], v178
s_waitcnt lgkmcnt(10)
v_cvt_pk_bf16_f32 v105, v34, v35
s_cbranch_scc1 L_loopck
s_mov_b32 s41, 0
s_mov_b32 s15, 3
s_mov_b32 s12, 7
s_mov_b32 s92, 4
s_mov_b32 s87, 4
s_mov_b32 s59, -1
.p2align 3
L_loopnk:
v_smfmac_f32_16x16x64_bf16 v[8:11], a[0:3], v[44:51], v138
ds_read_b128 v[32:35], v2 offset:1408
v_cvt_pk_bf16_f32 v106, v36, v37
v_smfmac_f32_16x16x64_bf16 v[8:11], a[36:39], v[52:59], v142
s_waitcnt lgkmcnt(9)
v_cvt_pk_bf16_f32 v107, v38, v39
v_smfmac_f32_16x16x64_bf16 v[12:15], a[4:7], v[44:51], v138 abid:1
ds_read_b128 v[36:39], v2 offset:1472
v_cvt_pk_bf16_f32 v112, v40, v41
v_smfmac_f32_16x16x64_bf16 v[12:15], a[40:43], v[52:59], v142 abid:1
s_waitcnt lgkmcnt(8)
ds_read_b128 v[60:63], v0 offset:4096
v_cvt_pk_bf16_f32 v113, v42, v43
v_smfmac_f32_16x16x64_bf16 v[16:19], a[8:11], v[44:51], v139
s_cmp_eq_u32 s4, 129920
ds_read_b128 v[40:43], v2 offset:1536
v_cndmask_b32_dpp v108, v96, v92, vcc quad_perm:[1,0,3,2] row_mask:0xf bank_mask:0xf
v_smfmac_f32_16x16x64_bf16 v[16:19], a[44:47], v[52:59], v143
s_waitcnt lgkmcnt(8)
ds_read_u16 v82, v82
v_cndmask_b32_dpp v109, v97, v93, vcc quad_perm:[1,0,3,2] row_mask:0xf bank_mask:0xf
v_smfmac_f32_16x16x64_bf16 v[20:23], a[12:15], v[44:51], v139 abid:1
s_cselect_b32 s43, -129920, s5
ds_read_u16 v84, v84
v_cndmask_b32_dpp v110, v98, v94, vcc quad_perm:[1,0,3,2] row_mask:0xf bank_mask:0xf
v_smfmac_f32_16x16x64_bf16 v[20:23], a[48:51], v[52:59], v143 abid:1
s_waitcnt lgkmcnt(8)
ds_read_b128 v[64:67], v1 offset:4096
v_cndmask_b32_dpp v111, v99, v95, vcc quad_perm:[1,0,3,2] row_mask:0xf bank_mask:0xf
v_smfmac_f32_16x16x64_bf16 v[24:27], a[16:19], v[44:51], v140
s_add_u32 s4, s4, s43
ds_read_b128 v[68:71], v0 offset:6144
v_add_u32_sdwa v87, s42, v123 dst_sel:DWORD dst_unused:UNUSED_PAD src0_sel:DWORD src1_sel:WORD_1
v_smfmac_f32_16x16x64_bf16 v[24:27], a[52:55], v[52:59], v144
buffer_store_dwordx4 v[108:111], v4, s[20:23], s46 offen offset:0 sc1
s_mov_b64 vcc, s[82:83]
s_waitcnt lgkmcnt(8)
ds_read_b128 v[72:75], v1 offset:6144
v_cndmask_b32_dpp v96, v92, v96, vcc quad_perm:[1,0,3,2] row_mask:0xf bank_mask:0xf
v_cndmask_b32_dpp v97, v93, v97, vcc quad_perm:[1,0,3,2] row_mask:0xf bank_mask:0xf
v_smfmac_f32_16x16x64_bf16 v[28:31], a[20:23], v[44:51], v140 abid:1
s_add_u32 s41, s41, 1
ds_read_u16 v83, v83
v_cndmask_b32_dpp v98, v94, v98, vcc quad_perm:[1,0,3,2] row_mask:0xf bank_mask:0xf
v_smfmac_f32_16x16x64_bf16 v[28:31], a[56:59], v[52:59], v144 abid:1
s_waitcnt lgkmcnt(9)
ds_read_b128 v[114:117], v2 offset:64
v_cndmask_b32_dpp v99, v95, v99, vcc quad_perm:[1,0,3,2] row_mask:0xf bank_mask:0xf
v_smfmac_f32_16x16x64_bf16 v[32:35], a[24:27], v[44:51], v141
ds_read_u16 v85, v85
v_add_u32_sdwa v88, s42, v124 dst_sel:DWORD dst_unused:UNUSED_PAD src0_sel:DWORD src1_sel:WORD_0
v_smfmac_f32_16x16x64_bf16 v[32:35], a[60:63], v[52:59], v145
s_waitcnt lgkmcnt(10)
ds_read_u16 v86, v86
v_add_u32_sdwa v89, s42, v124 dst_sel:DWORD dst_unused:UNUSED_PAD src0_sel:DWORD src1_sel:WORD_1
v_smfmac_f32_16x16x64_bf16 v[36:39], a[28:31], v[44:51], v141 abid:1
ds_read_u16 v87, v87
v_add_u32_sdwa v90, s42, v125 dst_sel:DWORD dst_unused:UNUSED_PAD src0_sel:DWORD src1_sel:WORD_0
v_smfmac_f32_16x16x64_bf16 v[36:39], a[64:67], v[52:59], v145 abid:1
s_waitcnt lgkmcnt(10)
ds_read_u16 v88, v88
v_add_u32_sdwa v91, s42, v125 dst_sel:DWORD dst_unused:UNUSED_PAD src0_sel:DWORD src1_sel:WORD_1
v_smfmac_f32_16x16x64_bf16 v[40:43], a[32:35], v[44:51], v174
buffer_store_dwordx4 v[96:99], v4, s[20:23], s46 offen offset:1152 sc1
s_mov_b64 vcc, s[80:81]
ds_read_u16 v89, v89
v_cndmask_b32_dpp v92, v104, v100, vcc quad_perm:[1,0,3,2] row_mask:0xf bank_mask:0xf
v_cndmask_b32_dpp v93, v105, v101, vcc quad_perm:[1,0,3,2] row_mask:0xf bank_mask:0xf
v_smfmac_f32_16x16x64_bf16 v[40:43], a[68:71], v[52:59], v174 abid:1
s_waitcnt lgkmcnt(9)
ds_read_u16 v90, v90
v_cndmask_b32_dpp v94, v106, v102, vcc quad_perm:[1,0,3,2] row_mask:0xf bank_mask:0xf
v_smfmac_f32_16x16x64_bf16 v[8:11], a[72:75], v[60:67], v146
s_waitcnt lgkmcnt(8)
ds_read_u16 v91, v91
v_cndmask_b32_dpp v95, v107, v103, vcc quad_perm:[1,0,3,2] row_mask:0xf bank_mask:0xf
v_smfmac_f32_16x16x64_bf16 v[8:11], a[108:111], v[68:75], v150
s_waitcnt lgkmcnt(7)
ds_bpermute_b32 v112, v6, v112
v_smfmac_f32_16x16x64_bf16 v[8:11], v[114:117], v[76:83], v179
ds_bpermute_b32 v113, v6, v113
v_smfmac_f32_16x16x64_bf16 v[12:15], v[114:117], v[76:83], v179 abid:1
ds_read_b128 v[114:117], v2 offset:128
v_add_u32_sdwa v76, s42, v126 dst_sel:DWORD dst_unused:UNUSED_PAD src0_sel:DWORD src1_sel:WORD_0
v_smfmac_f32_16x16x64_bf16 v[12:15], a[76:79], v[60:67], v146 abid:1
ds_read_u16 v76, v76
v_add_u32_sdwa v77, s42, v126 dst_sel:DWORD dst_unused:UNUSED_PAD src0_sel:DWORD src1_sel:WORD_1
v_smfmac_f32_16x16x64_bf16 v[12:15], a[112:115], v[68:75], v150 abid:1
buffer_store_dwordx4 v[92:95], v4, s[20:23], s46 offen offset:128 sc1
s_mov_b64 vcc, s[82:83]
ds_read_u16 v77, v77
v_cndmask_b32_dpp v104, v100, v104, vcc quad_perm:[1,0,3,2] row_mask:0xf bank_mask:0xf
v_cndmask_b32_dpp v105, v101, v105, vcc quad_perm:[1,0,3,2] row_mask:0xf bank_mask:0xf
v_smfmac_f32_16x16x64_bf16 v[24:27], a[88:91], v[60:67], v148
ds_read_b128 v[44:47], v0 offset:8192
v_add_u32_sdwa v78, s42, v127 dst_sel:DWORD dst_unused:UNUSED_PAD src0_sel:DWORD src1_sel:WORD_0
v_smfmac_f32_16x16x64_bf16 v[24:27], a[124:127], v[68:75], v152
ds_read_u16 v78, v78
v_cndmask_b32_dpp v106, v102, v106, vcc quad_perm:[1,0,3,2] row_mask:0xf bank_mask:0xf
v_smfmac_f32_16x16x64_bf16 v[28:31], a[92:95], v[60:67], v148 abid:1
ds_read_b128 v[48:51], v1 offset:8192
v_cndmask_b32_dpp v107, v103, v107, vcc quad_perm:[1,0,3,2] row_mask:0xf bank_mask:0xf
v_smfmac_f32_16x16x64_bf16 v[28:31], a[128:131], v[68:75], v152 abid:1
ds_read_b128 v[52:55], v0 offset:10240
v_add_u32_sdwa v79, s42, v127 dst_sel:DWORD dst_unused:UNUSED_PAD src0_sel:DWORD src1_sel:WORD_1
v_smfmac_f32_16x16x64_bf16 v[32:35], a[96:99], v[60:67], v149
ds_read_u16 v79, v79
v_add_u32_sdwa v80, s42, v128 dst_sel:DWORD dst_unused:UNUSED_PAD src0_sel:DWORD src1_sel:WORD_0
v_smfmac_f32_16x16x64_bf16 v[32:35], a[132:135], v[68:75], v153
ds_read_u16 v80, v80
v_add_u32_sdwa v81, s42, v128 dst_sel:DWORD dst_unused:UNUSED_PAD src0_sel:DWORD src1_sel:WORD_1
v_smfmac_f32_16x16x64_bf16 v[16:19], a[80:83], v[60:67], v147
buffer_store_dwordx4 v[104:107], v4, s[20:23], s46 offen offset:1280 sc1
s_mov_b64 vcc, s[80:81]
ds_read_b128 v[56:59], v1 offset:10240
v_add_u32_sdwa v82, s42, v129 dst_sel:DWORD dst_unused:UNUSED_PAD src0_sel:DWORD src1_sel:WORD_0
v_add_u32_sdwa v83, s42, v129 dst_sel:DWORD dst_unused:UNUSED_PAD src0_sel:DWORD src1_sel:WORD_1
v_smfmac_f32_16x16x64_bf16 v[16:19], a[116:119], v[68:75], v151
s_waitcnt lgkmcnt(9)
ds_read_b128 v[92:95], v0 offset:12288
v_add_u32_sdwa v100, s42, v130 dst_sel:DWORD dst_unused:UNUSED_PAD src0_sel:DWORD src1_sel:WORD_0
v_smfmac_f32_16x16x64_bf16 v[16:19], v[114:117], v[84:91], v180 abid:1
ds_read_u16 v81, v81
v_add_u32_sdwa v101, s42, v130 dst_sel:DWORD dst_unused:UNUSED_PAD src0_sel:DWORD src1_sel:WORD_1
v_smfmac_f32_16x16x64_bf16 v[12:15], v[114:117], v[84:91], v180
ds_read_b128 v[96:99], v1 offset:12288
v_add_u32_sdwa v102, s42, v131 dst_sel:DWORD dst_unused:UNUSED_PAD src0_sel:DWORD src1_sel:WORD_0
v_smfmac_f32_16x16x64_bf16 v[20:23], v[114:117], v[84:91], v181
ds_read_u16 v82, v82
v_add_u32_sdwa v103, s42, v131 dst_sel:DWORD dst_unused:UNUSED_PAD src0_sel:DWORD src1_sel:WORD_1
v_smfmac_f32_16x16x64_bf16 v[20:23], a[84:87], v[60:67], v147 abid:1
ds_read_u16 v100, v100
v_add_u32_sdwa v104, s42, v132 dst_sel:DWORD dst_unused:UNUSED_PAD src0_sel:DWORD src1_sel:WORD_0
v_smfmac_f32_16x16x64_bf16 v[20:23], a[120:123], v[68:75], v151 abid:1
ds_read_u16 v83, v83
v_add_u32_sdwa v105, s42, v132 dst_sel:DWORD dst_unused:UNUSED_PAD src0_sel:DWORD src1_sel:WORD_1
v_smfmac_f32_16x16x64_bf16 v[36:39], a[100:103], v[60:67], v149 abid:1
buffer_store_dwordx2 v[112:113], v5, s[20:23], s46 offen
ds_read_b128 v[114:117], v2 offset:192
v_add_u32_sdwa v106, s42, v133 dst_sel:DWORD dst_unused:UNUSED_PAD src0_sel:DWORD src1_sel:WORD_0
v_smfmac_f32_16x16x64_bf16 v[36:39], a[136:139], v[68:75], v153 abid:1
s_mov_b32 s22, 75497472
ds_read_u16 v101, v101
v_add_u32_sdwa v107, s42, v133 dst_sel:DWORD dst_unused:UNUSED_PAD src0_sel:DWORD src1_sel:WORD_1
v_smfmac_f32_16x16x64_bf16 v[40:43], a[104:107], v[60:67], v175
s_mov_b32 s46, s48
ds_read_u16 v102, v102
v_add_u32_sdwa v84, s42, v134 dst_sel:DWORD dst_unused:UNUSED_PAD src0_sel:DWORD src1_sel:WORD_0
v_smfmac_f32_16x16x64_bf16 v[40:43], a[140:143], v[68:75], v175 abid:1
s_waitcnt lgkmcnt(13)
ds_read_u16 v103, v103
v_add_u32_sdwa v85, s42, v134 dst_sel:DWORD dst_unused:UNUSED_PAD src0_sel:DWORD src1_sel:WORD_1
v_smfmac_f32_16x16x64_bf16 v[8:11], a[144:147], v[44:51], v154
s_waitcnt lgkmcnt(10)
ds_read_u16 v104, v104
v_add_u32_sdwa v86, s42, v135 dst_sel:DWORD dst_unused:UNUSED_PAD src0_sel:DWORD src1_sel:WORD_0
v_smfmac_f32_16x16x64_bf16 v[8:11], a[180:183], v[52:59], v158
s_waitcnt lgkmcnt(8)
ds_read_u16 v105, v105
v_add_u32_sdwa v87, s42, v135 dst_sel:DWORD dst_unused:UNUSED_PAD src0_sel:DWORD src1_sel:WORD_1
v_smfmac_f32_16x16x64_bf16 v[8:11], a[216:219], v[92:99], v162
s_mov_b32 s48, s49
ds_read_u16 v106, v106
v_add_u32_sdwa v88, s42, v136 dst_sel:DWORD dst_unused:UNUSED_PAD src0_sel:DWORD src1_sel:WORD_0
v_smfmac_f32_16x16x64_bf16 v[24:27], a[160:163], v[44:51], v156
s_mov_b32 s49, s50
s_add_u32 s50, s50, 4718592
v_add_u32_sdwa v89, s42, v136 dst_sel:DWORD dst_unused:UNUSED_PAD src0_sel:DWORD src1_sel:WORD_1
v_smfmac_f32_16x16x64_bf16 v[24:27], a[196:199], v[52:59], v160
ds_read_u16 v107, v107
v_add_u32_sdwa v90, s42, v137 dst_sel:DWORD dst_unused:UNUSED_PAD src0_sel:DWORD src1_sel:WORD_0
v_smfmac_f32_16x16x64_bf16 v[24:27], a[232:235], v[92:99], v164
s_waitcnt lgkmcnt(7)
ds_read_u16 v84, v84
v_add_u32_sdwa v91, s42, v137 dst_sel:DWORD dst_unused:UNUSED_PAD src0_sel:DWORD src1_sel:WORD_1
v_smfmac_f32_16x16x64_bf16 v[24:27], v[114:117], v[76:83], v182
ds_read_u16 v85, v85
v_smfmac_f32_16x16x64_bf16 v[20:23], v[114:117], v[76:83], v181 abid:1
ds_read_u16 v86, v86
v_smfmac_f32_16x16x64_bf16 v[28:31], v[114:117], v[76:83], v182 abid:1
ds_read_b128 v[114:117], v2 offset:256
v_add_u32_sdwa v76, s4, v118 dst_sel:DWORD dst_unused:UNUSED_PAD src0_sel:DWORD src1_sel:WORD_0
v_smfmac_f32_16x16x64_bf16 v[28:31], a[164:167], v[44:51], v156 abid:1
ds_read_u16 v87, v87
v_add_u32_sdwa v77, s4, v118 dst_sel:DWORD dst_unused:UNUSED_PAD src0_sel:DWORD src1_sel:WORD_1
v_smfmac_f32_16x16x64_bf16 v[28:31], a[200:203], v[52:59], v160 abid:1
ds_read_u16 v88, v88
v_add_u32_sdwa v78, s4, v119 dst_sel:DWORD dst_unused:UNUSED_PAD src0_sel:DWORD src1_sel:WORD_0
v_smfmac_f32_16x16x64_bf16 v[28:31], a[236:239], v[92:99], v164 abid:1
ds_read_b128 v[60:63], v0 offset:14336
v_add_u32_sdwa v79, s4, v119 dst_sel:DWORD dst_unused:UNUSED_PAD src0_sel:DWORD src1_sel:WORD_1
v_smfmac_f32_16x16x64_bf16 v[12:15], a[148:151], v[44:51], v154 abid:1
ds_read_u16 v89, v89
v_add_u32_sdwa v80, s4, v120 dst_sel:DWORD dst_unused:UNUSED_PAD src0_sel:DWORD src1_sel:WORD_0
v_smfmac_f32_16x16x64_bf16 v[12:15], a[184:187], v[52:59], v158 abid:1
ds_read_b128 v[64:67], v1 offset:14336
v_add_u32_sdwa v81, s4, v120 dst_sel:DWORD dst_unused:UNUSED_PAD src0_sel:DWORD src1_sel:WORD_1
v_smfmac_f32_16x16x64_bf16 v[12:15], a[220:223], v[92:99], v162 abid:1
v_add_u32_sdwa v82, s4, v121 dst_sel:DWORD dst_unused:UNUSED_PAD src0_sel:DWORD src1_sel:WORD_0
v_smfmac_f32_16x16x64_bf16 v[32:35], a[168:171], v[44:51], v157
ds_read_b128 v[68:71], v0 offset:16384
v_add_u32_sdwa v83, s4, v121 dst_sel:DWORD dst_unused:UNUSED_PAD src0_sel:DWORD src1_sel:WORD_1
v_smfmac_f32_16x16x64_bf16 v[32:35], a[204:207], v[52:59], v161
ds_read_u16 v90, v90
v_smfmac_f32_16x16x64_bf16 v[32:35], a[240:243], v[92:99], v165
s_waitcnt lgkmcnt(7)
ds_read_b128 v[72:75], v1 offset:16384
v_add_u32 v0, s43, v0
v_smfmac_f32_16x16x64_bf16 v[32:35], v[114:117], v[100:107], v183 abid:1
ds_read_u16 v91, v91
v_add_u32 v1, s43, v1
v_smfmac_f32_16x16x64_bf16 v[28:31], v[114:117], v[100:107], v183
v_smfmac_f32_16x16x64_bf16 v[36:39], v[114:117], v[100:107], v184
ds_read_b128 v[114:117], v2 offset:320
v_smfmac_f32_16x16x64_bf16 v[36:39], a[172:175], v[44:51], v157 abid:1
v_smfmac_f32_16x16x64_bf16 v[36:39], a[208:211], v[52:59], v161 abid:1
v_smfmac_f32_16x16x64_bf16 v[36:39], a[244:247], v[92:99], v165 abid:1
v_smfmac_f32_16x16x64_bf16 v[16:19], a[152:155], v[44:51], v155
v_smfmac_f32_16x16x64_bf16 v[16:19], a[188:191], v[52:59], v159
v_smfmac_f32_16x16x64_bf16 v[16:19], a[224:227], v[92:99], v163
v_smfmac_f32_16x16x64_bf16 v[20:23], a[156:159], v[44:51], v155 abid:1
v_smfmac_f32_16x16x64_bf16 v[20:23], a[192:195], v[52:59], v159 abid:1
v_smfmac_f32_16x16x64_bf16 v[20:23], a[228:231], v[92:99], v163 abid:1
v_smfmac_f32_16x16x64_bf16 v[40:43], a[176:179], v[44:51], v176
s_bitcmp1_b32 s92, s41
v_smfmac_f32_16x16x64_bf16 v[40:43], a[212:215], v[52:59], v176 abid:1
s_cbranch_scc1 L_loopnk_w
L_loopnk_wb:
v_smfmac_f32_16x16x64_bf16 v[40:43], a[248:251], v[92:99], v177
s_waitcnt lgkmcnt(0)
v_smfmac_f32_16x16x64_bf16 v[40:43], v[114:117], v[84:91], v185
v_smfmac_f32_16x16x64_bf16 v[36:39], v[114:117], v[84:91], v184 abid:1
s_waitcnt vmcnt(20)
s_barrier
L_loopnk_p3:
v_smfmac_f32_16x16x64_bf16 v[8:11], a[252:255], v[60:67], v166
s_mov_b32 s42, s4
v_smfmac_f32_16x16x64_bf16 v[8:11], v[218:221], v[68:75], v170
ds_read_b128 v[44:47], v0 offset:0
v_add_u32_sdwa v84, s42, v122 dst_sel:DWORD dst_unused:UNUSED_PAD src0_sel:DWORD src1_sel:WORD_0
v_smfmac_f32_16x16x64_bf16 v[12:15], v[186:189], v[60:67], v166 abid:1
ds_read_b128 v[48:51], v1 offset:0
v_add_u32_sdwa v85, s42, v122 dst_sel:DWORD dst_unused:UNUSED_PAD src0_sel:DWORD src1_sel:WORD_1
v_smfmac_f32_16x16x64_bf16 v[12:15], v[222:225], v[68:75], v170 abid:1
ds_read_b128 v[52:55], v0 offset:2048
v_add_u32_sdwa v86, s42, v123 dst_sel:DWORD dst_unused:UNUSED_PAD src0_sel:DWORD src1_sel:WORD_0
v_smfmac_f32_16x16x64_bf16 v[16:19], v[190:193], v[60:67], v167
ds_read_b128 v[56:59], v1 offset:2048
v_cvt_pk_bf16_f32 v92, v8, v9
v_smfmac_f32_16x16x64_bf16 v[16:19], v[226:229], v[68:75], v171
ds_read_u16 v76, v76
v_cvt_pk_bf16_f32 v93, v10, v11
v_smfmac_f32_16x16x64_bf16 v[20:23], v[194:197], v[60:67], v167 abid:1
ds_read_b128 v[8:11], v2 offset:1024
v_cvt_pk_bf16_f32 v94, v12, v13
v_smfmac_f32_16x16x64_bf16 v[20:23], v[230:233], v[68:75], v171 abid:1
ds_read_u16 v77, v77
v_cvt_pk_bf16_f32 v95, v14, v15
v_smfmac_f32_16x16x64_bf16 v[24:27], v[198:201], v[60:67], v168
ds_read_b128 v[12:15], v2 offset:1088
v_cvt_pk_bf16_f32 v96, v16, v17
v_smfmac_f32_16x16x64_bf16 v[24:27], v[234:237], v[68:75], v172
ds_read_u16 v78, v78
v_cvt_pk_bf16_f32 v97, v18, v19
v_smfmac_f32_16x16x64_bf16 v[28:31], v[202:205], v[60:67], v168 abid:1
ds_read_b128 v[16:19], v2 offset:1152
v_cvt_pk_bf16_f32 v98, v20, v21
v_smfmac_f32_16x16x64_bf16 v[28:31], v[238:241], v[68:75], v172 abid:1
ds_read_u16 v79, v79
v_cvt_pk_bf16_f32 v99, v22, v23
v_smfmac_f32_16x16x64_bf16 v[32:35], v[206:209], v[60:67], v169
ds_read_b128 v[20:23], v2 offset:1216
v_cvt_pk_bf16_f32 v100, v24, v25
v_smfmac_f32_16x16x64_bf16 v[32:35], v[242:245], v[68:75], v173
ds_read_u16 v80, v80
v_cvt_pk_bf16_f32 v101, v26, v27
v_smfmac_f32_16x16x64_bf16 v[36:39], v[210:213], v[60:67], v169 abid:1
ds_read_b128 v[24:27], v2 offset:1280
v_cvt_pk_bf16_f32 v102, v28, v29
v_smfmac_f32_16x16x64_bf16 v[36:39], v[246:249], v[68:75], v173 abid:1
ds_read_u16 v81, v81
v_cvt_pk_bf16_f32 v103, v30, v31
v_smfmac_f32_16x16x64_bf16 v[40:43], v[214:217], v[60:67], v177 abid:1
s_bitcmp1_b32 s12, s41
ds_read_b128 v[28:31], v2 offset:1344
v_cvt_pk_bf16_f32 v104, v32, v33
v_smfmac_f32_16x16x64_bf16 v[40:43], v[250:253], v[68:75], v178
s_waitcnt lgkmcnt(10)
v_cvt_pk_bf16_f32 v105, v34, v35
s_cbranch_scc1 L_loopnk
s_cmp_eq_u32 s41, s59
s_cbranch_scc1 L_loopck
s_cmp_lt_u32 s41, s15
s_cbranch_scc1 L_loopk
s_nop 0
v_cndmask_b32_dpp v108, v96, v92, vcc quad_perm:[1,0,3,2] row_mask:0xf bank_mask:0xf
v_cndmask_b32_dpp v109, v97, v93, vcc quad_perm:[1,0,3,2] row_mask:0xf bank_mask:0xf
v_cndmask_b32_dpp v110, v98, v94, vcc quad_perm:[1,0,3,2] row_mask:0xf bank_mask:0xf
v_cndmask_b32_dpp v111, v99, v95, vcc quad_perm:[1,0,3,2] row_mask:0xf bank_mask:0xf
buffer_store_dwordx4 v[108:111], v4, s[20:23], s46 offen offset:0 sc1
s_mov_b64 vcc, s[82:83]
v_cvt_pk_bf16_f32 v112, v40, v41
v_cvt_pk_bf16_f32 v113, v42, v43
ds_bpermute_b32 v112, v6, v112
ds_bpermute_b32 v113, v6, v113
v_cndmask_b32_dpp v96, v92, v96, vcc quad_perm:[1,0,3,2] row_mask:0xf bank_mask:0xf
v_cndmask_b32_dpp v97, v93, v97, vcc quad_perm:[1,0,3,2] row_mask:0xf bank_mask:0xf
v_cndmask_b32_dpp v98, v94, v98, vcc quad_perm:[1,0,3,2] row_mask:0xf bank_mask:0xf
v_cndmask_b32_dpp v99, v95, v99, vcc quad_perm:[1,0,3,2] row_mask:0xf bank_mask:0xf
buffer_store_dwordx4 v[96:99], v4, s[20:23], s46 offen offset:1152 sc1
s_mov_b64 vcc, s[80:81]
v_cvt_pk_bf16_f32 v106, v36, v37
v_cvt_pk_bf16_f32 v107, v38, v39
v_cndmask_b32_dpp v92, v104, v100, vcc quad_perm:[1,0,3,2] row_mask:0xf bank_mask:0xf
v_cndmask_b32_dpp v93, v105, v101, vcc quad_perm:[1,0,3,2] row_mask:0xf bank_mask:0xf
v_cndmask_b32_dpp v94, v106, v102, vcc quad_perm:[1,0,3,2] row_mask:0xf bank_mask:0xf
v_cndmask_b32_dpp v95, v107, v103, vcc quad_perm:[1,0,3,2] row_mask:0xf bank_mask:0xf
buffer_store_dwordx4 v[92:95], v4, s[20:23], s46 offen offset:128 sc1
s_mov_b64 vcc, s[82:83]
v_cndmask_b32_dpp v104, v100, v104, vcc quad_perm:[1,0,3,2] row_mask:0xf bank_mask:0xf
v_cndmask_b32_dpp v105, v101, v105, vcc quad_perm:[1,0,3,2] row_mask:0xf bank_mask:0xf
v_cndmask_b32_dpp v106, v102, v106, vcc quad_perm:[1,0,3,2] row_mask:0xf bank_mask:0xf
v_cndmask_b32_dpp v107, v103, v107, vcc quad_perm:[1,0,3,2] row_mask:0xf bank_mask:0xf
buffer_store_dwordx4 v[104:107], v4, s[20:23], s46 offen offset:1280 sc1
s_mov_b64 vcc, s[80:81]
s_waitcnt lgkmcnt(0)
buffer_store_dwordx2 v[112:113], v5, s[20:23], s46 offen
s_branch L_fin
L_loopk_w:
s_bitcmp1_b32 s87, s41
s_waitcnt vmcnt(15)
s_cbranch_scc0 L_loopk_wb
s_waitcnt vmcnt(10)
s_branch L_loopk_wb
L_loopnk_w:
s_bitcmp1_b32 s87, s41
s_waitcnt vmcnt(15)
s_cbranch_scc0 L_loopnk_wb
s_waitcnt vmcnt(10)
s_branch L_loopnk_wb
L_slow:
s_waitcnt vmcnt(0) lgkmcnt(0)
s_mov_b32 s87, 0
L_sm:
s_lshl_b32 s86, s2, 1
s_add_u32 s86, s86, s87
s_add_u32 s86, s86, 1
s_mul_i32 s86, s86, 393216
s_mov_b32 s84, 0
L_st:
s_and_b32 s48, s84, 3
s_lshr_b32 s49, s84, 2
s_sub_u32 s50, s84, 36
s_lshl_b32 s51, s40, 4
s_lshl_b32 s52, s50, 1
s_lshl_b32 s53, s48, 8
s_cmp_lt_u32 s84, 36
s_cselect_b32 s52, s49, s52
s_cselect_b32 s53, s53, 1024
s_cselect_b32 s54, 8, 73728
s_cselect_b32 s55, 32, 8
s_cselect_b32 s56, 16, 32
s_cselect_b32 s57, 128, 64
s_mul_i32 s52, s52, 73728
s_mul_i32 s58, s40, 18432
v_and_b32 v58, 1, v7
v_bfe_u32 v59, v7, 1, 1
v_bfe_u32 v60, v7, 2, 2
v_bfe_u32 v62, v7, 4, 1
v_lshrrev_b32 v63, 5, v7
v_lshl_add_u32 v50, v58, 2, s52
v_mad_u32_u24 v50, v59, s54, v50
v_mad_u32_u24 v50, v60, s55, v50
v_mad_u32_u24 v50, v62, s56, v50
v_mad_u32_u24 v50, v63, s57, v50
v_add_u32 v50, s53, v50
v_add_u32 v50, s58, v50
v_add_u32 v62, 4608, v50
v_add_u32 v63, 9216, v50
v_add_u32 v64, 13824, v50
buffer_load_dword v8, v50, s[28:31], 0 offen offset:0
buffer_load_dword v9, v50, s[28:31], 0 offen offset:1152
buffer_load_dword v10, v50, s[28:31], 0 offen offset:2304
buffer_load_dword v11, v50, s[28:31], 0 offen offset:3456
buffer_load_dword v12, v62, s[28:31], 0 offen offset:0
buffer_load_dword v13, v62, s[28:31], 0 offen offset:1152
buffer_load_dword v14, v62, s[28:31], 0 offen offset:2304
buffer_load_dword v15, v62, s[28:31], 0 offen offset:3456
buffer_load_dword v16, v63, s[28:31], 0 offen offset:0
buffer_load_dword v17, v63, s[28:31], 0 offen offset:1152
buffer_load_dword v18, v63, s[28:31], 0 offen offset:2304
buffer_load_dword v19, v63, s[28:31], 0 offen offset:3456
buffer_load_dword v20, v64, s[28:31], 0 offen offset:0
buffer_load_dword v21, v64, s[28:31], 0 offen offset:1152
buffer_load_dword v22, v64, s[28:31], 0 offen offset:2304
buffer_load_dword v23, v64, s[28:31], 0 offen offset:3456
s_mul_i32 s52, s48, 9
s_add_u32 s52, s52, s49
s_mul_i32 s53, s52, 9
s_mul_i32 s54, s50, 18
s_add_u32 s54, s54, 8
s_lshl_b32 s55, s52, 2
s_add_u32 s55, s55, s40
s_lshl_b32 s56, s50, 2
s_add_u32 s56, s56, s40
s_cmp_eq_u32 s84, 40
s_cselect_b32 s57, 0x100000, 9
s_cmp_lt_u32 s84, 36
s_cselect_b32 s53, s53, s54
s_cselect_b32 s54, 2, 81
s_cselect_b32 s57, 1, s57
s_cselect_b32 s55, s55, s56
s_mov_b32 s56, 331776
s_cselect_b32 s56, s56, 368640
s_mov_b32 s58, 373760
s_cselect_b32 s58, s58, 382976
s_cselect_b32 s59, 16, 4
s_cselect_b32 s60, 4, 64
s_cselect_b32 s61, 12, 11
s_cselect_b32 s62, 1, 0x8001
v_lshrrev_b32 v61, 4, v7
v_lshlrev_b32 v62, 1, v58
v_lshl_add_u32 v60, v60, 2, v62
v_add_u32 v62, v60, v59
v_mul_u32_u24 v51, s54, v61
v_add_lshl_u32 v51, v51, s53, 6
v_add3_u32 v51, v51, v62, s51
v_lshl_add_u32 v51, v51, 4, s86
s_lshl_b32 s57, s57, 10
v_add_u32 v66, s57, v51
s_lshl_b32 s52, s55, 8
s_add_u32 s52, s52, s56
s_add_u32 s52, s52, s86
v_mul_u32_u24 v52, s59, v62
v_mad_u32_u24 v52, v61, s60, v52
v_add_u32 v52, s52, v52
v_mov_b32 v55, 0x05040100
v_mov_b32 v62, 0x03020706
v_cmp_eq_u32 vcc, 1, v59
v_mov_b32 v68, 0xf0a0500
v_mov_b32 v69, 0x8f8a8580
v_mov_b32 v70, 0x1f1a1510
v_mov_b32 v71, 0x9f9a9590
v_mov_b32 v72, 0x2f2a2520
v_mov_b32 v73, 0xafaaa5a0
v_mov_b32 v74, 0x3f3a3530
v_mov_b32 v75, 0xbfbab5b0
v_cndmask_b32 v55, v55, v62, vcc
s_mov_b32 s64, 0x5040500
s_mov_b32 s65, 0x5040501
s_mov_b32 s66, 0x5040502
s_mov_b32 s67, 0x5040503
s_mov_b32 s68, 0x7060700
s_mov_b32 s69, 0x7060701
s_mov_b32 s70, 0x7060702
s_mov_b32 s71, 0x7060703
s_mov_b32 s72, 0x05060102
s_cmp_lg_u32 s87, 0
s_waitcnt vmcnt(12)
v_perm_b32 v24, v8, v68, s64
v_perm_b32 v25, v9, v68, s65
v_perm_b32 v26, v10, v68, s66
v_perm_b32 v27, v11, v68, s67
v_max3_f32 v28, |v24|, |v25|, |v26|
v_med3_f32 v29, |v24|, |v25|, |v26|
v_min3_f32 v30, |v24|, |v25|, |v26|
v_med3_f32 v32, v28, v29, |v27|
v_med3_f32 v33, v29, v30, |v27|
v_max_f32 v31, v28, |v27|
v_cmp_eq_u32_sdwa vcc, v33, v32 src0_sel:WORD_1 src1_sel:WORD_1
s_cbranch_scc0 L_rb0g
v_min_f32 v30, v30, |v27|
v_cndmask_b32 v31, 0, v33, vcc
v_cmp_eq_u32_sdwa vcc, v30, v32 src0_sel:WORD_1 src1_sel:WORD_1
s_nop 1
v_cndmask_b32 v32, 0, v30, vcc
L_rb0g:
v_perm_b32 v36, v31, v32, s72
v_bfi_b32 v44, 3, v32, v31
v_perm_b32 v24, v8, v69, s68
v_perm_b32 v25, v9, v69, s69
v_perm_b32 v26, v10, v69, s70
v_perm_b32 v27, v11, v69, s71
v_max3_f32 v28, |v24|, |v25|, |v26|
v_med3_f32 v29, |v24|, |v25|, |v26|
v_min3_f32 v30, |v24|, |v25|, |v26|
v_med3_f32 v32, v28, v29, |v27|
v_med3_f32 v33, v29, v30, |v27|
v_max_f32 v31, v28, |v27|
v_cmp_eq_u32_sdwa vcc, v33, v32 src0_sel:WORD_1 src1_sel:WORD_1
s_cbranch_scc0 L_rb1g
v_min_f32 v30, v30, |v27|
v_cndmask_b32 v31, 0, v33, vcc
v_cmp_eq_u32_sdwa vcc, v30, v32 src0_sel:WORD_1 src1_sel:WORD_1
s_nop 1
v_cndmask_b32 v32, 0, v30, vcc
L_rb1g:
v_perm_b32 v40, v31, v32, s72
v_bfi_b32 v46, 3, v32, v31
s_waitcnt vmcnt(8)
v_perm_b32 v24, v12, v70, s64
v_perm_b32 v25, v13, v70, s65
v_perm_b32 v26, v14, v70, s66
v_perm_b32 v27, v15, v70, s67
v_max3_f32 v28, |v24|, |v25|, |v26|
v_med3_f32 v29, |v24|, |v25|, |v26|
v_min3_f32 v30, |v24|, |v25|, |v26|
v_med3_f32 v32, v28, v29, |v27|
v_med3_f32 v33, v29, v30, |v27|
v_max_f32 v31, v28, |v27|
v_cmp_eq_u32_sdwa vcc, v33, v32 src0_sel:WORD_1 src1_sel:WORD_1
s_cbranch_scc0 L_rb2g
v_min_f32 v30, v30, |v27|
v_cndmask_b32 v31, 0, v33, vcc
v_cmp_eq_u32_sdwa vcc, v30, v32 src0_sel:WORD_1 src1_sel:WORD_1
s_nop 1
v_cndmask_b32 v32, 0, v30, vcc
L_rb2g:
v_perm_b32 v37, v31, v32, s72
v_bfi_b32 v31, 3, v32, v31
v_lshlrev_b32 v31, 4, v31
v_bfi_b32 v44, 15, v44, v31
v_perm_b32 v24, v12, v71, s68
v_perm_b32 v25, v13, v71, s69
v_perm_b32 v26, v14, v71, s70
v_perm_b32 v27, v15, v71, s71
v_max3_f32 v28, |v24|, |v25|, |v26|
v_med3_f32 v29, |v24|, |v25|, |v26|
v_min3_f32 v30, |v24|, |v25|, |v26|
v_med3_f32 v32, v28, v29, |v27|
v_med3_f32 v33, v29, v30, |v27|
v_max_f32 v31, v28, |v27|
v_cmp_eq_u32_sdwa vcc, v33, v32 src0_sel:WORD_1 src1_sel:WORD_1
s_cbranch_scc0 L_rb3g
v_min_f32 v30, v30, |v27|
v_cndmask_b32 v31, 0, v33, vcc
v_cmp_eq_u32_sdwa vcc, v30, v32 src0_sel:WORD_1 src1_sel:WORD_1
s_nop 1
v_cndmask_b32 v32, 0, v30, vcc
L_rb3g:
v_perm_b32 v41, v31, v32, s72
v_bfi_b32 v31, 3, v32, v31
v_lshlrev_b32 v31, 4, v31
v_bfi_b32 v46, 15, v46, v31
s_waitcnt vmcnt(4)
v_perm_b32 v24, v16, v72, s64
v_perm_b32 v25, v17, v72, s65
v_perm_b32 v26, v18, v72, s66
v_perm_b32 v27, v19, v72, s67
v_max3_f32 v28, |v24|, |v25|, |v26|
v_med3_f32 v29, |v24|, |v25|, |v26|
v_min3_f32 v30, |v24|, |v25|, |v26|
v_med3_f32 v32, v28, v29, |v27|
v_med3_f32 v33, v29, v30, |v27|
v_max_f32 v31, v28, |v27|
v_cmp_eq_u32_sdwa vcc, v33, v32 src0_sel:WORD_1 src1_sel:WORD_1
s_cbranch_scc0 L_rb4g
v_min_f32 v30, v30, |v27|
v_cndmask_b32 v31, 0, v33, vcc
v_cmp_eq_u32_sdwa vcc, v30, v32 src0_sel:WORD_1 src1_sel:WORD_1
s_nop 1
v_cndmask_b32 v32, 0, v30, vcc
L_rb4g:
v_perm_b32 v38, v31, v32, s72
v_bfi_b32 v45, 3, v32, v31
v_perm_b32 v24, v16, v73, s68
v_perm_b32 v25, v17, v73, s69
v_perm_b32 v26, v18, v73, s70
v_perm_b32 v27, v19, v73, s71
v_max3_f32 v28, |v24|, |v25|, |v26|
v_med3_f32 v29, |v24|, |v25|, |v26|
v_min3_f32 v30, |v24|, |v25|, |v26|
v_med3_f32 v32, v28, v29, |v27|
v_med3_f32 v33, v29, v30, |v27|
v_max_f32 v31, v28, |v27|
v_cmp_eq_u32_sdwa vcc, v33, v32 src0_sel:WORD_1 src1_sel:WORD_1
s_cbranch_scc0 L_rb5g
v_min_f32 v30, v30, |v27|
v_cndmask_b32 v31, 0, v33, vcc
v_cmp_eq_u32_sdwa vcc, v30, v32 src0_sel:WORD_1 src1_sel:WORD_1
s_nop 1
v_cndmask_b32 v32, 0, v30, vcc
L_rb5g:
v_perm_b32 v42, v31, v32, s72
v_bfi_b32 v47, 3, v32, v31
s_waitcnt vmcnt(0)
v_perm_b32 v24, v20, v74, s64
v_perm_b32 v25, v21, v74, s65
v_perm_b32 v26, v22, v74, s66
v_perm_b32 v27, v23, v74, s67
v_max3_f32 v28, |v24|, |v25|, |v26|
v_med3_f32 v29, |v24|, |v25|, |v26|
v_min3_f32 v30, |v24|, |v25|, |v26|
v_med3_f32 v32, v28, v29, |v27|
v_med3_f32 v33, v29, v30, |v27|
v_max_f32 v31, v28, |v27|
v_cmp_eq_u32_sdwa vcc, v33, v32 src0_sel:WORD_1 src1_sel:WORD_1
s_cbranch_scc0 L_rb6g
v_min_f32 v30, v30, |v27|
v_cndmask_b32 v31, 0, v33, vcc
v_cmp_eq_u32_sdwa vcc, v30, v32 src0_sel:WORD_1 src1_sel:WORD_1
s_nop 1
v_cndmask_b32 v32, 0, v30, vcc
L_rb6g:
v_perm_b32 v39, v31, v32, s72
v_bfi_b32 v31, 3, v32, v31
v_lshlrev_b32 v31, 4, v31
v_bfi_b32 v45, 15, v45, v31
v_perm_b32 v24, v20, v75, s68
v_perm_b32 v25, v21, v75, s69
v_perm_b32 v26, v22, v75, s70
v_perm_b32 v27, v23, v75, s71
v_max3_f32 v28, |v24|, |v25|, |v26|
v_med3_f32 v29, |v24|, |v25|, |v26|
v_min3_f32 v30, |v24|, |v25|, |v26|
v_med3_f32 v32, v28, v29, |v27|
v_med3_f32 v33, v29, v30, |v27|
v_max_f32 v31, v28, |v27|
v_cmp_eq_u32_sdwa vcc, v33, v32 src0_sel:WORD_1 src1_sel:WORD_1
s_cbranch_scc0 L_rb7g
v_min_f32 v30, v30, |v27|
v_cndmask_b32 v31, 0, v33, vcc
v_cmp_eq_u32_sdwa vcc, v30, v32 src0_sel:WORD_1 src1_sel:WORD_1
s_nop 1
v_cndmask_b32 v32, 0, v30, vcc
L_rb7g:
v_perm_b32 v43, v31, v32, s72
v_bfi_b32 v31, 3, v32, v31
v_lshlrev_b32 v31, 4, v31
v_bfi_b32 v47, 15, v47, v31
s_mov_b32 vcc_lo, 0x33333333
s_mov_b32 vcc_hi, 0x33333333
v_cndmask_b32_dpp v24, v40, v36, vcc quad_perm:[2,3,0,1] row_mask:0xf bank_mask:0xf
v_cndmask_b32_dpp v25, v41, v37, vcc quad_perm:[2,3,0,1] row_mask:0xf bank_mask:0xf
v_cndmask_b32_dpp v26, v42, v38, vcc quad_perm:[2,3,0,1] row_mask:0xf bank_mask:0xf
v_cndmask_b32_dpp v27, v43, v39, vcc quad_perm:[2,3,0,1] row_mask:0xf bank_mask:0xf
s_not_b64 vcc, vcc
buffer_store_dwordx4 v[24:27], v51, s[24:27], 0 offen sc1
v_cndmask_b32_dpp v40, v36, v40, vcc quad_perm:[2,3,0,1] row_mask:0xf bank_mask:0xf
v_cndmask_b32_dpp v41, v37, v41, vcc quad_perm:[2,3,0,1] row_mask:0xf bank_mask:0xf
v_cndmask_b32_dpp v42, v38, v42, vcc quad_perm:[2,3,0,1] row_mask:0xf bank_mask:0xf
v_cndmask_b32_dpp v43, v39, v43, vcc quad_perm:[2,3,0,1] row_mask:0xf bank_mask:0xf
s_mov_b32 s52, 0x0c0c0400
s_mov_b32 s53, 0x04000c0c
buffer_store_dwordx4 v[40:43], v66, s[24:27], 0 offen sc1
v_perm_b32 v48, v45, v44, s52
v_perm_b32 v49, v47, v46, s53
v_or_b32 v48, v48, v49
s_nop 1
v_mov_b32_dpp v49, v48 quad_perm:[2,3,0,1] row_mask:0xf bank_mask:0xf
v_perm_b32 v48, v49, v48, v55
buffer_store_dword v48, v52, s[24:27], 0 offen sc1
s_waitcnt vmcnt(0)
s_add_u32 s84, s84, 1
s_cmp_lt_u32 s84, 41
s_cbranch_scc1 L_st
s_add_u32 s87, s87, 1
s_cmp_lt_u32 s87, 2
s_cbranch_scc1 L_sm
v_lshrrev_b32 v72, 3, v7
v_and_b32 v73, 7, v7
v_xor_b32 v73, v73, v72
v_mul_u32_u24 v72, 1152, v72
s_and_b32 s47, s40, 1
s_mul_i32 s47, s47, 9216
s_lshr_b32 s3, s40, 1
s_lshl_b32 s3, s3, 7
s_add_u32 s47, s47, s3
v_lshl_add_u32 v72, v73, 4, v72
v_add_u32 v3, s47, v72
s_lshl_b32 s44, s40, 10
s_mul_i32 s45, s2, 18432
s_mov_b32 s46, s45
s_lshr_b32 s47, s40, 1
s_lshl_b32 s3, s47, 11
s_sub_u32 s8, 15488, s3
s_lshl_b32 s3, s47, 7
s_add_u32 s7, s45, 128
s_sub_u32 s7, s7, s3
s_sub_u32 s10, s47, 1
s_sub_u32 s11, 0, s47
s_mov_b32 s9, s44
s_mov_b32 s13, 4718592
s_mov_b32 s15, 16
s_mov_b32 s14, s13
s_mov_b32 s22, 75497472
s_mov_b32 s18, 75497472
s_mov_b32 s41, 0
L_stile:
s_barrier
s_add_u32 m0, s44, 0
s_nop 0
buffer_load_dwordx4 v3, s[16:19], s45 offen offset:0 nt lds
s_add_u32 m0, s44, 3840
s_nop 0
buffer_load_dwordx4 v3, s[16:19], s45 offen offset:256 nt lds
s_add_u32 m0, s44, 7680
s_nop 0
buffer_load_dwordx4 v3, s[16:19], s45 offen offset:512 nt lds
s_add_u32 m0, s44, 11520
s_nop 0
buffer_load_dwordx4 v3, s[16:19], s45 offen offset:768 nt lds
s_add_u32 m0, s44, s8
s_mov_b64 exec, s[10:11]
buffer_load_dwordx4 v3, s[16:19], s7 offen offset:896 nt lds
s_mov_b64 exec, -1
ds_read_b128 v[8:11], v2 offset:1024
ds_read_b128 v[12:15], v2 offset:1088
ds_read_b128 v[16:19], v2 offset:1152
ds_read_b128 v[20:23], v2 offset:1216
ds_read_b128 v[24:27], v2 offset:1280
ds_read_b128 v[28:31], v2 offset:1344
ds_read_b128 v[32:35], v2 offset:1408
ds_read_b128 v[36:39], v2 offset:1472
ds_read_b128 v[40:43], v2 offset:1536
s_mov_b32 s87, 0
L_spass:
s_lshl_b32 s86, s2, 1
s_add_u32 s86, s86, s87
s_add_u32 s86, s86, 1
s_mul_i32 s86, s86, 393216
s_mul_i32 s47, s40, 82944
s_add_u32 s47, s47, s86
v_lshl_add_u32 v104, v7, 4, s47
s_mul_i32 s47, s40, 9216
s_add_u32 s47, s47, s86
s_add_u32 s47, s47, 331776
v_lshl_add_u32 v105, v7, 4, s47
s_lshl_b32 s47, s40, 6
s_add_u32 s47, s47, s86
s_add_u32 s47, s47, 368640
v_and_b32 v106, 15, v7
v_lshl_add_u32 v106, v106, 2, s47
v_lshrrev_b32 v107, 4, v7
v_lshl_add_u32 v106, v107, 8, v106
buffer_load_dword v174, v106, s[24:27], 0 offen offset:0 sc1
buffer_load_dword v175, v106, s[24:27], 0 offen offset:1024 sc1
buffer_load_dword v176, v106, s[24:27], 0 offen offset:2048 sc1
buffer_load_dword v177, v106, s[24:27], 0 offen offset:3072 sc1
s_mov_b32 s99, 4096
buffer_load_dword v178, v106, s[24:27], s99 offen offset:0 sc1
s_mov_b32 s98, 0
buffer_load_dwordx4 v[138:141], v105, s[24:27], s98 offen sc1
s_mov_b32 s99, 0
buffer_load_dwordx4 a[0:3], v104, s[24:27], s99 offen offset:0 sc1
buffer_load_dwordx4 a[4:7], v104, s[24:27], s99 offen offset:1024 sc1
buffer_load_dwordx4 a[8:11], v104, s[24:27], s99 offen offset:2048 sc1
buffer_load_dwordx4 a[12:15], v104, s[24:27], s99 offen offset:3072 sc1
s_mov_b32 s99, 4096
buffer_load_dwordx4 a[16:19], v104, s[24:27], s99 offen offset:0 sc1
buffer_load_dwordx4 a[20:23], v104, s[24:27], s99 offen offset:1024 sc1
buffer_load_dwordx4 a[24:27], v104, s[24:27], s99 offen offset:2048 sc1
buffer_load_dwordx4 a[28:31], v104, s[24:27], s99 offen offset:3072 sc1
s_mov_b32 s99, 8192
buffer_load_dwordx4 a[32:35], v104, s[24:27], s99 offen offset:0 sc1
s_mov_b32 s98, 1024
buffer_load_dwordx4 v[142:145], v105, s[24:27], s98 offen sc1
buffer_load_dwordx4 a[36:39], v104, s[24:27], s99 offen offset:1024 sc1
buffer_load_dwordx4 a[40:43], v104, s[24:27], s99 offen offset:2048 sc1
buffer_load_dwordx4 a[44:47], v104, s[24:27], s99 offen offset:3072 sc1
s_mov_b32 s99, 12288
buffer_load_dwordx4 a[48:51], v104, s[24:27], s99 offen offset:0 sc1
buffer_load_dwordx4 a[52:55], v104, s[24:27], s99 offen offset:1024 sc1
buffer_load_dwordx4 a[56:59], v104, s[24:27], s99 offen offset:2048 sc1
buffer_load_dwordx4 a[60:63], v104, s[24:27], s99 offen offset:3072 sc1
s_mov_b32 s99, 16384
buffer_load_dwordx4 a[64:67], v104, s[24:27], s99 offen offset:0 sc1
buffer_load_dwordx4 a[68:71], v104, s[24:27], s99 offen offset:1024 sc1
s_mov_b32 s98, 2048
buffer_load_dwordx4 v[146:149], v105, s[24:27], s98 offen sc1
buffer_load_dwordx4 a[72:75], v104, s[24:27], s99 offen offset:2048 sc1
buffer_load_dwordx4 a[76:79], v104, s[24:27], s99 offen offset:3072 sc1
s_mov_b32 s99, 20480
buffer_load_dwordx4 a[80:83], v104, s[24:27], s99 offen offset:0 sc1
buffer_load_dwordx4 a[84:87], v104, s[24:27], s99 offen offset:1024 sc1
buffer_load_dwordx4 a[88:91], v104, s[24:27], s99 offen offset:2048 sc1
buffer_load_dwordx4 a[92:95], v104, s[24:27], s99 offen offset:3072 sc1
s_mov_b32 s99, 24576
buffer_load_dwordx4 a[96:99], v104, s[24:27], s99 offen offset:0 sc1
buffer_load_dwordx4 a[100:103], v104, s[24:27], s99 offen offset:1024 sc1
buffer_load_dwordx4 a[104:107], v104, s[24:27], s99 offen offset:2048 sc1
s_mov_b32 s98, 3072
buffer_load_dwordx4 v[150:153], v105, s[24:27], s98 offen sc1
buffer_load_dwordx4 a[108:111], v104, s[24:27], s99 offen offset:3072 sc1
s_mov_b32 s99, 28672
buffer_load_dwordx4 a[112:115], v104, s[24:27], s99 offen offset:0 sc1
buffer_load_dwordx4 a[116:119], v104, s[24:27], s99 offen offset:1024 sc1
buffer_load_dwordx4 a[120:123], v104, s[24:27], s99 offen offset:2048 sc1
buffer_load_dwordx4 a[124:127], v104, s[24:27], s99 offen offset:3072 sc1
s_mov_b32 s99, 32768
buffer_load_dwordx4 a[128:131], v104, s[24:27], s99 offen offset:0 sc1
buffer_load_dwordx4 a[132:135], v104, s[24:27], s99 offen offset:1024 sc1
buffer_load_dwordx4 a[136:139], v104, s[24:27], s99 offen offset:2048 sc1
buffer_load_dwordx4 a[140:143], v104, s[24:27], s99 offen offset:3072 sc1
s_mov_b32 s98, 4096
buffer_load_dwordx4 v[154:157], v105, s[24:27], s98 offen sc1
s_mov_b32 s99, 36864
buffer_load_dwordx4 a[144:147], v104, s[24:27], s99 offen offset:0 sc1
buffer_load_dwordx4 a[148:151], v104, s[24:27], s99 offen offset:1024 sc1
buffer_load_dwordx4 a[152:155], v104, s[24:27], s99 offen offset:2048 sc1
buffer_load_dwordx4 a[156:159], v104, s[24:27], s99 offen offset:3072 sc1
s_mov_b32 s99, 40960
buffer_load_dwordx4 a[160:163], v104, s[24:27], s99 offen offset:0 sc1
buffer_load_dwordx4 a[164:167], v104, s[24:27], s99 offen offset:1024 sc1
buffer_load_dwordx4 a[168:171], v104, s[24:27], s99 offen offset:2048 sc1
buffer_load_dwordx4 a[172:175], v104, s[24:27], s99 offen offset:3072 sc1
s_mov_b32 s99, 45056
buffer_load_dwordx4 a[176:179], v104, s[24:27], s99 offen offset:0 sc1
s_mov_b32 s98, 5120
buffer_load_dwordx4 v[158:161], v105, s[24:27], s98 offen sc1
buffer_load_dwordx4 a[180:183], v104, s[24:27], s99 offen offset:1024 sc1
buffer_load_dwordx4 a[184:187], v104, s[24:27], s99 offen offset:2048 sc1
buffer_load_dwordx4 a[188:191], v104, s[24:27], s99 offen offset:3072 sc1
s_mov_b32 s99, 49152
buffer_load_dwordx4 a[192:195], v104, s[24:27], s99 offen offset:0 sc1
buffer_load_dwordx4 a[196:199], v104, s[24:27], s99 offen offset:1024 sc1
buffer_load_dwordx4 a[200:203], v104, s[24:27], s99 offen offset:2048 sc1
buffer_load_dwordx4 a[204:207], v104, s[24:27], s99 offen offset:3072 sc1
s_mov_b32 s99, 53248
buffer_load_dwordx4 a[208:211], v104, s[24:27], s99 offen offset:0 sc1
buffer_load_dwordx4 a[212:215], v104, s[24:27], s99 offen offset:1024 sc1
s_mov_b32 s98, 6144
buffer_load_dwordx4 v[162:165], v105, s[24:27], s98 offen sc1
buffer_load_dwordx4 a[216:219], v104, s[24:27], s99 offen offset:2048 sc1
buffer_load_dwordx4 a[220:223], v104, s[24:27], s99 offen offset:3072 sc1
s_mov_b32 s99, 57344
buffer_load_dwordx4 a[224:227], v104, s[24:27], s99 offen offset:0 sc1
buffer_load_dwordx4 a[228:231], v104, s[24:27], s99 offen offset:1024 sc1
buffer_load_dwordx4 a[232:235], v104, s[24:27], s99 offen offset:2048 sc1
buffer_load_dwordx4 a[236:239], v104, s[24:27], s99 offen offset:3072 sc1
s_mov_b32 s99, 61440
buffer_load_dwordx4 a[240:243], v104, s[24:27], s99 offen offset:0 sc1
buffer_load_dwordx4 a[244:247], v104, s[24:27], s99 offen offset:1024 sc1
buffer_load_dwordx4 a[248:251], v104, s[24:27], s99 offen offset:2048 sc1
s_mov_b32 s98, 7168
buffer_load_dwordx4 v[166:169], v105, s[24:27], s98 offen sc1
buffer_load_dwordx4 a[252:255], v104, s[24:27], s99 offen offset:3072 sc1
s_mov_b32 s99, 65536
buffer_load_dwordx4 v[186:189], v104, s[24:27], s99 offen offset:0 sc1
buffer_load_dwordx4 v[190:193], v104, s[24:27], s99 offen offset:1024 sc1
buffer_load_dwordx4 v[194:197], v104, s[24:27], s99 offen offset:2048 sc1
buffer_load_dwordx4 v[198:201], v104, s[24:27], s99 offen offset:3072 sc1
s_mov_b32 s99, 69632
buffer_load_dwordx4 v[202:205], v104, s[24:27], s99 offen offset:0 sc1
buffer_load_dwordx4 v[206:209], v104, s[24:27], s99 offen offset:1024 sc1
buffer_load_dwordx4 v[210:213], v104, s[24:27], s99 offen offset:2048 sc1
buffer_load_dwordx4 v[214:217], v104, s[24:27], s99 offen offset:3072 sc1
s_mov_b32 s98, 8192
buffer_load_dwordx4 v[170:173], v105, s[24:27], s98 offen sc1
s_mov_b32 s99, 73728
buffer_load_dwordx4 v[218:221], v104, s[24:27], s99 offen offset:0 sc1
buffer_load_dwordx4 v[222:225], v104, s[24:27], s99 offen offset:1024 sc1
buffer_load_dwordx4 v[226:229], v104, s[24:27], s99 offen offset:2048 sc1
buffer_load_dwordx4 v[230:233], v104, s[24:27], s99 offen offset:3072 sc1
s_mov_b32 s99, 77824
buffer_load_dwordx4 v[234:237], v104, s[24:27], s99 offen offset:0 sc1
buffer_load_dwordx4 v[238:241], v104, s[24:27], s99 offen offset:1024 sc1
buffer_load_dwordx4 v[242:245], v104, s[24:27], s99 offen offset:2048 sc1
buffer_load_dwordx4 v[246:249], v104, s[24:27], s99 offen offset:3072 sc1
s_mov_b32 s99, 81920
buffer_load_dwordx4 v[250:253], v104, s[24:27], s99 offen offset:0 sc1
s_waitcnt vmcnt(0)
s_barrier
ds_read_b128 v[44:47], v0 offset:0
ds_read_b128 v[48:51], v1 offset:0
s_waitcnt lgkmcnt(0)
v_smfmac_f32_16x16x64_bf16 v[8:11], a[0:3], v[44:51], v138
v_smfmac_f32_16x16x64_bf16 v[12:15], a[4:7], v[44:51], v138 abid:1
v_smfmac_f32_16x16x64_bf16 v[16:19], a[8:11], v[44:51], v139
v_smfmac_f32_16x16x64_bf16 v[20:23], a[12:15], v[44:51], v139 abid:1
v_smfmac_f32_16x16x64_bf16 v[24:27], a[16:19], v[44:51], v140
v_smfmac_f32_16x16x64_bf16 v[28:31], a[20:23], v[44:51], v140 abid:1
v_smfmac_f32_16x16x64_bf16 v[32:35], a[24:27], v[44:51], v141
v_smfmac_f32_16x16x64_bf16 v[36:39], a[28:31], v[44:51], v141 abid:1
v_smfmac_f32_16x16x64_bf16 v[40:43], a[32:35], v[44:51], v174
s_nop 7
ds_read_b128 v[44:47], v0 offset:2048
ds_read_b128 v[48:51], v1 offset:2048
s_waitcnt lgkmcnt(0)
v_smfmac_f32_16x16x64_bf16 v[8:11], a[36:39], v[44:51], v142
v_smfmac_f32_16x16x64_bf16 v[12:15], a[40:43], v[44:51], v142 abid:1
v_smfmac_f32_16x16x64_bf16 v[16:19], a[44:47], v[44:51], v143
v_smfmac_f32_16x16x64_bf16 v[20:23], a[48:51], v[44:51], v143 abid:1
v_smfmac_f32_16x16x64_bf16 v[24:27], a[52:55], v[44:51], v144
v_smfmac_f32_16x16x64_bf16 v[28:31], a[56:59], v[44:51], v144 abid:1
v_smfmac_f32_16x16x64_bf16 v[32:35], a[60:63], v[44:51], v145
v_smfmac_f32_16x16x64_bf16 v[36:39], a[64:67], v[44:51], v145 abid:1
v_smfmac_f32_16x16x64_bf16 v[40:43], a[68:71], v[44:51], v174 abid:1
s_nop 7
ds_read_b128 v[44:47], v0 offset:4096
ds_read_b128 v[48:51], v1 offset:4096
s_waitcnt lgkmcnt(0)
v_smfmac_f32_16x16x64_bf16 v[8:11], a[72:75], v[44:51], v146
v_smfmac_f32_16x16x64_bf16 v[12:15], a[76:79], v[44:51], v146 abid:1
v_smfmac_f32_16x16x64_bf16 v[16:19], a[80:83], v[44:51], v147
v_smfmac_f32_16x16x64_bf16 v[20:23], a[84:87], v[44:51], v147 abid:1
v_smfmac_f32_16x16x64_bf16 v[24:27], a[88:91], v[44:51], v148
v_smfmac_f32_16x16x64_bf16 v[28:31], a[92:95], v[44:51], v148 abid:1
v_smfmac_f32_16x16x64_bf16 v[32:35], a[96:99], v[44:51], v149
v_smfmac_f32_16x16x64_bf16 v[36:39], a[100:103], v[44:51], v149 abid:1
v_smfmac_f32_16x16x64_bf16 v[40:43], a[104:107], v[44:51], v175
s_nop 7
ds_read_b128 v[44:47], v0 offset:6144
ds_read_b128 v[48:51], v1 offset:6144
s_waitcnt lgkmcnt(0)
v_smfmac_f32_16x16x64_bf16 v[8:11], a[108:111], v[44:51], v150
v_smfmac_f32_16x16x64_bf16 v[12:15], a[112:115], v[44:51], v150 abid:1
v_smfmac_f32_16x16x64_bf16 v[16:19], a[116:119], v[44:51], v151
v_smfmac_f32_16x16x64_bf16 v[20:23], a[120:123], v[44:51], v151 abid:1
v_smfmac_f32_16x16x64_bf16 v[24:27], a[124:127], v[44:51], v152
v_smfmac_f32_16x16x64_bf16 v[28:31], a[128:131], v[44:51], v152 abid:1
v_smfmac_f32_16x16x64_bf16 v[32:35], a[132:135], v[44:51], v153
v_smfmac_f32_16x16x64_bf16 v[36:39], a[136:139], v[44:51], v153 abid:1
v_smfmac_f32_16x16x64_bf16 v[40:43], a[140:143], v[44:51], v175 abid:1
s_nop 7
ds_read_b128 v[44:47], v0 offset:8192
ds_read_b128 v[48:51], v1 offset:8192
s_waitcnt lgkmcnt(0)
v_smfmac_f32_16x16x64_bf16 v[8:11], a[144:147], v[44:51], v154
v_smfmac_f32_16x16x64_bf16 v[12:15], a[148:151], v[44:51], v154 abid:1
v_smfmac_f32_16x16x64_bf16 v[16:19], a[152:155], v[44:51], v155
v_smfmac_f32_16x16x64_bf16 v[20:23], a[156:159], v[44:51], v155 abid:1
v_smfmac_f32_16x16x64_bf16 v[24:27], a[160:163], v[44:51], v156
v_smfmac_f32_16x16x64_bf16 v[28:31], a[164:167], v[44:51], v156 abid:1
v_smfmac_f32_16x16x64_bf16 v[32:35], a[168:171], v[44:51], v157
v_smfmac_f32_16x16x64_bf16 v[36:39], a[172:175], v[44:51], v157 abid:1
v_smfmac_f32_16x16x64_bf16 v[40:43], a[176:179], v[44:51], v176
s_nop 7
ds_read_b128 v[44:47], v0 offset:10240
ds_read_b128 v[48:51], v1 offset:10240
s_waitcnt lgkmcnt(0)
v_smfmac_f32_16x16x64_bf16 v[8:11], a[180:183], v[44:51], v158
v_smfmac_f32_16x16x64_bf16 v[12:15], a[184:187], v[44:51], v158 abid:1
v_smfmac_f32_16x16x64_bf16 v[16:19], a[188:191], v[44:51], v159
v_smfmac_f32_16x16x64_bf16 v[20:23], a[192:195], v[44:51], v159 abid:1
v_smfmac_f32_16x16x64_bf16 v[24:27], a[196:199], v[44:51], v160
v_smfmac_f32_16x16x64_bf16 v[28:31], a[200:203], v[44:51], v160 abid:1
v_smfmac_f32_16x16x64_bf16 v[32:35], a[204:207], v[44:51], v161
v_smfmac_f32_16x16x64_bf16 v[36:39], a[208:211], v[44:51], v161 abid:1
v_smfmac_f32_16x16x64_bf16 v[40:43], a[212:215], v[44:51], v176 abid:1
s_nop 7
ds_read_b128 v[44:47], v0 offset:12288
ds_read_b128 v[48:51], v1 offset:12288
s_waitcnt lgkmcnt(0)
v_smfmac_f32_16x16x64_bf16 v[8:11], a[216:219], v[44:51], v162
v_smfmac_f32_16x16x64_bf16 v[12:15], a[220:223], v[44:51], v162 abid:1
v_smfmac_f32_16x16x64_bf16 v[16:19], a[224:227], v[44:51], v163
v_smfmac_f32_16x16x64_bf16 v[20:23], a[228:231], v[44:51], v163 abid:1
v_smfmac_f32_16x16x64_bf16 v[24:27], a[232:235], v[44:51], v164
v_smfmac_f32_16x16x64_bf16 v[28:31], a[236:239], v[44:51], v164 abid:1
v_smfmac_f32_16x16x64_bf16 v[32:35], a[240:243], v[44:51], v165
v_smfmac_f32_16x16x64_bf16 v[36:39], a[244:247], v[44:51], v165 abid:1
v_smfmac_f32_16x16x64_bf16 v[40:43], a[248:251], v[44:51], v177
s_nop 7
ds_read_b128 v[44:47], v0 offset:14336
ds_read_b128 v[48:51], v1 offset:14336
s_waitcnt lgkmcnt(0)
v_smfmac_f32_16x16x64_bf16 v[8:11], a[252:255], v[44:51], v166
v_smfmac_f32_16x16x64_bf16 v[12:15], v[186:189], v[44:51], v166 abid:1
v_smfmac_f32_16x16x64_bf16 v[16:19], v[190:193], v[44:51], v167
v_smfmac_f32_16x16x64_bf16 v[20:23], v[194:197], v[44:51], v167 abid:1
v_smfmac_f32_16x16x64_bf16 v[24:27], v[198:201], v[44:51], v168
v_smfmac_f32_16x16x64_bf16 v[28:31], v[202:205], v[44:51], v168 abid:1
v_smfmac_f32_16x16x64_bf16 v[32:35], v[206:209], v[44:51], v169
v_smfmac_f32_16x16x64_bf16 v[36:39], v[210:213], v[44:51], v169 abid:1
v_smfmac_f32_16x16x64_bf16 v[40:43], v[214:217], v[44:51], v177 abid:1
s_nop 7
ds_read_b128 v[44:47], v0 offset:16384
ds_read_b128 v[48:51], v1 offset:16384
s_waitcnt lgkmcnt(0)
v_smfmac_f32_16x16x64_bf16 v[8:11], v[218:221], v[44:51], v170
v_smfmac_f32_16x16x64_bf16 v[12:15], v[222:225], v[44:51], v170 abid:1
v_smfmac_f32_16x16x64_bf16 v[16:19], v[226:229], v[44:51], v171
v_smfmac_f32_16x16x64_bf16 v[20:23], v[230:233], v[44:51], v171 abid:1
v_smfmac_f32_16x16x64_bf16 v[24:27], v[234:237], v[44:51], v172
v_smfmac_f32_16x16x64_bf16 v[28:31], v[238:241], v[44:51], v172 abid:1
v_smfmac_f32_16x16x64_bf16 v[32:35], v[242:245], v[44:51], v173
v_smfmac_f32_16x16x64_bf16 v[36:39], v[246:249], v[44:51], v173 abid:1
v_smfmac_f32_16x16x64_bf16 v[40:43], v[250:253], v[44:51], v178
s_nop 7
s_add_u32 s87, s87, 1
s_cmp_lt_u32 s87, 2
s_cbranch_scc1 L_spass
v_cvt_pk_bf16_f32 v92, v8, v9
v_cvt_pk_bf16_f32 v93, v10, v11
v_cvt_pk_bf16_f32 v94, v12, v13
v_cvt_pk_bf16_f32 v95, v14, v15
v_cvt_pk_bf16_f32 v96, v16, v17
v_cvt_pk_bf16_f32 v97, v18, v19
v_cvt_pk_bf16_f32 v98, v20, v21
v_cvt_pk_bf16_f32 v99, v22, v23
v_cvt_pk_bf16_f32 v100, v24, v25
v_cvt_pk_bf16_f32 v101, v26, v27
v_cvt_pk_bf16_f32 v102, v28, v29
v_cvt_pk_bf16_f32 v103, v30, v31
v_cvt_pk_bf16_f32 v104, v32, v33
v_cvt_pk_bf16_f32 v105, v34, v35
s_mov_b64 vcc, s[80:81]
s_nop 0
v_cndmask_b32_dpp v108, v96, v92, vcc quad_perm:[1,0,3,2] row_mask:0xf bank_mask:0xf
v_cndmask_b32_dpp v109, v97, v93, vcc quad_perm:[1,0,3,2] row_mask:0xf bank_mask:0xf
v_cndmask_b32_dpp v110, v98, v94, vcc quad_perm:[1,0,3,2] row_mask:0xf bank_mask:0xf
v_cndmask_b32_dpp v111, v99, v95, vcc quad_perm:[1,0,3,2] row_mask:0xf bank_mask:0xf
buffer_store_dwordx4 v[108:111], v4, s[20:23], s46 offen offset:0 sc1
s_mov_b64 vcc, s[82:83]
v_cvt_pk_bf16_f32 v112, v40, v41
v_cvt_pk_bf16_f32 v113, v42, v43
ds_bpermute_b32 v112, v6, v112
ds_bpermute_b32 v113, v6, v113
v_cndmask_b32_dpp v96, v92, v96, vcc quad_perm:[1,0,3,2] row_mask:0xf bank_mask:0xf
v_cndmask_b32_dpp v97, v93, v97, vcc quad_perm:[1,0,3,2] row_mask:0xf bank_mask:0xf
v_cndmask_b32_dpp v98, v94, v98, vcc quad_perm:[1,0,3,2] row_mask:0xf bank_mask:0xf
v_cndmask_b32_dpp v99, v95, v99, vcc quad_perm:[1,0,3,2] row_mask:0xf bank_mask:0xf
buffer_store_dwordx4 v[96:99], v4, s[20:23], s46 offen offset:1152 sc1
s_mov_b64 vcc, s[80:81]
v_cvt_pk_bf16_f32 v106, v36, v37
v_cvt_pk_bf16_f32 v107, v38, v39
v_cndmask_b32_dpp v92, v104, v100, vcc quad_perm:[1,0,3,2] row_mask:0xf bank_mask:0xf
v_cndmask_b32_dpp v93, v105, v101, vcc quad_perm:[1,0,3,2] row_mask:0xf bank_mask:0xf
v_cndmask_b32_dpp v94, v106, v102, vcc quad_perm:[1,0,3,2] row_mask:0xf bank_mask:0xf
v_cndmask_b32_dpp v95, v107, v103, vcc quad_perm:[1,0,3,2] row_mask:0xf bank_mask:0xf
buffer_store_dwordx4 v[92:95], v4, s[20:23], s46 offen offset:128 sc1
s_mov_b64 vcc, s[82:83]
v_cndmask_b32_dpp v104, v100, v104, vcc quad_perm:[1,0,3,2] row_mask:0xf bank_mask:0xf
v_cndmask_b32_dpp v105, v101, v105, vcc quad_perm:[1,0,3,2] row_mask:0xf bank_mask:0xf
v_cndmask_b32_dpp v106, v102, v106, vcc quad_perm:[1,0,3,2] row_mask:0xf bank_mask:0xf
v_cndmask_b32_dpp v107, v103, v107, vcc quad_perm:[1,0,3,2] row_mask:0xf bank_mask:0xf
buffer_store_dwordx4 v[104:107], v4, s[20:23], s46 offen offset:1280 sc1
s_mov_b64 vcc, s[80:81]
s_waitcnt lgkmcnt(0)
buffer_store_dwordx2 v[112:113], v5, s[20:23], s46 offen
s_add_u32 s45, s45, s13
s_add_u32 s7, s7, s13
s_add_u32 s46, s46, s13
s_mov_b32 s13, 4718592
s_add_u32 s41, s41, 1
s_cmp_lt_u32 s41, s15
s_cbranch_scc1 L_stile
s_branch L_fin
.section .rodata,"a"
.p2align 6
.amdhsa_kernel standalone__structured_sparse_n_m__ragged_kernel
  .amdhsa_next_free_vgpr 512
  .amdhsa_next_free_sgpr 102
  .amdhsa_accum_offset 256
  .amdhsa_group_segment_fixed_size 0
  .amdhsa_float_denorm_mode_32 3
  .amdhsa_kernarg_size 48
  .amdhsa_user_sgpr_count 2
  .amdhsa_user_sgpr_kernarg_segment_ptr 1
  .amdhsa_system_sgpr_workgroup_id_x 1
.end_amdhsa_kernel
```

```asm
; @launch grid=(256,1,1) block=(256,1,1) lds=163840
.amdgcn_target "amdgcn-amd-amdhsa--gfx950"
.text
.globl standalone__structured_sparse_n_m__ragged_kernel
.p2align 8
.type standalone__structured_sparse_n_m__ragged_kernel,@function
standalone__structured_sparse_n_m__ragged_kernel:
s_load_dwordx8 s[4:11], s[0:1], 0
s_load_dwordx4 s[12:15], s[0:1], 32
s_cmp_ge_u32 s2, 256
s_cbranch_scc1 L_end_standalone__structured_sparse_n_m__ragged_kernel
v_lshlrev_b32 v3, 7, v0
s_getpc_b64 s[96:97]
v_min_u32 v2, L_slow-standalone__structured_sparse_n_m__ragged_kernel, v3
global_load_dword v120, v2, s[96:97]
v_lshrrev_b32 v1, 6, v0
v_and_b32 v7, 63, v0
v_readfirstlane_b32 s40, v1
s_mov_b32 s86, 0
s_lshr_b32 s84, s2, 6
s_and_b32 s47, s2, 9
s_lshl1_add_u32 s84, s84, s47
s_bfe_u32 s3, s2, 0x20004
s_lshl2_add_u32 s84, s84, s3
s_and_b32 s47, s2, 7
s_cmp_lt_u32 s47, 2
s_cselect_b32 s84, s84, 63
s_cmp_lt_u32 s84, 41
s_cbranch_scc1 L_prod
s_mov_b32 s85, 0x800020
s_mov_b32 s47, 0x800020
s_bitcmp1_b32 s2, 3
s_cselect_b32 s85, s85, 0x230003c
s_cselect_b32 s47, s47, 0x230003c
s_bitcmp1_b32 s2, 6
s_cselect_b32 s85, s47, s85
v_lshrrev_b32 v72, 3, v7
v_and_b32 v73, 7, v7
v_xor_b32 v73, v73, v72
v_mul_u32_u24 v72, 1152, v72
s_and_b32 s47, s40, 1
s_mul_i32 s47, s47, 9216
s_lshr_b32 s3, s40, 1
s_lshl_b32 s3, s3, 7
s_add_u32 s47, s47, s3
v_lshl_add_u32 v72, v73, 4, v72
v_add_u32 v3, s47, v72
s_lshl_b32 s44, s40, 10
s_mul_i32 s45, s2, 18432
s_mov_b32 s46, s45
s_waitcnt lgkmcnt(0)
s_mov_b32 s30, 663552
s_mov_b32 s31, 0x20000
s_mov_b32 s28, s6
s_and_b32 s29, s7, 0xffff
s_mov_b32 s18, 75497472
s_mov_b32 s19, 0x20000
s_mov_b32 s16, s4
s_and_b32 s17, s5, 0xffff
s_mov_b32 s26, 301989888
s_mov_b32 s27, 0x20000
s_mov_b32 s24, s14
s_and_b32 s25, s15, 0xffff
s_mov_b32 s34, 1152
s_mov_b32 s35, 0x20000
s_mov_b32 s32, s8
s_and_b32 s33, s9, 0xffff
s_mov_b32 s22, 0
s_mov_b32 s23, 0x20000
s_mov_b32 s20, s10
s_and_b32 s21, s11, 0xffff
s_mov_b32 s38, 256
s_mov_b32 s39, 0x20000
s_mov_b32 s36, s12
s_and_b32 s37, s13, 0xffff
s_cmp_lg_u32 s2, 200
s_cbranch_scc1 L_cons3
v_lshlrev_b32 v8, 4, v0
v_mov_b64 v[12:13], 0
v_mov_b64 v[14:15], 0
buffer_store_dwordx4 v[12:15], v8, s[36:39], 0 offen sc1
v_add_u32 v8, 458752, v8
v_add_u32 v9, 4096, v8
buffer_store_dwordx4 v[12:15], v8, s[24:27], 0 offen sc1
buffer_store_dwordx4 v[12:15], v9, s[24:27], 0 offen sc1
v_mov_b32 v10, 1
v_lshlrev_b32 v11, 2, v0
s_waitcnt vmcnt(0)
s_barrier
s_mov_b32 exec_hi, 0
buffer_store_dword v10, v11, s[36:39], 0 offen sc1
s_mov_b64 exec, -1
L_cons3:
s_lshr_b32 s47, s40, 1
s_lshl_b32 s3, s47, 11
s_sub_u32 s8, 15488, s3
s_lshl_b32 s3, s47, 7
s_add_u32 s7, s45, 128
s_sub_u32 s7, s7, s3
s_sub_u32 s10, s47, 1
s_sub_u32 s11, 0, s47
s_mov_b32 s9, s44
s_mov_b32 s13, 4718592
s_mov_b32 s15, 16
s_mov_b32 s14, s13
v_and_b32 v80, 3, v7
v_bfe_u32 v81, v7, 2, 2
v_bfe_u32 v82, v7, 4, 1
v_lshlrev_b32 v81, 3, v81
v_lshl_add_u32 v81, v80, 5, v81
v_lshl_add_u32 v81, v82, 7, v81
s_lshl_b32 s47, s40, 8
v_add_u32 v81, s47, v81
s_lshl_b32 s47, s40, 5
s_add_u32 s47, s47, 1024
v_lshl_add_u32 v80, v80, 3, s47
v_cmp_gt_u32 vcc, 32, v7
s_nop 1
v_cndmask_b32 v80, v80, v81, vcc
buffer_load_dwordx2 v[110:111], v80, s[32:35], 0 offen
s_waitcnt vmcnt(0)
L_pf0:
s_bfe_u32 s88, s85, 0x40014
s_mov_b32 s3, 55680
s_cmp_ge_u32 s88, 6
s_cselect_b32 s3, s3, 0
s_cmp_ge_u32 s84, 41
s_cselect_b32 s3, s3, 0
L_pf:
s_add_u32 m0, s44, 0
s_nop 0
buffer_load_dwordx4 v3, s[16:19], s45 offen offset:0 nt lds
s_add_u32 m0, s44, 3840
s_nop 0
buffer_load_dwordx4 v3, s[16:19], s45 offen offset:256 nt lds
s_add_u32 m0, s44, 7680
s_nop 0
buffer_load_dwordx4 v3, s[16:19], s45 offen offset:512 nt lds
s_add_u32 m0, s44, 11520
s_nop 0
buffer_load_dwordx4 v3, s[16:19], s45 offen offset:768 nt lds
s_add_u32 m0, s44, s8
s_mov_b64 exec, s[10:11]
buffer_load_dwordx4 v3, s[16:19], s7 offen offset:896 nt lds
s_mov_b64 exec, -1
s_cmp_lg_u32 s44, 37120
s_cbranch_scc1 L_pf_f
s_mov_b64 exec, 1
buffer_load_dword v124, off, s[36:39], 0 sc1
s_mov_b64 exec, -1
L_pf_f:
s_cmp_ge_u32 s44, s3
s_cbranch_scc1 L_pf_n
s_waitcnt vmcnt(1)
L_pf_n:
s_add_u32 s7, s7, s13
s_add_u32 s44, s44, 18560
s_add_u32 s45, s45, s13
s_mov_b32 s13, 4718592
s_sub_u32 s88, s88, 1
s_cmp_lg_u32 s88, 0
s_cbranch_scc1 L_pf
L_pf_e:
s_branch L_rest
L_prod:
s_and_b32 s48, s84, 3
s_lshr_b32 s49, s84, 2
s_sub_u32 s50, s84, 36
s_lshl_b32 s51, s40, 4
s_lshl_b32 s52, s50, 1
s_lshl_b32 s53, s48, 8
s_cmp_lt_u32 s84, 36
s_cselect_b32 s52, s49, s52
s_cselect_b32 s53, s53, 1024
s_cselect_b32 s54, 8, 73728
s_cselect_b32 s55, 32, 8
s_cselect_b32 s56, 16, 32
s_cselect_b32 s57, 128, 64
s_mul_i32 s52, s52, 73728
s_mul_i32 s58, s40, 18432
v_and_b32 v58, 1, v7
v_bfe_u32 v59, v7, 1, 1
v_bfe_u32 v60, v7, 2, 2
v_bfe_u32 v62, v7, 4, 1
v_lshrrev_b32 v63, 5, v7
v_lshl_add_u32 v50, v58, 2, s52
v_mad_u32_u24 v50, v59, s54, v50
v_mad_u32_u24 v50, v60, s55, v50
v_mad_u32_u24 v50, v62, s56, v50
v_mad_u32_u24 v50, v63, s57, v50
v_add_u32 v50, s53, v50
v_add_u32 v50, s58, v50
v_add_u32 v62, 4608, v50
v_add_u32 v63, 9216, v50
v_add_u32 v64, 13824, v50
s_waitcnt lgkmcnt(0)
s_mov_b32 s30, 663552
s_mov_b32 s31, 0x20000
s_mov_b32 s28, s6
s_and_b32 s29, s7, 0xffff
buffer_load_dword v8, v50, s[28:31], 0 offen offset:0 nt
buffer_load_dword v9, v50, s[28:31], 0 offen offset:1152 nt
buffer_load_dword v10, v50, s[28:31], 0 offen offset:2304 nt
buffer_load_dword v11, v50, s[28:31], 0 offen offset:3456 nt
buffer_load_dword v12, v62, s[28:31], 0 offen offset:0 nt
buffer_load_dword v13, v62, s[28:31], 0 offen offset:1152 nt
buffer_load_dword v14, v62, s[28:31], 0 offen offset:2304 nt
buffer_load_dword v15, v62, s[28:31], 0 offen offset:3456 nt
buffer_load_dword v16, v63, s[28:31], 0 offen offset:0 nt
buffer_load_dword v17, v63, s[28:31], 0 offen offset:1152 nt
buffer_load_dword v18, v63, s[28:31], 0 offen offset:2304 nt
buffer_load_dword v19, v63, s[28:31], 0 offen offset:3456 nt
buffer_load_dword v20, v64, s[28:31], 0 offen offset:0 nt
buffer_load_dword v21, v64, s[28:31], 0 offen offset:1152 nt
buffer_load_dword v22, v64, s[28:31], 0 offen offset:2304 nt
buffer_load_dword v23, v64, s[28:31], 0 offen offset:3456 nt
s_mov_b32 s18, 75497472
s_mov_b32 s19, 0x20000
s_mov_b32 s16, s4
s_and_b32 s17, s5, 0xffff
s_mov_b32 s26, 301989888
s_mov_b32 s27, 0x20000
s_mov_b32 s24, s14
s_and_b32 s25, s15, 0xffff
s_mov_b32 s34, 1152
s_mov_b32 s35, 0x20000
s_mov_b32 s32, s8
s_and_b32 s33, s9, 0xffff
s_mov_b32 s22, 0
s_mov_b32 s23, 0x20000
s_mov_b32 s20, s10
s_and_b32 s21, s11, 0xffff
s_mov_b32 s38, 256
s_mov_b32 s39, 0x20000
s_mov_b32 s36, s12
s_and_b32 s37, s13, 0xffff
s_mul_i32 s52, s48, 9
s_add_u32 s52, s52, s49
s_mul_i32 s53, s52, 9
s_mul_i32 s54, s50, 18
s_add_u32 s54, s54, 8
s_lshl_b32 s55, s52, 2
s_add_u32 s55, s55, s40
s_lshl_b32 s56, s50, 2
s_add_u32 s56, s56, s40
s_cmp_eq_u32 s84, 40
s_cselect_b32 s57, 0x100000, 9
s_cmp_lt_u32 s84, 36
s_cselect_b32 s53, s53, s54
s_cselect_b32 s54, 2, 81
s_cselect_b32 s57, 1, s57
s_cselect_b32 s55, s55, s56
s_mov_b32 s56, 331776
s_cselect_b32 s56, s56, 368640
s_mov_b32 s58, 373760
s_cselect_b32 s58, s58, 382976
s_cselect_b32 s59, 16, 4
s_cselect_b32 s60, 4, 64
s_cselect_b32 s61, 12, 11
s_cselect_b32 s62, 1, 0x8001
v_lshrrev_b32 v61, 4, v7
v_lshlrev_b32 v62, 1, v58
v_lshl_add_u32 v60, v60, 2, v62
v_add_u32 v62, v60, v59
v_mul_u32_u24 v51, s54, v61
v_add_lshl_u32 v51, v51, s53, 6
v_add3_u32 v51, v51, v62, s51
v_lshl_add_u32 v51, v51, 4, s86
s_lshl_b32 s57, s57, 10
v_add_u32 v66, s57, v51
s_lshl_b32 s52, s55, 8
s_add_u32 s52, s52, s56
s_add_u32 s52, s52, s86
v_mul_u32_u24 v52, s59, v62
v_mad_u32_u24 v52, v61, s60, v52
v_lshl_add_u32 v54, v7, 2, s52
s_lshr_b32 s52, s55, 2
s_lshl_b32 s52, s52, 8
s_add_u32 s58, s58, s52
s_lshl2_add_u32 s58, s51, s58
s_lshl_b32 s52, s51, 1
s_add_u32 s52, s52, s62
v_lshl_add_u32 v62, v61, 1, v59
v_lshlrev_b32 v62, s61, v62
v_lshl_add_u32 v53, v60, 7, v62
v_add_u32 v53, s52, v53
v_and_b32 v62, 12, v7
v_and_b32 v63, 15, v7
v_mad_u32_u24 v62, v62, 3, v63
v_lshl_add_u32 v62, v62, 2, s51
v_mov_b32 v67, 0
ds_write_b32 v62, v67
s_lshl2_add_u32 s52, s84, s40
s_lshl_b32 s52, s52, 7
s_add_u32 s52, s52, 393152
v_lshl_add_u32 v65, v7, 2, s58
v_lshl_add_u32 v62, v7, 2, s52
v_cmp_gt_u32 vcc, 16, v7
s_lshl_b32 s52, s51, 2
v_lshl_add_u32 v57, v7, 2, s52
v_cndmask_b32 v65, v62, v65, vcc
s_mov_b32 s75, 0
s_mov_b32 s73, 0x05060100
s_mov_b32 s74, 0xffff
v_mov_b32 v55, 0x05040100
v_mov_b32 v62, 0x03020706
v_cmp_eq_u32 vcc, 1, v59
v_mov_b32 v68, 0xf0a0500
v_mov_b32 v69, 0x8f8a8580
v_mov_b32 v70, 0x1f1a1510
v_mov_b32 v71, 0x9f9a9590
v_mov_b32 v72, 0x2f2a2520
v_mov_b32 v73, 0xafaaa5a0
v_mov_b32 v74, 0x3f3a3530
v_mov_b32 v75, 0xbfbab5b0
v_cndmask_b32 v55, v55, v62, vcc
v_mov_b64 v[76:77], 0
v_mov_b64 v[78:79], 0
v_mov_b64 v[80:81], 0
v_mov_b32 v82, 0
s_mov_b32 s64, 0x5040500
s_mov_b32 s65, 0x5040501
s_mov_b32 s66, 0x5040502
s_mov_b32 s67, 0x5040503
s_mov_b32 s68, 0x7060700
s_mov_b32 s69, 0x7060701
s_mov_b32 s70, 0x7060702
s_mov_b32 s71, 0x7060703
s_mov_b32 s72, 0x05060102
s_waitcnt vmcnt(12)
v_perm_b32 v24, v8, v68, s64
v_perm_b32 v25, v9, v68, s65
v_perm_b32 v26, v10, v68, s66
v_perm_b32 v27, v11, v68, s67
v_max3_f32 v28, |v24|, |v25|, |v26|
v_med3_f32 v29, |v24|, |v25|, |v26|
v_min3_f32 v30, |v24|, |v25|, |v26|
v_med3_f32 v32, v28, v29, |v27|
v_med3_f32 v33, v29, v30, |v27|
v_max_f32 v31, v28, |v27|
v_perm_b32 v36, v31, v32, s72
v_bfi_b32 v44, 3, v32, v31
v_cmpx_eq_u32_sdwa vcc, v33, v32 src0_sel:WORD_1 src1_sel:WORD_1
v_mov_b32 v76, v33
v_min_f32 v77, v30, |v27|
s_mov_b64 exec, -1
v_perm_b32 v24, v8, v69, s68
v_perm_b32 v25, v9, v69, s69
v_perm_b32 v26, v10, v69, s70
v_perm_b32 v27, v11, v69, s71
v_max3_f32 v28, |v24|, |v25|, |v26|
v_med3_f32 v29, |v24|, |v25|, |v26|
v_min3_f32 v30, |v24|, |v25|, |v26|
v_med3_f32 v32, v28, v29, |v27|
v_med3_f32 v33, v29, v30, |v27|
v_max_f32 v31, v28, |v27|
v_perm_b32 v40, v31, v32, s72
v_bfi_b32 v46, 3, v32, v31
v_cmpx_eq_u32_sdwa vcc, v33, v32 src0_sel:WORD_1 src1_sel:WORD_1
v_mov_b64 v[78:79], v[76:77]
v_mov_b32 v76, v33
v_min_f32 v77, v30, |v27|
s_mov_b64 exec, -1
s_waitcnt vmcnt(8)
v_perm_b32 v24, v12, v70, s64
v_perm_b32 v25, v13, v70, s65
v_perm_b32 v26, v14, v70, s66
v_perm_b32 v27, v15, v70, s67
v_max3_f32 v28, |v24|, |v25|, |v26|
v_med3_f32 v29, |v24|, |v25|, |v26|
v_min3_f32 v30, |v24|, |v25|, |v26|
v_med3_f32 v32, v28, v29, |v27|
v_med3_f32 v33, v29, v30, |v27|
v_max_f32 v31, v28, |v27|
v_perm_b32 v37, v31, v32, s72
v_bfi_b32 v31, 3, v32, v31
v_lshlrev_b32 v31, 4, v31
v_bfi_b32 v44, 15, v44, v31
v_cmpx_eq_u32_sdwa vcc, v33, v32 src0_sel:WORD_1 src1_sel:WORD_1
v_mov_b64 v[80:81], v[78:79]
v_mov_b64 v[78:79], v[76:77]
v_mov_b32 v76, v33
v_min_f32 v77, v30, |v27|
s_mov_b64 exec, -1
v_perm_b32 v24, v12, v71, s68
v_perm_b32 v25, v13, v71, s69
v_perm_b32 v26, v14, v71, s70
v_perm_b32 v27, v15, v71, s71
v_max3_f32 v28, |v24|, |v25|, |v26|
v_med3_f32 v29, |v24|, |v25|, |v26|
v_min3_f32 v30, |v24|, |v25|, |v26|
v_med3_f32 v32, v28, v29, |v27|
v_med3_f32 v33, v29, v30, |v27|
v_max_f32 v31, v28, |v27|
v_perm_b32 v41, v31, v32, s72
v_bfi_b32 v31, 3, v32, v31
v_lshlrev_b32 v31, 4, v31
v_bfi_b32 v46, 15, v46, v31
v_cmpx_eq_u32_sdwa vcc, v33, v32 src0_sel:WORD_1 src1_sel:WORD_1
v_or_b32 v82, v82, v80
v_mov_b64 v[80:81], v[78:79]
v_mov_b64 v[78:79], v[76:77]
v_mov_b32 v76, v33
v_min_f32 v77, v30, |v27|
s_mov_b64 exec, -1
s_waitcnt vmcnt(4)
v_perm_b32 v24, v16, v72, s64
v_perm_b32 v25, v17, v72, s65
v_perm_b32 v26, v18, v72, s66
v_perm_b32 v27, v19, v72, s67
v_max3_f32 v28, |v24|, |v25|, |v26|
v_med3_f32 v29, |v24|, |v25|, |v26|
v_min3_f32 v30, |v24|, |v25|, |v26|
v_med3_f32 v32, v28, v29, |v27|
v_med3_f32 v33, v29, v30, |v27|
v_max_f32 v31, v28, |v27|
v_perm_b32 v38, v31, v32, s72
v_bfi_b32 v45, 3, v32, v31
v_cmpx_eq_u32_sdwa vcc, v33, v32 src0_sel:WORD_1 src1_sel:WORD_1
v_or_b32 v82, v82, v80
v_mov_b64 v[80:81], v[78:79]
v_mov_b64 v[78:79], v[76:77]
v_mov_b32 v76, v33
v_min_f32 v77, v30, |v27|
s_mov_b64 exec, -1
v_perm_b32 v24, v16, v73, s68
v_perm_b32 v25, v17, v73, s69
v_perm_b32 v26, v18, v73, s70
v_perm_b32 v27, v19, v73, s71
v_max3_f32 v28, |v24|, |v25|, |v26|
v_med3_f32 v29, |v24|, |v25|, |v26|
v_min3_f32 v30, |v24|, |v25|, |v26|
v_med3_f32 v32, v28, v29, |v27|
v_med3_f32 v33, v29, v30, |v27|
v_max_f32 v31, v28, |v27|
v_perm_b32 v42, v31, v32, s72
v_bfi_b32 v47, 3, v32, v31
v_cmpx_eq_u32_sdwa vcc, v33, v32 src0_sel:WORD_1 src1_sel:WORD_1
v_or_b32 v82, v82, v80
v_mov_b64 v[80:81], v[78:79]
v_mov_b64 v[78:79], v[76:77]
v_mov_b32 v76, v33
v_min_f32 v77, v30, |v27|
s_mov_b64 exec, -1
s_waitcnt vmcnt(0)
v_perm_b32 v24, v20, v74, s64
v_perm_b32 v25, v21, v74, s65
v_perm_b32 v26, v22, v74, s66
v_perm_b32 v27, v23, v74, s67
v_max3_f32 v28, |v24|, |v25|, |v26|
v_med3_f32 v29, |v24|, |v25|, |v26|
v_min3_f32 v30, |v24|, |v25|, |v26|
v_med3_f32 v32, v28, v29, |v27|
v_med3_f32 v33, v29, v30, |v27|
v_max_f32 v31, v28, |v27|
v_perm_b32 v39, v31, v32, s72
v_bfi_b32 v31, 3, v32, v31
v_lshlrev_b32 v31, 4, v31
v_bfi_b32 v45, 15, v45, v31
v_cmpx_eq_u32_sdwa vcc, v33, v32 src0_sel:WORD_1 src1_sel:WORD_1
v_or_b32 v82, v82, v80
v_mov_b64 v[80:81], v[78:79]
v_mov_b64 v[78:79], v[76:77]
v_mov_b32 v76, v33
v_min_f32 v77, v30, |v27|
s_mov_b64 exec, -1
v_perm_b32 v24, v20, v75, s68
v_perm_b32 v25, v21, v75, s69
v_perm_b32 v26, v22, v75, s70
v_perm_b32 v27, v23, v75, s71
v_max3_f32 v28, |v24|, |v25|, |v26|
v_med3_f32 v29, |v24|, |v25|, |v26|
v_min3_f32 v30, |v24|, |v25|, |v26|
v_med3_f32 v32, v28, v29, |v27|
v_med3_f32 v33, v29, v30, |v27|
v_max_f32 v31, v28, |v27|
v_perm_b32 v43, v31, v32, s72
v_bfi_b32 v31, 3, v32, v31
v_lshlrev_b32 v31, 4, v31
v_bfi_b32 v47, 15, v47, v31
v_cmpx_eq_u32_sdwa vcc, v33, v32 src0_sel:WORD_1 src1_sel:WORD_1
v_or_b32 v82, v82, v80
v_mov_b64 v[80:81], v[78:79]
v_mov_b64 v[78:79], v[76:77]
v_mov_b32 v76, v33
v_min_f32 v77, v30, |v27|
s_mov_b64 exec, -1
s_mov_b32 vcc_lo, 0x33333333
s_mov_b32 vcc_hi, 0x33333333
v_cndmask_b32_dpp v24, v40, v36, vcc quad_perm:[2,3,0,1] row_mask:0xf bank_mask:0xf
v_cndmask_b32_dpp v25, v41, v37, vcc quad_perm:[2,3,0,1] row_mask:0xf bank_mask:0xf
v_cndmask_b32_dpp v26, v42, v38, vcc quad_perm:[2,3,0,1] row_mask:0xf bank_mask:0xf
v_cndmask_b32_dpp v27, v43, v39, vcc quad_perm:[2,3,0,1] row_mask:0xf bank_mask:0xf
s_not_b64 vcc, vcc
buffer_store_dwordx4 v[24:27], v51, s[24:27], 0 offen sc1
v_cndmask_b32_dpp v40, v36, v40, vcc quad_perm:[2,3,0,1] row_mask:0xf bank_mask:0xf
v_cndmask_b32_dpp v41, v37, v41, vcc quad_perm:[2,3,0,1] row_mask:0xf bank_mask:0xf
v_cndmask_b32_dpp v42, v38, v42, vcc quad_perm:[2,3,0,1] row_mask:0xf bank_mask:0xf
v_cndmask_b32_dpp v43, v39, v43, vcc quad_perm:[2,3,0,1] row_mask:0xf bank_mask:0xf
s_mov_b32 s52, 0x0c0c0400
s_mov_b32 s53, 0x04000c0c
buffer_store_dwordx4 v[40:43], v66, s[24:27], 0 offen sc1
v_perm_b32 v48, v45, v44, s52
v_perm_b32 v49, v47, v46, s53
v_or_b32 v48, v48, v49
s_nop 1
v_mov_b32_dpp v49, v48 quad_perm:[2,3,0,1] row_mask:0xf bank_mask:0xf
v_perm_b32 v48, v49, v48, v55
ds_permute_b32 v48, v52, v48
v_cmp_lt_u32 s[54:55], s74, v82
L_emit:
v_cmp_lt_u32 vcc, s74, v76
v_cmp_eq_u32_sdwa s[48:49], v77, v76 src0_sel:WORD_1 src1_sel:WORD_1
v_perm_b32 v63, v76, v53, s73
v_bfe_u32 v62, v76, 2, 4
v_and_b32 v64, 0x80, v76
v_lshl_add_u32 v63, v62, 1, v63
v_mbcnt_lo_u32_b32 v62, vcc_lo, 0
v_mbcnt_hi_u32_b32 v62, vcc_hi, v62
v_add_u32 v63, v64, v63
v_add_u32 v62, s75, v62
s_bcnt1_i32_b64 s52, vcc
s_add_u32 s75, s75, s52
v_cmp_gt_u32 s[52:53], 15, v62
v_and_b32 v64, 12, v62
v_mad_u32_u24 v62, v64, 3, v62
v_lshl_add_u32 v62, v62, 2, s51
s_and_b64 s[48:49], s[48:49], vcc
s_and_b64 exec, s[52:53], vcc
ds_write_b32 v62, v63
s_mov_b64 exec, s[48:49]
v_mov_b32 v76, v77
v_mov_b32 v77, 0
s_not_b64 exec, exec
v_mov_b64 v[76:77], v[78:79]
v_mov_b64 v[78:79], v[80:81]
v_mov_b64 v[80:81], 0
s_mov_b64 exec, -1
v_or3_b32 v62, v76, v78, v80
v_cmp_lt_u32 vcc, s74, v62
s_cmp_lg_u64 s[54:55], 0
s_cselect_b32 s52, 99, s75
s_cmp_gt_u32 s52, 15
s_cselect_b32 s52, -1, 0
v_mov_b32 v63, s51
s_cbranch_vccnz L_emit
v_mov_b32 v62, s52
ds_write_b32 v63, v62 offset:204
v_lshlrev_b32 v11, 4, v63
s_waitcnt lgkmcnt(0)
s_barrier
s_mov_b64 exec, 0xffff
ds_read_b32 v67, v57
s_mov_b64 exec, -1
buffer_store_dword v48, v54, s[24:27], 0 offen sc1
s_mov_b32 exec_hi, 0xffff
s_waitcnt lgkmcnt(0)
buffer_store_dword v67, v65, s[24:27], 0 offen sc1
s_mov_b64 exec, 1
buffer_load_dword v8, v11, s[36:39], 0 offen sc1
s_mov_b64 exec, -1
s_lshl_b32 s52, s84, 7
s_add_u32 s52, s52, 458752
v_lshl_add_u32 v9, v7, 2, s52
v_mov_b32 v10, 1
s_waitcnt vmcnt(0)
s_mov_b32 s85, 0x230003c
s_barrier
s_cmp_lg_u32 s40, 0
s_cbranch_scc1 L_cons2
v_readfirstlane_b32 s47, v8
s_mov_b64 exec, 0xffff
s_cmp_lg_u32 s47, 1
s_cbranch_scc1 L_pwait
L_pset:
buffer_store_dword v10, v9, s[24:27], 0 offen sc1
L_notlast:
s_mov_b64 exec, -1
L_cons2:
v_lshrrev_b32 v72, 3, v7
v_and_b32 v73, 7, v7
v_xor_b32 v73, v73, v72
v_mul_u32_u24 v72, 1152, v72
s_and_b32 s47, s40, 1
s_mul_i32 s47, s47, 9216
s_lshr_b32 s3, s40, 1
s_lshl_b32 s3, s3, 7
s_add_u32 s47, s47, s3
v_lshl_add_u32 v72, v73, 4, v72
v_add_u32 v3, s47, v72
s_lshl_b32 s44, s40, 10
s_mul_i32 s45, s2, 18432
s_mov_b32 s46, s45
s_branch L_cons3
L_pwait:
s_mov_b32 s3, 20015
L_pwait1:
buffer_load_dword v8, off, s[36:39], 0 sc1
s_waitcnt vmcnt(0)
v_readfirstlane_b32 s47, v8
s_nop 3
s_cmp_eq_u32 s47, 1
s_cbranch_scc1 L_pset
s_sub_u32 s3, s3, 1
s_cbranch_scc0 L_pwait1
s_branch L_notlast
L_rest:
s_mov_b32 s92, 0x80
s_mov_b32 s47, 0x80
s_bitcmp1_b32 s2, 3
s_cselect_b32 s92, s92, 0x88
s_cselect_b32 s47, s47, 0x88
s_bitcmp1_b32 s2, 6
s_cselect_b32 s92, s47, s92
s_mov_b32 s3, 0x88
s_cmp_lt_u32 s84, 41
s_cselect_b32 s92, s3, s92
s_mov_b32 s87, 0x80
s_mov_b32 s3, 0x80
s_cmp_lt_u32 s84, 41
s_cselect_b32 s87, s3, s87
v_and_b32 v72, 15, v7
v_lshrrev_b32 v73, 4, v7
v_and_b32 v74, 7, v7
v_xor_b32 v74, v74, v73
v_lshlrev_b32 v74, 4, v74
v_lshl_add_u32 v0, v72, 7, v74
v_xor_b32 v1, 64, v0
s_mul_i32 s93, s40, 3584
s_add_u32 s93, s93, 148480
v_lshl_add_u32 v2, v73, 4, s93
v_and_b32 v74, 14, v7
v_mul_u32_u24 v4, 1152, v74
v_and_b32 v74, 1, v7
v_lshl_add_u32 v4, v74, 4, v4
v_lshl_add_u32 v4, v73, 5, v4
s_lshl_b32 s47, s40, 8
v_add_u32 v4, s47, v4
s_lshl_b32 s47, s40, 5
s_add_u32 s47, s47, 1024
v_lshrrev_b32 v72, 2, v7
v_and_b32 v73, 3, v7
v_lshl_add_u32 v6, v73, 4, v72
v_lshlrev_b32 v6, 2, v6
v_mul_u32_u24 v5, 1152, v72
v_lshl_add_u32 v5, v73, 3, v5
v_add_u32 v5, s47, v5
s_mov_b32 s80, 0x55555555
s_mov_b32 s81, 0x55555555
s_mov_b32 s82, 0xaaaaaaaa
s_mov_b32 s83, 0xaaaaaaaa
v_lshl_add_u32 v109, v7, 4, s93
v_lshl_add_u32 v89, v7, 2, s93
v_mov_b32 v76, 0
v_mov_b32 v77, 0
v_mov_b32 v78, 0
v_mov_b32 v79, 0
v_mov_b32 v90, 0xdddddddd
ds_write_b128 v109, v[76:79]
ds_write_b32 v89, v90 offset:1792
ds_write_b32 v89, v90 offset:2048
ds_write_b32 v89, v90 offset:2304
ds_write_b32 v89, v90 offset:2560
ds_write_b32 v89, v90 offset:2816
ds_write_b32 v89, v90 offset:3072
ds_write_b32 v89, v90 offset:3328
s_lshl_b32 s47, s40, 2
s_add_u32 s47, s47, 163072
v_mov_b32 v88, s47
ds_write_b32 v88, v76
s_mul_i32 s47, s40, 2304
s_add_u32 s47, s47, 373760
v_and_b32 v73, 60, v7
v_mad_u32_u24 v73, v73, 3, v7
v_lshl_add_u32 v72, v73, 4, s47
s_mov_b32 s47, 380672
v_lshl_add_u32 v73, v73, 4, s47
v_lshrrev_b32 v74, 2, v7
v_cmp_gt_u32 vcc, 36, v7
v_lshlrev_b32 v90, 11, v74
v_subrev_u32 v74, 9, v74
v_lshlrev_b32 v74, 12, v74
v_cndmask_b32 v72, v73, v72, vcc
v_cndmask_b32 v90, v74, v90, vcc
s_lshl_b32 s47, s40, 12
s_add_u32 s47, s47, 0x8001
v_mov_b32 v88, 1
v_mov_b32 v94, 0xf001
v_mov_b32 v95, s47
v_cndmask_b32 v94, v94, v88, vcc
v_cndmask_b32 v95, v95, v88, vcc
v_cndmask_b32 v96, 0, 28, vcc
v_cndmask_b32 v97, 32, 0, vcc
v_add_u32 v97, s93, v97
v_cmp_gt_u32 vcc, 56, v7
v_mov_b32 v73, 0x40000000
s_lshr_b32 s47, s2, 3
s_lshl_b32 s47, s47, 2
s_add_u32 s47, s47, s40
s_mul_i32 s47, s47, 2944
v_cndmask_b32 v72, v73, v72, vcc
v_lshl_add_u32 v93, v7, 4, s47
s_mul_i32 s47, s40, 82944
s_add_u32 s47, s47, s86
v_lshl_add_u32 v112, v7, 4, s47
s_mul_i32 s47, s40, 9216
s_add_u32 s47, s47, s86
s_add_u32 s47, s47, 331776
v_lshl_add_u32 v113, v7, 4, s47
s_lshl_b32 s47, s40, 6
s_add_u32 s47, s47, s86
s_add_u32 s47, s47, 368640
v_and_b32 v106, 15, v7
v_lshl_add_u32 v106, v106, 2, s47
v_lshrrev_b32 v107, 4, v7
v_lshl_add_u32 v106, v107, 8, v106
v_and_b32 v74, 15, v7
v_and_b32 v73, 7, v7
v_lshlrev_b32 v100, 1, v73
v_lshlrev_b32 v100, v100, v88
v_lshlrev_b32 v73, 4, v73
v_lshl_add_u32 v92, v74, 7, v73
v_lshl_or_b32 v92, v92, 16, v92
v_lshrrev_b32 v98, 5, v7
v_bfe_u32 v99, v7, 3, 2
v_lshl_add_u32 v99, v99, 6, s93
v_lshl_add_u32 v101, v7, 1, s93
v_lshrrev_b32 v102, 4, v7
v_lshl_add_u32 v102, v102, 3, s93
v_lshrrev_b32 v103, 1, v7
v_lshlrev_b32 v103, 5, v103
s_mov_b32 s89, 0
s_cmp_lg_u32 s40, 0
s_cbranch_scc1 L_ready
s_mov_b32 s3, 20015
s_mov_b32 s47, 458752
v_lshl_add_u32 v9, v7, 7, s47
s_bfe_u32 s47, s85, 0x40014
s_cmp_ge_u32 s47, 6
s_waitcnt vmcnt(15)
s_cbranch_scc1 L_deep
s_waitcnt vmcnt(0)
L_deep:
v_readfirstlane_b32 s47, v124
s_mov_b32 exec_hi, 511
s_cmp_lg_u32 s47, 1
s_cbranch_scc1 L_cwait
L_poll:
buffer_load_dword v8, v9, s[24:27], 0 offen sc1
s_sub_u32 s3, s3, 1
s_cbranch_scc1 L_giveup
s_waitcnt vmcnt(0)
v_cmp_ne_u32 vcc, 1, v8
s_nop 4
s_cbranch_vccnz L_poll
L_polled:
s_mov_b64 exec, -1
L_ready:
s_waitcnt lgkmcnt(0)
s_barrier
buffer_load_dwordx4 v[8:11], v72, s[24:27], 0 offen offset:0 sc1
buffer_load_dwordx4 v[12:15], v72, s[24:27], 0 offen offset:64 sc1
buffer_load_dwordx4 v[16:19], v72, s[24:27], 0 offen offset:128 sc1
buffer_load_dwordx4 v[20:23], v72, s[24:27], 0 offen offset:192 sc1
buffer_load_dwordx4 v[76:79], v93, s[24:27], 0 offen offset:0 sc1
buffer_load_dwordx4 v[80:83], v93, s[24:27], 0 offen offset:1024 sc1
buffer_load_dwordx4 v[84:87], v93, s[24:27], 0 offen offset:2048 sc1
buffer_load_dword v174, v106, s[24:27], 0 offen offset:0 sc1
buffer_load_dword v175, v106, s[24:27], 0 offen offset:1024 sc1
buffer_load_dword v176, v106, s[24:27], 0 offen offset:2048 sc1
buffer_load_dword v177, v106, s[24:27], 0 offen offset:3072 sc1
s_mov_b32 s99, 4096
buffer_load_dword v178, v106, s[24:27], s99 offen offset:0 sc1
s_mov_b32 s98, 0
buffer_load_dwordx4 v[138:141], v113, s[24:27], s98 offen sc1
s_mov_b32 s99, 0
buffer_load_dwordx4 a[0:3], v112, s[24:27], s99 offen offset:0 sc1
buffer_load_dwordx4 a[4:7], v112, s[24:27], s99 offen offset:1024 sc1
buffer_load_dwordx4 a[8:11], v112, s[24:27], s99 offen offset:2048 sc1
s_waitcnt vmcnt(12)
v_cmp_ne_u32 s[90:91], 0, v23
v_cmp_ne_u32 s[78:79], 0, v16
v_and_b32 v73, v94, v8
v_lshrrev_b32 v72, 10, v8
v_cmp_eq_u32 s[48:49], v73, v95
v_and_or_b32 v24, v72, v96, v97
s_mov_b64 exec, s[48:49]
ds_add_rtn_u32 v40, v24, v88
s_mov_b64 exec, -1
v_and_b32 v73, v94, v9
v_lshrrev_b32 v72, 10, v9
v_cmp_eq_u32 s[50:51], v73, v95
v_and_or_b32 v25, v72, v96, v97
s_mov_b64 exec, s[50:51]
ds_add_rtn_u32 v41, v25, v88
s_mov_b64 exec, -1
buffer_load_dwordx4 a[12:15], v112, s[24:27], s99 offen offset:3072 sc1
v_and_b32 v73, v94, v10
v_lshrrev_b32 v72, 10, v10
v_cmp_eq_u32 s[52:53], v73, v95
v_and_or_b32 v26, v72, v96, v97
s_mov_b64 exec, s[52:53]
ds_add_rtn_u32 v42, v26, v88
s_mov_b64 exec, -1
v_and_b32 v73, v94, v11
v_lshrrev_b32 v72, 10, v11
v_cmp_eq_u32 s[54:55], v73, v95
v_and_or_b32 v27, v72, v96, v97
s_mov_b64 exec, s[54:55]
ds_add_rtn_u32 v43, v27, v88
s_mov_b64 exec, -1
s_mov_b32 s99, 4096
buffer_load_dwordx4 a[16:19], v112, s[24:27], s99 offen offset:0 sc1
v_and_b32 v73, v94, v12
v_lshrrev_b32 v72, 10, v12
v_cmp_eq_u32 s[56:57], v73, v95
v_and_or_b32 v28, v72, v96, v97
s_mov_b64 exec, s[56:57]
ds_add_rtn_u32 v44, v28, v88
s_mov_b64 exec, -1
v_and_b32 v73, v94, v13
v_lshrrev_b32 v72, 10, v13
v_cmp_eq_u32 s[58:59], v73, v95
v_and_or_b32 v29, v72, v96, v97
s_mov_b64 exec, s[58:59]
ds_add_rtn_u32 v45, v29, v88
s_mov_b64 exec, -1
buffer_load_dwordx4 a[20:23], v112, s[24:27], s99 offen offset:1024 sc1
v_and_b32 v73, v94, v14
v_lshrrev_b32 v72, 10, v14
v_cmp_eq_u32 s[60:61], v73, v95
v_and_or_b32 v30, v72, v96, v97
s_mov_b64 exec, s[60:61]
ds_add_rtn_u32 v46, v30, v88
s_mov_b64 exec, -1
v_and_b32 v73, v94, v15
v_lshrrev_b32 v72, 10, v15
v_cmp_eq_u32 s[62:63], v73, v95
v_and_or_b32 v31, v72, v96, v97
s_mov_b64 exec, s[62:63]
ds_add_rtn_u32 v47, v31, v88
s_mov_b64 exec, -1
buffer_load_dwordx4 a[24:27], v112, s[24:27], s99 offen offset:2048 sc1
s_cmp_lg_u64 s[78:79], 0
s_cbranch_scc1 L_more1
L_more1b:
ds_read_b32 v72, v89
v_mov_b32 v73, 0
buffer_load_dwordx4 a[28:31], v112, s[24:27], s99 offen offset:3072 sc1
s_mov_b32 s99, 8192
buffer_load_dwordx4 a[32:35], v112, s[24:27], s99 offen offset:0 sc1
s_waitcnt lgkmcnt(0)
s_mov_b64 vcc, s[80:81]
v_cndmask_b32_dpp v73, v72, v73, vcc quad_perm:[0,0,2,2] row_mask:0xf bank_mask:0xf
v_add_u32 v91, v103, v73
v_add_u32 v73, v72, v73
v_cmp_lt_u32 vcc, 32, v73
s_or_b32 s90, s90, s91
s_and_b32 s47, vcc_lo, 0x1ff
s_or_b32 s47, s47, s90
s_cbranch_scc1 L_greedy
L_greedyb:
s_mov_b32 s98, 1024
buffer_load_dwordx4 v[142:145], v113, s[24:27], s98 offen sc1
ds_bpermute_b32 v56, v24, v91
ds_bpermute_b32 v57, v25, v91
ds_bpermute_b32 v58, v26, v91
ds_bpermute_b32 v59, v27, v91
ds_bpermute_b32 v60, v28, v91
ds_bpermute_b32 v61, v29, v91
ds_bpermute_b32 v62, v30, v91
ds_bpermute_b32 v63, v31, v91
buffer_load_dwordx4 a[36:39], v112, s[24:27], s99 offen offset:1024 sc1
buffer_load_dwordx4 a[40:43], v112, s[24:27], s99 offen offset:2048 sc1
s_waitcnt lgkmcnt(7)
v_add_u32 v73, v40, v56
v_and_b32 v72, 0x87e, v8
v_lshl_add_u32 v73, v73, 1, s93
v_add_u32 v72, v90, v72
s_andn2_b64 exec, s[48:49], s[90:91]
ds_write_b16_d16_hi v73, v8 offset:64
ds_write_b16 v73, v72 offset:384
ds_write_b16 v73, v8 offset:704
s_mov_b64 exec, -1
buffer_load_dwordx4 a[44:47], v112, s[24:27], s99 offen offset:3072 sc1
s_waitcnt lgkmcnt(9)
v_add_u32 v73, v41, v57
v_and_b32 v72, 0x87e, v9
v_lshl_add_u32 v73, v73, 1, s93
v_add_u32 v72, v90, v72
s_andn2_b64 exec, s[50:51], s[90:91]
ds_write_b16_d16_hi v73, v9 offset:64
ds_write_b16 v73, v72 offset:384
ds_write_b16 v73, v9 offset:704
s_mov_b64 exec, -1
s_mov_b32 s99, 12288
buffer_load_dwordx4 a[48:51], v112, s[24:27], s99 offen offset:0 sc1
s_waitcnt lgkmcnt(11)
v_add_u32 v73, v42, v58
v_and_b32 v72, 0x87e, v10
v_lshl_add_u32 v73, v73, 1, s93
v_add_u32 v72, v90, v72
s_andn2_b64 exec, s[52:53], s[90:91]
ds_write_b16_d16_hi v73, v10 offset:64
ds_write_b16 v73, v72 offset:384
ds_write_b16 v73, v10 offset:704
s_mov_b64 exec, -1
buffer_load_dwordx4 a[52:55], v112, s[24:27], s99 offen offset:1024 sc1
s_waitcnt lgkmcnt(13)
v_add_u32 v73, v43, v59
v_and_b32 v72, 0x87e, v11
v_lshl_add_u32 v73, v73, 1, s93
v_add_u32 v72, v90, v72
s_andn2_b64 exec, s[54:55], s[90:91]
ds_write_b16_d16_hi v73, v11 offset:64
ds_write_b16 v73, v72 offset:384
ds_write_b16 v73, v11 offset:704
s_mov_b64 exec, -1
s_waitcnt lgkmcnt(15)
v_add_u32 v73, v44, v60
v_and_b32 v72, 0x87e, v12
v_lshl_add_u32 v73, v73, 1, s93
v_add_u32 v72, v90, v72
s_andn2_b64 exec, s[56:57], s[90:91]
ds_write_b16_d16_hi v73, v12 offset:64
ds_write_b16 v73, v72 offset:384
ds_write_b16 v73, v12 offset:704
s_mov_b64 exec, -1
buffer_load_dwordx4 a[56:59], v112, s[24:27], s99 offen offset:2048 sc1
s_waitcnt lgkmcnt(15)
v_add_u32 v73, v45, v61
v_and_b32 v72, 0x87e, v13
v_lshl_add_u32 v73, v73, 1, s93
v_add_u32 v72, v90, v72
s_andn2_b64 exec, s[58:59], s[90:91]
ds_write_b16_d16_hi v73, v13 offset:64
ds_write_b16 v73, v72 offset:384
ds_write_b16 v73, v13 offset:704
s_mov_b64 exec, -1
buffer_load_dwordx4 a[60:63], v112, s[24:27], s99 offen offset:3072 sc1
s_waitcnt lgkmcnt(15)
v_add_u32 v73, v46, v62
v_and_b32 v72, 0x87e, v14
v_lshl_add_u32 v73, v73, 1, s93
v_add_u32 v72, v90, v72
s_andn2_b64 exec, s[60:61], s[90:91]
ds_write_b16_d16_hi v73, v14 offset:64
ds_write_b16 v73, v72 offset:384
ds_write_b16 v73, v14 offset:704
s_mov_b64 exec, -1
s_waitcnt lgkmcnt(15)
v_add_u32 v73, v47, v63
v_and_b32 v72, 0x87e, v15
v_lshl_add_u32 v73, v73, 1, s93
v_add_u32 v72, v90, v72
s_andn2_b64 exec, s[62:63], s[90:91]
ds_write_b16_d16_hi v73, v15 offset:64
ds_write_b16 v73, v72 offset:384
ds_write_b16 v73, v15 offset:704
s_mov_b64 exec, -1
s_mov_b32 s99, 16384
buffer_load_dwordx4 a[64:67], v112, s[24:27], s99 offen offset:0 sc1
s_cmp_lg_u64 s[78:79], 0
s_cbranch_scc1 L_more2
L_more2b:
ds_read_u16 v8, v101 offset:704
ds_read_u16 v9, v101 offset:832
ds_read_u16 v10, v101 offset:960
ds_read2_b64 v[118:121], v102 offset0:48 offset1:52
ds_read2_b64 v[122:125], v102 offset0:56 offset1:60
ds_read2_b64 v[126:129], v102 offset0:64 offset1:68
ds_read2_b64 v[130:133], v102 offset0:72 offset1:76
ds_read2_b64 v[134:137], v102 offset0:80 offset1:84
buffer_load_dwordx4 a[68:71], v112, s[24:27], s99 offen offset:1024 sc1
s_mov_b32 s98, 2048
buffer_load_dwordx4 v[146:149], v113, s[24:27], s98 offen sc1
buffer_load_dwordx4 a[72:75], v112, s[24:27], s99 offen offset:2048 sc1
s_waitcnt lgkmcnt(5)
v_lshrrev_b32 v72, 12, v8
v_cmp_ne_u32 vcc, 0, v8
v_min_u32 v72, 8, v72
v_add3_u32 v72, v72, v98, 0
v_lshlrev_b32 v73, 4, v72
v_lshrrev_b32 v72, 1, v72
v_lshlrev_b32 v73, v73, v100
v_lshl_add_u32 v72, v72, 8, v99
v_bfe_u32 v74, v8, 7, 4
v_lshl_add_u32 v72, v74, 2, v72
s_mov_b64 exec, vcc
ds_xor_b32 v72, v73 offset:1792
s_mov_b64 exec, -1
buffer_load_dwordx4 a[76:79], v112, s[24:27], s99 offen offset:3072 sc1
v_lshrrev_b32 v72, 12, v9
v_cmp_ne_u32 vcc, 0, v9
v_min_u32 v72, 8, v72
v_add3_u32 v72, v72, v98, 2
v_lshlrev_b32 v73, 4, v72
v_lshrrev_b32 v72, 1, v72
v_lshlrev_b32 v73, v73, v100
v_lshl_add_u32 v72, v72, 8, v99
v_bfe_u32 v74, v9, 7, 4
v_lshl_add_u32 v72, v74, 2, v72
s_mov_b64 exec, vcc
ds_xor_b32 v72, v73 offset:1792
s_mov_b64 exec, -1
s_mov_b32 s99, 20480
buffer_load_dwordx4 a[80:83], v112, s[24:27], s99 offen offset:0 sc1
v_lshrrev_b32 v72, 12, v10
v_cmp_ne_u32 vcc, 0, v10
v_min_u32 v72, 8, v72
v_add3_u32 v72, v72, v98, 4
v_lshlrev_b32 v73, 4, v72
v_lshrrev_b32 v72, 1, v72
v_lshlrev_b32 v73, v73, v100
v_lshl_add_u32 v72, v72, 8, v99
v_bfe_u32 v74, v10, 7, 4
v_lshl_add_u32 v72, v74, 2, v72
s_mov_b64 exec, vcc
s_mov_b32 exec_hi, 0
ds_xor_b32 v72, v73 offset:1792
s_mov_b64 exec, -1
buffer_load_dwordx4 a[84:87], v112, s[24:27], s99 offen offset:1024 sc1
ds_read_b32 v179, v89 offset:1792
ds_read_b32 v180, v89 offset:2048
ds_read_b32 v181, v89 offset:2304
ds_read_b32 v182, v89 offset:2560
ds_read_b32 v183, v89 offset:2816
ds_read_b32 v184, v89 offset:3072
ds_read_b32 v185, v89 offset:3328
s_waitcnt lgkmcnt(10)
v_xor_b32 v118, v92, v118
v_xor_b32 v119, v92, v119
v_xor_b32 v120, v92, v120
v_xor_b32 v121, v92, v121
buffer_load_dwordx4 a[88:91], v112, s[24:27], s99 offen offset:2048 sc1
v_xor_b32 v122, v92, v122
v_xor_b32 v123, v92, v123
v_xor_b32 v124, v92, v124
v_xor_b32 v125, v92, v125
v_xor_b32 v126, v92, v126
v_xor_b32 v127, v92, v127
v_xor_b32 v128, v92, v128
v_xor_b32 v129, v92, v129
v_xor_b32 v130, v92, v130
v_xor_b32 v131, v92, v131
v_xor_b32 v132, v92, v132
v_xor_b32 v133, v92, v133
buffer_load_dwordx4 a[92:95], v112, s[24:27], s99 offen offset:3072 sc1
v_xor_b32 v134, v92, v134
v_xor_b32 v135, v92, v135
v_xor_b32 v136, v92, v136
v_xor_b32 v137, v92, v137
v_lshlrev_b32 v114, 16, v110
v_and_b32 v115, 0xffff0000, v110
v_lshlrev_b32 v116, 16, v111
v_and_b32 v117, 0xffff0000, v111
s_mov_b32 exec_hi, 15
ds_write_b128 v109, v[114:117] offset:1024
s_mov_b64 exec, -1
s_mov_b32 s41, 2
s_mov_b32 s42, 0
s_mov_b32 s4, 37120
s_mov_b32 s22, 75497472
s_mov_b32 s5, 18560
s_mov_b32 s6, 4718592
s_mov_b64 vcc, s[80:81]
s_andn2_b32 s12, 63, s85
s_mov_b32 s59, 6
s_add_u32 s48, s46, 9437184
s_add_u32 s49, s48, 4718592
s_add_u32 s50, s49, 4718592
s_sub_u32 s58, s7, s45
s_bfe_u32 s47, s2, 0x20004
s_mul_i32 s57, s47, 294912
s_add_u32 s57, s57, 47185920
s_lshl_b32 s47, s47, 7
s_add_u32 s47, s47, 393216
s_add_u32 s32, s24, s47
s_addc_u32 s33, s25, 0
s_cmp_eq_u32 s40, 0
s_cselect_b32 s34, 4, 0
s_cselect_b64 s[62:63], 1, 0
s_waitcnt lgkmcnt(0)
v_mov_b32 v114, 163072
s_barrier
ds_read_b32 v114, v114
ds_read_b128 v[44:47], v0 offset:0
ds_read_b128 v[48:51], v1 offset:0
s_waitcnt vmcnt(18)
ds_read_b128 v[76:79], v2 offset:1024
ds_read_b128 v[80:83], v2 offset:1088
ds_read_b128 v[84:87], v2 offset:1152
ds_read_b128 v[88:91], v2 offset:1216
ds_read_b128 v[92:95], v2 offset:1280
ds_read_b128 v[96:99], v2 offset:1344
ds_read_b128 v[100:103], v2 offset:1408
ds_read_b128 v[104:107], v2 offset:1472
ds_read_b128 v[108:111], v2 offset:1536
s_mov_b32 s99, 24576
buffer_load_dwordx4 a[96:99], v112, s[24:27], s99 offen offset:0 sc1
ds_read_b128 v[8:11], v2 offset:1024
ds_read_b128 v[12:15], v2 offset:1088
ds_read_b128 v[16:19], v2 offset:1152
ds_read_b128 v[20:23], v2 offset:1216
ds_read_b128 v[24:27], v2 offset:1280
ds_read_b128 v[28:31], v2 offset:1344
ds_read_b128 v[32:35], v2 offset:1408
ds_read_b128 v[36:39], v2 offset:1472
ds_read_b128 v[40:43], v2 offset:1536
buffer_load_dwordx4 a[100:103], v112, s[24:27], s99 offen offset:1024 sc1
s_waitcnt lgkmcnt(15)
v_readfirstlane_b32 s47, v114
v_add_u32_sdwa v60, s42, v118 dst_sel:DWORD dst_unused:UNUSED_PAD src0_sel:DWORD src1_sel:WORD_0
s_nop 2
s_cmp_lg_u32 s47, 0
s_cbranch_scc1 L_slow
v_smfmac_f32_16x16x64_bf16 v[76:79], a[0:3], v[44:51], v138
ds_read_b128 v[52:55], v0 offset:18560
ds_read_b128 v[56:59], v1 offset:18560
ds_read_u16 v68, v60 offset:18560
ds_read_u16 v60, v60
v_add_u32_sdwa v61, s42, v118 dst_sel:DWORD dst_unused:UNUSED_PAD src0_sel:DWORD src1_sel:WORD_1
v_smfmac_f32_16x16x64_bf16 v[80:83], a[4:7], v[44:51], v138 abid:1
ds_read_u16 v69, v61 offset:18560
ds_read_u16 v61, v61
v_add_u32_sdwa v62, s42, v119 dst_sel:DWORD dst_unused:UNUSED_PAD src0_sel:DWORD src1_sel:WORD_0
v_smfmac_f32_16x16x64_bf16 v[84:87], a[8:11], v[44:51], v139
buffer_load_dwordx4 a[104:107], v112, s[24:27], s99 offen offset:2048 sc1
ds_read_u16 v70, v62 offset:18560
ds_read_u16 v62, v62
v_add_u32_sdwa v63, s42, v119 dst_sel:DWORD dst_unused:UNUSED_PAD src0_sel:DWORD src1_sel:WORD_1
s_waitcnt lgkmcnt(15)
v_smfmac_f32_16x16x64_bf16 v[88:91], a[12:15], v[44:51], v139 abid:1
ds_read_u16 v71, v63 offset:18560
ds_read_u16 v63, v63
v_add_u32_sdwa v64, s42, v120 dst_sel:DWORD dst_unused:UNUSED_PAD src0_sel:DWORD src1_sel:WORD_0
v_smfmac_f32_16x16x64_bf16 v[92:95], a[16:19], v[44:51], v140
s_mov_b32 s98, 3072
buffer_load_dwordx4 v[150:153], v113, s[24:27], s98 offen sc1
ds_read_u16 v72, v64 offset:18560
ds_read_u16 v64, v64
v_add_u32_sdwa v65, s42, v120 dst_sel:DWORD dst_unused:UNUSED_PAD src0_sel:DWORD src1_sel:WORD_1
v_smfmac_f32_16x16x64_bf16 v[96:99], a[20:23], v[44:51], v140 abid:1
ds_read_u16 v73, v65 offset:18560
ds_read_u16 v65, v65
v_add_u32_sdwa v66, s42, v121 dst_sel:DWORD dst_unused:UNUSED_PAD src0_sel:DWORD src1_sel:WORD_0
v_smfmac_f32_16x16x64_bf16 v[100:103], a[24:27], v[44:51], v141
buffer_load_dwordx4 a[108:111], v112, s[24:27], s99 offen offset:3072 sc1
ds_read_u16 v74, v66 offset:18560
ds_read_u16 v66, v66
v_add_u32_sdwa v67, s42, v121 dst_sel:DWORD dst_unused:UNUSED_PAD src0_sel:DWORD src1_sel:WORD_1
v_smfmac_f32_16x16x64_bf16 v[104:107], a[28:31], v[44:51], v141 abid:1
ds_read_u16 v75, v67 offset:18560
ds_read_u16 v67, v67
s_waitcnt vmcnt(18)
v_smfmac_f32_16x16x64_bf16 v[108:111], a[32:35], v[44:51], v174
ds_read_b128 v[114:117], v2 offset:64
s_waitcnt lgkmcnt(15)
v_smfmac_f32_16x16x64_bf16 v[8:11], a[0:3], v[52:59], v138
s_mov_b32 s99, 28672
buffer_load_dwordx4 a[112:115], v112, s[24:27], s99 offen offset:0 sc1
ds_read_b128 v[44:47], v0 offset:2048
v_smfmac_f32_16x16x64_bf16 v[12:15], a[4:7], v[52:59], v138 abid:1
ds_read_b128 v[48:51], v1 offset:2048
v_smfmac_f32_16x16x64_bf16 v[16:19], a[8:11], v[52:59], v139
buffer_load_dwordx4 a[116:119], v112, s[24:27], s99 offen offset:1024 sc1
v_smfmac_f32_16x16x64_bf16 v[20:23], a[12:15], v[52:59], v139 abid:1
v_smfmac_f32_16x16x64_bf16 v[24:27], a[16:19], v[52:59], v140
buffer_load_dwordx4 a[120:123], v112, s[24:27], s99 offen offset:2048 sc1
v_smfmac_f32_16x16x64_bf16 v[28:31], a[20:23], v[52:59], v140 abid:1
v_smfmac_f32_16x16x64_bf16 v[32:35], a[24:27], v[52:59], v141
v_smfmac_f32_16x16x64_bf16 v[36:39], a[28:31], v[52:59], v141 abid:1
buffer_load_dwordx4 a[124:127], v112, s[24:27], s99 offen offset:3072 sc1
v_smfmac_f32_16x16x64_bf16 v[40:43], a[32:35], v[52:59], v174
s_waitcnt lgkmcnt(2)
v_smfmac_f32_16x16x64_bf16 v[8:11], v[114:117], v[68:75], v179
s_mov_b32 s99, 32768
buffer_load_dwordx4 a[128:131], v112, s[24:27], s99 offen offset:0 sc1
v_smfmac_f32_16x16x64_bf16 v[12:15], v[114:117], v[68:75], v179 abid:1
v_smfmac_f32_16x16x64_bf16 v[76:79], v[114:117], v[60:67], v179
buffer_load_dwordx4 a[132:135], v112, s[24:27], s99 offen offset:1024 sc1
v_smfmac_f32_16x16x64_bf16 v[80:83], v[114:117], v[60:67], v179 abid:1
v_add_u32_sdwa v60, s42, v122 dst_sel:DWORD dst_unused:UNUSED_PAD src0_sel:DWORD src1_sel:WORD_0
s_waitcnt lgkmcnt(0)
v_smfmac_f32_16x16x64_bf16 v[76:79], a[36:39], v[44:51], v142
ds_read_b128 v[52:55], v0 offset:20608
ds_read_b128 v[56:59], v1 offset:20608
ds_read_u16 v68, v60 offset:18560
ds_read_u16 v60, v60
v_add_u32_sdwa v61, s42, v122 dst_sel:DWORD dst_unused:UNUSED_PAD src0_sel:DWORD src1_sel:WORD_1
v_smfmac_f32_16x16x64_bf16 v[80:83], a[40:43], v[44:51], v142 abid:1
buffer_load_dwordx4 a[136:139], v112, s[24:27], s99 offen offset:2048 sc1
ds_read_u16 v69, v61 offset:18560
ds_read_u16 v61, v61
v_add_u32_sdwa v62, s42, v123 dst_sel:DWORD dst_unused:UNUSED_PAD src0_sel:DWORD src1_sel:WORD_0
v_smfmac_f32_16x16x64_bf16 v[84:87], a[44:47], v[44:51], v143
ds_read_u16 v70, v62 offset:18560
ds_read_u16 v62, v62
v_add_u32_sdwa v63, s42, v123 dst_sel:DWORD dst_unused:UNUSED_PAD src0_sel:DWORD src1_sel:WORD_1
s_waitcnt vmcnt(18)
v_smfmac_f32_16x16x64_bf16 v[88:91], a[48:51], v[44:51], v143 abid:1
buffer_load_dwordx4 a[140:143], v112, s[24:27], s99 offen offset:3072 sc1
ds_read_u16 v71, v63 offset:18560
ds_read_u16 v63, v63
v_add_u32_sdwa v64, s42, v124 dst_sel:DWORD dst_unused:UNUSED_PAD src0_sel:DWORD src1_sel:WORD_0
v_smfmac_f32_16x16x64_bf16 v[92:95], a[52:55], v[44:51], v144
ds_read_u16 v72, v64 offset:18560
ds_read_u16 v64, v64
v_add_u32_sdwa v65, s42, v124 dst_sel:DWORD dst_unused:UNUSED_PAD src0_sel:DWORD src1_sel:WORD_1
v_smfmac_f32_16x16x64_bf16 v[96:99], a[56:59], v[44:51], v144 abid:1
s_mov_b32 s98, 4096
buffer_load_dwordx4 v[154:157], v113, s[24:27], s98 offen sc1
ds_read_u16 v73, v65 offset:18560
ds_read_u16 v65, v65
v_add_u32_sdwa v66, s42, v125 dst_sel:DWORD dst_unused:UNUSED_PAD src0_sel:DWORD src1_sel:WORD_0
v_smfmac_f32_16x16x64_bf16 v[100:103], a[60:63], v[44:51], v145
ds_read_u16 v74, v66 offset:18560
ds_read_u16 v66, v66
v_add_u32_sdwa v67, s42, v125 dst_sel:DWORD dst_unused:UNUSED_PAD src0_sel:DWORD src1_sel:WORD_1
v_smfmac_f32_16x16x64_bf16 v[104:107], a[64:67], v[44:51], v145 abid:1
ds_read_u16 v75, v67 offset:18560
ds_read_u16 v67, v67
v_smfmac_f32_16x16x64_bf16 v[108:111], a[68:71], v[44:51], v174 abid:1
s_mov_b32 s99, 36864
buffer_load_dwordx4 a[144:147], v112, s[24:27], s99 offen offset:0 sc1
ds_read_b128 v[114:117], v2 offset:128
s_waitcnt lgkmcnt(15)
v_smfmac_f32_16x16x64_bf16 v[8:11], a[36:39], v[52:59], v142
ds_read_b128 v[44:47], v0 offset:4096
v_smfmac_f32_16x16x64_bf16 v[12:15], a[40:43], v[52:59], v142 abid:1
buffer_load_dwordx4 a[148:151], v112, s[24:27], s99 offen offset:1024 sc1
ds_read_b128 v[48:51], v1 offset:4096
v_smfmac_f32_16x16x64_bf16 v[16:19], a[44:47], v[52:59], v143
v_smfmac_f32_16x16x64_bf16 v[20:23], a[48:51], v[52:59], v143 abid:1
buffer_load_dwordx4 a[152:155], v112, s[24:27], s99 offen offset:2048 sc1
v_smfmac_f32_16x16x64_bf16 v[24:27], a[52:55], v[52:59], v144
v_smfmac_f32_16x16x64_bf16 v[28:31], a[56:59], v[52:59], v144 abid:1
v_smfmac_f32_16x16x64_bf16 v[32:35], a[60:63], v[52:59], v145
buffer_load_dwordx4 a[156:159], v112, s[24:27], s99 offen offset:3072 sc1
v_smfmac_f32_16x16x64_bf16 v[36:39], a[64:67], v[52:59], v145 abid:1
v_smfmac_f32_16x16x64_bf16 v[40:43], a[68:71], v[52:59], v174 abid:1
s_mov_b32 s99, 40960
buffer_load_dwordx4 a[160:163], v112, s[24:27], s99 offen offset:0 sc1
s_waitcnt lgkmcnt(2)
v_smfmac_f32_16x16x64_bf16 v[12:15], v[114:117], v[68:75], v180
v_smfmac_f32_16x16x64_bf16 v[16:19], v[114:117], v[68:75], v180 abid:1
buffer_load_dwordx4 a[164:167], v112, s[24:27], s99 offen offset:1024 sc1
v_smfmac_f32_16x16x64_bf16 v[20:23], v[114:117], v[68:75], v181
v_smfmac_f32_16x16x64_bf16 v[80:83], v[114:117], v[60:67], v180
v_smfmac_f32_16x16x64_bf16 v[84:87], v[114:117], v[60:67], v180 abid:1
buffer_load_dwordx4 a[168:171], v112, s[24:27], s99 offen offset:2048 sc1
v_smfmac_f32_16x16x64_bf16 v[88:91], v[114:117], v[60:67], v181
v_add_u32_sdwa v60, s42, v126 dst_sel:DWORD dst_unused:UNUSED_PAD src0_sel:DWORD src1_sel:WORD_0
s_waitcnt lgkmcnt(0)
s_waitcnt vmcnt(18)
v_smfmac_f32_16x16x64_bf16 v[76:79], a[72:75], v[44:51], v146
buffer_load_dwordx4 a[172:175], v112, s[24:27], s99 offen offset:3072 sc1
ds_read_b128 v[52:55], v0 offset:22656
ds_read_b128 v[56:59], v1 offset:22656
ds_read_u16 v68, v60 offset:18560
ds_read_u16 v60, v60
v_add_u32_sdwa v61, s42, v126 dst_sel:DWORD dst_unused:UNUSED_PAD src0_sel:DWORD src1_sel:WORD_1
v_smfmac_f32_16x16x64_bf16 v[80:83], a[76:79], v[44:51], v146 abid:1
ds_read_u16 v69, v61 offset:18560
ds_read_u16 v61, v61
v_add_u32_sdwa v62, s42, v127 dst_sel:DWORD dst_unused:UNUSED_PAD src0_sel:DWORD src1_sel:WORD_0
v_smfmac_f32_16x16x64_bf16 v[84:87], a[80:83], v[44:51], v147
s_mov_b32 s99, 45056
buffer_load_dwordx4 a[176:179], v112, s[24:27], s99 offen offset:0 sc1
ds_read_u16 v70, v62 offset:18560
ds_read_u16 v62, v62
v_add_u32_sdwa v63, s42, v127 dst_sel:DWORD dst_unused:UNUSED_PAD src0_sel:DWORD src1_sel:WORD_1
v_smfmac_f32_16x16x64_bf16 v[88:91], a[84:87], v[44:51], v147 abid:1
ds_read_u16 v71, v63 offset:18560
ds_read_u16 v63, v63
v_add_u32_sdwa v64, s42, v128 dst_sel:DWORD dst_unused:UNUSED_PAD src0_sel:DWORD src1_sel:WORD_0
v_smfmac_f32_16x16x64_bf16 v[92:95], a[88:91], v[44:51], v148
ds_read_u16 v72, v64 offset:18560
ds_read_u16 v64, v64
v_add_u32_sdwa v65, s42, v128 dst_sel:DWORD dst_unused:UNUSED_PAD src0_sel:DWORD src1_sel:WORD_1
v_smfmac_f32_16x16x64_bf16 v[96:99], a[92:95], v[44:51], v148 abid:1
s_mov_b32 s98, 5120
buffer_load_dwordx4 v[158:161], v113, s[24:27], s98 offen sc1
ds_read_u16 v73, v65 offset:18560
ds_read_u16 v65, v65
v_add_u32_sdwa v66, s42, v129 dst_sel:DWORD dst_unused:UNUSED_PAD src0_sel:DWORD src1_sel:WORD_0
v_smfmac_f32_16x16x64_bf16 v[100:103], a[96:99], v[44:51], v149
ds_read_u16 v74, v66 offset:18560
ds_read_u16 v66, v66
v_add_u32_sdwa v67, s42, v129 dst_sel:DWORD dst_unused:UNUSED_PAD src0_sel:DWORD src1_sel:WORD_1
v_smfmac_f32_16x16x64_bf16 v[104:107], a[100:103], v[44:51], v149 abid:1
buffer_load_dwordx4 a[180:183], v112, s[24:27], s99 offen offset:1024 sc1
ds_read_u16 v75, v67 offset:18560
ds_read_u16 v67, v67
v_smfmac_f32_16x16x64_bf16 v[108:111], a[104:107], v[44:51], v175
ds_read_b128 v[114:117], v2 offset:192
s_waitcnt lgkmcnt(15)
v_smfmac_f32_16x16x64_bf16 v[8:11], a[72:75], v[52:59], v146
buffer_load_dwordx4 a[184:187], v112, s[24:27], s99 offen offset:2048 sc1
ds_read_b128 v[44:47], v0 offset:6144
v_smfmac_f32_16x16x64_bf16 v[12:15], a[76:79], v[52:59], v146 abid:1
ds_read_b128 v[48:51], v1 offset:6144
v_smfmac_f32_16x16x64_bf16 v[16:19], a[80:83], v[52:59], v147
v_smfmac_f32_16x16x64_bf16 v[20:23], a[84:87], v[52:59], v147 abid:1
buffer_load_dwordx4 a[188:191], v112, s[24:27], s99 offen offset:3072 sc1
v_smfmac_f32_16x16x64_bf16 v[24:27], a[88:91], v[52:59], v148
v_smfmac_f32_16x16x64_bf16 v[28:31], a[92:95], v[52:59], v148 abid:1
s_mov_b32 s99, 49152
buffer_load_dwordx4 a[192:195], v112, s[24:27], s99 offen offset:0 sc1
v_smfmac_f32_16x16x64_bf16 v[32:35], a[96:99], v[52:59], v149
v_smfmac_f32_16x16x64_bf16 v[36:39], a[100:103], v[52:59], v149 abid:1
buffer_load_dwordx4 a[196:199], v112, s[24:27], s99 offen offset:1024 sc1
v_smfmac_f32_16x16x64_bf16 v[40:43], a[104:107], v[52:59], v175
s_waitcnt lgkmcnt(2)
v_smfmac_f32_16x16x64_bf16 v[20:23], v[114:117], v[68:75], v181 abid:1
v_smfmac_f32_16x16x64_bf16 v[24:27], v[114:117], v[68:75], v182
buffer_load_dwordx4 a[200:203], v112, s[24:27], s99 offen offset:2048 sc1
v_smfmac_f32_16x16x64_bf16 v[28:31], v[114:117], v[68:75], v182 abid:1
v_smfmac_f32_16x16x64_bf16 v[88:91], v[114:117], v[60:67], v181 abid:1
buffer_load_dwordx4 a[204:207], v112, s[24:27], s99 offen offset:3072 sc1
v_smfmac_f32_16x16x64_bf16 v[92:95], v[114:117], v[60:67], v182
v_smfmac_f32_16x16x64_bf16 v[96:99], v[114:117], v[60:67], v182 abid:1
s_mov_b32 s99, 53248
buffer_load_dwordx4 a[208:211], v112, s[24:27], s99 offen offset:0 sc1
v_add_u32_sdwa v60, s42, v130 dst_sel:DWORD dst_unused:UNUSED_PAD src0_sel:DWORD src1_sel:WORD_0
s_waitcnt lgkmcnt(0)
s_waitcnt vmcnt(18)
v_smfmac_f32_16x16x64_bf16 v[76:79], a[108:111], v[44:51], v150
ds_read_b128 v[52:55], v0 offset:24704
ds_read_b128 v[56:59], v1 offset:24704
ds_read_u16 v68, v60 offset:18560
ds_read_u16 v60, v60
v_add_u32_sdwa v61, s42, v130 dst_sel:DWORD dst_unused:UNUSED_PAD src0_sel:DWORD src1_sel:WORD_1
v_smfmac_f32_16x16x64_bf16 v[80:83], a[112:115], v[44:51], v150 abid:1
ds_read_u16 v69, v61 offset:18560
ds_read_u16 v61, v61
v_add_u32_sdwa v62, s42, v131 dst_sel:DWORD dst_unused:UNUSED_PAD src0_sel:DWORD src1_sel:WORD_0
v_smfmac_f32_16x16x64_bf16 v[84:87], a[116:119], v[44:51], v151
buffer_load_dwordx4 a[212:215], v112, s[24:27], s99 offen offset:1024 sc1
ds_read_u16 v70, v62 offset:18560
ds_read_u16 v62, v62
v_add_u32_sdwa v63, s42, v131 dst_sel:DWORD dst_unused:UNUSED_PAD src0_sel:DWORD src1_sel:WORD_1
v_smfmac_f32_16x16x64_bf16 v[88:91], a[120:123], v[44:51], v151 abid:1
ds_read_u16 v71, v63 offset:18560
ds_read_u16 v63, v63
v_add_u32_sdwa v64, s42, v132 dst_sel:DWORD dst_unused:UNUSED_PAD src0_sel:DWORD src1_sel:WORD_0
v_smfmac_f32_16x16x64_bf16 v[92:95], a[124:127], v[44:51], v152
s_mov_b32 s98, 6144
buffer_load_dwordx4 v[162:165], v113, s[24:27], s98 offen sc1
ds_read_u16 v72, v64 offset:18560
ds_read_u16 v64, v64
v_add_u32_sdwa v65, s42, v132 dst_sel:DWORD dst_unused:UNUSED_PAD src0_sel:DWORD src1_sel:WORD_1
v_smfmac_f32_16x16x64_bf16 v[96:99], a[128:131], v[44:51], v152 abid:1
ds_read_u16 v73, v65 offset:18560
ds_read_u16 v65, v65
v_add_u32_sdwa v66, s42, v133 dst_sel:DWORD dst_unused:UNUSED_PAD src0_sel:DWORD src1_sel:WORD_0
v_smfmac_f32_16x16x64_bf16 v[100:103], a[132:135], v[44:51], v153
buffer_load_dwordx4 a[216:219], v112, s[24:27], s99 offen offset:2048 sc1
ds_read_u16 v74, v66 offset:18560
ds_read_u16 v66, v66
v_add_u32_sdwa v67, s42, v133 dst_sel:DWORD dst_unused:UNUSED_PAD src0_sel:DWORD src1_sel:WORD_1
v_smfmac_f32_16x16x64_bf16 v[104:107], a[136:139], v[44:51], v153 abid:1
ds_read_u16 v75, v67 offset:18560
ds_read_u16 v67, v67
v_smfmac_f32_16x16x64_bf16 v[108:111], a[140:143], v[44:51], v175 abid:1
ds_read_b128 v[114:117], v2 offset:256
s_waitcnt lgkmcnt(15)
v_smfmac_f32_16x16x64_bf16 v[8:11], a[108:111], v[52:59], v150
buffer_load_dwordx4 a[220:223], v112, s[24:27], s99 offen offset:3072 sc1
ds_read_b128 v[44:47], v0 offset:8192
v_smfmac_f32_16x16x64_bf16 v[12:15], a[112:115], v[52:59], v150 abid:1
ds_read_b128 v[48:51], v1 offset:8192
v_smfmac_f32_16x16x64_bf16 v[16:19], a[116:119], v[52:59], v151
s_mov_b32 s99, 57344
buffer_load_dwordx4 a[224:227], v112, s[24:27], s99 offen offset:0 sc1
v_smfmac_f32_16x16x64_bf16 v[20:23], a[120:123], v[52:59], v151 abid:1
v_smfmac_f32_16x16x64_bf16 v[24:27], a[124:127], v[52:59], v152
buffer_load_dwordx4 a[228:231], v112, s[24:27], s99 offen offset:1024 sc1
v_smfmac_f32_16x16x64_bf16 v[28:31], a[128:131], v[52:59], v152 abid:1
v_smfmac_f32_16x16x64_bf16 v[32:35], a[132:135], v[52:59], v153
v_smfmac_f32_16x16x64_bf16 v[36:39], a[136:139], v[52:59], v153 abid:1
buffer_load_dwordx4 a[232:235], v112, s[24:27], s99 offen offset:2048 sc1
v_smfmac_f32_16x16x64_bf16 v[40:43], a[140:143], v[52:59], v175 abid:1
s_waitcnt lgkmcnt(2)
v_smfmac_f32_16x16x64_bf16 v[28:31], v[114:117], v[68:75], v183
buffer_load_dwordx4 a[236:239], v112, s[24:27], s99 offen offset:3072 sc1
v_smfmac_f32_16x16x64_bf16 v[32:35], v[114:117], v[68:75], v183 abid:1
v_smfmac_f32_16x16x64_bf16 v[36:39], v[114:117], v[68:75], v184
s_mov_b32 s99, 61440
buffer_load_dwordx4 a[240:243], v112, s[24:27], s99 offen offset:0 sc1
v_smfmac_f32_16x16x64_bf16 v[96:99], v[114:117], v[60:67], v183
v_smfmac_f32_16x16x64_bf16 v[100:103], v[114:117], v[60:67], v183 abid:1
v_smfmac_f32_16x16x64_bf16 v[104:107], v[114:117], v[60:67], v184
buffer_load_dwordx4 a[244:247], v112, s[24:27], s99 offen offset:1024 sc1
v_add_u32_sdwa v60, s42, v134 dst_sel:DWORD dst_unused:UNUSED_PAD src0_sel:DWORD src1_sel:WORD_0
s_waitcnt lgkmcnt(0)
s_waitcnt vmcnt(18)
v_smfmac_f32_16x16x64_bf16 v[76:79], a[144:147], v[44:51], v154
ds_read_b128 v[52:55], v0 offset:26752
ds_read_b128 v[56:59], v1 offset:26752
ds_read_u16 v68, v60 offset:18560
ds_read_u16 v60, v60
v_add_u32_sdwa v61, s42, v134 dst_sel:DWORD dst_unused:UNUSED_PAD src0_sel:DWORD src1_sel:WORD_1
v_smfmac_f32_16x16x64_bf16 v[80:83], a[148:151], v[44:51], v154 abid:1
buffer_load_dwordx4 a[248:251], v112, s[24:27], s99 offen offset:2048 sc1
ds_read_u16 v69, v61 offset:18560
ds_read_u16 v61, v61
v_add_u32_sdwa v62, s42, v135 dst_sel:DWORD dst_unused:UNUSED_PAD src0_sel:DWORD src1_sel:WORD_0
v_smfmac_f32_16x16x64_bf16 v[84:87], a[152:155], v[44:51], v155
ds_read_u16 v70, v62 offset:18560
ds_read_u16 v62, v62
v_add_u32_sdwa v63, s42, v135 dst_sel:DWORD dst_unused:UNUSED_PAD src0_sel:DWORD src1_sel:WORD_1
v_smfmac_f32_16x16x64_bf16 v[88:91], a[156:159], v[44:51], v155 abid:1
s_mov_b32 s98, 7168
buffer_load_dwordx4 v[166:169], v113, s[24:27], s98 offen sc1
ds_read_u16 v71, v63 offset:18560
ds_read_u16 v63, v63
v_add_u32_sdwa v64, s42, v136 dst_sel:DWORD dst_unused:UNUSED_PAD src0_sel:DWORD src1_sel:WORD_0
v_smfmac_f32_16x16x64_bf16 v[92:95], a[160:163], v[44:51], v156
ds_read_u16 v72, v64 offset:18560
ds_read_u16 v64, v64
v_add_u32_sdwa v65, s42, v136 dst_sel:DWORD dst_unused:UNUSED_PAD src0_sel:DWORD src1_sel:WORD_1
v_smfmac_f32_16x16x64_bf16 v[96:99], a[164:167], v[44:51], v156 abid:1
ds_read_u16 v73, v65 offset:18560
ds_read_u16 v65, v65
v_add_u32_sdwa v66, s42, v137 dst_sel:DWORD dst_unused:UNUSED_PAD src0_sel:DWORD src1_sel:WORD_0
v_smfmac_f32_16x16x64_bf16 v[100:103], a[168:171], v[44:51], v157
s_mov_b32 s98, 8192
buffer_load_dwordx4 v[170:173], v113, s[24:27], s98 offen sc1
ds_read_u16 v74, v66 offset:18560
ds_read_u16 v66, v66
v_add_u32_sdwa v67, s42, v137 dst_sel:DWORD dst_unused:UNUSED_PAD src0_sel:DWORD src1_sel:WORD_1
v_smfmac_f32_16x16x64_bf16 v[104:107], a[172:175], v[44:51], v157 abid:1
ds_read_u16 v75, v67 offset:18560
ds_read_u16 v67, v67
v_smfmac_f32_16x16x64_bf16 v[108:111], a[176:179], v[44:51], v176
s_mov_b32 s99, 69632
buffer_load_dwordx4 v[214:217], v112, s[24:27], s99 offen offset:3072 sc1
ds_read_b128 v[114:117], v2 offset:320
s_waitcnt lgkmcnt(15)
v_smfmac_f32_16x16x64_bf16 v[8:11], a[144:147], v[52:59], v154
ds_read_b128 v[44:47], v0 offset:10240
v_smfmac_f32_16x16x64_bf16 v[12:15], a[148:151], v[52:59], v154 abid:1
s_mov_b32 s99, 81920
buffer_load_dwordx4 v[250:253], v112, s[24:27], s99 offen offset:0 sc1
ds_read_b128 v[48:51], v1 offset:10240
v_smfmac_f32_16x16x64_bf16 v[16:19], a[152:155], v[52:59], v155
v_smfmac_f32_16x16x64_bf16 v[20:23], a[156:159], v[52:59], v155 abid:1
v_smfmac_f32_16x16x64_bf16 v[24:27], a[160:163], v[52:59], v156
s_mov_b32 s99, 61440
buffer_load_dwordx4 a[252:255], v112, s[24:27], s99 offen offset:3072 sc1
v_smfmac_f32_16x16x64_bf16 v[28:31], a[164:167], v[52:59], v156 abid:1
v_smfmac_f32_16x16x64_bf16 v[32:35], a[168:171], v[52:59], v157
s_mov_b32 s99, 73728
buffer_load_dwordx4 v[218:221], v112, s[24:27], s99 offen offset:0 sc1
v_smfmac_f32_16x16x64_bf16 v[36:39], a[172:175], v[52:59], v157 abid:1
v_smfmac_f32_16x16x64_bf16 v[40:43], a[176:179], v[52:59], v176
s_mov_b32 s99, 65536
buffer_load_dwordx4 v[186:189], v112, s[24:27], s99 offen offset:0 sc1
s_waitcnt lgkmcnt(2)
v_smfmac_f32_16x16x64_bf16 v[36:39], v[114:117], v[68:75], v184 abid:1
v_smfmac_f32_16x16x64_bf16 v[40:43], v[114:117], v[68:75], v185
v_smfmac_f32_16x16x64_bf16 v[104:107], v[114:117], v[60:67], v184 abid:1
s_mov_b32 s99, 73728
buffer_load_dwordx4 v[222:225], v112, s[24:27], s99 offen offset:1024 sc1
v_smfmac_f32_16x16x64_bf16 v[108:111], v[114:117], v[60:67], v185
s_waitcnt lgkmcnt(0)
s_waitcnt vmcnt(18)
v_smfmac_f32_16x16x64_bf16 v[76:79], a[180:183], v[44:51], v158
s_mov_b32 s99, 65536
buffer_load_dwordx4 v[190:193], v112, s[24:27], s99 offen offset:1024 sc1
ds_read_b128 v[52:55], v0 offset:28800
ds_read_b128 v[56:59], v1 offset:28800
v_smfmac_f32_16x16x64_bf16 v[80:83], a[184:187], v[44:51], v158 abid:1
v_smfmac_f32_16x16x64_bf16 v[84:87], a[188:191], v[44:51], v159
s_mov_b32 s99, 73728
buffer_load_dwordx4 v[226:229], v112, s[24:27], s99 offen offset:2048 sc1
ds_read_b128 v[60:63], v0 offset:32896
v_smfmac_f32_16x16x64_bf16 v[88:91], a[192:195], v[44:51], v159 abid:1
ds_read_b128 v[64:67], v1 offset:32896
v_smfmac_f32_16x16x64_bf16 v[92:95], a[196:199], v[44:51], v160
v_smfmac_f32_16x16x64_bf16 v[96:99], a[200:203], v[44:51], v160 abid:1
s_mov_b32 s99, 65536
buffer_load_dwordx4 v[194:197], v112, s[24:27], s99 offen offset:2048 sc1
v_smfmac_f32_16x16x64_bf16 v[100:103], a[204:207], v[44:51], v161
v_smfmac_f32_16x16x64_bf16 v[104:107], a[208:211], v[44:51], v161 abid:1
s_mov_b32 s99, 73728
buffer_load_dwordx4 v[230:233], v112, s[24:27], s99 offen offset:3072 sc1
v_smfmac_f32_16x16x64_bf16 v[108:111], a[212:215], v[44:51], v176 abid:1
s_waitcnt lgkmcnt(2)
v_smfmac_f32_16x16x64_bf16 v[8:11], a[180:183], v[52:59], v158
s_mov_b32 s99, 65536
buffer_load_dwordx4 v[198:201], v112, s[24:27], s99 offen offset:3072 sc1
ds_read_b128 v[44:47], v0 offset:12288
v_smfmac_f32_16x16x64_bf16 v[12:15], a[184:187], v[52:59], v158 abid:1
ds_read_b128 v[48:51], v1 offset:12288
v_smfmac_f32_16x16x64_bf16 v[16:19], a[188:191], v[52:59], v159
v_smfmac_f32_16x16x64_bf16 v[20:23], a[192:195], v[52:59], v159 abid:1
s_mov_b32 s99, 77824
buffer_load_dwordx4 v[234:237], v112, s[24:27], s99 offen offset:0 sc1
v_smfmac_f32_16x16x64_bf16 v[24:27], a[196:199], v[52:59], v160
v_smfmac_f32_16x16x64_bf16 v[28:31], a[200:203], v[52:59], v160 abid:1
s_mov_b32 s99, 69632
buffer_load_dwordx4 v[202:205], v112, s[24:27], s99 offen offset:0 sc1
v_smfmac_f32_16x16x64_bf16 v[32:35], a[204:207], v[52:59], v161
v_smfmac_f32_16x16x64_bf16 v[36:39], a[208:211], v[52:59], v161 abid:1
s_mov_b32 s99, 77824
buffer_load_dwordx4 v[238:241], v112, s[24:27], s99 offen offset:1024 sc1
v_smfmac_f32_16x16x64_bf16 v[40:43], a[212:215], v[52:59], v176 abid:1
s_waitcnt lgkmcnt(0)
s_waitcnt vmcnt(18)
v_smfmac_f32_16x16x64_bf16 v[76:79], a[216:219], v[44:51], v162
ds_read_b128 v[52:55], v0 offset:30848
ds_read_b128 v[56:59], v1 offset:30848
v_smfmac_f32_16x16x64_bf16 v[80:83], a[220:223], v[44:51], v162 abid:1
s_mov_b32 s99, 69632
buffer_load_dwordx4 v[206:209], v112, s[24:27], s99 offen offset:1024 sc1
v_smfmac_f32_16x16x64_bf16 v[84:87], a[224:227], v[44:51], v163
ds_read_b128 v[68:71], v0 offset:34944
v_smfmac_f32_16x16x64_bf16 v[88:91], a[228:231], v[44:51], v163 abid:1
s_mov_b32 s99, 77824
buffer_load_dwordx4 v[242:245], v112, s[24:27], s99 offen offset:2048 sc1
ds_read_b128 v[72:75], v1 offset:34944
v_smfmac_f32_16x16x64_bf16 v[92:95], a[232:235], v[44:51], v164
v_smfmac_f32_16x16x64_bf16 v[96:99], a[236:239], v[44:51], v164 abid:1
s_mov_b32 s99, 69632
buffer_load_dwordx4 v[210:213], v112, s[24:27], s99 offen offset:2048 sc1
v_smfmac_f32_16x16x64_bf16 v[100:103], a[240:243], v[44:51], v165
s_waitcnt vmcnt(18)
v_smfmac_f32_16x16x64_bf16 v[104:107], a[244:247], v[44:51], v165 abid:1
v_smfmac_f32_16x16x64_bf16 v[108:111], a[248:251], v[44:51], v177
s_mov_b32 s99, 77824
buffer_load_dwordx4 v[246:249], v112, s[24:27], s99 offen offset:3072 sc1
s_waitcnt lgkmcnt(2)
v_smfmac_f32_16x16x64_bf16 v[8:11], a[216:219], v[52:59], v162
ds_read_b128 v[44:47], v0 offset:14336
v_smfmac_f32_16x16x64_bf16 v[12:15], a[220:223], v[52:59], v162 abid:1
ds_read_b128 v[48:51], v1 offset:14336
v_smfmac_f32_16x16x64_bf16 v[16:19], a[224:227], v[52:59], v163
v_smfmac_f32_16x16x64_bf16 v[20:23], a[228:231], v[52:59], v163 abid:1
v_smfmac_f32_16x16x64_bf16 v[24:27], a[232:235], v[52:59], v164
v_smfmac_f32_16x16x64_bf16 v[28:31], a[236:239], v[52:59], v164 abid:1
v_smfmac_f32_16x16x64_bf16 v[32:35], a[240:243], v[52:59], v165
v_smfmac_f32_16x16x64_bf16 v[36:39], a[244:247], v[52:59], v165 abid:1
v_smfmac_f32_16x16x64_bf16 v[40:43], a[248:251], v[52:59], v177
ds_read_b128 v[52:55], v0 offset:16384
ds_read_b128 v[56:59], v1 offset:16384
s_waitcnt lgkmcnt(2)
s_waitcnt vmcnt(17)
v_smfmac_f32_16x16x64_bf16 v[108:111], v[214:217], v[44:51], v177 abid:1
s_waitcnt lgkmcnt(0)
s_waitcnt vmcnt(16)
v_smfmac_f32_16x16x64_bf16 v[108:111], v[250:253], v[52:59], v178
v_add_u32 v0, 37120, v0
v_add_u32 v1, 37120, v1
s_waitcnt vmcnt(15)
v_smfmac_f32_16x16x64_bf16 v[76:79], a[252:255], v[44:51], v166
s_waitcnt vmcnt(14)
v_smfmac_f32_16x16x64_bf16 v[76:79], v[218:221], v[52:59], v170
s_nop 1
v_cvt_pk_bf16_f32 v108, v108, v109
v_cvt_pk_bf16_f32 v109, v110, v111
ds_bpermute_b32 v108, v6, v108
ds_bpermute_b32 v109, v6, v109
s_waitcnt vmcnt(13)
v_smfmac_f32_16x16x64_bf16 v[80:83], v[186:189], v[44:51], v166 abid:1
s_waitcnt vmcnt(12)
v_smfmac_f32_16x16x64_bf16 v[80:83], v[222:225], v[52:59], v170 abid:1
v_cvt_pk_bf16_f32 v76, v76, v77
v_cvt_pk_bf16_f32 v77, v78, v79
s_waitcnt vmcnt(11)
v_smfmac_f32_16x16x64_bf16 v[84:87], v[190:193], v[44:51], v167
s_waitcnt vmcnt(10)
v_smfmac_f32_16x16x64_bf16 v[84:87], v[226:229], v[52:59], v171
s_nop 1
v_cvt_pk_bf16_f32 v78, v80, v81
v_cvt_pk_bf16_f32 v79, v82, v83
s_waitcnt lgkmcnt(0)
buffer_store_dwordx2 v[108:109], v5, s[20:23], s46 offen
s_waitcnt vmcnt(10)
v_smfmac_f32_16x16x64_bf16 v[88:91], v[194:197], v[44:51], v167 abid:1
s_waitcnt vmcnt(9)
v_smfmac_f32_16x16x64_bf16 v[88:91], v[230:233], v[52:59], v171 abid:1
v_cvt_pk_bf16_f32 v80, v84, v85
v_cvt_pk_bf16_f32 v81, v86, v87
s_waitcnt vmcnt(8)
v_smfmac_f32_16x16x64_bf16 v[92:95], v[198:201], v[44:51], v168
s_waitcnt vmcnt(7)
v_smfmac_f32_16x16x64_bf16 v[92:95], v[234:237], v[52:59], v172
s_nop 1
v_cvt_pk_bf16_f32 v82, v88, v89
v_cvt_pk_bf16_f32 v83, v90, v91
v_cndmask_b32_dpp v114, v80, v76, vcc quad_perm:[1,0,3,2] row_mask:0xf bank_mask:0xf
v_cndmask_b32_dpp v115, v81, v77, vcc quad_perm:[1,0,3,2] row_mask:0xf bank_mask:0xf
v_cndmask_b32_dpp v116, v82, v78, vcc quad_perm:[1,0,3,2] row_mask:0xf bank_mask:0xf
v_cndmask_b32_dpp v117, v83, v79, vcc quad_perm:[1,0,3,2] row_mask:0xf bank_mask:0xf
buffer_store_dwordx4 v[114:117], v4, s[20:23], s46 offen offset:0 sc1
s_mov_b64 vcc, s[82:83]
s_waitcnt vmcnt(7)
v_smfmac_f32_16x16x64_bf16 v[96:99], v[202:205], v[44:51], v168 abid:1
s_waitcnt vmcnt(6)
v_smfmac_f32_16x16x64_bf16 v[96:99], v[238:241], v[52:59], v172 abid:1
v_cvt_pk_bf16_f32 v84, v92, v93
v_cvt_pk_bf16_f32 v85, v94, v95
v_cndmask_b32_dpp v80, v76, v80, vcc quad_perm:[1,0,3,2] row_mask:0xf bank_mask:0xf
v_cndmask_b32_dpp v81, v77, v81, vcc quad_perm:[1,0,3,2] row_mask:0xf bank_mask:0xf
v_cndmask_b32_dpp v82, v78, v82, vcc quad_perm:[1,0,3,2] row_mask:0xf bank_mask:0xf
v_cndmask_b32_dpp v83, v79, v83, vcc quad_perm:[1,0,3,2] row_mask:0xf bank_mask:0xf
buffer_store_dwordx4 v[80:83], v4, s[20:23], s46 offen offset:1152 sc1
s_mov_b64 vcc, s[80:81]
s_waitcnt vmcnt(6)
v_smfmac_f32_16x16x64_bf16 v[100:103], v[206:209], v[44:51], v169
s_waitcnt vmcnt(5)
v_smfmac_f32_16x16x64_bf16 v[100:103], v[242:245], v[52:59], v173
v_cvt_pk_bf16_f32 v86, v96, v97
v_cvt_pk_bf16_f32 v87, v98, v99
v_add_u32_sdwa v76, s4, v118 dst_sel:DWORD dst_unused:UNUSED_PAD src0_sel:DWORD src1_sel:WORD_0
v_add_u32_sdwa v77, s4, v118 dst_sel:DWORD dst_unused:UNUSED_PAD src0_sel:DWORD src1_sel:WORD_1
v_add_u32_sdwa v78, s4, v119 dst_sel:DWORD dst_unused:UNUSED_PAD src0_sel:DWORD src1_sel:WORD_0
v_add_u32_sdwa v79, s4, v119 dst_sel:DWORD dst_unused:UNUSED_PAD src0_sel:DWORD src1_sel:WORD_1
s_waitcnt vmcnt(4)
v_smfmac_f32_16x16x64_bf16 v[104:107], v[210:213], v[44:51], v169 abid:1
s_waitcnt vmcnt(3)
v_smfmac_f32_16x16x64_bf16 v[104:107], v[246:249], v[52:59], v173 abid:1
v_cvt_pk_bf16_f32 v88, v100, v101
v_cvt_pk_bf16_f32 v89, v102, v103
v_add_u32_sdwa v80, s4, v120 dst_sel:DWORD dst_unused:UNUSED_PAD src0_sel:DWORD src1_sel:WORD_0
v_add_u32_sdwa v81, s4, v120 dst_sel:DWORD dst_unused:UNUSED_PAD src0_sel:DWORD src1_sel:WORD_1
v_add_u32_sdwa v82, s4, v121 dst_sel:DWORD dst_unused:UNUSED_PAD src0_sel:DWORD src1_sel:WORD_0
v_add_u32_sdwa v83, s4, v121 dst_sel:DWORD dst_unused:UNUSED_PAD src0_sel:DWORD src1_sel:WORD_1
s_nop 1
v_cvt_pk_bf16_f32 v90, v104, v105
v_cvt_pk_bf16_f32 v91, v106, v107
v_cndmask_b32_dpp v92, v88, v84, vcc quad_perm:[1,0,3,2] row_mask:0xf bank_mask:0xf
v_cndmask_b32_dpp v93, v89, v85, vcc quad_perm:[1,0,3,2] row_mask:0xf bank_mask:0xf
v_cndmask_b32_dpp v94, v90, v86, vcc quad_perm:[1,0,3,2] row_mask:0xf bank_mask:0xf
v_cndmask_b32_dpp v95, v91, v87, vcc quad_perm:[1,0,3,2] row_mask:0xf bank_mask:0xf
buffer_store_dwordx4 v[92:95], v4, s[20:23], s46 offen offset:128 sc1
s_mov_b64 vcc, s[82:83]
v_cndmask_b32_dpp v88, v84, v88, vcc quad_perm:[1,0,3,2] row_mask:0xf bank_mask:0xf
v_cndmask_b32_dpp v89, v85, v89, vcc quad_perm:[1,0,3,2] row_mask:0xf bank_mask:0xf
v_cndmask_b32_dpp v90, v86, v90, vcc quad_perm:[1,0,3,2] row_mask:0xf bank_mask:0xf
v_cndmask_b32_dpp v91, v87, v91, vcc quad_perm:[1,0,3,2] row_mask:0xf bank_mask:0xf
buffer_store_dwordx4 v[88:91], v4, s[20:23], s46 offen offset:1280 sc1
s_mov_b64 vcc, s[80:81]
s_bfe_u32 s88, s85, 0x40018
s_cbranch_scc0 L_pf2_e
L_pf2:
s_add_u32 m0, s44, 0
s_nop 0
buffer_load_dwordx4 v3, s[16:19], s45 offen offset:0 nt lds
s_add_u32 m0, s44, 3840
s_nop 0
buffer_load_dwordx4 v3, s[16:19], s45 offen offset:256 nt lds
s_add_u32 m0, s44, 7680
s_nop 0
buffer_load_dwordx4 v3, s[16:19], s45 offen offset:512 nt lds
s_add_u32 m0, s44, 11520
s_nop 0
buffer_load_dwordx4 v3, s[16:19], s45 offen offset:768 nt lds
s_add_u32 m0, s44, s8
s_mov_b64 exec, s[10:11]
buffer_load_dwordx4 v3, s[16:19], s7 offen offset:896 nt lds
s_mov_b64 exec, -1
s_add_u32 s7, s7, s13
s_add_u32 s44, s44, 18560
s_add_u32 s45, s45, s13
s_mov_b32 s13, 4718592
s_sub_u32 s88, s88, 1
s_cmp_lg_u32 s88, 0
s_cbranch_scc1 L_pf2
L_pf2_e:
s_cmp_ge_u32 s44, 148480
s_cselect_b32 s44, s9, s44
s_add_u32 s46, s46, 4718592
s_waitcnt lgkmcnt(0)
s_barrier
s_cmp_lg_u32 s89, 0
s_cbranch_scc1 L_loopnk_p3
s_branch L_loopn_p3
.p2align 6
L_loop:
v_smfmac_f32_16x16x64_bf16 v[8:11], a[0:3], v[44:51], v138
ds_read_b128 v[32:35], v2 offset:1408
v_cvt_pk_bf16_f32 v106, v36, v37
v_smfmac_f32_16x16x64_bf16 v[8:11], a[36:39], v[52:59], v142
s_waitcnt lgkmcnt(9)
v_cvt_pk_bf16_f32 v107, v38, v39
v_smfmac_f32_16x16x64_bf16 v[12:15], a[4:7], v[44:51], v138 abid:1
ds_read_b128 v[36:39], v2 offset:1472
v_cvt_pk_bf16_f32 v112, v40, v41
v_smfmac_f32_16x16x64_bf16 v[12:15], a[40:43], v[52:59], v142 abid:1
s_waitcnt lgkmcnt(8)
ds_read_b128 v[60:63], v0 offset:4096
v_cvt_pk_bf16_f32 v113, v42, v43
v_smfmac_f32_16x16x64_bf16 v[16:19], a[8:11], v[44:51], v139
s_cmp_eq_u32 s4, 129920
ds_read_b128 v[40:43], v2 offset:1536
v_cndmask_b32_dpp v108, v96, v92, vcc quad_perm:[1,0,3,2] row_mask:0xf bank_mask:0xf
v_smfmac_f32_16x16x64_bf16 v[16:19], a[44:47], v[52:59], v143
s_waitcnt lgkmcnt(8)
ds_read_u16 v82, v82
v_cndmask_b32_dpp v109, v97, v93, vcc quad_perm:[1,0,3,2] row_mask:0xf bank_mask:0xf
v_smfmac_f32_16x16x64_bf16 v[20:23], a[12:15], v[44:51], v139 abid:1
s_cselect_b32 s43, -129920, s5
ds_read_u16 v84, v84
v_cndmask_b32_dpp v110, v98, v94, vcc quad_perm:[1,0,3,2] row_mask:0xf bank_mask:0xf
v_smfmac_f32_16x16x64_bf16 v[20:23], a[48:51], v[52:59], v143 abid:1
s_waitcnt lgkmcnt(8)
ds_read_b128 v[64:67], v1 offset:4096
v_cndmask_b32_dpp v111, v99, v95, vcc quad_perm:[1,0,3,2] row_mask:0xf bank_mask:0xf
v_smfmac_f32_16x16x64_bf16 v[24:27], a[16:19], v[44:51], v140
s_add_u32 s4, s4, s43
ds_read_b128 v[68:71], v0 offset:6144
v_add_u32_sdwa v87, s42, v123 dst_sel:DWORD dst_unused:UNUSED_PAD src0_sel:DWORD src1_sel:WORD_1
v_smfmac_f32_16x16x64_bf16 v[24:27], a[52:55], v[52:59], v144
buffer_store_dwordx4 v[108:111], v4, s[20:23], s46 offen offset:0 sc1
s_mov_b64 vcc, s[82:83]
s_waitcnt lgkmcnt(8)
ds_read_b128 v[72:75], v1 offset:6144
v_cndmask_b32_dpp v96, v92, v96, vcc quad_perm:[1,0,3,2] row_mask:0xf bank_mask:0xf
v_cndmask_b32_dpp v97, v93, v97, vcc quad_perm:[1,0,3,2] row_mask:0xf bank_mask:0xf
v_smfmac_f32_16x16x64_bf16 v[28:31], a[20:23], v[44:51], v140 abid:1
s_add_u32 s41, s41, 1
ds_read_u16 v83, v83
v_cndmask_b32_dpp v98, v94, v98, vcc quad_perm:[1,0,3,2] row_mask:0xf bank_mask:0xf
v_smfmac_f32_16x16x64_bf16 v[28:31], a[56:59], v[52:59], v144 abid:1
s_waitcnt lgkmcnt(9)
ds_read_b128 v[114:117], v2 offset:64
v_cndmask_b32_dpp v99, v95, v99, vcc quad_perm:[1,0,3,2] row_mask:0xf bank_mask:0xf
v_smfmac_f32_16x16x64_bf16 v[32:35], a[24:27], v[44:51], v141
ds_read_u16 v85, v85
v_add_u32_sdwa v88, s42, v124 dst_sel:DWORD dst_unused:UNUSED_PAD src0_sel:DWORD src1_sel:WORD_0
v_smfmac_f32_16x16x64_bf16 v[32:35], a[60:63], v[52:59], v145
s_waitcnt lgkmcnt(10)
ds_read_u16 v86, v86
v_add_u32_sdwa v89, s42, v124 dst_sel:DWORD dst_unused:UNUSED_PAD src0_sel:DWORD src1_sel:WORD_1
v_smfmac_f32_16x16x64_bf16 v[36:39], a[28:31], v[44:51], v141 abid:1
ds_read_u16 v87, v87
v_add_u32_sdwa v90, s42, v125 dst_sel:DWORD dst_unused:UNUSED_PAD src0_sel:DWORD src1_sel:WORD_0
v_smfmac_f32_16x16x64_bf16 v[36:39], a[64:67], v[52:59], v145 abid:1
s_waitcnt lgkmcnt(10)
ds_read_u16 v88, v88
v_add_u32_sdwa v91, s42, v125 dst_sel:DWORD dst_unused:UNUSED_PAD src0_sel:DWORD src1_sel:WORD_1
v_smfmac_f32_16x16x64_bf16 v[40:43], a[32:35], v[44:51], v174
buffer_store_dwordx4 v[96:99], v4, s[20:23], s46 offen offset:1152 sc1
s_mov_b64 vcc, s[80:81]
ds_read_u16 v89, v89
v_cndmask_b32_dpp v92, v104, v100, vcc quad_perm:[1,0,3,2] row_mask:0xf bank_mask:0xf
v_cndmask_b32_dpp v93, v105, v101, vcc quad_perm:[1,0,3,2] row_mask:0xf bank_mask:0xf
v_smfmac_f32_16x16x64_bf16 v[40:43], a[68:71], v[52:59], v174 abid:1
s_waitcnt lgkmcnt(9)
ds_read_u16 v90, v90
v_cndmask_b32_dpp v94, v106, v102, vcc quad_perm:[1,0,3,2] row_mask:0xf bank_mask:0xf
v_smfmac_f32_16x16x64_bf16 v[8:11], a[72:75], v[60:67], v146
s_waitcnt lgkmcnt(8)
ds_read_u16 v91, v91
v_cndmask_b32_dpp v95, v107, v103, vcc quad_perm:[1,0,3,2] row_mask:0xf bank_mask:0xf
v_smfmac_f32_16x16x64_bf16 v[8:11], a[108:111], v[68:75], v150
s_waitcnt lgkmcnt(7)
ds_bpermute_b32 v112, v6, v112
v_smfmac_f32_16x16x64_bf16 v[8:11], v[114:117], v[76:83], v179
s_waitcnt vmcnt(2)
ds_bpermute_b32 v113, v6, v113
v_smfmac_f32_16x16x64_bf16 v[12:15], v[114:117], v[76:83], v179 abid:1
ds_read_b128 v[114:117], v2 offset:128
v_add_u32_sdwa v76, s42, v126 dst_sel:DWORD dst_unused:UNUSED_PAD src0_sel:DWORD src1_sel:WORD_0
v_smfmac_f32_16x16x64_bf16 v[12:15], a[76:79], v[60:67], v146 abid:1
ds_read_u16 v76, v76
v_add_u32_sdwa v77, s42, v126 dst_sel:DWORD dst_unused:UNUSED_PAD src0_sel:DWORD src1_sel:WORD_1
v_smfmac_f32_16x16x64_bf16 v[12:15], a[112:115], v[68:75], v150 abid:1
buffer_store_dwordx4 v[92:95], v4, s[20:23], s46 offen offset:128 sc1
s_mov_b64 vcc, s[82:83]
ds_read_u16 v77, v77
v_cndmask_b32_dpp v104, v100, v104, vcc quad_perm:[1,0,3,2] row_mask:0xf bank_mask:0xf
v_add_u32_sdwa v78, s42, v127 dst_sel:DWORD dst_unused:UNUSED_PAD src0_sel:DWORD src1_sel:WORD_0
v_smfmac_f32_16x16x64_bf16 v[24:27], a[88:91], v[60:67], v148
ds_read_u16 v78, v78
v_cndmask_b32_dpp v105, v101, v105, vcc quad_perm:[1,0,3,2] row_mask:0xf bank_mask:0xf
v_smfmac_f32_16x16x64_bf16 v[24:27], a[124:127], v[68:75], v152
ds_read_b128 v[44:47], v0 offset:8192
v_cndmask_b32_dpp v106, v102, v106, vcc quad_perm:[1,0,3,2] row_mask:0xf bank_mask:0xf
v_smfmac_f32_16x16x64_bf16 v[28:31], a[92:95], v[60:67], v148 abid:1
ds_read_b128 v[48:51], v1 offset:8192
v_add_u32_sdwa v79, s42, v127 dst_sel:DWORD dst_unused:UNUSED_PAD src0_sel:DWORD src1_sel:WORD_1
v_smfmac_f32_16x16x64_bf16 v[28:31], a[128:131], v[68:75], v152 abid:1
ds_read_u16 v79, v79
v_cndmask_b32_dpp v107, v103, v107, vcc quad_perm:[1,0,3,2] row_mask:0xf bank_mask:0xf
v_smfmac_f32_16x16x64_bf16 v[32:35], a[96:99], v[60:67], v149
ds_read_b128 v[52:55], v0 offset:10240
v_add_u32_sdwa v80, s42, v128 dst_sel:DWORD dst_unused:UNUSED_PAD src0_sel:DWORD src1_sel:WORD_0
v_smfmac_f32_16x16x64_bf16 v[32:35], a[132:135], v[68:75], v153
ds_read_u16 v80, v80
v_add_u32_sdwa v81, s42, v128 dst_sel:DWORD dst_unused:UNUSED_PAD src0_sel:DWORD src1_sel:WORD_1
v_smfmac_f32_16x16x64_bf16 v[16:19], a[80:83], v[60:67], v147
buffer_store_dwordx4 v[104:107], v4, s[20:23], s46 offen offset:1280 sc1
s_mov_b64 vcc, s[80:81]
ds_read_b128 v[56:59], v1 offset:10240
v_add_u32_sdwa v82, s42, v129 dst_sel:DWORD dst_unused:UNUSED_PAD src0_sel:DWORD src1_sel:WORD_0
v_add_u32_sdwa v83, s42, v129 dst_sel:DWORD dst_unused:UNUSED_PAD src0_sel:DWORD src1_sel:WORD_1
v_smfmac_f32_16x16x64_bf16 v[16:19], a[116:119], v[68:75], v151
s_waitcnt lgkmcnt(9)
ds_read_b128 v[92:95], v0 offset:12288
v_add_u32_sdwa v100, s42, v130 dst_sel:DWORD dst_unused:UNUSED_PAD src0_sel:DWORD src1_sel:WORD_0
v_smfmac_f32_16x16x64_bf16 v[16:19], v[114:117], v[84:91], v180 abid:1
ds_read_u16 v81, v81
v_add_u32_sdwa v101, s42, v130 dst_sel:DWORD dst_unused:UNUSED_PAD src0_sel:DWORD src1_sel:WORD_1
v_smfmac_f32_16x16x64_bf16 v[20:23], v[114:117], v[84:91], v181
ds_read_b128 v[96:99], v1 offset:12288
v_add_u32_sdwa v102, s42, v131 dst_sel:DWORD dst_unused:UNUSED_PAD src0_sel:DWORD src1_sel:WORD_0
v_smfmac_f32_16x16x64_bf16 v[20:23], a[84:87], v[60:67], v147 abid:1
ds_read_u16 v100, v100
v_add_u32_sdwa v103, s42, v131 dst_sel:DWORD dst_unused:UNUSED_PAD src0_sel:DWORD src1_sel:WORD_1
v_smfmac_f32_16x16x64_bf16 v[20:23], a[120:123], v[68:75], v151 abid:1
ds_read_u16 v82, v82
v_add_u32_sdwa v104, s42, v132 dst_sel:DWORD dst_unused:UNUSED_PAD src0_sel:DWORD src1_sel:WORD_0
v_smfmac_f32_16x16x64_bf16 v[36:39], a[100:103], v[60:67], v149 abid:1
ds_read_u16 v101, v101
v_add_u32_sdwa v105, s42, v132 dst_sel:DWORD dst_unused:UNUSED_PAD src0_sel:DWORD src1_sel:WORD_1
v_smfmac_f32_16x16x64_bf16 v[36:39], a[136:139], v[68:75], v153 abid:1
buffer_store_dwordx2 v[112:113], v5, s[20:23], s46 offen
ds_read_u16 v83, v83
v_add_u32_sdwa v106, s42, v133 dst_sel:DWORD dst_unused:UNUSED_PAD src0_sel:DWORD src1_sel:WORD_0
v_smfmac_f32_16x16x64_bf16 v[40:43], a[104:107], v[60:67], v175
s_mov_b32 s22, 75497472
ds_read_b128 v[114:117], v2 offset:192
v_add_u32_sdwa v107, s42, v133 dst_sel:DWORD dst_unused:UNUSED_PAD src0_sel:DWORD src1_sel:WORD_1
v_smfmac_f32_16x16x64_bf16 v[40:43], a[140:143], v[68:75], v175 abid:1
s_waitcnt lgkmcnt(12)
ds_read_u16 v102, v102
v_add_u32_sdwa v84, s42, v134 dst_sel:DWORD dst_unused:UNUSED_PAD src0_sel:DWORD src1_sel:WORD_0
v_smfmac_f32_16x16x64_bf16 v[8:11], a[144:147], v[44:51], v154
s_waitcnt lgkmcnt(9)
ds_read_u16 v103, v103
v_add_u32_sdwa v85, s42, v134 dst_sel:DWORD dst_unused:UNUSED_PAD src0_sel:DWORD src1_sel:WORD_1
v_smfmac_f32_16x16x64_bf16 v[8:11], a[180:183], v[52:59], v158
s_waitcnt lgkmcnt(7)
ds_read_u16 v104, v104
v_add_u32_sdwa v86, s42, v135 dst_sel:DWORD dst_unused:UNUSED_PAD src0_sel:DWORD src1_sel:WORD_0
v_smfmac_f32_16x16x64_bf16 v[8:11], a[216:219], v[92:99], v162
s_mov_b32 s46, s48
ds_read_u16 v105, v105
v_add_u32_sdwa v87, s42, v135 dst_sel:DWORD dst_unused:UNUSED_PAD src0_sel:DWORD src1_sel:WORD_1
v_smfmac_f32_16x16x64_bf16 v[24:27], a[160:163], v[44:51], v156
s_add_u32 m0, s44, 0
ds_read_u16 v106, v106
v_add_u32_sdwa v88, s42, v136 dst_sel:DWORD dst_unused:UNUSED_PAD src0_sel:DWORD src1_sel:WORD_0
v_smfmac_f32_16x16x64_bf16 v[24:27], a[196:199], v[52:59], v160
buffer_load_dwordx4 v3, s[16:19], s45 offen offset:0 nt lds
v_add_u32_sdwa v89, s42, v136 dst_sel:DWORD dst_unused:UNUSED_PAD src0_sel:DWORD src1_sel:WORD_1
v_smfmac_f32_16x16x64_bf16 v[24:27], a[232:235], v[92:99], v164
s_waitcnt lgkmcnt(5)
ds_read_u16 v107, v107
v_add_u32_sdwa v90, s42, v137 dst_sel:DWORD dst_unused:UNUSED_PAD src0_sel:DWORD src1_sel:WORD_0
v_smfmac_f32_16x16x64_bf16 v[24:27], v[114:117], v[76:83], v182
s_mov_b32 s48, s49
ds_read_u16 v84, v84
v_add_u32_sdwa v91, s42, v137 dst_sel:DWORD dst_unused:UNUSED_PAD src0_sel:DWORD src1_sel:WORD_1
v_smfmac_f32_16x16x64_bf16 v[28:31], v[114:117], v[76:83], v182 abid:1
s_mov_b32 s49, s50
ds_read_b128 v[114:117], v2 offset:256
v_add_u32_sdwa v76, s4, v118 dst_sel:DWORD dst_unused:UNUSED_PAD src0_sel:DWORD src1_sel:WORD_0
v_smfmac_f32_16x16x64_bf16 v[28:31], a[164:167], v[44:51], v156 abid:1
s_add_u32 s50, s50, 4718592
ds_read_u16 v85, v85
v_add_u32_sdwa v77, s4, v118 dst_sel:DWORD dst_unused:UNUSED_PAD src0_sel:DWORD src1_sel:WORD_1
v_smfmac_f32_16x16x64_bf16 v[28:31], a[200:203], v[52:59], v160 abid:1
ds_read_u16 v86, v86
v_add_u32_sdwa v78, s4, v119 dst_sel:DWORD dst_unused:UNUSED_PAD src0_sel:DWORD src1_sel:WORD_0
v_smfmac_f32_16x16x64_bf16 v[28:31], a[236:239], v[92:99], v164 abid:1
ds_read_u16 v87, v87
v_add_u32_sdwa v79, s4, v119 dst_sel:DWORD dst_unused:UNUSED_PAD src0_sel:DWORD src1_sel:WORD_1
v_smfmac_f32_16x16x64_bf16 v[12:15], a[148:151], v[44:51], v154 abid:1
s_add_u32 m0, s44, 3840
ds_read_u16 v88, v88
v_add_u32_sdwa v80, s4, v120 dst_sel:DWORD dst_unused:UNUSED_PAD src0_sel:DWORD src1_sel:WORD_0
v_smfmac_f32_16x16x64_bf16 v[12:15], a[184:187], v[52:59], v158 abid:1
buffer_load_dwordx4 v3, s[16:19], s45 offen offset:256 nt lds
v_add_u32_sdwa v81, s4, v120 dst_sel:DWORD dst_unused:UNUSED_PAD src0_sel:DWORD src1_sel:WORD_1
v_smfmac_f32_16x16x64_bf16 v[12:15], a[220:223], v[92:99], v162 abid:1
ds_read_b128 v[60:63], v0 offset:14336
v_add_u32_sdwa v82, s4, v121 dst_sel:DWORD dst_unused:UNUSED_PAD src0_sel:DWORD src1_sel:WORD_0
v_smfmac_f32_16x16x64_bf16 v[32:35], a[168:171], v[44:51], v157
ds_read_u16 v89, v89
v_add_u32_sdwa v83, s4, v121 dst_sel:DWORD dst_unused:UNUSED_PAD src0_sel:DWORD src1_sel:WORD_1
v_smfmac_f32_16x16x64_bf16 v[32:35], a[204:207], v[52:59], v161
ds_read_b128 v[64:67], v1 offset:14336
v_smfmac_f32_16x16x64_bf16 v[32:35], a[240:243], v[92:99], v165
s_waitcnt lgkmcnt(7)
ds_read_b128 v[68:71], v0 offset:16384
v_smfmac_f32_16x16x64_bf16 v[32:35], v[114:117], v[100:107], v183 abid:1
ds_read_u16 v90, v90
v_smfmac_f32_16x16x64_bf16 v[36:39], v[114:117], v[100:107], v184
ds_read_b128 v[72:75], v1 offset:16384
v_add_u32 v0, s43, v0
v_smfmac_f32_16x16x64_bf16 v[36:39], a[172:175], v[44:51], v157 abid:1
s_add_u32 m0, s44, 7680
ds_read_u16 v91, v91
v_add_u32 v1, s43, v1
v_smfmac_f32_16x16x64_bf16 v[36:39], a[208:211], v[52:59], v161 abid:1
buffer_load_dwordx4 v3, s[16:19], s45 offen offset:512 nt lds
v_smfmac_f32_16x16x64_bf16 v[36:39], a[244:247], v[92:99], v165 abid:1
ds_read_b128 v[114:117], v2 offset:320
v_smfmac_f32_16x16x64_bf16 v[16:19], a[152:155], v[44:51], v155
s_add_u32 m0, s44, 11520
v_smfmac_f32_16x16x64_bf16 v[16:19], a[188:191], v[52:59], v159
buffer_load_dwordx4 v3, s[16:19], s45 offen offset:768 nt lds
v_smfmac_f32_16x16x64_bf16 v[16:19], a[224:227], v[92:99], v163
v_smfmac_f32_16x16x64_bf16 v[20:23], a[156:159], v[44:51], v155 abid:1
s_add_u32 m0, s44, s8
v_smfmac_f32_16x16x64_bf16 v[20:23], a[192:195], v[52:59], v159 abid:1
s_mov_b64 exec, s[10:11]
buffer_load_dwordx4 v3, s[16:19], s7 offen offset:896 nt lds
s_mov_b64 exec, -1
v_smfmac_f32_16x16x64_bf16 v[20:23], a[228:231], v[92:99], v163 abid:1
s_add_u32 s45, s45, 4718592
s_add_u32 s7, s7, 4718592
s_add_u32 s44, s44, s5
v_smfmac_f32_16x16x64_bf16 v[40:43], a[176:179], v[44:51], v176
s_cmp_ge_u32 s44, 148480
s_cselect_b32 s44, s9, s44
s_bitcmp1_b32 s92, s41
v_smfmac_f32_16x16x64_bf16 v[40:43], a[212:215], v[52:59], v176 abid:1
s_cbranch_scc1 L_loop_w
L_loop_wb:
v_smfmac_f32_16x16x64_bf16 v[40:43], a[248:251], v[92:99], v177
s_waitcnt lgkmcnt(0)
v_smfmac_f32_16x16x64_bf16 v[40:43], v[114:117], v[84:91], v185
s_waitcnt vmcnt(20)
s_barrier
v_smfmac_f32_16x16x64_bf16 v[8:11], a[252:255], v[60:67], v166
s_mov_b32 s42, s4
v_smfmac_f32_16x16x64_bf16 v[8:11], v[218:221], v[68:75], v170
ds_read_b128 v[44:47], v0 offset:0
v_add_u32_sdwa v84, s42, v122 dst_sel:DWORD dst_unused:UNUSED_PAD src0_sel:DWORD src1_sel:WORD_0
v_smfmac_f32_16x16x64_bf16 v[12:15], v[186:189], v[60:67], v166 abid:1
ds_read_b128 v[48:51], v1 offset:0
v_add_u32_sdwa v85, s42, v122 dst_sel:DWORD dst_unused:UNUSED_PAD src0_sel:DWORD src1_sel:WORD_1
v_smfmac_f32_16x16x64_bf16 v[12:15], v[222:225], v[68:75], v170 abid:1
ds_read_b128 v[52:55], v0 offset:2048
v_add_u32_sdwa v86, s42, v123 dst_sel:DWORD dst_unused:UNUSED_PAD src0_sel:DWORD src1_sel:WORD_0
v_smfmac_f32_16x16x64_bf16 v[16:19], v[190:193], v[60:67], v167
ds_read_b128 v[56:59], v1 offset:2048
v_cvt_pk_bf16_f32 v92, v8, v9
v_smfmac_f32_16x16x64_bf16 v[16:19], v[226:229], v[68:75], v171
ds_read_u16 v76, v76
v_cvt_pk_bf16_f32 v93, v10, v11
v_smfmac_f32_16x16x64_bf16 v[20:23], v[194:197], v[60:67], v167 abid:1
ds_read_b128 v[8:11], v2 offset:1024
v_cvt_pk_bf16_f32 v94, v12, v13
v_smfmac_f32_16x16x64_bf16 v[20:23], v[230:233], v[68:75], v171 abid:1
ds_read_u16 v77, v77
v_cvt_pk_bf16_f32 v95, v14, v15
v_smfmac_f32_16x16x64_bf16 v[24:27], v[198:201], v[60:67], v168
ds_read_b128 v[12:15], v2 offset:1088
v_cvt_pk_bf16_f32 v96, v16, v17
v_smfmac_f32_16x16x64_bf16 v[24:27], v[234:237], v[68:75], v172
ds_read_u16 v78, v78
v_cvt_pk_bf16_f32 v97, v18, v19
v_smfmac_f32_16x16x64_bf16 v[28:31], v[202:205], v[60:67], v168 abid:1
ds_read_b128 v[16:19], v2 offset:1152
v_cvt_pk_bf16_f32 v98, v20, v21
v_smfmac_f32_16x16x64_bf16 v[28:31], v[238:241], v[68:75], v172 abid:1
ds_read_u16 v79, v79
v_cvt_pk_bf16_f32 v99, v22, v23
v_smfmac_f32_16x16x64_bf16 v[32:35], v[206:209], v[60:67], v169
ds_read_b128 v[20:23], v2 offset:1216
v_cvt_pk_bf16_f32 v100, v24, v25
v_smfmac_f32_16x16x64_bf16 v[32:35], v[242:245], v[68:75], v173
ds_read_u16 v80, v80
v_cvt_pk_bf16_f32 v101, v26, v27
v_smfmac_f32_16x16x64_bf16 v[36:39], v[210:213], v[60:67], v169 abid:1
ds_read_b128 v[24:27], v2 offset:1280
v_cvt_pk_bf16_f32 v102, v28, v29
v_smfmac_f32_16x16x64_bf16 v[36:39], v[246:249], v[68:75], v173 abid:1
ds_read_u16 v81, v81
v_cvt_pk_bf16_f32 v103, v30, v31
v_smfmac_f32_16x16x64_bf16 v[40:43], v[214:217], v[60:67], v177 abid:1
s_bitcmp1_b32 s85, s41
ds_read_b128 v[28:31], v2 offset:1344
v_cvt_pk_bf16_f32 v104, v32, v33
v_smfmac_f32_16x16x64_bf16 v[40:43], v[250:253], v[68:75], v178
s_waitcnt lgkmcnt(10)
v_cvt_pk_bf16_f32 v105, v34, v35
s_cbranch_scc1 L_loop
s_cmp_lg_u32 s41, 6
s_cbranch_scc1 L_loopn
.p2align 3
L_loopc:
v_smfmac_f32_16x16x64_bf16 v[8:11], a[0:3], v[44:51], v138
ds_read_b128 v[32:35], v2 offset:1408
v_cvt_pk_bf16_f32 v106, v36, v37
v_mov_b32 v7, 1
v_smfmac_f32_16x16x64_bf16 v[8:11], a[36:39], v[52:59], v142
s_waitcnt lgkmcnt(9)
buffer_atomic_add v7, v6, s[32:35], 0 offen sc0 sc1
v_cvt_pk_bf16_f32 v107, v38, v39
v_smfmac_f32_16x16x64_bf16 v[12:15], a[4:7], v[44:51], v138 abid:1
ds_read_b128 v[36:39], v2 offset:1472
v_cvt_pk_bf16_f32 v112, v40, v41
v_smfmac_f32_16x16x64_bf16 v[12:15], a[40:43], v[52:59], v142 abid:1
s_waitcnt lgkmcnt(8)
ds_read_b128 v[60:63], v0 offset:4096
v_cvt_pk_bf16_f32 v113, v42, v43
v_smfmac_f32_16x16x64_bf16 v[16:19], a[8:11], v[44:51], v139
s_cmp_eq_u32 s4, 129920
ds_read_b128 v[40:43], v2 offset:1536
v_cndmask_b32_dpp v108, v96, v92, vcc quad_perm:[1,0,3,2] row_mask:0xf bank_mask:0xf
v_smfmac_f32_16x16x64_bf16 v[16:19], a[44:47], v[52:59], v143
s_waitcnt lgkmcnt(8)
ds_read_u16 v82, v82
v_cndmask_b32_dpp v109, v97, v93, vcc quad_perm:[1,0,3,2] row_mask:0xf bank_mask:0xf
v_smfmac_f32_16x16x64_bf16 v[20:23], a[12:15], v[44:51], v139 abid:1
s_cselect_b32 s43, -129920, s5
ds_read_u16 v84, v84
v_cndmask_b32_dpp v110, v98, v94, vcc quad_perm:[1,0,3,2] row_mask:0xf bank_mask:0xf
v_smfmac_f32_16x16x64_bf16 v[20:23], a[48:51], v[52:59], v143 abid:1
s_waitcnt lgkmcnt(8)
ds_read_b128 v[64:67], v1 offset:4096
v_cndmask_b32_dpp v111, v99, v95, vcc quad_perm:[1,0,3,2] row_mask:0xf bank_mask:0xf
v_smfmac_f32_16x16x64_bf16 v[24:27], a[16:19], v[44:51], v140
s_add_u32 s4, s4, s43
ds_read_b128 v[68:71], v0 offset:6144
v_add_u32_sdwa v87, s42, v123 dst_sel:DWORD dst_unused:UNUSED_PAD src0_sel:DWORD src1_sel:WORD_1
v_smfmac_f32_16x16x64_bf16 v[24:27], a[52:55], v[52:59], v144
buffer_store_dwordx4 v[108:111], v4, s[20:23], s46 offen offset:0 sc1
s_mov_b64 vcc, s[82:83]
s_waitcnt lgkmcnt(8)
ds_read_b128 v[72:75], v1 offset:6144
v_cndmask_b32_dpp v96, v92, v96, vcc quad_perm:[1,0,3,2] row_mask:0xf bank_mask:0xf
v_cndmask_b32_dpp v97, v93, v97, vcc quad_perm:[1,0,3,2] row_mask:0xf bank_mask:0xf
v_smfmac_f32_16x16x64_bf16 v[28:31], a[20:23], v[44:51], v140 abid:1
s_add_u32 s7, s45, s58
ds_read_u16 v83, v83
v_cndmask_b32_dpp v98, v94, v98, vcc quad_perm:[1,0,3,2] row_mask:0xf bank_mask:0xf
v_smfmac_f32_16x16x64_bf16 v[28:31], a[56:59], v[52:59], v144 abid:1
s_waitcnt lgkmcnt(9)
ds_read_b128 v[114:117], v2 offset:64
v_cndmask_b32_dpp v99, v95, v99, vcc quad_perm:[1,0,3,2] row_mask:0xf bank_mask:0xf
v_smfmac_f32_16x16x64_bf16 v[32:35], a[24:27], v[44:51], v141
ds_read_u16 v85, v85
v_add_u32_sdwa v88, s42, v124 dst_sel:DWORD dst_unused:UNUSED_PAD src0_sel:DWORD src1_sel:WORD_0
v_smfmac_f32_16x16x64_bf16 v[32:35], a[60:63], v[52:59], v145
s_waitcnt lgkmcnt(10)
ds_read_u16 v86, v86
v_add_u32_sdwa v89, s42, v124 dst_sel:DWORD dst_unused:UNUSED_PAD src0_sel:DWORD src1_sel:WORD_1
v_smfmac_f32_16x16x64_bf16 v[36:39], a[28:31], v[44:51], v141 abid:1
ds_read_u16 v87, v87
v_add_u32_sdwa v90, s42, v125 dst_sel:DWORD dst_unused:UNUSED_PAD src0_sel:DWORD src1_sel:WORD_0
v_smfmac_f32_16x16x64_bf16 v[36:39], a[64:67], v[52:59], v145 abid:1
s_waitcnt lgkmcnt(10)
ds_read_u16 v88, v88
v_add_u32_sdwa v91, s42, v125 dst_sel:DWORD dst_unused:UNUSED_PAD src0_sel:DWORD src1_sel:WORD_1
v_smfmac_f32_16x16x64_bf16 v[40:43], a[32:35], v[44:51], v174
buffer_store_dwordx4 v[96:99], v4, s[20:23], s46 offen offset:1152 sc1
s_mov_b64 vcc, s[80:81]
ds_read_u16 v89, v89
v_cndmask_b32_dpp v92, v104, v100, vcc quad_perm:[1,0,3,2] row_mask:0xf bank_mask:0xf
v_cndmask_b32_dpp v93, v105, v101, vcc quad_perm:[1,0,3,2] row_mask:0xf bank_mask:0xf
v_smfmac_f32_16x16x64_bf16 v[40:43], a[68:71], v[52:59], v174 abid:1
s_waitcnt lgkmcnt(9)
ds_read_u16 v90, v90
v_cndmask_b32_dpp v94, v106, v102, vcc quad_perm:[1,0,3,2] row_mask:0xf bank_mask:0xf
v_smfmac_f32_16x16x64_bf16 v[8:11], a[72:75], v[60:67], v146
s_waitcnt lgkmcnt(8)
ds_read_u16 v91, v91
v_cndmask_b32_dpp v95, v107, v103, vcc quad_perm:[1,0,3,2] row_mask:0xf bank_mask:0xf
v_smfmac_f32_16x16x64_bf16 v[8:11], a[108:111], v[68:75], v150
s_waitcnt lgkmcnt(7)
ds_bpermute_b32 v112, v6, v112
v_smfmac_f32_16x16x64_bf16 v[8:11], v[114:117], v[76:83], v179
ds_bpermute_b32 v113, v6, v113
v_smfmac_f32_16x16x64_bf16 v[12:15], v[114:117], v[76:83], v179 abid:1
ds_read_b128 v[114:117], v2 offset:128
v_add_u32_sdwa v76, s42, v126 dst_sel:DWORD dst_unused:UNUSED_PAD src0_sel:DWORD src1_sel:WORD_0
v_smfmac_f32_16x16x64_bf16 v[12:15], a[76:79], v[60:67], v146 abid:1
ds_read_u16 v76, v76
v_add_u32_sdwa v77, s42, v126 dst_sel:DWORD dst_unused:UNUSED_PAD src0_sel:DWORD src1_sel:WORD_1
v_smfmac_f32_16x16x64_bf16 v[12:15], a[112:115], v[68:75], v150 abid:1
buffer_store_dwordx4 v[92:95], v4, s[20:23], s46 offen offset:128 sc1
s_mov_b64 vcc, s[82:83]
ds_read_u16 v77, v77
v_cndmask_b32_dpp v104, v100, v104, vcc quad_perm:[1,0,3,2] row_mask:0xf bank_mask:0xf
v_add_u32_sdwa v78, s42, v127 dst_sel:DWORD dst_unused:UNUSED_PAD src0_sel:DWORD src1_sel:WORD_0
v_smfmac_f32_16x16x64_bf16 v[24:27], a[88:91], v[60:67], v148
ds_read_u16 v78, v78
v_cndmask_b32_dpp v105, v101, v105, vcc quad_perm:[1,0,3,2] row_mask:0xf bank_mask:0xf
v_smfmac_f32_16x16x64_bf16 v[24:27], a[124:127], v[68:75], v152
ds_read_b128 v[44:47], v0 offset:8192
v_cndmask_b32_dpp v106, v102, v106, vcc quad_perm:[1,0,3,2] row_mask:0xf bank_mask:0xf
v_smfmac_f32_16x16x64_bf16 v[28:31], a[92:95], v[60:67], v148 abid:1
ds_read_b128 v[48:51], v1 offset:8192
v_add_u32_sdwa v79, s42, v127 dst_sel:DWORD dst_unused:UNUSED_PAD src0_sel:DWORD src1_sel:WORD_1
v_smfmac_f32_16x16x64_bf16 v[28:31], a[128:131], v[68:75], v152 abid:1
ds_read_u16 v79, v79
v_cndmask_b32_dpp v107, v103, v107, vcc quad_perm:[1,0,3,2] row_mask:0xf bank_mask:0xf
v_smfmac_f32_16x16x64_bf16 v[32:35], a[96:99], v[60:67], v149
ds_read_b128 v[52:55], v0 offset:10240
v_add_u32_sdwa v80, s42, v128 dst_sel:DWORD dst_unused:UNUSED_PAD src0_sel:DWORD src1_sel:WORD_0
v_smfmac_f32_16x16x64_bf16 v[32:35], a[132:135], v[68:75], v153
ds_read_u16 v80, v80
v_add_u32_sdwa v81, s42, v128 dst_sel:DWORD dst_unused:UNUSED_PAD src0_sel:DWORD src1_sel:WORD_1
v_smfmac_f32_16x16x64_bf16 v[16:19], a[80:83], v[60:67], v147
buffer_store_dwordx4 v[104:107], v4, s[20:23], s46 offen offset:1280 sc1
s_mov_b64 vcc, s[80:81]
ds_read_b128 v[56:59], v1 offset:10240
v_add_u32_sdwa v82, s42, v129 dst_sel:DWORD dst_unused:UNUSED_PAD src0_sel:DWORD src1_sel:WORD_0
v_add_u32_sdwa v83, s42, v129 dst_sel:DWORD dst_unused:UNUSED_PAD src0_sel:DWORD src1_sel:WORD_1
v_smfmac_f32_16x16x64_bf16 v[16:19], a[116:119], v[68:75], v151
s_waitcnt lgkmcnt(9)
ds_read_b128 v[92:95], v0 offset:12288
v_add_u32_sdwa v100, s42, v130 dst_sel:DWORD dst_unused:UNUSED_PAD src0_sel:DWORD src1_sel:WORD_0
v_smfmac_f32_16x16x64_bf16 v[16:19], v[114:117], v[84:91], v180 abid:1
ds_read_u16 v81, v81
v_add_u32_sdwa v101, s42, v130 dst_sel:DWORD dst_unused:UNUSED_PAD src0_sel:DWORD src1_sel:WORD_1
v_smfmac_f32_16x16x64_bf16 v[20:23], v[114:117], v[84:91], v181
ds_read_b128 v[96:99], v1 offset:12288
v_add_u32_sdwa v102, s42, v131 dst_sel:DWORD dst_unused:UNUSED_PAD src0_sel:DWORD src1_sel:WORD_0
v_smfmac_f32_16x16x64_bf16 v[20:23], a[84:87], v[60:67], v147 abid:1
ds_read_u16 v100, v100
v_add_u32_sdwa v103, s42, v131 dst_sel:DWORD dst_unused:UNUSED_PAD src0_sel:DWORD src1_sel:WORD_1
v_smfmac_f32_16x16x64_bf16 v[20:23], a[120:123], v[68:75], v151 abid:1
ds_read_u16 v82, v82
v_add_u32_sdwa v104, s42, v132 dst_sel:DWORD dst_unused:UNUSED_PAD src0_sel:DWORD src1_sel:WORD_0
v_smfmac_f32_16x16x64_bf16 v[36:39], a[100:103], v[60:67], v149 abid:1
ds_read_u16 v101, v101
v_add_u32_sdwa v105, s42, v132 dst_sel:DWORD dst_unused:UNUSED_PAD src0_sel:DWORD src1_sel:WORD_1
v_smfmac_f32_16x16x64_bf16 v[36:39], a[136:139], v[68:75], v153 abid:1
buffer_store_dwordx2 v[112:113], v5, s[20:23], s46 offen
ds_read_u16 v83, v83
v_add_u32_sdwa v106, s42, v133 dst_sel:DWORD dst_unused:UNUSED_PAD src0_sel:DWORD src1_sel:WORD_0
v_smfmac_f32_16x16x64_bf16 v[40:43], a[104:107], v[60:67], v175
s_mov_b32 s46, s48
ds_read_b128 v[114:117], v2 offset:192
v_add_u32_sdwa v107, s42, v133 dst_sel:DWORD dst_unused:UNUSED_PAD src0_sel:DWORD src1_sel:WORD_1
v_smfmac_f32_16x16x64_bf16 v[40:43], a[140:143], v[68:75], v175 abid:1
s_waitcnt lgkmcnt(12)
ds_read_u16 v102, v102
v_add_u32_sdwa v84, s42, v134 dst_sel:DWORD dst_unused:UNUSED_PAD src0_sel:DWORD src1_sel:WORD_0
v_smfmac_f32_16x16x64_bf16 v[8:11], a[144:147], v[44:51], v154
s_waitcnt lgkmcnt(9)
ds_read_u16 v103, v103
v_add_u32_sdwa v85, s42, v134 dst_sel:DWORD dst_unused:UNUSED_PAD src0_sel:DWORD src1_sel:WORD_1
v_smfmac_f32_16x16x64_bf16 v[8:11], a[180:183], v[52:59], v158
s_waitcnt lgkmcnt(7)
ds_read_u16 v104, v104
v_add_u32_sdwa v86, s42, v135 dst_sel:DWORD dst_unused:UNUSED_PAD src0_sel:DWORD src1_sel:WORD_0
v_smfmac_f32_16x16x64_bf16 v[8:11], a[216:219], v[92:99], v162
s_mov_b32 s48, s49
ds_read_u16 v105, v105
v_add_u32_sdwa v87, s42, v135 dst_sel:DWORD dst_unused:UNUSED_PAD src0_sel:DWORD src1_sel:WORD_1
v_smfmac_f32_16x16x64_bf16 v[24:27], a[160:163], v[44:51], v156
s_add_u32 m0, s44, 0
ds_read_u16 v106, v106
v_add_u32_sdwa v88, s42, v136 dst_sel:DWORD dst_unused:UNUSED_PAD src0_sel:DWORD src1_sel:WORD_0
v_smfmac_f32_16x16x64_bf16 v[24:27], a[196:199], v[52:59], v160
buffer_load_dwordx4 v3, s[16:19], s45 offen offset:0 nt lds
v_add_u32_sdwa v89, s42, v136 dst_sel:DWORD dst_unused:UNUSED_PAD src0_sel:DWORD src1_sel:WORD_1
v_smfmac_f32_16x16x64_bf16 v[24:27], a[232:235], v[92:99], v164
s_waitcnt lgkmcnt(5)
ds_read_u16 v107, v107
v_add_u32_sdwa v90, s42, v137 dst_sel:DWORD dst_unused:UNUSED_PAD src0_sel:DWORD src1_sel:WORD_0
v_smfmac_f32_16x16x64_bf16 v[24:27], v[114:117], v[76:83], v182
s_waitcnt vmcnt(6)
ds_read_u16 v84, v84
v_add_u32_sdwa v91, s42, v137 dst_sel:DWORD dst_unused:UNUSED_PAD src0_sel:DWORD src1_sel:WORD_1
v_smfmac_f32_16x16x64_bf16 v[28:31], v[114:117], v[76:83], v182 abid:1
s_mov_b32 s49, s50
ds_read_b128 v[114:117], v2 offset:256
v_add_u32_sdwa v76, s4, v118 dst_sel:DWORD dst_unused:UNUSED_PAD src0_sel:DWORD src1_sel:WORD_0
v_smfmac_f32_16x16x64_bf16 v[28:31], a[164:167], v[44:51], v156 abid:1
s_mov_b32 s50, s45
ds_read_u16 v85, v85
v_add_u32_sdwa v77, s4, v118 dst_sel:DWORD dst_unused:UNUSED_PAD src0_sel:DWORD src1_sel:WORD_1
v_smfmac_f32_16x16x64_bf16 v[28:31], a[200:203], v[52:59], v160 abid:1
ds_read_u16 v86, v86
v_add_u32_sdwa v78, s4, v119 dst_sel:DWORD dst_unused:UNUSED_PAD src0_sel:DWORD src1_sel:WORD_0
v_smfmac_f32_16x16x64_bf16 v[28:31], a[236:239], v[92:99], v164 abid:1
ds_read_u16 v87, v87
v_add_u32_sdwa v79, s4, v119 dst_sel:DWORD dst_unused:UNUSED_PAD src0_sel:DWORD src1_sel:WORD_1
v_smfmac_f32_16x16x64_bf16 v[12:15], a[148:151], v[44:51], v154 abid:1
s_add_u32 m0, s44, 3840
ds_read_u16 v88, v88
v_add_u32_sdwa v80, s4, v120 dst_sel:DWORD dst_unused:UNUSED_PAD src0_sel:DWORD src1_sel:WORD_0
v_smfmac_f32_16x16x64_bf16 v[12:15], a[184:187], v[52:59], v158 abid:1
buffer_load_dwordx4 v3, s[16:19], s45 offen offset:256 nt lds
v_add_u32_sdwa v81, s4, v120 dst_sel:DWORD dst_unused:UNUSED_PAD src0_sel:DWORD src1_sel:WORD_1
v_smfmac_f32_16x16x64_bf16 v[12:15], a[220:223], v[92:99], v162 abid:1
ds_read_b128 v[60:63], v0 offset:14336
v_add_u32_sdwa v82, s4, v121 dst_sel:DWORD dst_unused:UNUSED_PAD src0_sel:DWORD src1_sel:WORD_0
v_smfmac_f32_16x16x64_bf16 v[32:35], a[168:171], v[44:51], v157
ds_read_u16 v89, v89
v_add_u32_sdwa v83, s4, v121 dst_sel:DWORD dst_unused:UNUSED_PAD src0_sel:DWORD src1_sel:WORD_1
v_smfmac_f32_16x16x64_bf16 v[32:35], a[204:207], v[52:59], v161
ds_read_b128 v[64:67], v1 offset:14336
v_smfmac_f32_16x16x64_bf16 v[32:35], a[240:243], v[92:99], v165
s_waitcnt lgkmcnt(7)
ds_read_b128 v[68:71], v0 offset:16384
v_smfmac_f32_16x16x64_bf16 v[32:35], v[114:117], v[100:107], v183 abid:1
ds_read_u16 v90, v90
v_smfmac_f32_16x16x64_bf16 v[36:39], v[114:117], v[100:107], v184
ds_read_b128 v[72:75], v1 offset:16384
v_add_u32 v0, s43, v0
v_smfmac_f32_16x16x64_bf16 v[36:39], a[172:175], v[44:51], v157 abid:1
s_add_u32 m0, s44, 7680
ds_read_u16 v91, v91
v_add_u32 v1, s43, v1
v_smfmac_f32_16x16x64_bf16 v[36:39], a[208:211], v[52:59], v161 abid:1
buffer_load_dwordx4 v3, s[16:19], s45 offen offset:512 nt lds
v_smfmac_f32_16x16x64_bf16 v[36:39], a[244:247], v[92:99], v165 abid:1
ds_read_b128 v[114:117], v2 offset:320
v_smfmac_f32_16x16x64_bf16 v[16:19], a[152:155], v[44:51], v155
s_add_u32 m0, s44, 11520
v_smfmac_f32_16x16x64_bf16 v[16:19], a[188:191], v[52:59], v159
buffer_load_dwordx4 v3, s[16:19], s45 offen offset:768 nt lds
v_smfmac_f32_16x16x64_bf16 v[16:19], a[224:227], v[92:99], v163
s_mov_b64 exec, s[62:63]
ds_write_b32 v0, v7 offset:18432
s_mov_b64 exec, -1
v_smfmac_f32_16x16x64_bf16 v[20:23], a[156:159], v[44:51], v155 abid:1
s_add_u32 m0, s44, s8
v_smfmac_f32_16x16x64_bf16 v[20:23], a[192:195], v[52:59], v159 abid:1
s_mov_b64 exec, s[10:11]
buffer_load_dwordx4 v3, s[16:19], s7 offen offset:896 nt lds
s_mov_b64 exec, -1
v_smfmac_f32_16x16x64_bf16 v[20:23], a[228:231], v[92:99], v163 abid:1
s_add_u32 s44, s44, s5
s_cmp_ge_u32 s44, 148480
s_cselect_b32 s44, s9, s44
v_smfmac_f32_16x16x64_bf16 v[40:43], a[176:179], v[44:51], v176
v_smfmac_f32_16x16x64_bf16 v[40:43], a[212:215], v[52:59], v176 abid:1
v_smfmac_f32_16x16x64_bf16 v[40:43], a[248:251], v[92:99], v177
s_waitcnt lgkmcnt(0)
v_smfmac_f32_16x16x64_bf16 v[40:43], v[114:117], v[84:91], v185
s_barrier
v_smfmac_f32_16x16x64_bf16 v[8:11], a[252:255], v[60:67], v166
s_mov_b32 s42, s4
ds_read_b32 v7, v0 offset:18432
v_smfmac_f32_16x16x64_bf16 v[8:11], v[218:221], v[68:75], v170
ds_read_b128 v[44:47], v0 offset:0
v_add_u32_sdwa v84, s42, v122 dst_sel:DWORD dst_unused:UNUSED_PAD src0_sel:DWORD src1_sel:WORD_0
v_smfmac_f32_16x16x64_bf16 v[12:15], v[186:189], v[60:67], v166 abid:1
ds_read_b128 v[48:51], v1 offset:0
v_add_u32_sdwa v85, s42, v122 dst_sel:DWORD dst_unused:UNUSED_PAD src0_sel:DWORD src1_sel:WORD_1
v_smfmac_f32_16x16x64_bf16 v[12:15], v[222:225], v[68:75], v170 abid:1
ds_read_b128 v[52:55], v0 offset:2048
v_add_u32_sdwa v86, s42, v123 dst_sel:DWORD dst_unused:UNUSED_PAD src0_sel:DWORD src1_sel:WORD_0
v_smfmac_f32_16x16x64_bf16 v[16:19], v[190:193], v[60:67], v167
ds_read_b128 v[56:59], v1 offset:2048
v_cvt_pk_bf16_f32 v92, v8, v9
v_smfmac_f32_16x16x64_bf16 v[16:19], v[226:229], v[68:75], v171
ds_read_u16 v76, v76
v_cvt_pk_bf16_f32 v93, v10, v11
v_smfmac_f32_16x16x64_bf16 v[20:23], v[194:197], v[60:67], v167 abid:1
ds_read_b128 v[8:11], v2 offset:1024
v_cvt_pk_bf16_f32 v94, v12, v13
v_smfmac_f32_16x16x64_bf16 v[20:23], v[230:233], v[68:75], v171 abid:1
ds_read_u16 v77, v77
v_cvt_pk_bf16_f32 v95, v14, v15
v_smfmac_f32_16x16x64_bf16 v[24:27], v[198:201], v[60:67], v168
ds_read_b128 v[12:15], v2 offset:1088
v_cvt_pk_bf16_f32 v96, v16, v17
v_smfmac_f32_16x16x64_bf16 v[24:27], v[234:237], v[68:75], v172
s_waitcnt lgkmcnt(8)
ds_read_u16 v78, v78
v_cvt_pk_bf16_f32 v97, v18, v19
v_readfirstlane_b32 s56, v7
v_smfmac_f32_16x16x64_bf16 v[28:31], v[202:205], v[60:67], v168 abid:1
s_lshr_b32 s60, s56, 4
ds_read_b128 v[16:19], v2 offset:1152
v_cvt_pk_bf16_f32 v98, v20, v21
v_smfmac_f32_16x16x64_bf16 v[28:31], v[238:241], v[68:75], v172 abid:1
s_mul_i32 s60, s60, 884736
ds_read_u16 v79, v79
v_cvt_pk_bf16_f32 v99, v22, v23
v_smfmac_f32_16x16x64_bf16 v[32:35], v[206:209], v[60:67], v169
s_mul_i32 s61, s56, 18432
ds_read_b128 v[20:23], v2 offset:1216
v_cvt_pk_bf16_f32 v100, v24, v25
v_smfmac_f32_16x16x64_bf16 v[32:35], v[242:245], v[68:75], v173
s_add_u32 s60, s60, s57
ds_read_u16 v80, v80
v_cvt_pk_bf16_f32 v101, v26, v27
v_smfmac_f32_16x16x64_bf16 v[36:39], v[210:213], v[60:67], v169 abid:1
s_add_u32 s45, s60, s61
ds_read_b128 v[24:27], v2 offset:1280
v_cvt_pk_bf16_f32 v102, v28, v29
v_smfmac_f32_16x16x64_bf16 v[36:39], v[246:249], v[68:75], v173 abid:1
ds_read_u16 v81, v81
v_cvt_pk_bf16_f32 v103, v30, v31
v_smfmac_f32_16x16x64_bf16 v[40:43], v[214:217], v[60:67], v177 abid:1
s_cmp_lt_u32 s56, 384
ds_read_b128 v[28:31], v2 offset:1344
v_cvt_pk_bf16_f32 v104, v32, v33
v_smfmac_f32_16x16x64_bf16 v[40:43], v[250:253], v[68:75], v178
s_waitcnt lgkmcnt(10)
v_cvt_pk_bf16_f32 v105, v34, v35
s_cbranch_scc1 L_loopc
s_mov_b32 s41, 0
s_mov_b32 s15, 3
s_mov_b32 s12, 7
s_mov_b32 s92, 4
s_mov_b32 s87, 4
s_mov_b32 s59, -1
.p2align 3
L_loopn:
v_smfmac_f32_16x16x64_bf16 v[8:11], a[0:3], v[44:51], v138
ds_read_b128 v[32:35], v2 offset:1408
v_cvt_pk_bf16_f32 v106, v36, v37
v_smfmac_f32_16x16x64_bf16 v[8:11], a[36:39], v[52:59], v142
s_waitcnt lgkmcnt(9)
v_cvt_pk_bf16_f32 v107, v38, v39
v_smfmac_f32_16x16x64_bf16 v[12:15], a[4:7], v[44:51], v138 abid:1
ds_read_b128 v[36:39], v2 offset:1472
v_cvt_pk_bf16_f32 v112, v40, v41
v_smfmac_f32_16x16x64_bf16 v[12:15], a[40:43], v[52:59], v142 abid:1
s_waitcnt lgkmcnt(8)
ds_read_b128 v[60:63], v0 offset:4096
v_cvt_pk_bf16_f32 v113, v42, v43
v_smfmac_f32_16x16x64_bf16 v[16:19], a[8:11], v[44:51], v139
s_cmp_eq_u32 s4, 129920
ds_read_b128 v[40:43], v2 offset:1536
v_cndmask_b32_dpp v108, v96, v92, vcc quad_perm:[1,0,3,2] row_mask:0xf bank_mask:0xf
v_smfmac_f32_16x16x64_bf16 v[16:19], a[44:47], v[52:59], v143
s_waitcnt lgkmcnt(8)
ds_read_u16 v82, v82
v_cndmask_b32_dpp v109, v97, v93, vcc quad_perm:[1,0,3,2] row_mask:0xf bank_mask:0xf
v_smfmac_f32_16x16x64_bf16 v[20:23], a[12:15], v[44:51], v139 abid:1
s_cselect_b32 s43, -129920, s5
ds_read_u16 v84, v84
v_cndmask_b32_dpp v110, v98, v94, vcc quad_perm:[1,0,3,2] row_mask:0xf bank_mask:0xf
v_smfmac_f32_16x16x64_bf16 v[20:23], a[48:51], v[52:59], v143 abid:1
s_waitcnt lgkmcnt(8)
ds_read_b128 v[64:67], v1 offset:4096
v_cndmask_b32_dpp v111, v99, v95, vcc quad_perm:[1,0,3,2] row_mask:0xf bank_mask:0xf
v_smfmac_f32_16x16x64_bf16 v[24:27], a[16:19], v[44:51], v140
s_add_u32 s4, s4, s43
ds_read_b128 v[68:71], v0 offset:6144
v_add_u32_sdwa v87, s42, v123 dst_sel:DWORD dst_unused:UNUSED_PAD src0_sel:DWORD src1_sel:WORD_1
v_smfmac_f32_16x16x64_bf16 v[24:27], a[52:55], v[52:59], v144
buffer_store_dwordx4 v[108:111], v4, s[20:23], s46 offen offset:0 sc1
s_mov_b64 vcc, s[82:83]
s_waitcnt lgkmcnt(8)
ds_read_b128 v[72:75], v1 offset:6144
v_cndmask_b32_dpp v96, v92, v96, vcc quad_perm:[1,0,3,2] row_mask:0xf bank_mask:0xf
v_cndmask_b32_dpp v97, v93, v97, vcc quad_perm:[1,0,3,2] row_mask:0xf bank_mask:0xf
v_smfmac_f32_16x16x64_bf16 v[28:31], a[20:23], v[44:51], v140 abid:1
s_add_u32 s41, s41, 1
ds_read_u16 v83, v83
v_cndmask_b32_dpp v98, v94, v98, vcc quad_perm:[1,0,3,2] row_mask:0xf bank_mask:0xf
v_smfmac_f32_16x16x64_bf16 v[28:31], a[56:59], v[52:59], v144 abid:1
s_waitcnt lgkmcnt(9)
ds_read_b128 v[114:117], v2 offset:64
v_cndmask_b32_dpp v99, v95, v99, vcc quad_perm:[1,0,3,2] row_mask:0xf bank_mask:0xf
v_smfmac_f32_16x16x64_bf16 v[32:35], a[24:27], v[44:51], v141
ds_read_u16 v85, v85
v_add_u32_sdwa v88, s42, v124 dst_sel:DWORD dst_unused:UNUSED_PAD src0_sel:DWORD src1_sel:WORD_0
v_smfmac_f32_16x16x64_bf16 v[32:35], a[60:63], v[52:59], v145
s_waitcnt lgkmcnt(10)
ds_read_u16 v86, v86
v_add_u32_sdwa v89, s42, v124 dst_sel:DWORD dst_unused:UNUSED_PAD src0_sel:DWORD src1_sel:WORD_1
v_smfmac_f32_16x16x64_bf16 v[36:39], a[28:31], v[44:51], v141 abid:1
ds_read_u16 v87, v87
v_add_u32_sdwa v90, s42, v125 dst_sel:DWORD dst_unused:UNUSED_PAD src0_sel:DWORD src1_sel:WORD_0
v_smfmac_f32_16x16x64_bf16 v[36:39], a[64:67], v[52:59], v145 abid:1
s_waitcnt lgkmcnt(10)
ds_read_u16 v88, v88
v_add_u32_sdwa v91, s42, v125 dst_sel:DWORD dst_unused:UNUSED_PAD src0_sel:DWORD src1_sel:WORD_1
v_smfmac_f32_16x16x64_bf16 v[40:43], a[32:35], v[44:51], v174
buffer_store_dwordx4 v[96:99], v4, s[20:23], s46 offen offset:1152 sc1
s_mov_b64 vcc, s[80:81]
ds_read_u16 v89, v89
v_cndmask_b32_dpp v92, v104, v100, vcc quad_perm:[1,0,3,2] row_mask:0xf bank_mask:0xf
v_cndmask_b32_dpp v93, v105, v101, vcc quad_perm:[1,0,3,2] row_mask:0xf bank_mask:0xf
v_smfmac_f32_16x16x64_bf16 v[40:43], a[68:71], v[52:59], v174 abid:1
s_waitcnt lgkmcnt(9)
ds_read_u16 v90, v90
v_cndmask_b32_dpp v94, v106, v102, vcc quad_perm:[1,0,3,2] row_mask:0xf bank_mask:0xf
v_smfmac_f32_16x16x64_bf16 v[8:11], a[72:75], v[60:67], v146
s_waitcnt lgkmcnt(8)
ds_read_u16 v91, v91
v_cndmask_b32_dpp v95, v107, v103, vcc quad_perm:[1,0,3,2] row_mask:0xf bank_mask:0xf
v_smfmac_f32_16x16x64_bf16 v[8:11], a[108:111], v[68:75], v150
s_waitcnt lgkmcnt(7)
ds_bpermute_b32 v112, v6, v112
v_smfmac_f32_16x16x64_bf16 v[8:11], v[114:117], v[76:83], v179
ds_bpermute_b32 v113, v6, v113
v_smfmac_f32_16x16x64_bf16 v[12:15], v[114:117], v[76:83], v179 abid:1
ds_read_b128 v[114:117], v2 offset:128
v_add_u32_sdwa v76, s42, v126 dst_sel:DWORD dst_unused:UNUSED_PAD src0_sel:DWORD src1_sel:WORD_0
v_smfmac_f32_16x16x64_bf16 v[12:15], a[76:79], v[60:67], v146 abid:1
ds_read_u16 v76, v76
v_add_u32_sdwa v77, s42, v126 dst_sel:DWORD dst_unused:UNUSED_PAD src0_sel:DWORD src1_sel:WORD_1
v_smfmac_f32_16x16x64_bf16 v[12:15], a[112:115], v[68:75], v150 abid:1
buffer_store_dwordx4 v[92:95], v4, s[20:23], s46 offen offset:128 sc1
s_mov_b64 vcc, s[82:83]
ds_read_u16 v77, v77
v_cndmask_b32_dpp v104, v100, v104, vcc quad_perm:[1,0,3,2] row_mask:0xf bank_mask:0xf
v_add_u32_sdwa v78, s42, v127 dst_sel:DWORD dst_unused:UNUSED_PAD src0_sel:DWORD src1_sel:WORD_0
v_smfmac_f32_16x16x64_bf16 v[24:27], a[88:91], v[60:67], v148
ds_read_u16 v78, v78
v_cndmask_b32_dpp v105, v101, v105, vcc quad_perm:[1,0,3,2] row_mask:0xf bank_mask:0xf
v_smfmac_f32_16x16x64_bf16 v[24:27], a[124:127], v[68:75], v152
ds_read_b128 v[44:47], v0 offset:8192
v_cndmask_b32_dpp v106, v102, v106, vcc quad_perm:[1,0,3,2] row_mask:0xf bank_mask:0xf
v_smfmac_f32_16x16x64_bf16 v[28:31], a[92:95], v[60:67], v148 abid:1
ds_read_b128 v[48:51], v1 offset:8192
v_add_u32_sdwa v79, s42, v127 dst_sel:DWORD dst_unused:UNUSED_PAD src0_sel:DWORD src1_sel:WORD_1
v_smfmac_f32_16x16x64_bf16 v[28:31], a[128:131], v[68:75], v152 abid:1
ds_read_u16 v79, v79
v_cndmask_b32_dpp v107, v103, v107, vcc quad_perm:[1,0,3,2] row_mask:0xf bank_mask:0xf
v_smfmac_f32_16x16x64_bf16 v[32:35], a[96:99], v[60:67], v149
ds_read_b128 v[52:55], v0 offset:10240
v_add_u32_sdwa v80, s42, v128 dst_sel:DWORD dst_unused:UNUSED_PAD src0_sel:DWORD src1_sel:WORD_0
v_smfmac_f32_16x16x64_bf16 v[32:35], a[132:135], v[68:75], v153
ds_read_u16 v80, v80
v_add_u32_sdwa v81, s42, v128 dst_sel:DWORD dst_unused:UNUSED_PAD src0_sel:DWORD src1_sel:WORD_1
v_smfmac_f32_16x16x64_bf16 v[16:19], a[80:83], v[60:67], v147
buffer_store_dwordx4 v[104:107], v4, s[20:23], s46 offen offset:1280 sc1
s_mov_b64 vcc, s[80:81]
ds_read_b128 v[56:59], v1 offset:10240
v_add_u32_sdwa v82, s42, v129 dst_sel:DWORD dst_unused:UNUSED_PAD src0_sel:DWORD src1_sel:WORD_0
v_add_u32_sdwa v83, s42, v129 dst_sel:DWORD dst_unused:UNUSED_PAD src0_sel:DWORD src1_sel:WORD_1
v_smfmac_f32_16x16x64_bf16 v[16:19], a[116:119], v[68:75], v151
s_waitcnt lgkmcnt(9)
ds_read_b128 v[92:95], v0 offset:12288
v_add_u32_sdwa v100, s42, v130 dst_sel:DWORD dst_unused:UNUSED_PAD src0_sel:DWORD src1_sel:WORD_0
v_smfmac_f32_16x16x64_bf16 v[16:19], v[114:117], v[84:91], v180 abid:1
ds_read_u16 v81, v81
v_add_u32_sdwa v101, s42, v130 dst_sel:DWORD dst_unused:UNUSED_PAD src0_sel:DWORD src1_sel:WORD_1
v_smfmac_f32_16x16x64_bf16 v[20:23], v[114:117], v[84:91], v181
ds_read_b128 v[96:99], v1 offset:12288
v_add_u32_sdwa v102, s42, v131 dst_sel:DWORD dst_unused:UNUSED_PAD src0_sel:DWORD src1_sel:WORD_0
v_smfmac_f32_16x16x64_bf16 v[20:23], a[84:87], v[60:67], v147 abid:1
ds_read_u16 v100, v100
v_add_u32_sdwa v103, s42, v131 dst_sel:DWORD dst_unused:UNUSED_PAD src0_sel:DWORD src1_sel:WORD_1
v_smfmac_f32_16x16x64_bf16 v[20:23], a[120:123], v[68:75], v151 abid:1
ds_read_u16 v82, v82
v_add_u32_sdwa v104, s42, v132 dst_sel:DWORD dst_unused:UNUSED_PAD src0_sel:DWORD src1_sel:WORD_0
v_smfmac_f32_16x16x64_bf16 v[36:39], a[100:103], v[60:67], v149 abid:1
ds_read_u16 v101, v101
v_add_u32_sdwa v105, s42, v132 dst_sel:DWORD dst_unused:UNUSED_PAD src0_sel:DWORD src1_sel:WORD_1
v_smfmac_f32_16x16x64_bf16 v[36:39], a[136:139], v[68:75], v153 abid:1
buffer_store_dwordx2 v[112:113], v5, s[20:23], s46 offen
ds_read_u16 v83, v83
v_add_u32_sdwa v106, s42, v133 dst_sel:DWORD dst_unused:UNUSED_PAD src0_sel:DWORD src1_sel:WORD_0
v_smfmac_f32_16x16x64_bf16 v[40:43], a[104:107], v[60:67], v175
s_mov_b32 s22, 75497472
ds_read_b128 v[114:117], v2 offset:192
v_add_u32_sdwa v107, s42, v133 dst_sel:DWORD dst_unused:UNUSED_PAD src0_sel:DWORD src1_sel:WORD_1
v_smfmac_f32_16x16x64_bf16 v[40:43], a[140:143], v[68:75], v175 abid:1
s_waitcnt lgkmcnt(12)
ds_read_u16 v102, v102
v_add_u32_sdwa v84, s42, v134 dst_sel:DWORD dst_unused:UNUSED_PAD src0_sel:DWORD src1_sel:WORD_0
v_smfmac_f32_16x16x64_bf16 v[8:11], a[144:147], v[44:51], v154
s_waitcnt lgkmcnt(9)
ds_read_u16 v103, v103
v_add_u32_sdwa v85, s42, v134 dst_sel:DWORD dst_unused:UNUSED_PAD src0_sel:DWORD src1_sel:WORD_1
v_smfmac_f32_16x16x64_bf16 v[8:11], a[180:183], v[52:59], v158
s_waitcnt lgkmcnt(7)
ds_read_u16 v104, v104
v_add_u32_sdwa v86, s42, v135 dst_sel:DWORD dst_unused:UNUSED_PAD src0_sel:DWORD src1_sel:WORD_0
v_smfmac_f32_16x16x64_bf16 v[8:11], a[216:219], v[92:99], v162
s_mov_b32 s46, s48
ds_read_u16 v105, v105
v_add_u32_sdwa v87, s42, v135 dst_sel:DWORD dst_unused:UNUSED_PAD src0_sel:DWORD src1_sel:WORD_1
v_smfmac_f32_16x16x64_bf16 v[24:27], a[160:163], v[44:51], v156
s_mov_b32 s48, s49
ds_read_u16 v106, v106
v_add_u32_sdwa v88, s42, v136 dst_sel:DWORD dst_unused:UNUSED_PAD src0_sel:DWORD src1_sel:WORD_0
v_smfmac_f32_16x16x64_bf16 v[24:27], a[196:199], v[52:59], v160
s_mov_b32 s49, s50
s_add_u32 s50, s50, 4718592
v_add_u32_sdwa v89, s42, v136 dst_sel:DWORD dst_unused:UNUSED_PAD src0_sel:DWORD src1_sel:WORD_1
v_smfmac_f32_16x16x64_bf16 v[24:27], a[232:235], v[92:99], v164
s_waitcnt lgkmcnt(5)
ds_read_u16 v107, v107
v_add_u32_sdwa v90, s42, v137 dst_sel:DWORD dst_unused:UNUSED_PAD src0_sel:DWORD src1_sel:WORD_0
v_smfmac_f32_16x16x64_bf16 v[24:27], v[114:117], v[76:83], v182
ds_read_u16 v84, v84
v_add_u32_sdwa v91, s42, v137 dst_sel:DWORD dst_unused:UNUSED_PAD src0_sel:DWORD src1_sel:WORD_1
v_smfmac_f32_16x16x64_bf16 v[28:31], v[114:117], v[76:83], v182 abid:1
ds_read_b128 v[114:117], v2 offset:256
v_add_u32_sdwa v76, s4, v118 dst_sel:DWORD dst_unused:UNUSED_PAD src0_sel:DWORD src1_sel:WORD_0
v_smfmac_f32_16x16x64_bf16 v[28:31], a[164:167], v[44:51], v156 abid:1
ds_read_u16 v85, v85
v_add_u32_sdwa v77, s4, v118 dst_sel:DWORD dst_unused:UNUSED_PAD src0_sel:DWORD src1_sel:WORD_1
v_smfmac_f32_16x16x64_bf16 v[28:31], a[200:203], v[52:59], v160 abid:1
ds_read_u16 v86, v86
v_add_u32_sdwa v78, s4, v119 dst_sel:DWORD dst_unused:UNUSED_PAD src0_sel:DWORD src1_sel:WORD_0
v_smfmac_f32_16x16x64_bf16 v[28:31], a[236:239], v[92:99], v164 abid:1
ds_read_u16 v87, v87
v_add_u32_sdwa v79, s4, v119 dst_sel:DWORD dst_unused:UNUSED_PAD src0_sel:DWORD src1_sel:WORD_1
v_smfmac_f32_16x16x64_bf16 v[12:15], a[148:151], v[44:51], v154 abid:1
ds_read_u16 v88, v88
v_add_u32_sdwa v80, s4, v120 dst_sel:DWORD dst_unused:UNUSED_PAD src0_sel:DWORD src1_sel:WORD_0
v_smfmac_f32_16x16x64_bf16 v[12:15], a[184:187], v[52:59], v158 abid:1
v_add_u32_sdwa v81, s4, v120 dst_sel:DWORD dst_unused:UNUSED_PAD src0_sel:DWORD src1_sel:WORD_1
v_smfmac_f32_16x16x64_bf16 v[12:15], a[220:223], v[92:99], v162 abid:1
ds_read_b128 v[60:63], v0 offset:14336
v_add_u32_sdwa v82, s4, v121 dst_sel:DWORD dst_unused:UNUSED_PAD src0_sel:DWORD src1_sel:WORD_0
v_smfmac_f32_16x16x64_bf16 v[32:35], a[168:171], v[44:51], v157
ds_read_u16 v89, v89
v_add_u32_sdwa v83, s4, v121 dst_sel:DWORD dst_unused:UNUSED_PAD src0_sel:DWORD src1_sel:WORD_1
v_smfmac_f32_16x16x64_bf16 v[32:35], a[204:207], v[52:59], v161
ds_read_b128 v[64:67], v1 offset:14336
v_smfmac_f32_16x16x64_bf16 v[32:35], a[240:243], v[92:99], v165
s_waitcnt lgkmcnt(7)
ds_read_b128 v[68:71], v0 offset:16384
v_smfmac_f32_16x16x64_bf16 v[32:35], v[114:117], v[100:107], v183 abid:1
ds_read_u16 v90, v90
v_smfmac_f32_16x16x64_bf16 v[36:39], v[114:117], v[100:107], v184
ds_read_b128 v[72:75], v1 offset:16384
v_add_u32 v0, s43, v0
v_smfmac_f32_16x16x64_bf16 v[36:39], a[172:175], v[44:51], v157 abid:1
ds_read_u16 v91, v91
v_add_u32 v1, s43, v1
v_smfmac_f32_16x16x64_bf16 v[36:39], a[208:211], v[52:59], v161 abid:1
v_smfmac_f32_16x16x64_bf16 v[36:39], a[244:247], v[92:99], v165 abid:1
ds_read_b128 v[114:117], v2 offset:320
v_smfmac_f32_16x16x64_bf16 v[16:19], a[152:155], v[44:51], v155
v_smfmac_f32_16x16x64_bf16 v[16:19], a[188:191], v[52:59], v159
v_smfmac_f32_16x16x64_bf16 v[16:19], a[224:227], v[92:99], v163
v_smfmac_f32_16x16x64_bf16 v[20:23], a[156:159], v[44:51], v155 abid:1
v_smfmac_f32_16x16x64_bf16 v[20:23], a[192:195], v[52:59], v159 abid:1
v_smfmac_f32_16x16x64_bf16 v[20:23], a[228:231], v[92:99], v163 abid:1
v_smfmac_f32_16x16x64_bf16 v[40:43], a[176:179], v[44:51], v176
s_bitcmp1_b32 s92, s41
v_smfmac_f32_16x16x64_bf16 v[40:43], a[212:215], v[52:59], v176 abid:1
s_cbranch_scc1 L_loopn_w
L_loopn_wb:
v_smfmac_f32_16x16x64_bf16 v[40:43], a[248:251], v[92:99], v177
s_waitcnt lgkmcnt(0)
v_smfmac_f32_16x16x64_bf16 v[40:43], v[114:117], v[84:91], v185
s_waitcnt vmcnt(20)
s_barrier
L_loopn_p3:
v_smfmac_f32_16x16x64_bf16 v[8:11], a[252:255], v[60:67], v166
s_mov_b32 s42, s4
v_smfmac_f32_16x16x64_bf16 v[8:11], v[218:221], v[68:75], v170
ds_read_b128 v[44:47], v0 offset:0
v_add_u32_sdwa v84, s42, v122 dst_sel:DWORD dst_unused:UNUSED_PAD src0_sel:DWORD src1_sel:WORD_0
v_smfmac_f32_16x16x64_bf16 v[12:15], v[186:189], v[60:67], v166 abid:1
ds_read_b128 v[48:51], v1 offset:0
v_add_u32_sdwa v85, s42, v122 dst_sel:DWORD dst_unused:UNUSED_PAD src0_sel:DWORD src1_sel:WORD_1
v_smfmac_f32_16x16x64_bf16 v[12:15], v[222:225], v[68:75], v170 abid:1
ds_read_b128 v[52:55], v0 offset:2048
v_add_u32_sdwa v86, s42, v123 dst_sel:DWORD dst_unused:UNUSED_PAD src0_sel:DWORD src1_sel:WORD_0
v_smfmac_f32_16x16x64_bf16 v[16:19], v[190:193], v[60:67], v167
ds_read_b128 v[56:59], v1 offset:2048
v_cvt_pk_bf16_f32 v92, v8, v9
v_smfmac_f32_16x16x64_bf16 v[16:19], v[226:229], v[68:75], v171
ds_read_u16 v76, v76
v_cvt_pk_bf16_f32 v93, v10, v11
v_smfmac_f32_16x16x64_bf16 v[20:23], v[194:197], v[60:67], v167 abid:1
ds_read_b128 v[8:11], v2 offset:1024
v_cvt_pk_bf16_f32 v94, v12, v13
v_smfmac_f32_16x16x64_bf16 v[20:23], v[230:233], v[68:75], v171 abid:1
ds_read_u16 v77, v77
v_cvt_pk_bf16_f32 v95, v14, v15
v_smfmac_f32_16x16x64_bf16 v[24:27], v[198:201], v[60:67], v168
ds_read_b128 v[12:15], v2 offset:1088
v_cvt_pk_bf16_f32 v96, v16, v17
v_smfmac_f32_16x16x64_bf16 v[24:27], v[234:237], v[68:75], v172
ds_read_u16 v78, v78
v_cvt_pk_bf16_f32 v97, v18, v19
v_smfmac_f32_16x16x64_bf16 v[28:31], v[202:205], v[60:67], v168 abid:1
ds_read_b128 v[16:19], v2 offset:1152
v_cvt_pk_bf16_f32 v98, v20, v21
v_smfmac_f32_16x16x64_bf16 v[28:31], v[238:241], v[68:75], v172 abid:1
ds_read_u16 v79, v79
v_cvt_pk_bf16_f32 v99, v22, v23
v_smfmac_f32_16x16x64_bf16 v[32:35], v[206:209], v[60:67], v169
ds_read_b128 v[20:23], v2 offset:1216
v_cvt_pk_bf16_f32 v100, v24, v25
v_smfmac_f32_16x16x64_bf16 v[32:35], v[242:245], v[68:75], v173
ds_read_u16 v80, v80
v_cvt_pk_bf16_f32 v101, v26, v27
v_smfmac_f32_16x16x64_bf16 v[36:39], v[210:213], v[60:67], v169 abid:1
ds_read_b128 v[24:27], v2 offset:1280
v_cvt_pk_bf16_f32 v102, v28, v29
v_smfmac_f32_16x16x64_bf16 v[36:39], v[246:249], v[68:75], v173 abid:1
ds_read_u16 v81, v81
v_cvt_pk_bf16_f32 v103, v30, v31
v_smfmac_f32_16x16x64_bf16 v[40:43], v[214:217], v[60:67], v177 abid:1
s_bitcmp1_b32 s12, s41
ds_read_b128 v[28:31], v2 offset:1344
v_cvt_pk_bf16_f32 v104, v32, v33
v_smfmac_f32_16x16x64_bf16 v[40:43], v[250:253], v[68:75], v178
s_waitcnt lgkmcnt(10)
v_cvt_pk_bf16_f32 v105, v34, v35
s_cbranch_scc1 L_loopn
s_cmp_eq_u32 s41, s59
s_cbranch_scc1 L_loopc
s_cmp_lt_u32 s41, s15
s_cbranch_scc1 L_loop
s_nop 0
v_cndmask_b32_dpp v108, v96, v92, vcc quad_perm:[1,0,3,2] row_mask:0xf bank_mask:0xf
v_cndmask_b32_dpp v109, v97, v93, vcc quad_perm:[1,0,3,2] row_mask:0xf bank_mask:0xf
v_cndmask_b32_dpp v110, v98, v94, vcc quad_perm:[1,0,3,2] row_mask:0xf bank_mask:0xf
v_cndmask_b32_dpp v111, v99, v95, vcc quad_perm:[1,0,3,2] row_mask:0xf bank_mask:0xf
buffer_store_dwordx4 v[108:111], v4, s[20:23], s46 offen offset:0 sc1
s_mov_b64 vcc, s[82:83]
v_cvt_pk_bf16_f32 v112, v40, v41
v_cvt_pk_bf16_f32 v113, v42, v43
ds_bpermute_b32 v112, v6, v112
ds_bpermute_b32 v113, v6, v113
v_cndmask_b32_dpp v96, v92, v96, vcc quad_perm:[1,0,3,2] row_mask:0xf bank_mask:0xf
v_cndmask_b32_dpp v97, v93, v97, vcc quad_perm:[1,0,3,2] row_mask:0xf bank_mask:0xf
v_cndmask_b32_dpp v98, v94, v98, vcc quad_perm:[1,0,3,2] row_mask:0xf bank_mask:0xf
v_cndmask_b32_dpp v99, v95, v99, vcc quad_perm:[1,0,3,2] row_mask:0xf bank_mask:0xf
buffer_store_dwordx4 v[96:99], v4, s[20:23], s46 offen offset:1152 sc1
s_mov_b64 vcc, s[80:81]
v_cvt_pk_bf16_f32 v106, v36, v37
v_cvt_pk_bf16_f32 v107, v38, v39
v_cndmask_b32_dpp v92, v104, v100, vcc quad_perm:[1,0,3,2] row_mask:0xf bank_mask:0xf
v_cndmask_b32_dpp v93, v105, v101, vcc quad_perm:[1,0,3,2] row_mask:0xf bank_mask:0xf
v_cndmask_b32_dpp v94, v106, v102, vcc quad_perm:[1,0,3,2] row_mask:0xf bank_mask:0xf
v_cndmask_b32_dpp v95, v107, v103, vcc quad_perm:[1,0,3,2] row_mask:0xf bank_mask:0xf
buffer_store_dwordx4 v[92:95], v4, s[20:23], s46 offen offset:128 sc1
s_mov_b64 vcc, s[82:83]
v_cndmask_b32_dpp v104, v100, v104, vcc quad_perm:[1,0,3,2] row_mask:0xf bank_mask:0xf
v_cndmask_b32_dpp v105, v101, v105, vcc quad_perm:[1,0,3,2] row_mask:0xf bank_mask:0xf
v_cndmask_b32_dpp v106, v102, v106, vcc quad_perm:[1,0,3,2] row_mask:0xf bank_mask:0xf
v_cndmask_b32_dpp v107, v103, v107, vcc quad_perm:[1,0,3,2] row_mask:0xf bank_mask:0xf
buffer_store_dwordx4 v[104:107], v4, s[20:23], s46 offen offset:1280 sc1
s_mov_b64 vcc, s[80:81]
s_waitcnt lgkmcnt(0)
buffer_store_dwordx2 v[112:113], v5, s[20:23], s46 offen
L_fin:
L_end_standalone__structured_sparse_n_m__ragged_kernel:
s_endpgm
L_more1:
v_and_b32 v73, v94, v16
v_lshrrev_b32 v72, 10, v16
v_cmp_eq_u32 s[64:65], v73, v95
v_and_or_b32 v32, v72, v96, v97
s_mov_b64 exec, s[64:65]
ds_add_rtn_u32 v48, v32, v88
s_mov_b64 exec, -1
v_and_b32 v73, v94, v17
v_lshrrev_b32 v72, 10, v17
v_cmp_eq_u32 s[66:67], v73, v95
v_and_or_b32 v33, v72, v96, v97
s_mov_b64 exec, s[66:67]
ds_add_rtn_u32 v49, v33, v88
s_mov_b64 exec, -1
v_and_b32 v73, v94, v18
v_lshrrev_b32 v72, 10, v18
v_cmp_eq_u32 s[68:69], v73, v95
v_and_or_b32 v34, v72, v96, v97
s_mov_b64 exec, s[68:69]
ds_add_rtn_u32 v50, v34, v88
s_mov_b64 exec, -1
v_and_b32 v73, v94, v19
v_lshrrev_b32 v72, 10, v19
v_cmp_eq_u32 s[70:71], v73, v95
v_and_or_b32 v35, v72, v96, v97
s_mov_b64 exec, s[70:71]
ds_add_rtn_u32 v51, v35, v88
s_mov_b64 exec, -1
v_and_b32 v73, v94, v20
v_lshrrev_b32 v72, 10, v20
v_cmp_eq_u32 s[72:73], v73, v95
v_and_or_b32 v36, v72, v96, v97
s_mov_b64 exec, s[72:73]
ds_add_rtn_u32 v52, v36, v88
s_mov_b64 exec, -1
v_and_b32 v73, v94, v21
v_lshrrev_b32 v72, 10, v21
v_cmp_eq_u32 s[74:75], v73, v95
v_and_or_b32 v37, v72, v96, v97
s_mov_b64 exec, s[74:75]
ds_add_rtn_u32 v53, v37, v88
s_mov_b64 exec, -1
v_and_b32 v73, v94, v22
v_lshrrev_b32 v72, 10, v22
v_cmp_eq_u32 s[76:77], v73, v95
v_and_or_b32 v38, v72, v96, v97
s_mov_b64 exec, s[76:77]
ds_add_rtn_u32 v54, v38, v88
s_mov_b64 exec, -1
s_branch L_more1b
L_greedy:
s_mov_b32 s47, 0
s_mov_b32 s89, 1
v_readlane_b32 s3, v72, 0
s_max_u32 s47, s47, 0
v_writelane_b32 v91, s47, 0
s_nop 1
s_add_u32 s47, s47, s3
s_cmp_gt_u32 s47, 32
s_cselect_b32 s90, 1, s90
v_readlane_b32 s3, v72, 1
s_max_u32 s47, s47, 0
v_writelane_b32 v91, s47, 1
s_nop 1
s_add_u32 s47, s47, s3
s_cmp_gt_u32 s47, 64
s_cselect_b32 s90, 1, s90
v_readlane_b32 s3, v72, 2
s_max_u32 s47, s47, 32
v_writelane_b32 v91, s47, 2
s_nop 1
s_add_u32 s47, s47, s3
s_cmp_gt_u32 s47, 64
s_cselect_b32 s90, 1, s90
v_readlane_b32 s3, v72, 3
s_max_u32 s47, s47, 32
v_writelane_b32 v91, s47, 3
s_nop 1
s_add_u32 s47, s47, s3
s_cmp_gt_u32 s47, 96
s_cselect_b32 s90, 1, s90
v_readlane_b32 s3, v72, 4
s_max_u32 s47, s47, 64
v_writelane_b32 v91, s47, 4
s_nop 1
s_add_u32 s47, s47, s3
s_cmp_gt_u32 s47, 96
s_cselect_b32 s90, 1, s90
v_readlane_b32 s3, v72, 5
s_max_u32 s47, s47, 64
v_writelane_b32 v91, s47, 5
s_nop 1
s_add_u32 s47, s47, s3
s_cmp_gt_u32 s47, 128
s_cselect_b32 s90, 1, s90
v_readlane_b32 s3, v72, 6
s_max_u32 s47, s47, 96
v_writelane_b32 v91, s47, 6
s_nop 1
s_add_u32 s47, s47, s3
s_cmp_gt_u32 s47, 128
s_cselect_b32 s90, 1, s90
v_readlane_b32 s3, v72, 7
s_max_u32 s47, s47, 96
v_writelane_b32 v91, s47, 7
s_nop 1
s_add_u32 s47, s47, s3
s_cmp_gt_u32 s47, 160
s_cselect_b32 s90, 1, s90
v_readlane_b32 s3, v72, 8
s_max_u32 s47, s47, 128
v_writelane_b32 v91, s47, 8
s_nop 1
s_add_u32 s47, s47, s3
s_cmp_gt_u32 s47, 160
s_cselect_b32 s90, 1, s90
s_cmp_lg_u32 s90, 0
s_cselect_b64 s[90:91], -1, 0
v_mov_b32 v73, 163072
s_mov_b64 exec, s[90:91]
ds_write_b32 v73, v88
s_mov_b64 exec, -1
s_branch L_greedyb
L_more2:
ds_bpermute_b32 v64, v32, v91
ds_bpermute_b32 v65, v33, v91
ds_bpermute_b32 v66, v34, v91
ds_bpermute_b32 v67, v35, v91
ds_bpermute_b32 v68, v36, v91
ds_bpermute_b32 v69, v37, v91
ds_bpermute_b32 v70, v38, v91
s_waitcnt lgkmcnt(0)
v_add_u32 v73, v48, v64
v_and_b32 v72, 0x87e, v16
v_lshl_add_u32 v73, v73, 1, s93
v_add_u32 v72, v90, v72
s_andn2_b64 exec, s[64:65], s[90:91]
ds_write_b16_d16_hi v73, v16 offset:64
ds_write_b16 v73, v72 offset:384
ds_write_b16 v73, v16 offset:704
s_mov_b64 exec, -1
v_add_u32 v73, v49, v65
v_and_b32 v72, 0x87e, v17
v_lshl_add_u32 v73, v73, 1, s93
v_add_u32 v72, v90, v72
s_andn2_b64 exec, s[66:67], s[90:91]
ds_write_b16_d16_hi v73, v17 offset:64
ds_write_b16 v73, v72 offset:384
ds_write_b16 v73, v17 offset:704
s_mov_b64 exec, -1
v_add_u32 v73, v50, v66
v_and_b32 v72, 0x87e, v18
v_lshl_add_u32 v73, v73, 1, s93
v_add_u32 v72, v90, v72
s_andn2_b64 exec, s[68:69], s[90:91]
ds_write_b16_d16_hi v73, v18 offset:64
ds_write_b16 v73, v72 offset:384
ds_write_b16 v73, v18 offset:704
s_mov_b64 exec, -1
v_add_u32 v73, v51, v67
v_and_b32 v72, 0x87e, v19
v_lshl_add_u32 v73, v73, 1, s93
v_add_u32 v72, v90, v72
s_andn2_b64 exec, s[70:71], s[90:91]
ds_write_b16_d16_hi v73, v19 offset:64
ds_write_b16 v73, v72 offset:384
ds_write_b16 v73, v19 offset:704
s_mov_b64 exec, -1
v_add_u32 v73, v52, v68
v_and_b32 v72, 0x87e, v20
v_lshl_add_u32 v73, v73, 1, s93
v_add_u32 v72, v90, v72
s_andn2_b64 exec, s[72:73], s[90:91]
ds_write_b16_d16_hi v73, v20 offset:64
ds_write_b16 v73, v72 offset:384
ds_write_b16 v73, v20 offset:704
s_mov_b64 exec, -1
v_add_u32 v73, v53, v69
v_and_b32 v72, 0x87e, v21
v_lshl_add_u32 v73, v73, 1, s93
v_add_u32 v72, v90, v72
s_andn2_b64 exec, s[74:75], s[90:91]
ds_write_b16_d16_hi v73, v21 offset:64
ds_write_b16 v73, v72 offset:384
ds_write_b16 v73, v21 offset:704
s_mov_b64 exec, -1
v_add_u32 v73, v54, v70
v_and_b32 v72, 0x87e, v22
v_lshl_add_u32 v73, v73, 1, s93
v_add_u32 v72, v90, v72
s_andn2_b64 exec, s[76:77], s[90:91]
ds_write_b16_d16_hi v73, v22 offset:64
ds_write_b16 v73, v72 offset:384
ds_write_b16 v73, v22 offset:704
s_mov_b64 exec, -1
s_branch L_more2b
L_cwait:
buffer_load_dword v8, off, s[36:39], 0 sc1
s_sub_u32 s3, s3, 1
s_cbranch_scc1 L_giveup
s_waitcnt vmcnt(0)
v_readfirstlane_b32 s47, v8
s_nop 3
s_cmp_lg_u32 s47, 1
s_cbranch_scc1 L_cwait
s_branch L_poll
L_giveup:
s_waitcnt vmcnt(0)
v_mov_b32 v8, 163072
v_mov_b32 v9, 1
ds_write_b32 v8, v9
s_branch L_polled
L_loop_w:
s_bitcmp1_b32 s87, s41
s_waitcnt vmcnt(15)
s_cbranch_scc0 L_loop_wb
s_waitcnt vmcnt(10)
s_branch L_loop_wb
L_loopn_w:
s_bitcmp1_b32 s87, s41
s_waitcnt vmcnt(15)
s_cbranch_scc0 L_loopn_wb
s_waitcnt vmcnt(10)
s_branch L_loopn_wb
L_linked:
.p2align 6
L_loopk:
v_smfmac_f32_16x16x64_bf16 v[8:11], a[0:3], v[44:51], v138
ds_read_b128 v[32:35], v2 offset:1408
v_cvt_pk_bf16_f32 v106, v36, v37
v_smfmac_f32_16x16x64_bf16 v[8:11], a[36:39], v[52:59], v142
s_waitcnt lgkmcnt(9)
v_cvt_pk_bf16_f32 v107, v38, v39
v_smfmac_f32_16x16x64_bf16 v[12:15], a[4:7], v[44:51], v138 abid:1
ds_read_b128 v[36:39], v2 offset:1472
v_cvt_pk_bf16_f32 v112, v40, v41
v_smfmac_f32_16x16x64_bf16 v[12:15], a[40:43], v[52:59], v142 abid:1
s_waitcnt lgkmcnt(8)
ds_read_b128 v[60:63], v0 offset:4096
v_cvt_pk_bf16_f32 v113, v42, v43
v_smfmac_f32_16x16x64_bf16 v[16:19], a[8:11], v[44:51], v139
s_cmp_eq_u32 s4, 129920
ds_read_b128 v[40:43], v2 offset:1536
v_cndmask_b32_dpp v108, v96, v92, vcc quad_perm:[1,0,3,2] row_mask:0xf bank_mask:0xf
v_smfmac_f32_16x16x64_bf16 v[16:19], a[44:47], v[52:59], v143
s_waitcnt lgkmcnt(8)
ds_read_u16 v82, v82
v_cndmask_b32_dpp v109, v97, v93, vcc quad_perm:[1,0,3,2] row_mask:0xf bank_mask:0xf
v_smfmac_f32_16x16x64_bf16 v[20:23], a[12:15], v[44:51], v139 abid:1
s_cselect_b32 s43, -129920, s5
ds_read_u16 v84, v84
v_cndmask_b32_dpp v110, v98, v94, vcc quad_perm:[1,0,3,2] row_mask:0xf bank_mask:0xf
v_smfmac_f32_16x16x64_bf16 v[20:23], a[48:51], v[52:59], v143 abid:1
s_waitcnt lgkmcnt(8)
ds_read_b128 v[64:67], v1 offset:4096
v_cndmask_b32_dpp v111, v99, v95, vcc quad_perm:[1,0,3,2] row_mask:0xf bank_mask:0xf
v_smfmac_f32_16x16x64_bf16 v[24:27], a[16:19], v[44:51], v140
s_add_u32 s4, s4, s43
ds_read_b128 v[68:71], v0 offset:6144
v_add_u32_sdwa v87, s42, v123 dst_sel:DWORD dst_unused:UNUSED_PAD src0_sel:DWORD src1_sel:WORD_1
v_smfmac_f32_16x16x64_bf16 v[24:27], a[52:55], v[52:59], v144
buffer_store_dwordx4 v[108:111], v4, s[20:23], s46 offen offset:0 sc1
s_mov_b64 vcc, s[82:83]
s_waitcnt lgkmcnt(8)
ds_read_b128 v[72:75], v1 offset:6144
v_cndmask_b32_dpp v96, v92, v96, vcc quad_perm:[1,0,3,2] row_mask:0xf bank_mask:0xf
v_cndmask_b32_dpp v97, v93, v97, vcc quad_perm:[1,0,3,2] row_mask:0xf bank_mask:0xf
v_smfmac_f32_16x16x64_bf16 v[28:31], a[20:23], v[44:51], v140 abid:1
s_add_u32 s41, s41, 1
ds_read_u16 v83, v83
v_cndmask_b32_dpp v98, v94, v98, vcc quad_perm:[1,0,3,2] row_mask:0xf bank_mask:0xf
v_smfmac_f32_16x16x64_bf16 v[28:31], a[56:59], v[52:59], v144 abid:1
s_waitcnt lgkmcnt(9)
ds_read_b128 v[114:117], v2 offset:64
v_cndmask_b32_dpp v99, v95, v99, vcc quad_perm:[1,0,3,2] row_mask:0xf bank_mask:0xf
v_smfmac_f32_16x16x64_bf16 v[32:35], a[24:27], v[44:51], v141
ds_read_u16 v85, v85
v_add_u32_sdwa v88, s42, v124 dst_sel:DWORD dst_unused:UNUSED_PAD src0_sel:DWORD src1_sel:WORD_0
v_smfmac_f32_16x16x64_bf16 v[32:35], a[60:63], v[52:59], v145
s_waitcnt lgkmcnt(10)
ds_read_u16 v86, v86
v_add_u32_sdwa v89, s42, v124 dst_sel:DWORD dst_unused:UNUSED_PAD src0_sel:DWORD src1_sel:WORD_1
v_smfmac_f32_16x16x64_bf16 v[36:39], a[28:31], v[44:51], v141 abid:1
ds_read_u16 v87, v87
v_add_u32_sdwa v90, s42, v125 dst_sel:DWORD dst_unused:UNUSED_PAD src0_sel:DWORD src1_sel:WORD_0
v_smfmac_f32_16x16x64_bf16 v[36:39], a[64:67], v[52:59], v145 abid:1
s_waitcnt lgkmcnt(10)
ds_read_u16 v88, v88
v_add_u32_sdwa v91, s42, v125 dst_sel:DWORD dst_unused:UNUSED_PAD src0_sel:DWORD src1_sel:WORD_1
v_smfmac_f32_16x16x64_bf16 v[40:43], a[32:35], v[44:51], v174
buffer_store_dwordx4 v[96:99], v4, s[20:23], s46 offen offset:1152 sc1
s_mov_b64 vcc, s[80:81]
ds_read_u16 v89, v89
v_cndmask_b32_dpp v92, v104, v100, vcc quad_perm:[1,0,3,2] row_mask:0xf bank_mask:0xf
v_cndmask_b32_dpp v93, v105, v101, vcc quad_perm:[1,0,3,2] row_mask:0xf bank_mask:0xf
v_smfmac_f32_16x16x64_bf16 v[40:43], a[68:71], v[52:59], v174 abid:1
s_waitcnt lgkmcnt(9)
ds_read_u16 v90, v90
v_cndmask_b32_dpp v94, v106, v102, vcc quad_perm:[1,0,3,2] row_mask:0xf bank_mask:0xf
v_smfmac_f32_16x16x64_bf16 v[8:11], a[72:75], v[60:67], v146
s_waitcnt lgkmcnt(8)
ds_read_u16 v91, v91
v_cndmask_b32_dpp v95, v107, v103, vcc quad_perm:[1,0,3,2] row_mask:0xf bank_mask:0xf
v_smfmac_f32_16x16x64_bf16 v[8:11], a[108:111], v[68:75], v150
s_waitcnt lgkmcnt(7)
ds_bpermute_b32 v112, v6, v112
v_smfmac_f32_16x16x64_bf16 v[8:11], v[114:117], v[76:83], v179
s_waitcnt vmcnt(2)
ds_bpermute_b32 v113, v6, v113
v_smfmac_f32_16x16x64_bf16 v[12:15], v[114:117], v[76:83], v179 abid:1
ds_read_b128 v[114:117], v2 offset:128
v_add_u32_sdwa v76, s42, v126 dst_sel:DWORD dst_unused:UNUSED_PAD src0_sel:DWORD src1_sel:WORD_0
v_smfmac_f32_16x16x64_bf16 v[12:15], a[76:79], v[60:67], v146 abid:1
ds_read_u16 v76, v76
v_add_u32_sdwa v77, s42, v126 dst_sel:DWORD dst_unused:UNUSED_PAD src0_sel:DWORD src1_sel:WORD_1
v_smfmac_f32_16x16x64_bf16 v[12:15], a[112:115], v[68:75], v150 abid:1
buffer_store_dwordx4 v[92:95], v4, s[20:23], s46 offen offset:128 sc1
s_mov_b64 vcc, s[82:83]
ds_read_u16 v77, v77
v_cndmask_b32_dpp v104, v100, v104, vcc quad_perm:[1,0,3,2] row_mask:0xf bank_mask:0xf
v_cndmask_b32_dpp v105, v101, v105, vcc quad_perm:[1,0,3,2] row_mask:0xf bank_mask:0xf
v_smfmac_f32_16x16x64_bf16 v[24:27], a[88:91], v[60:67], v148
ds_read_b128 v[44:47], v0 offset:8192
v_add_u32_sdwa v78, s42, v127 dst_sel:DWORD dst_unused:UNUSED_PAD src0_sel:DWORD src1_sel:WORD_0
v_smfmac_f32_16x16x64_bf16 v[24:27], a[124:127], v[68:75], v152
ds_read_u16 v78, v78
v_cndmask_b32_dpp v106, v102, v106, vcc quad_perm:[1,0,3,2] row_mask:0xf bank_mask:0xf
v_smfmac_f32_16x16x64_bf16 v[28:31], a[92:95], v[60:67], v148 abid:1
ds_read_b128 v[48:51], v1 offset:8192
v_cndmask_b32_dpp v107, v103, v107, vcc quad_perm:[1,0,3,2] row_mask:0xf bank_mask:0xf
v_smfmac_f32_16x16x64_bf16 v[28:31], a[128:131], v[68:75], v152 abid:1
ds_read_b128 v[52:55], v0 offset:10240
v_add_u32_sdwa v79, s42, v127 dst_sel:DWORD dst_unused:UNUSED_PAD src0_sel:DWORD src1_sel:WORD_1
v_smfmac_f32_16x16x64_bf16 v[32:35], a[96:99], v[60:67], v149
ds_read_u16 v79, v79
v_add_u32_sdwa v80, s42, v128 dst_sel:DWORD dst_unused:UNUSED_PAD src0_sel:DWORD src1_sel:WORD_0
v_smfmac_f32_16x16x64_bf16 v[32:35], a[132:135], v[68:75], v153
ds_read_u16 v80, v80
v_add_u32_sdwa v81, s42, v128 dst_sel:DWORD dst_unused:UNUSED_PAD src0_sel:DWORD src1_sel:WORD_1
v_smfmac_f32_16x16x64_bf16 v[16:19], a[80:83], v[60:67], v147
buffer_store_dwordx4 v[104:107], v4, s[20:23], s46 offen offset:1280 sc1
s_mov_b64 vcc, s[80:81]
ds_read_b128 v[56:59], v1 offset:10240
v_add_u32_sdwa v82, s42, v129 dst_sel:DWORD dst_unused:UNUSED_PAD src0_sel:DWORD src1_sel:WORD_0
v_add_u32_sdwa v83, s42, v129 dst_sel:DWORD dst_unused:UNUSED_PAD src0_sel:DWORD src1_sel:WORD_1
v_smfmac_f32_16x16x64_bf16 v[16:19], a[116:119], v[68:75], v151
s_waitcnt lgkmcnt(9)
ds_read_b128 v[92:95], v0 offset:12288
v_add_u32_sdwa v100, s42, v130 dst_sel:DWORD dst_unused:UNUSED_PAD src0_sel:DWORD src1_sel:WORD_0
v_smfmac_f32_16x16x64_bf16 v[16:19], v[114:117], v[84:91], v180 abid:1
ds_read_u16 v81, v81
v_add_u32_sdwa v101, s42, v130 dst_sel:DWORD dst_unused:UNUSED_PAD src0_sel:DWORD src1_sel:WORD_1
v_smfmac_f32_16x16x64_bf16 v[12:15], v[114:117], v[84:91], v180
ds_read_b128 v[96:99], v1 offset:12288
v_add_u32_sdwa v102, s42, v131 dst_sel:DWORD dst_unused:UNUSED_PAD src0_sel:DWORD src1_sel:WORD_0
v_smfmac_f32_16x16x64_bf16 v[20:23], v[114:117], v[84:91], v181
ds_read_u16 v82, v82
v_add_u32_sdwa v103, s42, v131 dst_sel:DWORD dst_unused:UNUSED_PAD src0_sel:DWORD src1_sel:WORD_1
v_smfmac_f32_16x16x64_bf16 v[20:23], a[84:87], v[60:67], v147 abid:1
ds_read_u16 v100, v100
v_add_u32_sdwa v104, s42, v132 dst_sel:DWORD dst_unused:UNUSED_PAD src0_sel:DWORD src1_sel:WORD_0
v_smfmac_f32_16x16x64_bf16 v[20:23], a[120:123], v[68:75], v151 abid:1
ds_read_u16 v83, v83
v_add_u32_sdwa v105, s42, v132 dst_sel:DWORD dst_unused:UNUSED_PAD src0_sel:DWORD src1_sel:WORD_1
v_smfmac_f32_16x16x64_bf16 v[36:39], a[100:103], v[60:67], v149 abid:1
buffer_store_dwordx2 v[112:113], v5, s[20:23], s46 offen
ds_read_b128 v[114:117], v2 offset:192
v_add_u32_sdwa v106, s42, v133 dst_sel:DWORD dst_unused:UNUSED_PAD src0_sel:DWORD src1_sel:WORD_0
v_smfmac_f32_16x16x64_bf16 v[36:39], a[136:139], v[68:75], v153 abid:1
s_mov_b32 s22, 75497472
ds_read_u16 v101, v101
v_add_u32_sdwa v107, s42, v133 dst_sel:DWORD dst_unused:UNUSED_PAD src0_sel:DWORD src1_sel:WORD_1
v_smfmac_f32_16x16x64_bf16 v[40:43], a[104:107], v[60:67], v175
s_mov_b32 s46, s48
ds_read_u16 v102, v102
v_add_u32_sdwa v84, s42, v134 dst_sel:DWORD dst_unused:UNUSED_PAD src0_sel:DWORD src1_sel:WORD_0
v_smfmac_f32_16x16x64_bf16 v[40:43], a[140:143], v[68:75], v175 abid:1
s_waitcnt lgkmcnt(13)
ds_read_u16 v103, v103
v_add_u32_sdwa v85, s42, v134 dst_sel:DWORD dst_unused:UNUSED_PAD src0_sel:DWORD src1_sel:WORD_1
v_smfmac_f32_16x16x64_bf16 v[8:11], a[144:147], v[44:51], v154
s_waitcnt lgkmcnt(10)
ds_read_u16 v104, v104
v_add_u32_sdwa v86, s42, v135 dst_sel:DWORD dst_unused:UNUSED_PAD src0_sel:DWORD src1_sel:WORD_0
v_smfmac_f32_16x16x64_bf16 v[8:11], a[180:183], v[52:59], v158
s_waitcnt lgkmcnt(8)
ds_read_u16 v105, v105
v_add_u32_sdwa v87, s42, v135 dst_sel:DWORD dst_unused:UNUSED_PAD src0_sel:DWORD src1_sel:WORD_1
v_smfmac_f32_16x16x64_bf16 v[8:11], a[216:219], v[92:99], v162
s_add_u32 m0, s44, 0
ds_read_u16 v106, v106
v_add_u32_sdwa v88, s42, v136 dst_sel:DWORD dst_unused:UNUSED_PAD src0_sel:DWORD src1_sel:WORD_0
v_smfmac_f32_16x16x64_bf16 v[24:27], a[160:163], v[44:51], v156
buffer_load_dwordx4 v3, s[16:19], s45 offen offset:0 nt lds
v_add_u32_sdwa v89, s42, v136 dst_sel:DWORD dst_unused:UNUSED_PAD src0_sel:DWORD src1_sel:WORD_1
v_smfmac_f32_16x16x64_bf16 v[24:27], a[196:199], v[52:59], v160
s_mov_b32 s48, s49
ds_read_u16 v107, v107
v_add_u32_sdwa v90, s42, v137 dst_sel:DWORD dst_unused:UNUSED_PAD src0_sel:DWORD src1_sel:WORD_0
v_smfmac_f32_16x16x64_bf16 v[24:27], a[232:235], v[92:99], v164
s_waitcnt lgkmcnt(7)
ds_read_u16 v84, v84
v_add_u32_sdwa v91, s42, v137 dst_sel:DWORD dst_unused:UNUSED_PAD src0_sel:DWORD src1_sel:WORD_1
v_smfmac_f32_16x16x64_bf16 v[24:27], v[114:117], v[76:83], v182
s_mov_b32 s49, s50
ds_read_u16 v85, v85
v_smfmac_f32_16x16x64_bf16 v[20:23], v[114:117], v[76:83], v181 abid:1
s_add_u32 s50, s50, 4718592
ds_read_u16 v86, v86
v_smfmac_f32_16x16x64_bf16 v[28:31], v[114:117], v[76:83], v182 abid:1
ds_read_b128 v[114:117], v2 offset:256
v_add_u32_sdwa v76, s4, v118 dst_sel:DWORD dst_unused:UNUSED_PAD src0_sel:DWORD src1_sel:WORD_0
v_smfmac_f32_16x16x64_bf16 v[28:31], a[164:167], v[44:51], v156 abid:1
ds_read_u16 v87, v87
v_add_u32_sdwa v77, s4, v118 dst_sel:DWORD dst_unused:UNUSED_PAD src0_sel:DWORD src1_sel:WORD_1
v_smfmac_f32_16x16x64_bf16 v[28:31], a[200:203], v[52:59], v160 abid:1
ds_read_u16 v88, v88
v_add_u32_sdwa v78, s4, v119 dst_sel:DWORD dst_unused:UNUSED_PAD src0_sel:DWORD src1_sel:WORD_0
v_smfmac_f32_16x16x64_bf16 v[28:31], a[236:239], v[92:99], v164 abid:1
ds_read_b128 v[60:63], v0 offset:14336
v_add_u32_sdwa v79, s4, v119 dst_sel:DWORD dst_unused:UNUSED_PAD src0_sel:DWORD src1_sel:WORD_1
v_smfmac_f32_16x16x64_bf16 v[12:15], a[148:151], v[44:51], v154 abid:1
ds_read_u16 v89, v89
v_add_u32_sdwa v80, s4, v120 dst_sel:DWORD dst_unused:UNUSED_PAD src0_sel:DWORD src1_sel:WORD_0
v_smfmac_f32_16x16x64_bf16 v[12:15], a[184:187], v[52:59], v158 abid:1
s_add_u32 m0, s44, 3840
ds_read_b128 v[64:67], v1 offset:14336
v_add_u32_sdwa v81, s4, v120 dst_sel:DWORD dst_unused:UNUSED_PAD src0_sel:DWORD src1_sel:WORD_1
v_smfmac_f32_16x16x64_bf16 v[12:15], a[220:223], v[92:99], v162 abid:1
buffer_load_dwordx4 v3, s[16:19], s45 offen offset:256 nt lds
v_add_u32_sdwa v82, s4, v121 dst_sel:DWORD dst_unused:UNUSED_PAD src0_sel:DWORD src1_sel:WORD_0
v_smfmac_f32_16x16x64_bf16 v[32:35], a[168:171], v[44:51], v157
ds_read_b128 v[68:71], v0 offset:16384
v_add_u32_sdwa v83, s4, v121 dst_sel:DWORD dst_unused:UNUSED_PAD src0_sel:DWORD src1_sel:WORD_1
v_smfmac_f32_16x16x64_bf16 v[32:35], a[204:207], v[52:59], v161
ds_read_u16 v90, v90
v_smfmac_f32_16x16x64_bf16 v[32:35], a[240:243], v[92:99], v165
s_waitcnt lgkmcnt(7)
ds_read_b128 v[72:75], v1 offset:16384
v_add_u32 v0, s43, v0
v_smfmac_f32_16x16x64_bf16 v[32:35], v[114:117], v[100:107], v183 abid:1
ds_read_u16 v91, v91
v_add_u32 v1, s43, v1
v_smfmac_f32_16x16x64_bf16 v[28:31], v[114:117], v[100:107], v183
v_smfmac_f32_16x16x64_bf16 v[36:39], v[114:117], v[100:107], v184
ds_read_b128 v[114:117], v2 offset:320
v_smfmac_f32_16x16x64_bf16 v[36:39], a[172:175], v[44:51], v157 abid:1
s_add_u32 m0, s44, 7680
v_smfmac_f32_16x16x64_bf16 v[36:39], a[208:211], v[52:59], v161 abid:1
buffer_load_dwordx4 v3, s[16:19], s45 offen offset:512 nt lds
v_smfmac_f32_16x16x64_bf16 v[36:39], a[244:247], v[92:99], v165 abid:1
v_smfmac_f32_16x16x64_bf16 v[16:19], a[152:155], v[44:51], v155
s_add_u32 m0, s44, 11520
v_smfmac_f32_16x16x64_bf16 v[16:19], a[188:191], v[52:59], v159
buffer_load_dwordx4 v3, s[16:19], s45 offen offset:768 nt lds
v_smfmac_f32_16x16x64_bf16 v[16:19], a[224:227], v[92:99], v163
v_smfmac_f32_16x16x64_bf16 v[20:23], a[156:159], v[44:51], v155 abid:1
s_add_u32 m0, s44, s8
v_smfmac_f32_16x16x64_bf16 v[20:23], a[192:195], v[52:59], v159 abid:1
s_mov_b64 exec, s[10:11]
buffer_load_dwordx4 v3, s[16:19], s7 offen offset:896 nt lds
s_mov_b64 exec, -1
v_smfmac_f32_16x16x64_bf16 v[20:23], a[228:231], v[92:99], v163 abid:1
s_add_u32 s45, s45, 4718592
s_add_u32 s7, s7, 4718592
s_add_u32 s44, s44, s5
v_smfmac_f32_16x16x64_bf16 v[40:43], a[176:179], v[44:51], v176
s_cmp_ge_u32 s44, 148480
s_cselect_b32 s44, s9, s44
s_bitcmp1_b32 s92, s41
v_smfmac_f32_16x16x64_bf16 v[40:43], a[212:215], v[52:59], v176 abid:1
s_cbranch_scc1 L_loopk_w
L_loopk_wb:
v_smfmac_f32_16x16x64_bf16 v[40:43], a[248:251], v[92:99], v177
s_waitcnt lgkmcnt(0)
v_smfmac_f32_16x16x64_bf16 v[40:43], v[114:117], v[84:91], v185
v_smfmac_f32_16x16x64_bf16 v[36:39], v[114:117], v[84:91], v184 abid:1
s_waitcnt vmcnt(20)
s_barrier
v_smfmac_f32_16x16x64_bf16 v[8:11], a[252:255], v[60:67], v166
s_mov_b32 s42, s4
v_smfmac_f32_16x16x64_bf16 v[8:11], v[218:221], v[68:75], v170
ds_read_b128 v[44:47], v0 offset:0
v_add_u32_sdwa v84, s42, v122 dst_sel:DWORD dst_unused:UNUSED_PAD src0_sel:DWORD src1_sel:WORD_0
v_smfmac_f32_16x16x64_bf16 v[12:15], v[186:189], v[60:67], v166 abid:1
ds_read_b128 v[48:51], v1 offset:0
v_add_u32_sdwa v85, s42, v122 dst_sel:DWORD dst_unused:UNUSED_PAD src0_sel:DWORD src1_sel:WORD_1
v_smfmac_f32_16x16x64_bf16 v[12:15], v[222:225], v[68:75], v170 abid:1
ds_read_b128 v[52:55], v0 offset:2048
v_add_u32_sdwa v86, s42, v123 dst_sel:DWORD dst_unused:UNUSED_PAD src0_sel:DWORD src1_sel:WORD_0
v_smfmac_f32_16x16x64_bf16 v[16:19], v[190:193], v[60:67], v167
ds_read_b128 v[56:59], v1 offset:2048
v_cvt_pk_bf16_f32 v92, v8, v9
v_smfmac_f32_16x16x64_bf16 v[16:19], v[226:229], v[68:75], v171
ds_read_u16 v76, v76
v_cvt_pk_bf16_f32 v93, v10, v11
v_smfmac_f32_16x16x64_bf16 v[20:23], v[194:197], v[60:67], v167 abid:1
ds_read_b128 v[8:11], v2 offset:1024
v_cvt_pk_bf16_f32 v94, v12, v13
v_smfmac_f32_16x16x64_bf16 v[20:23], v[230:233], v[68:75], v171 abid:1
ds_read_u16 v77, v77
v_cvt_pk_bf16_f32 v95, v14, v15
v_smfmac_f32_16x16x64_bf16 v[24:27], v[198:201], v[60:67], v168
ds_read_b128 v[12:15], v2 offset:1088
v_cvt_pk_bf16_f32 v96, v16, v17
v_smfmac_f32_16x16x64_bf16 v[24:27], v[234:237], v[68:75], v172
ds_read_u16 v78, v78
v_cvt_pk_bf16_f32 v97, v18, v19
v_smfmac_f32_16x16x64_bf16 v[28:31], v[202:205], v[60:67], v168 abid:1
ds_read_b128 v[16:19], v2 offset:1152
v_cvt_pk_bf16_f32 v98, v20, v21
v_smfmac_f32_16x16x64_bf16 v[28:31], v[238:241], v[68:75], v172 abid:1
ds_read_u16 v79, v79
v_cvt_pk_bf16_f32 v99, v22, v23
v_smfmac_f32_16x16x64_bf16 v[32:35], v[206:209], v[60:67], v169
ds_read_b128 v[20:23], v2 offset:1216
v_cvt_pk_bf16_f32 v100, v24, v25
v_smfmac_f32_16x16x64_bf16 v[32:35], v[242:245], v[68:75], v173
ds_read_u16 v80, v80
v_cvt_pk_bf16_f32 v101, v26, v27
v_smfmac_f32_16x16x64_bf16 v[36:39], v[210:213], v[60:67], v169 abid:1
ds_read_b128 v[24:27], v2 offset:1280
v_cvt_pk_bf16_f32 v102, v28, v29
v_smfmac_f32_16x16x64_bf16 v[36:39], v[246:249], v[68:75], v173 abid:1
ds_read_u16 v81, v81
v_cvt_pk_bf16_f32 v103, v30, v31
v_smfmac_f32_16x16x64_bf16 v[40:43], v[214:217], v[60:67], v177 abid:1
s_bitcmp1_b32 s85, s41
ds_read_b128 v[28:31], v2 offset:1344
v_cvt_pk_bf16_f32 v104, v32, v33
v_smfmac_f32_16x16x64_bf16 v[40:43], v[250:253], v[68:75], v178
s_waitcnt lgkmcnt(10)
v_cvt_pk_bf16_f32 v105, v34, v35
s_cbranch_scc1 L_loopk
s_cmp_lg_u32 s41, 6
s_cbranch_scc1 L_loopnk
.p2align 3
L_loopck:
v_smfmac_f32_16x16x64_bf16 v[8:11], a[0:3], v[44:51], v138
ds_read_b128 v[32:35], v2 offset:1408
v_cvt_pk_bf16_f32 v106, v36, v37
v_mov_b32 v7, 1
v_smfmac_f32_16x16x64_bf16 v[8:11], a[36:39], v[52:59], v142
s_waitcnt lgkmcnt(9)
buffer_atomic_add v7, v6, s[32:35], 0 offen sc0 sc1
v_cvt_pk_bf16_f32 v107, v38, v39
v_smfmac_f32_16x16x64_bf16 v[12:15], a[4:7], v[44:51], v138 abid:1
ds_read_b128 v[36:39], v2 offset:1472
v_cvt_pk_bf16_f32 v112, v40, v41
v_smfmac_f32_16x16x64_bf16 v[12:15], a[40:43], v[52:59], v142 abid:1
s_waitcnt lgkmcnt(8)
ds_read_b128 v[60:63], v0 offset:4096
v_cvt_pk_bf16_f32 v113, v42, v43
v_smfmac_f32_16x16x64_bf16 v[16:19], a[8:11], v[44:51], v139
s_cmp_eq_u32 s4, 129920
ds_read_b128 v[40:43], v2 offset:1536
v_cndmask_b32_dpp v108, v96, v92, vcc quad_perm:[1,0,3,2] row_mask:0xf bank_mask:0xf
v_smfmac_f32_16x16x64_bf16 v[16:19], a[44:47], v[52:59], v143
s_waitcnt lgkmcnt(8)
ds_read_u16 v82, v82
v_cndmask_b32_dpp v109, v97, v93, vcc quad_perm:[1,0,3,2] row_mask:0xf bank_mask:0xf
v_smfmac_f32_16x16x64_bf16 v[20:23], a[12:15], v[44:51], v139 abid:1
s_cselect_b32 s43, -129920, s5
ds_read_u16 v84, v84
v_cndmask_b32_dpp v110, v98, v94, vcc quad_perm:[1,0,3,2] row_mask:0xf bank_mask:0xf
v_smfmac_f32_16x16x64_bf16 v[20:23], a[48:51], v[52:59], v143 abid:1
s_waitcnt lgkmcnt(8)
ds_read_b128 v[64:67], v1 offset:4096
v_cndmask_b32_dpp v111, v99, v95, vcc quad_perm:[1,0,3,2] row_mask:0xf bank_mask:0xf
v_smfmac_f32_16x16x64_bf16 v[24:27], a[16:19], v[44:51], v140
s_add_u32 s4, s4, s43
ds_read_b128 v[68:71], v0 offset:6144
v_add_u32_sdwa v87, s42, v123 dst_sel:DWORD dst_unused:UNUSED_PAD src0_sel:DWORD src1_sel:WORD_1
v_smfmac_f32_16x16x64_bf16 v[24:27], a[52:55], v[52:59], v144
buffer_store_dwordx4 v[108:111], v4, s[20:23], s46 offen offset:0 sc1
s_mov_b64 vcc, s[82:83]
s_waitcnt lgkmcnt(8)
ds_read_b128 v[72:75], v1 offset:6144
v_cndmask_b32_dpp v96, v92, v96, vcc quad_perm:[1,0,3,2] row_mask:0xf bank_mask:0xf
v_cndmask_b32_dpp v97, v93, v97, vcc quad_perm:[1,0,3,2] row_mask:0xf bank_mask:0xf
v_smfmac_f32_16x16x64_bf16 v[28:31], a[20:23], v[44:51], v140 abid:1
s_add_u32 s7, s45, s58
ds_read_u16 v83, v83
v_cndmask_b32_dpp v98, v94, v98, vcc quad_perm:[1,0,3,2] row_mask:0xf bank_mask:0xf
v_smfmac_f32_16x16x64_bf16 v[28:31], a[56:59], v[52:59], v144 abid:1
s_waitcnt lgkmcnt(9)
ds_read_b128 v[114:117], v2 offset:64
v_cndmask_b32_dpp v99, v95, v99, vcc quad_perm:[1,0,3,2] row_mask:0xf bank_mask:0xf
v_smfmac_f32_16x16x64_bf16 v[32:35], a[24:27], v[44:51], v141
ds_read_u16 v85, v85
v_add_u32_sdwa v88, s42, v124 dst_sel:DWORD dst_unused:UNUSED_PAD src0_sel:DWORD src1_sel:WORD_0
v_smfmac_f32_16x16x64_bf16 v[32:35], a[60:63], v[52:59], v145
s_waitcnt lgkmcnt(10)
ds_read_u16 v86, v86
v_add_u32_sdwa v89, s42, v124 dst_sel:DWORD dst_unused:UNUSED_PAD src0_sel:DWORD src1_sel:WORD_1
v_smfmac_f32_16x16x64_bf16 v[36:39], a[28:31], v[44:51], v141 abid:1
ds_read_u16 v87, v87
v_add_u32_sdwa v90, s42, v125 dst_sel:DWORD dst_unused:UNUSED_PAD src0_sel:DWORD src1_sel:WORD_0
v_smfmac_f32_16x16x64_bf16 v[36:39], a[64:67], v[52:59], v145 abid:1
s_waitcnt lgkmcnt(10)
ds_read_u16 v88, v88
v_add_u32_sdwa v91, s42, v125 dst_sel:DWORD dst_unused:UNUSED_PAD src0_sel:DWORD src1_sel:WORD_1
v_smfmac_f32_16x16x64_bf16 v[40:43], a[32:35], v[44:51], v174
buffer_store_dwordx4 v[96:99], v4, s[20:23], s46 offen offset:1152 sc1
s_mov_b64 vcc, s[80:81]
ds_read_u16 v89, v89
v_cndmask_b32_dpp v92, v104, v100, vcc quad_perm:[1,0,3,2] row_mask:0xf bank_mask:0xf
v_cndmask_b32_dpp v93, v105, v101, vcc quad_perm:[1,0,3,2] row_mask:0xf bank_mask:0xf
v_smfmac_f32_16x16x64_bf16 v[40:43], a[68:71], v[52:59], v174 abid:1
s_waitcnt lgkmcnt(9)
ds_read_u16 v90, v90
v_cndmask_b32_dpp v94, v106, v102, vcc quad_perm:[1,0,3,2] row_mask:0xf bank_mask:0xf
v_smfmac_f32_16x16x64_bf16 v[8:11], a[72:75], v[60:67], v146
s_waitcnt lgkmcnt(8)
ds_read_u16 v91, v91
v_cndmask_b32_dpp v95, v107, v103, vcc quad_perm:[1,0,3,2] row_mask:0xf bank_mask:0xf
v_smfmac_f32_16x16x64_bf16 v[8:11], a[108:111], v[68:75], v150
s_waitcnt lgkmcnt(7)
ds_bpermute_b32 v112, v6, v112
v_smfmac_f32_16x16x64_bf16 v[8:11], v[114:117], v[76:83], v179
ds_bpermute_b32 v113, v6, v113
v_smfmac_f32_16x16x64_bf16 v[12:15], v[114:117], v[76:83], v179 abid:1
ds_read_b128 v[114:117], v2 offset:128
v_add_u32_sdwa v76, s42, v126 dst_sel:DWORD dst_unused:UNUSED_PAD src0_sel:DWORD src1_sel:WORD_0
v_smfmac_f32_16x16x64_bf16 v[12:15], a[76:79], v[60:67], v146 abid:1
ds_read_u16 v76, v76
v_add_u32_sdwa v77, s42, v126 dst_sel:DWORD dst_unused:UNUSED_PAD src0_sel:DWORD src1_sel:WORD_1
v_smfmac_f32_16x16x64_bf16 v[12:15], a[112:115], v[68:75], v150 abid:1
buffer_store_dwordx4 v[92:95], v4, s[20:23], s46 offen offset:128 sc1
s_mov_b64 vcc, s[82:83]
ds_read_u16 v77, v77
v_cndmask_b32_dpp v104, v100, v104, vcc quad_perm:[1,0,3,2] row_mask:0xf bank_mask:0xf
v_cndmask_b32_dpp v105, v101, v105, vcc quad_perm:[1,0,3,2] row_mask:0xf bank_mask:0xf
v_smfmac_f32_16x16x64_bf16 v[24:27], a[88:91], v[60:67], v148
ds_read_b128 v[44:47], v0 offset:8192
v_add_u32_sdwa v78, s42, v127 dst_sel:DWORD dst_unused:UNUSED_PAD src0_sel:DWORD src1_sel:WORD_0
v_smfmac_f32_16x16x64_bf16 v[24:27], a[124:127], v[68:75], v152
ds_read_u16 v78, v78
v_cndmask_b32_dpp v106, v102, v106, vcc quad_perm:[1,0,3,2] row_mask:0xf bank_mask:0xf
v_smfmac_f32_16x16x64_bf16 v[28:31], a[92:95], v[60:67], v148 abid:1
ds_read_b128 v[48:51], v1 offset:8192
v_cndmask_b32_dpp v107, v103, v107, vcc quad_perm:[1,0,3,2] row_mask:0xf bank_mask:0xf
v_smfmac_f32_16x16x64_bf16 v[28:31], a[128:131], v[68:75], v152 abid:1
ds_read_b128 v[52:55], v0 offset:10240
v_add_u32_sdwa v79, s42, v127 dst_sel:DWORD dst_unused:UNUSED_PAD src0_sel:DWORD src1_sel:WORD_1
v_smfmac_f32_16x16x64_bf16 v[32:35], a[96:99], v[60:67], v149
ds_read_u16 v79, v79
v_add_u32_sdwa v80, s42, v128 dst_sel:DWORD dst_unused:UNUSED_PAD src0_sel:DWORD src1_sel:WORD_0
v_smfmac_f32_16x16x64_bf16 v[32:35], a[132:135], v[68:75], v153
ds_read_u16 v80, v80
v_add_u32_sdwa v81, s42, v128 dst_sel:DWORD dst_unused:UNUSED_PAD src0_sel:DWORD src1_sel:WORD_1
v_smfmac_f32_16x16x64_bf16 v[16:19], a[80:83], v[60:67], v147
buffer_store_dwordx4 v[104:107], v4, s[20:23], s46 offen offset:1280 sc1
s_mov_b64 vcc, s[80:81]
ds_read_b128 v[56:59], v1 offset:10240
v_add_u32_sdwa v82, s42, v129 dst_sel:DWORD dst_unused:UNUSED_PAD src0_sel:DWORD src1_sel:WORD_0
v_add_u32_sdwa v83, s42, v129 dst_sel:DWORD dst_unused:UNUSED_PAD src0_sel:DWORD src1_sel:WORD_1
v_smfmac_f32_16x16x64_bf16 v[16:19], a[116:119], v[68:75], v151
s_waitcnt lgkmcnt(9)
ds_read_b128 v[92:95], v0 offset:12288
v_add_u32_sdwa v100, s42, v130 dst_sel:DWORD dst_unused:UNUSED_PAD src0_sel:DWORD src1_sel:WORD_0
v_smfmac_f32_16x16x64_bf16 v[16:19], v[114:117], v[84:91], v180 abid:1
ds_read_u16 v81, v81
v_add_u32_sdwa v101, s42, v130 dst_sel:DWORD dst_unused:UNUSED_PAD src0_sel:DWORD src1_sel:WORD_1
v_smfmac_f32_16x16x64_bf16 v[12:15], v[114:117], v[84:91], v180
ds_read_b128 v[96:99], v1 offset:12288
v_add_u32_sdwa v102, s42, v131 dst_sel:DWORD dst_unused:UNUSED_PAD src0_sel:DWORD src1_sel:WORD_0
v_smfmac_f32_16x16x64_bf16 v[20:23], v[114:117], v[84:91], v181
ds_read_u16 v82, v82
v_add_u32_sdwa v103, s42, v131 dst_sel:DWORD dst_unused:UNUSED_PAD src0_sel:DWORD src1_sel:WORD_1
v_smfmac_f32_16x16x64_bf16 v[20:23], a[84:87], v[60:67], v147 abid:1
ds_read_u16 v100, v100
v_add_u32_sdwa v104, s42, v132 dst_sel:DWORD dst_unused:UNUSED_PAD src0_sel:DWORD src1_sel:WORD_0
v_smfmac_f32_16x16x64_bf16 v[20:23], a[120:123], v[68:75], v151 abid:1
ds_read_u16 v83, v83
v_add_u32_sdwa v105, s42, v132 dst_sel:DWORD dst_unused:UNUSED_PAD src0_sel:DWORD src1_sel:WORD_1
v_smfmac_f32_16x16x64_bf16 v[36:39], a[100:103], v[60:67], v149 abid:1
buffer_store_dwordx2 v[112:113], v5, s[20:23], s46 offen
ds_read_b128 v[114:117], v2 offset:192
v_add_u32_sdwa v106, s42, v133 dst_sel:DWORD dst_unused:UNUSED_PAD src0_sel:DWORD src1_sel:WORD_0
v_smfmac_f32_16x16x64_bf16 v[36:39], a[136:139], v[68:75], v153 abid:1
s_mov_b32 s46, s48
ds_read_u16 v101, v101
v_add_u32_sdwa v107, s42, v133 dst_sel:DWORD dst_unused:UNUSED_PAD src0_sel:DWORD src1_sel:WORD_1
v_smfmac_f32_16x16x64_bf16 v[40:43], a[104:107], v[60:67], v175
s_mov_b32 s48, s49
ds_read_u16 v102, v102
v_add_u32_sdwa v84, s42, v134 dst_sel:DWORD dst_unused:UNUSED_PAD src0_sel:DWORD src1_sel:WORD_0
v_smfmac_f32_16x16x64_bf16 v[40:43], a[140:143], v[68:75], v175 abid:1
s_waitcnt lgkmcnt(13)
ds_read_u16 v103, v103
v_add_u32_sdwa v85, s42, v134 dst_sel:DWORD dst_unused:UNUSED_PAD src0_sel:DWORD src1_sel:WORD_1
v_smfmac_f32_16x16x64_bf16 v[8:11], a[144:147], v[44:51], v154
s_waitcnt lgkmcnt(10)
ds_read_u16 v104, v104
v_add_u32_sdwa v86, s42, v135 dst_sel:DWORD dst_unused:UNUSED_PAD src0_sel:DWORD src1_sel:WORD_0
v_smfmac_f32_16x16x64_bf16 v[8:11], a[180:183], v[52:59], v158
s_waitcnt lgkmcnt(8)
ds_read_u16 v105, v105
v_add_u32_sdwa v87, s42, v135 dst_sel:DWORD dst_unused:UNUSED_PAD src0_sel:DWORD src1_sel:WORD_1
v_smfmac_f32_16x16x64_bf16 v[8:11], a[216:219], v[92:99], v162
s_add_u32 m0, s44, 0
ds_read_u16 v106, v106
v_add_u32_sdwa v88, s42, v136 dst_sel:DWORD dst_unused:UNUSED_PAD src0_sel:DWORD src1_sel:WORD_0
v_smfmac_f32_16x16x64_bf16 v[24:27], a[160:163], v[44:51], v156
buffer_load_dwordx4 v3, s[16:19], s45 offen offset:0 nt lds
v_add_u32_sdwa v89, s42, v136 dst_sel:DWORD dst_unused:UNUSED_PAD src0_sel:DWORD src1_sel:WORD_1
v_smfmac_f32_16x16x64_bf16 v[24:27], a[196:199], v[52:59], v160
s_mov_b32 s49, s50
ds_read_u16 v107, v107
v_add_u32_sdwa v90, s42, v137 dst_sel:DWORD dst_unused:UNUSED_PAD src0_sel:DWORD src1_sel:WORD_0
v_smfmac_f32_16x16x64_bf16 v[24:27], a[232:235], v[92:99], v164
s_waitcnt lgkmcnt(7)
s_waitcnt vmcnt(6)
ds_read_u16 v84, v84
v_add_u32_sdwa v91, s42, v137 dst_sel:DWORD dst_unused:UNUSED_PAD src0_sel:DWORD src1_sel:WORD_1
v_smfmac_f32_16x16x64_bf16 v[24:27], v[114:117], v[76:83], v182
s_mov_b32 s50, s45
ds_read_u16 v85, v85
v_smfmac_f32_16x16x64_bf16 v[20:23], v[114:117], v[76:83], v181 abid:1
ds_read_u16 v86, v86
v_smfmac_f32_16x16x64_bf16 v[28:31], v[114:117], v[76:83], v182 abid:1
ds_read_b128 v[114:117], v2 offset:256
v_add_u32_sdwa v76, s4, v118 dst_sel:DWORD dst_unused:UNUSED_PAD src0_sel:DWORD src1_sel:WORD_0
v_smfmac_f32_16x16x64_bf16 v[28:31], a[164:167], v[44:51], v156 abid:1
ds_read_u16 v87, v87
v_add_u32_sdwa v77, s4, v118 dst_sel:DWORD dst_unused:UNUSED_PAD src0_sel:DWORD src1_sel:WORD_1
v_smfmac_f32_16x16x64_bf16 v[28:31], a[200:203], v[52:59], v160 abid:1
ds_read_u16 v88, v88
v_add_u32_sdwa v78, s4, v119 dst_sel:DWORD dst_unused:UNUSED_PAD src0_sel:DWORD src1_sel:WORD_0
v_smfmac_f32_16x16x64_bf16 v[28:31], a[236:239], v[92:99], v164 abid:1
ds_read_b128 v[60:63], v0 offset:14336
v_add_u32_sdwa v79, s4, v119 dst_sel:DWORD dst_unused:UNUSED_PAD src0_sel:DWORD src1_sel:WORD_1
v_smfmac_f32_16x16x64_bf16 v[12:15], a[148:151], v[44:51], v154 abid:1
ds_read_u16 v89, v89
v_add_u32_sdwa v80, s4, v120 dst_sel:DWORD dst_unused:UNUSED_PAD src0_sel:DWORD src1_sel:WORD_0
v_smfmac_f32_16x16x64_bf16 v[12:15], a[184:187], v[52:59], v158 abid:1
s_add_u32 m0, s44, 3840
ds_read_b128 v[64:67], v1 offset:14336
v_add_u32_sdwa v81, s4, v120 dst_sel:DWORD dst_unused:UNUSED_PAD src0_sel:DWORD src1_sel:WORD_1
v_smfmac_f32_16x16x64_bf16 v[12:15], a[220:223], v[92:99], v162 abid:1
buffer_load_dwordx4 v3, s[16:19], s45 offen offset:256 nt lds
v_add_u32_sdwa v82, s4, v121 dst_sel:DWORD dst_unused:UNUSED_PAD src0_sel:DWORD src1_sel:WORD_0
v_smfmac_f32_16x16x64_bf16 v[32:35], a[168:171], v[44:51], v157
ds_read_b128 v[68:71], v0 offset:16384
v_add_u32_sdwa v83, s4, v121 dst_sel:DWORD dst_unused:UNUSED_PAD src0_sel:DWORD src1_sel:WORD_1
v_smfmac_f32_16x16x64_bf16 v[32:35], a[204:207], v[52:59], v161
ds_read_u16 v90, v90
v_smfmac_f32_16x16x64_bf16 v[32:35], a[240:243], v[92:99], v165
s_waitcnt lgkmcnt(7)
ds_read_b128 v[72:75], v1 offset:16384
v_add_u32 v0, s43, v0
v_smfmac_f32_16x16x64_bf16 v[32:35], v[114:117], v[100:107], v183 abid:1
ds_read_u16 v91, v91
v_add_u32 v1, s43, v1
v_smfmac_f32_16x16x64_bf16 v[28:31], v[114:117], v[100:107], v183
v_smfmac_f32_16x16x64_bf16 v[36:39], v[114:117], v[100:107], v184
ds_read_b128 v[114:117], v2 offset:320
v_smfmac_f32_16x16x64_bf16 v[36:39], a[172:175], v[44:51], v157 abid:1
s_add_u32 m0, s44, 7680
v_smfmac_f32_16x16x64_bf16 v[36:39], a[208:211], v[52:59], v161 abid:1
buffer_load_dwordx4 v3, s[16:19], s45 offen offset:512 nt lds
v_smfmac_f32_16x16x64_bf16 v[36:39], a[244:247], v[92:99], v165 abid:1
v_smfmac_f32_16x16x64_bf16 v[16:19], a[152:155], v[44:51], v155
s_add_u32 m0, s44, 11520
v_smfmac_f32_16x16x64_bf16 v[16:19], a[188:191], v[52:59], v159
buffer_load_dwordx4 v3, s[16:19], s45 offen offset:768 nt lds
v_smfmac_f32_16x16x64_bf16 v[16:19], a[224:227], v[92:99], v163
s_mov_b64 exec, s[62:63]
ds_write_b32 v0, v7 offset:18432
s_mov_b64 exec, -1
v_smfmac_f32_16x16x64_bf16 v[20:23], a[156:159], v[44:51], v155 abid:1
s_add_u32 m0, s44, s8
v_smfmac_f32_16x16x64_bf16 v[20:23], a[192:195], v[52:59], v159 abid:1
s_mov_b64 exec, s[10:11]
buffer_load_dwordx4 v3, s[16:19], s7 offen offset:896 nt lds
s_mov_b64 exec, -1
v_smfmac_f32_16x16x64_bf16 v[20:23], a[228:231], v[92:99], v163 abid:1
s_add_u32 s44, s44, s5
s_cmp_ge_u32 s44, 148480
s_cselect_b32 s44, s9, s44
v_smfmac_f32_16x16x64_bf16 v[40:43], a[176:179], v[44:51], v176
v_smfmac_f32_16x16x64_bf16 v[40:43], a[212:215], v[52:59], v176 abid:1
v_smfmac_f32_16x16x64_bf16 v[40:43], a[248:251], v[92:99], v177
s_waitcnt lgkmcnt(0)
v_smfmac_f32_16x16x64_bf16 v[40:43], v[114:117], v[84:91], v185
v_smfmac_f32_16x16x64_bf16 v[36:39], v[114:117], v[84:91], v184 abid:1
s_barrier
v_smfmac_f32_16x16x64_bf16 v[8:11], a[252:255], v[60:67], v166
s_mov_b32 s42, s4
ds_read_b32 v7, v0 offset:18432
v_smfmac_f32_16x16x64_bf16 v[8:11], v[218:221], v[68:75], v170
ds_read_b128 v[44:47], v0 offset:0
v_add_u32_sdwa v84, s42, v122 dst_sel:DWORD dst_unused:UNUSED_PAD src0_sel:DWORD src1_sel:WORD_0
v_smfmac_f32_16x16x64_bf16 v[12:15], v[186:189], v[60:67], v166 abid:1
ds_read_b128 v[48:51], v1 offset:0
v_add_u32_sdwa v85, s42, v122 dst_sel:DWORD dst_unused:UNUSED_PAD src0_sel:DWORD src1_sel:WORD_1
v_smfmac_f32_16x16x64_bf16 v[12:15], v[222:225], v[68:75], v170 abid:1
ds_read_b128 v[52:55], v0 offset:2048
v_add_u32_sdwa v86, s42, v123 dst_sel:DWORD dst_unused:UNUSED_PAD src0_sel:DWORD src1_sel:WORD_0
v_smfmac_f32_16x16x64_bf16 v[16:19], v[190:193], v[60:67], v167
ds_read_b128 v[56:59], v1 offset:2048
v_cvt_pk_bf16_f32 v92, v8, v9
v_smfmac_f32_16x16x64_bf16 v[16:19], v[226:229], v[68:75], v171
ds_read_u16 v76, v76
v_cvt_pk_bf16_f32 v93, v10, v11
v_smfmac_f32_16x16x64_bf16 v[20:23], v[194:197], v[60:67], v167 abid:1
ds_read_b128 v[8:11], v2 offset:1024
v_cvt_pk_bf16_f32 v94, v12, v13
v_smfmac_f32_16x16x64_bf16 v[20:23], v[230:233], v[68:75], v171 abid:1
ds_read_u16 v77, v77
v_cvt_pk_bf16_f32 v95, v14, v15
v_smfmac_f32_16x16x64_bf16 v[24:27], v[198:201], v[60:67], v168
ds_read_b128 v[12:15], v2 offset:1088
v_cvt_pk_bf16_f32 v96, v16, v17
v_smfmac_f32_16x16x64_bf16 v[24:27], v[234:237], v[68:75], v172
s_waitcnt lgkmcnt(8)
ds_read_u16 v78, v78
v_cvt_pk_bf16_f32 v97, v18, v19
v_readfirstlane_b32 s56, v7
v_smfmac_f32_16x16x64_bf16 v[28:31], v[202:205], v[60:67], v168 abid:1
s_lshr_b32 s60, s56, 4
ds_read_b128 v[16:19], v2 offset:1152
v_cvt_pk_bf16_f32 v98, v20, v21
v_smfmac_f32_16x16x64_bf16 v[28:31], v[238:241], v[68:75], v172 abid:1
s_mul_i32 s60, s60, 884736
ds_read_u16 v79, v79
v_cvt_pk_bf16_f32 v99, v22, v23
v_smfmac_f32_16x16x64_bf16 v[32:35], v[206:209], v[60:67], v169
s_mul_i32 s61, s56, 18432
ds_read_b128 v[20:23], v2 offset:1216
v_cvt_pk_bf16_f32 v100, v24, v25
v_smfmac_f32_16x16x64_bf16 v[32:35], v[242:245], v[68:75], v173
s_add_u32 s60, s60, s57
ds_read_u16 v80, v80
v_cvt_pk_bf16_f32 v101, v26, v27
v_smfmac_f32_16x16x64_bf16 v[36:39], v[210:213], v[60:67], v169 abid:1
s_add_u32 s45, s60, s61
ds_read_b128 v[24:27], v2 offset:1280
v_cvt_pk_bf16_f32 v102, v28, v29
v_smfmac_f32_16x16x64_bf16 v[36:39], v[246:249], v[68:75], v173 abid:1
ds_read_u16 v81, v81
v_cvt_pk_bf16_f32 v103, v30, v31
v_smfmac_f32_16x16x64_bf16 v[40:43], v[214:217], v[60:67], v177 abid:1
s_cmp_lt_u32 s56, 384
ds_read_b128 v[28:31], v2 offset:1344
v_cvt_pk_bf16_f32 v104, v32, v33
v_smfmac_f32_16x16x64_bf16 v[40:43], v[250:253], v[68:75], v178
s_waitcnt lgkmcnt(10)
v_cvt_pk_bf16_f32 v105, v34, v35
s_cbranch_scc1 L_loopck
s_mov_b32 s41, 0
s_mov_b32 s15, 3
s_mov_b32 s12, 7
s_mov_b32 s92, 4
s_mov_b32 s87, 4
s_mov_b32 s59, -1
.p2align 3
L_loopnk:
v_smfmac_f32_16x16x64_bf16 v[8:11], a[0:3], v[44:51], v138
ds_read_b128 v[32:35], v2 offset:1408
v_cvt_pk_bf16_f32 v106, v36, v37
v_smfmac_f32_16x16x64_bf16 v[8:11], a[36:39], v[52:59], v142
s_waitcnt lgkmcnt(9)
v_cvt_pk_bf16_f32 v107, v38, v39
v_smfmac_f32_16x16x64_bf16 v[12:15], a[4:7], v[44:51], v138 abid:1
ds_read_b128 v[36:39], v2 offset:1472
v_cvt_pk_bf16_f32 v112, v40, v41
v_smfmac_f32_16x16x64_bf16 v[12:15], a[40:43], v[52:59], v142 abid:1
s_waitcnt lgkmcnt(8)
ds_read_b128 v[60:63], v0 offset:4096
v_cvt_pk_bf16_f32 v113, v42, v43
v_smfmac_f32_16x16x64_bf16 v[16:19], a[8:11], v[44:51], v139
s_cmp_eq_u32 s4, 129920
ds_read_b128 v[40:43], v2 offset:1536
v_cndmask_b32_dpp v108, v96, v92, vcc quad_perm:[1,0,3,2] row_mask:0xf bank_mask:0xf
v_smfmac_f32_16x16x64_bf16 v[16:19], a[44:47], v[52:59], v143
s_waitcnt lgkmcnt(8)
ds_read_u16 v82, v82
v_cndmask_b32_dpp v109, v97, v93, vcc quad_perm:[1,0,3,2] row_mask:0xf bank_mask:0xf
v_smfmac_f32_16x16x64_bf16 v[20:23], a[12:15], v[44:51], v139 abid:1
s_cselect_b32 s43, -129920, s5
ds_read_u16 v84, v84
v_cndmask_b32_dpp v110, v98, v94, vcc quad_perm:[1,0,3,2] row_mask:0xf bank_mask:0xf
v_smfmac_f32_16x16x64_bf16 v[20:23], a[48:51], v[52:59], v143 abid:1
s_waitcnt lgkmcnt(8)
ds_read_b128 v[64:67], v1 offset:4096
v_cndmask_b32_dpp v111, v99, v95, vcc quad_perm:[1,0,3,2] row_mask:0xf bank_mask:0xf
v_smfmac_f32_16x16x64_bf16 v[24:27], a[16:19], v[44:51], v140
s_add_u32 s4, s4, s43
ds_read_b128 v[68:71], v0 offset:6144
v_add_u32_sdwa v87, s42, v123 dst_sel:DWORD dst_unused:UNUSED_PAD src0_sel:DWORD src1_sel:WORD_1
v_smfmac_f32_16x16x64_bf16 v[24:27], a[52:55], v[52:59], v144
buffer_store_dwordx4 v[108:111], v4, s[20:23], s46 offen offset:0 sc1
s_mov_b64 vcc, s[82:83]
s_waitcnt lgkmcnt(8)
ds_read_b128 v[72:75], v1 offset:6144
v_cndmask_b32_dpp v96, v92, v96, vcc quad_perm:[1,0,3,2] row_mask:0xf bank_mask:0xf
v_cndmask_b32_dpp v97, v93, v97, vcc quad_perm:[1,0,3,2] row_mask:0xf bank_mask:0xf
v_smfmac_f32_16x16x64_bf16 v[28:31], a[20:23], v[44:51], v140 abid:1
s_add_u32 s41, s41, 1
ds_read_u16 v83, v83
v_cndmask_b32_dpp v98, v94, v98, vcc quad_perm:[1,0,3,2] row_mask:0xf bank_mask:0xf
v_smfmac_f32_16x16x64_bf16 v[28:31], a[56:59], v[52:59], v144 abid:1
s_waitcnt lgkmcnt(9)
ds_read_b128 v[114:117], v2 offset:64
v_cndmask_b32_dpp v99, v95, v99, vcc quad_perm:[1,0,3,2] row_mask:0xf bank_mask:0xf
v_smfmac_f32_16x16x64_bf16 v[32:35], a[24:27], v[44:51], v141
ds_read_u16 v85, v85
v_add_u32_sdwa v88, s42, v124 dst_sel:DWORD dst_unused:UNUSED_PAD src0_sel:DWORD src1_sel:WORD_0
v_smfmac_f32_16x16x64_bf16 v[32:35], a[60:63], v[52:59], v145
s_waitcnt lgkmcnt(10)
ds_read_u16 v86, v86
v_add_u32_sdwa v89, s42, v124 dst_sel:DWORD dst_unused:UNUSED_PAD src0_sel:DWORD src1_sel:WORD_1
v_smfmac_f32_16x16x64_bf16 v[36:39], a[28:31], v[44:51], v141 abid:1
ds_read_u16 v87, v87
v_add_u32_sdwa v90, s42, v125 dst_sel:DWORD dst_unused:UNUSED_PAD src0_sel:DWORD src1_sel:WORD_0
v_smfmac_f32_16x16x64_bf16 v[36:39], a[64:67], v[52:59], v145 abid:1
s_waitcnt lgkmcnt(10)
ds_read_u16 v88, v88
v_add_u32_sdwa v91, s42, v125 dst_sel:DWORD dst_unused:UNUSED_PAD src0_sel:DWORD src1_sel:WORD_1
v_smfmac_f32_16x16x64_bf16 v[40:43], a[32:35], v[44:51], v174
buffer_store_dwordx4 v[96:99], v4, s[20:23], s46 offen offset:1152 sc1
s_mov_b64 vcc, s[80:81]
ds_read_u16 v89, v89
v_cndmask_b32_dpp v92, v104, v100, vcc quad_perm:[1,0,3,2] row_mask:0xf bank_mask:0xf
v_cndmask_b32_dpp v93, v105, v101, vcc quad_perm:[1,0,3,2] row_mask:0xf bank_mask:0xf
v_smfmac_f32_16x16x64_bf16 v[40:43], a[68:71], v[52:59], v174 abid:1
s_waitcnt lgkmcnt(9)
ds_read_u16 v90, v90
v_cndmask_b32_dpp v94, v106, v102, vcc quad_perm:[1,0,3,2] row_mask:0xf bank_mask:0xf
v_smfmac_f32_16x16x64_bf16 v[8:11], a[72:75], v[60:67], v146
s_waitcnt lgkmcnt(8)
ds_read_u16 v91, v91
v_cndmask_b32_dpp v95, v107, v103, vcc quad_perm:[1,0,3,2] row_mask:0xf bank_mask:0xf
v_smfmac_f32_16x16x64_bf16 v[8:11], a[108:111], v[68:75], v150
s_waitcnt lgkmcnt(7)
ds_bpermute_b32 v112, v6, v112
v_smfmac_f32_16x16x64_bf16 v[8:11], v[114:117], v[76:83], v179
ds_bpermute_b32 v113, v6, v113
v_smfmac_f32_16x16x64_bf16 v[12:15], v[114:117], v[76:83], v179 abid:1
ds_read_b128 v[114:117], v2 offset:128
v_add_u32_sdwa v76, s42, v126 dst_sel:DWORD dst_unused:UNUSED_PAD src0_sel:DWORD src1_sel:WORD_0
v_smfmac_f32_16x16x64_bf16 v[12:15], a[76:79], v[60:67], v146 abid:1
ds_read_u16 v76, v76
v_add_u32_sdwa v77, s42, v126 dst_sel:DWORD dst_unused:UNUSED_PAD src0_sel:DWORD src1_sel:WORD_1
v_smfmac_f32_16x16x64_bf16 v[12:15], a[112:115], v[68:75], v150 abid:1
buffer_store_dwordx4 v[92:95], v4, s[20:23], s46 offen offset:128 sc1
s_mov_b64 vcc, s[82:83]
ds_read_u16 v77, v77
v_cndmask_b32_dpp v104, v100, v104, vcc quad_perm:[1,0,3,2] row_mask:0xf bank_mask:0xf
v_cndmask_b32_dpp v105, v101, v105, vcc quad_perm:[1,0,3,2] row_mask:0xf bank_mask:0xf
v_smfmac_f32_16x16x64_bf16 v[24:27], a[88:91], v[60:67], v148
ds_read_b128 v[44:47], v0 offset:8192
v_add_u32_sdwa v78, s42, v127 dst_sel:DWORD dst_unused:UNUSED_PAD src0_sel:DWORD src1_sel:WORD_0
v_smfmac_f32_16x16x64_bf16 v[24:27], a[124:127], v[68:75], v152
ds_read_u16 v78, v78
v_cndmask_b32_dpp v106, v102, v106, vcc quad_perm:[1,0,3,2] row_mask:0xf bank_mask:0xf
v_smfmac_f32_16x16x64_bf16 v[28:31], a[92:95], v[60:67], v148 abid:1
ds_read_b128 v[48:51], v1 offset:8192
v_cndmask_b32_dpp v107, v103, v107, vcc quad_perm:[1,0,3,2] row_mask:0xf bank_mask:0xf
v_smfmac_f32_16x16x64_bf16 v[28:31], a[128:131], v[68:75], v152 abid:1
ds_read_b128 v[52:55], v0 offset:10240
v_add_u32_sdwa v79, s42, v127 dst_sel:DWORD dst_unused:UNUSED_PAD src0_sel:DWORD src1_sel:WORD_1
v_smfmac_f32_16x16x64_bf16 v[32:35], a[96:99], v[60:67], v149
ds_read_u16 v79, v79
v_add_u32_sdwa v80, s42, v128 dst_sel:DWORD dst_unused:UNUSED_PAD src0_sel:DWORD src1_sel:WORD_0
v_smfmac_f32_16x16x64_bf16 v[32:35], a[132:135], v[68:75], v153
ds_read_u16 v80, v80
v_add_u32_sdwa v81, s42, v128 dst_sel:DWORD dst_unused:UNUSED_PAD src0_sel:DWORD src1_sel:WORD_1
v_smfmac_f32_16x16x64_bf16 v[16:19], a[80:83], v[60:67], v147
buffer_store_dwordx4 v[104:107], v4, s[20:23], s46 offen offset:1280 sc1
s_mov_b64 vcc, s[80:81]
ds_read_b128 v[56:59], v1 offset:10240
v_add_u32_sdwa v82, s42, v129 dst_sel:DWORD dst_unused:UNUSED_PAD src0_sel:DWORD src1_sel:WORD_0
v_add_u32_sdwa v83, s42, v129 dst_sel:DWORD dst_unused:UNUSED_PAD src0_sel:DWORD src1_sel:WORD_1
v_smfmac_f32_16x16x64_bf16 v[16:19], a[116:119], v[68:75], v151
s_waitcnt lgkmcnt(9)
ds_read_b128 v[92:95], v0 offset:12288
v_add_u32_sdwa v100, s42, v130 dst_sel:DWORD dst_unused:UNUSED_PAD src0_sel:DWORD src1_sel:WORD_0
v_smfmac_f32_16x16x64_bf16 v[16:19], v[114:117], v[84:91], v180 abid:1
ds_read_u16 v81, v81
v_add_u32_sdwa v101, s42, v130 dst_sel:DWORD dst_unused:UNUSED_PAD src0_sel:DWORD src1_sel:WORD_1
v_smfmac_f32_16x16x64_bf16 v[12:15], v[114:117], v[84:91], v180
ds_read_b128 v[96:99], v1 offset:12288
v_add_u32_sdwa v102, s42, v131 dst_sel:DWORD dst_unused:UNUSED_PAD src0_sel:DWORD src1_sel:WORD_0
v_smfmac_f32_16x16x64_bf16 v[20:23], v[114:117], v[84:91], v181
ds_read_u16 v82, v82
v_add_u32_sdwa v103, s42, v131 dst_sel:DWORD dst_unused:UNUSED_PAD src0_sel:DWORD src1_sel:WORD_1
v_smfmac_f32_16x16x64_bf16 v[20:23], a[84:87], v[60:67], v147 abid:1
ds_read_u16 v100, v100
v_add_u32_sdwa v104, s42, v132 dst_sel:DWORD dst_unused:UNUSED_PAD src0_sel:DWORD src1_sel:WORD_0
v_smfmac_f32_16x16x64_bf16 v[20:23], a[120:123], v[68:75], v151 abid:1
ds_read_u16 v83, v83
v_add_u32_sdwa v105, s42, v132 dst_sel:DWORD dst_unused:UNUSED_PAD src0_sel:DWORD src1_sel:WORD_1
v_smfmac_f32_16x16x64_bf16 v[36:39], a[100:103], v[60:67], v149 abid:1
buffer_store_dwordx2 v[112:113], v5, s[20:23], s46 offen
ds_read_b128 v[114:117], v2 offset:192
v_add_u32_sdwa v106, s42, v133 dst_sel:DWORD dst_unused:UNUSED_PAD src0_sel:DWORD src1_sel:WORD_0
v_smfmac_f32_16x16x64_bf16 v[36:39], a[136:139], v[68:75], v153 abid:1
s_mov_b32 s22, 75497472
ds_read_u16 v101, v101
v_add_u32_sdwa v107, s42, v133 dst_sel:DWORD dst_unused:UNUSED_PAD src0_sel:DWORD src1_sel:WORD_1
v_smfmac_f32_16x16x64_bf16 v[40:43], a[104:107], v[60:67], v175
s_mov_b32 s46, s48
ds_read_u16 v102, v102
v_add_u32_sdwa v84, s42, v134 dst_sel:DWORD dst_unused:UNUSED_PAD src0_sel:DWORD src1_sel:WORD_0
v_smfmac_f32_16x16x64_bf16 v[40:43], a[140:143], v[68:75], v175 abid:1
s_waitcnt lgkmcnt(13)
ds_read_u16 v103, v103
v_add_u32_sdwa v85, s42, v134 dst_sel:DWORD dst_unused:UNUSED_PAD src0_sel:DWORD src1_sel:WORD_1
v_smfmac_f32_16x16x64_bf16 v[8:11], a[144:147], v[44:51], v154
s_waitcnt lgkmcnt(10)
ds_read_u16 v104, v104
v_add_u32_sdwa v86, s42, v135 dst_sel:DWORD dst_unused:UNUSED_PAD src0_sel:DWORD src1_sel:WORD_0
v_smfmac_f32_16x16x64_bf16 v[8:11], a[180:183], v[52:59], v158
s_waitcnt lgkmcnt(8)
ds_read_u16 v105, v105
v_add_u32_sdwa v87, s42, v135 dst_sel:DWORD dst_unused:UNUSED_PAD src0_sel:DWORD src1_sel:WORD_1
v_smfmac_f32_16x16x64_bf16 v[8:11], a[216:219], v[92:99], v162
s_mov_b32 s48, s49
ds_read_u16 v106, v106
v_add_u32_sdwa v88, s42, v136 dst_sel:DWORD dst_unused:UNUSED_PAD src0_sel:DWORD src1_sel:WORD_0
v_smfmac_f32_16x16x64_bf16 v[24:27], a[160:163], v[44:51], v156
s_mov_b32 s49, s50
s_add_u32 s50, s50, 4718592
v_add_u32_sdwa v89, s42, v136 dst_sel:DWORD dst_unused:UNUSED_PAD src0_sel:DWORD src1_sel:WORD_1
v_smfmac_f32_16x16x64_bf16 v[24:27], a[196:199], v[52:59], v160
ds_read_u16 v107, v107
v_add_u32_sdwa v90, s42, v137 dst_sel:DWORD dst_unused:UNUSED_PAD src0_sel:DWORD src1_sel:WORD_0
v_smfmac_f32_16x16x64_bf16 v[24:27], a[232:235], v[92:99], v164
s_waitcnt lgkmcnt(7)
ds_read_u16 v84, v84
v_add_u32_sdwa v91, s42, v137 dst_sel:DWORD dst_unused:UNUSED_PAD src0_sel:DWORD src1_sel:WORD_1
v_smfmac_f32_16x16x64_bf16 v[24:27], v[114:117], v[76:83], v182
ds_read_u16 v85, v85
v_smfmac_f32_16x16x64_bf16 v[20:23], v[114:117], v[76:83], v181 abid:1
ds_read_u16 v86, v86
v_smfmac_f32_16x16x64_bf16 v[28:31], v[114:117], v[76:83], v182 abid:1
ds_read_b128 v[114:117], v2 offset:256
v_add_u32_sdwa v76, s4, v118 dst_sel:DWORD dst_unused:UNUSED_PAD src0_sel:DWORD src1_sel:WORD_0
v_smfmac_f32_16x16x64_bf16 v[28:31], a[164:167], v[44:51], v156 abid:1
ds_read_u16 v87, v87
v_add_u32_sdwa v77, s4, v118 dst_sel:DWORD dst_unused:UNUSED_PAD src0_sel:DWORD src1_sel:WORD_1
v_smfmac_f32_16x16x64_bf16 v[28:31], a[200:203], v[52:59], v160 abid:1
ds_read_u16 v88, v88
v_add_u32_sdwa v78, s4, v119 dst_sel:DWORD dst_unused:UNUSED_PAD src0_sel:DWORD src1_sel:WORD_0
v_smfmac_f32_16x16x64_bf16 v[28:31], a[236:239], v[92:99], v164 abid:1
ds_read_b128 v[60:63], v0 offset:14336
v_add_u32_sdwa v79, s4, v119 dst_sel:DWORD dst_unused:UNUSED_PAD src0_sel:DWORD src1_sel:WORD_1
v_smfmac_f32_16x16x64_bf16 v[12:15], a[148:151], v[44:51], v154 abid:1
ds_read_u16 v89, v89
v_add_u32_sdwa v80, s4, v120 dst_sel:DWORD dst_unused:UNUSED_PAD src0_sel:DWORD src1_sel:WORD_0
v_smfmac_f32_16x16x64_bf16 v[12:15], a[184:187], v[52:59], v158 abid:1
ds_read_b128 v[64:67], v1 offset:14336
v_add_u32_sdwa v81, s4, v120 dst_sel:DWORD dst_unused:UNUSED_PAD src0_sel:DWORD src1_sel:WORD_1
v_smfmac_f32_16x16x64_bf16 v[12:15], a[220:223], v[92:99], v162 abid:1
v_add_u32_sdwa v82, s4, v121 dst_sel:DWORD dst_unused:UNUSED_PAD src0_sel:DWORD src1_sel:WORD_0
v_smfmac_f32_16x16x64_bf16 v[32:35], a[168:171], v[44:51], v157
ds_read_b128 v[68:71], v0 offset:16384
v_add_u32_sdwa v83, s4, v121 dst_sel:DWORD dst_unused:UNUSED_PAD src0_sel:DWORD src1_sel:WORD_1
v_smfmac_f32_16x16x64_bf16 v[32:35], a[204:207], v[52:59], v161
ds_read_u16 v90, v90
v_smfmac_f32_16x16x64_bf16 v[32:35], a[240:243], v[92:99], v165
s_waitcnt lgkmcnt(7)
ds_read_b128 v[72:75], v1 offset:16384
v_add_u32 v0, s43, v0
v_smfmac_f32_16x16x64_bf16 v[32:35], v[114:117], v[100:107], v183 abid:1
ds_read_u16 v91, v91
v_add_u32 v1, s43, v1
v_smfmac_f32_16x16x64_bf16 v[28:31], v[114:117], v[100:107], v183
v_smfmac_f32_16x16x64_bf16 v[36:39], v[114:117], v[100:107], v184
ds_read_b128 v[114:117], v2 offset:320
v_smfmac_f32_16x16x64_bf16 v[36:39], a[172:175], v[44:51], v157 abid:1
v_smfmac_f32_16x16x64_bf16 v[36:39], a[208:211], v[52:59], v161 abid:1
v_smfmac_f32_16x16x64_bf16 v[36:39], a[244:247], v[92:99], v165 abid:1
v_smfmac_f32_16x16x64_bf16 v[16:19], a[152:155], v[44:51], v155
v_smfmac_f32_16x16x64_bf16 v[16:19], a[188:191], v[52:59], v159
v_smfmac_f32_16x16x64_bf16 v[16:19], a[224:227], v[92:99], v163
v_smfmac_f32_16x16x64_bf16 v[20:23], a[156:159], v[44:51], v155 abid:1
v_smfmac_f32_16x16x64_bf16 v[20:23], a[192:195], v[52:59], v159 abid:1
v_smfmac_f32_16x16x64_bf16 v[20:23], a[228:231], v[92:99], v163 abid:1
v_smfmac_f32_16x16x64_bf16 v[40:43], a[176:179], v[44:51], v176
s_bitcmp1_b32 s92, s41
v_smfmac_f32_16x16x64_bf16 v[40:43], a[212:215], v[52:59], v176 abid:1
s_cbranch_scc1 L_loopnk_w
L_loopnk_wb:
v_smfmac_f32_16x16x64_bf16 v[40:43], a[248:251], v[92:99], v177
s_waitcnt lgkmcnt(0)
v_smfmac_f32_16x16x64_bf16 v[40:43], v[114:117], v[84:91], v185
v_smfmac_f32_16x16x64_bf16 v[36:39], v[114:117], v[84:91], v184 abid:1
s_waitcnt vmcnt(20)
s_barrier
L_loopnk_p3:
v_smfmac_f32_16x16x64_bf16 v[8:11], a[252:255], v[60:67], v166
s_mov_b32 s42, s4
v_smfmac_f32_16x16x64_bf16 v[8:11], v[218:221], v[68:75], v170
ds_read_b128 v[44:47], v0 offset:0
v_add_u32_sdwa v84, s42, v122 dst_sel:DWORD dst_unused:UNUSED_PAD src0_sel:DWORD src1_sel:WORD_0
v_smfmac_f32_16x16x64_bf16 v[12:15], v[186:189], v[60:67], v166 abid:1
ds_read_b128 v[48:51], v1 offset:0
v_add_u32_sdwa v85, s42, v122 dst_sel:DWORD dst_unused:UNUSED_PAD src0_sel:DWORD src1_sel:WORD_1
v_smfmac_f32_16x16x64_bf16 v[12:15], v[222:225], v[68:75], v170 abid:1
ds_read_b128 v[52:55], v0 offset:2048
v_add_u32_sdwa v86, s42, v123 dst_sel:DWORD dst_unused:UNUSED_PAD src0_sel:DWORD src1_sel:WORD_0
v_smfmac_f32_16x16x64_bf16 v[16:19], v[190:193], v[60:67], v167
ds_read_b128 v[56:59], v1 offset:2048
v_cvt_pk_bf16_f32 v92, v8, v9
v_smfmac_f32_16x16x64_bf16 v[16:19], v[226:229], v[68:75], v171
ds_read_u16 v76, v76
v_cvt_pk_bf16_f32 v93, v10, v11
v_smfmac_f32_16x16x64_bf16 v[20:23], v[194:197], v[60:67], v167 abid:1
ds_read_b128 v[8:11], v2 offset:1024
v_cvt_pk_bf16_f32 v94, v12, v13
v_smfmac_f32_16x16x64_bf16 v[20:23], v[230:233], v[68:75], v171 abid:1
ds_read_u16 v77, v77
v_cvt_pk_bf16_f32 v95, v14, v15
v_smfmac_f32_16x16x64_bf16 v[24:27], v[198:201], v[60:67], v168
ds_read_b128 v[12:15], v2 offset:1088
v_cvt_pk_bf16_f32 v96, v16, v17
v_smfmac_f32_16x16x64_bf16 v[24:27], v[234:237], v[68:75], v172
ds_read_u16 v78, v78
v_cvt_pk_bf16_f32 v97, v18, v19
v_smfmac_f32_16x16x64_bf16 v[28:31], v[202:205], v[60:67], v168 abid:1
ds_read_b128 v[16:19], v2 offset:1152
v_cvt_pk_bf16_f32 v98, v20, v21
v_smfmac_f32_16x16x64_bf16 v[28:31], v[238:241], v[68:75], v172 abid:1
ds_read_u16 v79, v79
v_cvt_pk_bf16_f32 v99, v22, v23
v_smfmac_f32_16x16x64_bf16 v[32:35], v[206:209], v[60:67], v169
ds_read_b128 v[20:23], v2 offset:1216
v_cvt_pk_bf16_f32 v100, v24, v25
v_smfmac_f32_16x16x64_bf16 v[32:35], v[242:245], v[68:75], v173
ds_read_u16 v80, v80
v_cvt_pk_bf16_f32 v101, v26, v27
v_smfmac_f32_16x16x64_bf16 v[36:39], v[210:213], v[60:67], v169 abid:1
ds_read_b128 v[24:27], v2 offset:1280
v_cvt_pk_bf16_f32 v102, v28, v29
v_smfmac_f32_16x16x64_bf16 v[36:39], v[246:249], v[68:75], v173 abid:1
ds_read_u16 v81, v81
v_cvt_pk_bf16_f32 v103, v30, v31
v_smfmac_f32_16x16x64_bf16 v[40:43], v[214:217], v[60:67], v177 abid:1
s_bitcmp1_b32 s12, s41
ds_read_b128 v[28:31], v2 offset:1344
v_cvt_pk_bf16_f32 v104, v32, v33
v_smfmac_f32_16x16x64_bf16 v[40:43], v[250:253], v[68:75], v178
s_waitcnt lgkmcnt(10)
v_cvt_pk_bf16_f32 v105, v34, v35
s_cbranch_scc1 L_loopnk
s_cmp_eq_u32 s41, s59
s_cbranch_scc1 L_loopck
s_cmp_lt_u32 s41, s15
s_cbranch_scc1 L_loopk
s_nop 0
v_cndmask_b32_dpp v108, v96, v92, vcc quad_perm:[1,0,3,2] row_mask:0xf bank_mask:0xf
v_cndmask_b32_dpp v109, v97, v93, vcc quad_perm:[1,0,3,2] row_mask:0xf bank_mask:0xf
v_cndmask_b32_dpp v110, v98, v94, vcc quad_perm:[1,0,3,2] row_mask:0xf bank_mask:0xf
v_cndmask_b32_dpp v111, v99, v95, vcc quad_perm:[1,0,3,2] row_mask:0xf bank_mask:0xf
buffer_store_dwordx4 v[108:111], v4, s[20:23], s46 offen offset:0 sc1
s_mov_b64 vcc, s[82:83]
v_cvt_pk_bf16_f32 v112, v40, v41
v_cvt_pk_bf16_f32 v113, v42, v43
ds_bpermute_b32 v112, v6, v112
ds_bpermute_b32 v113, v6, v113
v_cndmask_b32_dpp v96, v92, v96, vcc quad_perm:[1,0,3,2] row_mask:0xf bank_mask:0xf
v_cndmask_b32_dpp v97, v93, v97, vcc quad_perm:[1,0,3,2] row_mask:0xf bank_mask:0xf
v_cndmask_b32_dpp v98, v94, v98, vcc quad_perm:[1,0,3,2] row_mask:0xf bank_mask:0xf
v_cndmask_b32_dpp v99, v95, v99, vcc quad_perm:[1,0,3,2] row_mask:0xf bank_mask:0xf
buffer_store_dwordx4 v[96:99], v4, s[20:23], s46 offen offset:1152 sc1
s_mov_b64 vcc, s[80:81]
v_cvt_pk_bf16_f32 v106, v36, v37
v_cvt_pk_bf16_f32 v107, v38, v39
v_cndmask_b32_dpp v92, v104, v100, vcc quad_perm:[1,0,3,2] row_mask:0xf bank_mask:0xf
v_cndmask_b32_dpp v93, v105, v101, vcc quad_perm:[1,0,3,2] row_mask:0xf bank_mask:0xf
v_cndmask_b32_dpp v94, v106, v102, vcc quad_perm:[1,0,3,2] row_mask:0xf bank_mask:0xf
v_cndmask_b32_dpp v95, v107, v103, vcc quad_perm:[1,0,3,2] row_mask:0xf bank_mask:0xf
buffer_store_dwordx4 v[92:95], v4, s[20:23], s46 offen offset:128 sc1
s_mov_b64 vcc, s[82:83]
v_cndmask_b32_dpp v104, v100, v104, vcc quad_perm:[1,0,3,2] row_mask:0xf bank_mask:0xf
v_cndmask_b32_dpp v105, v101, v105, vcc quad_perm:[1,0,3,2] row_mask:0xf bank_mask:0xf
v_cndmask_b32_dpp v106, v102, v106, vcc quad_perm:[1,0,3,2] row_mask:0xf bank_mask:0xf
v_cndmask_b32_dpp v107, v103, v107, vcc quad_perm:[1,0,3,2] row_mask:0xf bank_mask:0xf
buffer_store_dwordx4 v[104:107], v4, s[20:23], s46 offen offset:1280 sc1
s_mov_b64 vcc, s[80:81]
s_waitcnt lgkmcnt(0)
buffer_store_dwordx2 v[112:113], v5, s[20:23], s46 offen
s_branch L_fin
L_loopk_w:
s_bitcmp1_b32 s87, s41
s_waitcnt vmcnt(15)
s_cbranch_scc0 L_loopk_wb
s_waitcnt vmcnt(10)
s_branch L_loopk_wb
L_loopnk_w:
s_bitcmp1_b32 s87, s41
s_waitcnt vmcnt(15)
s_cbranch_scc0 L_loopnk_wb
s_waitcnt vmcnt(10)
s_branch L_loopnk_wb
L_slow:
s_waitcnt vmcnt(0) lgkmcnt(0)
s_mov_b32 s87, 0
L_sm:
s_lshl_b32 s86, s2, 1
s_add_u32 s86, s86, s87
s_add_u32 s86, s86, 2
s_mul_i32 s86, s86, 393216
s_mov_b32 s84, 0
L_st:
s_and_b32 s48, s84, 3
s_lshr_b32 s49, s84, 2
s_sub_u32 s50, s84, 36
s_lshl_b32 s51, s40, 4
s_lshl_b32 s52, s50, 1
s_lshl_b32 s53, s48, 8
s_cmp_lt_u32 s84, 36
s_cselect_b32 s52, s49, s52
s_cselect_b32 s53, s53, 1024
s_cselect_b32 s54, 8, 73728
s_cselect_b32 s55, 32, 8
s_cselect_b32 s56, 16, 32
s_cselect_b32 s57, 128, 64
s_mul_i32 s52, s52, 73728
s_mul_i32 s58, s40, 18432
v_and_b32 v58, 1, v7
v_bfe_u32 v59, v7, 1, 1
v_bfe_u32 v60, v7, 2, 2
v_bfe_u32 v62, v7, 4, 1
v_lshrrev_b32 v63, 5, v7
v_lshl_add_u32 v50, v58, 2, s52
v_mad_u32_u24 v50, v59, s54, v50
v_mad_u32_u24 v50, v60, s55, v50
v_mad_u32_u24 v50, v62, s56, v50
v_mad_u32_u24 v50, v63, s57, v50
v_add_u32 v50, s53, v50
v_add_u32 v50, s58, v50
v_add_u32 v62, 4608, v50
v_add_u32 v63, 9216, v50
v_add_u32 v64, 13824, v50
buffer_load_dword v8, v50, s[28:31], 0 offen offset:0
buffer_load_dword v9, v50, s[28:31], 0 offen offset:1152
buffer_load_dword v10, v50, s[28:31], 0 offen offset:2304
buffer_load_dword v11, v50, s[28:31], 0 offen offset:3456
buffer_load_dword v12, v62, s[28:31], 0 offen offset:0
buffer_load_dword v13, v62, s[28:31], 0 offen offset:1152
buffer_load_dword v14, v62, s[28:31], 0 offen offset:2304
buffer_load_dword v15, v62, s[28:31], 0 offen offset:3456
buffer_load_dword v16, v63, s[28:31], 0 offen offset:0
buffer_load_dword v17, v63, s[28:31], 0 offen offset:1152
buffer_load_dword v18, v63, s[28:31], 0 offen offset:2304
buffer_load_dword v19, v63, s[28:31], 0 offen offset:3456
buffer_load_dword v20, v64, s[28:31], 0 offen offset:0
buffer_load_dword v21, v64, s[28:31], 0 offen offset:1152
buffer_load_dword v22, v64, s[28:31], 0 offen offset:2304
buffer_load_dword v23, v64, s[28:31], 0 offen offset:3456
s_mul_i32 s52, s48, 9
s_add_u32 s52, s52, s49
s_mul_i32 s53, s52, 9
s_mul_i32 s54, s50, 18
s_add_u32 s54, s54, 8
s_lshl_b32 s55, s52, 2
s_add_u32 s55, s55, s40
s_lshl_b32 s56, s50, 2
s_add_u32 s56, s56, s40
s_cmp_eq_u32 s84, 40
s_cselect_b32 s57, 0x100000, 9
s_cmp_lt_u32 s84, 36
s_cselect_b32 s53, s53, s54
s_cselect_b32 s54, 2, 81
s_cselect_b32 s57, 1, s57
s_cselect_b32 s55, s55, s56
s_mov_b32 s56, 331776
s_cselect_b32 s56, s56, 368640
s_mov_b32 s58, 373760
s_cselect_b32 s58, s58, 382976
s_cselect_b32 s59, 16, 4
s_cselect_b32 s60, 4, 64
s_cselect_b32 s61, 12, 11
s_cselect_b32 s62, 1, 0x8001
v_lshrrev_b32 v61, 4, v7
v_lshlrev_b32 v62, 1, v58
v_lshl_add_u32 v60, v60, 2, v62
v_add_u32 v62, v60, v59
v_mul_u32_u24 v51, s54, v61
v_add_lshl_u32 v51, v51, s53, 6
v_add3_u32 v51, v51, v62, s51
v_lshl_add_u32 v51, v51, 4, s86
s_lshl_b32 s57, s57, 10
v_add_u32 v66, s57, v51
s_lshl_b32 s52, s55, 8
s_add_u32 s52, s52, s56
s_add_u32 s52, s52, s86
v_mul_u32_u24 v52, s59, v62
v_mad_u32_u24 v52, v61, s60, v52
v_lshl_add_u32 v54, v7, 2, s52
v_mov_b32 v55, 0x05040100
v_mov_b32 v62, 0x03020706
v_cmp_eq_u32 vcc, 1, v59
v_mov_b32 v68, 0xf0a0500
v_mov_b32 v69, 0x8f8a8580
v_mov_b32 v70, 0x1f1a1510
v_mov_b32 v71, 0x9f9a9590
v_mov_b32 v72, 0x2f2a2520
v_mov_b32 v73, 0xafaaa5a0
v_mov_b32 v74, 0x3f3a3530
v_mov_b32 v75, 0xbfbab5b0
v_cndmask_b32 v55, v55, v62, vcc
s_mov_b32 s64, 0x5040500
s_mov_b32 s65, 0x5040501
s_mov_b32 s66, 0x5040502
s_mov_b32 s67, 0x5040503
s_mov_b32 s68, 0x7060700
s_mov_b32 s69, 0x7060701
s_mov_b32 s70, 0x7060702
s_mov_b32 s71, 0x7060703
s_mov_b32 s72, 0x05060102
s_cmp_lg_u32 s87, 0
s_waitcnt vmcnt(12)
v_perm_b32 v24, v8, v68, s64
v_perm_b32 v25, v9, v68, s65
v_perm_b32 v26, v10, v68, s66
v_perm_b32 v27, v11, v68, s67
v_max3_f32 v28, |v24|, |v25|, |v26|
v_med3_f32 v29, |v24|, |v25|, |v26|
v_min3_f32 v30, |v24|, |v25|, |v26|
v_med3_f32 v32, v28, v29, |v27|
v_med3_f32 v33, v29, v30, |v27|
v_max_f32 v31, v28, |v27|
v_cmp_eq_u32_sdwa vcc, v33, v32 src0_sel:WORD_1 src1_sel:WORD_1
s_cbranch_scc0 L_rb0g
v_min_f32 v30, v30, |v27|
v_cndmask_b32 v31, 0, v33, vcc
v_cmp_eq_u32_sdwa vcc, v30, v32 src0_sel:WORD_1 src1_sel:WORD_1
s_nop 1
v_cndmask_b32 v32, 0, v30, vcc
L_rb0g:
v_perm_b32 v36, v31, v32, s72
v_bfi_b32 v44, 3, v32, v31
v_perm_b32 v24, v8, v69, s68
v_perm_b32 v25, v9, v69, s69
v_perm_b32 v26, v10, v69, s70
v_perm_b32 v27, v11, v69, s71
v_max3_f32 v28, |v24|, |v25|, |v26|
v_med3_f32 v29, |v24|, |v25|, |v26|
v_min3_f32 v30, |v24|, |v25|, |v26|
v_med3_f32 v32, v28, v29, |v27|
v_med3_f32 v33, v29, v30, |v27|
v_max_f32 v31, v28, |v27|
v_cmp_eq_u32_sdwa vcc, v33, v32 src0_sel:WORD_1 src1_sel:WORD_1
s_cbranch_scc0 L_rb1g
v_min_f32 v30, v30, |v27|
v_cndmask_b32 v31, 0, v33, vcc
v_cmp_eq_u32_sdwa vcc, v30, v32 src0_sel:WORD_1 src1_sel:WORD_1
s_nop 1
v_cndmask_b32 v32, 0, v30, vcc
L_rb1g:
v_perm_b32 v40, v31, v32, s72
v_bfi_b32 v46, 3, v32, v31
s_waitcnt vmcnt(8)
v_perm_b32 v24, v12, v70, s64
v_perm_b32 v25, v13, v70, s65
v_perm_b32 v26, v14, v70, s66
v_perm_b32 v27, v15, v70, s67
v_max3_f32 v28, |v24|, |v25|, |v26|
v_med3_f32 v29, |v24|, |v25|, |v26|
v_min3_f32 v30, |v24|, |v25|, |v26|
v_med3_f32 v32, v28, v29, |v27|
v_med3_f32 v33, v29, v30, |v27|
v_max_f32 v31, v28, |v27|
v_cmp_eq_u32_sdwa vcc, v33, v32 src0_sel:WORD_1 src1_sel:WORD_1
s_cbranch_scc0 L_rb2g
v_min_f32 v30, v30, |v27|
v_cndmask_b32 v31, 0, v33, vcc
v_cmp_eq_u32_sdwa vcc, v30, v32 src0_sel:WORD_1 src1_sel:WORD_1
s_nop 1
v_cndmask_b32 v32, 0, v30, vcc
L_rb2g:
v_perm_b32 v37, v31, v32, s72
v_bfi_b32 v31, 3, v32, v31
v_lshlrev_b32 v31, 4, v31
v_bfi_b32 v44, 15, v44, v31
v_perm_b32 v24, v12, v71, s68
v_perm_b32 v25, v13, v71, s69
v_perm_b32 v26, v14, v71, s70
v_perm_b32 v27, v15, v71, s71
v_max3_f32 v28, |v24|, |v25|, |v26|
v_med3_f32 v29, |v24|, |v25|, |v26|
v_min3_f32 v30, |v24|, |v25|, |v26|
v_med3_f32 v32, v28, v29, |v27|
v_med3_f32 v33, v29, v30, |v27|
v_max_f32 v31, v28, |v27|
v_cmp_eq_u32_sdwa vcc, v33, v32 src0_sel:WORD_1 src1_sel:WORD_1
s_cbranch_scc0 L_rb3g
v_min_f32 v30, v30, |v27|
v_cndmask_b32 v31, 0, v33, vcc
v_cmp_eq_u32_sdwa vcc, v30, v32 src0_sel:WORD_1 src1_sel:WORD_1
s_nop 1
v_cndmask_b32 v32, 0, v30, vcc
L_rb3g:
v_perm_b32 v41, v31, v32, s72
v_bfi_b32 v31, 3, v32, v31
v_lshlrev_b32 v31, 4, v31
v_bfi_b32 v46, 15, v46, v31
s_waitcnt vmcnt(4)
v_perm_b32 v24, v16, v72, s64
v_perm_b32 v25, v17, v72, s65
v_perm_b32 v26, v18, v72, s66
v_perm_b32 v27, v19, v72, s67
v_max3_f32 v28, |v24|, |v25|, |v26|
v_med3_f32 v29, |v24|, |v25|, |v26|
v_min3_f32 v30, |v24|, |v25|, |v26|
v_med3_f32 v32, v28, v29, |v27|
v_med3_f32 v33, v29, v30, |v27|
v_max_f32 v31, v28, |v27|
v_cmp_eq_u32_sdwa vcc, v33, v32 src0_sel:WORD_1 src1_sel:WORD_1
s_cbranch_scc0 L_rb4g
v_min_f32 v30, v30, |v27|
v_cndmask_b32 v31, 0, v33, vcc
v_cmp_eq_u32_sdwa vcc, v30, v32 src0_sel:WORD_1 src1_sel:WORD_1
s_nop 1
v_cndmask_b32 v32, 0, v30, vcc
L_rb4g:
v_perm_b32 v38, v31, v32, s72
v_bfi_b32 v45, 3, v32, v31
v_perm_b32 v24, v16, v73, s68
v_perm_b32 v25, v17, v73, s69
v_perm_b32 v26, v18, v73, s70
v_perm_b32 v27, v19, v73, s71
v_max3_f32 v28, |v24|, |v25|, |v26|
v_med3_f32 v29, |v24|, |v25|, |v26|
v_min3_f32 v30, |v24|, |v25|, |v26|
v_med3_f32 v32, v28, v29, |v27|
v_med3_f32 v33, v29, v30, |v27|
v_max_f32 v31, v28, |v27|
v_cmp_eq_u32_sdwa vcc, v33, v32 src0_sel:WORD_1 src1_sel:WORD_1
s_cbranch_scc0 L_rb5g
v_min_f32 v30, v30, |v27|
v_cndmask_b32 v31, 0, v33, vcc
v_cmp_eq_u32_sdwa vcc, v30, v32 src0_sel:WORD_1 src1_sel:WORD_1
s_nop 1
v_cndmask_b32 v32, 0, v30, vcc
L_rb5g:
v_perm_b32 v42, v31, v32, s72
v_bfi_b32 v47, 3, v32, v31
s_waitcnt vmcnt(0)
v_perm_b32 v24, v20, v74, s64
v_perm_b32 v25, v21, v74, s65
v_perm_b32 v26, v22, v74, s66
v_perm_b32 v27, v23, v74, s67
v_max3_f32 v28, |v24|, |v25|, |v26|
v_med3_f32 v29, |v24|, |v25|, |v26|
v_min3_f32 v30, |v24|, |v25|, |v26|
v_med3_f32 v32, v28, v29, |v27|
v_med3_f32 v33, v29, v30, |v27|
v_max_f32 v31, v28, |v27|
v_cmp_eq_u32_sdwa vcc, v33, v32 src0_sel:WORD_1 src1_sel:WORD_1
s_cbranch_scc0 L_rb6g
v_min_f32 v30, v30, |v27|
v_cndmask_b32 v31, 0, v33, vcc
v_cmp_eq_u32_sdwa vcc, v30, v32 src0_sel:WORD_1 src1_sel:WORD_1
s_nop 1
v_cndmask_b32 v32, 0, v30, vcc
L_rb6g:
v_perm_b32 v39, v31, v32, s72
v_bfi_b32 v31, 3, v32, v31
v_lshlrev_b32 v31, 4, v31
v_bfi_b32 v45, 15, v45, v31
v_perm_b32 v24, v20, v75, s68
v_perm_b32 v25, v21, v75, s69
v_perm_b32 v26, v22, v75, s70
v_perm_b32 v27, v23, v75, s71
v_max3_f32 v28, |v24|, |v25|, |v26|
v_med3_f32 v29, |v24|, |v25|, |v26|
v_min3_f32 v30, |v24|, |v25|, |v26|
v_med3_f32 v32, v28, v29, |v27|
v_med3_f32 v33, v29, v30, |v27|
v_max_f32 v31, v28, |v27|
v_cmp_eq_u32_sdwa vcc, v33, v32 src0_sel:WORD_1 src1_sel:WORD_1
s_cbranch_scc0 L_rb7g
v_min_f32 v30, v30, |v27|
v_cndmask_b32 v31, 0, v33, vcc
v_cmp_eq_u32_sdwa vcc, v30, v32 src0_sel:WORD_1 src1_sel:WORD_1
s_nop 1
v_cndmask_b32 v32, 0, v30, vcc
L_rb7g:
v_perm_b32 v43, v31, v32, s72
v_bfi_b32 v31, 3, v32, v31
v_lshlrev_b32 v31, 4, v31
v_bfi_b32 v47, 15, v47, v31
s_mov_b32 vcc_lo, 0x33333333
s_mov_b32 vcc_hi, 0x33333333
v_cndmask_b32_dpp v24, v40, v36, vcc quad_perm:[2,3,0,1] row_mask:0xf bank_mask:0xf
v_cndmask_b32_dpp v25, v41, v37, vcc quad_perm:[2,3,0,1] row_mask:0xf bank_mask:0xf
v_cndmask_b32_dpp v26, v42, v38, vcc quad_perm:[2,3,0,1] row_mask:0xf bank_mask:0xf
v_cndmask_b32_dpp v27, v43, v39, vcc quad_perm:[2,3,0,1] row_mask:0xf bank_mask:0xf
s_not_b64 vcc, vcc
buffer_store_dwordx4 v[24:27], v51, s[24:27], 0 offen sc1
v_cndmask_b32_dpp v40, v36, v40, vcc quad_perm:[2,3,0,1] row_mask:0xf bank_mask:0xf
v_cndmask_b32_dpp v41, v37, v41, vcc quad_perm:[2,3,0,1] row_mask:0xf bank_mask:0xf
v_cndmask_b32_dpp v42, v38, v42, vcc quad_perm:[2,3,0,1] row_mask:0xf bank_mask:0xf
v_cndmask_b32_dpp v43, v39, v43, vcc quad_perm:[2,3,0,1] row_mask:0xf bank_mask:0xf
s_mov_b32 s52, 0x0c0c0400
s_mov_b32 s53, 0x04000c0c
buffer_store_dwordx4 v[40:43], v66, s[24:27], 0 offen sc1
v_perm_b32 v48, v45, v44, s52
v_perm_b32 v49, v47, v46, s53
v_or_b32 v48, v48, v49
s_nop 1
v_mov_b32_dpp v49, v48 quad_perm:[2,3,0,1] row_mask:0xf bank_mask:0xf
v_perm_b32 v48, v49, v48, v55
ds_permute_b32 v48, v52, v48
s_waitcnt lgkmcnt(0)
buffer_store_dword v48, v54, s[24:27], 0 offen sc1
s_waitcnt vmcnt(0)
s_add_u32 s84, s84, 1
s_cmp_lt_u32 s84, 41
s_cbranch_scc1 L_st
s_add_u32 s87, s87, 1
s_cmp_lt_u32 s87, 2
s_cbranch_scc1 L_sm
v_lshrrev_b32 v72, 3, v7
v_and_b32 v73, 7, v7
v_xor_b32 v73, v73, v72
v_mul_u32_u24 v72, 1152, v72
s_and_b32 s47, s40, 1
s_mul_i32 s47, s47, 9216
s_lshr_b32 s3, s40, 1
s_lshl_b32 s3, s3, 7
s_add_u32 s47, s47, s3
v_lshl_add_u32 v72, v73, 4, v72
v_add_u32 v3, s47, v72
s_lshl_b32 s44, s40, 10
s_mul_i32 s45, s2, 18432
s_mov_b32 s46, s45
s_lshr_b32 s47, s40, 1
s_lshl_b32 s3, s47, 11
s_sub_u32 s8, 15488, s3
s_lshl_b32 s3, s47, 7
s_add_u32 s7, s45, 128
s_sub_u32 s7, s7, s3
s_sub_u32 s10, s47, 1
s_sub_u32 s11, 0, s47
s_mov_b32 s9, s44
s_mov_b32 s13, 4718592
s_mov_b32 s15, 16
s_mov_b32 s14, s13
s_mov_b32 s22, 75497472
s_mov_b32 s18, 75497472
s_mov_b32 s41, 0
L_stile:
s_barrier
s_add_u32 m0, s44, 0
s_nop 0
buffer_load_dwordx4 v3, s[16:19], s45 offen offset:0 nt lds
s_add_u32 m0, s44, 3840
s_nop 0
buffer_load_dwordx4 v3, s[16:19], s45 offen offset:256 nt lds
s_add_u32 m0, s44, 7680
s_nop 0
buffer_load_dwordx4 v3, s[16:19], s45 offen offset:512 nt lds
s_add_u32 m0, s44, 11520
s_nop 0
buffer_load_dwordx4 v3, s[16:19], s45 offen offset:768 nt lds
s_add_u32 m0, s44, s8
s_mov_b64 exec, s[10:11]
buffer_load_dwordx4 v3, s[16:19], s7 offen offset:896 nt lds
s_mov_b64 exec, -1
ds_read_b128 v[8:11], v2 offset:1024
ds_read_b128 v[12:15], v2 offset:1088
ds_read_b128 v[16:19], v2 offset:1152
ds_read_b128 v[20:23], v2 offset:1216
ds_read_b128 v[24:27], v2 offset:1280
ds_read_b128 v[28:31], v2 offset:1344
ds_read_b128 v[32:35], v2 offset:1408
ds_read_b128 v[36:39], v2 offset:1472
ds_read_b128 v[40:43], v2 offset:1536
s_mov_b32 s87, 0
L_spass:
s_lshl_b32 s86, s2, 1
s_add_u32 s86, s86, s87
s_add_u32 s86, s86, 2
s_mul_i32 s86, s86, 393216
s_mul_i32 s47, s40, 82944
s_add_u32 s47, s47, s86
v_lshl_add_u32 v104, v7, 4, s47
s_mul_i32 s47, s40, 9216
s_add_u32 s47, s47, s86
s_add_u32 s47, s47, 331776
v_lshl_add_u32 v105, v7, 4, s47
s_lshl_b32 s47, s40, 6
s_add_u32 s47, s47, s86
s_add_u32 s47, s47, 368640
v_and_b32 v106, 15, v7
v_lshl_add_u32 v106, v106, 2, s47
v_lshrrev_b32 v107, 4, v7
v_lshl_add_u32 v106, v107, 8, v106
buffer_load_dword v174, v106, s[24:27], 0 offen offset:0 sc1
buffer_load_dword v175, v106, s[24:27], 0 offen offset:1024 sc1
buffer_load_dword v176, v106, s[24:27], 0 offen offset:2048 sc1
buffer_load_dword v177, v106, s[24:27], 0 offen offset:3072 sc1
s_mov_b32 s99, 4096
buffer_load_dword v178, v106, s[24:27], s99 offen offset:0 sc1
s_mov_b32 s98, 0
buffer_load_dwordx4 v[138:141], v105, s[24:27], s98 offen sc1
s_mov_b32 s99, 0
buffer_load_dwordx4 a[0:3], v104, s[24:27], s99 offen offset:0 sc1
buffer_load_dwordx4 a[4:7], v104, s[24:27], s99 offen offset:1024 sc1
buffer_load_dwordx4 a[8:11], v104, s[24:27], s99 offen offset:2048 sc1
buffer_load_dwordx4 a[12:15], v104, s[24:27], s99 offen offset:3072 sc1
s_mov_b32 s99, 4096
buffer_load_dwordx4 a[16:19], v104, s[24:27], s99 offen offset:0 sc1
buffer_load_dwordx4 a[20:23], v104, s[24:27], s99 offen offset:1024 sc1
buffer_load_dwordx4 a[24:27], v104, s[24:27], s99 offen offset:2048 sc1
buffer_load_dwordx4 a[28:31], v104, s[24:27], s99 offen offset:3072 sc1
s_mov_b32 s99, 8192
buffer_load_dwordx4 a[32:35], v104, s[24:27], s99 offen offset:0 sc1
s_mov_b32 s98, 1024
buffer_load_dwordx4 v[142:145], v105, s[24:27], s98 offen sc1
buffer_load_dwordx4 a[36:39], v104, s[24:27], s99 offen offset:1024 sc1
buffer_load_dwordx4 a[40:43], v104, s[24:27], s99 offen offset:2048 sc1
buffer_load_dwordx4 a[44:47], v104, s[24:27], s99 offen offset:3072 sc1
s_mov_b32 s99, 12288
buffer_load_dwordx4 a[48:51], v104, s[24:27], s99 offen offset:0 sc1
buffer_load_dwordx4 a[52:55], v104, s[24:27], s99 offen offset:1024 sc1
buffer_load_dwordx4 a[56:59], v104, s[24:27], s99 offen offset:2048 sc1
buffer_load_dwordx4 a[60:63], v104, s[24:27], s99 offen offset:3072 sc1
s_mov_b32 s99, 16384
buffer_load_dwordx4 a[64:67], v104, s[24:27], s99 offen offset:0 sc1
buffer_load_dwordx4 a[68:71], v104, s[24:27], s99 offen offset:1024 sc1
s_mov_b32 s98, 2048
buffer_load_dwordx4 v[146:149], v105, s[24:27], s98 offen sc1
buffer_load_dwordx4 a[72:75], v104, s[24:27], s99 offen offset:2048 sc1
buffer_load_dwordx4 a[76:79], v104, s[24:27], s99 offen offset:3072 sc1
s_mov_b32 s99, 20480
buffer_load_dwordx4 a[80:83], v104, s[24:27], s99 offen offset:0 sc1
buffer_load_dwordx4 a[84:87], v104, s[24:27], s99 offen offset:1024 sc1
buffer_load_dwordx4 a[88:91], v104, s[24:27], s99 offen offset:2048 sc1
buffer_load_dwordx4 a[92:95], v104, s[24:27], s99 offen offset:3072 sc1
s_mov_b32 s99, 24576
buffer_load_dwordx4 a[96:99], v104, s[24:27], s99 offen offset:0 sc1
buffer_load_dwordx4 a[100:103], v104, s[24:27], s99 offen offset:1024 sc1
buffer_load_dwordx4 a[104:107], v104, s[24:27], s99 offen offset:2048 sc1
s_mov_b32 s98, 3072
buffer_load_dwordx4 v[150:153], v105, s[24:27], s98 offen sc1
buffer_load_dwordx4 a[108:111], v104, s[24:27], s99 offen offset:3072 sc1
s_mov_b32 s99, 28672
buffer_load_dwordx4 a[112:115], v104, s[24:27], s99 offen offset:0 sc1
buffer_load_dwordx4 a[116:119], v104, s[24:27], s99 offen offset:1024 sc1
buffer_load_dwordx4 a[120:123], v104, s[24:27], s99 offen offset:2048 sc1
buffer_load_dwordx4 a[124:127], v104, s[24:27], s99 offen offset:3072 sc1
s_mov_b32 s99, 32768
buffer_load_dwordx4 a[128:131], v104, s[24:27], s99 offen offset:0 sc1
buffer_load_dwordx4 a[132:135], v104, s[24:27], s99 offen offset:1024 sc1
buffer_load_dwordx4 a[136:139], v104, s[24:27], s99 offen offset:2048 sc1
buffer_load_dwordx4 a[140:143], v104, s[24:27], s99 offen offset:3072 sc1
s_mov_b32 s98, 4096
buffer_load_dwordx4 v[154:157], v105, s[24:27], s98 offen sc1
s_mov_b32 s99, 36864
buffer_load_dwordx4 a[144:147], v104, s[24:27], s99 offen offset:0 sc1
buffer_load_dwordx4 a[148:151], v104, s[24:27], s99 offen offset:1024 sc1
buffer_load_dwordx4 a[152:155], v104, s[24:27], s99 offen offset:2048 sc1
buffer_load_dwordx4 a[156:159], v104, s[24:27], s99 offen offset:3072 sc1
s_mov_b32 s99, 40960
buffer_load_dwordx4 a[160:163], v104, s[24:27], s99 offen offset:0 sc1
buffer_load_dwordx4 a[164:167], v104, s[24:27], s99 offen offset:1024 sc1
buffer_load_dwordx4 a[168:171], v104, s[24:27], s99 offen offset:2048 sc1
buffer_load_dwordx4 a[172:175], v104, s[24:27], s99 offen offset:3072 sc1
s_mov_b32 s99, 45056
buffer_load_dwordx4 a[176:179], v104, s[24:27], s99 offen offset:0 sc1
s_mov_b32 s98, 5120
buffer_load_dwordx4 v[158:161], v105, s[24:27], s98 offen sc1
buffer_load_dwordx4 a[180:183], v104, s[24:27], s99 offen offset:1024 sc1
buffer_load_dwordx4 a[184:187], v104, s[24:27], s99 offen offset:2048 sc1
buffer_load_dwordx4 a[188:191], v104, s[24:27], s99 offen offset:3072 sc1
s_mov_b32 s99, 49152
buffer_load_dwordx4 a[192:195], v104, s[24:27], s99 offen offset:0 sc1
buffer_load_dwordx4 a[196:199], v104, s[24:27], s99 offen offset:1024 sc1
buffer_load_dwordx4 a[200:203], v104, s[24:27], s99 offen offset:2048 sc1
buffer_load_dwordx4 a[204:207], v104, s[24:27], s99 offen offset:3072 sc1
s_mov_b32 s99, 53248
buffer_load_dwordx4 a[208:211], v104, s[24:27], s99 offen offset:0 sc1
buffer_load_dwordx4 a[212:215], v104, s[24:27], s99 offen offset:1024 sc1
s_mov_b32 s98, 6144
buffer_load_dwordx4 v[162:165], v105, s[24:27], s98 offen sc1
buffer_load_dwordx4 a[216:219], v104, s[24:27], s99 offen offset:2048 sc1
buffer_load_dwordx4 a[220:223], v104, s[24:27], s99 offen offset:3072 sc1
s_mov_b32 s99, 57344
buffer_load_dwordx4 a[224:227], v104, s[24:27], s99 offen offset:0 sc1
buffer_load_dwordx4 a[228:231], v104, s[24:27], s99 offen offset:1024 sc1
buffer_load_dwordx4 a[232:235], v104, s[24:27], s99 offen offset:2048 sc1
buffer_load_dwordx4 a[236:239], v104, s[24:27], s99 offen offset:3072 sc1
s_mov_b32 s99, 61440
buffer_load_dwordx4 a[240:243], v104, s[24:27], s99 offen offset:0 sc1
buffer_load_dwordx4 a[244:247], v104, s[24:27], s99 offen offset:1024 sc1
buffer_load_dwordx4 a[248:251], v104, s[24:27], s99 offen offset:2048 sc1
s_mov_b32 s98, 7168
buffer_load_dwordx4 v[166:169], v105, s[24:27], s98 offen sc1
buffer_load_dwordx4 a[252:255], v104, s[24:27], s99 offen offset:3072 sc1
s_mov_b32 s99, 65536
buffer_load_dwordx4 v[186:189], v104, s[24:27], s99 offen offset:0 sc1
buffer_load_dwordx4 v[190:193], v104, s[24:27], s99 offen offset:1024 sc1
buffer_load_dwordx4 v[194:197], v104, s[24:27], s99 offen offset:2048 sc1
buffer_load_dwordx4 v[198:201], v104, s[24:27], s99 offen offset:3072 sc1
s_mov_b32 s99, 69632
buffer_load_dwordx4 v[202:205], v104, s[24:27], s99 offen offset:0 sc1
buffer_load_dwordx4 v[206:209], v104, s[24:27], s99 offen offset:1024 sc1
buffer_load_dwordx4 v[210:213], v104, s[24:27], s99 offen offset:2048 sc1
buffer_load_dwordx4 v[214:217], v104, s[24:27], s99 offen offset:3072 sc1
s_mov_b32 s98, 8192
buffer_load_dwordx4 v[170:173], v105, s[24:27], s98 offen sc1
s_mov_b32 s99, 73728
buffer_load_dwordx4 v[218:221], v104, s[24:27], s99 offen offset:0 sc1
buffer_load_dwordx4 v[222:225], v104, s[24:27], s99 offen offset:1024 sc1
buffer_load_dwordx4 v[226:229], v104, s[24:27], s99 offen offset:2048 sc1
buffer_load_dwordx4 v[230:233], v104, s[24:27], s99 offen offset:3072 sc1
s_mov_b32 s99, 77824
buffer_load_dwordx4 v[234:237], v104, s[24:27], s99 offen offset:0 sc1
buffer_load_dwordx4 v[238:241], v104, s[24:27], s99 offen offset:1024 sc1
buffer_load_dwordx4 v[242:245], v104, s[24:27], s99 offen offset:2048 sc1
buffer_load_dwordx4 v[246:249], v104, s[24:27], s99 offen offset:3072 sc1
s_mov_b32 s99, 81920
buffer_load_dwordx4 v[250:253], v104, s[24:27], s99 offen offset:0 sc1
s_waitcnt vmcnt(0)
s_barrier
ds_read_b128 v[44:47], v0 offset:0
ds_read_b128 v[48:51], v1 offset:0
s_waitcnt lgkmcnt(0)
v_smfmac_f32_16x16x64_bf16 v[8:11], a[0:3], v[44:51], v138
v_smfmac_f32_16x16x64_bf16 v[12:15], a[4:7], v[44:51], v138 abid:1
v_smfmac_f32_16x16x64_bf16 v[16:19], a[8:11], v[44:51], v139
v_smfmac_f32_16x16x64_bf16 v[20:23], a[12:15], v[44:51], v139 abid:1
v_smfmac_f32_16x16x64_bf16 v[24:27], a[16:19], v[44:51], v140
v_smfmac_f32_16x16x64_bf16 v[28:31], a[20:23], v[44:51], v140 abid:1
v_smfmac_f32_16x16x64_bf16 v[32:35], a[24:27], v[44:51], v141
v_smfmac_f32_16x16x64_bf16 v[36:39], a[28:31], v[44:51], v141 abid:1
v_smfmac_f32_16x16x64_bf16 v[40:43], a[32:35], v[44:51], v174
s_nop 7
ds_read_b128 v[44:47], v0 offset:2048
ds_read_b128 v[48:51], v1 offset:2048
s_waitcnt lgkmcnt(0)
v_smfmac_f32_16x16x64_bf16 v[8:11], a[36:39], v[44:51], v142
v_smfmac_f32_16x16x64_bf16 v[12:15], a[40:43], v[44:51], v142 abid:1
v_smfmac_f32_16x16x64_bf16 v[16:19], a[44:47], v[44:51], v143
v_smfmac_f32_16x16x64_bf16 v[20:23], a[48:51], v[44:51], v143 abid:1
v_smfmac_f32_16x16x64_bf16 v[24:27], a[52:55], v[44:51], v144
v_smfmac_f32_16x16x64_bf16 v[28:31], a[56:59], v[44:51], v144 abid:1
v_smfmac_f32_16x16x64_bf16 v[32:35], a[60:63], v[44:51], v145
v_smfmac_f32_16x16x64_bf16 v[36:39], a[64:67], v[44:51], v145 abid:1
v_smfmac_f32_16x16x64_bf16 v[40:43], a[68:71], v[44:51], v174 abid:1
s_nop 7
ds_read_b128 v[44:47], v0 offset:4096
ds_read_b128 v[48:51], v1 offset:4096
s_waitcnt lgkmcnt(0)
v_smfmac_f32_16x16x64_bf16 v[8:11], a[72:75], v[44:51], v146
v_smfmac_f32_16x16x64_bf16 v[12:15], a[76:79], v[44:51], v146 abid:1
v_smfmac_f32_16x16x64_bf16 v[16:19], a[80:83], v[44:51], v147
v_smfmac_f32_16x16x64_bf16 v[20:23], a[84:87], v[44:51], v147 abid:1
v_smfmac_f32_16x16x64_bf16 v[24:27], a[88:91], v[44:51], v148
v_smfmac_f32_16x16x64_bf16 v[28:31], a[92:95], v[44:51], v148 abid:1
v_smfmac_f32_16x16x64_bf16 v[32:35], a[96:99], v[44:51], v149
v_smfmac_f32_16x16x64_bf16 v[36:39], a[100:103], v[44:51], v149 abid:1
v_smfmac_f32_16x16x64_bf16 v[40:43], a[104:107], v[44:51], v175
s_nop 7
ds_read_b128 v[44:47], v0 offset:6144
ds_read_b128 v[48:51], v1 offset:6144
s_waitcnt lgkmcnt(0)
v_smfmac_f32_16x16x64_bf16 v[8:11], a[108:111], v[44:51], v150
v_smfmac_f32_16x16x64_bf16 v[12:15], a[112:115], v[44:51], v150 abid:1
v_smfmac_f32_16x16x64_bf16 v[16:19], a[116:119], v[44:51], v151
v_smfmac_f32_16x16x64_bf16 v[20:23], a[120:123], v[44:51], v151 abid:1
v_smfmac_f32_16x16x64_bf16 v[24:27], a[124:127], v[44:51], v152
v_smfmac_f32_16x16x64_bf16 v[28:31], a[128:131], v[44:51], v152 abid:1
v_smfmac_f32_16x16x64_bf16 v[32:35], a[132:135], v[44:51], v153
v_smfmac_f32_16x16x64_bf16 v[36:39], a[136:139], v[44:51], v153 abid:1
v_smfmac_f32_16x16x64_bf16 v[40:43], a[140:143], v[44:51], v175 abid:1
s_nop 7
ds_read_b128 v[44:47], v0 offset:8192
ds_read_b128 v[48:51], v1 offset:8192
s_waitcnt lgkmcnt(0)
v_smfmac_f32_16x16x64_bf16 v[8:11], a[144:147], v[44:51], v154
v_smfmac_f32_16x16x64_bf16 v[12:15], a[148:151], v[44:51], v154 abid:1
v_smfmac_f32_16x16x64_bf16 v[16:19], a[152:155], v[44:51], v155
v_smfmac_f32_16x16x64_bf16 v[20:23], a[156:159], v[44:51], v155 abid:1
v_smfmac_f32_16x16x64_bf16 v[24:27], a[160:163], v[44:51], v156
v_smfmac_f32_16x16x64_bf16 v[28:31], a[164:167], v[44:51], v156 abid:1
v_smfmac_f32_16x16x64_bf16 v[32:35], a[168:171], v[44:51], v157
v_smfmac_f32_16x16x64_bf16 v[36:39], a[172:175], v[44:51], v157 abid:1
v_smfmac_f32_16x16x64_bf16 v[40:43], a[176:179], v[44:51], v176
s_nop 7
ds_read_b128 v[44:47], v0 offset:10240
ds_read_b128 v[48:51], v1 offset:10240
s_waitcnt lgkmcnt(0)
v_smfmac_f32_16x16x64_bf16 v[8:11], a[180:183], v[44:51], v158
v_smfmac_f32_16x16x64_bf16 v[12:15], a[184:187], v[44:51], v158 abid:1
v_smfmac_f32_16x16x64_bf16 v[16:19], a[188:191], v[44:51], v159
v_smfmac_f32_16x16x64_bf16 v[20:23], a[192:195], v[44:51], v159 abid:1
v_smfmac_f32_16x16x64_bf16 v[24:27], a[196:199], v[44:51], v160
v_smfmac_f32_16x16x64_bf16 v[28:31], a[200:203], v[44:51], v160 abid:1
v_smfmac_f32_16x16x64_bf16 v[32:35], a[204:207], v[44:51], v161
v_smfmac_f32_16x16x64_bf16 v[36:39], a[208:211], v[44:51], v161 abid:1
v_smfmac_f32_16x16x64_bf16 v[40:43], a[212:215], v[44:51], v176 abid:1
s_nop 7
ds_read_b128 v[44:47], v0 offset:12288
ds_read_b128 v[48:51], v1 offset:12288
s_waitcnt lgkmcnt(0)
v_smfmac_f32_16x16x64_bf16 v[8:11], a[216:219], v[44:51], v162
v_smfmac_f32_16x16x64_bf16 v[12:15], a[220:223], v[44:51], v162 abid:1
v_smfmac_f32_16x16x64_bf16 v[16:19], a[224:227], v[44:51], v163
v_smfmac_f32_16x16x64_bf16 v[20:23], a[228:231], v[44:51], v163 abid:1
v_smfmac_f32_16x16x64_bf16 v[24:27], a[232:235], v[44:51], v164
v_smfmac_f32_16x16x64_bf16 v[28:31], a[236:239], v[44:51], v164 abid:1
v_smfmac_f32_16x16x64_bf16 v[32:35], a[240:243], v[44:51], v165
v_smfmac_f32_16x16x64_bf16 v[36:39], a[244:247], v[44:51], v165 abid:1
v_smfmac_f32_16x16x64_bf16 v[40:43], a[248:251], v[44:51], v177
s_nop 7
ds_read_b128 v[44:47], v0 offset:14336
ds_read_b128 v[48:51], v1 offset:14336
s_waitcnt lgkmcnt(0)
v_smfmac_f32_16x16x64_bf16 v[8:11], a[252:255], v[44:51], v166
v_smfmac_f32_16x16x64_bf16 v[12:15], v[186:189], v[44:51], v166 abid:1
v_smfmac_f32_16x16x64_bf16 v[16:19], v[190:193], v[44:51], v167
v_smfmac_f32_16x16x64_bf16 v[20:23], v[194:197], v[44:51], v167 abid:1
v_smfmac_f32_16x16x64_bf16 v[24:27], v[198:201], v[44:51], v168
v_smfmac_f32_16x16x64_bf16 v[28:31], v[202:205], v[44:51], v168 abid:1
v_smfmac_f32_16x16x64_bf16 v[32:35], v[206:209], v[44:51], v169
v_smfmac_f32_16x16x64_bf16 v[36:39], v[210:213], v[44:51], v169 abid:1
v_smfmac_f32_16x16x64_bf16 v[40:43], v[214:217], v[44:51], v177 abid:1
s_nop 7
ds_read_b128 v[44:47], v0 offset:16384
ds_read_b128 v[48:51], v1 offset:16384
s_waitcnt lgkmcnt(0)
v_smfmac_f32_16x16x64_bf16 v[8:11], v[218:221], v[44:51], v170
v_smfmac_f32_16x16x64_bf16 v[12:15], v[222:225], v[44:51], v170 abid:1
v_smfmac_f32_16x16x64_bf16 v[16:19], v[226:229], v[44:51], v171
v_smfmac_f32_16x16x64_bf16 v[20:23], v[230:233], v[44:51], v171 abid:1
v_smfmac_f32_16x16x64_bf16 v[24:27], v[234:237], v[44:51], v172
v_smfmac_f32_16x16x64_bf16 v[28:31], v[238:241], v[44:51], v172 abid:1
v_smfmac_f32_16x16x64_bf16 v[32:35], v[242:245], v[44:51], v173
v_smfmac_f32_16x16x64_bf16 v[36:39], v[246:249], v[44:51], v173 abid:1
v_smfmac_f32_16x16x64_bf16 v[40:43], v[250:253], v[44:51], v178
s_nop 7
s_add_u32 s87, s87, 1
s_cmp_lt_u32 s87, 2
s_cbranch_scc1 L_spass
v_cvt_pk_bf16_f32 v92, v8, v9
v_cvt_pk_bf16_f32 v93, v10, v11
v_cvt_pk_bf16_f32 v94, v12, v13
v_cvt_pk_bf16_f32 v95, v14, v15
v_cvt_pk_bf16_f32 v96, v16, v17
v_cvt_pk_bf16_f32 v97, v18, v19
v_cvt_pk_bf16_f32 v98, v20, v21
v_cvt_pk_bf16_f32 v99, v22, v23
v_cvt_pk_bf16_f32 v100, v24, v25
v_cvt_pk_bf16_f32 v101, v26, v27
v_cvt_pk_bf16_f32 v102, v28, v29
v_cvt_pk_bf16_f32 v103, v30, v31
v_cvt_pk_bf16_f32 v104, v32, v33
v_cvt_pk_bf16_f32 v105, v34, v35
s_mov_b64 vcc, s[80:81]
s_nop 0
v_cndmask_b32_dpp v108, v96, v92, vcc quad_perm:[1,0,3,2] row_mask:0xf bank_mask:0xf
v_cndmask_b32_dpp v109, v97, v93, vcc quad_perm:[1,0,3,2] row_mask:0xf bank_mask:0xf
v_cndmask_b32_dpp v110, v98, v94, vcc quad_perm:[1,0,3,2] row_mask:0xf bank_mask:0xf
v_cndmask_b32_dpp v111, v99, v95, vcc quad_perm:[1,0,3,2] row_mask:0xf bank_mask:0xf
buffer_store_dwordx4 v[108:111], v4, s[20:23], s46 offen offset:0 sc1
s_mov_b64 vcc, s[82:83]
v_cvt_pk_bf16_f32 v112, v40, v41
v_cvt_pk_bf16_f32 v113, v42, v43
ds_bpermute_b32 v112, v6, v112
ds_bpermute_b32 v113, v6, v113
v_cndmask_b32_dpp v96, v92, v96, vcc quad_perm:[1,0,3,2] row_mask:0xf bank_mask:0xf
v_cndmask_b32_dpp v97, v93, v97, vcc quad_perm:[1,0,3,2] row_mask:0xf bank_mask:0xf
v_cndmask_b32_dpp v98, v94, v98, vcc quad_perm:[1,0,3,2] row_mask:0xf bank_mask:0xf
v_cndmask_b32_dpp v99, v95, v99, vcc quad_perm:[1,0,3,2] row_mask:0xf bank_mask:0xf
buffer_store_dwordx4 v[96:99], v4, s[20:23], s46 offen offset:1152 sc1
s_mov_b64 vcc, s[80:81]
v_cvt_pk_bf16_f32 v106, v36, v37
v_cvt_pk_bf16_f32 v107, v38, v39
v_cndmask_b32_dpp v92, v104, v100, vcc quad_perm:[1,0,3,2] row_mask:0xf bank_mask:0xf
v_cndmask_b32_dpp v93, v105, v101, vcc quad_perm:[1,0,3,2] row_mask:0xf bank_mask:0xf
v_cndmask_b32_dpp v94, v106, v102, vcc quad_perm:[1,0,3,2] row_mask:0xf bank_mask:0xf
v_cndmask_b32_dpp v95, v107, v103, vcc quad_perm:[1,0,3,2] row_mask:0xf bank_mask:0xf
buffer_store_dwordx4 v[92:95], v4, s[20:23], s46 offen offset:128 sc1
s_mov_b64 vcc, s[82:83]
v_cndmask_b32_dpp v104, v100, v104, vcc quad_perm:[1,0,3,2] row_mask:0xf bank_mask:0xf
v_cndmask_b32_dpp v105, v101, v105, vcc quad_perm:[1,0,3,2] row_mask:0xf bank_mask:0xf
v_cndmask_b32_dpp v106, v102, v106, vcc quad_perm:[1,0,3,2] row_mask:0xf bank_mask:0xf
v_cndmask_b32_dpp v107, v103, v107, vcc quad_perm:[1,0,3,2] row_mask:0xf bank_mask:0xf
buffer_store_dwordx4 v[104:107], v4, s[20:23], s46 offen offset:1280 sc1
s_mov_b64 vcc, s[80:81]
s_waitcnt lgkmcnt(0)
buffer_store_dwordx2 v[112:113], v5, s[20:23], s46 offen
s_add_u32 s45, s45, s13
s_add_u32 s7, s7, s13
s_add_u32 s46, s46, s13
s_mov_b32 s13, 4718592
s_add_u32 s41, s41, 1
s_cmp_lt_u32 s41, s15
s_cbranch_scc1 L_stile
s_branch L_fin
.section .rodata,"a"
.p2align 6
.amdhsa_kernel standalone__structured_sparse_n_m__ragged_kernel
  .amdhsa_next_free_vgpr 512
  .amdhsa_next_free_sgpr 102
  .amdhsa_accum_offset 256
  .amdhsa_group_segment_fixed_size 0
  .amdhsa_float_denorm_mode_32 3
  .amdhsa_kernarg_size 48
  .amdhsa_user_sgpr_count 2
  .amdhsa_user_sgpr_kernarg_segment_ptr 1
  .amdhsa_system_sgpr_workgroup_id_x 1
.end_amdhsa_kernel
```

```asm
; @launch grid=(256,1,1) block=(256,1,1) lds=163840
.amdgcn_target "amdgcn-amd-amdhsa--gfx950"
.text
.globl standalone__structured_sparse_n_m__ragged_kernel
.p2align 8
.type standalone__structured_sparse_n_m__ragged_kernel,@function
standalone__structured_sparse_n_m__ragged_kernel:
s_load_dwordx8 s[4:11], s[0:1], 0
s_load_dwordx4 s[12:15], s[0:1], 32
s_cmp_ge_u32 s2, 256
s_cbranch_scc1 L_end_standalone__structured_sparse_n_m__ragged_kernel
v_lshlrev_b32 v3, 7, v0
s_getpc_b64 s[96:97]
v_min_u32 v2, L_slow-standalone__structured_sparse_n_m__ragged_kernel, v3
global_load_dword v120, v2, s[96:97]
v_lshrrev_b32 v1, 6, v0
v_and_b32 v7, 63, v0
v_readfirstlane_b32 s40, v1
s_mov_b32 s86, 0
s_lshr_b32 s84, s2, 6
s_and_b32 s47, s2, 9
s_lshl1_add_u32 s84, s84, s47
s_bfe_u32 s3, s2, 0x20004
s_lshl2_add_u32 s84, s84, s3
s_and_b32 s47, s2, 7
s_cmp_lt_u32 s47, 2
s_cselect_b32 s84, s84, 63
s_cmp_lt_u32 s84, 41
s_cbranch_scc1 L_prod
s_mov_b32 s85, 0x800020
s_mov_b32 s47, 0x800020
s_bitcmp1_b32 s2, 3
s_cselect_b32 s85, s85, 0x230003c
s_cselect_b32 s47, s47, 0x230003c
s_bitcmp1_b32 s2, 6
s_cselect_b32 s85, s47, s85
v_lshrrev_b32 v72, 3, v7
v_and_b32 v73, 7, v7
v_xor_b32 v73, v73, v72
v_mul_u32_u24 v72, 1152, v72
s_and_b32 s47, s40, 1
s_mul_i32 s47, s47, 9216
s_lshr_b32 s3, s40, 1
s_lshl_b32 s3, s3, 7
s_add_u32 s47, s47, s3
v_lshl_add_u32 v72, v73, 4, v72
v_add_u32 v3, s47, v72
s_lshl_b32 s44, s40, 10
s_mul_i32 s45, s2, 18432
s_mov_b32 s46, s45
s_waitcnt lgkmcnt(0)
s_mov_b32 s30, 663552
s_mov_b32 s31, 0x20000
s_mov_b32 s28, s6
s_and_b32 s29, s7, 0xffff
s_mov_b32 s18, 75497472
s_mov_b32 s19, 0x20000
s_mov_b32 s16, s4
s_and_b32 s17, s5, 0xffff
s_mov_b32 s26, 301989888
s_mov_b32 s27, 0x20000
s_mov_b32 s24, s14
s_and_b32 s25, s15, 0xffff
s_mov_b32 s34, 1152
s_mov_b32 s35, 0x20000
s_mov_b32 s32, s8
s_and_b32 s33, s9, 0xffff
s_mov_b32 s22, 0
s_mov_b32 s23, 0x20000
s_mov_b32 s20, s10
s_and_b32 s21, s11, 0xffff
s_mov_b32 s38, 256
s_mov_b32 s39, 0x20000
s_mov_b32 s36, s12
s_and_b32 s37, s13, 0xffff
s_cmp_lg_u32 s2, 200
s_cbranch_scc1 L_cons3
v_lshlrev_b32 v8, 4, v0
v_mov_b64 v[12:13], 0
v_mov_b64 v[14:15], 0
buffer_store_dwordx4 v[12:15], v8, s[36:39], 0 offen sc1
v_add_u32 v8, 458752, v8
v_add_u32 v9, 4096, v8
buffer_store_dwordx4 v[12:15], v8, s[24:27], 0 offen sc1
buffer_store_dwordx4 v[12:15], v9, s[24:27], 0 offen sc1
v_mov_b32 v10, 1
v_lshlrev_b32 v11, 2, v0
s_waitcnt vmcnt(0)
s_barrier
s_mov_b32 exec_hi, 0
buffer_store_dword v10, v11, s[36:39], 0 offen sc1
s_mov_b64 exec, -1
L_cons3:
s_lshr_b32 s47, s40, 1
s_lshl_b32 s3, s47, 11
s_sub_u32 s8, 15488, s3
s_lshl_b32 s3, s47, 7
s_add_u32 s7, s45, 128
s_sub_u32 s7, s7, s3
s_sub_u32 s10, s47, 1
s_sub_u32 s11, 0, s47
s_mov_b32 s9, s44
s_mov_b32 s13, 4718592
s_mov_b32 s15, 16
s_mov_b32 s14, s13
v_and_b32 v80, 3, v7
v_bfe_u32 v81, v7, 2, 2
v_bfe_u32 v82, v7, 4, 1
v_lshlrev_b32 v81, 3, v81
v_lshl_add_u32 v81, v80, 5, v81
v_lshl_add_u32 v81, v82, 7, v81
s_lshl_b32 s47, s40, 8
v_add_u32 v81, s47, v81
s_lshl_b32 s47, s40, 5
s_add_u32 s47, s47, 1024
v_lshl_add_u32 v80, v80, 3, s47
v_cmp_gt_u32 vcc, 32, v7
s_nop 1
v_cndmask_b32 v80, v80, v81, vcc
buffer_load_dwordx2 v[110:111], v80, s[32:35], 0 offen
s_waitcnt vmcnt(0)
s_bfe_u32 s88, s85, 0x40014
s_mov_b32 s3, 55680
s_cmp_ge_u32 s88, 6
s_cselect_b32 s3, s3, 0
s_cmp_ge_u32 s84, 41
s_cselect_b32 s3, s3, 0
L_pf:
s_add_u32 m0, s44, 0
s_nop 0
buffer_load_dwordx4 v3, s[16:19], s45 offen offset:0 nt lds
s_add_u32 m0, s44, 3840
s_nop 0
buffer_load_dwordx4 v3, s[16:19], s45 offen offset:256 nt lds
s_add_u32 m0, s44, 7680
s_nop 0
buffer_load_dwordx4 v3, s[16:19], s45 offen offset:512 nt lds
s_add_u32 m0, s44, 11520
s_nop 0
buffer_load_dwordx4 v3, s[16:19], s45 offen offset:768 nt lds
s_add_u32 m0, s44, s8
s_mov_b64 exec, s[10:11]
buffer_load_dwordx4 v3, s[16:19], s7 offen offset:896 nt lds
s_mov_b64 exec, -1
s_cmp_lg_u32 s44, 37120
s_cbranch_scc1 L_pf_f
s_mov_b64 exec, 1
buffer_load_dword v124, off, s[36:39], 0 sc1
s_mov_b64 exec, -1
L_pf_f:
s_cmp_ge_u32 s44, s3
s_cbranch_scc1 L_pf_n
s_waitcnt vmcnt(1)
L_pf_n:
s_add_u32 s7, s7, s13
s_add_u32 s44, s44, 18560
s_add_u32 s45, s45, s13
s_mov_b32 s13, 4718592
s_sub_u32 s88, s88, 1
s_cmp_lg_u32 s88, 0
s_cbranch_scc1 L_pf
L_pf_e:
s_branch L_rest
L_prod:
s_and_b32 s48, s84, 3
s_lshr_b32 s49, s84, 2
s_sub_u32 s50, s84, 36
s_lshl_b32 s51, s40, 4
s_lshl_b32 s52, s50, 1
s_lshl_b32 s53, s48, 8
s_cmp_lt_u32 s84, 36
s_cselect_b32 s52, s49, s52
s_cselect_b32 s53, s53, 1024
s_cselect_b32 s54, 8, 73728
s_cselect_b32 s55, 32, 8
s_cselect_b32 s56, 16, 32
s_cselect_b32 s57, 128, 64
s_mul_i32 s52, s52, 73728
s_mul_i32 s58, s40, 18432
v_and_b32 v58, 1, v7
v_bfe_u32 v59, v7, 1, 1
v_bfe_u32 v60, v7, 2, 2
v_bfe_u32 v62, v7, 4, 1
v_lshrrev_b32 v63, 5, v7
v_lshl_add_u32 v50, v58, 2, s52
v_mad_u32_u24 v50, v59, s54, v50
v_mad_u32_u24 v50, v60, s55, v50
v_mad_u32_u24 v50, v62, s56, v50
v_mad_u32_u24 v50, v63, s57, v50
v_add_u32 v50, s53, v50
v_add_u32 v50, s58, v50
v_add_u32 v62, 4608, v50
v_add_u32 v63, 9216, v50
v_add_u32 v64, 13824, v50
s_waitcnt lgkmcnt(0)
s_mov_b32 s30, 663552
s_mov_b32 s31, 0x20000
s_mov_b32 s28, s6
s_and_b32 s29, s7, 0xffff
buffer_load_dword v8, v50, s[28:31], 0 offen offset:0 nt
buffer_load_dword v9, v50, s[28:31], 0 offen offset:1152 nt
buffer_load_dword v10, v50, s[28:31], 0 offen offset:2304 nt
buffer_load_dword v11, v50, s[28:31], 0 offen offset:3456 nt
buffer_load_dword v12, v62, s[28:31], 0 offen offset:0 nt
buffer_load_dword v13, v62, s[28:31], 0 offen offset:1152 nt
buffer_load_dword v14, v62, s[28:31], 0 offen offset:2304 nt
buffer_load_dword v15, v62, s[28:31], 0 offen offset:3456 nt
buffer_load_dword v16, v63, s[28:31], 0 offen offset:0 nt
buffer_load_dword v17, v63, s[28:31], 0 offen offset:1152 nt
buffer_load_dword v18, v63, s[28:31], 0 offen offset:2304 nt
buffer_load_dword v19, v63, s[28:31], 0 offen offset:3456 nt
buffer_load_dword v20, v64, s[28:31], 0 offen offset:0 nt
buffer_load_dword v21, v64, s[28:31], 0 offen offset:1152 nt
buffer_load_dword v22, v64, s[28:31], 0 offen offset:2304 nt
buffer_load_dword v23, v64, s[28:31], 0 offen offset:3456 nt
s_mov_b32 s18, 75497472
s_mov_b32 s19, 0x20000
s_mov_b32 s16, s4
s_and_b32 s17, s5, 0xffff
s_mov_b32 s26, 301989888
s_mov_b32 s27, 0x20000
s_mov_b32 s24, s14
s_and_b32 s25, s15, 0xffff
s_mov_b32 s34, 1152
s_mov_b32 s35, 0x20000
s_mov_b32 s32, s8
s_and_b32 s33, s9, 0xffff
s_mov_b32 s22, 0
s_mov_b32 s23, 0x20000
s_mov_b32 s20, s10
s_and_b32 s21, s11, 0xffff
s_mov_b32 s38, 256
s_mov_b32 s39, 0x20000
s_mov_b32 s36, s12
s_and_b32 s37, s13, 0xffff
s_mul_i32 s52, s48, 9
s_add_u32 s52, s52, s49
s_mul_i32 s53, s52, 9
s_mul_i32 s54, s50, 18
s_add_u32 s54, s54, 8
s_lshl_b32 s55, s52, 2
s_add_u32 s55, s55, s40
s_lshl_b32 s56, s50, 2
s_add_u32 s56, s56, s40
s_cmp_eq_u32 s84, 40
s_cselect_b32 s57, 0x100000, 9
s_cmp_lt_u32 s84, 36
s_cselect_b32 s53, s53, s54
s_cselect_b32 s54, 2, 81
s_cselect_b32 s57, 1, s57
s_cselect_b32 s55, s55, s56
s_mov_b32 s56, 331776
s_cselect_b32 s56, s56, 368640
s_mov_b32 s58, 373760
s_cselect_b32 s58, s58, 382976
s_cselect_b32 s59, 16, 4
s_cselect_b32 s60, 4, 64
s_cselect_b32 s61, 12, 11
s_cselect_b32 s62, 1, 0x8001
v_lshrrev_b32 v61, 4, v7
v_lshlrev_b32 v62, 1, v58
v_lshl_add_u32 v60, v60, 2, v62
v_add_u32 v62, v60, v59
v_mul_u32_u24 v51, s54, v61
v_add_lshl_u32 v51, v51, s53, 6
v_add3_u32 v51, v51, v62, s51
v_lshl_add_u32 v51, v51, 4, s86
s_lshl_b32 s57, s57, 10
v_add_u32 v66, s57, v51
s_lshl_b32 s52, s55, 8
s_add_u32 s52, s52, s56
s_add_u32 s52, s52, s86
v_mul_u32_u24 v52, s59, v62
v_mad_u32_u24 v52, v61, s60, v52
v_lshl_add_u32 v54, v7, 2, s52
s_lshr_b32 s52, s55, 2
s_lshl_b32 s52, s52, 8
s_add_u32 s58, s58, s52
s_lshl2_add_u32 s58, s51, s58
s_lshl_b32 s52, s51, 1
s_add_u32 s52, s52, s62
v_lshl_add_u32 v62, v61, 1, v59
v_lshlrev_b32 v62, s61, v62
v_lshl_add_u32 v53, v60, 7, v62
v_add_u32 v53, s52, v53
v_and_b32 v62, 12, v7
v_and_b32 v63, 15, v7
v_mad_u32_u24 v62, v62, 3, v63
v_lshl_add_u32 v62, v62, 2, s51
v_mov_b32 v67, 0
ds_write_b32 v62, v67
s_lshl2_add_u32 s52, s84, s40
s_lshl_b32 s52, s52, 7
s_add_u32 s52, s52, 393152
v_lshl_add_u32 v65, v7, 2, s58
v_lshl_add_u32 v62, v7, 2, s52
v_cmp_gt_u32 vcc, 16, v7
s_lshl_b32 s52, s51, 2
v_lshl_add_u32 v57, v7, 2, s52
v_cndmask_b32 v65, v62, v65, vcc
s_mov_b32 s75, 0
s_mov_b32 s73, 0x05060100
s_mov_b32 s74, 0xffff
v_mov_b32 v55, 0x05040100
v_mov_b32 v62, 0x03020706
v_cmp_eq_u32 vcc, 1, v59
v_mov_b32 v68, 0xf0a0500
v_mov_b32 v69, 0x8f8a8580
v_mov_b32 v70, 0x1f1a1510
v_mov_b32 v71, 0x9f9a9590
v_mov_b32 v72, 0x2f2a2520
v_mov_b32 v73, 0xafaaa5a0
v_mov_b32 v74, 0x3f3a3530
v_mov_b32 v75, 0xbfbab5b0
v_cndmask_b32 v55, v55, v62, vcc
v_mov_b64 v[76:77], 0
v_mov_b64 v[78:79], 0
v_mov_b64 v[80:81], 0
v_mov_b32 v82, 0
s_mov_b32 s64, 0x5040500
s_mov_b32 s65, 0x5040501
s_mov_b32 s66, 0x5040502
s_mov_b32 s67, 0x5040503
s_mov_b32 s68, 0x7060700
s_mov_b32 s69, 0x7060701
s_mov_b32 s70, 0x7060702
s_mov_b32 s71, 0x7060703
s_mov_b32 s72, 0x05060102
s_waitcnt vmcnt(12)
v_perm_b32 v24, v8, v68, s64
v_perm_b32 v25, v9, v68, s65
v_perm_b32 v26, v10, v68, s66
v_perm_b32 v27, v11, v68, s67
v_max3_f32 v28, |v24|, |v25|, |v26|
v_med3_f32 v29, |v24|, |v25|, |v26|
v_min3_f32 v30, |v24|, |v25|, |v26|
v_med3_f32 v32, v28, v29, |v27|
v_med3_f32 v33, v29, v30, |v27|
v_max_f32 v31, v28, |v27|
v_perm_b32 v36, v31, v32, s72
v_bfi_b32 v44, 3, v32, v31
v_cmpx_eq_u32_sdwa vcc, v33, v32 src0_sel:WORD_1 src1_sel:WORD_1
v_mov_b32 v76, v33
v_min_f32 v77, v30, |v27|
s_mov_b64 exec, -1
v_perm_b32 v24, v8, v69, s68
v_perm_b32 v25, v9, v69, s69
v_perm_b32 v26, v10, v69, s70
v_perm_b32 v27, v11, v69, s71
v_max3_f32 v28, |v24|, |v25|, |v26|
v_med3_f32 v29, |v24|, |v25|, |v26|
v_min3_f32 v30, |v24|, |v25|, |v26|
v_med3_f32 v32, v28, v29, |v27|
v_med3_f32 v33, v29, v30, |v27|
v_max_f32 v31, v28, |v27|
v_perm_b32 v40, v31, v32, s72
v_bfi_b32 v46, 3, v32, v31
v_cmpx_eq_u32_sdwa vcc, v33, v32 src0_sel:WORD_1 src1_sel:WORD_1
v_mov_b64 v[78:79], v[76:77]
v_mov_b32 v76, v33
v_min_f32 v77, v30, |v27|
s_mov_b64 exec, -1
s_waitcnt vmcnt(8)
v_perm_b32 v24, v12, v70, s64
v_perm_b32 v25, v13, v70, s65
v_perm_b32 v26, v14, v70, s66
v_perm_b32 v27, v15, v70, s67
v_max3_f32 v28, |v24|, |v25|, |v26|
v_med3_f32 v29, |v24|, |v25|, |v26|
v_min3_f32 v30, |v24|, |v25|, |v26|
v_med3_f32 v32, v28, v29, |v27|
v_med3_f32 v33, v29, v30, |v27|
v_max_f32 v31, v28, |v27|
v_perm_b32 v37, v31, v32, s72
v_bfi_b32 v31, 3, v32, v31
v_lshlrev_b32 v31, 4, v31
v_bfi_b32 v44, 15, v44, v31
v_cmpx_eq_u32_sdwa vcc, v33, v32 src0_sel:WORD_1 src1_sel:WORD_1
v_mov_b64 v[80:81], v[78:79]
v_mov_b64 v[78:79], v[76:77]
v_mov_b32 v76, v33
v_min_f32 v77, v30, |v27|
s_mov_b64 exec, -1
v_perm_b32 v24, v12, v71, s68
v_perm_b32 v25, v13, v71, s69
v_perm_b32 v26, v14, v71, s70
v_perm_b32 v27, v15, v71, s71
v_max3_f32 v28, |v24|, |v25|, |v26|
v_med3_f32 v29, |v24|, |v25|, |v26|
v_min3_f32 v30, |v24|, |v25|, |v26|
v_med3_f32 v32, v28, v29, |v27|
v_med3_f32 v33, v29, v30, |v27|
v_max_f32 v31, v28, |v27|
v_perm_b32 v41, v31, v32, s72
v_bfi_b32 v31, 3, v32, v31
v_lshlrev_b32 v31, 4, v31
v_bfi_b32 v46, 15, v46, v31
v_cmpx_eq_u32_sdwa vcc, v33, v32 src0_sel:WORD_1 src1_sel:WORD_1
v_or_b32 v82, v82, v80
v_mov_b64 v[80:81], v[78:79]
v_mov_b64 v[78:79], v[76:77]
v_mov_b32 v76, v33
v_min_f32 v77, v30, |v27|
s_mov_b64 exec, -1
s_waitcnt vmcnt(4)
v_perm_b32 v24, v16, v72, s64
v_perm_b32 v25, v17, v72, s65
v_perm_b32 v26, v18, v72, s66
v_perm_b32 v27, v19, v72, s67
v_max3_f32 v28, |v24|, |v25|, |v26|
v_med3_f32 v29, |v24|, |v25|, |v26|
v_min3_f32 v30, |v24|, |v25|, |v26|
v_med3_f32 v32, v28, v29, |v27|
v_med3_f32 v33, v29, v30, |v27|
v_max_f32 v31, v28, |v27|
v_perm_b32 v38, v31, v32, s72
v_bfi_b32 v45, 3, v32, v31
v_cmpx_eq_u32_sdwa vcc, v33, v32 src0_sel:WORD_1 src1_sel:WORD_1
v_or_b32 v82, v82, v80
v_mov_b64 v[80:81], v[78:79]
v_mov_b64 v[78:79], v[76:77]
v_mov_b32 v76, v33
v_min_f32 v77, v30, |v27|
s_mov_b64 exec, -1
v_perm_b32 v24, v16, v73, s68
v_perm_b32 v25, v17, v73, s69
v_perm_b32 v26, v18, v73, s70
v_perm_b32 v27, v19, v73, s71
v_max3_f32 v28, |v24|, |v25|, |v26|
v_med3_f32 v29, |v24|, |v25|, |v26|
v_min3_f32 v30, |v24|, |v25|, |v26|
v_med3_f32 v32, v28, v29, |v27|
v_med3_f32 v33, v29, v30, |v27|
v_max_f32 v31, v28, |v27|
v_perm_b32 v42, v31, v32, s72
v_bfi_b32 v47, 3, v32, v31
v_cmpx_eq_u32_sdwa vcc, v33, v32 src0_sel:WORD_1 src1_sel:WORD_1
v_or_b32 v82, v82, v80
v_mov_b64 v[80:81], v[78:79]
v_mov_b64 v[78:79], v[76:77]
v_mov_b32 v76, v33
v_min_f32 v77, v30, |v27|
s_mov_b64 exec, -1
s_waitcnt vmcnt(0)
v_perm_b32 v24, v20, v74, s64
v_perm_b32 v25, v21, v74, s65
v_perm_b32 v26, v22, v74, s66
v_perm_b32 v27, v23, v74, s67
v_max3_f32 v28, |v24|, |v25|, |v26|
v_med3_f32 v29, |v24|, |v25|, |v26|
v_min3_f32 v30, |v24|, |v25|, |v26|
v_med3_f32 v32, v28, v29, |v27|
v_med3_f32 v33, v29, v30, |v27|
v_max_f32 v31, v28, |v27|
v_perm_b32 v39, v31, v32, s72
v_bfi_b32 v31, 3, v32, v31
v_lshlrev_b32 v31, 4, v31
v_bfi_b32 v45, 15, v45, v31
v_cmpx_eq_u32_sdwa vcc, v33, v32 src0_sel:WORD_1 src1_sel:WORD_1
v_or_b32 v82, v82, v80
v_mov_b64 v[80:81], v[78:79]
v_mov_b64 v[78:79], v[76:77]
v_mov_b32 v76, v33
v_min_f32 v77, v30, |v27|
s_mov_b64 exec, -1
v_perm_b32 v24, v20, v75, s68
v_perm_b32 v25, v21, v75, s69
v_perm_b32 v26, v22, v75, s70
v_perm_b32 v27, v23, v75, s71
v_max3_f32 v28, |v24|, |v25|, |v26|
v_med3_f32 v29, |v24|, |v25|, |v26|
v_min3_f32 v30, |v24|, |v25|, |v26|
v_med3_f32 v32, v28, v29, |v27|
v_med3_f32 v33, v29, v30, |v27|
v_max_f32 v31, v28, |v27|
v_perm_b32 v43, v31, v32, s72
v_bfi_b32 v31, 3, v32, v31
v_lshlrev_b32 v31, 4, v31
v_bfi_b32 v47, 15, v47, v31
v_cmpx_eq_u32_sdwa vcc, v33, v32 src0_sel:WORD_1 src1_sel:WORD_1
v_or_b32 v82, v82, v80
v_mov_b64 v[80:81], v[78:79]
v_mov_b64 v[78:79], v[76:77]
v_mov_b32 v76, v33
v_min_f32 v77, v30, |v27|
s_mov_b64 exec, -1
s_mov_b32 vcc_lo, 0x33333333
s_mov_b32 vcc_hi, 0x33333333
v_cndmask_b32_dpp v24, v40, v36, vcc quad_perm:[2,3,0,1] row_mask:0xf bank_mask:0xf
v_cndmask_b32_dpp v25, v41, v37, vcc quad_perm:[2,3,0,1] row_mask:0xf bank_mask:0xf
v_cndmask_b32_dpp v26, v42, v38, vcc quad_perm:[2,3,0,1] row_mask:0xf bank_mask:0xf
v_cndmask_b32_dpp v27, v43, v39, vcc quad_perm:[2,3,0,1] row_mask:0xf bank_mask:0xf
s_not_b64 vcc, vcc
buffer_store_dwordx4 v[24:27], v51, s[24:27], 0 offen sc1
v_cndmask_b32_dpp v40, v36, v40, vcc quad_perm:[2,3,0,1] row_mask:0xf bank_mask:0xf
v_cndmask_b32_dpp v41, v37, v41, vcc quad_perm:[2,3,0,1] row_mask:0xf bank_mask:0xf
v_cndmask_b32_dpp v42, v38, v42, vcc quad_perm:[2,3,0,1] row_mask:0xf bank_mask:0xf
v_cndmask_b32_dpp v43, v39, v43, vcc quad_perm:[2,3,0,1] row_mask:0xf bank_mask:0xf
s_mov_b32 s52, 0x0c0c0400
s_mov_b32 s53, 0x04000c0c
buffer_store_dwordx4 v[40:43], v66, s[24:27], 0 offen sc1
v_perm_b32 v48, v45, v44, s52
v_perm_b32 v49, v47, v46, s53
v_or_b32 v48, v48, v49
s_nop 1
v_mov_b32_dpp v49, v48 quad_perm:[2,3,0,1] row_mask:0xf bank_mask:0xf
v_perm_b32 v48, v49, v48, v55
ds_permute_b32 v48, v52, v48
v_cmp_lt_u32 s[54:55], s74, v82
L_emit:
v_cmp_lt_u32 vcc, s74, v76
v_cmp_eq_u32_sdwa s[48:49], v77, v76 src0_sel:WORD_1 src1_sel:WORD_1
v_perm_b32 v63, v76, v53, s73
v_bfe_u32 v62, v76, 2, 4
v_and_b32 v64, 0x80, v76
v_lshl_add_u32 v63, v62, 1, v63
v_mbcnt_lo_u32_b32 v62, vcc_lo, 0
v_mbcnt_hi_u32_b32 v62, vcc_hi, v62
v_add_u32 v63, v64, v63
v_add_u32 v62, s75, v62
s_bcnt1_i32_b64 s52, vcc
s_add_u32 s75, s75, s52
v_cmp_gt_u32 s[52:53], 15, v62
v_and_b32 v64, 12, v62
v_mad_u32_u24 v62, v64, 3, v62
v_lshl_add_u32 v62, v62, 2, s51
s_and_b64 s[48:49], s[48:49], vcc
s_and_b64 exec, s[52:53], vcc
ds_write_b32 v62, v63
s_mov_b64 exec, s[48:49]
v_mov_b32 v76, v77
v_mov_b32 v77, 0
s_not_b64 exec, exec
v_mov_b64 v[76:77], v[78:79]
v_mov_b64 v[78:79], v[80:81]
v_mov_b64 v[80:81], 0
s_mov_b64 exec, -1
v_or3_b32 v62, v76, v78, v80
v_cmp_lt_u32 vcc, s74, v62
s_cmp_lg_u64 s[54:55], 0
s_cselect_b32 s52, 99, s75
s_cmp_gt_u32 s52, 15
s_cselect_b32 s52, -1, 0
v_mov_b32 v63, s51
s_cbranch_vccnz L_emit
v_mov_b32 v62, s52
ds_write_b32 v63, v62 offset:204
v_lshlrev_b32 v11, 4, v63
s_waitcnt lgkmcnt(0)
s_barrier
s_mov_b64 exec, 0xffff
ds_read_b32 v67, v57
s_mov_b64 exec, -1
buffer_store_dword v48, v54, s[24:27], 0 offen sc1
s_mov_b32 exec_hi, 0xffff
s_waitcnt lgkmcnt(0)
buffer_store_dword v67, v65, s[24:27], 0 offen sc1
s_mov_b64 exec, 1
buffer_load_dword v8, v11, s[36:39], 0 offen sc1
s_mov_b64 exec, -1
s_lshl_b32 s52, s84, 7
s_add_u32 s52, s52, 458752
v_lshl_add_u32 v9, v7, 2, s52
v_mov_b32 v10, 1
s_waitcnt vmcnt(0)
s_mov_b32 s85, 0x230003c
s_barrier
s_cmp_lg_u32 s40, 0
s_cbranch_scc1 L_cons2
v_readfirstlane_b32 s47, v8
s_mov_b64 exec, 0xffff
s_cmp_lg_u32 s47, 1
s_cbranch_scc1 L_pwait
L_pset:
buffer_store_dword v10, v9, s[24:27], 0 offen sc1
L_notlast:
s_mov_b64 exec, -1
L_cons2:
v_lshrrev_b32 v72, 3, v7
v_and_b32 v73, 7, v7
v_xor_b32 v73, v73, v72
v_mul_u32_u24 v72, 1152, v72
s_and_b32 s47, s40, 1
s_mul_i32 s47, s47, 9216
s_lshr_b32 s3, s40, 1
s_lshl_b32 s3, s3, 7
s_add_u32 s47, s47, s3
v_lshl_add_u32 v72, v73, 4, v72
v_add_u32 v3, s47, v72
s_lshl_b32 s44, s40, 10
s_mul_i32 s45, s2, 18432
s_mov_b32 s46, s45
s_branch L_cons3
L_pwait:
s_mov_b32 s3, 20015
L_pwait1:
buffer_load_dword v8, off, s[36:39], 0 sc1
s_waitcnt vmcnt(0)
v_readfirstlane_b32 s47, v8
s_nop 3
s_cmp_eq_u32 s47, 1
s_cbranch_scc1 L_pset
s_sub_u32 s3, s3, 1
s_cbranch_scc0 L_pwait1
s_branch L_notlast
L_rest:
s_mov_b32 s92, 0x80
s_mov_b32 s47, 0x80
s_bitcmp1_b32 s2, 3
s_cselect_b32 s92, s92, 0x88
s_cselect_b32 s47, s47, 0x88
s_bitcmp1_b32 s2, 6
s_cselect_b32 s92, s47, s92
s_mov_b32 s3, 0x88
s_cmp_lt_u32 s84, 41
s_cselect_b32 s92, s3, s92
s_mov_b32 s87, 0x80
s_mov_b32 s3, 0x80
s_cmp_lt_u32 s84, 41
s_cselect_b32 s87, s3, s87
v_and_b32 v72, 15, v7
v_lshrrev_b32 v73, 4, v7
v_and_b32 v74, 7, v7
v_xor_b32 v74, v74, v73
v_lshlrev_b32 v74, 4, v74
v_lshl_add_u32 v0, v72, 7, v74
v_xor_b32 v1, 64, v0
s_mul_i32 s93, s40, 3584
s_add_u32 s93, s93, 148480
v_lshl_add_u32 v2, v73, 4, s93
v_and_b32 v74, 14, v7
v_mul_u32_u24 v4, 1152, v74
v_and_b32 v74, 1, v7
v_lshl_add_u32 v4, v74, 4, v4
v_lshl_add_u32 v4, v73, 5, v4
s_lshl_b32 s47, s40, 8
v_add_u32 v4, s47, v4
s_lshl_b32 s47, s40, 5
s_add_u32 s47, s47, 1024
v_lshrrev_b32 v72, 2, v7
v_and_b32 v73, 3, v7
v_lshl_add_u32 v6, v73, 4, v72
v_lshlrev_b32 v6, 2, v6
v_mul_u32_u24 v5, 1152, v72
v_lshl_add_u32 v5, v73, 3, v5
v_add_u32 v5, s47, v5
s_mov_b32 s80, 0x55555555
s_mov_b32 s81, 0x55555555
s_mov_b32 s82, 0xaaaaaaaa
s_mov_b32 s83, 0xaaaaaaaa
v_lshl_add_u32 v109, v7, 4, s93
v_lshl_add_u32 v89, v7, 2, s93
v_mov_b32 v76, 0
v_mov_b32 v77, 0
v_mov_b32 v78, 0
v_mov_b32 v79, 0
v_mov_b32 v90, 0xdddddddd
ds_write_b128 v109, v[76:79]
ds_write_b32 v89, v90 offset:1792
ds_write_b32 v89, v90 offset:2048
ds_write_b32 v89, v90 offset:2304
ds_write_b32 v89, v90 offset:2560
ds_write_b32 v89, v90 offset:2816
ds_write_b32 v89, v90 offset:3072
ds_write_b32 v89, v90 offset:3328
s_lshl_b32 s47, s40, 2
s_add_u32 s47, s47, 163072
v_mov_b32 v88, s47
ds_write_b32 v88, v76
s_mul_i32 s47, s40, 2304
s_add_u32 s47, s47, 373760
v_and_b32 v73, 60, v7
v_mad_u32_u24 v73, v73, 3, v7
v_lshl_add_u32 v72, v73, 4, s47
s_mov_b32 s47, 380672
v_lshl_add_u32 v73, v73, 4, s47
v_lshrrev_b32 v74, 2, v7
v_cmp_gt_u32 vcc, 36, v7
v_lshlrev_b32 v90, 11, v74
v_subrev_u32 v74, 9, v74
v_lshlrev_b32 v74, 12, v74
v_cndmask_b32 v72, v73, v72, vcc
v_cndmask_b32 v90, v74, v90, vcc
s_lshl_b32 s47, s40, 12
s_add_u32 s47, s47, 0x8001
v_mov_b32 v88, 1
v_mov_b32 v94, 0xf001
v_mov_b32 v95, s47
v_cndmask_b32 v94, v94, v88, vcc
v_cndmask_b32 v95, v95, v88, vcc
v_cndmask_b32 v96, 0, 28, vcc
v_cndmask_b32 v97, 32, 0, vcc
v_add_u32 v97, s93, v97
v_cmp_gt_u32 vcc, 56, v7
v_mov_b32 v73, 0x40000000
s_lshr_b32 s47, s2, 3
s_lshl_b32 s47, s47, 2
s_add_u32 s47, s47, s40
s_mul_i32 s47, s47, 2944
v_cndmask_b32 v72, v73, v72, vcc
v_lshl_add_u32 v93, v7, 4, s47
s_mul_i32 s47, s40, 82944
s_add_u32 s47, s47, s86
v_lshl_add_u32 v112, v7, 4, s47
s_mul_i32 s47, s40, 9216
s_add_u32 s47, s47, s86
s_add_u32 s47, s47, 331776
v_lshl_add_u32 v113, v7, 4, s47
s_lshl_b32 s47, s40, 6
s_add_u32 s47, s47, s86
s_add_u32 s47, s47, 368640
v_and_b32 v106, 15, v7
v_lshl_add_u32 v106, v106, 2, s47
v_lshrrev_b32 v107, 4, v7
v_lshl_add_u32 v106, v107, 8, v106
v_and_b32 v74, 15, v7
v_and_b32 v73, 7, v7
v_lshlrev_b32 v100, 1, v73
v_lshlrev_b32 v100, v100, v88
v_lshlrev_b32 v73, 4, v73
v_lshl_add_u32 v92, v74, 7, v73
v_lshl_or_b32 v92, v92, 16, v92
v_lshrrev_b32 v98, 5, v7
v_bfe_u32 v99, v7, 3, 2
v_lshl_add_u32 v99, v99, 6, s93
v_lshl_add_u32 v101, v7, 1, s93
v_lshrrev_b32 v102, 4, v7
v_lshl_add_u32 v102, v102, 3, s93
v_lshrrev_b32 v103, 1, v7
v_lshlrev_b32 v103, 5, v103
s_mov_b32 s89, 0
s_cmp_lg_u32 s40, 0
s_cbranch_scc1 L_ready
s_mov_b32 s3, 20015
s_mov_b32 s47, 458752
v_lshl_add_u32 v9, v7, 7, s47
s_bfe_u32 s47, s85, 0x40014
s_cmp_ge_u32 s47, 6
s_waitcnt vmcnt(15)
s_cbranch_scc1 L_deep
s_waitcnt vmcnt(0)
L_deep:
v_readfirstlane_b32 s47, v124
s_mov_b32 exec_hi, 511
s_cmp_lg_u32 s47, 1
s_cbranch_scc1 L_cwait
L_poll:
buffer_load_dword v8, v9, s[24:27], 0 offen sc1
s_sub_u32 s3, s3, 1
s_cbranch_scc1 L_giveup
s_waitcnt vmcnt(0)
v_cmp_ne_u32 vcc, 1, v8
s_nop 4
s_cbranch_vccnz L_poll
L_polled:
s_mov_b64 exec, -1
L_ready:
s_waitcnt lgkmcnt(0)
s_barrier
buffer_load_dwordx4 v[8:11], v72, s[24:27], 0 offen offset:0 sc1
buffer_load_dwordx4 v[12:15], v72, s[24:27], 0 offen offset:64 sc1
buffer_load_dwordx4 v[16:19], v72, s[24:27], 0 offen offset:128 sc1
buffer_load_dwordx4 v[20:23], v72, s[24:27], 0 offen offset:192 sc1
buffer_load_dwordx4 v[76:79], v93, s[24:27], 0 offen offset:0 sc1
buffer_load_dwordx4 v[80:83], v93, s[24:27], 0 offen offset:1024 sc1
buffer_load_dwordx4 v[84:87], v93, s[24:27], 0 offen offset:2048 sc1
buffer_load_dword v174, v106, s[24:27], 0 offen offset:0 sc1
buffer_load_dword v175, v106, s[24:27], 0 offen offset:1024 sc1
buffer_load_dword v176, v106, s[24:27], 0 offen offset:2048 sc1
buffer_load_dword v177, v106, s[24:27], 0 offen offset:3072 sc1
s_mov_b32 s99, 4096
buffer_load_dword v178, v106, s[24:27], s99 offen offset:0 sc1
s_mov_b32 s98, 0
buffer_load_dwordx4 v[138:141], v113, s[24:27], s98 offen sc1
s_mov_b32 s99, 0
buffer_load_dwordx4 a[0:3], v112, s[24:27], s99 offen offset:0 sc1
buffer_load_dwordx4 a[4:7], v112, s[24:27], s99 offen offset:1024 sc1
buffer_load_dwordx4 a[8:11], v112, s[24:27], s99 offen offset:2048 sc1
s_waitcnt vmcnt(12)
v_cmp_ne_u32 s[90:91], 0, v23
v_cmp_ne_u32 s[78:79], 0, v16
v_and_b32 v73, v94, v8
v_lshrrev_b32 v72, 10, v8
v_cmp_eq_u32 s[48:49], v73, v95
v_and_or_b32 v24, v72, v96, v97
s_mov_b64 exec, s[48:49]
ds_add_rtn_u32 v40, v24, v88
s_mov_b64 exec, -1
buffer_load_dwordx4 a[12:15], v112, s[24:27], s99 offen offset:3072 sc1
v_and_b32 v73, v94, v9
v_lshrrev_b32 v72, 10, v9
v_cmp_eq_u32 s[50:51], v73, v95
v_and_or_b32 v25, v72, v96, v97
s_mov_b64 exec, s[50:51]
ds_add_rtn_u32 v41, v25, v88
s_mov_b64 exec, -1
v_and_b32 v73, v94, v10
v_lshrrev_b32 v72, 10, v10
v_cmp_eq_u32 s[52:53], v73, v95
v_and_or_b32 v26, v72, v96, v97
s_mov_b64 exec, s[52:53]
ds_add_rtn_u32 v42, v26, v88
s_mov_b64 exec, -1
s_mov_b32 s99, 4096
buffer_load_dwordx4 a[16:19], v112, s[24:27], s99 offen offset:0 sc1
v_and_b32 v73, v94, v11
v_lshrrev_b32 v72, 10, v11
v_cmp_eq_u32 s[54:55], v73, v95
v_and_or_b32 v27, v72, v96, v97
s_mov_b64 exec, s[54:55]
ds_add_rtn_u32 v43, v27, v88
s_mov_b64 exec, -1
buffer_load_dwordx4 a[20:23], v112, s[24:27], s99 offen offset:1024 sc1
v_and_b32 v73, v94, v12
v_lshrrev_b32 v72, 10, v12
v_cmp_eq_u32 s[56:57], v73, v95
v_and_or_b32 v28, v72, v96, v97
s_mov_b64 exec, s[56:57]
ds_add_rtn_u32 v44, v28, v88
s_mov_b64 exec, -1
buffer_load_dwordx4 a[24:27], v112, s[24:27], s99 offen offset:2048 sc1
v_and_b32 v73, v94, v13
v_lshrrev_b32 v72, 10, v13
v_cmp_eq_u32 s[58:59], v73, v95
v_and_or_b32 v29, v72, v96, v97
s_mov_b64 exec, s[58:59]
ds_add_rtn_u32 v45, v29, v88
s_mov_b64 exec, -1
v_and_b32 v73, v94, v14
v_lshrrev_b32 v72, 10, v14
v_cmp_eq_u32 s[60:61], v73, v95
v_and_or_b32 v30, v72, v96, v97
s_mov_b64 exec, s[60:61]
ds_add_rtn_u32 v46, v30, v88
s_mov_b64 exec, -1
buffer_load_dwordx4 a[28:31], v112, s[24:27], s99 offen offset:3072 sc1
v_and_b32 v73, v94, v15
v_lshrrev_b32 v72, 10, v15
v_cmp_eq_u32 s[62:63], v73, v95
v_and_or_b32 v31, v72, v96, v97
s_mov_b64 exec, s[62:63]
ds_add_rtn_u32 v47, v31, v88
s_mov_b64 exec, -1
s_mov_b32 s99, 8192
buffer_load_dwordx4 a[32:35], v112, s[24:27], s99 offen offset:0 sc1
s_cmp_lg_u64 s[78:79], 0
s_cbranch_scc1 L_more1
L_more1b:
ds_read_b32 v72, v89
v_mov_b32 v73, 0
s_mov_b32 s98, 1024
buffer_load_dwordx4 v[142:145], v113, s[24:27], s98 offen sc1
buffer_load_dwordx4 a[36:39], v112, s[24:27], s99 offen offset:1024 sc1
buffer_load_dwordx4 a[40:43], v112, s[24:27], s99 offen offset:2048 sc1
s_waitcnt lgkmcnt(0)
s_mov_b64 vcc, s[80:81]
v_cndmask_b32_dpp v73, v72, v73, vcc quad_perm:[0,0,2,2] row_mask:0xf bank_mask:0xf
v_add_u32 v91, v103, v73
v_add_u32 v73, v72, v73
v_cmp_lt_u32 vcc, 32, v73
s_or_b32 s90, s90, s91
s_and_b32 s47, vcc_lo, 0x1ff
s_or_b32 s47, s47, s90
s_cbranch_scc1 L_greedy
L_greedyb:
buffer_load_dwordx4 a[44:47], v112, s[24:27], s99 offen offset:3072 sc1
ds_bpermute_b32 v56, v24, v91
ds_bpermute_b32 v57, v25, v91
ds_bpermute_b32 v58, v26, v91
ds_bpermute_b32 v59, v27, v91
ds_bpermute_b32 v60, v28, v91
ds_bpermute_b32 v61, v29, v91
ds_bpermute_b32 v62, v30, v91
ds_bpermute_b32 v63, v31, v91
s_mov_b32 s99, 12288
buffer_load_dwordx4 a[48:51], v112, s[24:27], s99 offen offset:0 sc1
buffer_load_dwordx4 a[52:55], v112, s[24:27], s99 offen offset:1024 sc1
buffer_load_dwordx4 a[56:59], v112, s[24:27], s99 offen offset:2048 sc1
s_waitcnt lgkmcnt(7)
v_add_u32 v73, v40, v56
v_and_b32 v72, 0x87e, v8
v_lshl_add_u32 v73, v73, 1, s93
v_add_u32 v72, v90, v72
s_andn2_b64 exec, s[48:49], s[90:91]
ds_write_b16_d16_hi v73, v8 offset:64
ds_write_b16 v73, v72 offset:384
ds_write_b16 v73, v8 offset:704
s_mov_b64 exec, -1
buffer_load_dwordx4 a[60:63], v112, s[24:27], s99 offen offset:3072 sc1
s_waitcnt lgkmcnt(9)
v_add_u32 v73, v41, v57
v_and_b32 v72, 0x87e, v9
v_lshl_add_u32 v73, v73, 1, s93
v_add_u32 v72, v90, v72
s_andn2_b64 exec, s[50:51], s[90:91]
ds_write_b16_d16_hi v73, v9 offset:64
ds_write_b16 v73, v72 offset:384
ds_write_b16 v73, v9 offset:704
s_mov_b64 exec, -1
s_mov_b32 s99, 16384
buffer_load_dwordx4 a[64:67], v112, s[24:27], s99 offen offset:0 sc1
s_waitcnt lgkmcnt(11)
v_add_u32 v73, v42, v58
v_and_b32 v72, 0x87e, v10
v_lshl_add_u32 v73, v73, 1, s93
v_add_u32 v72, v90, v72
s_andn2_b64 exec, s[52:53], s[90:91]
ds_write_b16_d16_hi v73, v10 offset:64
ds_write_b16 v73, v72 offset:384
ds_write_b16 v73, v10 offset:704
s_mov_b64 exec, -1
buffer_load_dwordx4 a[68:71], v112, s[24:27], s99 offen offset:1024 sc1
s_waitcnt lgkmcnt(13)
v_add_u32 v73, v43, v59
v_and_b32 v72, 0x87e, v11
v_lshl_add_u32 v73, v73, 1, s93
v_add_u32 v72, v90, v72
s_andn2_b64 exec, s[54:55], s[90:91]
ds_write_b16_d16_hi v73, v11 offset:64
ds_write_b16 v73, v72 offset:384
ds_write_b16 v73, v11 offset:704
s_mov_b64 exec, -1
s_mov_b32 s98, 2048
buffer_load_dwordx4 v[146:149], v113, s[24:27], s98 offen sc1
s_waitcnt lgkmcnt(15)
v_add_u32 v73, v44, v60
v_and_b32 v72, 0x87e, v12
v_lshl_add_u32 v73, v73, 1, s93
v_add_u32 v72, v90, v72
s_andn2_b64 exec, s[56:57], s[90:91]
ds_write_b16_d16_hi v73, v12 offset:64
ds_write_b16 v73, v72 offset:384
ds_write_b16 v73, v12 offset:704
s_mov_b64 exec, -1
buffer_load_dwordx4 a[72:75], v112, s[24:27], s99 offen offset:2048 sc1
s_waitcnt lgkmcnt(15)
v_add_u32 v73, v45, v61
v_and_b32 v72, 0x87e, v13
v_lshl_add_u32 v73, v73, 1, s93
v_add_u32 v72, v90, v72
s_andn2_b64 exec, s[58:59], s[90:91]
ds_write_b16_d16_hi v73, v13 offset:64
ds_write_b16 v73, v72 offset:384
ds_write_b16 v73, v13 offset:704
s_mov_b64 exec, -1
buffer_load_dwordx4 a[76:79], v112, s[24:27], s99 offen offset:3072 sc1
s_waitcnt lgkmcnt(15)
v_add_u32 v73, v46, v62
v_and_b32 v72, 0x87e, v14
v_lshl_add_u32 v73, v73, 1, s93
v_add_u32 v72, v90, v72
s_andn2_b64 exec, s[60:61], s[90:91]
ds_write_b16_d16_hi v73, v14 offset:64
ds_write_b16 v73, v72 offset:384
ds_write_b16 v73, v14 offset:704
s_mov_b64 exec, -1
s_mov_b32 s99, 20480
buffer_load_dwordx4 a[80:83], v112, s[24:27], s99 offen offset:0 sc1
s_waitcnt lgkmcnt(15)
v_add_u32 v73, v47, v63
v_and_b32 v72, 0x87e, v15
v_lshl_add_u32 v73, v73, 1, s93
v_add_u32 v72, v90, v72
s_andn2_b64 exec, s[62:63], s[90:91]
ds_write_b16_d16_hi v73, v15 offset:64
ds_write_b16 v73, v72 offset:384
ds_write_b16 v73, v15 offset:704
s_mov_b64 exec, -1
buffer_load_dwordx4 a[84:87], v112, s[24:27], s99 offen offset:1024 sc1
buffer_load_dwordx4 a[88:91], v112, s[24:27], s99 offen offset:2048 sc1
s_cmp_lg_u64 s[78:79], 0
s_cbranch_scc1 L_more2
L_more2b:
ds_read_u16 v8, v101 offset:704
ds_read_u16 v9, v101 offset:832
ds_read_u16 v10, v101 offset:960
ds_read2_b64 v[118:121], v102 offset0:48 offset1:52
ds_read2_b64 v[122:125], v102 offset0:56 offset1:60
ds_read2_b64 v[126:129], v102 offset0:64 offset1:68
ds_read2_b64 v[130:133], v102 offset0:72 offset1:76
ds_read2_b64 v[134:137], v102 offset0:80 offset1:84
buffer_load_dwordx4 a[92:95], v112, s[24:27], s99 offen offset:3072 sc1
s_mov_b32 s99, 24576
buffer_load_dwordx4 a[96:99], v112, s[24:27], s99 offen offset:0 sc1
buffer_load_dwordx4 a[100:103], v112, s[24:27], s99 offen offset:1024 sc1
s_waitcnt lgkmcnt(5)
v_lshrrev_b32 v72, 12, v8
v_cmp_ne_u32 vcc, 0, v8
v_min_u32 v72, 8, v72
v_add3_u32 v72, v72, v98, 0
v_lshlrev_b32 v73, 4, v72
v_lshrrev_b32 v72, 1, v72
buffer_load_dwordx4 a[104:107], v112, s[24:27], s99 offen offset:2048 sc1
v_lshlrev_b32 v73, v73, v100
v_lshl_add_u32 v72, v72, 8, v99
v_bfe_u32 v74, v8, 7, 4
v_lshl_add_u32 v72, v74, 2, v72
s_mov_b64 exec, vcc
ds_xor_b32 v72, v73 offset:1792
s_mov_b64 exec, -1
v_lshrrev_b32 v72, 12, v9
v_cmp_ne_u32 vcc, 0, v9
v_min_u32 v72, 8, v72
v_add3_u32 v72, v72, v98, 2
v_lshlrev_b32 v73, 4, v72
v_lshrrev_b32 v72, 1, v72
s_mov_b32 s98, 3072
buffer_load_dwordx4 v[150:153], v113, s[24:27], s98 offen sc1
v_lshlrev_b32 v73, v73, v100
v_lshl_add_u32 v72, v72, 8, v99
v_bfe_u32 v74, v9, 7, 4
v_lshl_add_u32 v72, v74, 2, v72
s_mov_b64 exec, vcc
ds_xor_b32 v72, v73 offset:1792
s_mov_b64 exec, -1
buffer_load_dwordx4 a[108:111], v112, s[24:27], s99 offen offset:3072 sc1
v_lshrrev_b32 v72, 12, v10
v_cmp_ne_u32 vcc, 0, v10
v_min_u32 v72, 8, v72
v_add3_u32 v72, v72, v98, 4
v_lshlrev_b32 v73, 4, v72
v_lshrrev_b32 v72, 1, v72
v_lshlrev_b32 v73, v73, v100
v_lshl_add_u32 v72, v72, 8, v99
v_bfe_u32 v74, v10, 7, 4
v_lshl_add_u32 v72, v74, 2, v72
s_mov_b64 exec, vcc
s_mov_b32 exec_hi, 0
ds_xor_b32 v72, v73 offset:1792
s_mov_b64 exec, -1
s_mov_b32 s99, 28672
buffer_load_dwordx4 a[112:115], v112, s[24:27], s99 offen offset:0 sc1
ds_read_b32 v179, v89 offset:1792
ds_read_b32 v180, v89 offset:2048
ds_read_b32 v181, v89 offset:2304
ds_read_b32 v182, v89 offset:2560
ds_read_b32 v183, v89 offset:2816
ds_read_b32 v184, v89 offset:3072
ds_read_b32 v185, v89 offset:3328
buffer_load_dwordx4 a[116:119], v112, s[24:27], s99 offen offset:1024 sc1
s_waitcnt lgkmcnt(10)
v_xor_b32 v118, v92, v118
v_xor_b32 v119, v92, v119
v_xor_b32 v120, v92, v120
v_xor_b32 v121, v92, v121
buffer_load_dwordx4 a[120:123], v112, s[24:27], s99 offen offset:2048 sc1
v_xor_b32 v122, v92, v122
v_xor_b32 v123, v92, v123
v_xor_b32 v124, v92, v124
v_xor_b32 v125, v92, v125
v_xor_b32 v126, v92, v126
v_xor_b32 v127, v92, v127
v_xor_b32 v128, v92, v128
v_xor_b32 v129, v92, v129
buffer_load_dwordx4 a[124:127], v112, s[24:27], s99 offen offset:3072 sc1
v_xor_b32 v130, v92, v130
v_xor_b32 v131, v92, v131
v_xor_b32 v132, v92, v132
v_xor_b32 v133, v92, v133
v_xor_b32 v134, v92, v134
v_xor_b32 v135, v92, v135
v_xor_b32 v136, v92, v136
v_xor_b32 v137, v92, v137
v_lshlrev_b32 v114, 16, v110
v_and_b32 v115, 0xffff0000, v110
v_lshlrev_b32 v116, 16, v111
v_and_b32 v117, 0xffff0000, v111
s_mov_b32 exec_hi, 15
ds_write_b128 v109, v[114:117] offset:1024
s_mov_b64 exec, -1
s_mov_b32 s99, 32768
buffer_load_dwordx4 a[128:131], v112, s[24:27], s99 offen offset:0 sc1
s_mov_b32 s41, 2
s_mov_b32 s42, 0
s_mov_b32 s4, 37120
s_mov_b32 s22, 75497472
s_mov_b32 s5, 18560
s_mov_b32 s6, 4718592
s_mov_b64 vcc, s[80:81]
s_andn2_b32 s12, 63, s85
s_mov_b32 s59, 6
s_mov_b32 s56, 0
s_mov_b32 s64, 384
s_bitcmp1_b32 s2, 0
s_cselect_b32 s65, 288, -1
s_add_u32 s48, s46, 9437184
s_add_u32 s49, s48, 4718592
s_add_u32 s50, s49, 4718592
s_sub_u32 s58, s7, s45
s_bfe_u32 s47, s2, 0x20004
s_mul_i32 s57, s47, 294912
s_add_u32 s57, s57, 47185920
s_lshl_b32 s47, s47, 7
s_add_u32 s47, s47, 393216
s_add_u32 s32, s24, s47
s_addc_u32 s33, s25, 0
s_cmp_eq_u32 s40, 0
s_cselect_b32 s34, 4, 0
s_cselect_b64 s[62:63], 1, 0
s_waitcnt lgkmcnt(0)
v_mov_b32 v114, 163072
s_barrier
ds_read_b32 v114, v114
ds_read_b128 v[44:47], v0 offset:0
ds_read_b128 v[48:51], v1 offset:0
s_waitcnt vmcnt(18)
ds_read_b128 v[76:79], v2 offset:1024
ds_read_b128 v[80:83], v2 offset:1088
ds_read_b128 v[84:87], v2 offset:1152
ds_read_b128 v[88:91], v2 offset:1216
ds_read_b128 v[92:95], v2 offset:1280
ds_read_b128 v[96:99], v2 offset:1344
ds_read_b128 v[100:103], v2 offset:1408
ds_read_b128 v[104:107], v2 offset:1472
ds_read_b128 v[108:111], v2 offset:1536
buffer_load_dwordx4 a[132:135], v112, s[24:27], s99 offen offset:1024 sc1
ds_read_b128 v[8:11], v2 offset:1024
ds_read_b128 v[12:15], v2 offset:1088
ds_read_b128 v[16:19], v2 offset:1152
ds_read_b128 v[20:23], v2 offset:1216
ds_read_b128 v[24:27], v2 offset:1280
ds_read_b128 v[28:31], v2 offset:1344
ds_read_b128 v[32:35], v2 offset:1408
ds_read_b128 v[36:39], v2 offset:1472
ds_read_b128 v[40:43], v2 offset:1536
buffer_load_dwordx4 a[136:139], v112, s[24:27], s99 offen offset:2048 sc1
s_waitcnt lgkmcnt(15)
v_readfirstlane_b32 s47, v114
v_add_u32_sdwa v60, s42, v118 dst_sel:DWORD dst_unused:UNUSED_PAD src0_sel:DWORD src1_sel:WORD_0
s_cmp_lg_u32 s47, 0
s_cbranch_scc1 L_slow
v_smfmac_f32_16x16x64_bf16 v[76:79], a[0:3], v[44:51], v138
ds_read_b128 v[52:55], v0 offset:18560
ds_read_b128 v[56:59], v1 offset:18560
v_add_u32_sdwa v68, s42, v118 dst_sel:DWORD dst_unused:UNUSED_PAD src0_sel:DWORD src1_sel:WORD_0
v_smfmac_f32_16x16x64_bf16 v[80:83], a[4:7], v[44:51], v138 abid:1
ds_read_u16 v68, v68 offset:18560
v_add_u32_sdwa v69, s42, v118 dst_sel:DWORD dst_unused:UNUSED_PAD src0_sel:DWORD src1_sel:WORD_1
v_smfmac_f32_16x16x64_bf16 v[84:87], a[8:11], v[44:51], v139
s_waitcnt lgkmcnt(15)
buffer_load_dwordx4 a[140:143], v112, s[24:27], s99 offen offset:3072 sc1
ds_read_u16 v69, v69 offset:18560
v_add_u32_sdwa v70, s42, v119 dst_sel:DWORD dst_unused:UNUSED_PAD src0_sel:DWORD src1_sel:WORD_0
v_smfmac_f32_16x16x64_bf16 v[88:91], a[12:15], v[44:51], v139 abid:1
ds_read_u16 v70, v70 offset:18560
v_add_u32_sdwa v71, s42, v119 dst_sel:DWORD dst_unused:UNUSED_PAD src0_sel:DWORD src1_sel:WORD_1
v_smfmac_f32_16x16x64_bf16 v[92:95], a[16:19], v[44:51], v140
ds_read_u16 v71, v71 offset:18560
v_add_u32_sdwa v72, s42, v120 dst_sel:DWORD dst_unused:UNUSED_PAD src0_sel:DWORD src1_sel:WORD_0
v_smfmac_f32_16x16x64_bf16 v[96:99], a[20:23], v[44:51], v140 abid:1
s_waitcnt lgkmcnt(15)
s_mov_b32 s98, 4096
buffer_load_dwordx4 v[154:157], v113, s[24:27], s98 offen sc1
ds_read_u16 v72, v72 offset:18560
v_add_u32_sdwa v73, s42, v120 dst_sel:DWORD dst_unused:UNUSED_PAD src0_sel:DWORD src1_sel:WORD_1
v_smfmac_f32_16x16x64_bf16 v[100:103], a[24:27], v[44:51], v141
ds_read_u16 v73, v73 offset:18560
v_add_u32_sdwa v74, s42, v121 dst_sel:DWORD dst_unused:UNUSED_PAD src0_sel:DWORD src1_sel:WORD_0
v_smfmac_f32_16x16x64_bf16 v[104:107], a[28:31], v[44:51], v141 abid:1
ds_read_u16 v74, v74 offset:18560
v_add_u32_sdwa v75, s42, v121 dst_sel:DWORD dst_unused:UNUSED_PAD src0_sel:DWORD src1_sel:WORD_1
v_smfmac_f32_16x16x64_bf16 v[108:111], a[32:35], v[44:51], v174
s_waitcnt lgkmcnt(7)
s_mov_b32 s99, 36864
buffer_load_dwordx4 a[144:147], v112, s[24:27], s99 offen offset:0 sc1
ds_read_u16 v75, v75 offset:18560
v_smfmac_f32_16x16x64_bf16 v[8:11], a[0:3], v[52:59], v138
ds_read_b128 v[114:117], v2 offset:64
v_add_u32_sdwa v60, s42, v118 dst_sel:DWORD dst_unused:UNUSED_PAD src0_sel:DWORD src1_sel:WORD_0
v_smfmac_f32_16x16x64_bf16 v[12:15], a[4:7], v[52:59], v138 abid:1
ds_read_b128 v[44:47], v0 offset:2048
v_add_u32_sdwa v61, s42, v118 dst_sel:DWORD dst_unused:UNUSED_PAD src0_sel:DWORD src1_sel:WORD_1
v_smfmac_f32_16x16x64_bf16 v[16:19], a[8:11], v[52:59], v139
buffer_load_dwordx4 a[148:151], v112, s[24:27], s99 offen offset:1024 sc1
ds_read_b128 v[48:51], v1 offset:2048
v_add_u32_sdwa v62, s42, v119 dst_sel:DWORD dst_unused:UNUSED_PAD src0_sel:DWORD src1_sel:WORD_0
v_smfmac_f32_16x16x64_bf16 v[20:23], a[12:15], v[52:59], v139 abid:1
ds_read_u16 v60, v60 offset:0
v_add_u32_sdwa v63, s42, v119 dst_sel:DWORD dst_unused:UNUSED_PAD src0_sel:DWORD src1_sel:WORD_1
v_smfmac_f32_16x16x64_bf16 v[24:27], a[16:19], v[52:59], v140
ds_read_u16 v61, v61 offset:0
v_add_u32_sdwa v64, s42, v120 dst_sel:DWORD dst_unused:UNUSED_PAD src0_sel:DWORD src1_sel:WORD_0
v_smfmac_f32_16x16x64_bf16 v[28:31], a[20:23], v[52:59], v140 abid:1
buffer_load_dwordx4 a[152:155], v112, s[24:27], s99 offen offset:2048 sc1
ds_read_u16 v62, v62 offset:0
v_add_u32_sdwa v65, s42, v120 dst_sel:DWORD dst_unused:UNUSED_PAD src0_sel:DWORD src1_sel:WORD_1
v_smfmac_f32_16x16x64_bf16 v[32:35], a[24:27], v[52:59], v141
ds_read_u16 v63, v63 offset:0
v_add_u32_sdwa v66, s42, v121 dst_sel:DWORD dst_unused:UNUSED_PAD src0_sel:DWORD src1_sel:WORD_0
v_smfmac_f32_16x16x64_bf16 v[36:39], a[28:31], v[52:59], v141 abid:1
ds_read_u16 v64, v64 offset:0
v_add_u32_sdwa v67, s42, v121 dst_sel:DWORD dst_unused:UNUSED_PAD src0_sel:DWORD src1_sel:WORD_1
v_smfmac_f32_16x16x64_bf16 v[40:43], a[32:35], v[52:59], v174
s_waitcnt lgkmcnt(7)
buffer_load_dwordx4 a[156:159], v112, s[24:27], s99 offen offset:3072 sc1
ds_read_u16 v65, v65 offset:0
v_smfmac_f32_16x16x64_bf16 v[8:11], v[114:117], v[68:75], v179
ds_read_u16 v66, v66 offset:0
v_smfmac_f32_16x16x64_bf16 v[12:15], v[114:117], v[68:75], v179 abid:1
s_waitcnt lgkmcnt(7)
ds_read_u16 v67, v67 offset:0
v_smfmac_f32_16x16x64_bf16 v[76:79], a[36:39], v[44:51], v142
s_mov_b32 s99, 40960
buffer_load_dwordx4 a[160:163], v112, s[24:27], s99 offen offset:0 sc1
ds_read_b128 v[52:55], v0 offset:20608
v_add_u32_sdwa v68, s42, v122 dst_sel:DWORD dst_unused:UNUSED_PAD src0_sel:DWORD src1_sel:WORD_0
v_smfmac_f32_16x16x64_bf16 v[80:83], a[40:43], v[44:51], v142 abid:1
ds_read_b128 v[56:59], v1 offset:20608
v_add_u32_sdwa v69, s42, v122 dst_sel:DWORD dst_unused:UNUSED_PAD src0_sel:DWORD src1_sel:WORD_1
v_smfmac_f32_16x16x64_bf16 v[84:87], a[44:47], v[44:51], v143
ds_read_u16 v68, v68 offset:18560
v_add_u32_sdwa v70, s42, v123 dst_sel:DWORD dst_unused:UNUSED_PAD src0_sel:DWORD src1_sel:WORD_0
v_smfmac_f32_16x16x64_bf16 v[88:91], a[48:51], v[44:51], v143 abid:1
buffer_load_dwordx4 a[164:167], v112, s[24:27], s99 offen offset:1024 sc1
ds_read_u16 v69, v69 offset:18560
v_add_u32_sdwa v71, s42, v123 dst_sel:DWORD dst_unused:UNUSED_PAD src0_sel:DWORD src1_sel:WORD_1
v_smfmac_f32_16x16x64_bf16 v[92:95], a[52:55], v[44:51], v144
ds_read_u16 v70, v70 offset:18560
v_add_u32_sdwa v72, s42, v124 dst_sel:DWORD dst_unused:UNUSED_PAD src0_sel:DWORD src1_sel:WORD_0
v_smfmac_f32_16x16x64_bf16 v[96:99], a[56:59], v[44:51], v144 abid:1
ds_read_u16 v71, v71 offset:18560
v_add_u32_sdwa v73, s42, v124 dst_sel:DWORD dst_unused:UNUSED_PAD src0_sel:DWORD src1_sel:WORD_1
v_smfmac_f32_16x16x64_bf16 v[100:103], a[60:63], v[44:51], v145
buffer_load_dwordx4 a[168:171], v112, s[24:27], s99 offen offset:2048 sc1
ds_read_u16 v72, v72 offset:18560
v_add_u32_sdwa v74, s42, v125 dst_sel:DWORD dst_unused:UNUSED_PAD src0_sel:DWORD src1_sel:WORD_0
v_smfmac_f32_16x16x64_bf16 v[104:107], a[64:67], v[44:51], v145 abid:1
s_waitcnt vmcnt(18)
ds_read_u16 v73, v73 offset:18560
v_add_u32_sdwa v75, s42, v125 dst_sel:DWORD dst_unused:UNUSED_PAD src0_sel:DWORD src1_sel:WORD_1
v_smfmac_f32_16x16x64_bf16 v[108:111], a[68:71], v[44:51], v174 abid:1
s_waitcnt lgkmcnt(8)
ds_read_u16 v74, v74 offset:18560
v_smfmac_f32_16x16x64_bf16 v[76:79], v[114:117], v[60:67], v179
buffer_load_dwordx4 a[172:175], v112, s[24:27], s99 offen offset:3072 sc1
ds_read_u16 v75, v75 offset:18560
v_smfmac_f32_16x16x64_bf16 v[80:83], v[114:117], v[60:67], v179 abid:1
s_waitcnt lgkmcnt(8)
v_smfmac_f32_16x16x64_bf16 v[8:11], a[36:39], v[52:59], v142
ds_read_b128 v[114:117], v2 offset:128
v_add_u32_sdwa v60, s42, v122 dst_sel:DWORD dst_unused:UNUSED_PAD src0_sel:DWORD src1_sel:WORD_0
v_smfmac_f32_16x16x64_bf16 v[12:15], a[40:43], v[52:59], v142 abid:1
s_mov_b32 s99, 45056
buffer_load_dwordx4 a[176:179], v112, s[24:27], s99 offen offset:0 sc1
ds_read_b128 v[44:47], v0 offset:4096
v_add_u32_sdwa v61, s42, v122 dst_sel:DWORD dst_unused:UNUSED_PAD src0_sel:DWORD src1_sel:WORD_1
v_smfmac_f32_16x16x64_bf16 v[16:19], a[44:47], v[52:59], v143
ds_read_b128 v[48:51], v1 offset:4096
v_add_u32_sdwa v62, s42, v123 dst_sel:DWORD dst_unused:UNUSED_PAD src0_sel:DWORD src1_sel:WORD_0
v_smfmac_f32_16x16x64_bf16 v[20:23], a[48:51], v[52:59], v143 abid:1
ds_read_u16 v60, v60 offset:0
v_add_u32_sdwa v63, s42, v123 dst_sel:DWORD dst_unused:UNUSED_PAD src0_sel:DWORD src1_sel:WORD_1
v_smfmac_f32_16x16x64_bf16 v[24:27], a[52:55], v[52:59], v144
s_mov_b32 s98, 5120
buffer_load_dwordx4 v[158:161], v113, s[24:27], s98 offen sc1
ds_read_u16 v61, v61 offset:0
v_add_u32_sdwa v64, s42, v124 dst_sel:DWORD dst_unused:UNUSED_PAD src0_sel:DWORD src1_sel:WORD_0
v_smfmac_f32_16x16x64_bf16 v[28:31], a[56:59], v[52:59], v144 abid:1
ds_read_u16 v62, v62 offset:0
v_add_u32_sdwa v65, s42, v124 dst_sel:DWORD dst_unused:UNUSED_PAD src0_sel:DWORD src1_sel:WORD_1
v_smfmac_f32_16x16x64_bf16 v[32:35], a[60:63], v[52:59], v145
ds_read_u16 v63, v63 offset:0
v_add_u32_sdwa v66, s42, v125 dst_sel:DWORD dst_unused:UNUSED_PAD src0_sel:DWORD src1_sel:WORD_0
v_smfmac_f32_16x16x64_bf16 v[36:39], a[64:67], v[52:59], v145 abid:1
buffer_load_dwordx4 a[180:183], v112, s[24:27], s99 offen offset:1024 sc1
ds_read_u16 v64, v64 offset:0
v_add_u32_sdwa v67, s42, v125 dst_sel:DWORD dst_unused:UNUSED_PAD src0_sel:DWORD src1_sel:WORD_1
v_smfmac_f32_16x16x64_bf16 v[40:43], a[68:71], v[52:59], v174 abid:1
s_waitcnt lgkmcnt(7)
ds_read_u16 v65, v65 offset:0
v_smfmac_f32_16x16x64_bf16 v[12:15], v[114:117], v[68:75], v180
ds_read_u16 v66, v66 offset:0
v_smfmac_f32_16x16x64_bf16 v[16:19], v[114:117], v[68:75], v180 abid:1
buffer_load_dwordx4 a[184:187], v112, s[24:27], s99 offen offset:2048 sc1
ds_read_u16 v67, v67 offset:0
v_smfmac_f32_16x16x64_bf16 v[20:23], v[114:117], v[68:75], v181
s_waitcnt lgkmcnt(8)
v_smfmac_f32_16x16x64_bf16 v[76:79], a[72:75], v[44:51], v146
ds_read_b128 v[52:55], v0 offset:22656
v_add_u32_sdwa v68, s42, v126 dst_sel:DWORD dst_unused:UNUSED_PAD src0_sel:DWORD src1_sel:WORD_0
v_smfmac_f32_16x16x64_bf16 v[80:83], a[76:79], v[44:51], v146 abid:1
buffer_load_dwordx4 a[188:191], v112, s[24:27], s99 offen offset:3072 sc1
ds_read_b128 v[56:59], v1 offset:22656
v_add_u32_sdwa v69, s42, v126 dst_sel:DWORD dst_unused:UNUSED_PAD src0_sel:DWORD src1_sel:WORD_1
v_smfmac_f32_16x16x64_bf16 v[84:87], a[80:83], v[44:51], v147
ds_read_u16 v68, v68 offset:18560
v_add_u32_sdwa v70, s42, v127 dst_sel:DWORD dst_unused:UNUSED_PAD src0_sel:DWORD src1_sel:WORD_0
v_smfmac_f32_16x16x64_bf16 v[88:91], a[84:87], v[44:51], v147 abid:1
ds_read_u16 v69, v69 offset:18560
v_add_u32_sdwa v71, s42, v127 dst_sel:DWORD dst_unused:UNUSED_PAD src0_sel:DWORD src1_sel:WORD_1
v_smfmac_f32_16x16x64_bf16 v[92:95], a[88:91], v[44:51], v148
s_mov_b32 s99, 49152
buffer_load_dwordx4 a[192:195], v112, s[24:27], s99 offen offset:0 sc1
ds_read_u16 v70, v70 offset:18560
v_add_u32_sdwa v72, s42, v128 dst_sel:DWORD dst_unused:UNUSED_PAD src0_sel:DWORD src1_sel:WORD_0
v_smfmac_f32_16x16x64_bf16 v[96:99], a[92:95], v[44:51], v148 abid:1
ds_read_u16 v71, v71 offset:18560
v_add_u32_sdwa v73, s42, v128 dst_sel:DWORD dst_unused:UNUSED_PAD src0_sel:DWORD src1_sel:WORD_1
v_smfmac_f32_16x16x64_bf16 v[100:103], a[96:99], v[44:51], v149
ds_read_u16 v72, v72 offset:18560
v_add_u32_sdwa v74, s42, v129 dst_sel:DWORD dst_unused:UNUSED_PAD src0_sel:DWORD src1_sel:WORD_0
v_smfmac_f32_16x16x64_bf16 v[104:107], a[100:103], v[44:51], v149 abid:1
buffer_load_dwordx4 a[196:199], v112, s[24:27], s99 offen offset:1024 sc1
ds_read_u16 v73, v73 offset:18560
v_add_u32_sdwa v75, s42, v129 dst_sel:DWORD dst_unused:UNUSED_PAD src0_sel:DWORD src1_sel:WORD_1
v_smfmac_f32_16x16x64_bf16 v[108:111], a[104:107], v[44:51], v175
s_waitcnt lgkmcnt(8)
ds_read_u16 v74, v74 offset:18560
v_smfmac_f32_16x16x64_bf16 v[80:83], v[114:117], v[60:67], v180
ds_read_u16 v75, v75 offset:18560
v_smfmac_f32_16x16x64_bf16 v[84:87], v[114:117], v[60:67], v180 abid:1
buffer_load_dwordx4 a[200:203], v112, s[24:27], s99 offen offset:2048 sc1
v_smfmac_f32_16x16x64_bf16 v[88:91], v[114:117], v[60:67], v181
s_waitcnt lgkmcnt(8)
v_smfmac_f32_16x16x64_bf16 v[8:11], a[72:75], v[52:59], v146
ds_read_b128 v[114:117], v2 offset:192
v_add_u32_sdwa v60, s42, v126 dst_sel:DWORD dst_unused:UNUSED_PAD src0_sel:DWORD src1_sel:WORD_0
v_smfmac_f32_16x16x64_bf16 v[12:15], a[76:79], v[52:59], v146 abid:1
buffer_load_dwordx4 a[204:207], v112, s[24:27], s99 offen offset:3072 sc1
ds_read_b128 v[44:47], v0 offset:6144
v_add_u32_sdwa v61, s42, v126 dst_sel:DWORD dst_unused:UNUSED_PAD src0_sel:DWORD src1_sel:WORD_1
v_smfmac_f32_16x16x64_bf16 v[16:19], a[80:83], v[52:59], v147
ds_read_b128 v[48:51], v1 offset:6144
v_add_u32_sdwa v62, s42, v127 dst_sel:DWORD dst_unused:UNUSED_PAD src0_sel:DWORD src1_sel:WORD_0
v_smfmac_f32_16x16x64_bf16 v[20:23], a[84:87], v[52:59], v147 abid:1
ds_read_u16 v60, v60 offset:0
v_add_u32_sdwa v63, s42, v127 dst_sel:DWORD dst_unused:UNUSED_PAD src0_sel:DWORD src1_sel:WORD_1
v_smfmac_f32_16x16x64_bf16 v[24:27], a[88:91], v[52:59], v148
s_mov_b32 s99, 53248
buffer_load_dwordx4 a[208:211], v112, s[24:27], s99 offen offset:0 sc1
ds_read_u16 v61, v61 offset:0
v_add_u32_sdwa v64, s42, v128 dst_sel:DWORD dst_unused:UNUSED_PAD src0_sel:DWORD src1_sel:WORD_0
v_smfmac_f32_16x16x64_bf16 v[28:31], a[92:95], v[52:59], v148 abid:1
ds_read_u16 v62, v62 offset:0
v_add_u32_sdwa v65, s42, v128 dst_sel:DWORD dst_unused:UNUSED_PAD src0_sel:DWORD src1_sel:WORD_1
v_smfmac_f32_16x16x64_bf16 v[32:35], a[96:99], v[52:59], v149
ds_read_u16 v63, v63 offset:0
v_add_u32_sdwa v66, s42, v129 dst_sel:DWORD dst_unused:UNUSED_PAD src0_sel:DWORD src1_sel:WORD_0
v_smfmac_f32_16x16x64_bf16 v[36:39], a[100:103], v[52:59], v149 abid:1
buffer_load_dwordx4 a[212:215], v112, s[24:27], s99 offen offset:1024 sc1
ds_read_u16 v64, v64 offset:0
v_add_u32_sdwa v67, s42, v129 dst_sel:DWORD dst_unused:UNUSED_PAD src0_sel:DWORD src1_sel:WORD_1
v_smfmac_f32_16x16x64_bf16 v[40:43], a[104:107], v[52:59], v175
s_waitcnt lgkmcnt(7)
ds_read_u16 v65, v65 offset:0
v_smfmac_f32_16x16x64_bf16 v[20:23], v[114:117], v[68:75], v181 abid:1
ds_read_u16 v66, v66 offset:0
v_smfmac_f32_16x16x64_bf16 v[24:27], v[114:117], v[68:75], v182
s_mov_b32 s98, 6144
buffer_load_dwordx4 v[162:165], v113, s[24:27], s98 offen sc1
ds_read_u16 v67, v67 offset:0
v_smfmac_f32_16x16x64_bf16 v[28:31], v[114:117], v[68:75], v182 abid:1
s_waitcnt vmcnt(18) lgkmcnt(8)
v_smfmac_f32_16x16x64_bf16 v[76:79], a[108:111], v[44:51], v150
ds_read_b128 v[52:55], v0 offset:24704
v_add_u32_sdwa v68, s42, v130 dst_sel:DWORD dst_unused:UNUSED_PAD src0_sel:DWORD src1_sel:WORD_0
v_smfmac_f32_16x16x64_bf16 v[80:83], a[112:115], v[44:51], v150 abid:1
buffer_load_dwordx4 a[216:219], v112, s[24:27], s99 offen offset:2048 sc1
ds_read_b128 v[56:59], v1 offset:24704
v_add_u32_sdwa v69, s42, v130 dst_sel:DWORD dst_unused:UNUSED_PAD src0_sel:DWORD src1_sel:WORD_1
v_smfmac_f32_16x16x64_bf16 v[84:87], a[116:119], v[44:51], v151
ds_read_u16 v68, v68 offset:18560
v_add_u32_sdwa v70, s42, v131 dst_sel:DWORD dst_unused:UNUSED_PAD src0_sel:DWORD src1_sel:WORD_0
v_smfmac_f32_16x16x64_bf16 v[88:91], a[120:123], v[44:51], v151 abid:1
ds_read_u16 v69, v69 offset:18560
v_add_u32_sdwa v71, s42, v131 dst_sel:DWORD dst_unused:UNUSED_PAD src0_sel:DWORD src1_sel:WORD_1
v_smfmac_f32_16x16x64_bf16 v[92:95], a[124:127], v[44:51], v152
buffer_load_dwordx4 a[220:223], v112, s[24:27], s99 offen offset:3072 sc1
ds_read_u16 v70, v70 offset:18560
v_add_u32_sdwa v72, s42, v132 dst_sel:DWORD dst_unused:UNUSED_PAD src0_sel:DWORD src1_sel:WORD_0
v_smfmac_f32_16x16x64_bf16 v[96:99], a[128:131], v[44:51], v152 abid:1
ds_read_u16 v71, v71 offset:18560
v_add_u32_sdwa v73, s42, v132 dst_sel:DWORD dst_unused:UNUSED_PAD src0_sel:DWORD src1_sel:WORD_1
v_smfmac_f32_16x16x64_bf16 v[100:103], a[132:135], v[44:51], v153
ds_read_u16 v72, v72 offset:18560
v_add_u32_sdwa v74, s42, v133 dst_sel:DWORD dst_unused:UNUSED_PAD src0_sel:DWORD src1_sel:WORD_0
v_smfmac_f32_16x16x64_bf16 v[104:107], a[136:139], v[44:51], v153 abid:1
s_mov_b32 s99, 57344
buffer_load_dwordx4 a[224:227], v112, s[24:27], s99 offen offset:0 sc1
ds_read_u16 v73, v73 offset:18560
v_add_u32_sdwa v75, s42, v133 dst_sel:DWORD dst_unused:UNUSED_PAD src0_sel:DWORD src1_sel:WORD_1
v_smfmac_f32_16x16x64_bf16 v[108:111], a[140:143], v[44:51], v175 abid:1
s_waitcnt lgkmcnt(8)
ds_read_u16 v74, v74 offset:18560
v_smfmac_f32_16x16x64_bf16 v[88:91], v[114:117], v[60:67], v181 abid:1
buffer_load_dwordx4 a[228:231], v112, s[24:27], s99 offen offset:1024 sc1
ds_read_u16 v75, v75 offset:18560
v_smfmac_f32_16x16x64_bf16 v[92:95], v[114:117], v[60:67], v182
v_smfmac_f32_16x16x64_bf16 v[96:99], v[114:117], v[60:67], v182 abid:1
s_waitcnt lgkmcnt(8)
v_smfmac_f32_16x16x64_bf16 v[8:11], a[108:111], v[52:59], v150
buffer_load_dwordx4 a[232:235], v112, s[24:27], s99 offen offset:2048 sc1
ds_read_b128 v[114:117], v2 offset:256
v_add_u32_sdwa v60, s42, v130 dst_sel:DWORD dst_unused:UNUSED_PAD src0_sel:DWORD src1_sel:WORD_0
v_smfmac_f32_16x16x64_bf16 v[12:15], a[112:115], v[52:59], v150 abid:1
ds_read_b128 v[44:47], v0 offset:8192
v_add_u32_sdwa v61, s42, v130 dst_sel:DWORD dst_unused:UNUSED_PAD src0_sel:DWORD src1_sel:WORD_1
v_smfmac_f32_16x16x64_bf16 v[16:19], a[116:119], v[52:59], v151
ds_read_b128 v[48:51], v1 offset:8192
v_add_u32_sdwa v62, s42, v131 dst_sel:DWORD dst_unused:UNUSED_PAD src0_sel:DWORD src1_sel:WORD_0
v_smfmac_f32_16x16x64_bf16 v[20:23], a[120:123], v[52:59], v151 abid:1
buffer_load_dwordx4 a[236:239], v112, s[24:27], s99 offen offset:3072 sc1
ds_read_u16 v60, v60 offset:0
v_add_u32_sdwa v63, s42, v131 dst_sel:DWORD dst_unused:UNUSED_PAD src0_sel:DWORD src1_sel:WORD_1
v_smfmac_f32_16x16x64_bf16 v[24:27], a[124:127], v[52:59], v152
ds_read_u16 v61, v61 offset:0
v_add_u32_sdwa v64, s42, v132 dst_sel:DWORD dst_unused:UNUSED_PAD src0_sel:DWORD src1_sel:WORD_0
v_smfmac_f32_16x16x64_bf16 v[28:31], a[128:131], v[52:59], v152 abid:1
ds_read_u16 v62, v62 offset:0
v_add_u32_sdwa v65, s42, v132 dst_sel:DWORD dst_unused:UNUSED_PAD src0_sel:DWORD src1_sel:WORD_1
v_smfmac_f32_16x16x64_bf16 v[32:35], a[132:135], v[52:59], v153
s_mov_b32 s99, 61440
buffer_load_dwordx4 a[240:243], v112, s[24:27], s99 offen offset:0 sc1
ds_read_u16 v63, v63 offset:0
v_add_u32_sdwa v66, s42, v133 dst_sel:DWORD dst_unused:UNUSED_PAD src0_sel:DWORD src1_sel:WORD_0
v_smfmac_f32_16x16x64_bf16 v[36:39], a[136:139], v[52:59], v153 abid:1
ds_read_u16 v64, v64 offset:0
v_add_u32_sdwa v67, s42, v133 dst_sel:DWORD dst_unused:UNUSED_PAD src0_sel:DWORD src1_sel:WORD_1
v_smfmac_f32_16x16x64_bf16 v[40:43], a[140:143], v[52:59], v175 abid:1
s_waitcnt lgkmcnt(7)
ds_read_u16 v65, v65 offset:0
v_smfmac_f32_16x16x64_bf16 v[28:31], v[114:117], v[68:75], v183
buffer_load_dwordx4 a[244:247], v112, s[24:27], s99 offen offset:1024 sc1
ds_read_u16 v66, v66 offset:0
v_smfmac_f32_16x16x64_bf16 v[32:35], v[114:117], v[68:75], v183 abid:1
ds_read_u16 v67, v67 offset:0
v_smfmac_f32_16x16x64_bf16 v[36:39], v[114:117], v[68:75], v184
s_waitcnt lgkmcnt(8)
v_smfmac_f32_16x16x64_bf16 v[76:79], a[144:147], v[44:51], v154
buffer_load_dwordx4 a[248:251], v112, s[24:27], s99 offen offset:2048 sc1
ds_read_b128 v[52:55], v0 offset:26752
v_add_u32_sdwa v68, s42, v134 dst_sel:DWORD dst_unused:UNUSED_PAD src0_sel:DWORD src1_sel:WORD_0
v_smfmac_f32_16x16x64_bf16 v[80:83], a[148:151], v[44:51], v154 abid:1
s_waitcnt vmcnt(18)
ds_read_b128 v[56:59], v1 offset:26752
v_add_u32_sdwa v69, s42, v134 dst_sel:DWORD dst_unused:UNUSED_PAD src0_sel:DWORD src1_sel:WORD_1
v_smfmac_f32_16x16x64_bf16 v[84:87], a[152:155], v[44:51], v155
ds_read_u16 v68, v68 offset:18560
v_add_u32_sdwa v70, s42, v135 dst_sel:DWORD dst_unused:UNUSED_PAD src0_sel:DWORD src1_sel:WORD_0
v_smfmac_f32_16x16x64_bf16 v[88:91], a[156:159], v[44:51], v155 abid:1
s_mov_b32 s98, 7168
buffer_load_dwordx4 v[166:169], v113, s[24:27], s98 offen sc1
ds_read_u16 v69, v69 offset:18560
v_add_u32_sdwa v71, s42, v135 dst_sel:DWORD dst_unused:UNUSED_PAD src0_sel:DWORD src1_sel:WORD_1
v_smfmac_f32_16x16x64_bf16 v[92:95], a[160:163], v[44:51], v156
ds_read_u16 v70, v70 offset:18560
v_add_u32_sdwa v72, s42, v136 dst_sel:DWORD dst_unused:UNUSED_PAD src0_sel:DWORD src1_sel:WORD_0
v_smfmac_f32_16x16x64_bf16 v[96:99], a[164:167], v[44:51], v156 abid:1
ds_read_u16 v71, v71 offset:18560
v_add_u32_sdwa v73, s42, v136 dst_sel:DWORD dst_unused:UNUSED_PAD src0_sel:DWORD src1_sel:WORD_1
v_smfmac_f32_16x16x64_bf16 v[100:103], a[168:171], v[44:51], v157
s_mov_b32 s98, 8192
buffer_load_dwordx4 v[170:173], v113, s[24:27], s98 offen sc1
ds_read_u16 v72, v72 offset:18560
v_add_u32_sdwa v74, s42, v137 dst_sel:DWORD dst_unused:UNUSED_PAD src0_sel:DWORD src1_sel:WORD_0
v_smfmac_f32_16x16x64_bf16 v[104:107], a[172:175], v[44:51], v157 abid:1
ds_read_u16 v73, v73 offset:18560
v_add_u32_sdwa v75, s42, v137 dst_sel:DWORD dst_unused:UNUSED_PAD src0_sel:DWORD src1_sel:WORD_1
v_smfmac_f32_16x16x64_bf16 v[108:111], a[176:179], v[44:51], v176
s_waitcnt lgkmcnt(8)
ds_read_u16 v74, v74 offset:18560
v_smfmac_f32_16x16x64_bf16 v[96:99], v[114:117], v[60:67], v183
s_mov_b32 s99, 69632
buffer_load_dwordx4 v[214:217], v112, s[24:27], s99 offen offset:3072 sc1
ds_read_u16 v75, v75 offset:18560
v_smfmac_f32_16x16x64_bf16 v[100:103], v[114:117], v[60:67], v183 abid:1
v_smfmac_f32_16x16x64_bf16 v[104:107], v[114:117], v[60:67], v184
s_waitcnt lgkmcnt(8)
v_smfmac_f32_16x16x64_bf16 v[8:11], a[144:147], v[52:59], v154
s_mov_b32 s99, 81920
buffer_load_dwordx4 v[250:253], v112, s[24:27], s99 offen offset:0 sc1
ds_read_b128 v[114:117], v2 offset:320
v_add_u32_sdwa v60, s42, v134 dst_sel:DWORD dst_unused:UNUSED_PAD src0_sel:DWORD src1_sel:WORD_0
v_smfmac_f32_16x16x64_bf16 v[12:15], a[148:151], v[52:59], v154 abid:1
ds_read_b128 v[44:47], v0 offset:10240
v_add_u32_sdwa v61, s42, v134 dst_sel:DWORD dst_unused:UNUSED_PAD src0_sel:DWORD src1_sel:WORD_1
v_smfmac_f32_16x16x64_bf16 v[16:19], a[152:155], v[52:59], v155
ds_read_b128 v[48:51], v1 offset:10240
v_add_u32_sdwa v62, s42, v135 dst_sel:DWORD dst_unused:UNUSED_PAD src0_sel:DWORD src1_sel:WORD_0
v_smfmac_f32_16x16x64_bf16 v[20:23], a[156:159], v[52:59], v155 abid:1
s_mov_b32 s99, 61440
buffer_load_dwordx4 a[252:255], v112, s[24:27], s99 offen offset:3072 sc1
ds_read_u16 v60, v60 offset:0
v_add_u32_sdwa v63, s42, v135 dst_sel:DWORD dst_unused:UNUSED_PAD src0_sel:DWORD src1_sel:WORD_1
v_smfmac_f32_16x16x64_bf16 v[24:27], a[160:163], v[52:59], v156
ds_read_u16 v61, v61 offset:0
v_add_u32_sdwa v64, s42, v136 dst_sel:DWORD dst_unused:UNUSED_PAD src0_sel:DWORD src1_sel:WORD_0
v_smfmac_f32_16x16x64_bf16 v[28:31], a[164:167], v[52:59], v156 abid:1
ds_read_u16 v62, v62 offset:0
v_add_u32_sdwa v65, s42, v136 dst_sel:DWORD dst_unused:UNUSED_PAD src0_sel:DWORD src1_sel:WORD_1
v_smfmac_f32_16x16x64_bf16 v[32:35], a[168:171], v[52:59], v157
s_mov_b32 s99, 73728
buffer_load_dwordx4 v[218:221], v112, s[24:27], s99 offen offset:0 sc1
ds_read_u16 v63, v63 offset:0
v_add_u32_sdwa v66, s42, v137 dst_sel:DWORD dst_unused:UNUSED_PAD src0_sel:DWORD src1_sel:WORD_0
v_smfmac_f32_16x16x64_bf16 v[36:39], a[172:175], v[52:59], v157 abid:1
ds_read_u16 v64, v64 offset:0
v_add_u32_sdwa v67, s42, v137 dst_sel:DWORD dst_unused:UNUSED_PAD src0_sel:DWORD src1_sel:WORD_1
v_smfmac_f32_16x16x64_bf16 v[40:43], a[176:179], v[52:59], v176
s_waitcnt lgkmcnt(7)
ds_read_u16 v65, v65 offset:0
v_smfmac_f32_16x16x64_bf16 v[36:39], v[114:117], v[68:75], v184 abid:1
s_mov_b32 s99, 65536
buffer_load_dwordx4 v[186:189], v112, s[24:27], s99 offen offset:0 sc1
ds_read_u16 v66, v66 offset:0
v_smfmac_f32_16x16x64_bf16 v[40:43], v[114:117], v[68:75], v185
s_waitcnt lgkmcnt(7)
ds_read_u16 v67, v67 offset:0
v_smfmac_f32_16x16x64_bf16 v[76:79], a[180:183], v[44:51], v158
s_waitcnt vmcnt(18)
ds_read_b128 v[52:55], v0 offset:28800
v_smfmac_f32_16x16x64_bf16 v[80:83], a[184:187], v[44:51], v158 abid:1
s_mov_b32 s99, 73728
buffer_load_dwordx4 v[222:225], v112, s[24:27], s99 offen offset:1024 sc1
ds_read_b128 v[56:59], v1 offset:28800
v_smfmac_f32_16x16x64_bf16 v[84:87], a[188:191], v[44:51], v159
ds_read_b128 v[68:71], v0 offset:34944
v_smfmac_f32_16x16x64_bf16 v[88:91], a[192:195], v[44:51], v159 abid:1
ds_read_b128 v[72:75], v1 offset:34944
v_smfmac_f32_16x16x64_bf16 v[92:95], a[196:199], v[44:51], v160
s_mov_b32 s99, 65536
buffer_load_dwordx4 v[190:193], v112, s[24:27], s99 offen offset:1024 sc1
v_smfmac_f32_16x16x64_bf16 v[96:99], a[200:203], v[44:51], v160 abid:1
v_smfmac_f32_16x16x64_bf16 v[100:103], a[204:207], v[44:51], v161
v_smfmac_f32_16x16x64_bf16 v[104:107], a[208:211], v[44:51], v161 abid:1
s_waitcnt vmcnt(18)
s_mov_b32 s99, 73728
buffer_load_dwordx4 v[226:229], v112, s[24:27], s99 offen offset:2048 sc1
v_smfmac_f32_16x16x64_bf16 v[108:111], a[212:215], v[44:51], v176 abid:1
s_waitcnt lgkmcnt(4)
v_smfmac_f32_16x16x64_bf16 v[104:107], v[114:117], v[60:67], v184 abid:1
v_smfmac_f32_16x16x64_bf16 v[108:111], v[114:117], v[60:67], v185
s_waitcnt lgkmcnt(2)
s_mov_b32 s99, 65536
buffer_load_dwordx4 v[194:197], v112, s[24:27], s99 offen offset:2048 sc1
v_smfmac_f32_16x16x64_bf16 v[8:11], a[180:183], v[52:59], v158
ds_read_b128 v[44:47], v0 offset:12288
v_smfmac_f32_16x16x64_bf16 v[12:15], a[184:187], v[52:59], v158 abid:1
ds_read_b128 v[48:51], v1 offset:12288
v_smfmac_f32_16x16x64_bf16 v[16:19], a[188:191], v[52:59], v159
s_mov_b32 s99, 73728
buffer_load_dwordx4 v[230:233], v112, s[24:27], s99 offen offset:3072 sc1
ds_read_b128 v[60:63], v0 offset:32896
v_smfmac_f32_16x16x64_bf16 v[20:23], a[192:195], v[52:59], v159 abid:1
ds_read_b128 v[64:67], v1 offset:32896
v_smfmac_f32_16x16x64_bf16 v[24:27], a[196:199], v[52:59], v160
v_smfmac_f32_16x16x64_bf16 v[28:31], a[200:203], v[52:59], v160 abid:1
s_mov_b32 s99, 65536
buffer_load_dwordx4 v[198:201], v112, s[24:27], s99 offen offset:3072 sc1
v_smfmac_f32_16x16x64_bf16 v[32:35], a[204:207], v[52:59], v161
v_smfmac_f32_16x16x64_bf16 v[36:39], a[208:211], v[52:59], v161 abid:1
v_smfmac_f32_16x16x64_bf16 v[40:43], a[212:215], v[52:59], v176 abid:1
s_waitcnt vmcnt(18) lgkmcnt(2)
s_mov_b32 s99, 77824
buffer_load_dwordx4 v[234:237], v112, s[24:27], s99 offen offset:0 sc1
v_smfmac_f32_16x16x64_bf16 v[76:79], a[216:219], v[44:51], v162
ds_read_b128 v[52:55], v0 offset:30848
v_smfmac_f32_16x16x64_bf16 v[80:83], a[220:223], v[44:51], v162 abid:1
ds_read_b128 v[56:59], v1 offset:30848
v_smfmac_f32_16x16x64_bf16 v[84:87], a[224:227], v[44:51], v163
s_mov_b32 s99, 69632
buffer_load_dwordx4 v[202:205], v112, s[24:27], s99 offen offset:0 sc1
v_smfmac_f32_16x16x64_bf16 v[88:91], a[228:231], v[44:51], v163 abid:1
s_waitcnt vmcnt(18)
v_smfmac_f32_16x16x64_bf16 v[92:95], a[232:235], v[44:51], v164
v_smfmac_f32_16x16x64_bf16 v[96:99], a[236:239], v[44:51], v164 abid:1
s_waitcnt vmcnt(17)
s_mov_b32 s99, 77824
buffer_load_dwordx4 v[238:241], v112, s[24:27], s99 offen offset:1024 sc1
v_smfmac_f32_16x16x64_bf16 v[100:103], a[240:243], v[44:51], v165
s_waitcnt vmcnt(17)
v_smfmac_f32_16x16x64_bf16 v[104:107], a[244:247], v[44:51], v165 abid:1
s_waitcnt vmcnt(16)
v_smfmac_f32_16x16x64_bf16 v[108:111], a[248:251], v[44:51], v177
s_waitcnt lgkmcnt(0)
s_mov_b32 s99, 69632
buffer_load_dwordx4 v[206:209], v112, s[24:27], s99 offen offset:1024 sc1
v_smfmac_f32_16x16x64_bf16 v[8:11], a[216:219], v[52:59], v162
ds_read_b128 v[44:47], v0 offset:14336
v_smfmac_f32_16x16x64_bf16 v[12:15], a[220:223], v[52:59], v162 abid:1
ds_read_b128 v[48:51], v1 offset:14336
v_smfmac_f32_16x16x64_bf16 v[16:19], a[224:227], v[52:59], v163
s_mov_b32 s99, 77824
buffer_load_dwordx4 v[242:245], v112, s[24:27], s99 offen offset:2048 sc1
v_smfmac_f32_16x16x64_bf16 v[20:23], a[228:231], v[52:59], v163 abid:1
v_smfmac_f32_16x16x64_bf16 v[24:27], a[232:235], v[52:59], v164
v_smfmac_f32_16x16x64_bf16 v[28:31], a[236:239], v[52:59], v164 abid:1
s_mov_b32 s99, 69632
buffer_load_dwordx4 v[210:213], v112, s[24:27], s99 offen offset:2048 sc1
v_smfmac_f32_16x16x64_bf16 v[32:35], a[240:243], v[52:59], v165
v_smfmac_f32_16x16x64_bf16 v[36:39], a[244:247], v[52:59], v165 abid:1
v_smfmac_f32_16x16x64_bf16 v[40:43], a[248:251], v[52:59], v177
s_mov_b32 s99, 77824
buffer_load_dwordx4 v[246:249], v112, s[24:27], s99 offen offset:3072 sc1
s_bfe_u32 s47, s85, 0x40018
s_cbranch_scc0 L_ptail0
ds_read_b128 v[52:55], v0 offset:16384
ds_read_b128 v[56:59], v1 offset:16384
s_waitcnt vmcnt(17) lgkmcnt(2)
v_smfmac_f32_16x16x64_bf16 v[108:111], v[214:217], v[44:51], v177 abid:1
s_add_u32 m0, s44, 0
s_nop 0
buffer_load_dwordx4 v3, s[16:19], s45 offen offset:0 nt lds
s_waitcnt vmcnt(17) lgkmcnt(0)
v_smfmac_f32_16x16x64_bf16 v[108:111], v[250:253], v[52:59], v178
s_add_u32 m0, s44, 3840
s_nop 0
buffer_load_dwordx4 v3, s[16:19], s45 offen offset:256 nt lds
v_add_u32 v0, 37120, v0
v_add_u32 v1, 37120, v1
s_waitcnt vmcnt(17)
v_smfmac_f32_16x16x64_bf16 v[76:79], a[252:255], v[44:51], v166
s_add_u32 m0, s44, 7680
s_nop 0
buffer_load_dwordx4 v3, s[16:19], s45 offen offset:512 nt lds
s_waitcnt vmcnt(17)
v_smfmac_f32_16x16x64_bf16 v[76:79], v[218:221], v[52:59], v170
v_cvt_pk_bf16_f32 v108, v108, v109
v_cvt_pk_bf16_f32 v109, v110, v111
ds_bpermute_b32 v108, v6, v108
ds_bpermute_b32 v109, v6, v109
s_waitcnt vmcnt(16)
v_smfmac_f32_16x16x64_bf16 v[80:83], v[186:189], v[44:51], v166 abid:1
s_add_u32 m0, s44, 11520
s_nop 0
buffer_load_dwordx4 v3, s[16:19], s45 offen offset:768 nt lds
s_waitcnt vmcnt(16)
v_smfmac_f32_16x16x64_bf16 v[80:83], v[222:225], v[52:59], v170 abid:1
s_add_u32 m0, s44, s8
s_mov_b64 exec, s[10:11]
buffer_load_dwordx4 v3, s[16:19], s7 offen offset:896 nt lds
s_mov_b64 exec, -1
s_add_u32 s7, s7, 4718592
s_add_u32 s44, s44, 18560
s_add_u32 s45, s45, 4718592
v_cvt_pk_bf16_f32 v76, v76, v77
v_cvt_pk_bf16_f32 v77, v78, v79
s_waitcnt vmcnt(16)
v_smfmac_f32_16x16x64_bf16 v[84:87], v[190:193], v[44:51], v167
s_waitcnt vmcnt(15)
v_smfmac_f32_16x16x64_bf16 v[84:87], v[226:229], v[52:59], v171
s_add_u32 m0, s44, 0
s_nop 0
buffer_load_dwordx4 v3, s[16:19], s45 offen offset:0 nt lds
v_cvt_pk_bf16_f32 v78, v80, v81
v_cvt_pk_bf16_f32 v79, v82, v83
s_waitcnt lgkmcnt(0)
buffer_store_dwordx2 v[108:109], v5, s[20:23], s46 offen
s_waitcnt vmcnt(16)
v_smfmac_f32_16x16x64_bf16 v[88:91], v[194:197], v[44:51], v167 abid:1
s_add_u32 m0, s44, 3840
s_nop 0
buffer_load_dwordx4 v3, s[16:19], s45 offen offset:256 nt lds
s_waitcnt vmcnt(16)
v_smfmac_f32_16x16x64_bf16 v[88:91], v[230:233], v[52:59], v171 abid:1
s_add_u32 m0, s44, 7680
s_nop 0
buffer_load_dwordx4 v3, s[16:19], s45 offen offset:512 nt lds
v_cvt_pk_bf16_f32 v80, v84, v85
v_cvt_pk_bf16_f32 v81, v86, v87
s_waitcnt vmcnt(16)
v_smfmac_f32_16x16x64_bf16 v[92:95], v[198:201], v[44:51], v168
s_waitcnt vmcnt(15)
v_smfmac_f32_16x16x64_bf16 v[92:95], v[234:237], v[52:59], v172
s_add_u32 m0, s44, 11520
s_nop 0
buffer_load_dwordx4 v3, s[16:19], s45 offen offset:768 nt lds
v_cvt_pk_bf16_f32 v82, v88, v89
v_cvt_pk_bf16_f32 v83, v90, v91
v_cndmask_b32_dpp v114, v80, v76, vcc quad_perm:[1,0,3,2] row_mask:0xf bank_mask:0xf
v_cndmask_b32_dpp v115, v81, v77, vcc quad_perm:[1,0,3,2] row_mask:0xf bank_mask:0xf
v_cndmask_b32_dpp v116, v82, v78, vcc quad_perm:[1,0,3,2] row_mask:0xf bank_mask:0xf
v_cndmask_b32_dpp v117, v83, v79, vcc quad_perm:[1,0,3,2] row_mask:0xf bank_mask:0xf
buffer_store_dwordx4 v[114:117], v4, s[20:23], s46 offen offset:0 sc1
s_mov_b64 vcc, s[82:83]
s_waitcnt vmcnt(16)
v_smfmac_f32_16x16x64_bf16 v[96:99], v[202:205], v[44:51], v168 abid:1
s_add_u32 m0, s44, s8
s_mov_b64 exec, s[10:11]
buffer_load_dwordx4 v3, s[16:19], s7 offen offset:896 nt lds
s_mov_b64 exec, -1
s_add_u32 s7, s7, 4718592
s_add_u32 s44, s44, 18560
s_add_u32 s45, s45, 4718592
s_waitcnt vmcnt(16)
v_smfmac_f32_16x16x64_bf16 v[96:99], v[238:241], v[52:59], v172 abid:1
v_cvt_pk_bf16_f32 v84, v92, v93
v_cvt_pk_bf16_f32 v85, v94, v95
v_cndmask_b32_dpp v80, v76, v80, vcc quad_perm:[1,0,3,2] row_mask:0xf bank_mask:0xf
v_cndmask_b32_dpp v81, v77, v81, vcc quad_perm:[1,0,3,2] row_mask:0xf bank_mask:0xf
v_cndmask_b32_dpp v82, v78, v82, vcc quad_perm:[1,0,3,2] row_mask:0xf bank_mask:0xf
v_cndmask_b32_dpp v83, v79, v83, vcc quad_perm:[1,0,3,2] row_mask:0xf bank_mask:0xf
buffer_store_dwordx4 v[80:83], v4, s[20:23], s46 offen offset:1152 sc1
s_mov_b64 vcc, s[80:81]
s_waitcnt vmcnt(16)
v_smfmac_f32_16x16x64_bf16 v[100:103], v[206:209], v[44:51], v169
s_waitcnt vmcnt(15)
v_smfmac_f32_16x16x64_bf16 v[100:103], v[242:245], v[52:59], v173
v_cvt_pk_bf16_f32 v86, v96, v97
v_cvt_pk_bf16_f32 v87, v98, v99
v_add_u32_sdwa v76, s4, v118 dst_sel:DWORD dst_unused:UNUSED_PAD src0_sel:DWORD src1_sel:WORD_0
v_add_u32_sdwa v77, s4, v118 dst_sel:DWORD dst_unused:UNUSED_PAD src0_sel:DWORD src1_sel:WORD_1
v_add_u32_sdwa v78, s4, v119 dst_sel:DWORD dst_unused:UNUSED_PAD src0_sel:DWORD src1_sel:WORD_0
v_add_u32_sdwa v79, s4, v119 dst_sel:DWORD dst_unused:UNUSED_PAD src0_sel:DWORD src1_sel:WORD_1
s_waitcnt vmcnt(14)
v_smfmac_f32_16x16x64_bf16 v[104:107], v[210:213], v[44:51], v169 abid:1
s_waitcnt vmcnt(13)
v_smfmac_f32_16x16x64_bf16 v[104:107], v[246:249], v[52:59], v173 abid:1
v_cvt_pk_bf16_f32 v88, v100, v101
v_cvt_pk_bf16_f32 v89, v102, v103
v_add_u32_sdwa v80, s4, v120 dst_sel:DWORD dst_unused:UNUSED_PAD src0_sel:DWORD src1_sel:WORD_0
v_add_u32_sdwa v81, s4, v120 dst_sel:DWORD dst_unused:UNUSED_PAD src0_sel:DWORD src1_sel:WORD_1
v_add_u32_sdwa v82, s4, v121 dst_sel:DWORD dst_unused:UNUSED_PAD src0_sel:DWORD src1_sel:WORD_0
v_add_u32_sdwa v83, s4, v121 dst_sel:DWORD dst_unused:UNUSED_PAD src0_sel:DWORD src1_sel:WORD_1
s_nop 1
v_cvt_pk_bf16_f32 v90, v104, v105
v_cvt_pk_bf16_f32 v91, v106, v107
v_cndmask_b32_dpp v92, v88, v84, vcc quad_perm:[1,0,3,2] row_mask:0xf bank_mask:0xf
v_cndmask_b32_dpp v93, v89, v85, vcc quad_perm:[1,0,3,2] row_mask:0xf bank_mask:0xf
v_cndmask_b32_dpp v94, v90, v86, vcc quad_perm:[1,0,3,2] row_mask:0xf bank_mask:0xf
v_cndmask_b32_dpp v95, v91, v87, vcc quad_perm:[1,0,3,2] row_mask:0xf bank_mask:0xf
buffer_store_dwordx4 v[92:95], v4, s[20:23], s46 offen offset:128 sc1
s_mov_b64 vcc, s[82:83]
v_cndmask_b32_dpp v88, v84, v88, vcc quad_perm:[1,0,3,2] row_mask:0xf bank_mask:0xf
v_cndmask_b32_dpp v89, v85, v89, vcc quad_perm:[1,0,3,2] row_mask:0xf bank_mask:0xf
v_cndmask_b32_dpp v90, v86, v90, vcc quad_perm:[1,0,3,2] row_mask:0xf bank_mask:0xf
v_cndmask_b32_dpp v91, v87, v91, vcc quad_perm:[1,0,3,2] row_mask:0xf bank_mask:0xf
buffer_store_dwordx4 v[88:91], v4, s[20:23], s46 offen offset:1280 sc1
s_mov_b64 vcc, s[80:81]
s_branch L_ptail1
L_ptail0:
ds_read_b128 v[52:55], v0 offset:16384
ds_read_b128 v[56:59], v1 offset:16384
s_waitcnt vmcnt(17) lgkmcnt(2)
v_smfmac_f32_16x16x64_bf16 v[108:111], v[214:217], v[44:51], v177 abid:1
s_waitcnt vmcnt(16) lgkmcnt(0)
v_smfmac_f32_16x16x64_bf16 v[108:111], v[250:253], v[52:59], v178
v_add_u32 v0, 37120, v0
v_add_u32 v1, 37120, v1
s_waitcnt vmcnt(15)
v_smfmac_f32_16x16x64_bf16 v[76:79], a[252:255], v[44:51], v166
s_waitcnt vmcnt(14)
v_smfmac_f32_16x16x64_bf16 v[76:79], v[218:221], v[52:59], v170
s_nop 1
v_cvt_pk_bf16_f32 v108, v108, v109
v_cvt_pk_bf16_f32 v109, v110, v111
ds_bpermute_b32 v108, v6, v108
ds_bpermute_b32 v109, v6, v109
s_waitcnt vmcnt(13)
v_smfmac_f32_16x16x64_bf16 v[80:83], v[186:189], v[44:51], v166 abid:1
s_waitcnt vmcnt(12)
v_smfmac_f32_16x16x64_bf16 v[80:83], v[222:225], v[52:59], v170 abid:1
v_cvt_pk_bf16_f32 v76, v76, v77
v_cvt_pk_bf16_f32 v77, v78, v79
s_waitcnt vmcnt(11)
v_smfmac_f32_16x16x64_bf16 v[84:87], v[190:193], v[44:51], v167
s_waitcnt vmcnt(10)
v_smfmac_f32_16x16x64_bf16 v[84:87], v[226:229], v[52:59], v171
s_nop 1
v_cvt_pk_bf16_f32 v78, v80, v81
v_cvt_pk_bf16_f32 v79, v82, v83
s_waitcnt lgkmcnt(0)
buffer_store_dwordx2 v[108:109], v5, s[20:23], s46 offen
s_waitcnt vmcnt(10)
v_smfmac_f32_16x16x64_bf16 v[88:91], v[194:197], v[44:51], v167 abid:1
s_waitcnt vmcnt(9)
v_smfmac_f32_16x16x64_bf16 v[88:91], v[230:233], v[52:59], v171 abid:1
v_cvt_pk_bf16_f32 v80, v84, v85
v_cvt_pk_bf16_f32 v81, v86, v87
s_waitcnt vmcnt(8)
v_smfmac_f32_16x16x64_bf16 v[92:95], v[198:201], v[44:51], v168
s_waitcnt vmcnt(7)
v_smfmac_f32_16x16x64_bf16 v[92:95], v[234:237], v[52:59], v172
s_nop 1
v_cvt_pk_bf16_f32 v82, v88, v89
v_cvt_pk_bf16_f32 v83, v90, v91
v_cndmask_b32_dpp v114, v80, v76, vcc quad_perm:[1,0,3,2] row_mask:0xf bank_mask:0xf
v_cndmask_b32_dpp v115, v81, v77, vcc quad_perm:[1,0,3,2] row_mask:0xf bank_mask:0xf
v_cndmask_b32_dpp v116, v82, v78, vcc quad_perm:[1,0,3,2] row_mask:0xf bank_mask:0xf
v_cndmask_b32_dpp v117, v83, v79, vcc quad_perm:[1,0,3,2] row_mask:0xf bank_mask:0xf
buffer_store_dwordx4 v[114:117], v4, s[20:23], s46 offen offset:0 sc1
s_mov_b64 vcc, s[82:83]
s_waitcnt vmcnt(7)
v_smfmac_f32_16x16x64_bf16 v[96:99], v[202:205], v[44:51], v168 abid:1
s_waitcnt vmcnt(6)
v_smfmac_f32_16x16x64_bf16 v[96:99], v[238:241], v[52:59], v172 abid:1
v_cvt_pk_bf16_f32 v84, v92, v93
v_cvt_pk_bf16_f32 v85, v94, v95
v_cndmask_b32_dpp v80, v76, v80, vcc quad_perm:[1,0,3,2] row_mask:0xf bank_mask:0xf
v_cndmask_b32_dpp v81, v77, v81, vcc quad_perm:[1,0,3,2] row_mask:0xf bank_mask:0xf
v_cndmask_b32_dpp v82, v78, v82, vcc quad_perm:[1,0,3,2] row_mask:0xf bank_mask:0xf
v_cndmask_b32_dpp v83, v79, v83, vcc quad_perm:[1,0,3,2] row_mask:0xf bank_mask:0xf
buffer_store_dwordx4 v[80:83], v4, s[20:23], s46 offen offset:1152 sc1
s_mov_b64 vcc, s[80:81]
s_waitcnt vmcnt(6)
v_smfmac_f32_16x16x64_bf16 v[100:103], v[206:209], v[44:51], v169
s_waitcnt vmcnt(5)
v_smfmac_f32_16x16x64_bf16 v[100:103], v[242:245], v[52:59], v173
v_cvt_pk_bf16_f32 v86, v96, v97
v_cvt_pk_bf16_f32 v87, v98, v99
v_add_u32_sdwa v76, s4, v118 dst_sel:DWORD dst_unused:UNUSED_PAD src0_sel:DWORD src1_sel:WORD_0
v_add_u32_sdwa v77, s4, v118 dst_sel:DWORD dst_unused:UNUSED_PAD src0_sel:DWORD src1_sel:WORD_1
v_add_u32_sdwa v78, s4, v119 dst_sel:DWORD dst_unused:UNUSED_PAD src0_sel:DWORD src1_sel:WORD_0
v_add_u32_sdwa v79, s4, v119 dst_sel:DWORD dst_unused:UNUSED_PAD src0_sel:DWORD src1_sel:WORD_1
s_waitcnt vmcnt(4)
v_smfmac_f32_16x16x64_bf16 v[104:107], v[210:213], v[44:51], v169 abid:1
s_waitcnt vmcnt(3)
v_smfmac_f32_16x16x64_bf16 v[104:107], v[246:249], v[52:59], v173 abid:1
v_cvt_pk_bf16_f32 v88, v100, v101
v_cvt_pk_bf16_f32 v89, v102, v103
v_add_u32_sdwa v80, s4, v120 dst_sel:DWORD dst_unused:UNUSED_PAD src0_sel:DWORD src1_sel:WORD_0
v_add_u32_sdwa v81, s4, v120 dst_sel:DWORD dst_unused:UNUSED_PAD src0_sel:DWORD src1_sel:WORD_1
v_add_u32_sdwa v82, s4, v121 dst_sel:DWORD dst_unused:UNUSED_PAD src0_sel:DWORD src1_sel:WORD_0
v_add_u32_sdwa v83, s4, v121 dst_sel:DWORD dst_unused:UNUSED_PAD src0_sel:DWORD src1_sel:WORD_1
s_nop 1
v_cvt_pk_bf16_f32 v90, v104, v105
v_cvt_pk_bf16_f32 v91, v106, v107
v_cndmask_b32_dpp v92, v88, v84, vcc quad_perm:[1,0,3,2] row_mask:0xf bank_mask:0xf
v_cndmask_b32_dpp v93, v89, v85, vcc quad_perm:[1,0,3,2] row_mask:0xf bank_mask:0xf
v_cndmask_b32_dpp v94, v90, v86, vcc quad_perm:[1,0,3,2] row_mask:0xf bank_mask:0xf
v_cndmask_b32_dpp v95, v91, v87, vcc quad_perm:[1,0,3,2] row_mask:0xf bank_mask:0xf
buffer_store_dwordx4 v[92:95], v4, s[20:23], s46 offen offset:128 sc1
s_mov_b64 vcc, s[82:83]
v_cndmask_b32_dpp v88, v84, v88, vcc quad_perm:[1,0,3,2] row_mask:0xf bank_mask:0xf
v_cndmask_b32_dpp v89, v85, v89, vcc quad_perm:[1,0,3,2] row_mask:0xf bank_mask:0xf
v_cndmask_b32_dpp v90, v86, v90, vcc quad_perm:[1,0,3,2] row_mask:0xf bank_mask:0xf
v_cndmask_b32_dpp v91, v87, v91, vcc quad_perm:[1,0,3,2] row_mask:0xf bank_mask:0xf
buffer_store_dwordx4 v[88:91], v4, s[20:23], s46 offen offset:1280 sc1
s_mov_b64 vcc, s[80:81]
L_ptail1:
s_cmp_ge_u32 s44, 148480
s_cselect_b32 s44, s9, s44
s_add_u32 s46, s46, 4718592
s_waitcnt lgkmcnt(0)
s_barrier
s_cmp_lg_u32 s89, 0
s_cbranch_scc1 L_loopnk_p3
s_branch L_loopn_p3
.p2align 6
L_loop:
v_smfmac_f32_16x16x64_bf16 v[8:11], a[0:3], v[44:51], v138
ds_read_b128 v[32:35], v2 offset:1408
v_cvt_pk_bf16_f32 v106, v36, v37
v_smfmac_f32_16x16x64_bf16 v[8:11], a[36:39], v[52:59], v142
s_waitcnt lgkmcnt(9)
v_cvt_pk_bf16_f32 v107, v38, v39
v_smfmac_f32_16x16x64_bf16 v[12:15], a[4:7], v[44:51], v138 abid:1
ds_read_b128 v[36:39], v2 offset:1472
v_cvt_pk_bf16_f32 v112, v40, v41
v_smfmac_f32_16x16x64_bf16 v[12:15], a[40:43], v[52:59], v142 abid:1
s_waitcnt lgkmcnt(8)
ds_read_b128 v[60:63], v0 offset:4096
v_cvt_pk_bf16_f32 v113, v42, v43
v_smfmac_f32_16x16x64_bf16 v[16:19], a[8:11], v[44:51], v139
s_cmp_eq_u32 s4, 129920
ds_read_b128 v[40:43], v2 offset:1536
v_cndmask_b32_dpp v108, v96, v92, vcc quad_perm:[1,0,3,2] row_mask:0xf bank_mask:0xf
v_smfmac_f32_16x16x64_bf16 v[16:19], a[44:47], v[52:59], v143
s_waitcnt lgkmcnt(8)
ds_read_u16 v82, v82
v_cndmask_b32_dpp v109, v97, v93, vcc quad_perm:[1,0,3,2] row_mask:0xf bank_mask:0xf
v_smfmac_f32_16x16x64_bf16 v[20:23], a[12:15], v[44:51], v139 abid:1
s_cselect_b32 s43, -129920, s5
ds_read_u16 v84, v84
v_cndmask_b32_dpp v110, v98, v94, vcc quad_perm:[1,0,3,2] row_mask:0xf bank_mask:0xf
v_smfmac_f32_16x16x64_bf16 v[20:23], a[48:51], v[52:59], v143 abid:1
s_waitcnt lgkmcnt(8)
ds_read_b128 v[64:67], v1 offset:4096
v_cndmask_b32_dpp v111, v99, v95, vcc quad_perm:[1,0,3,2] row_mask:0xf bank_mask:0xf
v_smfmac_f32_16x16x64_bf16 v[24:27], a[16:19], v[44:51], v140
s_add_u32 s4, s4, s43
ds_read_b128 v[68:71], v0 offset:6144
v_add_u32_sdwa v87, s42, v123 dst_sel:DWORD dst_unused:UNUSED_PAD src0_sel:DWORD src1_sel:WORD_1
v_smfmac_f32_16x16x64_bf16 v[24:27], a[52:55], v[52:59], v144
buffer_store_dwordx4 v[108:111], v4, s[20:23], s46 offen offset:0 sc1
s_mov_b64 vcc, s[82:83]
s_waitcnt lgkmcnt(8)
ds_read_b128 v[72:75], v1 offset:6144
v_cndmask_b32_dpp v96, v92, v96, vcc quad_perm:[1,0,3,2] row_mask:0xf bank_mask:0xf
v_cndmask_b32_dpp v97, v93, v97, vcc quad_perm:[1,0,3,2] row_mask:0xf bank_mask:0xf
v_smfmac_f32_16x16x64_bf16 v[28:31], a[20:23], v[44:51], v140 abid:1
s_add_u32 s41, s41, 1
ds_read_u16 v83, v83
v_cndmask_b32_dpp v98, v94, v98, vcc quad_perm:[1,0,3,2] row_mask:0xf bank_mask:0xf
v_smfmac_f32_16x16x64_bf16 v[28:31], a[56:59], v[52:59], v144 abid:1
s_waitcnt lgkmcnt(9)
ds_read_b128 v[114:117], v2 offset:64
v_cndmask_b32_dpp v99, v95, v99, vcc quad_perm:[1,0,3,2] row_mask:0xf bank_mask:0xf
v_smfmac_f32_16x16x64_bf16 v[32:35], a[24:27], v[44:51], v141
ds_read_u16 v85, v85
v_add_u32_sdwa v88, s42, v124 dst_sel:DWORD dst_unused:UNUSED_PAD src0_sel:DWORD src1_sel:WORD_0
v_smfmac_f32_16x16x64_bf16 v[32:35], a[60:63], v[52:59], v145
s_waitcnt lgkmcnt(10)
ds_read_u16 v86, v86
v_add_u32_sdwa v89, s42, v124 dst_sel:DWORD dst_unused:UNUSED_PAD src0_sel:DWORD src1_sel:WORD_1
v_smfmac_f32_16x16x64_bf16 v[36:39], a[28:31], v[44:51], v141 abid:1
ds_read_u16 v87, v87
v_add_u32_sdwa v90, s42, v125 dst_sel:DWORD dst_unused:UNUSED_PAD src0_sel:DWORD src1_sel:WORD_0
v_smfmac_f32_16x16x64_bf16 v[36:39], a[64:67], v[52:59], v145 abid:1
s_waitcnt lgkmcnt(10)
ds_read_u16 v88, v88
v_add_u32_sdwa v91, s42, v125 dst_sel:DWORD dst_unused:UNUSED_PAD src0_sel:DWORD src1_sel:WORD_1
v_smfmac_f32_16x16x64_bf16 v[40:43], a[32:35], v[44:51], v174
buffer_store_dwordx4 v[96:99], v4, s[20:23], s46 offen offset:1152 sc1
s_mov_b64 vcc, s[80:81]
ds_read_u16 v89, v89
v_cndmask_b32_dpp v92, v104, v100, vcc quad_perm:[1,0,3,2] row_mask:0xf bank_mask:0xf
v_cndmask_b32_dpp v93, v105, v101, vcc quad_perm:[1,0,3,2] row_mask:0xf bank_mask:0xf
v_smfmac_f32_16x16x64_bf16 v[40:43], a[68:71], v[52:59], v174 abid:1
s_waitcnt lgkmcnt(9)
ds_read_u16 v90, v90
v_cndmask_b32_dpp v94, v106, v102, vcc quad_perm:[1,0,3,2] row_mask:0xf bank_mask:0xf
v_smfmac_f32_16x16x64_bf16 v[8:11], a[72:75], v[60:67], v146
s_waitcnt lgkmcnt(8)
ds_read_u16 v91, v91
v_cndmask_b32_dpp v95, v107, v103, vcc quad_perm:[1,0,3,2] row_mask:0xf bank_mask:0xf
v_smfmac_f32_16x16x64_bf16 v[8:11], a[108:111], v[68:75], v150
s_waitcnt lgkmcnt(7)
ds_bpermute_b32 v112, v6, v112
v_smfmac_f32_16x16x64_bf16 v[8:11], v[114:117], v[76:83], v179
s_waitcnt vmcnt(2)
ds_bpermute_b32 v113, v6, v113
v_smfmac_f32_16x16x64_bf16 v[12:15], v[114:117], v[76:83], v179 abid:1
ds_read_b128 v[114:117], v2 offset:128
v_add_u32_sdwa v76, s42, v126 dst_sel:DWORD dst_unused:UNUSED_PAD src0_sel:DWORD src1_sel:WORD_0
v_smfmac_f32_16x16x64_bf16 v[12:15], a[76:79], v[60:67], v146 abid:1
ds_read_u16 v76, v76
v_add_u32_sdwa v77, s42, v126 dst_sel:DWORD dst_unused:UNUSED_PAD src0_sel:DWORD src1_sel:WORD_1
v_smfmac_f32_16x16x64_bf16 v[12:15], a[112:115], v[68:75], v150 abid:1
buffer_store_dwordx4 v[92:95], v4, s[20:23], s46 offen offset:128 sc1
s_mov_b64 vcc, s[82:83]
ds_read_u16 v77, v77
v_cndmask_b32_dpp v104, v100, v104, vcc quad_perm:[1,0,3,2] row_mask:0xf bank_mask:0xf
v_add_u32_sdwa v78, s42, v127 dst_sel:DWORD dst_unused:UNUSED_PAD src0_sel:DWORD src1_sel:WORD_0
v_smfmac_f32_16x16x64_bf16 v[24:27], a[88:91], v[60:67], v148
ds_read_u16 v78, v78
v_cndmask_b32_dpp v105, v101, v105, vcc quad_perm:[1,0,3,2] row_mask:0xf bank_mask:0xf
v_smfmac_f32_16x16x64_bf16 v[24:27], a[124:127], v[68:75], v152
ds_read_b128 v[44:47], v0 offset:8192
v_cndmask_b32_dpp v106, v102, v106, vcc quad_perm:[1,0,3,2] row_mask:0xf bank_mask:0xf
v_smfmac_f32_16x16x64_bf16 v[28:31], a[92:95], v[60:67], v148 abid:1
ds_read_b128 v[48:51], v1 offset:8192
v_add_u32_sdwa v79, s42, v127 dst_sel:DWORD dst_unused:UNUSED_PAD src0_sel:DWORD src1_sel:WORD_1
v_smfmac_f32_16x16x64_bf16 v[28:31], a[128:131], v[68:75], v152 abid:1
ds_read_u16 v79, v79
v_cndmask_b32_dpp v107, v103, v107, vcc quad_perm:[1,0,3,2] row_mask:0xf bank_mask:0xf
v_smfmac_f32_16x16x64_bf16 v[32:35], a[96:99], v[60:67], v149
ds_read_b128 v[52:55], v0 offset:10240
v_add_u32_sdwa v80, s42, v128 dst_sel:DWORD dst_unused:UNUSED_PAD src0_sel:DWORD src1_sel:WORD_0
v_smfmac_f32_16x16x64_bf16 v[32:35], a[132:135], v[68:75], v153
ds_read_u16 v80, v80
v_add_u32_sdwa v81, s42, v128 dst_sel:DWORD dst_unused:UNUSED_PAD src0_sel:DWORD src1_sel:WORD_1
v_smfmac_f32_16x16x64_bf16 v[16:19], a[80:83], v[60:67], v147
buffer_store_dwordx4 v[104:107], v4, s[20:23], s46 offen offset:1280 sc1
s_mov_b64 vcc, s[80:81]
ds_read_b128 v[56:59], v1 offset:10240
v_add_u32_sdwa v82, s42, v129 dst_sel:DWORD dst_unused:UNUSED_PAD src0_sel:DWORD src1_sel:WORD_0
v_add_u32_sdwa v83, s42, v129 dst_sel:DWORD dst_unused:UNUSED_PAD src0_sel:DWORD src1_sel:WORD_1
v_smfmac_f32_16x16x64_bf16 v[16:19], a[116:119], v[68:75], v151
s_waitcnt lgkmcnt(9)
ds_read_b128 v[92:95], v0 offset:12288
v_add_u32_sdwa v100, s42, v130 dst_sel:DWORD dst_unused:UNUSED_PAD src0_sel:DWORD src1_sel:WORD_0
v_smfmac_f32_16x16x64_bf16 v[16:19], v[114:117], v[84:91], v180 abid:1
ds_read_u16 v81, v81
v_add_u32_sdwa v101, s42, v130 dst_sel:DWORD dst_unused:UNUSED_PAD src0_sel:DWORD src1_sel:WORD_1
v_smfmac_f32_16x16x64_bf16 v[20:23], v[114:117], v[84:91], v181
ds_read_b128 v[96:99], v1 offset:12288
v_add_u32_sdwa v102, s42, v131 dst_sel:DWORD dst_unused:UNUSED_PAD src0_sel:DWORD src1_sel:WORD_0
v_smfmac_f32_16x16x64_bf16 v[20:23], a[84:87], v[60:67], v147 abid:1
ds_read_u16 v100, v100
v_add_u32_sdwa v103, s42, v131 dst_sel:DWORD dst_unused:UNUSED_PAD src0_sel:DWORD src1_sel:WORD_1
v_smfmac_f32_16x16x64_bf16 v[20:23], a[120:123], v[68:75], v151 abid:1
ds_read_u16 v82, v82
v_add_u32_sdwa v104, s42, v132 dst_sel:DWORD dst_unused:UNUSED_PAD src0_sel:DWORD src1_sel:WORD_0
v_smfmac_f32_16x16x64_bf16 v[36:39], a[100:103], v[60:67], v149 abid:1
ds_read_u16 v101, v101
v_add_u32_sdwa v105, s42, v132 dst_sel:DWORD dst_unused:UNUSED_PAD src0_sel:DWORD src1_sel:WORD_1
v_smfmac_f32_16x16x64_bf16 v[36:39], a[136:139], v[68:75], v153 abid:1
buffer_store_dwordx2 v[112:113], v5, s[20:23], s46 offen
ds_read_u16 v83, v83
v_add_u32_sdwa v106, s42, v133 dst_sel:DWORD dst_unused:UNUSED_PAD src0_sel:DWORD src1_sel:WORD_0
v_smfmac_f32_16x16x64_bf16 v[40:43], a[104:107], v[60:67], v175
s_mov_b32 s22, 75497472
ds_read_b128 v[114:117], v2 offset:192
v_add_u32_sdwa v107, s42, v133 dst_sel:DWORD dst_unused:UNUSED_PAD src0_sel:DWORD src1_sel:WORD_1
v_smfmac_f32_16x16x64_bf16 v[40:43], a[140:143], v[68:75], v175 abid:1
s_waitcnt lgkmcnt(12)
ds_read_u16 v102, v102
v_add_u32_sdwa v84, s42, v134 dst_sel:DWORD dst_unused:UNUSED_PAD src0_sel:DWORD src1_sel:WORD_0
v_smfmac_f32_16x16x64_bf16 v[8:11], a[144:147], v[44:51], v154
s_waitcnt lgkmcnt(9)
ds_read_u16 v103, v103
v_add_u32_sdwa v85, s42, v134 dst_sel:DWORD dst_unused:UNUSED_PAD src0_sel:DWORD src1_sel:WORD_1
v_smfmac_f32_16x16x64_bf16 v[8:11], a[180:183], v[52:59], v158
s_waitcnt lgkmcnt(7)
ds_read_u16 v104, v104
v_add_u32_sdwa v86, s42, v135 dst_sel:DWORD dst_unused:UNUSED_PAD src0_sel:DWORD src1_sel:WORD_0
v_smfmac_f32_16x16x64_bf16 v[8:11], a[216:219], v[92:99], v162
s_mov_b32 s46, s48
ds_read_u16 v105, v105
v_add_u32_sdwa v87, s42, v135 dst_sel:DWORD dst_unused:UNUSED_PAD src0_sel:DWORD src1_sel:WORD_1
v_smfmac_f32_16x16x64_bf16 v[24:27], a[160:163], v[44:51], v156
s_add_u32 m0, s44, 0
ds_read_u16 v106, v106
v_add_u32_sdwa v88, s42, v136 dst_sel:DWORD dst_unused:UNUSED_PAD src0_sel:DWORD src1_sel:WORD_0
v_smfmac_f32_16x16x64_bf16 v[24:27], a[196:199], v[52:59], v160
buffer_load_dwordx4 v3, s[16:19], s45 offen offset:0 nt lds
v_add_u32_sdwa v89, s42, v136 dst_sel:DWORD dst_unused:UNUSED_PAD src0_sel:DWORD src1_sel:WORD_1
v_smfmac_f32_16x16x64_bf16 v[24:27], a[232:235], v[92:99], v164
s_waitcnt lgkmcnt(5)
ds_read_u16 v107, v107
v_add_u32_sdwa v90, s42, v137 dst_sel:DWORD dst_unused:UNUSED_PAD src0_sel:DWORD src1_sel:WORD_0
v_smfmac_f32_16x16x64_bf16 v[24:27], v[114:117], v[76:83], v182
s_mov_b32 s48, s49
ds_read_u16 v84, v84
v_add_u32_sdwa v91, s42, v137 dst_sel:DWORD dst_unused:UNUSED_PAD src0_sel:DWORD src1_sel:WORD_1
v_smfmac_f32_16x16x64_bf16 v[28:31], v[114:117], v[76:83], v182 abid:1
s_mov_b32 s49, s50
ds_read_b128 v[114:117], v2 offset:256
v_add_u32_sdwa v76, s4, v118 dst_sel:DWORD dst_unused:UNUSED_PAD src0_sel:DWORD src1_sel:WORD_0
v_smfmac_f32_16x16x64_bf16 v[28:31], a[164:167], v[44:51], v156 abid:1
s_add_u32 s50, s50, 4718592
ds_read_u16 v85, v85
v_add_u32_sdwa v77, s4, v118 dst_sel:DWORD dst_unused:UNUSED_PAD src0_sel:DWORD src1_sel:WORD_1
v_smfmac_f32_16x16x64_bf16 v[28:31], a[200:203], v[52:59], v160 abid:1
ds_read_u16 v86, v86
v_add_u32_sdwa v78, s4, v119 dst_sel:DWORD dst_unused:UNUSED_PAD src0_sel:DWORD src1_sel:WORD_0
v_smfmac_f32_16x16x64_bf16 v[28:31], a[236:239], v[92:99], v164 abid:1
ds_read_u16 v87, v87
v_add_u32_sdwa v79, s4, v119 dst_sel:DWORD dst_unused:UNUSED_PAD src0_sel:DWORD src1_sel:WORD_1
v_smfmac_f32_16x16x64_bf16 v[12:15], a[148:151], v[44:51], v154 abid:1
s_add_u32 m0, s44, 3840
ds_read_u16 v88, v88
v_add_u32_sdwa v80, s4, v120 dst_sel:DWORD dst_unused:UNUSED_PAD src0_sel:DWORD src1_sel:WORD_0
v_smfmac_f32_16x16x64_bf16 v[12:15], a[184:187], v[52:59], v158 abid:1
buffer_load_dwordx4 v3, s[16:19], s45 offen offset:256 nt lds
v_add_u32_sdwa v81, s4, v120 dst_sel:DWORD dst_unused:UNUSED_PAD src0_sel:DWORD src1_sel:WORD_1
v_smfmac_f32_16x16x64_bf16 v[12:15], a[220:223], v[92:99], v162 abid:1
ds_read_b128 v[60:63], v0 offset:14336
v_add_u32_sdwa v82, s4, v121 dst_sel:DWORD dst_unused:UNUSED_PAD src0_sel:DWORD src1_sel:WORD_0
v_smfmac_f32_16x16x64_bf16 v[32:35], a[168:171], v[44:51], v157
ds_read_u16 v89, v89
v_add_u32_sdwa v83, s4, v121 dst_sel:DWORD dst_unused:UNUSED_PAD src0_sel:DWORD src1_sel:WORD_1
v_smfmac_f32_16x16x64_bf16 v[32:35], a[204:207], v[52:59], v161
ds_read_b128 v[64:67], v1 offset:14336
v_smfmac_f32_16x16x64_bf16 v[32:35], a[240:243], v[92:99], v165
s_waitcnt lgkmcnt(7)
ds_read_b128 v[68:71], v0 offset:16384
v_smfmac_f32_16x16x64_bf16 v[32:35], v[114:117], v[100:107], v183 abid:1
ds_read_u16 v90, v90
v_smfmac_f32_16x16x64_bf16 v[36:39], v[114:117], v[100:107], v184
ds_read_b128 v[72:75], v1 offset:16384
v_add_u32 v0, s43, v0
v_smfmac_f32_16x16x64_bf16 v[36:39], a[172:175], v[44:51], v157 abid:1
s_add_u32 m0, s44, 7680
ds_read_u16 v91, v91
v_add_u32 v1, s43, v1
v_smfmac_f32_16x16x64_bf16 v[36:39], a[208:211], v[52:59], v161 abid:1
buffer_load_dwordx4 v3, s[16:19], s45 offen offset:512 nt lds
v_smfmac_f32_16x16x64_bf16 v[36:39], a[244:247], v[92:99], v165 abid:1
ds_read_b128 v[114:117], v2 offset:320
v_smfmac_f32_16x16x64_bf16 v[16:19], a[152:155], v[44:51], v155
s_add_u32 m0, s44, 11520
v_smfmac_f32_16x16x64_bf16 v[16:19], a[188:191], v[52:59], v159
buffer_load_dwordx4 v3, s[16:19], s45 offen offset:768 nt lds
v_smfmac_f32_16x16x64_bf16 v[16:19], a[224:227], v[92:99], v163
v_smfmac_f32_16x16x64_bf16 v[20:23], a[156:159], v[44:51], v155 abid:1
s_add_u32 m0, s44, s8
v_smfmac_f32_16x16x64_bf16 v[20:23], a[192:195], v[52:59], v159 abid:1
s_mov_b64 exec, s[10:11]
buffer_load_dwordx4 v3, s[16:19], s7 offen offset:896 nt lds
s_mov_b64 exec, -1
v_smfmac_f32_16x16x64_bf16 v[20:23], a[228:231], v[92:99], v163 abid:1
s_add_u32 s45, s45, 4718592
s_add_u32 s7, s7, 4718592
s_add_u32 s44, s44, s5
v_smfmac_f32_16x16x64_bf16 v[40:43], a[176:179], v[44:51], v176
s_cmp_ge_u32 s44, 148480
s_cselect_b32 s44, s9, s44
s_bitcmp1_b32 s92, s41
v_smfmac_f32_16x16x64_bf16 v[40:43], a[212:215], v[52:59], v176 abid:1
s_cbranch_scc1 L_loop_w
L_loop_wb:
v_smfmac_f32_16x16x64_bf16 v[40:43], a[248:251], v[92:99], v177
s_waitcnt lgkmcnt(0)
v_smfmac_f32_16x16x64_bf16 v[40:43], v[114:117], v[84:91], v185
s_waitcnt vmcnt(20)
s_barrier
v_smfmac_f32_16x16x64_bf16 v[8:11], a[252:255], v[60:67], v166
s_mov_b32 s42, s4
v_smfmac_f32_16x16x64_bf16 v[8:11], v[218:221], v[68:75], v170
ds_read_b128 v[44:47], v0 offset:0
v_add_u32_sdwa v84, s42, v122 dst_sel:DWORD dst_unused:UNUSED_PAD src0_sel:DWORD src1_sel:WORD_0
v_smfmac_f32_16x16x64_bf16 v[12:15], v[186:189], v[60:67], v166 abid:1
ds_read_b128 v[48:51], v1 offset:0
v_add_u32_sdwa v85, s42, v122 dst_sel:DWORD dst_unused:UNUSED_PAD src0_sel:DWORD src1_sel:WORD_1
v_smfmac_f32_16x16x64_bf16 v[12:15], v[222:225], v[68:75], v170 abid:1
ds_read_b128 v[52:55], v0 offset:2048
v_add_u32_sdwa v86, s42, v123 dst_sel:DWORD dst_unused:UNUSED_PAD src0_sel:DWORD src1_sel:WORD_0
v_smfmac_f32_16x16x64_bf16 v[16:19], v[190:193], v[60:67], v167
ds_read_b128 v[56:59], v1 offset:2048
v_cvt_pk_bf16_f32 v92, v8, v9
v_smfmac_f32_16x16x64_bf16 v[16:19], v[226:229], v[68:75], v171
ds_read_u16 v76, v76
v_cvt_pk_bf16_f32 v93, v10, v11
v_smfmac_f32_16x16x64_bf16 v[20:23], v[194:197], v[60:67], v167 abid:1
ds_read_b128 v[8:11], v2 offset:1024
v_cvt_pk_bf16_f32 v94, v12, v13
v_smfmac_f32_16x16x64_bf16 v[20:23], v[230:233], v[68:75], v171 abid:1
ds_read_u16 v77, v77
v_cvt_pk_bf16_f32 v95, v14, v15
v_smfmac_f32_16x16x64_bf16 v[24:27], v[198:201], v[60:67], v168
ds_read_b128 v[12:15], v2 offset:1088
v_cvt_pk_bf16_f32 v96, v16, v17
v_smfmac_f32_16x16x64_bf16 v[24:27], v[234:237], v[68:75], v172
ds_read_u16 v78, v78
v_cvt_pk_bf16_f32 v97, v18, v19
v_smfmac_f32_16x16x64_bf16 v[28:31], v[202:205], v[60:67], v168 abid:1
ds_read_b128 v[16:19], v2 offset:1152
v_cvt_pk_bf16_f32 v98, v20, v21
v_smfmac_f32_16x16x64_bf16 v[28:31], v[238:241], v[68:75], v172 abid:1
ds_read_u16 v79, v79
v_cvt_pk_bf16_f32 v99, v22, v23
v_smfmac_f32_16x16x64_bf16 v[32:35], v[206:209], v[60:67], v169
ds_read_b128 v[20:23], v2 offset:1216
v_cvt_pk_bf16_f32 v100, v24, v25
v_smfmac_f32_16x16x64_bf16 v[32:35], v[242:245], v[68:75], v173
ds_read_u16 v80, v80
v_cvt_pk_bf16_f32 v101, v26, v27
v_smfmac_f32_16x16x64_bf16 v[36:39], v[210:213], v[60:67], v169 abid:1
ds_read_b128 v[24:27], v2 offset:1280
v_cvt_pk_bf16_f32 v102, v28, v29
v_smfmac_f32_16x16x64_bf16 v[36:39], v[246:249], v[68:75], v173 abid:1
ds_read_u16 v81, v81
v_cvt_pk_bf16_f32 v103, v30, v31
v_smfmac_f32_16x16x64_bf16 v[40:43], v[214:217], v[60:67], v177 abid:1
s_bitcmp1_b32 s85, s41
ds_read_b128 v[28:31], v2 offset:1344
v_cvt_pk_bf16_f32 v104, v32, v33
v_smfmac_f32_16x16x64_bf16 v[40:43], v[250:253], v[68:75], v178
s_waitcnt lgkmcnt(10)
v_cvt_pk_bf16_f32 v105, v34, v35
s_cbranch_scc1 L_loop
s_cmp_lg_u32 s41, 6
s_cbranch_scc1 L_loopn
.p2align 3
L_loopc:
v_smfmac_f32_16x16x64_bf16 v[8:11], a[0:3], v[44:51], v138
s_cmp_lt_u32 s56, s65
s_cselect_b32 s34, s34, 0
s_cselect_b32 s64, s64, 0
ds_read_b128 v[32:35], v2 offset:1408
v_cvt_pk_bf16_f32 v106, v36, v37
v_mov_b32 v7, 1
v_smfmac_f32_16x16x64_bf16 v[8:11], a[36:39], v[52:59], v142
s_waitcnt lgkmcnt(9)
buffer_atomic_add v7, v6, s[32:35], 0 offen sc0 sc1
v_cvt_pk_bf16_f32 v107, v38, v39
v_smfmac_f32_16x16x64_bf16 v[12:15], a[4:7], v[44:51], v138 abid:1
ds_read_b128 v[36:39], v2 offset:1472
v_cvt_pk_bf16_f32 v112, v40, v41
v_smfmac_f32_16x16x64_bf16 v[12:15], a[40:43], v[52:59], v142 abid:1
s_waitcnt lgkmcnt(8)
ds_read_b128 v[60:63], v0 offset:4096
v_cvt_pk_bf16_f32 v113, v42, v43
v_smfmac_f32_16x16x64_bf16 v[16:19], a[8:11], v[44:51], v139
s_cmp_eq_u32 s4, 129920
ds_read_b128 v[40:43], v2 offset:1536
v_cndmask_b32_dpp v108, v96, v92, vcc quad_perm:[1,0,3,2] row_mask:0xf bank_mask:0xf
v_smfmac_f32_16x16x64_bf16 v[16:19], a[44:47], v[52:59], v143
s_waitcnt lgkmcnt(8)
ds_read_u16 v82, v82
v_cndmask_b32_dpp v109, v97, v93, vcc quad_perm:[1,0,3,2] row_mask:0xf bank_mask:0xf
v_smfmac_f32_16x16x64_bf16 v[20:23], a[12:15], v[44:51], v139 abid:1
s_cselect_b32 s43, -129920, s5
ds_read_u16 v84, v84
v_cndmask_b32_dpp v110, v98, v94, vcc quad_perm:[1,0,3,2] row_mask:0xf bank_mask:0xf
v_smfmac_f32_16x16x64_bf16 v[20:23], a[48:51], v[52:59], v143 abid:1
s_waitcnt lgkmcnt(8)
ds_read_b128 v[64:67], v1 offset:4096
v_cndmask_b32_dpp v111, v99, v95, vcc quad_perm:[1,0,3,2] row_mask:0xf bank_mask:0xf
v_smfmac_f32_16x16x64_bf16 v[24:27], a[16:19], v[44:51], v140
s_add_u32 s4, s4, s43
ds_read_b128 v[68:71], v0 offset:6144
v_add_u32_sdwa v87, s42, v123 dst_sel:DWORD dst_unused:UNUSED_PAD src0_sel:DWORD src1_sel:WORD_1
v_smfmac_f32_16x16x64_bf16 v[24:27], a[52:55], v[52:59], v144
buffer_store_dwordx4 v[108:111], v4, s[20:23], s46 offen offset:0 sc1
s_mov_b64 vcc, s[82:83]
s_waitcnt lgkmcnt(8)
ds_read_b128 v[72:75], v1 offset:6144
v_cndmask_b32_dpp v96, v92, v96, vcc quad_perm:[1,0,3,2] row_mask:0xf bank_mask:0xf
v_cndmask_b32_dpp v97, v93, v97, vcc quad_perm:[1,0,3,2] row_mask:0xf bank_mask:0xf
v_smfmac_f32_16x16x64_bf16 v[28:31], a[20:23], v[44:51], v140 abid:1
s_add_u32 s7, s45, s58
ds_read_u16 v83, v83
v_cndmask_b32_dpp v98, v94, v98, vcc quad_perm:[1,0,3,2] row_mask:0xf bank_mask:0xf
v_smfmac_f32_16x16x64_bf16 v[28:31], a[56:59], v[52:59], v144 abid:1
s_waitcnt lgkmcnt(9)
ds_read_b128 v[114:117], v2 offset:64
v_cndmask_b32_dpp v99, v95, v99, vcc quad_perm:[1,0,3,2] row_mask:0xf bank_mask:0xf
v_smfmac_f32_16x16x64_bf16 v[32:35], a[24:27], v[44:51], v141
ds_read_u16 v85, v85
v_add_u32_sdwa v88, s42, v124 dst_sel:DWORD dst_unused:UNUSED_PAD src0_sel:DWORD src1_sel:WORD_0
v_smfmac_f32_16x16x64_bf16 v[32:35], a[60:63], v[52:59], v145
s_waitcnt lgkmcnt(10)
ds_read_u16 v86, v86
v_add_u32_sdwa v89, s42, v124 dst_sel:DWORD dst_unused:UNUSED_PAD src0_sel:DWORD src1_sel:WORD_1
v_smfmac_f32_16x16x64_bf16 v[36:39], a[28:31], v[44:51], v141 abid:1
ds_read_u16 v87, v87
v_add_u32_sdwa v90, s42, v125 dst_sel:DWORD dst_unused:UNUSED_PAD src0_sel:DWORD src1_sel:WORD_0
v_smfmac_f32_16x16x64_bf16 v[36:39], a[64:67], v[52:59], v145 abid:1
s_waitcnt lgkmcnt(10)
ds_read_u16 v88, v88
v_add_u32_sdwa v91, s42, v125 dst_sel:DWORD dst_unused:UNUSED_PAD src0_sel:DWORD src1_sel:WORD_1
v_smfmac_f32_16x16x64_bf16 v[40:43], a[32:35], v[44:51], v174
buffer_store_dwordx4 v[96:99], v4, s[20:23], s46 offen offset:1152 sc1
s_mov_b64 vcc, s[80:81]
ds_read_u16 v89, v89
v_cndmask_b32_dpp v92, v104, v100, vcc quad_perm:[1,0,3,2] row_mask:0xf bank_mask:0xf
v_cndmask_b32_dpp v93, v105, v101, vcc quad_perm:[1,0,3,2] row_mask:0xf bank_mask:0xf
v_smfmac_f32_16x16x64_bf16 v[40:43], a[68:71], v[52:59], v174 abid:1
s_waitcnt lgkmcnt(9)
ds_read_u16 v90, v90
v_cndmask_b32_dpp v94, v106, v102, vcc quad_perm:[1,0,3,2] row_mask:0xf bank_mask:0xf
v_smfmac_f32_16x16x64_bf16 v[8:11], a[72:75], v[60:67], v146
s_waitcnt lgkmcnt(8)
ds_read_u16 v91, v91
v_cndmask_b32_dpp v95, v107, v103, vcc quad_perm:[1,0,3,2] row_mask:0xf bank_mask:0xf
v_smfmac_f32_16x16x64_bf16 v[8:11], a[108:111], v[68:75], v150
s_waitcnt lgkmcnt(7)
ds_bpermute_b32 v112, v6, v112
v_smfmac_f32_16x16x64_bf16 v[8:11], v[114:117], v[76:83], v179
ds_bpermute_b32 v113, v6, v113
v_smfmac_f32_16x16x64_bf16 v[12:15], v[114:117], v[76:83], v179 abid:1
ds_read_b128 v[114:117], v2 offset:128
v_add_u32_sdwa v76, s42, v126 dst_sel:DWORD dst_unused:UNUSED_PAD src0_sel:DWORD src1_sel:WORD_0
v_smfmac_f32_16x16x64_bf16 v[12:15], a[76:79], v[60:67], v146 abid:1
ds_read_u16 v76, v76
v_add_u32_sdwa v77, s42, v126 dst_sel:DWORD dst_unused:UNUSED_PAD src0_sel:DWORD src1_sel:WORD_1
v_smfmac_f32_16x16x64_bf16 v[12:15], a[112:115], v[68:75], v150 abid:1
buffer_store_dwordx4 v[92:95], v4, s[20:23], s46 offen offset:128 sc1
s_mov_b64 vcc, s[82:83]
ds_read_u16 v77, v77
v_cndmask_b32_dpp v104, v100, v104, vcc quad_perm:[1,0,3,2] row_mask:0xf bank_mask:0xf
v_add_u32_sdwa v78, s42, v127 dst_sel:DWORD dst_unused:UNUSED_PAD src0_sel:DWORD src1_sel:WORD_0
v_smfmac_f32_16x16x64_bf16 v[24:27], a[88:91], v[60:67], v148
ds_read_u16 v78, v78
v_cndmask_b32_dpp v105, v101, v105, vcc quad_perm:[1,0,3,2] row_mask:0xf bank_mask:0xf
v_smfmac_f32_16x16x64_bf16 v[24:27], a[124:127], v[68:75], v152
ds_read_b128 v[44:47], v0 offset:8192
v_cndmask_b32_dpp v106, v102, v106, vcc quad_perm:[1,0,3,2] row_mask:0xf bank_mask:0xf
v_smfmac_f32_16x16x64_bf16 v[28:31], a[92:95], v[60:67], v148 abid:1
ds_read_b128 v[48:51], v1 offset:8192
v_add_u32_sdwa v79, s42, v127 dst_sel:DWORD dst_unused:UNUSED_PAD src0_sel:DWORD src1_sel:WORD_1
v_smfmac_f32_16x16x64_bf16 v[28:31], a[128:131], v[68:75], v152 abid:1
ds_read_u16 v79, v79
v_cndmask_b32_dpp v107, v103, v107, vcc quad_perm:[1,0,3,2] row_mask:0xf bank_mask:0xf
v_smfmac_f32_16x16x64_bf16 v[32:35], a[96:99], v[60:67], v149
ds_read_b128 v[52:55], v0 offset:10240
v_add_u32_sdwa v80, s42, v128 dst_sel:DWORD dst_unused:UNUSED_PAD src0_sel:DWORD src1_sel:WORD_0
v_smfmac_f32_16x16x64_bf16 v[32:35], a[132:135], v[68:75], v153
ds_read_u16 v80, v80
v_add_u32_sdwa v81, s42, v128 dst_sel:DWORD dst_unused:UNUSED_PAD src0_sel:DWORD src1_sel:WORD_1
v_smfmac_f32_16x16x64_bf16 v[16:19], a[80:83], v[60:67], v147
buffer_store_dwordx4 v[104:107], v4, s[20:23], s46 offen offset:1280 sc1
s_mov_b64 vcc, s[80:81]
ds_read_b128 v[56:59], v1 offset:10240
v_add_u32_sdwa v82, s42, v129 dst_sel:DWORD dst_unused:UNUSED_PAD src0_sel:DWORD src1_sel:WORD_0
v_add_u32_sdwa v83, s42, v129 dst_sel:DWORD dst_unused:UNUSED_PAD src0_sel:DWORD src1_sel:WORD_1
v_smfmac_f32_16x16x64_bf16 v[16:19], a[116:119], v[68:75], v151
s_waitcnt lgkmcnt(9)
ds_read_b128 v[92:95], v0 offset:12288
v_add_u32_sdwa v100, s42, v130 dst_sel:DWORD dst_unused:UNUSED_PAD src0_sel:DWORD src1_sel:WORD_0
v_smfmac_f32_16x16x64_bf16 v[16:19], v[114:117], v[84:91], v180 abid:1
ds_read_u16 v81, v81
v_add_u32_sdwa v101, s42, v130 dst_sel:DWORD dst_unused:UNUSED_PAD src0_sel:DWORD src1_sel:WORD_1
v_smfmac_f32_16x16x64_bf16 v[20:23], v[114:117], v[84:91], v181
ds_read_b128 v[96:99], v1 offset:12288
v_add_u32_sdwa v102, s42, v131 dst_sel:DWORD dst_unused:UNUSED_PAD src0_sel:DWORD src1_sel:WORD_0
v_smfmac_f32_16x16x64_bf16 v[20:23], a[84:87], v[60:67], v147 abid:1
ds_read_u16 v100, v100
v_add_u32_sdwa v103, s42, v131 dst_sel:DWORD dst_unused:UNUSED_PAD src0_sel:DWORD src1_sel:WORD_1
v_smfmac_f32_16x16x64_bf16 v[20:23], a[120:123], v[68:75], v151 abid:1
ds_read_u16 v82, v82
v_add_u32_sdwa v104, s42, v132 dst_sel:DWORD dst_unused:UNUSED_PAD src0_sel:DWORD src1_sel:WORD_0
v_smfmac_f32_16x16x64_bf16 v[36:39], a[100:103], v[60:67], v149 abid:1
ds_read_u16 v101, v101
v_add_u32_sdwa v105, s42, v132 dst_sel:DWORD dst_unused:UNUSED_PAD src0_sel:DWORD src1_sel:WORD_1
v_smfmac_f32_16x16x64_bf16 v[36:39], a[136:139], v[68:75], v153 abid:1
buffer_store_dwordx2 v[112:113], v5, s[20:23], s46 offen
ds_read_u16 v83, v83
v_add_u32_sdwa v106, s42, v133 dst_sel:DWORD dst_unused:UNUSED_PAD src0_sel:DWORD src1_sel:WORD_0
v_smfmac_f32_16x16x64_bf16 v[40:43], a[104:107], v[60:67], v175
s_mov_b32 s46, s48
ds_read_b128 v[114:117], v2 offset:192
v_add_u32_sdwa v107, s42, v133 dst_sel:DWORD dst_unused:UNUSED_PAD src0_sel:DWORD src1_sel:WORD_1
v_smfmac_f32_16x16x64_bf16 v[40:43], a[140:143], v[68:75], v175 abid:1
s_waitcnt lgkmcnt(12)
ds_read_u16 v102, v102
v_add_u32_sdwa v84, s42, v134 dst_sel:DWORD dst_unused:UNUSED_PAD src0_sel:DWORD src1_sel:WORD_0
v_smfmac_f32_16x16x64_bf16 v[8:11], a[144:147], v[44:51], v154
s_waitcnt lgkmcnt(9)
ds_read_u16 v103, v103
v_add_u32_sdwa v85, s42, v134 dst_sel:DWORD dst_unused:UNUSED_PAD src0_sel:DWORD src1_sel:WORD_1
v_smfmac_f32_16x16x64_bf16 v[8:11], a[180:183], v[52:59], v158
s_waitcnt lgkmcnt(7)
ds_read_u16 v104, v104
v_add_u32_sdwa v86, s42, v135 dst_sel:DWORD dst_unused:UNUSED_PAD src0_sel:DWORD src1_sel:WORD_0
v_smfmac_f32_16x16x64_bf16 v[8:11], a[216:219], v[92:99], v162
s_mov_b32 s48, s49
ds_read_u16 v105, v105
v_add_u32_sdwa v87, s42, v135 dst_sel:DWORD dst_unused:UNUSED_PAD src0_sel:DWORD src1_sel:WORD_1
v_smfmac_f32_16x16x64_bf16 v[24:27], a[160:163], v[44:51], v156
s_add_u32 m0, s44, 0
ds_read_u16 v106, v106
v_add_u32_sdwa v88, s42, v136 dst_sel:DWORD dst_unused:UNUSED_PAD src0_sel:DWORD src1_sel:WORD_0
v_smfmac_f32_16x16x64_bf16 v[24:27], a[196:199], v[52:59], v160
buffer_load_dwordx4 v3, s[16:19], s45 offen offset:0 nt lds
v_add_u32_sdwa v89, s42, v136 dst_sel:DWORD dst_unused:UNUSED_PAD src0_sel:DWORD src1_sel:WORD_1
v_smfmac_f32_16x16x64_bf16 v[24:27], a[232:235], v[92:99], v164
s_waitcnt lgkmcnt(5)
ds_read_u16 v107, v107
v_add_u32_sdwa v90, s42, v137 dst_sel:DWORD dst_unused:UNUSED_PAD src0_sel:DWORD src1_sel:WORD_0
v_smfmac_f32_16x16x64_bf16 v[24:27], v[114:117], v[76:83], v182
s_waitcnt vmcnt(6)
ds_read_u16 v84, v84
v_add_u32_sdwa v91, s42, v137 dst_sel:DWORD dst_unused:UNUSED_PAD src0_sel:DWORD src1_sel:WORD_1
v_smfmac_f32_16x16x64_bf16 v[28:31], v[114:117], v[76:83], v182 abid:1
s_mov_b32 s49, s50
ds_read_b128 v[114:117], v2 offset:256
v_add_u32_sdwa v76, s4, v118 dst_sel:DWORD dst_unused:UNUSED_PAD src0_sel:DWORD src1_sel:WORD_0
v_smfmac_f32_16x16x64_bf16 v[28:31], a[164:167], v[44:51], v156 abid:1
s_mov_b32 s50, s45
ds_read_u16 v85, v85
v_add_u32_sdwa v77, s4, v118 dst_sel:DWORD dst_unused:UNUSED_PAD src0_sel:DWORD src1_sel:WORD_1
v_smfmac_f32_16x16x64_bf16 v[28:31], a[200:203], v[52:59], v160 abid:1
ds_read_u16 v86, v86
v_add_u32_sdwa v78, s4, v119 dst_sel:DWORD dst_unused:UNUSED_PAD src0_sel:DWORD src1_sel:WORD_0
v_smfmac_f32_16x16x64_bf16 v[28:31], a[236:239], v[92:99], v164 abid:1
ds_read_u16 v87, v87
v_add_u32_sdwa v79, s4, v119 dst_sel:DWORD dst_unused:UNUSED_PAD src0_sel:DWORD src1_sel:WORD_1
v_smfmac_f32_16x16x64_bf16 v[12:15], a[148:151], v[44:51], v154 abid:1
s_add_u32 m0, s44, 3840
ds_read_u16 v88, v88
v_add_u32_sdwa v80, s4, v120 dst_sel:DWORD dst_unused:UNUSED_PAD src0_sel:DWORD src1_sel:WORD_0
v_smfmac_f32_16x16x64_bf16 v[12:15], a[184:187], v[52:59], v158 abid:1
buffer_load_dwordx4 v3, s[16:19], s45 offen offset:256 nt lds
v_add_u32_sdwa v81, s4, v120 dst_sel:DWORD dst_unused:UNUSED_PAD src0_sel:DWORD src1_sel:WORD_1
v_smfmac_f32_16x16x64_bf16 v[12:15], a[220:223], v[92:99], v162 abid:1
ds_read_b128 v[60:63], v0 offset:14336
v_add_u32_sdwa v82, s4, v121 dst_sel:DWORD dst_unused:UNUSED_PAD src0_sel:DWORD src1_sel:WORD_0
v_smfmac_f32_16x16x64_bf16 v[32:35], a[168:171], v[44:51], v157
ds_read_u16 v89, v89
v_add_u32_sdwa v83, s4, v121 dst_sel:DWORD dst_unused:UNUSED_PAD src0_sel:DWORD src1_sel:WORD_1
v_smfmac_f32_16x16x64_bf16 v[32:35], a[204:207], v[52:59], v161
ds_read_b128 v[64:67], v1 offset:14336
v_smfmac_f32_16x16x64_bf16 v[32:35], a[240:243], v[92:99], v165
s_waitcnt lgkmcnt(7)
ds_read_b128 v[68:71], v0 offset:16384
v_smfmac_f32_16x16x64_bf16 v[32:35], v[114:117], v[100:107], v183 abid:1
ds_read_u16 v90, v90
v_smfmac_f32_16x16x64_bf16 v[36:39], v[114:117], v[100:107], v184
ds_read_b128 v[72:75], v1 offset:16384
v_add_u32 v0, s43, v0
v_smfmac_f32_16x16x64_bf16 v[36:39], a[172:175], v[44:51], v157 abid:1
s_add_u32 m0, s44, 7680
ds_read_u16 v91, v91
v_add_u32 v1, s43, v1
v_smfmac_f32_16x16x64_bf16 v[36:39], a[208:211], v[52:59], v161 abid:1
buffer_load_dwordx4 v3, s[16:19], s45 offen offset:512 nt lds
v_smfmac_f32_16x16x64_bf16 v[36:39], a[244:247], v[92:99], v165 abid:1
ds_read_b128 v[114:117], v2 offset:320
v_smfmac_f32_16x16x64_bf16 v[16:19], a[152:155], v[44:51], v155
s_add_u32 m0, s44, 11520
v_smfmac_f32_16x16x64_bf16 v[16:19], a[188:191], v[52:59], v159
buffer_load_dwordx4 v3, s[16:19], s45 offen offset:768 nt lds
v_smfmac_f32_16x16x64_bf16 v[16:19], a[224:227], v[92:99], v163
s_mov_b64 exec, s[62:63]
ds_write_b32 v0, v7 offset:18432
s_mov_b64 exec, -1
v_smfmac_f32_16x16x64_bf16 v[20:23], a[156:159], v[44:51], v155 abid:1
s_add_u32 m0, s44, s8
v_smfmac_f32_16x16x64_bf16 v[20:23], a[192:195], v[52:59], v159 abid:1
s_mov_b64 exec, s[10:11]
buffer_load_dwordx4 v3, s[16:19], s7 offen offset:896 nt lds
s_mov_b64 exec, -1
v_smfmac_f32_16x16x64_bf16 v[20:23], a[228:231], v[92:99], v163 abid:1
s_add_u32 s44, s44, s5
s_cmp_ge_u32 s44, 148480
s_cselect_b32 s44, s9, s44
v_smfmac_f32_16x16x64_bf16 v[40:43], a[176:179], v[44:51], v176
v_smfmac_f32_16x16x64_bf16 v[40:43], a[212:215], v[52:59], v176 abid:1
v_smfmac_f32_16x16x64_bf16 v[40:43], a[248:251], v[92:99], v177
s_waitcnt lgkmcnt(0)
v_smfmac_f32_16x16x64_bf16 v[40:43], v[114:117], v[84:91], v185
s_barrier
v_smfmac_f32_16x16x64_bf16 v[8:11], a[252:255], v[60:67], v166
s_mov_b32 s42, s4
ds_read_b32 v7, v0 offset:18432
v_smfmac_f32_16x16x64_bf16 v[8:11], v[218:221], v[68:75], v170
ds_read_b128 v[44:47], v0 offset:0
v_add_u32_sdwa v84, s42, v122 dst_sel:DWORD dst_unused:UNUSED_PAD src0_sel:DWORD src1_sel:WORD_0
v_smfmac_f32_16x16x64_bf16 v[12:15], v[186:189], v[60:67], v166 abid:1
ds_read_b128 v[48:51], v1 offset:0
v_add_u32_sdwa v85, s42, v122 dst_sel:DWORD dst_unused:UNUSED_PAD src0_sel:DWORD src1_sel:WORD_1
v_smfmac_f32_16x16x64_bf16 v[12:15], v[222:225], v[68:75], v170 abid:1
ds_read_b128 v[52:55], v0 offset:2048
v_add_u32_sdwa v86, s42, v123 dst_sel:DWORD dst_unused:UNUSED_PAD src0_sel:DWORD src1_sel:WORD_0
v_smfmac_f32_16x16x64_bf16 v[16:19], v[190:193], v[60:67], v167
ds_read_b128 v[56:59], v1 offset:2048
v_cvt_pk_bf16_f32 v92, v8, v9
v_smfmac_f32_16x16x64_bf16 v[16:19], v[226:229], v[68:75], v171
ds_read_u16 v76, v76
v_cvt_pk_bf16_f32 v93, v10, v11
v_smfmac_f32_16x16x64_bf16 v[20:23], v[194:197], v[60:67], v167 abid:1
ds_read_b128 v[8:11], v2 offset:1024
v_cvt_pk_bf16_f32 v94, v12, v13
v_smfmac_f32_16x16x64_bf16 v[20:23], v[230:233], v[68:75], v171 abid:1
ds_read_u16 v77, v77
v_cvt_pk_bf16_f32 v95, v14, v15
v_smfmac_f32_16x16x64_bf16 v[24:27], v[198:201], v[60:67], v168
ds_read_b128 v[12:15], v2 offset:1088
v_cvt_pk_bf16_f32 v96, v16, v17
v_smfmac_f32_16x16x64_bf16 v[24:27], v[234:237], v[68:75], v172
s_waitcnt lgkmcnt(8)
ds_read_u16 v78, v78
v_cvt_pk_bf16_f32 v97, v18, v19
v_readfirstlane_b32 s56, v7
v_smfmac_f32_16x16x64_bf16 v[28:31], v[202:205], v[60:67], v168 abid:1
s_lshr_b32 s60, s56, 4
ds_read_b128 v[16:19], v2 offset:1152
v_cvt_pk_bf16_f32 v98, v20, v21
v_smfmac_f32_16x16x64_bf16 v[28:31], v[238:241], v[68:75], v172 abid:1
s_mul_i32 s60, s60, 884736
ds_read_u16 v79, v79
v_cvt_pk_bf16_f32 v99, v22, v23
v_smfmac_f32_16x16x64_bf16 v[32:35], v[206:209], v[60:67], v169
s_mul_i32 s61, s56, 18432
ds_read_b128 v[20:23], v2 offset:1216
v_cvt_pk_bf16_f32 v100, v24, v25
v_smfmac_f32_16x16x64_bf16 v[32:35], v[242:245], v[68:75], v173
s_add_u32 s60, s60, s57
ds_read_u16 v80, v80
v_cvt_pk_bf16_f32 v101, v26, v27
v_smfmac_f32_16x16x64_bf16 v[36:39], v[210:213], v[60:67], v169 abid:1
s_add_u32 s45, s60, s61
ds_read_b128 v[24:27], v2 offset:1280
v_cvt_pk_bf16_f32 v102, v28, v29
v_smfmac_f32_16x16x64_bf16 v[36:39], v[246:249], v[68:75], v173 abid:1
ds_read_u16 v81, v81
v_cvt_pk_bf16_f32 v103, v30, v31
v_smfmac_f32_16x16x64_bf16 v[40:43], v[214:217], v[60:67], v177 abid:1
s_cmp_lt_u32 s56, s64
ds_read_b128 v[28:31], v2 offset:1344
v_cvt_pk_bf16_f32 v104, v32, v33
v_smfmac_f32_16x16x64_bf16 v[40:43], v[250:253], v[68:75], v178
s_waitcnt lgkmcnt(10)
v_cvt_pk_bf16_f32 v105, v34, v35
s_cbranch_scc1 L_loopc
s_mov_b32 s41, 0
s_mov_b32 s15, 3
s_mov_b32 s12, 7
s_mov_b32 s92, 4
s_mov_b32 s87, 4
s_mov_b32 s59, -1
.p2align 3
L_loopn:
v_smfmac_f32_16x16x64_bf16 v[8:11], a[0:3], v[44:51], v138
ds_read_b128 v[32:35], v2 offset:1408
v_cvt_pk_bf16_f32 v106, v36, v37
v_smfmac_f32_16x16x64_bf16 v[8:11], a[36:39], v[52:59], v142
s_waitcnt lgkmcnt(9)
v_cvt_pk_bf16_f32 v107, v38, v39
v_smfmac_f32_16x16x64_bf16 v[12:15], a[4:7], v[44:51], v138 abid:1
ds_read_b128 v[36:39], v2 offset:1472
v_cvt_pk_bf16_f32 v112, v40, v41
v_smfmac_f32_16x16x64_bf16 v[12:15], a[40:43], v[52:59], v142 abid:1
s_waitcnt lgkmcnt(8)
ds_read_b128 v[60:63], v0 offset:4096
v_cvt_pk_bf16_f32 v113, v42, v43
v_smfmac_f32_16x16x64_bf16 v[16:19], a[8:11], v[44:51], v139
s_cmp_eq_u32 s4, 129920
ds_read_b128 v[40:43], v2 offset:1536
v_cndmask_b32_dpp v108, v96, v92, vcc quad_perm:[1,0,3,2] row_mask:0xf bank_mask:0xf
v_smfmac_f32_16x16x64_bf16 v[16:19], a[44:47], v[52:59], v143
s_waitcnt lgkmcnt(8)
ds_read_u16 v82, v82
v_cndmask_b32_dpp v109, v97, v93, vcc quad_perm:[1,0,3,2] row_mask:0xf bank_mask:0xf
v_smfmac_f32_16x16x64_bf16 v[20:23], a[12:15], v[44:51], v139 abid:1
s_cselect_b32 s43, -129920, s5
ds_read_u16 v84, v84
v_cndmask_b32_dpp v110, v98, v94, vcc quad_perm:[1,0,3,2] row_mask:0xf bank_mask:0xf
v_smfmac_f32_16x16x64_bf16 v[20:23], a[48:51], v[52:59], v143 abid:1
s_waitcnt lgkmcnt(8)
ds_read_b128 v[64:67], v1 offset:4096
v_cndmask_b32_dpp v111, v99, v95, vcc quad_perm:[1,0,3,2] row_mask:0xf bank_mask:0xf
v_smfmac_f32_16x16x64_bf16 v[24:27], a[16:19], v[44:51], v140
s_add_u32 s4, s4, s43
ds_read_b128 v[68:71], v0 offset:6144
v_add_u32_sdwa v87, s42, v123 dst_sel:DWORD dst_unused:UNUSED_PAD src0_sel:DWORD src1_sel:WORD_1
v_smfmac_f32_16x16x64_bf16 v[24:27], a[52:55], v[52:59], v144
buffer_store_dwordx4 v[108:111], v4, s[20:23], s46 offen offset:0 sc1
s_mov_b64 vcc, s[82:83]
s_waitcnt lgkmcnt(8)
ds_read_b128 v[72:75], v1 offset:6144
v_cndmask_b32_dpp v96, v92, v96, vcc quad_perm:[1,0,3,2] row_mask:0xf bank_mask:0xf
v_cndmask_b32_dpp v97, v93, v97, vcc quad_perm:[1,0,3,2] row_mask:0xf bank_mask:0xf
v_smfmac_f32_16x16x64_bf16 v[28:31], a[20:23], v[44:51], v140 abid:1
s_add_u32 s41, s41, 1
ds_read_u16 v83, v83
v_cndmask_b32_dpp v98, v94, v98, vcc quad_perm:[1,0,3,2] row_mask:0xf bank_mask:0xf
v_smfmac_f32_16x16x64_bf16 v[28:31], a[56:59], v[52:59], v144 abid:1
s_waitcnt lgkmcnt(9)
ds_read_b128 v[114:117], v2 offset:64
v_cndmask_b32_dpp v99, v95, v99, vcc quad_perm:[1,0,3,2] row_mask:0xf bank_mask:0xf
v_smfmac_f32_16x16x64_bf16 v[32:35], a[24:27], v[44:51], v141
ds_read_u16 v85, v85
v_add_u32_sdwa v88, s42, v124 dst_sel:DWORD dst_unused:UNUSED_PAD src0_sel:DWORD src1_sel:WORD_0
v_smfmac_f32_16x16x64_bf16 v[32:35], a[60:63], v[52:59], v145
s_waitcnt lgkmcnt(10)
ds_read_u16 v86, v86
v_add_u32_sdwa v89, s42, v124 dst_sel:DWORD dst_unused:UNUSED_PAD src0_sel:DWORD src1_sel:WORD_1
v_smfmac_f32_16x16x64_bf16 v[36:39], a[28:31], v[44:51], v141 abid:1
ds_read_u16 v87, v87
v_add_u32_sdwa v90, s42, v125 dst_sel:DWORD dst_unused:UNUSED_PAD src0_sel:DWORD src1_sel:WORD_0
v_smfmac_f32_16x16x64_bf16 v[36:39], a[64:67], v[52:59], v145 abid:1
s_waitcnt lgkmcnt(10)
ds_read_u16 v88, v88
v_add_u32_sdwa v91, s42, v125 dst_sel:DWORD dst_unused:UNUSED_PAD src0_sel:DWORD src1_sel:WORD_1
v_smfmac_f32_16x16x64_bf16 v[40:43], a[32:35], v[44:51], v174
buffer_store_dwordx4 v[96:99], v4, s[20:23], s46 offen offset:1152 sc1
s_mov_b64 vcc, s[80:81]
ds_read_u16 v89, v89
v_cndmask_b32_dpp v92, v104, v100, vcc quad_perm:[1,0,3,2] row_mask:0xf bank_mask:0xf
v_cndmask_b32_dpp v93, v105, v101, vcc quad_perm:[1,0,3,2] row_mask:0xf bank_mask:0xf
v_smfmac_f32_16x16x64_bf16 v[40:43], a[68:71], v[52:59], v174 abid:1
s_waitcnt lgkmcnt(9)
ds_read_u16 v90, v90
v_cndmask_b32_dpp v94, v106, v102, vcc quad_perm:[1,0,3,2] row_mask:0xf bank_mask:0xf
v_smfmac_f32_16x16x64_bf16 v[8:11], a[72:75], v[60:67], v146
s_waitcnt lgkmcnt(8)
ds_read_u16 v91, v91
v_cndmask_b32_dpp v95, v107, v103, vcc quad_perm:[1,0,3,2] row_mask:0xf bank_mask:0xf
v_smfmac_f32_16x16x64_bf16 v[8:11], a[108:111], v[68:75], v150
s_waitcnt lgkmcnt(7)
ds_bpermute_b32 v112, v6, v112
v_smfmac_f32_16x16x64_bf16 v[8:11], v[114:117], v[76:83], v179
ds_bpermute_b32 v113, v6, v113
v_smfmac_f32_16x16x64_bf16 v[12:15], v[114:117], v[76:83], v179 abid:1
ds_read_b128 v[114:117], v2 offset:128
v_add_u32_sdwa v76, s42, v126 dst_sel:DWORD dst_unused:UNUSED_PAD src0_sel:DWORD src1_sel:WORD_0
v_smfmac_f32_16x16x64_bf16 v[12:15], a[76:79], v[60:67], v146 abid:1
ds_read_u16 v76, v76
v_add_u32_sdwa v77, s42, v126 dst_sel:DWORD dst_unused:UNUSED_PAD src0_sel:DWORD src1_sel:WORD_1
v_smfmac_f32_16x16x64_bf16 v[12:15], a[112:115], v[68:75], v150 abid:1
buffer_store_dwordx4 v[92:95], v4, s[20:23], s46 offen offset:128 sc1
s_mov_b64 vcc, s[82:83]
ds_read_u16 v77, v77
v_cndmask_b32_dpp v104, v100, v104, vcc quad_perm:[1,0,3,2] row_mask:0xf bank_mask:0xf
v_add_u32_sdwa v78, s42, v127 dst_sel:DWORD dst_unused:UNUSED_PAD src0_sel:DWORD src1_sel:WORD_0
v_smfmac_f32_16x16x64_bf16 v[24:27], a[88:91], v[60:67], v148
ds_read_u16 v78, v78
v_cndmask_b32_dpp v105, v101, v105, vcc quad_perm:[1,0,3,2] row_mask:0xf bank_mask:0xf
v_smfmac_f32_16x16x64_bf16 v[24:27], a[124:127], v[68:75], v152
ds_read_b128 v[44:47], v0 offset:8192
v_cndmask_b32_dpp v106, v102, v106, vcc quad_perm:[1,0,3,2] row_mask:0xf bank_mask:0xf
v_smfmac_f32_16x16x64_bf16 v[28:31], a[92:95], v[60:67], v148 abid:1
ds_read_b128 v[48:51], v1 offset:8192
v_add_u32_sdwa v79, s42, v127 dst_sel:DWORD dst_unused:UNUSED_PAD src0_sel:DWORD src1_sel:WORD_1
v_smfmac_f32_16x16x64_bf16 v[28:31], a[128:131], v[68:75], v152 abid:1
ds_read_u16 v79, v79
v_cndmask_b32_dpp v107, v103, v107, vcc quad_perm:[1,0,3,2] row_mask:0xf bank_mask:0xf
v_smfmac_f32_16x16x64_bf16 v[32:35], a[96:99], v[60:67], v149
ds_read_b128 v[52:55], v0 offset:10240
v_add_u32_sdwa v80, s42, v128 dst_sel:DWORD dst_unused:UNUSED_PAD src0_sel:DWORD src1_sel:WORD_0
v_smfmac_f32_16x16x64_bf16 v[32:35], a[132:135], v[68:75], v153
ds_read_u16 v80, v80
v_add_u32_sdwa v81, s42, v128 dst_sel:DWORD dst_unused:UNUSED_PAD src0_sel:DWORD src1_sel:WORD_1
v_smfmac_f32_16x16x64_bf16 v[16:19], a[80:83], v[60:67], v147
buffer_store_dwordx4 v[104:107], v4, s[20:23], s46 offen offset:1280 sc1
s_mov_b64 vcc, s[80:81]
ds_read_b128 v[56:59], v1 offset:10240
v_add_u32_sdwa v82, s42, v129 dst_sel:DWORD dst_unused:UNUSED_PAD src0_sel:DWORD src1_sel:WORD_0
v_add_u32_sdwa v83, s42, v129 dst_sel:DWORD dst_unused:UNUSED_PAD src0_sel:DWORD src1_sel:WORD_1
v_smfmac_f32_16x16x64_bf16 v[16:19], a[116:119], v[68:75], v151
s_waitcnt lgkmcnt(9)
ds_read_b128 v[92:95], v0 offset:12288
v_add_u32_sdwa v100, s42, v130 dst_sel:DWORD dst_unused:UNUSED_PAD src0_sel:DWORD src1_sel:WORD_0
v_smfmac_f32_16x16x64_bf16 v[16:19], v[114:117], v[84:91], v180 abid:1
ds_read_u16 v81, v81
v_add_u32_sdwa v101, s42, v130 dst_sel:DWORD dst_unused:UNUSED_PAD src0_sel:DWORD src1_sel:WORD_1
v_smfmac_f32_16x16x64_bf16 v[20:23], v[114:117], v[84:91], v181
ds_read_b128 v[96:99], v1 offset:12288
v_add_u32_sdwa v102, s42, v131 dst_sel:DWORD dst_unused:UNUSED_PAD src0_sel:DWORD src1_sel:WORD_0
v_smfmac_f32_16x16x64_bf16 v[20:23], a[84:87], v[60:67], v147 abid:1
ds_read_u16 v100, v100
v_add_u32_sdwa v103, s42, v131 dst_sel:DWORD dst_unused:UNUSED_PAD src0_sel:DWORD src1_sel:WORD_1
v_smfmac_f32_16x16x64_bf16 v[20:23], a[120:123], v[68:75], v151 abid:1
ds_read_u16 v82, v82
v_add_u32_sdwa v104, s42, v132 dst_sel:DWORD dst_unused:UNUSED_PAD src0_sel:DWORD src1_sel:WORD_0
v_smfmac_f32_16x16x64_bf16 v[36:39], a[100:103], v[60:67], v149 abid:1
ds_read_u16 v101, v101
v_add_u32_sdwa v105, s42, v132 dst_sel:DWORD dst_unused:UNUSED_PAD src0_sel:DWORD src1_sel:WORD_1
v_smfmac_f32_16x16x64_bf16 v[36:39], a[136:139], v[68:75], v153 abid:1
buffer_store_dwordx2 v[112:113], v5, s[20:23], s46 offen
ds_read_u16 v83, v83
v_add_u32_sdwa v106, s42, v133 dst_sel:DWORD dst_unused:UNUSED_PAD src0_sel:DWORD src1_sel:WORD_0
v_smfmac_f32_16x16x64_bf16 v[40:43], a[104:107], v[60:67], v175
s_mov_b32 s22, 75497472
ds_read_b128 v[114:117], v2 offset:192
v_add_u32_sdwa v107, s42, v133 dst_sel:DWORD dst_unused:UNUSED_PAD src0_sel:DWORD src1_sel:WORD_1
v_smfmac_f32_16x16x64_bf16 v[40:43], a[140:143], v[68:75], v175 abid:1
s_waitcnt lgkmcnt(12)
ds_read_u16 v102, v102
v_add_u32_sdwa v84, s42, v134 dst_sel:DWORD dst_unused:UNUSED_PAD src0_sel:DWORD src1_sel:WORD_0
v_smfmac_f32_16x16x64_bf16 v[8:11], a[144:147], v[44:51], v154
s_waitcnt lgkmcnt(9)
ds_read_u16 v103, v103
v_add_u32_sdwa v85, s42, v134 dst_sel:DWORD dst_unused:UNUSED_PAD src0_sel:DWORD src1_sel:WORD_1
v_smfmac_f32_16x16x64_bf16 v[8:11], a[180:183], v[52:59], v158
s_waitcnt lgkmcnt(7)
ds_read_u16 v104, v104
v_add_u32_sdwa v86, s42, v135 dst_sel:DWORD dst_unused:UNUSED_PAD src0_sel:DWORD src1_sel:WORD_0
v_smfmac_f32_16x16x64_bf16 v[8:11], a[216:219], v[92:99], v162
s_mov_b32 s46, s48
ds_read_u16 v105, v105
v_add_u32_sdwa v87, s42, v135 dst_sel:DWORD dst_unused:UNUSED_PAD src0_sel:DWORD src1_sel:WORD_1
v_smfmac_f32_16x16x64_bf16 v[24:27], a[160:163], v[44:51], v156
s_mov_b32 s48, s49
ds_read_u16 v106, v106
v_add_u32_sdwa v88, s42, v136 dst_sel:DWORD dst_unused:UNUSED_PAD src0_sel:DWORD src1_sel:WORD_0
v_smfmac_f32_16x16x64_bf16 v[24:27], a[196:199], v[52:59], v160
s_mov_b32 s49, s50
s_add_u32 s50, s50, 4718592
v_add_u32_sdwa v89, s42, v136 dst_sel:DWORD dst_unused:UNUSED_PAD src0_sel:DWORD src1_sel:WORD_1
v_smfmac_f32_16x16x64_bf16 v[24:27], a[232:235], v[92:99], v164
s_waitcnt lgkmcnt(5)
ds_read_u16 v107, v107
v_add_u32_sdwa v90, s42, v137 dst_sel:DWORD dst_unused:UNUSED_PAD src0_sel:DWORD src1_sel:WORD_0
v_smfmac_f32_16x16x64_bf16 v[24:27], v[114:117], v[76:83], v182
ds_read_u16 v84, v84
v_add_u32_sdwa v91, s42, v137 dst_sel:DWORD dst_unused:UNUSED_PAD src0_sel:DWORD src1_sel:WORD_1
v_smfmac_f32_16x16x64_bf16 v[28:31], v[114:117], v[76:83], v182 abid:1
ds_read_b128 v[114:117], v2 offset:256
v_add_u32_sdwa v76, s4, v118 dst_sel:DWORD dst_unused:UNUSED_PAD src0_sel:DWORD src1_sel:WORD_0
v_smfmac_f32_16x16x64_bf16 v[28:31], a[164:167], v[44:51], v156 abid:1
ds_read_u16 v85, v85
v_add_u32_sdwa v77, s4, v118 dst_sel:DWORD dst_unused:UNUSED_PAD src0_sel:DWORD src1_sel:WORD_1
v_smfmac_f32_16x16x64_bf16 v[28:31], a[200:203], v[52:59], v160 abid:1
ds_read_u16 v86, v86
v_add_u32_sdwa v78, s4, v119 dst_sel:DWORD dst_unused:UNUSED_PAD src0_sel:DWORD src1_sel:WORD_0
v_smfmac_f32_16x16x64_bf16 v[28:31], a[236:239], v[92:99], v164 abid:1
ds_read_u16 v87, v87
v_add_u32_sdwa v79, s4, v119 dst_sel:DWORD dst_unused:UNUSED_PAD src0_sel:DWORD src1_sel:WORD_1
v_smfmac_f32_16x16x64_bf16 v[12:15], a[148:151], v[44:51], v154 abid:1
ds_read_u16 v88, v88
v_add_u32_sdwa v80, s4, v120 dst_sel:DWORD dst_unused:UNUSED_PAD src0_sel:DWORD src1_sel:WORD_0
v_smfmac_f32_16x16x64_bf16 v[12:15], a[184:187], v[52:59], v158 abid:1
v_add_u32_sdwa v81, s4, v120 dst_sel:DWORD dst_unused:UNUSED_PAD src0_sel:DWORD src1_sel:WORD_1
v_smfmac_f32_16x16x64_bf16 v[12:15], a[220:223], v[92:99], v162 abid:1
ds_read_b128 v[60:63], v0 offset:14336
v_add_u32_sdwa v82, s4, v121 dst_sel:DWORD dst_unused:UNUSED_PAD src0_sel:DWORD src1_sel:WORD_0
v_smfmac_f32_16x16x64_bf16 v[32:35], a[168:171], v[44:51], v157
ds_read_u16 v89, v89
v_add_u32_sdwa v83, s4, v121 dst_sel:DWORD dst_unused:UNUSED_PAD src0_sel:DWORD src1_sel:WORD_1
v_smfmac_f32_16x16x64_bf16 v[32:35], a[204:207], v[52:59], v161
ds_read_b128 v[64:67], v1 offset:14336
v_smfmac_f32_16x16x64_bf16 v[32:35], a[240:243], v[92:99], v165
s_waitcnt lgkmcnt(7)
ds_read_b128 v[68:71], v0 offset:16384
v_smfmac_f32_16x16x64_bf16 v[32:35], v[114:117], v[100:107], v183 abid:1
ds_read_u16 v90, v90
v_smfmac_f32_16x16x64_bf16 v[36:39], v[114:117], v[100:107], v184
ds_read_b128 v[72:75], v1 offset:16384
v_add_u32 v0, s43, v0
v_smfmac_f32_16x16x64_bf16 v[36:39], a[172:175], v[44:51], v157 abid:1
ds_read_u16 v91, v91
v_add_u32 v1, s43, v1
v_smfmac_f32_16x16x64_bf16 v[36:39], a[208:211], v[52:59], v161 abid:1
v_smfmac_f32_16x16x64_bf16 v[36:39], a[244:247], v[92:99], v165 abid:1
ds_read_b128 v[114:117], v2 offset:320
v_smfmac_f32_16x16x64_bf16 v[16:19], a[152:155], v[44:51], v155
v_smfmac_f32_16x16x64_bf16 v[16:19], a[188:191], v[52:59], v159
v_smfmac_f32_16x16x64_bf16 v[16:19], a[224:227], v[92:99], v163
v_smfmac_f32_16x16x64_bf16 v[20:23], a[156:159], v[44:51], v155 abid:1
v_smfmac_f32_16x16x64_bf16 v[20:23], a[192:195], v[52:59], v159 abid:1
v_smfmac_f32_16x16x64_bf16 v[20:23], a[228:231], v[92:99], v163 abid:1
v_smfmac_f32_16x16x64_bf16 v[40:43], a[176:179], v[44:51], v176
s_bitcmp1_b32 s92, s41
v_smfmac_f32_16x16x64_bf16 v[40:43], a[212:215], v[52:59], v176 abid:1
s_cbranch_scc1 L_loopn_w
L_loopn_wb:
v_smfmac_f32_16x16x64_bf16 v[40:43], a[248:251], v[92:99], v177
s_waitcnt lgkmcnt(0)
v_smfmac_f32_16x16x64_bf16 v[40:43], v[114:117], v[84:91], v185
s_waitcnt vmcnt(20)
s_barrier
L_loopn_p3:
v_smfmac_f32_16x16x64_bf16 v[8:11], a[252:255], v[60:67], v166
s_mov_b32 s42, s4
v_smfmac_f32_16x16x64_bf16 v[8:11], v[218:221], v[68:75], v170
ds_read_b128 v[44:47], v0 offset:0
v_add_u32_sdwa v84, s42, v122 dst_sel:DWORD dst_unused:UNUSED_PAD src0_sel:DWORD src1_sel:WORD_0
v_smfmac_f32_16x16x64_bf16 v[12:15], v[186:189], v[60:67], v166 abid:1
ds_read_b128 v[48:51], v1 offset:0
v_add_u32_sdwa v85, s42, v122 dst_sel:DWORD dst_unused:UNUSED_PAD src0_sel:DWORD src1_sel:WORD_1
v_smfmac_f32_16x16x64_bf16 v[12:15], v[222:225], v[68:75], v170 abid:1
ds_read_b128 v[52:55], v0 offset:2048
v_add_u32_sdwa v86, s42, v123 dst_sel:DWORD dst_unused:UNUSED_PAD src0_sel:DWORD src1_sel:WORD_0
v_smfmac_f32_16x16x64_bf16 v[16:19], v[190:193], v[60:67], v167
ds_read_b128 v[56:59], v1 offset:2048
v_cvt_pk_bf16_f32 v92, v8, v9
v_smfmac_f32_16x16x64_bf16 v[16:19], v[226:229], v[68:75], v171
ds_read_u16 v76, v76
v_cvt_pk_bf16_f32 v93, v10, v11
v_smfmac_f32_16x16x64_bf16 v[20:23], v[194:197], v[60:67], v167 abid:1
ds_read_b128 v[8:11], v2 offset:1024
v_cvt_pk_bf16_f32 v94, v12, v13
v_smfmac_f32_16x16x64_bf16 v[20:23], v[230:233], v[68:75], v171 abid:1
ds_read_u16 v77, v77
v_cvt_pk_bf16_f32 v95, v14, v15
v_smfmac_f32_16x16x64_bf16 v[24:27], v[198:201], v[60:67], v168
ds_read_b128 v[12:15], v2 offset:1088
v_cvt_pk_bf16_f32 v96, v16, v17
v_smfmac_f32_16x16x64_bf16 v[24:27], v[234:237], v[68:75], v172
ds_read_u16 v78, v78
v_cvt_pk_bf16_f32 v97, v18, v19
v_smfmac_f32_16x16x64_bf16 v[28:31], v[202:205], v[60:67], v168 abid:1
ds_read_b128 v[16:19], v2 offset:1152
v_cvt_pk_bf16_f32 v98, v20, v21
v_smfmac_f32_16x16x64_bf16 v[28:31], v[238:241], v[68:75], v172 abid:1
ds_read_u16 v79, v79
v_cvt_pk_bf16_f32 v99, v22, v23
v_smfmac_f32_16x16x64_bf16 v[32:35], v[206:209], v[60:67], v169
ds_read_b128 v[20:23], v2 offset:1216
v_cvt_pk_bf16_f32 v100, v24, v25
v_smfmac_f32_16x16x64_bf16 v[32:35], v[242:245], v[68:75], v173
ds_read_u16 v80, v80
v_cvt_pk_bf16_f32 v101, v26, v27
v_smfmac_f32_16x16x64_bf16 v[36:39], v[210:213], v[60:67], v169 abid:1
ds_read_b128 v[24:27], v2 offset:1280
v_cvt_pk_bf16_f32 v102, v28, v29
v_smfmac_f32_16x16x64_bf16 v[36:39], v[246:249], v[68:75], v173 abid:1
ds_read_u16 v81, v81
v_cvt_pk_bf16_f32 v103, v30, v31
v_smfmac_f32_16x16x64_bf16 v[40:43], v[214:217], v[60:67], v177 abid:1
s_bitcmp1_b32 s12, s41
ds_read_b128 v[28:31], v2 offset:1344
v_cvt_pk_bf16_f32 v104, v32, v33
v_smfmac_f32_16x16x64_bf16 v[40:43], v[250:253], v[68:75], v178
s_waitcnt lgkmcnt(10)
v_cvt_pk_bf16_f32 v105, v34, v35
s_cbranch_scc1 L_loopn
s_cmp_eq_u32 s41, s59
s_cbranch_scc1 L_loopc
s_cmp_lt_u32 s41, s15
s_cbranch_scc1 L_loop
s_nop 0
v_cndmask_b32_dpp v108, v96, v92, vcc quad_perm:[1,0,3,2] row_mask:0xf bank_mask:0xf
v_cndmask_b32_dpp v109, v97, v93, vcc quad_perm:[1,0,3,2] row_mask:0xf bank_mask:0xf
v_cndmask_b32_dpp v110, v98, v94, vcc quad_perm:[1,0,3,2] row_mask:0xf bank_mask:0xf
v_cndmask_b32_dpp v111, v99, v95, vcc quad_perm:[1,0,3,2] row_mask:0xf bank_mask:0xf
buffer_store_dwordx4 v[108:111], v4, s[20:23], s46 offen offset:0 sc1
s_mov_b64 vcc, s[82:83]
v_cvt_pk_bf16_f32 v112, v40, v41
v_cvt_pk_bf16_f32 v113, v42, v43
ds_bpermute_b32 v112, v6, v112
ds_bpermute_b32 v113, v6, v113
v_cndmask_b32_dpp v96, v92, v96, vcc quad_perm:[1,0,3,2] row_mask:0xf bank_mask:0xf
v_cndmask_b32_dpp v97, v93, v97, vcc quad_perm:[1,0,3,2] row_mask:0xf bank_mask:0xf
v_cndmask_b32_dpp v98, v94, v98, vcc quad_perm:[1,0,3,2] row_mask:0xf bank_mask:0xf
v_cndmask_b32_dpp v99, v95, v99, vcc quad_perm:[1,0,3,2] row_mask:0xf bank_mask:0xf
buffer_store_dwordx4 v[96:99], v4, s[20:23], s46 offen offset:1152 sc1
s_mov_b64 vcc, s[80:81]
v_cvt_pk_bf16_f32 v106, v36, v37
v_cvt_pk_bf16_f32 v107, v38, v39
v_cndmask_b32_dpp v92, v104, v100, vcc quad_perm:[1,0,3,2] row_mask:0xf bank_mask:0xf
v_cndmask_b32_dpp v93, v105, v101, vcc quad_perm:[1,0,3,2] row_mask:0xf bank_mask:0xf
v_cndmask_b32_dpp v94, v106, v102, vcc quad_perm:[1,0,3,2] row_mask:0xf bank_mask:0xf
v_cndmask_b32_dpp v95, v107, v103, vcc quad_perm:[1,0,3,2] row_mask:0xf bank_mask:0xf
buffer_store_dwordx4 v[92:95], v4, s[20:23], s46 offen offset:128 sc1
s_mov_b64 vcc, s[82:83]
v_cndmask_b32_dpp v104, v100, v104, vcc quad_perm:[1,0,3,2] row_mask:0xf bank_mask:0xf
v_cndmask_b32_dpp v105, v101, v105, vcc quad_perm:[1,0,3,2] row_mask:0xf bank_mask:0xf
v_cndmask_b32_dpp v106, v102, v106, vcc quad_perm:[1,0,3,2] row_mask:0xf bank_mask:0xf
v_cndmask_b32_dpp v107, v103, v107, vcc quad_perm:[1,0,3,2] row_mask:0xf bank_mask:0xf
buffer_store_dwordx4 v[104:107], v4, s[20:23], s46 offen offset:1280 sc1
s_mov_b64 vcc, s[80:81]
s_waitcnt lgkmcnt(0)
buffer_store_dwordx2 v[112:113], v5, s[20:23], s46 offen
L_fin:
L_end_standalone__structured_sparse_n_m__ragged_kernel:
s_endpgm
L_more1:
v_and_b32 v73, v94, v16
v_lshrrev_b32 v72, 10, v16
v_cmp_eq_u32 s[64:65], v73, v95
v_and_or_b32 v32, v72, v96, v97
s_mov_b64 exec, s[64:65]
ds_add_rtn_u32 v48, v32, v88
s_mov_b64 exec, -1
v_and_b32 v73, v94, v17
v_lshrrev_b32 v72, 10, v17
v_cmp_eq_u32 s[66:67], v73, v95
v_and_or_b32 v33, v72, v96, v97
s_mov_b64 exec, s[66:67]
ds_add_rtn_u32 v49, v33, v88
s_mov_b64 exec, -1
v_and_b32 v73, v94, v18
v_lshrrev_b32 v72, 10, v18
v_cmp_eq_u32 s[68:69], v73, v95
v_and_or_b32 v34, v72, v96, v97
s_mov_b64 exec, s[68:69]
ds_add_rtn_u32 v50, v34, v88
s_mov_b64 exec, -1
v_and_b32 v73, v94, v19
v_lshrrev_b32 v72, 10, v19
v_cmp_eq_u32 s[70:71], v73, v95
v_and_or_b32 v35, v72, v96, v97
s_mov_b64 exec, s[70:71]
ds_add_rtn_u32 v51, v35, v88
s_mov_b64 exec, -1
v_and_b32 v73, v94, v20
v_lshrrev_b32 v72, 10, v20
v_cmp_eq_u32 s[72:73], v73, v95
v_and_or_b32 v36, v72, v96, v97
s_mov_b64 exec, s[72:73]
ds_add_rtn_u32 v52, v36, v88
s_mov_b64 exec, -1
v_and_b32 v73, v94, v21
v_lshrrev_b32 v72, 10, v21
v_cmp_eq_u32 s[74:75], v73, v95
v_and_or_b32 v37, v72, v96, v97
s_mov_b64 exec, s[74:75]
ds_add_rtn_u32 v53, v37, v88
s_mov_b64 exec, -1
v_and_b32 v73, v94, v22
v_lshrrev_b32 v72, 10, v22
v_cmp_eq_u32 s[76:77], v73, v95
v_and_or_b32 v38, v72, v96, v97
s_mov_b64 exec, s[76:77]
ds_add_rtn_u32 v54, v38, v88
s_mov_b64 exec, -1
s_branch L_more1b
L_greedy:
s_mov_b32 s47, 0
s_mov_b32 s89, 1
v_readlane_b32 s3, v72, 0
s_max_u32 s47, s47, 0
v_writelane_b32 v91, s47, 0
s_nop 1
s_add_u32 s47, s47, s3
s_cmp_gt_u32 s47, 32
s_cselect_b32 s90, 1, s90
v_readlane_b32 s3, v72, 1
s_max_u32 s47, s47, 0
v_writelane_b32 v91, s47, 1
s_nop 1
s_add_u32 s47, s47, s3
s_cmp_gt_u32 s47, 64
s_cselect_b32 s90, 1, s90
v_readlane_b32 s3, v72, 2
s_max_u32 s47, s47, 32
v_writelane_b32 v91, s47, 2
s_nop 1
s_add_u32 s47, s47, s3
s_cmp_gt_u32 s47, 64
s_cselect_b32 s90, 1, s90
v_readlane_b32 s3, v72, 3
s_max_u32 s47, s47, 32
v_writelane_b32 v91, s47, 3
s_nop 1
s_add_u32 s47, s47, s3
s_cmp_gt_u32 s47, 96
s_cselect_b32 s90, 1, s90
v_readlane_b32 s3, v72, 4
s_max_u32 s47, s47, 64
v_writelane_b32 v91, s47, 4
s_nop 1
s_add_u32 s47, s47, s3
s_cmp_gt_u32 s47, 96
s_cselect_b32 s90, 1, s90
v_readlane_b32 s3, v72, 5
s_max_u32 s47, s47, 64
v_writelane_b32 v91, s47, 5
s_nop 1
s_add_u32 s47, s47, s3
s_cmp_gt_u32 s47, 128
s_cselect_b32 s90, 1, s90
v_readlane_b32 s3, v72, 6
s_max_u32 s47, s47, 96
v_writelane_b32 v91, s47, 6
s_nop 1
s_add_u32 s47, s47, s3
s_cmp_gt_u32 s47, 128
s_cselect_b32 s90, 1, s90
v_readlane_b32 s3, v72, 7
s_max_u32 s47, s47, 96
v_writelane_b32 v91, s47, 7
s_nop 1
s_add_u32 s47, s47, s3
s_cmp_gt_u32 s47, 160
s_cselect_b32 s90, 1, s90
v_readlane_b32 s3, v72, 8
s_max_u32 s47, s47, 128
v_writelane_b32 v91, s47, 8
s_nop 1
s_add_u32 s47, s47, s3
s_cmp_gt_u32 s47, 160
s_cselect_b32 s90, 1, s90
s_cmp_lg_u32 s90, 0
s_cselect_b64 s[90:91], -1, 0
v_mov_b32 v73, 163072
s_mov_b64 exec, s[90:91]
ds_write_b32 v73, v88
s_mov_b64 exec, -1
s_branch L_greedyb
L_more2:
ds_bpermute_b32 v64, v32, v91
ds_bpermute_b32 v65, v33, v91
ds_bpermute_b32 v66, v34, v91
ds_bpermute_b32 v67, v35, v91
ds_bpermute_b32 v68, v36, v91
ds_bpermute_b32 v69, v37, v91
ds_bpermute_b32 v70, v38, v91
s_waitcnt lgkmcnt(0)
v_add_u32 v73, v48, v64
v_and_b32 v72, 0x87e, v16
v_lshl_add_u32 v73, v73, 1, s93
v_add_u32 v72, v90, v72
s_andn2_b64 exec, s[64:65], s[90:91]
ds_write_b16_d16_hi v73, v16 offset:64
ds_write_b16 v73, v72 offset:384
ds_write_b16 v73, v16 offset:704
s_mov_b64 exec, -1
v_add_u32 v73, v49, v65
v_and_b32 v72, 0x87e, v17
v_lshl_add_u32 v73, v73, 1, s93
v_add_u32 v72, v90, v72
s_andn2_b64 exec, s[66:67], s[90:91]
ds_write_b16_d16_hi v73, v17 offset:64
ds_write_b16 v73, v72 offset:384
ds_write_b16 v73, v17 offset:704
s_mov_b64 exec, -1
v_add_u32 v73, v50, v66
v_and_b32 v72, 0x87e, v18
v_lshl_add_u32 v73, v73, 1, s93
v_add_u32 v72, v90, v72
s_andn2_b64 exec, s[68:69], s[90:91]
ds_write_b16_d16_hi v73, v18 offset:64
ds_write_b16 v73, v72 offset:384
ds_write_b16 v73, v18 offset:704
s_mov_b64 exec, -1
v_add_u32 v73, v51, v67
v_and_b32 v72, 0x87e, v19
v_lshl_add_u32 v73, v73, 1, s93
v_add_u32 v72, v90, v72
s_andn2_b64 exec, s[70:71], s[90:91]
ds_write_b16_d16_hi v73, v19 offset:64
ds_write_b16 v73, v72 offset:384
ds_write_b16 v73, v19 offset:704
s_mov_b64 exec, -1
v_add_u32 v73, v52, v68
v_and_b32 v72, 0x87e, v20
v_lshl_add_u32 v73, v73, 1, s93
v_add_u32 v72, v90, v72
s_andn2_b64 exec, s[72:73], s[90:91]
ds_write_b16_d16_hi v73, v20 offset:64
ds_write_b16 v73, v72 offset:384
ds_write_b16 v73, v20 offset:704
s_mov_b64 exec, -1
v_add_u32 v73, v53, v69
v_and_b32 v72, 0x87e, v21
v_lshl_add_u32 v73, v73, 1, s93
v_add_u32 v72, v90, v72
s_andn2_b64 exec, s[74:75], s[90:91]
ds_write_b16_d16_hi v73, v21 offset:64
ds_write_b16 v73, v72 offset:384
ds_write_b16 v73, v21 offset:704
s_mov_b64 exec, -1
v_add_u32 v73, v54, v70
v_and_b32 v72, 0x87e, v22
v_lshl_add_u32 v73, v73, 1, s93
v_add_u32 v72, v90, v72
s_andn2_b64 exec, s[76:77], s[90:91]
ds_write_b16_d16_hi v73, v22 offset:64
ds_write_b16 v73, v72 offset:384
ds_write_b16 v73, v22 offset:704
s_mov_b64 exec, -1
s_branch L_more2b
L_cwait:
buffer_load_dword v8, off, s[36:39], 0 sc1
s_sub_u32 s3, s3, 1
s_cbranch_scc1 L_giveup
s_waitcnt vmcnt(0)
v_readfirstlane_b32 s47, v8
s_nop 3
s_cmp_lg_u32 s47, 1
s_cbranch_scc1 L_cwait
s_branch L_poll
L_giveup:
s_waitcnt vmcnt(0)
v_mov_b32 v8, 163072
v_mov_b32 v9, 1
ds_write_b32 v8, v9
s_branch L_polled
L_loop_w:
s_bitcmp1_b32 s87, s41
s_waitcnt vmcnt(15)
s_cbranch_scc0 L_loop_wb
s_waitcnt vmcnt(10)
s_branch L_loop_wb
L_loopn_w:
s_bitcmp1_b32 s87, s41
s_waitcnt vmcnt(15)
s_cbranch_scc0 L_loopn_wb
s_waitcnt vmcnt(10)
s_branch L_loopn_wb
L_linked:
.p2align 6
L_loopk:
v_smfmac_f32_16x16x64_bf16 v[8:11], a[0:3], v[44:51], v138
ds_read_b128 v[32:35], v2 offset:1408
v_cvt_pk_bf16_f32 v106, v36, v37
v_smfmac_f32_16x16x64_bf16 v[8:11], a[36:39], v[52:59], v142
s_waitcnt lgkmcnt(9)
v_cvt_pk_bf16_f32 v107, v38, v39
v_smfmac_f32_16x16x64_bf16 v[12:15], a[4:7], v[44:51], v138 abid:1
ds_read_b128 v[36:39], v2 offset:1472
v_cvt_pk_bf16_f32 v112, v40, v41
v_smfmac_f32_16x16x64_bf16 v[12:15], a[40:43], v[52:59], v142 abid:1
s_waitcnt lgkmcnt(8)
ds_read_b128 v[60:63], v0 offset:4096
v_cvt_pk_bf16_f32 v113, v42, v43
v_smfmac_f32_16x16x64_bf16 v[16:19], a[8:11], v[44:51], v139
s_cmp_eq_u32 s4, 129920
ds_read_b128 v[40:43], v2 offset:1536
v_cndmask_b32_dpp v108, v96, v92, vcc quad_perm:[1,0,3,2] row_mask:0xf bank_mask:0xf
v_smfmac_f32_16x16x64_bf16 v[16:19], a[44:47], v[52:59], v143
s_waitcnt lgkmcnt(8)
ds_read_u16 v82, v82
v_cndmask_b32_dpp v109, v97, v93, vcc quad_perm:[1,0,3,2] row_mask:0xf bank_mask:0xf
v_smfmac_f32_16x16x64_bf16 v[20:23], a[12:15], v[44:51], v139 abid:1
s_cselect_b32 s43, -129920, s5
ds_read_u16 v84, v84
v_cndmask_b32_dpp v110, v98, v94, vcc quad_perm:[1,0,3,2] row_mask:0xf bank_mask:0xf
v_smfmac_f32_16x16x64_bf16 v[20:23], a[48:51], v[52:59], v143 abid:1
s_waitcnt lgkmcnt(8)
ds_read_b128 v[64:67], v1 offset:4096
v_cndmask_b32_dpp v111, v99, v95, vcc quad_perm:[1,0,3,2] row_mask:0xf bank_mask:0xf
v_smfmac_f32_16x16x64_bf16 v[24:27], a[16:19], v[44:51], v140
s_add_u32 s4, s4, s43
ds_read_b128 v[68:71], v0 offset:6144
v_add_u32_sdwa v87, s42, v123 dst_sel:DWORD dst_unused:UNUSED_PAD src0_sel:DWORD src1_sel:WORD_1
v_smfmac_f32_16x16x64_bf16 v[24:27], a[52:55], v[52:59], v144
buffer_store_dwordx4 v[108:111], v4, s[20:23], s46 offen offset:0 sc1
s_mov_b64 vcc, s[82:83]
s_waitcnt lgkmcnt(8)
ds_read_b128 v[72:75], v1 offset:6144
v_cndmask_b32_dpp v96, v92, v96, vcc quad_perm:[1,0,3,2] row_mask:0xf bank_mask:0xf
v_cndmask_b32_dpp v97, v93, v97, vcc quad_perm:[1,0,3,2] row_mask:0xf bank_mask:0xf
v_smfmac_f32_16x16x64_bf16 v[28:31], a[20:23], v[44:51], v140 abid:1
s_add_u32 s41, s41, 1
ds_read_u16 v83, v83
v_cndmask_b32_dpp v98, v94, v98, vcc quad_perm:[1,0,3,2] row_mask:0xf bank_mask:0xf
v_smfmac_f32_16x16x64_bf16 v[28:31], a[56:59], v[52:59], v144 abid:1
s_waitcnt lgkmcnt(9)
ds_read_b128 v[114:117], v2 offset:64
v_cndmask_b32_dpp v99, v95, v99, vcc quad_perm:[1,0,3,2] row_mask:0xf bank_mask:0xf
v_smfmac_f32_16x16x64_bf16 v[32:35], a[24:27], v[44:51], v141
ds_read_u16 v85, v85
v_add_u32_sdwa v88, s42, v124 dst_sel:DWORD dst_unused:UNUSED_PAD src0_sel:DWORD src1_sel:WORD_0
v_smfmac_f32_16x16x64_bf16 v[32:35], a[60:63], v[52:59], v145
s_waitcnt lgkmcnt(10)
ds_read_u16 v86, v86
v_add_u32_sdwa v89, s42, v124 dst_sel:DWORD dst_unused:UNUSED_PAD src0_sel:DWORD src1_sel:WORD_1
v_smfmac_f32_16x16x64_bf16 v[36:39], a[28:31], v[44:51], v141 abid:1
ds_read_u16 v87, v87
v_add_u32_sdwa v90, s42, v125 dst_sel:DWORD dst_unused:UNUSED_PAD src0_sel:DWORD src1_sel:WORD_0
v_smfmac_f32_16x16x64_bf16 v[36:39], a[64:67], v[52:59], v145 abid:1
s_waitcnt lgkmcnt(10)
ds_read_u16 v88, v88
v_add_u32_sdwa v91, s42, v125 dst_sel:DWORD dst_unused:UNUSED_PAD src0_sel:DWORD src1_sel:WORD_1
v_smfmac_f32_16x16x64_bf16 v[40:43], a[32:35], v[44:51], v174
buffer_store_dwordx4 v[96:99], v4, s[20:23], s46 offen offset:1152 sc1
s_mov_b64 vcc, s[80:81]
ds_read_u16 v89, v89
v_cndmask_b32_dpp v92, v104, v100, vcc quad_perm:[1,0,3,2] row_mask:0xf bank_mask:0xf
v_cndmask_b32_dpp v93, v105, v101, vcc quad_perm:[1,0,3,2] row_mask:0xf bank_mask:0xf
v_smfmac_f32_16x16x64_bf16 v[40:43], a[68:71], v[52:59], v174 abid:1
s_waitcnt lgkmcnt(9)
ds_read_u16 v90, v90
v_cndmask_b32_dpp v94, v106, v102, vcc quad_perm:[1,0,3,2] row_mask:0xf bank_mask:0xf
v_smfmac_f32_16x16x64_bf16 v[8:11], a[72:75], v[60:67], v146
s_waitcnt lgkmcnt(8)
ds_read_u16 v91, v91
v_cndmask_b32_dpp v95, v107, v103, vcc quad_perm:[1,0,3,2] row_mask:0xf bank_mask:0xf
v_smfmac_f32_16x16x64_bf16 v[8:11], a[108:111], v[68:75], v150
s_waitcnt lgkmcnt(7)
ds_bpermute_b32 v112, v6, v112
v_smfmac_f32_16x16x64_bf16 v[8:11], v[114:117], v[76:83], v179
s_waitcnt vmcnt(2)
ds_bpermute_b32 v113, v6, v113
v_smfmac_f32_16x16x64_bf16 v[12:15], v[114:117], v[76:83], v179 abid:1
ds_read_b128 v[114:117], v2 offset:128
v_add_u32_sdwa v76, s42, v126 dst_sel:DWORD dst_unused:UNUSED_PAD src0_sel:DWORD src1_sel:WORD_0
v_smfmac_f32_16x16x64_bf16 v[12:15], a[76:79], v[60:67], v146 abid:1
ds_read_u16 v76, v76
v_add_u32_sdwa v77, s42, v126 dst_sel:DWORD dst_unused:UNUSED_PAD src0_sel:DWORD src1_sel:WORD_1
v_smfmac_f32_16x16x64_bf16 v[12:15], a[112:115], v[68:75], v150 abid:1
buffer_store_dwordx4 v[92:95], v4, s[20:23], s46 offen offset:128 sc1
s_mov_b64 vcc, s[82:83]
ds_read_u16 v77, v77
v_cndmask_b32_dpp v104, v100, v104, vcc quad_perm:[1,0,3,2] row_mask:0xf bank_mask:0xf
v_cndmask_b32_dpp v105, v101, v105, vcc quad_perm:[1,0,3,2] row_mask:0xf bank_mask:0xf
v_smfmac_f32_16x16x64_bf16 v[24:27], a[88:91], v[60:67], v148
ds_read_b128 v[44:47], v0 offset:8192
v_add_u32_sdwa v78, s42, v127 dst_sel:DWORD dst_unused:UNUSED_PAD src0_sel:DWORD src1_sel:WORD_0
v_smfmac_f32_16x16x64_bf16 v[24:27], a[124:127], v[68:75], v152
ds_read_u16 v78, v78
v_cndmask_b32_dpp v106, v102, v106, vcc quad_perm:[1,0,3,2] row_mask:0xf bank_mask:0xf
v_smfmac_f32_16x16x64_bf16 v[28:31], a[92:95], v[60:67], v148 abid:1
ds_read_b128 v[48:51], v1 offset:8192
v_cndmask_b32_dpp v107, v103, v107, vcc quad_perm:[1,0,3,2] row_mask:0xf bank_mask:0xf
v_smfmac_f32_16x16x64_bf16 v[28:31], a[128:131], v[68:75], v152 abid:1
ds_read_b128 v[52:55], v0 offset:10240
v_add_u32_sdwa v79, s42, v127 dst_sel:DWORD dst_unused:UNUSED_PAD src0_sel:DWORD src1_sel:WORD_1
v_smfmac_f32_16x16x64_bf16 v[32:35], a[96:99], v[60:67], v149
ds_read_u16 v79, v79
v_add_u32_sdwa v80, s42, v128 dst_sel:DWORD dst_unused:UNUSED_PAD src0_sel:DWORD src1_sel:WORD_0
v_smfmac_f32_16x16x64_bf16 v[32:35], a[132:135], v[68:75], v153
ds_read_u16 v80, v80
v_add_u32_sdwa v81, s42, v128 dst_sel:DWORD dst_unused:UNUSED_PAD src0_sel:DWORD src1_sel:WORD_1
v_smfmac_f32_16x16x64_bf16 v[16:19], a[80:83], v[60:67], v147
buffer_store_dwordx4 v[104:107], v4, s[20:23], s46 offen offset:1280 sc1
s_mov_b64 vcc, s[80:81]
ds_read_b128 v[56:59], v1 offset:10240
v_add_u32_sdwa v82, s42, v129 dst_sel:DWORD dst_unused:UNUSED_PAD src0_sel:DWORD src1_sel:WORD_0
v_add_u32_sdwa v83, s42, v129 dst_sel:DWORD dst_unused:UNUSED_PAD src0_sel:DWORD src1_sel:WORD_1
v_smfmac_f32_16x16x64_bf16 v[16:19], a[116:119], v[68:75], v151
s_waitcnt lgkmcnt(9)
ds_read_b128 v[92:95], v0 offset:12288
v_add_u32_sdwa v100, s42, v130 dst_sel:DWORD dst_unused:UNUSED_PAD src0_sel:DWORD src1_sel:WORD_0
v_smfmac_f32_16x16x64_bf16 v[16:19], v[114:117], v[84:91], v180 abid:1
ds_read_u16 v81, v81
v_add_u32_sdwa v101, s42, v130 dst_sel:DWORD dst_unused:UNUSED_PAD src0_sel:DWORD src1_sel:WORD_1
v_smfmac_f32_16x16x64_bf16 v[12:15], v[114:117], v[84:91], v180
ds_read_b128 v[96:99], v1 offset:12288
v_add_u32_sdwa v102, s42, v131 dst_sel:DWORD dst_unused:UNUSED_PAD src0_sel:DWORD src1_sel:WORD_0
v_smfmac_f32_16x16x64_bf16 v[20:23], v[114:117], v[84:91], v181
ds_read_u16 v82, v82
v_add_u32_sdwa v103, s42, v131 dst_sel:DWORD dst_unused:UNUSED_PAD src0_sel:DWORD src1_sel:WORD_1
v_smfmac_f32_16x16x64_bf16 v[20:23], a[84:87], v[60:67], v147 abid:1
ds_read_u16 v100, v100
v_add_u32_sdwa v104, s42, v132 dst_sel:DWORD dst_unused:UNUSED_PAD src0_sel:DWORD src1_sel:WORD_0
v_smfmac_f32_16x16x64_bf16 v[20:23], a[120:123], v[68:75], v151 abid:1
ds_read_u16 v83, v83
v_add_u32_sdwa v105, s42, v132 dst_sel:DWORD dst_unused:UNUSED_PAD src0_sel:DWORD src1_sel:WORD_1
v_smfmac_f32_16x16x64_bf16 v[36:39], a[100:103], v[60:67], v149 abid:1
buffer_store_dwordx2 v[112:113], v5, s[20:23], s46 offen
ds_read_b128 v[114:117], v2 offset:192
v_add_u32_sdwa v106, s42, v133 dst_sel:DWORD dst_unused:UNUSED_PAD src0_sel:DWORD src1_sel:WORD_0
v_smfmac_f32_16x16x64_bf16 v[36:39], a[136:139], v[68:75], v153 abid:1
s_mov_b32 s22, 75497472
ds_read_u16 v101, v101
v_add_u32_sdwa v107, s42, v133 dst_sel:DWORD dst_unused:UNUSED_PAD src0_sel:DWORD src1_sel:WORD_1
v_smfmac_f32_16x16x64_bf16 v[40:43], a[104:107], v[60:67], v175
s_mov_b32 s46, s48
ds_read_u16 v102, v102
v_add_u32_sdwa v84, s42, v134 dst_sel:DWORD dst_unused:UNUSED_PAD src0_sel:DWORD src1_sel:WORD_0
v_smfmac_f32_16x16x64_bf16 v[40:43], a[140:143], v[68:75], v175 abid:1
s_waitcnt lgkmcnt(13)
ds_read_u16 v103, v103
v_add_u32_sdwa v85, s42, v134 dst_sel:DWORD dst_unused:UNUSED_PAD src0_sel:DWORD src1_sel:WORD_1
v_smfmac_f32_16x16x64_bf16 v[8:11], a[144:147], v[44:51], v154
s_waitcnt lgkmcnt(10)
ds_read_u16 v104, v104
v_add_u32_sdwa v86, s42, v135 dst_sel:DWORD dst_unused:UNUSED_PAD src0_sel:DWORD src1_sel:WORD_0
v_smfmac_f32_16x16x64_bf16 v[8:11], a[180:183], v[52:59], v158
s_waitcnt lgkmcnt(8)
ds_read_u16 v105, v105
v_add_u32_sdwa v87, s42, v135 dst_sel:DWORD dst_unused:UNUSED_PAD src0_sel:DWORD src1_sel:WORD_1
v_smfmac_f32_16x16x64_bf16 v[8:11], a[216:219], v[92:99], v162
s_add_u32 m0, s44, 0
ds_read_u16 v106, v106
v_add_u32_sdwa v88, s42, v136 dst_sel:DWORD dst_unused:UNUSED_PAD src0_sel:DWORD src1_sel:WORD_0
v_smfmac_f32_16x16x64_bf16 v[24:27], a[160:163], v[44:51], v156
buffer_load_dwordx4 v3, s[16:19], s45 offen offset:0 nt lds
v_add_u32_sdwa v89, s42, v136 dst_sel:DWORD dst_unused:UNUSED_PAD src0_sel:DWORD src1_sel:WORD_1
v_smfmac_f32_16x16x64_bf16 v[24:27], a[196:199], v[52:59], v160
s_mov_b32 s48, s49
ds_read_u16 v107, v107
v_add_u32_sdwa v90, s42, v137 dst_sel:DWORD dst_unused:UNUSED_PAD src0_sel:DWORD src1_sel:WORD_0
v_smfmac_f32_16x16x64_bf16 v[24:27], a[232:235], v[92:99], v164
s_waitcnt lgkmcnt(7)
ds_read_u16 v84, v84
v_add_u32_sdwa v91, s42, v137 dst_sel:DWORD dst_unused:UNUSED_PAD src0_sel:DWORD src1_sel:WORD_1
v_smfmac_f32_16x16x64_bf16 v[24:27], v[114:117], v[76:83], v182
s_mov_b32 s49, s50
ds_read_u16 v85, v85
v_smfmac_f32_16x16x64_bf16 v[20:23], v[114:117], v[76:83], v181 abid:1
s_add_u32 s50, s50, 4718592
ds_read_u16 v86, v86
v_smfmac_f32_16x16x64_bf16 v[28:31], v[114:117], v[76:83], v182 abid:1
ds_read_b128 v[114:117], v2 offset:256
v_add_u32_sdwa v76, s4, v118 dst_sel:DWORD dst_unused:UNUSED_PAD src0_sel:DWORD src1_sel:WORD_0
v_smfmac_f32_16x16x64_bf16 v[28:31], a[164:167], v[44:51], v156 abid:1
ds_read_u16 v87, v87
v_add_u32_sdwa v77, s4, v118 dst_sel:DWORD dst_unused:UNUSED_PAD src0_sel:DWORD src1_sel:WORD_1
v_smfmac_f32_16x16x64_bf16 v[28:31], a[200:203], v[52:59], v160 abid:1
ds_read_u16 v88, v88
v_add_u32_sdwa v78, s4, v119 dst_sel:DWORD dst_unused:UNUSED_PAD src0_sel:DWORD src1_sel:WORD_0
v_smfmac_f32_16x16x64_bf16 v[28:31], a[236:239], v[92:99], v164 abid:1
ds_read_b128 v[60:63], v0 offset:14336
v_add_u32_sdwa v79, s4, v119 dst_sel:DWORD dst_unused:UNUSED_PAD src0_sel:DWORD src1_sel:WORD_1
v_smfmac_f32_16x16x64_bf16 v[12:15], a[148:151], v[44:51], v154 abid:1
ds_read_u16 v89, v89
v_add_u32_sdwa v80, s4, v120 dst_sel:DWORD dst_unused:UNUSED_PAD src0_sel:DWORD src1_sel:WORD_0
v_smfmac_f32_16x16x64_bf16 v[12:15], a[184:187], v[52:59], v158 abid:1
s_add_u32 m0, s44, 3840
ds_read_b128 v[64:67], v1 offset:14336
v_add_u32_sdwa v81, s4, v120 dst_sel:DWORD dst_unused:UNUSED_PAD src0_sel:DWORD src1_sel:WORD_1
v_smfmac_f32_16x16x64_bf16 v[12:15], a[220:223], v[92:99], v162 abid:1
buffer_load_dwordx4 v3, s[16:19], s45 offen offset:256 nt lds
v_add_u32_sdwa v82, s4, v121 dst_sel:DWORD dst_unused:UNUSED_PAD src0_sel:DWORD src1_sel:WORD_0
v_smfmac_f32_16x16x64_bf16 v[32:35], a[168:171], v[44:51], v157
ds_read_b128 v[68:71], v0 offset:16384
v_add_u32_sdwa v83, s4, v121 dst_sel:DWORD dst_unused:UNUSED_PAD src0_sel:DWORD src1_sel:WORD_1
v_smfmac_f32_16x16x64_bf16 v[32:35], a[204:207], v[52:59], v161
ds_read_u16 v90, v90
v_smfmac_f32_16x16x64_bf16 v[32:35], a[240:243], v[92:99], v165
s_waitcnt lgkmcnt(7)
ds_read_b128 v[72:75], v1 offset:16384
v_add_u32 v0, s43, v0
v_smfmac_f32_16x16x64_bf16 v[32:35], v[114:117], v[100:107], v183 abid:1
ds_read_u16 v91, v91
v_add_u32 v1, s43, v1
v_smfmac_f32_16x16x64_bf16 v[28:31], v[114:117], v[100:107], v183
v_smfmac_f32_16x16x64_bf16 v[36:39], v[114:117], v[100:107], v184
ds_read_b128 v[114:117], v2 offset:320
v_smfmac_f32_16x16x64_bf16 v[36:39], a[172:175], v[44:51], v157 abid:1
s_add_u32 m0, s44, 7680
v_smfmac_f32_16x16x64_bf16 v[36:39], a[208:211], v[52:59], v161 abid:1
buffer_load_dwordx4 v3, s[16:19], s45 offen offset:512 nt lds
v_smfmac_f32_16x16x64_bf16 v[36:39], a[244:247], v[92:99], v165 abid:1
v_smfmac_f32_16x16x64_bf16 v[16:19], a[152:155], v[44:51], v155
s_add_u32 m0, s44, 11520
v_smfmac_f32_16x16x64_bf16 v[16:19], a[188:191], v[52:59], v159
buffer_load_dwordx4 v3, s[16:19], s45 offen offset:768 nt lds
v_smfmac_f32_16x16x64_bf16 v[16:19], a[224:227], v[92:99], v163
v_smfmac_f32_16x16x64_bf16 v[20:23], a[156:159], v[44:51], v155 abid:1
s_add_u32 m0, s44, s8
v_smfmac_f32_16x16x64_bf16 v[20:23], a[192:195], v[52:59], v159 abid:1
s_mov_b64 exec, s[10:11]
buffer_load_dwordx4 v3, s[16:19], s7 offen offset:896 nt lds
s_mov_b64 exec, -1
v_smfmac_f32_16x16x64_bf16 v[20:23], a[228:231], v[92:99], v163 abid:1
s_add_u32 s45, s45, 4718592
s_add_u32 s7, s7, 4718592
s_add_u32 s44, s44, s5
v_smfmac_f32_16x16x64_bf16 v[40:43], a[176:179], v[44:51], v176
s_cmp_ge_u32 s44, 148480
s_cselect_b32 s44, s9, s44
s_bitcmp1_b32 s92, s41
v_smfmac_f32_16x16x64_bf16 v[40:43], a[212:215], v[52:59], v176 abid:1
s_cbranch_scc1 L_loopk_w
L_loopk_wb:
v_smfmac_f32_16x16x64_bf16 v[40:43], a[248:251], v[92:99], v177
s_waitcnt lgkmcnt(0)
v_smfmac_f32_16x16x64_bf16 v[40:43], v[114:117], v[84:91], v185
v_smfmac_f32_16x16x64_bf16 v[36:39], v[114:117], v[84:91], v184 abid:1
s_waitcnt vmcnt(20)
s_barrier
v_smfmac_f32_16x16x64_bf16 v[8:11], a[252:255], v[60:67], v166
s_mov_b32 s42, s4
v_smfmac_f32_16x16x64_bf16 v[8:11], v[218:221], v[68:75], v170
ds_read_b128 v[44:47], v0 offset:0
v_add_u32_sdwa v84, s42, v122 dst_sel:DWORD dst_unused:UNUSED_PAD src0_sel:DWORD src1_sel:WORD_0
v_smfmac_f32_16x16x64_bf16 v[12:15], v[186:189], v[60:67], v166 abid:1
ds_read_b128 v[48:51], v1 offset:0
v_add_u32_sdwa v85, s42, v122 dst_sel:DWORD dst_unused:UNUSED_PAD src0_sel:DWORD src1_sel:WORD_1
v_smfmac_f32_16x16x64_bf16 v[12:15], v[222:225], v[68:75], v170 abid:1
ds_read_b128 v[52:55], v0 offset:2048
v_add_u32_sdwa v86, s42, v123 dst_sel:DWORD dst_unused:UNUSED_PAD src0_sel:DWORD src1_sel:WORD_0
v_smfmac_f32_16x16x64_bf16 v[16:19], v[190:193], v[60:67], v167
ds_read_b128 v[56:59], v1 offset:2048
v_cvt_pk_bf16_f32 v92, v8, v9
v_smfmac_f32_16x16x64_bf16 v[16:19], v[226:229], v[68:75], v171
ds_read_u16 v76, v76
v_cvt_pk_bf16_f32 v93, v10, v11
v_smfmac_f32_16x16x64_bf16 v[20:23], v[194:197], v[60:67], v167 abid:1
ds_read_b128 v[8:11], v2 offset:1024
v_cvt_pk_bf16_f32 v94, v12, v13
v_smfmac_f32_16x16x64_bf16 v[20:23], v[230:233], v[68:75], v171 abid:1
ds_read_u16 v77, v77
v_cvt_pk_bf16_f32 v95, v14, v15
v_smfmac_f32_16x16x64_bf16 v[24:27], v[198:201], v[60:67], v168
ds_read_b128 v[12:15], v2 offset:1088
v_cvt_pk_bf16_f32 v96, v16, v17
v_smfmac_f32_16x16x64_bf16 v[24:27], v[234:237], v[68:75], v172
ds_read_u16 v78, v78
v_cvt_pk_bf16_f32 v97, v18, v19
v_smfmac_f32_16x16x64_bf16 v[28:31], v[202:205], v[60:67], v168 abid:1
ds_read_b128 v[16:19], v2 offset:1152
v_cvt_pk_bf16_f32 v98, v20, v21
v_smfmac_f32_16x16x64_bf16 v[28:31], v[238:241], v[68:75], v172 abid:1
ds_read_u16 v79, v79
v_cvt_pk_bf16_f32 v99, v22, v23
v_smfmac_f32_16x16x64_bf16 v[32:35], v[206:209], v[60:67], v169
ds_read_b128 v[20:23], v2 offset:1216
v_cvt_pk_bf16_f32 v100, v24, v25
v_smfmac_f32_16x16x64_bf16 v[32:35], v[242:245], v[68:75], v173
ds_read_u16 v80, v80
v_cvt_pk_bf16_f32 v101, v26, v27
v_smfmac_f32_16x16x64_bf16 v[36:39], v[210:213], v[60:67], v169 abid:1
ds_read_b128 v[24:27], v2 offset:1280
v_cvt_pk_bf16_f32 v102, v28, v29
v_smfmac_f32_16x16x64_bf16 v[36:39], v[246:249], v[68:75], v173 abid:1
ds_read_u16 v81, v81
v_cvt_pk_bf16_f32 v103, v30, v31
v_smfmac_f32_16x16x64_bf16 v[40:43], v[214:217], v[60:67], v177 abid:1
s_bitcmp1_b32 s85, s41
ds_read_b128 v[28:31], v2 offset:1344
v_cvt_pk_bf16_f32 v104, v32, v33
v_smfmac_f32_16x16x64_bf16 v[40:43], v[250:253], v[68:75], v178
s_waitcnt lgkmcnt(10)
v_cvt_pk_bf16_f32 v105, v34, v35
s_cbranch_scc1 L_loopk
s_cmp_lg_u32 s41, 6
s_cbranch_scc1 L_loopnk
.p2align 3
L_loopck:
v_smfmac_f32_16x16x64_bf16 v[8:11], a[0:3], v[44:51], v138
s_cmp_lt_u32 s56, s65
s_cselect_b32 s34, s34, 0
s_cselect_b32 s64, s64, 0
ds_read_b128 v[32:35], v2 offset:1408
v_cvt_pk_bf16_f32 v106, v36, v37
v_mov_b32 v7, 1
v_smfmac_f32_16x16x64_bf16 v[8:11], a[36:39], v[52:59], v142
s_waitcnt lgkmcnt(9)
buffer_atomic_add v7, v6, s[32:35], 0 offen sc0 sc1
v_cvt_pk_bf16_f32 v107, v38, v39
v_smfmac_f32_16x16x64_bf16 v[12:15], a[4:7], v[44:51], v138 abid:1
ds_read_b128 v[36:39], v2 offset:1472
v_cvt_pk_bf16_f32 v112, v40, v41
v_smfmac_f32_16x16x64_bf16 v[12:15], a[40:43], v[52:59], v142 abid:1
s_waitcnt lgkmcnt(8)
ds_read_b128 v[60:63], v0 offset:4096
v_cvt_pk_bf16_f32 v113, v42, v43
v_smfmac_f32_16x16x64_bf16 v[16:19], a[8:11], v[44:51], v139
s_cmp_eq_u32 s4, 129920
ds_read_b128 v[40:43], v2 offset:1536
v_cndmask_b32_dpp v108, v96, v92, vcc quad_perm:[1,0,3,2] row_mask:0xf bank_mask:0xf
v_smfmac_f32_16x16x64_bf16 v[16:19], a[44:47], v[52:59], v143
s_waitcnt lgkmcnt(8)
ds_read_u16 v82, v82
v_cndmask_b32_dpp v109, v97, v93, vcc quad_perm:[1,0,3,2] row_mask:0xf bank_mask:0xf
v_smfmac_f32_16x16x64_bf16 v[20:23], a[12:15], v[44:51], v139 abid:1
s_cselect_b32 s43, -129920, s5
ds_read_u16 v84, v84
v_cndmask_b32_dpp v110, v98, v94, vcc quad_perm:[1,0,3,2] row_mask:0xf bank_mask:0xf
v_smfmac_f32_16x16x64_bf16 v[20:23], a[48:51], v[52:59], v143 abid:1
s_waitcnt lgkmcnt(8)
ds_read_b128 v[64:67], v1 offset:4096
v_cndmask_b32_dpp v111, v99, v95, vcc quad_perm:[1,0,3,2] row_mask:0xf bank_mask:0xf
v_smfmac_f32_16x16x64_bf16 v[24:27], a[16:19], v[44:51], v140
s_add_u32 s4, s4, s43
ds_read_b128 v[68:71], v0 offset:6144
v_add_u32_sdwa v87, s42, v123 dst_sel:DWORD dst_unused:UNUSED_PAD src0_sel:DWORD src1_sel:WORD_1
v_smfmac_f32_16x16x64_bf16 v[24:27], a[52:55], v[52:59], v144
buffer_store_dwordx4 v[108:111], v4, s[20:23], s46 offen offset:0 sc1
s_mov_b64 vcc, s[82:83]
s_waitcnt lgkmcnt(8)
ds_read_b128 v[72:75], v1 offset:6144
v_cndmask_b32_dpp v96, v92, v96, vcc quad_perm:[1,0,3,2] row_mask:0xf bank_mask:0xf
v_cndmask_b32_dpp v97, v93, v97, vcc quad_perm:[1,0,3,2] row_mask:0xf bank_mask:0xf
v_smfmac_f32_16x16x64_bf16 v[28:31], a[20:23], v[44:51], v140 abid:1
s_add_u32 s7, s45, s58
ds_read_u16 v83, v83
v_cndmask_b32_dpp v98, v94, v98, vcc quad_perm:[1,0,3,2] row_mask:0xf bank_mask:0xf
v_smfmac_f32_16x16x64_bf16 v[28:31], a[56:59], v[52:59], v144 abid:1
s_waitcnt lgkmcnt(9)
ds_read_b128 v[114:117], v2 offset:64
v_cndmask_b32_dpp v99, v95, v99, vcc quad_perm:[1,0,3,2] row_mask:0xf bank_mask:0xf
v_smfmac_f32_16x16x64_bf16 v[32:35], a[24:27], v[44:51], v141
ds_read_u16 v85, v85
v_add_u32_sdwa v88, s42, v124 dst_sel:DWORD dst_unused:UNUSED_PAD src0_sel:DWORD src1_sel:WORD_0
v_smfmac_f32_16x16x64_bf16 v[32:35], a[60:63], v[52:59], v145
s_waitcnt lgkmcnt(10)
ds_read_u16 v86, v86
v_add_u32_sdwa v89, s42, v124 dst_sel:DWORD dst_unused:UNUSED_PAD src0_sel:DWORD src1_sel:WORD_1
v_smfmac_f32_16x16x64_bf16 v[36:39], a[28:31], v[44:51], v141 abid:1
ds_read_u16 v87, v87
v_add_u32_sdwa v90, s42, v125 dst_sel:DWORD dst_unused:UNUSED_PAD src0_sel:DWORD src1_sel:WORD_0
v_smfmac_f32_16x16x64_bf16 v[36:39], a[64:67], v[52:59], v145 abid:1
s_waitcnt lgkmcnt(10)
ds_read_u16 v88, v88
v_add_u32_sdwa v91, s42, v125 dst_sel:DWORD dst_unused:UNUSED_PAD src0_sel:DWORD src1_sel:WORD_1
v_smfmac_f32_16x16x64_bf16 v[40:43], a[32:35], v[44:51], v174
buffer_store_dwordx4 v[96:99], v4, s[20:23], s46 offen offset:1152 sc1
s_mov_b64 vcc, s[80:81]
ds_read_u16 v89, v89
v_cndmask_b32_dpp v92, v104, v100, vcc quad_perm:[1,0,3,2] row_mask:0xf bank_mask:0xf
v_cndmask_b32_dpp v93, v105, v101, vcc quad_perm:[1,0,3,2] row_mask:0xf bank_mask:0xf
v_smfmac_f32_16x16x64_bf16 v[40:43], a[68:71], v[52:59], v174 abid:1
s_waitcnt lgkmcnt(9)
ds_read_u16 v90, v90
v_cndmask_b32_dpp v94, v106, v102, vcc quad_perm:[1,0,3,2] row_mask:0xf bank_mask:0xf
v_smfmac_f32_16x16x64_bf16 v[8:11], a[72:75], v[60:67], v146
s_waitcnt lgkmcnt(8)
ds_read_u16 v91, v91
v_cndmask_b32_dpp v95, v107, v103, vcc quad_perm:[1,0,3,2] row_mask:0xf bank_mask:0xf
v_smfmac_f32_16x16x64_bf16 v[8:11], a[108:111], v[68:75], v150
s_waitcnt lgkmcnt(7)
ds_bpermute_b32 v112, v6, v112
v_smfmac_f32_16x16x64_bf16 v[8:11], v[114:117], v[76:83], v179
ds_bpermute_b32 v113, v6, v113
v_smfmac_f32_16x16x64_bf16 v[12:15], v[114:117], v[76:83], v179 abid:1
ds_read_b128 v[114:117], v2 offset:128
v_add_u32_sdwa v76, s42, v126 dst_sel:DWORD dst_unused:UNUSED_PAD src0_sel:DWORD src1_sel:WORD_0
v_smfmac_f32_16x16x64_bf16 v[12:15], a[76:79], v[60:67], v146 abid:1
ds_read_u16 v76, v76
v_add_u32_sdwa v77, s42, v126 dst_sel:DWORD dst_unused:UNUSED_PAD src0_sel:DWORD src1_sel:WORD_1
v_smfmac_f32_16x16x64_bf16 v[12:15], a[112:115], v[68:75], v150 abid:1
buffer_store_dwordx4 v[92:95], v4, s[20:23], s46 offen offset:128 sc1
s_mov_b64 vcc, s[82:83]
ds_read_u16 v77, v77
v_cndmask_b32_dpp v104, v100, v104, vcc quad_perm:[1,0,3,2] row_mask:0xf bank_mask:0xf
v_cndmask_b32_dpp v105, v101, v105, vcc quad_perm:[1,0,3,2] row_mask:0xf bank_mask:0xf
v_smfmac_f32_16x16x64_bf16 v[24:27], a[88:91], v[60:67], v148
ds_read_b128 v[44:47], v0 offset:8192
v_add_u32_sdwa v78, s42, v127 dst_sel:DWORD dst_unused:UNUSED_PAD src0_sel:DWORD src1_sel:WORD_0
v_smfmac_f32_16x16x64_bf16 v[24:27], a[124:127], v[68:75], v152
ds_read_u16 v78, v78
v_cndmask_b32_dpp v106, v102, v106, vcc quad_perm:[1,0,3,2] row_mask:0xf bank_mask:0xf
v_smfmac_f32_16x16x64_bf16 v[28:31], a[92:95], v[60:67], v148 abid:1
ds_read_b128 v[48:51], v1 offset:8192
v_cndmask_b32_dpp v107, v103, v107, vcc quad_perm:[1,0,3,2] row_mask:0xf bank_mask:0xf
v_smfmac_f32_16x16x64_bf16 v[28:31], a[128:131], v[68:75], v152 abid:1
ds_read_b128 v[52:55], v0 offset:10240
v_add_u32_sdwa v79, s42, v127 dst_sel:DWORD dst_unused:UNUSED_PAD src0_sel:DWORD src1_sel:WORD_1
v_smfmac_f32_16x16x64_bf16 v[32:35], a[96:99], v[60:67], v149
ds_read_u16 v79, v79
v_add_u32_sdwa v80, s42, v128 dst_sel:DWORD dst_unused:UNUSED_PAD src0_sel:DWORD src1_sel:WORD_0
v_smfmac_f32_16x16x64_bf16 v[32:35], a[132:135], v[68:75], v153
ds_read_u16 v80, v80
v_add_u32_sdwa v81, s42, v128 dst_sel:DWORD dst_unused:UNUSED_PAD src0_sel:DWORD src1_sel:WORD_1
v_smfmac_f32_16x16x64_bf16 v[16:19], a[80:83], v[60:67], v147
buffer_store_dwordx4 v[104:107], v4, s[20:23], s46 offen offset:1280 sc1
s_mov_b64 vcc, s[80:81]
ds_read_b128 v[56:59], v1 offset:10240
v_add_u32_sdwa v82, s42, v129 dst_sel:DWORD dst_unused:UNUSED_PAD src0_sel:DWORD src1_sel:WORD_0
v_add_u32_sdwa v83, s42, v129 dst_sel:DWORD dst_unused:UNUSED_PAD src0_sel:DWORD src1_sel:WORD_1
v_smfmac_f32_16x16x64_bf16 v[16:19], a[116:119], v[68:75], v151
s_waitcnt lgkmcnt(9)
ds_read_b128 v[92:95], v0 offset:12288
v_add_u32_sdwa v100, s42, v130 dst_sel:DWORD dst_unused:UNUSED_PAD src0_sel:DWORD src1_sel:WORD_0
v_smfmac_f32_16x16x64_bf16 v[16:19], v[114:117], v[84:91], v180 abid:1
ds_read_u16 v81, v81
v_add_u32_sdwa v101, s42, v130 dst_sel:DWORD dst_unused:UNUSED_PAD src0_sel:DWORD src1_sel:WORD_1
v_smfmac_f32_16x16x64_bf16 v[12:15], v[114:117], v[84:91], v180
ds_read_b128 v[96:99], v1 offset:12288
v_add_u32_sdwa v102, s42, v131 dst_sel:DWORD dst_unused:UNUSED_PAD src0_sel:DWORD src1_sel:WORD_0
v_smfmac_f32_16x16x64_bf16 v[20:23], v[114:117], v[84:91], v181
ds_read_u16 v82, v82
v_add_u32_sdwa v103, s42, v131 dst_sel:DWORD dst_unused:UNUSED_PAD src0_sel:DWORD src1_sel:WORD_1
v_smfmac_f32_16x16x64_bf16 v[20:23], a[84:87], v[60:67], v147 abid:1
ds_read_u16 v100, v100
v_add_u32_sdwa v104, s42, v132 dst_sel:DWORD dst_unused:UNUSED_PAD src0_sel:DWORD src1_sel:WORD_0
v_smfmac_f32_16x16x64_bf16 v[20:23], a[120:123], v[68:75], v151 abid:1
ds_read_u16 v83, v83
v_add_u32_sdwa v105, s42, v132 dst_sel:DWORD dst_unused:UNUSED_PAD src0_sel:DWORD src1_sel:WORD_1
v_smfmac_f32_16x16x64_bf16 v[36:39], a[100:103], v[60:67], v149 abid:1
buffer_store_dwordx2 v[112:113], v5, s[20:23], s46 offen
ds_read_b128 v[114:117], v2 offset:192
v_add_u32_sdwa v106, s42, v133 dst_sel:DWORD dst_unused:UNUSED_PAD src0_sel:DWORD src1_sel:WORD_0
v_smfmac_f32_16x16x64_bf16 v[36:39], a[136:139], v[68:75], v153 abid:1
s_mov_b32 s46, s48
ds_read_u16 v101, v101
v_add_u32_sdwa v107, s42, v133 dst_sel:DWORD dst_unused:UNUSED_PAD src0_sel:DWORD src1_sel:WORD_1
v_smfmac_f32_16x16x64_bf16 v[40:43], a[104:107], v[60:67], v175
s_mov_b32 s48, s49
ds_read_u16 v102, v102
v_add_u32_sdwa v84, s42, v134 dst_sel:DWORD dst_unused:UNUSED_PAD src0_sel:DWORD src1_sel:WORD_0
v_smfmac_f32_16x16x64_bf16 v[40:43], a[140:143], v[68:75], v175 abid:1
s_waitcnt lgkmcnt(13)
ds_read_u16 v103, v103
v_add_u32_sdwa v85, s42, v134 dst_sel:DWORD dst_unused:UNUSED_PAD src0_sel:DWORD src1_sel:WORD_1
v_smfmac_f32_16x16x64_bf16 v[8:11], a[144:147], v[44:51], v154
s_waitcnt lgkmcnt(10)
ds_read_u16 v104, v104
v_add_u32_sdwa v86, s42, v135 dst_sel:DWORD dst_unused:UNUSED_PAD src0_sel:DWORD src1_sel:WORD_0
v_smfmac_f32_16x16x64_bf16 v[8:11], a[180:183], v[52:59], v158
s_waitcnt lgkmcnt(8)
ds_read_u16 v105, v105
v_add_u32_sdwa v87, s42, v135 dst_sel:DWORD dst_unused:UNUSED_PAD src0_sel:DWORD src1_sel:WORD_1
v_smfmac_f32_16x16x64_bf16 v[8:11], a[216:219], v[92:99], v162
s_add_u32 m0, s44, 0
ds_read_u16 v106, v106
v_add_u32_sdwa v88, s42, v136 dst_sel:DWORD dst_unused:UNUSED_PAD src0_sel:DWORD src1_sel:WORD_0
v_smfmac_f32_16x16x64_bf16 v[24:27], a[160:163], v[44:51], v156
buffer_load_dwordx4 v3, s[16:19], s45 offen offset:0 nt lds
v_add_u32_sdwa v89, s42, v136 dst_sel:DWORD dst_unused:UNUSED_PAD src0_sel:DWORD src1_sel:WORD_1
v_smfmac_f32_16x16x64_bf16 v[24:27], a[196:199], v[52:59], v160
s_mov_b32 s49, s50
ds_read_u16 v107, v107
v_add_u32_sdwa v90, s42, v137 dst_sel:DWORD dst_unused:UNUSED_PAD src0_sel:DWORD src1_sel:WORD_0
v_smfmac_f32_16x16x64_bf16 v[24:27], a[232:235], v[92:99], v164
s_waitcnt lgkmcnt(7)
s_waitcnt vmcnt(6)
ds_read_u16 v84, v84
v_add_u32_sdwa v91, s42, v137 dst_sel:DWORD dst_unused:UNUSED_PAD src0_sel:DWORD src1_sel:WORD_1
v_smfmac_f32_16x16x64_bf16 v[24:27], v[114:117], v[76:83], v182
s_mov_b32 s50, s45
ds_read_u16 v85, v85
v_smfmac_f32_16x16x64_bf16 v[20:23], v[114:117], v[76:83], v181 abid:1
ds_read_u16 v86, v86
v_smfmac_f32_16x16x64_bf16 v[28:31], v[114:117], v[76:83], v182 abid:1
ds_read_b128 v[114:117], v2 offset:256
v_add_u32_sdwa v76, s4, v118 dst_sel:DWORD dst_unused:UNUSED_PAD src0_sel:DWORD src1_sel:WORD_0
v_smfmac_f32_16x16x64_bf16 v[28:31], a[164:167], v[44:51], v156 abid:1
ds_read_u16 v87, v87
v_add_u32_sdwa v77, s4, v118 dst_sel:DWORD dst_unused:UNUSED_PAD src0_sel:DWORD src1_sel:WORD_1
v_smfmac_f32_16x16x64_bf16 v[28:31], a[200:203], v[52:59], v160 abid:1
ds_read_u16 v88, v88
v_add_u32_sdwa v78, s4, v119 dst_sel:DWORD dst_unused:UNUSED_PAD src0_sel:DWORD src1_sel:WORD_0
v_smfmac_f32_16x16x64_bf16 v[28:31], a[236:239], v[92:99], v164 abid:1
ds_read_b128 v[60:63], v0 offset:14336
v_add_u32_sdwa v79, s4, v119 dst_sel:DWORD dst_unused:UNUSED_PAD src0_sel:DWORD src1_sel:WORD_1
v_smfmac_f32_16x16x64_bf16 v[12:15], a[148:151], v[44:51], v154 abid:1
ds_read_u16 v89, v89
v_add_u32_sdwa v80, s4, v120 dst_sel:DWORD dst_unused:UNUSED_PAD src0_sel:DWORD src1_sel:WORD_0
v_smfmac_f32_16x16x64_bf16 v[12:15], a[184:187], v[52:59], v158 abid:1
s_add_u32 m0, s44, 3840
ds_read_b128 v[64:67], v1 offset:14336
v_add_u32_sdwa v81, s4, v120 dst_sel:DWORD dst_unused:UNUSED_PAD src0_sel:DWORD src1_sel:WORD_1
v_smfmac_f32_16x16x64_bf16 v[12:15], a[220:223], v[92:99], v162 abid:1
buffer_load_dwordx4 v3, s[16:19], s45 offen offset:256 nt lds
v_add_u32_sdwa v82, s4, v121 dst_sel:DWORD dst_unused:UNUSED_PAD src0_sel:DWORD src1_sel:WORD_0
v_smfmac_f32_16x16x64_bf16 v[32:35], a[168:171], v[44:51], v157
ds_read_b128 v[68:71], v0 offset:16384
v_add_u32_sdwa v83, s4, v121 dst_sel:DWORD dst_unused:UNUSED_PAD src0_sel:DWORD src1_sel:WORD_1
v_smfmac_f32_16x16x64_bf16 v[32:35], a[204:207], v[52:59], v161
ds_read_u16 v90, v90
v_smfmac_f32_16x16x64_bf16 v[32:35], a[240:243], v[92:99], v165
s_waitcnt lgkmcnt(7)
ds_read_b128 v[72:75], v1 offset:16384
v_add_u32 v0, s43, v0
v_smfmac_f32_16x16x64_bf16 v[32:35], v[114:117], v[100:107], v183 abid:1
ds_read_u16 v91, v91
v_add_u32 v1, s43, v1
v_smfmac_f32_16x16x64_bf16 v[28:31], v[114:117], v[100:107], v183
v_smfmac_f32_16x16x64_bf16 v[36:39], v[114:117], v[100:107], v184
ds_read_b128 v[114:117], v2 offset:320
v_smfmac_f32_16x16x64_bf16 v[36:39], a[172:175], v[44:51], v157 abid:1
s_add_u32 m0, s44, 7680
v_smfmac_f32_16x16x64_bf16 v[36:39], a[208:211], v[52:59], v161 abid:1
buffer_load_dwordx4 v3, s[16:19], s45 offen offset:512 nt lds
v_smfmac_f32_16x16x64_bf16 v[36:39], a[244:247], v[92:99], v165 abid:1
v_smfmac_f32_16x16x64_bf16 v[16:19], a[152:155], v[44:51], v155
s_add_u32 m0, s44, 11520
v_smfmac_f32_16x16x64_bf16 v[16:19], a[188:191], v[52:59], v159
buffer_load_dwordx4 v3, s[16:19], s45 offen offset:768 nt lds
v_smfmac_f32_16x16x64_bf16 v[16:19], a[224:227], v[92:99], v163
s_mov_b64 exec, s[62:63]
ds_write_b32 v0, v7 offset:18432
s_mov_b64 exec, -1
v_smfmac_f32_16x16x64_bf16 v[20:23], a[156:159], v[44:51], v155 abid:1
s_add_u32 m0, s44, s8
v_smfmac_f32_16x16x64_bf16 v[20:23], a[192:195], v[52:59], v159 abid:1
s_mov_b64 exec, s[10:11]
buffer_load_dwordx4 v3, s[16:19], s7 offen offset:896 nt lds
s_mov_b64 exec, -1
v_smfmac_f32_16x16x64_bf16 v[20:23], a[228:231], v[92:99], v163 abid:1
s_add_u32 s44, s44, s5
s_cmp_ge_u32 s44, 148480
s_cselect_b32 s44, s9, s44
v_smfmac_f32_16x16x64_bf16 v[40:43], a[176:179], v[44:51], v176
v_smfmac_f32_16x16x64_bf16 v[40:43], a[212:215], v[52:59], v176 abid:1
v_smfmac_f32_16x16x64_bf16 v[40:43], a[248:251], v[92:99], v177
s_waitcnt lgkmcnt(0)
v_smfmac_f32_16x16x64_bf16 v[40:43], v[114:117], v[84:91], v185
v_smfmac_f32_16x16x64_bf16 v[36:39], v[114:117], v[84:91], v184 abid:1
s_barrier
v_smfmac_f32_16x16x64_bf16 v[8:11], a[252:255], v[60:67], v166
s_mov_b32 s42, s4
ds_read_b32 v7, v0 offset:18432
v_smfmac_f32_16x16x64_bf16 v[8:11], v[218:221], v[68:75], v170
ds_read_b128 v[44:47], v0 offset:0
v_add_u32_sdwa v84, s42, v122 dst_sel:DWORD dst_unused:UNUSED_PAD src0_sel:DWORD src1_sel:WORD_0
v_smfmac_f32_16x16x64_bf16 v[12:15], v[186:189], v[60:67], v166 abid:1
ds_read_b128 v[48:51], v1 offset:0
v_add_u32_sdwa v85, s42, v122 dst_sel:DWORD dst_unused:UNUSED_PAD src0_sel:DWORD src1_sel:WORD_1
v_smfmac_f32_16x16x64_bf16 v[12:15], v[222:225], v[68:75], v170 abid:1
ds_read_b128 v[52:55], v0 offset:2048
v_add_u32_sdwa v86, s42, v123 dst_sel:DWORD dst_unused:UNUSED_PAD src0_sel:DWORD src1_sel:WORD_0
v_smfmac_f32_16x16x64_bf16 v[16:19], v[190:193], v[60:67], v167
ds_read_b128 v[56:59], v1 offset:2048
v_cvt_pk_bf16_f32 v92, v8, v9
v_smfmac_f32_16x16x64_bf16 v[16:19], v[226:229], v[68:75], v171
ds_read_u16 v76, v76
v_cvt_pk_bf16_f32 v93, v10, v11
v_smfmac_f32_16x16x64_bf16 v[20:23], v[194:197], v[60:67], v167 abid:1
ds_read_b128 v[8:11], v2 offset:1024
v_cvt_pk_bf16_f32 v94, v12, v13
v_smfmac_f32_16x16x64_bf16 v[20:23], v[230:233], v[68:75], v171 abid:1
ds_read_u16 v77, v77
v_cvt_pk_bf16_f32 v95, v14, v15
v_smfmac_f32_16x16x64_bf16 v[24:27], v[198:201], v[60:67], v168
ds_read_b128 v[12:15], v2 offset:1088
v_cvt_pk_bf16_f32 v96, v16, v17
v_smfmac_f32_16x16x64_bf16 v[24:27], v[234:237], v[68:75], v172
s_waitcnt lgkmcnt(8)
ds_read_u16 v78, v78
v_cvt_pk_bf16_f32 v97, v18, v19
v_readfirstlane_b32 s56, v7
v_smfmac_f32_16x16x64_bf16 v[28:31], v[202:205], v[60:67], v168 abid:1
s_lshr_b32 s60, s56, 4
ds_read_b128 v[16:19], v2 offset:1152
v_cvt_pk_bf16_f32 v98, v20, v21
v_smfmac_f32_16x16x64_bf16 v[28:31], v[238:241], v[68:75], v172 abid:1
s_mul_i32 s60, s60, 884736
ds_read_u16 v79, v79
v_cvt_pk_bf16_f32 v99, v22, v23
v_smfmac_f32_16x16x64_bf16 v[32:35], v[206:209], v[60:67], v169
s_mul_i32 s61, s56, 18432
ds_read_b128 v[20:23], v2 offset:1216
v_cvt_pk_bf16_f32 v100, v24, v25
v_smfmac_f32_16x16x64_bf16 v[32:35], v[242:245], v[68:75], v173
s_add_u32 s60, s60, s57
ds_read_u16 v80, v80
v_cvt_pk_bf16_f32 v101, v26, v27
v_smfmac_f32_16x16x64_bf16 v[36:39], v[210:213], v[60:67], v169 abid:1
s_add_u32 s45, s60, s61
ds_read_b128 v[24:27], v2 offset:1280
v_cvt_pk_bf16_f32 v102, v28, v29
v_smfmac_f32_16x16x64_bf16 v[36:39], v[246:249], v[68:75], v173 abid:1
ds_read_u16 v81, v81
v_cvt_pk_bf16_f32 v103, v30, v31
v_smfmac_f32_16x16x64_bf16 v[40:43], v[214:217], v[60:67], v177 abid:1
s_cmp_lt_u32 s56, s64
ds_read_b128 v[28:31], v2 offset:1344
v_cvt_pk_bf16_f32 v104, v32, v33
v_smfmac_f32_16x16x64_bf16 v[40:43], v[250:253], v[68:75], v178
s_waitcnt lgkmcnt(10)
v_cvt_pk_bf16_f32 v105, v34, v35
s_cbranch_scc1 L_loopck
s_mov_b32 s41, 0
s_mov_b32 s15, 3
s_mov_b32 s12, 7
s_mov_b32 s92, 4
s_mov_b32 s87, 4
s_mov_b32 s59, -1
.p2align 3
L_loopnk:
v_smfmac_f32_16x16x64_bf16 v[8:11], a[0:3], v[44:51], v138
ds_read_b128 v[32:35], v2 offset:1408
v_cvt_pk_bf16_f32 v106, v36, v37
v_smfmac_f32_16x16x64_bf16 v[8:11], a[36:39], v[52:59], v142
s_waitcnt lgkmcnt(9)
v_cvt_pk_bf16_f32 v107, v38, v39
v_smfmac_f32_16x16x64_bf16 v[12:15], a[4:7], v[44:51], v138 abid:1
ds_read_b128 v[36:39], v2 offset:1472
v_cvt_pk_bf16_f32 v112, v40, v41
v_smfmac_f32_16x16x64_bf16 v[12:15], a[40:43], v[52:59], v142 abid:1
s_waitcnt lgkmcnt(8)
ds_read_b128 v[60:63], v0 offset:4096
v_cvt_pk_bf16_f32 v113, v42, v43
v_smfmac_f32_16x16x64_bf16 v[16:19], a[8:11], v[44:51], v139
s_cmp_eq_u32 s4, 129920
ds_read_b128 v[40:43], v2 offset:1536
v_cndmask_b32_dpp v108, v96, v92, vcc quad_perm:[1,0,3,2] row_mask:0xf bank_mask:0xf
v_smfmac_f32_16x16x64_bf16 v[16:19], a[44:47], v[52:59], v143
s_waitcnt lgkmcnt(8)
ds_read_u16 v82, v82
v_cndmask_b32_dpp v109, v97, v93, vcc quad_perm:[1,0,3,2] row_mask:0xf bank_mask:0xf
v_smfmac_f32_16x16x64_bf16 v[20:23], a[12:15], v[44:51], v139 abid:1
s_cselect_b32 s43, -129920, s5
ds_read_u16 v84, v84
v_cndmask_b32_dpp v110, v98, v94, vcc quad_perm:[1,0,3,2] row_mask:0xf bank_mask:0xf
v_smfmac_f32_16x16x64_bf16 v[20:23], a[48:51], v[52:59], v143 abid:1
s_waitcnt lgkmcnt(8)
ds_read_b128 v[64:67], v1 offset:4096
v_cndmask_b32_dpp v111, v99, v95, vcc quad_perm:[1,0,3,2] row_mask:0xf bank_mask:0xf
v_smfmac_f32_16x16x64_bf16 v[24:27], a[16:19], v[44:51], v140
s_add_u32 s4, s4, s43
ds_read_b128 v[68:71], v0 offset:6144
v_add_u32_sdwa v87, s42, v123 dst_sel:DWORD dst_unused:UNUSED_PAD src0_sel:DWORD src1_sel:WORD_1
v_smfmac_f32_16x16x64_bf16 v[24:27], a[52:55], v[52:59], v144
buffer_store_dwordx4 v[108:111], v4, s[20:23], s46 offen offset:0 sc1
s_mov_b64 vcc, s[82:83]
s_waitcnt lgkmcnt(8)
ds_read_b128 v[72:75], v1 offset:6144
v_cndmask_b32_dpp v96, v92, v96, vcc quad_perm:[1,0,3,2] row_mask:0xf bank_mask:0xf
v_cndmask_b32_dpp v97, v93, v97, vcc quad_perm:[1,0,3,2] row_mask:0xf bank_mask:0xf
v_smfmac_f32_16x16x64_bf16 v[28:31], a[20:23], v[44:51], v140 abid:1
s_add_u32 s41, s41, 1
ds_read_u16 v83, v83
v_cndmask_b32_dpp v98, v94, v98, vcc quad_perm:[1,0,3,2] row_mask:0xf bank_mask:0xf
v_smfmac_f32_16x16x64_bf16 v[28:31], a[56:59], v[52:59], v144 abid:1
s_waitcnt lgkmcnt(9)
ds_read_b128 v[114:117], v2 offset:64
v_cndmask_b32_dpp v99, v95, v99, vcc quad_perm:[1,0,3,2] row_mask:0xf bank_mask:0xf
v_smfmac_f32_16x16x64_bf16 v[32:35], a[24:27], v[44:51], v141
ds_read_u16 v85, v85
v_add_u32_sdwa v88, s42, v124 dst_sel:DWORD dst_unused:UNUSED_PAD src0_sel:DWORD src1_sel:WORD_0
v_smfmac_f32_16x16x64_bf16 v[32:35], a[60:63], v[52:59], v145
s_waitcnt lgkmcnt(10)
ds_read_u16 v86, v86
v_add_u32_sdwa v89, s42, v124 dst_sel:DWORD dst_unused:UNUSED_PAD src0_sel:DWORD src1_sel:WORD_1
v_smfmac_f32_16x16x64_bf16 v[36:39], a[28:31], v[44:51], v141 abid:1
ds_read_u16 v87, v87
v_add_u32_sdwa v90, s42, v125 dst_sel:DWORD dst_unused:UNUSED_PAD src0_sel:DWORD src1_sel:WORD_0
v_smfmac_f32_16x16x64_bf16 v[36:39], a[64:67], v[52:59], v145 abid:1
s_waitcnt lgkmcnt(10)
ds_read_u16 v88, v88
v_add_u32_sdwa v91, s42, v125 dst_sel:DWORD dst_unused:UNUSED_PAD src0_sel:DWORD src1_sel:WORD_1
v_smfmac_f32_16x16x64_bf16 v[40:43], a[32:35], v[44:51], v174
buffer_store_dwordx4 v[96:99], v4, s[20:23], s46 offen offset:1152 sc1
s_mov_b64 vcc, s[80:81]
ds_read_u16 v89, v89
v_cndmask_b32_dpp v92, v104, v100, vcc quad_perm:[1,0,3,2] row_mask:0xf bank_mask:0xf
v_cndmask_b32_dpp v93, v105, v101, vcc quad_perm:[1,0,3,2] row_mask:0xf bank_mask:0xf
v_smfmac_f32_16x16x64_bf16 v[40:43], a[68:71], v[52:59], v174 abid:1
s_waitcnt lgkmcnt(9)
ds_read_u16 v90, v90
v_cndmask_b32_dpp v94, v106, v102, vcc quad_perm:[1,0,3,2] row_mask:0xf bank_mask:0xf
v_smfmac_f32_16x16x64_bf16 v[8:11], a[72:75], v[60:67], v146
s_waitcnt lgkmcnt(8)
ds_read_u16 v91, v91
v_cndmask_b32_dpp v95, v107, v103, vcc quad_perm:[1,0,3,2] row_mask:0xf bank_mask:0xf
v_smfmac_f32_16x16x64_bf16 v[8:11], a[108:111], v[68:75], v150
s_waitcnt lgkmcnt(7)
ds_bpermute_b32 v112, v6, v112
v_smfmac_f32_16x16x64_bf16 v[8:11], v[114:117], v[76:83], v179
ds_bpermute_b32 v113, v6, v113
v_smfmac_f32_16x16x64_bf16 v[12:15], v[114:117], v[76:83], v179 abid:1
ds_read_b128 v[114:117], v2 offset:128
v_add_u32_sdwa v76, s42, v126 dst_sel:DWORD dst_unused:UNUSED_PAD src0_sel:DWORD src1_sel:WORD_0
v_smfmac_f32_16x16x64_bf16 v[12:15], a[76:79], v[60:67], v146 abid:1
ds_read_u16 v76, v76
v_add_u32_sdwa v77, s42, v126 dst_sel:DWORD dst_unused:UNUSED_PAD src0_sel:DWORD src1_sel:WORD_1
v_smfmac_f32_16x16x64_bf16 v[12:15], a[112:115], v[68:75], v150 abid:1
buffer_store_dwordx4 v[92:95], v4, s[20:23], s46 offen offset:128 sc1
s_mov_b64 vcc, s[82:83]
ds_read_u16 v77, v77
v_cndmask_b32_dpp v104, v100, v104, vcc quad_perm:[1,0,3,2] row_mask:0xf bank_mask:0xf
v_cndmask_b32_dpp v105, v101, v105, vcc quad_perm:[1,0,3,2] row_mask:0xf bank_mask:0xf
v_smfmac_f32_16x16x64_bf16 v[24:27], a[88:91], v[60:67], v148
ds_read_b128 v[44:47], v0 offset:8192
v_add_u32_sdwa v78, s42, v127 dst_sel:DWORD dst_unused:UNUSED_PAD src0_sel:DWORD src1_sel:WORD_0
v_smfmac_f32_16x16x64_bf16 v[24:27], a[124:127], v[68:75], v152
ds_read_u16 v78, v78
v_cndmask_b32_dpp v106, v102, v106, vcc quad_perm:[1,0,3,2] row_mask:0xf bank_mask:0xf
v_smfmac_f32_16x16x64_bf16 v[28:31], a[92:95], v[60:67], v148 abid:1
ds_read_b128 v[48:51], v1 offset:8192
v_cndmask_b32_dpp v107, v103, v107, vcc quad_perm:[1,0,3,2] row_mask:0xf bank_mask:0xf
v_smfmac_f32_16x16x64_bf16 v[28:31], a[128:131], v[68:75], v152 abid:1
ds_read_b128 v[52:55], v0 offset:10240
v_add_u32_sdwa v79, s42, v127 dst_sel:DWORD dst_unused:UNUSED_PAD src0_sel:DWORD src1_sel:WORD_1
v_smfmac_f32_16x16x64_bf16 v[32:35], a[96:99], v[60:67], v149
ds_read_u16 v79, v79
v_add_u32_sdwa v80, s42, v128 dst_sel:DWORD dst_unused:UNUSED_PAD src0_sel:DWORD src1_sel:WORD_0
v_smfmac_f32_16x16x64_bf16 v[32:35], a[132:135], v[68:75], v153
ds_read_u16 v80, v80
v_add_u32_sdwa v81, s42, v128 dst_sel:DWORD dst_unused:UNUSED_PAD src0_sel:DWORD src1_sel:WORD_1
v_smfmac_f32_16x16x64_bf16 v[16:19], a[80:83], v[60:67], v147
buffer_store_dwordx4 v[104:107], v4, s[20:23], s46 offen offset:1280 sc1
s_mov_b64 vcc, s[80:81]
ds_read_b128 v[56:59], v1 offset:10240
v_add_u32_sdwa v82, s42, v129 dst_sel:DWORD dst_unused:UNUSED_PAD src0_sel:DWORD src1_sel:WORD_0
v_add_u32_sdwa v83, s42, v129 dst_sel:DWORD dst_unused:UNUSED_PAD src0_sel:DWORD src1_sel:WORD_1
v_smfmac_f32_16x16x64_bf16 v[16:19], a[116:119], v[68:75], v151
s_waitcnt lgkmcnt(9)
ds_read_b128 v[92:95], v0 offset:12288
v_add_u32_sdwa v100, s42, v130 dst_sel:DWORD dst_unused:UNUSED_PAD src0_sel:DWORD src1_sel:WORD_0
v_smfmac_f32_16x16x64_bf16 v[16:19], v[114:117], v[84:91], v180 abid:1
ds_read_u16 v81, v81
v_add_u32_sdwa v101, s42, v130 dst_sel:DWORD dst_unused:UNUSED_PAD src0_sel:DWORD src1_sel:WORD_1
v_smfmac_f32_16x16x64_bf16 v[12:15], v[114:117], v[84:91], v180
ds_read_b128 v[96:99], v1 offset:12288
v_add_u32_sdwa v102, s42, v131 dst_sel:DWORD dst_unused:UNUSED_PAD src0_sel:DWORD src1_sel:WORD_0
v_smfmac_f32_16x16x64_bf16 v[20:23], v[114:117], v[84:91], v181
ds_read_u16 v82, v82
v_add_u32_sdwa v103, s42, v131 dst_sel:DWORD dst_unused:UNUSED_PAD src0_sel:DWORD src1_sel:WORD_1
v_smfmac_f32_16x16x64_bf16 v[20:23], a[84:87], v[60:67], v147 abid:1
ds_read_u16 v100, v100
v_add_u32_sdwa v104, s42, v132 dst_sel:DWORD dst_unused:UNUSED_PAD src0_sel:DWORD src1_sel:WORD_0
v_smfmac_f32_16x16x64_bf16 v[20:23], a[120:123], v[68:75], v151 abid:1
ds_read_u16 v83, v83
v_add_u32_sdwa v105, s42, v132 dst_sel:DWORD dst_unused:UNUSED_PAD src0_sel:DWORD src1_sel:WORD_1
v_smfmac_f32_16x16x64_bf16 v[36:39], a[100:103], v[60:67], v149 abid:1
buffer_store_dwordx2 v[112:113], v5, s[20:23], s46 offen
ds_read_b128 v[114:117], v2 offset:192
v_add_u32_sdwa v106, s42, v133 dst_sel:DWORD dst_unused:UNUSED_PAD src0_sel:DWORD src1_sel:WORD_0
v_smfmac_f32_16x16x64_bf16 v[36:39], a[136:139], v[68:75], v153 abid:1
s_mov_b32 s22, 75497472
ds_read_u16 v101, v101
v_add_u32_sdwa v107, s42, v133 dst_sel:DWORD dst_unused:UNUSED_PAD src0_sel:DWORD src1_sel:WORD_1
v_smfmac_f32_16x16x64_bf16 v[40:43], a[104:107], v[60:67], v175
s_mov_b32 s46, s48
ds_read_u16 v102, v102
v_add_u32_sdwa v84, s42, v134 dst_sel:DWORD dst_unused:UNUSED_PAD src0_sel:DWORD src1_sel:WORD_0
v_smfmac_f32_16x16x64_bf16 v[40:43], a[140:143], v[68:75], v175 abid:1
s_waitcnt lgkmcnt(13)
ds_read_u16 v103, v103
v_add_u32_sdwa v85, s42, v134 dst_sel:DWORD dst_unused:UNUSED_PAD src0_sel:DWORD src1_sel:WORD_1
v_smfmac_f32_16x16x64_bf16 v[8:11], a[144:147], v[44:51], v154
s_waitcnt lgkmcnt(10)
ds_read_u16 v104, v104
v_add_u32_sdwa v86, s42, v135 dst_sel:DWORD dst_unused:UNUSED_PAD src0_sel:DWORD src1_sel:WORD_0
v_smfmac_f32_16x16x64_bf16 v[8:11], a[180:183], v[52:59], v158
s_waitcnt lgkmcnt(8)
ds_read_u16 v105, v105
v_add_u32_sdwa v87, s42, v135 dst_sel:DWORD dst_unused:UNUSED_PAD src0_sel:DWORD src1_sel:WORD_1
v_smfmac_f32_16x16x64_bf16 v[8:11], a[216:219], v[92:99], v162
s_mov_b32 s48, s49
ds_read_u16 v106, v106
v_add_u32_sdwa v88, s42, v136 dst_sel:DWORD dst_unused:UNUSED_PAD src0_sel:DWORD src1_sel:WORD_0
v_smfmac_f32_16x16x64_bf16 v[24:27], a[160:163], v[44:51], v156
s_mov_b32 s49, s50
s_add_u32 s50, s50, 4718592
v_add_u32_sdwa v89, s42, v136 dst_sel:DWORD dst_unused:UNUSED_PAD src0_sel:DWORD src1_sel:WORD_1
v_smfmac_f32_16x16x64_bf16 v[24:27], a[196:199], v[52:59], v160
ds_read_u16 v107, v107
v_add_u32_sdwa v90, s42, v137 dst_sel:DWORD dst_unused:UNUSED_PAD src0_sel:DWORD src1_sel:WORD_0
v_smfmac_f32_16x16x64_bf16 v[24:27], a[232:235], v[92:99], v164
s_waitcnt lgkmcnt(7)
ds_read_u16 v84, v84
v_add_u32_sdwa v91, s42, v137 dst_sel:DWORD dst_unused:UNUSED_PAD src0_sel:DWORD src1_sel:WORD_1
v_smfmac_f32_16x16x64_bf16 v[24:27], v[114:117], v[76:83], v182
ds_read_u16 v85, v85
v_smfmac_f32_16x16x64_bf16 v[20:23], v[114:117], v[76:83], v181 abid:1
ds_read_u16 v86, v86
v_smfmac_f32_16x16x64_bf16 v[28:31], v[114:117], v[76:83], v182 abid:1
ds_read_b128 v[114:117], v2 offset:256
v_add_u32_sdwa v76, s4, v118 dst_sel:DWORD dst_unused:UNUSED_PAD src0_sel:DWORD src1_sel:WORD_0
v_smfmac_f32_16x16x64_bf16 v[28:31], a[164:167], v[44:51], v156 abid:1
ds_read_u16 v87, v87
v_add_u32_sdwa v77, s4, v118 dst_sel:DWORD dst_unused:UNUSED_PAD src0_sel:DWORD src1_sel:WORD_1
v_smfmac_f32_16x16x64_bf16 v[28:31], a[200:203], v[52:59], v160 abid:1
ds_read_u16 v88, v88
v_add_u32_sdwa v78, s4, v119 dst_sel:DWORD dst_unused:UNUSED_PAD src0_sel:DWORD src1_sel:WORD_0
v_smfmac_f32_16x16x64_bf16 v[28:31], a[236:239], v[92:99], v164 abid:1
ds_read_b128 v[60:63], v0 offset:14336
v_add_u32_sdwa v79, s4, v119 dst_sel:DWORD dst_unused:UNUSED_PAD src0_sel:DWORD src1_sel:WORD_1
v_smfmac_f32_16x16x64_bf16 v[12:15], a[148:151], v[44:51], v154 abid:1
ds_read_u16 v89, v89
v_add_u32_sdwa v80, s4, v120 dst_sel:DWORD dst_unused:UNUSED_PAD src0_sel:DWORD src1_sel:WORD_0
v_smfmac_f32_16x16x64_bf16 v[12:15], a[184:187], v[52:59], v158 abid:1
ds_read_b128 v[64:67], v1 offset:14336
v_add_u32_sdwa v81, s4, v120 dst_sel:DWORD dst_unused:UNUSED_PAD src0_sel:DWORD src1_sel:WORD_1
v_smfmac_f32_16x16x64_bf16 v[12:15], a[220:223], v[92:99], v162 abid:1
v_add_u32_sdwa v82, s4, v121 dst_sel:DWORD dst_unused:UNUSED_PAD src0_sel:DWORD src1_sel:WORD_0
v_smfmac_f32_16x16x64_bf16 v[32:35], a[168:171], v[44:51], v157
ds_read_b128 v[68:71], v0 offset:16384
v_add_u32_sdwa v83, s4, v121 dst_sel:DWORD dst_unused:UNUSED_PAD src0_sel:DWORD src1_sel:WORD_1
v_smfmac_f32_16x16x64_bf16 v[32:35], a[204:207], v[52:59], v161
ds_read_u16 v90, v90
v_smfmac_f32_16x16x64_bf16 v[32:35], a[240:243], v[92:99], v165
s_waitcnt lgkmcnt(7)
ds_read_b128 v[72:75], v1 offset:16384
v_add_u32 v0, s43, v0
v_smfmac_f32_16x16x64_bf16 v[32:35], v[114:117], v[100:107], v183 abid:1
ds_read_u16 v91, v91
v_add_u32 v1, s43, v1
v_smfmac_f32_16x16x64_bf16 v[28:31], v[114:117], v[100:107], v183
v_smfmac_f32_16x16x64_bf16 v[36:39], v[114:117], v[100:107], v184
ds_read_b128 v[114:117], v2 offset:320
v_smfmac_f32_16x16x64_bf16 v[36:39], a[172:175], v[44:51], v157 abid:1
v_smfmac_f32_16x16x64_bf16 v[36:39], a[208:211], v[52:59], v161 abid:1
v_smfmac_f32_16x16x64_bf16 v[36:39], a[244:247], v[92:99], v165 abid:1
v_smfmac_f32_16x16x64_bf16 v[16:19], a[152:155], v[44:51], v155
v_smfmac_f32_16x16x64_bf16 v[16:19], a[188:191], v[52:59], v159
v_smfmac_f32_16x16x64_bf16 v[16:19], a[224:227], v[92:99], v163
v_smfmac_f32_16x16x64_bf16 v[20:23], a[156:159], v[44:51], v155 abid:1
v_smfmac_f32_16x16x64_bf16 v[20:23], a[192:195], v[52:59], v159 abid:1
v_smfmac_f32_16x16x64_bf16 v[20:23], a[228:231], v[92:99], v163 abid:1
v_smfmac_f32_16x16x64_bf16 v[40:43], a[176:179], v[44:51], v176
s_bitcmp1_b32 s92, s41
v_smfmac_f32_16x16x64_bf16 v[40:43], a[212:215], v[52:59], v176 abid:1
s_cbranch_scc1 L_loopnk_w
L_loopnk_wb:
v_smfmac_f32_16x16x64_bf16 v[40:43], a[248:251], v[92:99], v177
s_waitcnt lgkmcnt(0)
v_smfmac_f32_16x16x64_bf16 v[40:43], v[114:117], v[84:91], v185
v_smfmac_f32_16x16x64_bf16 v[36:39], v[114:117], v[84:91], v184 abid:1
s_waitcnt vmcnt(20)
s_barrier
L_loopnk_p3:
v_smfmac_f32_16x16x64_bf16 v[8:11], a[252:255], v[60:67], v166
s_mov_b32 s42, s4
v_smfmac_f32_16x16x64_bf16 v[8:11], v[218:221], v[68:75], v170
ds_read_b128 v[44:47], v0 offset:0
v_add_u32_sdwa v84, s42, v122 dst_sel:DWORD dst_unused:UNUSED_PAD src0_sel:DWORD src1_sel:WORD_0
v_smfmac_f32_16x16x64_bf16 v[12:15], v[186:189], v[60:67], v166 abid:1
ds_read_b128 v[48:51], v1 offset:0
v_add_u32_sdwa v85, s42, v122 dst_sel:DWORD dst_unused:UNUSED_PAD src0_sel:DWORD src1_sel:WORD_1
v_smfmac_f32_16x16x64_bf16 v[12:15], v[222:225], v[68:75], v170 abid:1
ds_read_b128 v[52:55], v0 offset:2048
v_add_u32_sdwa v86, s42, v123 dst_sel:DWORD dst_unused:UNUSED_PAD src0_sel:DWORD src1_sel:WORD_0
v_smfmac_f32_16x16x64_bf16 v[16:19], v[190:193], v[60:67], v167
ds_read_b128 v[56:59], v1 offset:2048
v_cvt_pk_bf16_f32 v92, v8, v9
v_smfmac_f32_16x16x64_bf16 v[16:19], v[226:229], v[68:75], v171
ds_read_u16 v76, v76
v_cvt_pk_bf16_f32 v93, v10, v11
v_smfmac_f32_16x16x64_bf16 v[20:23], v[194:197], v[60:67], v167 abid:1
ds_read_b128 v[8:11], v2 offset:1024
v_cvt_pk_bf16_f32 v94, v12, v13
v_smfmac_f32_16x16x64_bf16 v[20:23], v[230:233], v[68:75], v171 abid:1
ds_read_u16 v77, v77
v_cvt_pk_bf16_f32 v95, v14, v15
v_smfmac_f32_16x16x64_bf16 v[24:27], v[198:201], v[60:67], v168
ds_read_b128 v[12:15], v2 offset:1088
v_cvt_pk_bf16_f32 v96, v16, v17
v_smfmac_f32_16x16x64_bf16 v[24:27], v[234:237], v[68:75], v172
ds_read_u16 v78, v78
v_cvt_pk_bf16_f32 v97, v18, v19
v_smfmac_f32_16x16x64_bf16 v[28:31], v[202:205], v[60:67], v168 abid:1
ds_read_b128 v[16:19], v2 offset:1152
v_cvt_pk_bf16_f32 v98, v20, v21
v_smfmac_f32_16x16x64_bf16 v[28:31], v[238:241], v[68:75], v172 abid:1
ds_read_u16 v79, v79
v_cvt_pk_bf16_f32 v99, v22, v23
v_smfmac_f32_16x16x64_bf16 v[32:35], v[206:209], v[60:67], v169
ds_read_b128 v[20:23], v2 offset:1216
v_cvt_pk_bf16_f32 v100, v24, v25
v_smfmac_f32_16x16x64_bf16 v[32:35], v[242:245], v[68:75], v173
ds_read_u16 v80, v80
v_cvt_pk_bf16_f32 v101, v26, v27
v_smfmac_f32_16x16x64_bf16 v[36:39], v[210:213], v[60:67], v169 abid:1
ds_read_b128 v[24:27], v2 offset:1280
v_cvt_pk_bf16_f32 v102, v28, v29
v_smfmac_f32_16x16x64_bf16 v[36:39], v[246:249], v[68:75], v173 abid:1
ds_read_u16 v81, v81
v_cvt_pk_bf16_f32 v103, v30, v31
v_smfmac_f32_16x16x64_bf16 v[40:43], v[214:217], v[60:67], v177 abid:1
s_bitcmp1_b32 s12, s41
ds_read_b128 v[28:31], v2 offset:1344
v_cvt_pk_bf16_f32 v104, v32, v33
v_smfmac_f32_16x16x64_bf16 v[40:43], v[250:253], v[68:75], v178
s_waitcnt lgkmcnt(10)
v_cvt_pk_bf16_f32 v105, v34, v35
s_cbranch_scc1 L_loopnk
s_cmp_eq_u32 s41, s59
s_cbranch_scc1 L_loopck
s_cmp_lt_u32 s41, s15
s_cbranch_scc1 L_loopk
s_nop 0
v_cndmask_b32_dpp v108, v96, v92, vcc quad_perm:[1,0,3,2] row_mask:0xf bank_mask:0xf
v_cndmask_b32_dpp v109, v97, v93, vcc quad_perm:[1,0,3,2] row_mask:0xf bank_mask:0xf
v_cndmask_b32_dpp v110, v98, v94, vcc quad_perm:[1,0,3,2] row_mask:0xf bank_mask:0xf
v_cndmask_b32_dpp v111, v99, v95, vcc quad_perm:[1,0,3,2] row_mask:0xf bank_mask:0xf
buffer_store_dwordx4 v[108:111], v4, s[20:23], s46 offen offset:0 sc1
s_mov_b64 vcc, s[82:83]
v_cvt_pk_bf16_f32 v112, v40, v41
v_cvt_pk_bf16_f32 v113, v42, v43
ds_bpermute_b32 v112, v6, v112
ds_bpermute_b32 v113, v6, v113
v_cndmask_b32_dpp v96, v92, v96, vcc quad_perm:[1,0,3,2] row_mask:0xf bank_mask:0xf
v_cndmask_b32_dpp v97, v93, v97, vcc quad_perm:[1,0,3,2] row_mask:0xf bank_mask:0xf
v_cndmask_b32_dpp v98, v94, v98, vcc quad_perm:[1,0,3,2] row_mask:0xf bank_mask:0xf
v_cndmask_b32_dpp v99, v95, v99, vcc quad_perm:[1,0,3,2] row_mask:0xf bank_mask:0xf
buffer_store_dwordx4 v[96:99], v4, s[20:23], s46 offen offset:1152 sc1
s_mov_b64 vcc, s[80:81]
v_cvt_pk_bf16_f32 v106, v36, v37
v_cvt_pk_bf16_f32 v107, v38, v39
v_cndmask_b32_dpp v92, v104, v100, vcc quad_perm:[1,0,3,2] row_mask:0xf bank_mask:0xf
v_cndmask_b32_dpp v93, v105, v101, vcc quad_perm:[1,0,3,2] row_mask:0xf bank_mask:0xf
v_cndmask_b32_dpp v94, v106, v102, vcc quad_perm:[1,0,3,2] row_mask:0xf bank_mask:0xf
v_cndmask_b32_dpp v95, v107, v103, vcc quad_perm:[1,0,3,2] row_mask:0xf bank_mask:0xf
buffer_store_dwordx4 v[92:95], v4, s[20:23], s46 offen offset:128 sc1
s_mov_b64 vcc, s[82:83]
v_cndmask_b32_dpp v104, v100, v104, vcc quad_perm:[1,0,3,2] row_mask:0xf bank_mask:0xf
v_cndmask_b32_dpp v105, v101, v105, vcc quad_perm:[1,0,3,2] row_mask:0xf bank_mask:0xf
v_cndmask_b32_dpp v106, v102, v106, vcc quad_perm:[1,0,3,2] row_mask:0xf bank_mask:0xf
v_cndmask_b32_dpp v107, v103, v107, vcc quad_perm:[1,0,3,2] row_mask:0xf bank_mask:0xf
buffer_store_dwordx4 v[104:107], v4, s[20:23], s46 offen offset:1280 sc1
s_mov_b64 vcc, s[80:81]
s_waitcnt lgkmcnt(0)
buffer_store_dwordx2 v[112:113], v5, s[20:23], s46 offen
s_branch L_fin
L_loopk_w:
s_bitcmp1_b32 s87, s41
s_waitcnt vmcnt(15)
s_cbranch_scc0 L_loopk_wb
s_waitcnt vmcnt(10)
s_branch L_loopk_wb
L_loopnk_w:
s_bitcmp1_b32 s87, s41
s_waitcnt vmcnt(15)
s_cbranch_scc0 L_loopnk_wb
s_waitcnt vmcnt(10)
s_branch L_loopnk_wb
L_slow:
s_waitcnt vmcnt(0) lgkmcnt(0)
s_mov_b32 s87, 0
L_sm:
s_lshl_b32 s86, s2, 1
s_add_u32 s86, s86, s87
s_add_u32 s86, s86, 2
s_mul_i32 s86, s86, 393216
s_mov_b32 s84, 0
L_st:
s_and_b32 s48, s84, 3
s_lshr_b32 s49, s84, 2
s_sub_u32 s50, s84, 36
s_lshl_b32 s51, s40, 4
s_lshl_b32 s52, s50, 1
s_lshl_b32 s53, s48, 8
s_cmp_lt_u32 s84, 36
s_cselect_b32 s52, s49, s52
s_cselect_b32 s53, s53, 1024
s_cselect_b32 s54, 8, 73728
s_cselect_b32 s55, 32, 8
s_cselect_b32 s56, 16, 32
s_cselect_b32 s57, 128, 64
s_mul_i32 s52, s52, 73728
s_mul_i32 s58, s40, 18432
v_and_b32 v58, 1, v7
v_bfe_u32 v59, v7, 1, 1
v_bfe_u32 v60, v7, 2, 2
v_bfe_u32 v62, v7, 4, 1
v_lshrrev_b32 v63, 5, v7
v_lshl_add_u32 v50, v58, 2, s52
v_mad_u32_u24 v50, v59, s54, v50
v_mad_u32_u24 v50, v60, s55, v50
v_mad_u32_u24 v50, v62, s56, v50
v_mad_u32_u24 v50, v63, s57, v50
v_add_u32 v50, s53, v50
v_add_u32 v50, s58, v50
v_add_u32 v62, 4608, v50
v_add_u32 v63, 9216, v50
v_add_u32 v64, 13824, v50
buffer_load_dword v8, v50, s[28:31], 0 offen offset:0
buffer_load_dword v9, v50, s[28:31], 0 offen offset:1152
buffer_load_dword v10, v50, s[28:31], 0 offen offset:2304
buffer_load_dword v11, v50, s[28:31], 0 offen offset:3456
buffer_load_dword v12, v62, s[28:31], 0 offen offset:0
buffer_load_dword v13, v62, s[28:31], 0 offen offset:1152
buffer_load_dword v14, v62, s[28:31], 0 offen offset:2304
buffer_load_dword v15, v62, s[28:31], 0 offen offset:3456
buffer_load_dword v16, v63, s[28:31], 0 offen offset:0
buffer_load_dword v17, v63, s[28:31], 0 offen offset:1152
buffer_load_dword v18, v63, s[28:31], 0 offen offset:2304
buffer_load_dword v19, v63, s[28:31], 0 offen offset:3456
buffer_load_dword v20, v64, s[28:31], 0 offen offset:0
buffer_load_dword v21, v64, s[28:31], 0 offen offset:1152
buffer_load_dword v22, v64, s[28:31], 0 offen offset:2304
buffer_load_dword v23, v64, s[28:31], 0 offen offset:3456
s_mul_i32 s52, s48, 9
s_add_u32 s52, s52, s49
s_mul_i32 s53, s52, 9
s_mul_i32 s54, s50, 18
s_add_u32 s54, s54, 8
s_lshl_b32 s55, s52, 2
s_add_u32 s55, s55, s40
s_lshl_b32 s56, s50, 2
s_add_u32 s56, s56, s40
s_cmp_eq_u32 s84, 40
s_cselect_b32 s57, 0x100000, 9
s_cmp_lt_u32 s84, 36
s_cselect_b32 s53, s53, s54
s_cselect_b32 s54, 2, 81
s_cselect_b32 s57, 1, s57
s_cselect_b32 s55, s55, s56
s_mov_b32 s56, 331776
s_cselect_b32 s56, s56, 368640
s_mov_b32 s58, 373760
s_cselect_b32 s58, s58, 382976
s_cselect_b32 s59, 16, 4
s_cselect_b32 s60, 4, 64
s_cselect_b32 s61, 12, 11
s_cselect_b32 s62, 1, 0x8001
v_lshrrev_b32 v61, 4, v7
v_lshlrev_b32 v62, 1, v58
v_lshl_add_u32 v60, v60, 2, v62
v_add_u32 v62, v60, v59
v_mul_u32_u24 v51, s54, v61
v_add_lshl_u32 v51, v51, s53, 6
v_add3_u32 v51, v51, v62, s51
v_lshl_add_u32 v51, v51, 4, s86
s_lshl_b32 s57, s57, 10
v_add_u32 v66, s57, v51
s_lshl_b32 s52, s55, 8
s_add_u32 s52, s52, s56
s_add_u32 s52, s52, s86
v_mul_u32_u24 v52, s59, v62
v_mad_u32_u24 v52, v61, s60, v52
v_lshl_add_u32 v54, v7, 2, s52
v_mov_b32 v55, 0x05040100
v_mov_b32 v62, 0x03020706
v_cmp_eq_u32 vcc, 1, v59
v_mov_b32 v68, 0xf0a0500
v_mov_b32 v69, 0x8f8a8580
v_mov_b32 v70, 0x1f1a1510
v_mov_b32 v71, 0x9f9a9590
v_mov_b32 v72, 0x2f2a2520
v_mov_b32 v73, 0xafaaa5a0
v_mov_b32 v74, 0x3f3a3530
v_mov_b32 v75, 0xbfbab5b0
v_cndmask_b32 v55, v55, v62, vcc
s_mov_b32 s64, 0x5040500
s_mov_b32 s65, 0x5040501
s_mov_b32 s66, 0x5040502
s_mov_b32 s67, 0x5040503
s_mov_b32 s68, 0x7060700
s_mov_b32 s69, 0x7060701
s_mov_b32 s70, 0x7060702
s_mov_b32 s71, 0x7060703
s_mov_b32 s72, 0x05060102
s_cmp_lg_u32 s87, 0
s_waitcnt vmcnt(12)
v_perm_b32 v24, v8, v68, s64
v_perm_b32 v25, v9, v68, s65
v_perm_b32 v26, v10, v68, s66
v_perm_b32 v27, v11, v68, s67
v_max3_f32 v28, |v24|, |v25|, |v26|
v_med3_f32 v29, |v24|, |v25|, |v26|
v_min3_f32 v30, |v24|, |v25|, |v26|
v_med3_f32 v32, v28, v29, |v27|
v_med3_f32 v33, v29, v30, |v27|
v_max_f32 v31, v28, |v27|
v_cmp_eq_u32_sdwa vcc, v33, v32 src0_sel:WORD_1 src1_sel:WORD_1
s_cbranch_scc0 L_rb0g
v_min_f32 v30, v30, |v27|
v_cndmask_b32 v31, 0, v33, vcc
v_cmp_eq_u32_sdwa vcc, v30, v32 src0_sel:WORD_1 src1_sel:WORD_1
s_nop 1
v_cndmask_b32 v32, 0, v30, vcc
L_rb0g:
v_perm_b32 v36, v31, v32, s72
v_bfi_b32 v44, 3, v32, v31
v_perm_b32 v24, v8, v69, s68
v_perm_b32 v25, v9, v69, s69
v_perm_b32 v26, v10, v69, s70
v_perm_b32 v27, v11, v69, s71
v_max3_f32 v28, |v24|, |v25|, |v26|
v_med3_f32 v29, |v24|, |v25|, |v26|
v_min3_f32 v30, |v24|, |v25|, |v26|
v_med3_f32 v32, v28, v29, |v27|
v_med3_f32 v33, v29, v30, |v27|
v_max_f32 v31, v28, |v27|
v_cmp_eq_u32_sdwa vcc, v33, v32 src0_sel:WORD_1 src1_sel:WORD_1
s_cbranch_scc0 L_rb1g
v_min_f32 v30, v30, |v27|
v_cndmask_b32 v31, 0, v33, vcc
v_cmp_eq_u32_sdwa vcc, v30, v32 src0_sel:WORD_1 src1_sel:WORD_1
s_nop 1
v_cndmask_b32 v32, 0, v30, vcc
L_rb1g:
v_perm_b32 v40, v31, v32, s72
v_bfi_b32 v46, 3, v32, v31
s_waitcnt vmcnt(8)
v_perm_b32 v24, v12, v70, s64
v_perm_b32 v25, v13, v70, s65
v_perm_b32 v26, v14, v70, s66
v_perm_b32 v27, v15, v70, s67
v_max3_f32 v28, |v24|, |v25|, |v26|
v_med3_f32 v29, |v24|, |v25|, |v26|
v_min3_f32 v30, |v24|, |v25|, |v26|
v_med3_f32 v32, v28, v29, |v27|
v_med3_f32 v33, v29, v30, |v27|
v_max_f32 v31, v28, |v27|
v_cmp_eq_u32_sdwa vcc, v33, v32 src0_sel:WORD_1 src1_sel:WORD_1
s_cbranch_scc0 L_rb2g
v_min_f32 v30, v30, |v27|
v_cndmask_b32 v31, 0, v33, vcc
v_cmp_eq_u32_sdwa vcc, v30, v32 src0_sel:WORD_1 src1_sel:WORD_1
s_nop 1
v_cndmask_b32 v32, 0, v30, vcc
L_rb2g:
v_perm_b32 v37, v31, v32, s72
v_bfi_b32 v31, 3, v32, v31
v_lshlrev_b32 v31, 4, v31
v_bfi_b32 v44, 15, v44, v31
v_perm_b32 v24, v12, v71, s68
v_perm_b32 v25, v13, v71, s69
v_perm_b32 v26, v14, v71, s70
v_perm_b32 v27, v15, v71, s71
v_max3_f32 v28, |v24|, |v25|, |v26|
v_med3_f32 v29, |v24|, |v25|, |v26|
v_min3_f32 v30, |v24|, |v25|, |v26|
v_med3_f32 v32, v28, v29, |v27|
v_med3_f32 v33, v29, v30, |v27|
v_max_f32 v31, v28, |v27|
v_cmp_eq_u32_sdwa vcc, v33, v32 src0_sel:WORD_1 src1_sel:WORD_1
s_cbranch_scc0 L_rb3g
v_min_f32 v30, v30, |v27|
v_cndmask_b32 v31, 0, v33, vcc
v_cmp_eq_u32_sdwa vcc, v30, v32 src0_sel:WORD_1 src1_sel:WORD_1
s_nop 1
v_cndmask_b32 v32, 0, v30, vcc
L_rb3g:
v_perm_b32 v41, v31, v32, s72
v_bfi_b32 v31, 3, v32, v31
v_lshlrev_b32 v31, 4, v31
v_bfi_b32 v46, 15, v46, v31
s_waitcnt vmcnt(4)
v_perm_b32 v24, v16, v72, s64
v_perm_b32 v25, v17, v72, s65
v_perm_b32 v26, v18, v72, s66
v_perm_b32 v27, v19, v72, s67
v_max3_f32 v28, |v24|, |v25|, |v26|
v_med3_f32 v29, |v24|, |v25|, |v26|
v_min3_f32 v30, |v24|, |v25|, |v26|
v_med3_f32 v32, v28, v29, |v27|
v_med3_f32 v33, v29, v30, |v27|
v_max_f32 v31, v28, |v27|
v_cmp_eq_u32_sdwa vcc, v33, v32 src0_sel:WORD_1 src1_sel:WORD_1
s_cbranch_scc0 L_rb4g
v_min_f32 v30, v30, |v27|
v_cndmask_b32 v31, 0, v33, vcc
v_cmp_eq_u32_sdwa vcc, v30, v32 src0_sel:WORD_1 src1_sel:WORD_1
s_nop 1
v_cndmask_b32 v32, 0, v30, vcc
L_rb4g:
v_perm_b32 v38, v31, v32, s72
v_bfi_b32 v45, 3, v32, v31
v_perm_b32 v24, v16, v73, s68
v_perm_b32 v25, v17, v73, s69
v_perm_b32 v26, v18, v73, s70
v_perm_b32 v27, v19, v73, s71
v_max3_f32 v28, |v24|, |v25|, |v26|
v_med3_f32 v29, |v24|, |v25|, |v26|
v_min3_f32 v30, |v24|, |v25|, |v26|
v_med3_f32 v32, v28, v29, |v27|
v_med3_f32 v33, v29, v30, |v27|
v_max_f32 v31, v28, |v27|
v_cmp_eq_u32_sdwa vcc, v33, v32 src0_sel:WORD_1 src1_sel:WORD_1
s_cbranch_scc0 L_rb5g
v_min_f32 v30, v30, |v27|
v_cndmask_b32 v31, 0, v33, vcc
v_cmp_eq_u32_sdwa vcc, v30, v32 src0_sel:WORD_1 src1_sel:WORD_1
s_nop 1
v_cndmask_b32 v32, 0, v30, vcc
L_rb5g:
v_perm_b32 v42, v31, v32, s72
v_bfi_b32 v47, 3, v32, v31
s_waitcnt vmcnt(0)
v_perm_b32 v24, v20, v74, s64
v_perm_b32 v25, v21, v74, s65
v_perm_b32 v26, v22, v74, s66
v_perm_b32 v27, v23, v74, s67
v_max3_f32 v28, |v24|, |v25|, |v26|
v_med3_f32 v29, |v24|, |v25|, |v26|
v_min3_f32 v30, |v24|, |v25|, |v26|
v_med3_f32 v32, v28, v29, |v27|
v_med3_f32 v33, v29, v30, |v27|
v_max_f32 v31, v28, |v27|
v_cmp_eq_u32_sdwa vcc, v33, v32 src0_sel:WORD_1 src1_sel:WORD_1
s_cbranch_scc0 L_rb6g
v_min_f32 v30, v30, |v27|
v_cndmask_b32 v31, 0, v33, vcc
v_cmp_eq_u32_sdwa vcc, v30, v32 src0_sel:WORD_1 src1_sel:WORD_1
s_nop 1
v_cndmask_b32 v32, 0, v30, vcc
L_rb6g:
v_perm_b32 v39, v31, v32, s72
v_bfi_b32 v31, 3, v32, v31
v_lshlrev_b32 v31, 4, v31
v_bfi_b32 v45, 15, v45, v31
v_perm_b32 v24, v20, v75, s68
v_perm_b32 v25, v21, v75, s69
v_perm_b32 v26, v22, v75, s70
v_perm_b32 v27, v23, v75, s71
v_max3_f32 v28, |v24|, |v25|, |v26|
v_med3_f32 v29, |v24|, |v25|, |v26|
v_min3_f32 v30, |v24|, |v25|, |v26|
v_med3_f32 v32, v28, v29, |v27|
v_med3_f32 v33, v29, v30, |v27|
v_max_f32 v31, v28, |v27|
v_cmp_eq_u32_sdwa vcc, v33, v32 src0_sel:WORD_1 src1_sel:WORD_1
s_cbranch_scc0 L_rb7g
v_min_f32 v30, v30, |v27|
v_cndmask_b32 v31, 0, v33, vcc
v_cmp_eq_u32_sdwa vcc, v30, v32 src0_sel:WORD_1 src1_sel:WORD_1
s_nop 1
v_cndmask_b32 v32, 0, v30, vcc
L_rb7g:
v_perm_b32 v43, v31, v32, s72
v_bfi_b32 v31, 3, v32, v31
v_lshlrev_b32 v31, 4, v31
v_bfi_b32 v47, 15, v47, v31
s_mov_b32 vcc_lo, 0x33333333
s_mov_b32 vcc_hi, 0x33333333
v_cndmask_b32_dpp v24, v40, v36, vcc quad_perm:[2,3,0,1] row_mask:0xf bank_mask:0xf
v_cndmask_b32_dpp v25, v41, v37, vcc quad_perm:[2,3,0,1] row_mask:0xf bank_mask:0xf
v_cndmask_b32_dpp v26, v42, v38, vcc quad_perm:[2,3,0,1] row_mask:0xf bank_mask:0xf
v_cndmask_b32_dpp v27, v43, v39, vcc quad_perm:[2,3,0,1] row_mask:0xf bank_mask:0xf
s_not_b64 vcc, vcc
buffer_store_dwordx4 v[24:27], v51, s[24:27], 0 offen sc1
v_cndmask_b32_dpp v40, v36, v40, vcc quad_perm:[2,3,0,1] row_mask:0xf bank_mask:0xf
v_cndmask_b32_dpp v41, v37, v41, vcc quad_perm:[2,3,0,1] row_mask:0xf bank_mask:0xf
v_cndmask_b32_dpp v42, v38, v42, vcc quad_perm:[2,3,0,1] row_mask:0xf bank_mask:0xf
v_cndmask_b32_dpp v43, v39, v43, vcc quad_perm:[2,3,0,1] row_mask:0xf bank_mask:0xf
s_mov_b32 s52, 0x0c0c0400
s_mov_b32 s53, 0x04000c0c
buffer_store_dwordx4 v[40:43], v66, s[24:27], 0 offen sc1
v_perm_b32 v48, v45, v44, s52
v_perm_b32 v49, v47, v46, s53
v_or_b32 v48, v48, v49
s_nop 1
v_mov_b32_dpp v49, v48 quad_perm:[2,3,0,1] row_mask:0xf bank_mask:0xf
v_perm_b32 v48, v49, v48, v55
ds_permute_b32 v48, v52, v48
s_waitcnt lgkmcnt(0)
buffer_store_dword v48, v54, s[24:27], 0 offen sc1
s_waitcnt vmcnt(0)
s_add_u32 s84, s84, 1
s_cmp_lt_u32 s84, 41
s_cbranch_scc1 L_st
s_add_u32 s87, s87, 1
s_cmp_lt_u32 s87, 2
s_cbranch_scc1 L_sm
v_lshrrev_b32 v72, 3, v7
v_and_b32 v73, 7, v7
v_xor_b32 v73, v73, v72
v_mul_u32_u24 v72, 1152, v72
s_and_b32 s47, s40, 1
s_mul_i32 s47, s47, 9216
s_lshr_b32 s3, s40, 1
s_lshl_b32 s3, s3, 7
s_add_u32 s47, s47, s3
v_lshl_add_u32 v72, v73, 4, v72
v_add_u32 v3, s47, v72
s_lshl_b32 s44, s40, 10
s_mul_i32 s45, s2, 18432
s_mov_b32 s46, s45
s_lshr_b32 s47, s40, 1
s_lshl_b32 s3, s47, 11
s_sub_u32 s8, 15488, s3
s_lshl_b32 s3, s47, 7
s_add_u32 s7, s45, 128
s_sub_u32 s7, s7, s3
s_sub_u32 s10, s47, 1
s_sub_u32 s11, 0, s47
s_mov_b32 s9, s44
s_mov_b32 s13, 4718592
s_mov_b32 s15, 16
s_mov_b32 s14, s13
s_mov_b32 s22, 75497472
s_mov_b32 s18, 75497472
s_mov_b32 s41, 0
s_bitcmp1_b32 s2, 0
s_cselect_b32 s15, 16, 22
L_stile:
s_barrier
s_add_u32 m0, s44, 0
s_nop 0
buffer_load_dwordx4 v3, s[16:19], s45 offen offset:0 nt lds
s_add_u32 m0, s44, 3840
s_nop 0
buffer_load_dwordx4 v3, s[16:19], s45 offen offset:256 nt lds
s_add_u32 m0, s44, 7680
s_nop 0
buffer_load_dwordx4 v3, s[16:19], s45 offen offset:512 nt lds
s_add_u32 m0, s44, 11520
s_nop 0
buffer_load_dwordx4 v3, s[16:19], s45 offen offset:768 nt lds
s_add_u32 m0, s44, s8
s_mov_b64 exec, s[10:11]
buffer_load_dwordx4 v3, s[16:19], s7 offen offset:896 nt lds
s_mov_b64 exec, -1
ds_read_b128 v[8:11], v2 offset:1024
ds_read_b128 v[12:15], v2 offset:1088
ds_read_b128 v[16:19], v2 offset:1152
ds_read_b128 v[20:23], v2 offset:1216
ds_read_b128 v[24:27], v2 offset:1280
ds_read_b128 v[28:31], v2 offset:1344
ds_read_b128 v[32:35], v2 offset:1408
ds_read_b128 v[36:39], v2 offset:1472
ds_read_b128 v[40:43], v2 offset:1536
s_mov_b32 s87, 0
L_spass:
s_lshl_b32 s86, s2, 1
s_add_u32 s86, s86, s87
s_add_u32 s86, s86, 2
s_mul_i32 s86, s86, 393216
s_mul_i32 s47, s40, 82944
s_add_u32 s47, s47, s86
v_lshl_add_u32 v104, v7, 4, s47
s_mul_i32 s47, s40, 9216
s_add_u32 s47, s47, s86
s_add_u32 s47, s47, 331776
v_lshl_add_u32 v105, v7, 4, s47
s_lshl_b32 s47, s40, 6
s_add_u32 s47, s47, s86
s_add_u32 s47, s47, 368640
v_and_b32 v106, 15, v7
v_lshl_add_u32 v106, v106, 2, s47
v_lshrrev_b32 v107, 4, v7
v_lshl_add_u32 v106, v107, 8, v106
buffer_load_dword v174, v106, s[24:27], 0 offen offset:0 sc1
buffer_load_dword v175, v106, s[24:27], 0 offen offset:1024 sc1
buffer_load_dword v176, v106, s[24:27], 0 offen offset:2048 sc1
buffer_load_dword v177, v106, s[24:27], 0 offen offset:3072 sc1
s_mov_b32 s99, 4096
buffer_load_dword v178, v106, s[24:27], s99 offen offset:0 sc1
s_mov_b32 s98, 0
buffer_load_dwordx4 v[138:141], v105, s[24:27], s98 offen sc1
s_mov_b32 s99, 0
buffer_load_dwordx4 a[0:3], v104, s[24:27], s99 offen offset:0 sc1
buffer_load_dwordx4 a[4:7], v104, s[24:27], s99 offen offset:1024 sc1
buffer_load_dwordx4 a[8:11], v104, s[24:27], s99 offen offset:2048 sc1
buffer_load_dwordx4 a[12:15], v104, s[24:27], s99 offen offset:3072 sc1
s_mov_b32 s99, 4096
buffer_load_dwordx4 a[16:19], v104, s[24:27], s99 offen offset:0 sc1
buffer_load_dwordx4 a[20:23], v104, s[24:27], s99 offen offset:1024 sc1
buffer_load_dwordx4 a[24:27], v104, s[24:27], s99 offen offset:2048 sc1
buffer_load_dwordx4 a[28:31], v104, s[24:27], s99 offen offset:3072 sc1
s_mov_b32 s99, 8192
buffer_load_dwordx4 a[32:35], v104, s[24:27], s99 offen offset:0 sc1
s_mov_b32 s98, 1024
buffer_load_dwordx4 v[142:145], v105, s[24:27], s98 offen sc1
buffer_load_dwordx4 a[36:39], v104, s[24:27], s99 offen offset:1024 sc1
buffer_load_dwordx4 a[40:43], v104, s[24:27], s99 offen offset:2048 sc1
buffer_load_dwordx4 a[44:47], v104, s[24:27], s99 offen offset:3072 sc1
s_mov_b32 s99, 12288
buffer_load_dwordx4 a[48:51], v104, s[24:27], s99 offen offset:0 sc1
buffer_load_dwordx4 a[52:55], v104, s[24:27], s99 offen offset:1024 sc1
buffer_load_dwordx4 a[56:59], v104, s[24:27], s99 offen offset:2048 sc1
buffer_load_dwordx4 a[60:63], v104, s[24:27], s99 offen offset:3072 sc1
s_mov_b32 s99, 16384
buffer_load_dwordx4 a[64:67], v104, s[24:27], s99 offen offset:0 sc1
buffer_load_dwordx4 a[68:71], v104, s[24:27], s99 offen offset:1024 sc1
s_mov_b32 s98, 2048
buffer_load_dwordx4 v[146:149], v105, s[24:27], s98 offen sc1
buffer_load_dwordx4 a[72:75], v104, s[24:27], s99 offen offset:2048 sc1
buffer_load_dwordx4 a[76:79], v104, s[24:27], s99 offen offset:3072 sc1
s_mov_b32 s99, 20480
buffer_load_dwordx4 a[80:83], v104, s[24:27], s99 offen offset:0 sc1
buffer_load_dwordx4 a[84:87], v104, s[24:27], s99 offen offset:1024 sc1
buffer_load_dwordx4 a[88:91], v104, s[24:27], s99 offen offset:2048 sc1
buffer_load_dwordx4 a[92:95], v104, s[24:27], s99 offen offset:3072 sc1
s_mov_b32 s99, 24576
buffer_load_dwordx4 a[96:99], v104, s[24:27], s99 offen offset:0 sc1
buffer_load_dwordx4 a[100:103], v104, s[24:27], s99 offen offset:1024 sc1
buffer_load_dwordx4 a[104:107], v104, s[24:27], s99 offen offset:2048 sc1
s_mov_b32 s98, 3072
buffer_load_dwordx4 v[150:153], v105, s[24:27], s98 offen sc1
buffer_load_dwordx4 a[108:111], v104, s[24:27], s99 offen offset:3072 sc1
s_mov_b32 s99, 28672
buffer_load_dwordx4 a[112:115], v104, s[24:27], s99 offen offset:0 sc1
buffer_load_dwordx4 a[116:119], v104, s[24:27], s99 offen offset:1024 sc1
buffer_load_dwordx4 a[120:123], v104, s[24:27], s99 offen offset:2048 sc1
buffer_load_dwordx4 a[124:127], v104, s[24:27], s99 offen offset:3072 sc1
s_mov_b32 s99, 32768
buffer_load_dwordx4 a[128:131], v104, s[24:27], s99 offen offset:0 sc1
buffer_load_dwordx4 a[132:135], v104, s[24:27], s99 offen offset:1024 sc1
buffer_load_dwordx4 a[136:139], v104, s[24:27], s99 offen offset:2048 sc1
buffer_load_dwordx4 a[140:143], v104, s[24:27], s99 offen offset:3072 sc1
s_mov_b32 s98, 4096
buffer_load_dwordx4 v[154:157], v105, s[24:27], s98 offen sc1
s_mov_b32 s99, 36864
buffer_load_dwordx4 a[144:147], v104, s[24:27], s99 offen offset:0 sc1
buffer_load_dwordx4 a[148:151], v104, s[24:27], s99 offen offset:1024 sc1
buffer_load_dwordx4 a[152:155], v104, s[24:27], s99 offen offset:2048 sc1
buffer_load_dwordx4 a[156:159], v104, s[24:27], s99 offen offset:3072 sc1
s_mov_b32 s99, 40960
buffer_load_dwordx4 a[160:163], v104, s[24:27], s99 offen offset:0 sc1
buffer_load_dwordx4 a[164:167], v104, s[24:27], s99 offen offset:1024 sc1
buffer_load_dwordx4 a[168:171], v104, s[24:27], s99 offen offset:2048 sc1
buffer_load_dwordx4 a[172:175], v104, s[24:27], s99 offen offset:3072 sc1
s_mov_b32 s99, 45056
buffer_load_dwordx4 a[176:179], v104, s[24:27], s99 offen offset:0 sc1
s_mov_b32 s98, 5120
buffer_load_dwordx4 v[158:161], v105, s[24:27], s98 offen sc1
buffer_load_dwordx4 a[180:183], v104, s[24:27], s99 offen offset:1024 sc1
buffer_load_dwordx4 a[184:187], v104, s[24:27], s99 offen offset:2048 sc1
buffer_load_dwordx4 a[188:191], v104, s[24:27], s99 offen offset:3072 sc1
s_mov_b32 s99, 49152
buffer_load_dwordx4 a[192:195], v104, s[24:27], s99 offen offset:0 sc1
buffer_load_dwordx4 a[196:199], v104, s[24:27], s99 offen offset:1024 sc1
buffer_load_dwordx4 a[200:203], v104, s[24:27], s99 offen offset:2048 sc1
buffer_load_dwordx4 a[204:207], v104, s[24:27], s99 offen offset:3072 sc1
s_mov_b32 s99, 53248
buffer_load_dwordx4 a[208:211], v104, s[24:27], s99 offen offset:0 sc1
buffer_load_dwordx4 a[212:215], v104, s[24:27], s99 offen offset:1024 sc1
s_mov_b32 s98, 6144
buffer_load_dwordx4 v[162:165], v105, s[24:27], s98 offen sc1
buffer_load_dwordx4 a[216:219], v104, s[24:27], s99 offen offset:2048 sc1
buffer_load_dwordx4 a[220:223], v104, s[24:27], s99 offen offset:3072 sc1
s_mov_b32 s99, 57344
buffer_load_dwordx4 a[224:227], v104, s[24:27], s99 offen offset:0 sc1
buffer_load_dwordx4 a[228:231], v104, s[24:27], s99 offen offset:1024 sc1
buffer_load_dwordx4 a[232:235], v104, s[24:27], s99 offen offset:2048 sc1
buffer_load_dwordx4 a[236:239], v104, s[24:27], s99 offen offset:3072 sc1
s_mov_b32 s99, 61440
buffer_load_dwordx4 a[240:243], v104, s[24:27], s99 offen offset:0 sc1
buffer_load_dwordx4 a[244:247], v104, s[24:27], s99 offen offset:1024 sc1
buffer_load_dwordx4 a[248:251], v104, s[24:27], s99 offen offset:2048 sc1
s_mov_b32 s98, 7168
buffer_load_dwordx4 v[166:169], v105, s[24:27], s98 offen sc1
buffer_load_dwordx4 a[252:255], v104, s[24:27], s99 offen offset:3072 sc1
s_mov_b32 s99, 65536
buffer_load_dwordx4 v[186:189], v104, s[24:27], s99 offen offset:0 sc1
buffer_load_dwordx4 v[190:193], v104, s[24:27], s99 offen offset:1024 sc1
buffer_load_dwordx4 v[194:197], v104, s[24:27], s99 offen offset:2048 sc1
buffer_load_dwordx4 v[198:201], v104, s[24:27], s99 offen offset:3072 sc1
s_mov_b32 s99, 69632
buffer_load_dwordx4 v[202:205], v104, s[24:27], s99 offen offset:0 sc1
buffer_load_dwordx4 v[206:209], v104, s[24:27], s99 offen offset:1024 sc1
buffer_load_dwordx4 v[210:213], v104, s[24:27], s99 offen offset:2048 sc1
buffer_load_dwordx4 v[214:217], v104, s[24:27], s99 offen offset:3072 sc1
s_mov_b32 s98, 8192
buffer_load_dwordx4 v[170:173], v105, s[24:27], s98 offen sc1
s_mov_b32 s99, 73728
buffer_load_dwordx4 v[218:221], v104, s[24:27], s99 offen offset:0 sc1
buffer_load_dwordx4 v[222:225], v104, s[24:27], s99 offen offset:1024 sc1
buffer_load_dwordx4 v[226:229], v104, s[24:27], s99 offen offset:2048 sc1
buffer_load_dwordx4 v[230:233], v104, s[24:27], s99 offen offset:3072 sc1
s_mov_b32 s99, 77824
buffer_load_dwordx4 v[234:237], v104, s[24:27], s99 offen offset:0 sc1
buffer_load_dwordx4 v[238:241], v104, s[24:27], s99 offen offset:1024 sc1
buffer_load_dwordx4 v[242:245], v104, s[24:27], s99 offen offset:2048 sc1
buffer_load_dwordx4 v[246:249], v104, s[24:27], s99 offen offset:3072 sc1
s_mov_b32 s99, 81920
buffer_load_dwordx4 v[250:253], v104, s[24:27], s99 offen offset:0 sc1
s_waitcnt vmcnt(0)
s_barrier
ds_read_b128 v[44:47], v0 offset:0
ds_read_b128 v[48:51], v1 offset:0
s_waitcnt lgkmcnt(0)
v_smfmac_f32_16x16x64_bf16 v[8:11], a[0:3], v[44:51], v138
v_smfmac_f32_16x16x64_bf16 v[12:15], a[4:7], v[44:51], v138 abid:1
v_smfmac_f32_16x16x64_bf16 v[16:19], a[8:11], v[44:51], v139
v_smfmac_f32_16x16x64_bf16 v[20:23], a[12:15], v[44:51], v139 abid:1
v_smfmac_f32_16x16x64_bf16 v[24:27], a[16:19], v[44:51], v140
v_smfmac_f32_16x16x64_bf16 v[28:31], a[20:23], v[44:51], v140 abid:1
v_smfmac_f32_16x16x64_bf16 v[32:35], a[24:27], v[44:51], v141
v_smfmac_f32_16x16x64_bf16 v[36:39], a[28:31], v[44:51], v141 abid:1
v_smfmac_f32_16x16x64_bf16 v[40:43], a[32:35], v[44:51], v174
s_nop 7
ds_read_b128 v[44:47], v0 offset:2048
ds_read_b128 v[48:51], v1 offset:2048
s_waitcnt lgkmcnt(0)
v_smfmac_f32_16x16x64_bf16 v[8:11], a[36:39], v[44:51], v142
v_smfmac_f32_16x16x64_bf16 v[12:15], a[40:43], v[44:51], v142 abid:1
v_smfmac_f32_16x16x64_bf16 v[16:19], a[44:47], v[44:51], v143
v_smfmac_f32_16x16x64_bf16 v[20:23], a[48:51], v[44:51], v143 abid:1
v_smfmac_f32_16x16x64_bf16 v[24:27], a[52:55], v[44:51], v144
v_smfmac_f32_16x16x64_bf16 v[28:31], a[56:59], v[44:51], v144 abid:1
v_smfmac_f32_16x16x64_bf16 v[32:35], a[60:63], v[44:51], v145
v_smfmac_f32_16x16x64_bf16 v[36:39], a[64:67], v[44:51], v145 abid:1
v_smfmac_f32_16x16x64_bf16 v[40:43], a[68:71], v[44:51], v174 abid:1
s_nop 7
ds_read_b128 v[44:47], v0 offset:4096
ds_read_b128 v[48:51], v1 offset:4096
s_waitcnt lgkmcnt(0)
v_smfmac_f32_16x16x64_bf16 v[8:11], a[72:75], v[44:51], v146
v_smfmac_f32_16x16x64_bf16 v[12:15], a[76:79], v[44:51], v146 abid:1
v_smfmac_f32_16x16x64_bf16 v[16:19], a[80:83], v[44:51], v147
v_smfmac_f32_16x16x64_bf16 v[20:23], a[84:87], v[44:51], v147 abid:1
v_smfmac_f32_16x16x64_bf16 v[24:27], a[88:91], v[44:51], v148
v_smfmac_f32_16x16x64_bf16 v[28:31], a[92:95], v[44:51], v148 abid:1
v_smfmac_f32_16x16x64_bf16 v[32:35], a[96:99], v[44:51], v149
v_smfmac_f32_16x16x64_bf16 v[36:39], a[100:103], v[44:51], v149 abid:1
v_smfmac_f32_16x16x64_bf16 v[40:43], a[104:107], v[44:51], v175
s_nop 7
ds_read_b128 v[44:47], v0 offset:6144
ds_read_b128 v[48:51], v1 offset:6144
s_waitcnt lgkmcnt(0)
v_smfmac_f32_16x16x64_bf16 v[8:11], a[108:111], v[44:51], v150
v_smfmac_f32_16x16x64_bf16 v[12:15], a[112:115], v[44:51], v150 abid:1
v_smfmac_f32_16x16x64_bf16 v[16:19], a[116:119], v[44:51], v151
v_smfmac_f32_16x16x64_bf16 v[20:23], a[120:123], v[44:51], v151 abid:1
v_smfmac_f32_16x16x64_bf16 v[24:27], a[124:127], v[44:51], v152
v_smfmac_f32_16x16x64_bf16 v[28:31], a[128:131], v[44:51], v152 abid:1
v_smfmac_f32_16x16x64_bf16 v[32:35], a[132:135], v[44:51], v153
v_smfmac_f32_16x16x64_bf16 v[36:39], a[136:139], v[44:51], v153 abid:1
v_smfmac_f32_16x16x64_bf16 v[40:43], a[140:143], v[44:51], v175 abid:1
s_nop 7
ds_read_b128 v[44:47], v0 offset:8192
ds_read_b128 v[48:51], v1 offset:8192
s_waitcnt lgkmcnt(0)
v_smfmac_f32_16x16x64_bf16 v[8:11], a[144:147], v[44:51], v154
v_smfmac_f32_16x16x64_bf16 v[12:15], a[148:151], v[44:51], v154 abid:1
v_smfmac_f32_16x16x64_bf16 v[16:19], a[152:155], v[44:51], v155
v_smfmac_f32_16x16x64_bf16 v[20:23], a[156:159], v[44:51], v155 abid:1
v_smfmac_f32_16x16x64_bf16 v[24:27], a[160:163], v[44:51], v156
v_smfmac_f32_16x16x64_bf16 v[28:31], a[164:167], v[44:51], v156 abid:1
v_smfmac_f32_16x16x64_bf16 v[32:35], a[168:171], v[44:51], v157
v_smfmac_f32_16x16x64_bf16 v[36:39], a[172:175], v[44:51], v157 abid:1
v_smfmac_f32_16x16x64_bf16 v[40:43], a[176:179], v[44:51], v176
s_nop 7
ds_read_b128 v[44:47], v0 offset:10240
ds_read_b128 v[48:51], v1 offset:10240
s_waitcnt lgkmcnt(0)
v_smfmac_f32_16x16x64_bf16 v[8:11], a[180:183], v[44:51], v158
v_smfmac_f32_16x16x64_bf16 v[12:15], a[184:187], v[44:51], v158 abid:1
v_smfmac_f32_16x16x64_bf16 v[16:19], a[188:191], v[44:51], v159
v_smfmac_f32_16x16x64_bf16 v[20:23], a[192:195], v[44:51], v159 abid:1
v_smfmac_f32_16x16x64_bf16 v[24:27], a[196:199], v[44:51], v160
v_smfmac_f32_16x16x64_bf16 v[28:31], a[200:203], v[44:51], v160 abid:1
v_smfmac_f32_16x16x64_bf16 v[32:35], a[204:207], v[44:51], v161
v_smfmac_f32_16x16x64_bf16 v[36:39], a[208:211], v[44:51], v161 abid:1
v_smfmac_f32_16x16x64_bf16 v[40:43], a[212:215], v[44:51], v176 abid:1
s_nop 7
ds_read_b128 v[44:47], v0 offset:12288
ds_read_b128 v[48:51], v1 offset:12288
s_waitcnt lgkmcnt(0)
v_smfmac_f32_16x16x64_bf16 v[8:11], a[216:219], v[44:51], v162
v_smfmac_f32_16x16x64_bf16 v[12:15], a[220:223], v[44:51], v162 abid:1
v_smfmac_f32_16x16x64_bf16 v[16:19], a[224:227], v[44:51], v163
v_smfmac_f32_16x16x64_bf16 v[20:23], a[228:231], v[44:51], v163 abid:1
v_smfmac_f32_16x16x64_bf16 v[24:27], a[232:235], v[44:51], v164
v_smfmac_f32_16x16x64_bf16 v[28:31], a[236:239], v[44:51], v164 abid:1
v_smfmac_f32_16x16x64_bf16 v[32:35], a[240:243], v[44:51], v165
v_smfmac_f32_16x16x64_bf16 v[36:39], a[244:247], v[44:51], v165 abid:1
v_smfmac_f32_16x16x64_bf16 v[40:43], a[248:251], v[44:51], v177
s_nop 7
ds_read_b128 v[44:47], v0 offset:14336
ds_read_b128 v[48:51], v1 offset:14336
s_waitcnt lgkmcnt(0)
v_smfmac_f32_16x16x64_bf16 v[8:11], a[252:255], v[44:51], v166
v_smfmac_f32_16x16x64_bf16 v[12:15], v[186:189], v[44:51], v166 abid:1
v_smfmac_f32_16x16x64_bf16 v[16:19], v[190:193], v[44:51], v167
v_smfmac_f32_16x16x64_bf16 v[20:23], v[194:197], v[44:51], v167 abid:1
v_smfmac_f32_16x16x64_bf16 v[24:27], v[198:201], v[44:51], v168
v_smfmac_f32_16x16x64_bf16 v[28:31], v[202:205], v[44:51], v168 abid:1
v_smfmac_f32_16x16x64_bf16 v[32:35], v[206:209], v[44:51], v169
v_smfmac_f32_16x16x64_bf16 v[36:39], v[210:213], v[44:51], v169 abid:1
v_smfmac_f32_16x16x64_bf16 v[40:43], v[214:217], v[44:51], v177 abid:1
s_nop 7
ds_read_b128 v[44:47], v0 offset:16384
ds_read_b128 v[48:51], v1 offset:16384
s_waitcnt lgkmcnt(0)
v_smfmac_f32_16x16x64_bf16 v[8:11], v[218:221], v[44:51], v170
v_smfmac_f32_16x16x64_bf16 v[12:15], v[222:225], v[44:51], v170 abid:1
v_smfmac_f32_16x16x64_bf16 v[16:19], v[226:229], v[44:51], v171
v_smfmac_f32_16x16x64_bf16 v[20:23], v[230:233], v[44:51], v171 abid:1
v_smfmac_f32_16x16x64_bf16 v[24:27], v[234:237], v[44:51], v172
v_smfmac_f32_16x16x64_bf16 v[28:31], v[238:241], v[44:51], v172 abid:1
v_smfmac_f32_16x16x64_bf16 v[32:35], v[242:245], v[44:51], v173
v_smfmac_f32_16x16x64_bf16 v[36:39], v[246:249], v[44:51], v173 abid:1
v_smfmac_f32_16x16x64_bf16 v[40:43], v[250:253], v[44:51], v178
s_nop 7
s_add_u32 s87, s87, 1
s_cmp_lt_u32 s87, 2
s_cbranch_scc1 L_spass
v_cvt_pk_bf16_f32 v92, v8, v9
v_cvt_pk_bf16_f32 v93, v10, v11
v_cvt_pk_bf16_f32 v94, v12, v13
v_cvt_pk_bf16_f32 v95, v14, v15
v_cvt_pk_bf16_f32 v96, v16, v17
v_cvt_pk_bf16_f32 v97, v18, v19
v_cvt_pk_bf16_f32 v98, v20, v21
v_cvt_pk_bf16_f32 v99, v22, v23
v_cvt_pk_bf16_f32 v100, v24, v25
v_cvt_pk_bf16_f32 v101, v26, v27
v_cvt_pk_bf16_f32 v102, v28, v29
v_cvt_pk_bf16_f32 v103, v30, v31
v_cvt_pk_bf16_f32 v104, v32, v33
v_cvt_pk_bf16_f32 v105, v34, v35
s_mov_b64 vcc, s[80:81]
s_nop 0
v_cndmask_b32_dpp v108, v96, v92, vcc quad_perm:[1,0,3,2] row_mask:0xf bank_mask:0xf
v_cndmask_b32_dpp v109, v97, v93, vcc quad_perm:[1,0,3,2] row_mask:0xf bank_mask:0xf
v_cndmask_b32_dpp v110, v98, v94, vcc quad_perm:[1,0,3,2] row_mask:0xf bank_mask:0xf
v_cndmask_b32_dpp v111, v99, v95, vcc quad_perm:[1,0,3,2] row_mask:0xf bank_mask:0xf
buffer_store_dwordx4 v[108:111], v4, s[20:23], s46 offen offset:0 sc1
s_mov_b64 vcc, s[82:83]
v_cvt_pk_bf16_f32 v112, v40, v41
v_cvt_pk_bf16_f32 v113, v42, v43
ds_bpermute_b32 v112, v6, v112
ds_bpermute_b32 v113, v6, v113
v_cndmask_b32_dpp v96, v92, v96, vcc quad_perm:[1,0,3,2] row_mask:0xf bank_mask:0xf
v_cndmask_b32_dpp v97, v93, v97, vcc quad_perm:[1,0,3,2] row_mask:0xf bank_mask:0xf
v_cndmask_b32_dpp v98, v94, v98, vcc quad_perm:[1,0,3,2] row_mask:0xf bank_mask:0xf
v_cndmask_b32_dpp v99, v95, v99, vcc quad_perm:[1,0,3,2] row_mask:0xf bank_mask:0xf
buffer_store_dwordx4 v[96:99], v4, s[20:23], s46 offen offset:1152 sc1
s_mov_b64 vcc, s[80:81]
v_cvt_pk_bf16_f32 v106, v36, v37
v_cvt_pk_bf16_f32 v107, v38, v39
v_cndmask_b32_dpp v92, v104, v100, vcc quad_perm:[1,0,3,2] row_mask:0xf bank_mask:0xf
v_cndmask_b32_dpp v93, v105, v101, vcc quad_perm:[1,0,3,2] row_mask:0xf bank_mask:0xf
v_cndmask_b32_dpp v94, v106, v102, vcc quad_perm:[1,0,3,2] row_mask:0xf bank_mask:0xf
v_cndmask_b32_dpp v95, v107, v103, vcc quad_perm:[1,0,3,2] row_mask:0xf bank_mask:0xf
buffer_store_dwordx4 v[92:95], v4, s[20:23], s46 offen offset:128 sc1
s_mov_b64 vcc, s[82:83]
v_cndmask_b32_dpp v104, v100, v104, vcc quad_perm:[1,0,3,2] row_mask:0xf bank_mask:0xf
v_cndmask_b32_dpp v105, v101, v105, vcc quad_perm:[1,0,3,2] row_mask:0xf bank_mask:0xf
v_cndmask_b32_dpp v106, v102, v106, vcc quad_perm:[1,0,3,2] row_mask:0xf bank_mask:0xf
v_cndmask_b32_dpp v107, v103, v107, vcc quad_perm:[1,0,3,2] row_mask:0xf bank_mask:0xf
buffer_store_dwordx4 v[104:107], v4, s[20:23], s46 offen offset:1280 sc1
s_mov_b64 vcc, s[80:81]
s_waitcnt lgkmcnt(0)
buffer_store_dwordx2 v[112:113], v5, s[20:23], s46 offen
s_cmp_eq_u32 s41, 15
s_cselect_b32 s13, -23574528, s13
s_add_u32 s45, s45, s13
s_add_u32 s7, s7, s13
s_add_u32 s46, s46, s13
s_mov_b32 s13, 4718592
s_add_u32 s41, s41, 1
s_cmp_lt_u32 s41, s15
s_cbranch_scc1 L_stile
s_branch L_fin
.section .rodata,"a"
.p2align 6
.amdhsa_kernel standalone__structured_sparse_n_m__ragged_kernel
  .amdhsa_next_free_vgpr 512
  .amdhsa_next_free_sgpr 102
  .amdhsa_accum_offset 256
  .amdhsa_group_segment_fixed_size 0
  .amdhsa_float_denorm_mode_32 3
  .amdhsa_kernarg_size 48
  .amdhsa_user_sgpr_count 2
  .amdhsa_user_sgpr_kernarg_segment_ptr 1
  .amdhsa_system_sgpr_workgroup_id_x 1
.end_amdhsa_kernel
```

```asm
; @launch grid=(256,1,1) block=(256,1,1) lds=163840
.amdgcn_target "amdgcn-amd-amdhsa--gfx950"
.text
.globl standalone__structured_sparse_n_m__ragged_kernel
.p2align 8
.type standalone__structured_sparse_n_m__ragged_kernel,@function
standalone__structured_sparse_n_m__ragged_kernel:
s_load_dwordx8 s[4:11], s[0:1], 0
s_load_dwordx4 s[12:15], s[0:1], 32
s_cmp_ge_u32 s2, 256
s_cbranch_scc1 L_end_standalone__structured_sparse_n_m__ragged_kernel
v_lshrrev_b32 v1, 6, v0
v_and_b32 v7, 63, v0
v_readfirstlane_b32 s40, v1
s_mov_b32 s86, 0
s_lshr_b32 s84, s2, 6
s_and_b32 s47, s2, 9
s_lshl1_add_u32 s84, s84, s47
s_bfe_u32 s3, s2, 0x20004
s_lshl2_add_u32 s84, s84, s3
s_and_b32 s47, s2, 7
s_cmp_lt_u32 s47, 2
s_cselect_b32 s84, s84, 63
s_cmp_lt_u32 s84, 41
s_cbranch_scc1 L_prod
v_lshlrev_b32 v3, 7, v0
s_getpc_b64 s[96:97]
v_min_u32 v2, L_slow-standalone__structured_sparse_n_m__ragged_kernel, v3
global_load_dword v120, v2, s[96:97]
s_branch L_cons
L_prod:
s_and_b32 s48, s84, 3
s_lshr_b32 s49, s84, 2
s_sub_u32 s50, s84, 36
s_lshl_b32 s51, s40, 4
s_lshl_b32 s52, s50, 1
s_lshl_b32 s53, s48, 8
s_cmp_lt_u32 s84, 36
s_cselect_b32 s52, s49, s52
s_cselect_b32 s53, s53, 1024
s_cselect_b32 s54, 8, 73728
s_cselect_b32 s55, 32, 8
s_cselect_b32 s56, 16, 32
s_cselect_b32 s57, 128, 64
s_mul_i32 s52, s52, 73728
s_mul_i32 s58, s40, 18432
v_and_b32 v58, 1, v7
v_bfe_u32 v59, v7, 1, 1
v_bfe_u32 v60, v7, 2, 2
v_bfe_u32 v62, v7, 4, 1
v_lshrrev_b32 v63, 5, v7
v_lshl_add_u32 v50, v58, 2, s52
v_mad_u32_u24 v50, v59, s54, v50
v_mad_u32_u24 v50, v60, s55, v50
v_mad_u32_u24 v50, v62, s56, v50
v_mad_u32_u24 v50, v63, s57, v50
v_add_u32 v50, s53, v50
v_add_u32 v50, s58, v50
v_add_u32 v62, 4608, v50
v_add_u32 v63, 9216, v50
v_add_u32 v64, 13824, v50
s_waitcnt lgkmcnt(0)
s_mov_b32 s30, 663552
s_mov_b32 s31, 0x20000
s_mov_b32 s28, s6
s_and_b32 s29, s7, 0xffff
buffer_load_dword v8, v50, s[28:31], 0 offen offset:0 nt
buffer_load_dword v9, v50, s[28:31], 0 offen offset:1152 nt
buffer_load_dword v10, v50, s[28:31], 0 offen offset:2304 nt
buffer_load_dword v11, v50, s[28:31], 0 offen offset:3456 nt
buffer_load_dword v12, v62, s[28:31], 0 offen offset:0 nt
buffer_load_dword v13, v62, s[28:31], 0 offen offset:1152 nt
buffer_load_dword v14, v62, s[28:31], 0 offen offset:2304 nt
buffer_load_dword v15, v62, s[28:31], 0 offen offset:3456 nt
buffer_load_dword v16, v63, s[28:31], 0 offen offset:0 nt
buffer_load_dword v17, v63, s[28:31], 0 offen offset:1152 nt
buffer_load_dword v18, v63, s[28:31], 0 offen offset:2304 nt
buffer_load_dword v19, v63, s[28:31], 0 offen offset:3456 nt
buffer_load_dword v20, v64, s[28:31], 0 offen offset:0 nt
buffer_load_dword v21, v64, s[28:31], 0 offen offset:1152 nt
buffer_load_dword v22, v64, s[28:31], 0 offen offset:2304 nt
buffer_load_dword v23, v64, s[28:31], 0 offen offset:3456 nt
s_mov_b32 s18, 75497472
s_mov_b32 s19, 0x20000
s_mov_b32 s16, s4
s_and_b32 s17, s5, 0xffff
s_mov_b32 s26, 301989888
s_mov_b32 s27, 0x20000
s_mov_b32 s24, s14
s_and_b32 s25, s15, 0xffff
s_mov_b32 s34, 1152
s_mov_b32 s35, 0x20000
s_mov_b32 s32, s8
s_and_b32 s33, s9, 0xffff
s_mov_b32 s22, 0
s_mov_b32 s23, 0x20000
s_mov_b32 s20, s10
s_and_b32 s21, s11, 0xffff
s_mov_b32 s38, 256
s_mov_b32 s39, 0x20000
s_mov_b32 s36, s12
s_and_b32 s37, s13, 0xffff
s_mul_i32 s52, s48, 9
s_add_u32 s52, s52, s49
s_mul_i32 s53, s52, 9
s_mul_i32 s54, s50, 18
s_add_u32 s54, s54, 8
s_lshl_b32 s55, s52, 2
s_add_u32 s55, s55, s40
s_lshl_b32 s56, s50, 2
s_add_u32 s56, s56, s40
s_cmp_eq_u32 s84, 40
s_cselect_b32 s57, 0x100000, 9
s_cmp_lt_u32 s84, 36
s_cselect_b32 s53, s53, s54
s_cselect_b32 s54, 2, 81
s_cselect_b32 s57, 1, s57
s_cselect_b32 s55, s55, s56
s_mov_b32 s56, 331776
s_cselect_b32 s56, s56, 368640
s_mov_b32 s58, 373760
s_cselect_b32 s58, s58, 382976
s_cselect_b32 s59, 16, 4
s_cselect_b32 s60, 4, 64
s_cselect_b32 s61, 12, 11
s_cselect_b32 s62, 1, 0x8001
v_lshrrev_b32 v61, 4, v7
v_lshlrev_b32 v62, 1, v58
v_lshl_add_u32 v60, v60, 2, v62
v_add_u32 v62, v60, v59
v_mul_u32_u24 v51, s54, v61
v_add_lshl_u32 v51, v51, s53, 6
v_add3_u32 v51, v51, v62, s51
v_lshl_add_u32 v51, v51, 4, s86
s_lshl_b32 s57, s57, 10
v_add_u32 v66, s57, v51
s_lshl_b32 s52, s55, 8
s_add_u32 s52, s52, s56
s_add_u32 s52, s52, s86
v_mul_u32_u24 v52, s59, v62
v_mad_u32_u24 v52, v61, s60, v52
v_lshl_add_u32 v54, v7, 2, s52
s_lshr_b32 s52, s55, 2
s_lshl_b32 s52, s52, 8
s_add_u32 s58, s58, s52
s_lshl2_add_u32 s58, s51, s58
s_lshl_b32 s52, s51, 1
s_add_u32 s52, s52, s62
v_lshl_add_u32 v62, v61, 1, v59
v_lshlrev_b32 v62, s61, v62
v_lshl_add_u32 v53, v60, 7, v62
v_add_u32 v53, s52, v53
v_and_b32 v62, 12, v7
v_and_b32 v63, 15, v7
v_mad_u32_u24 v62, v62, 3, v63
v_lshl_add_u32 v62, v62, 2, s51
v_mov_b32 v67, 0
ds_write_b32 v62, v67
s_lshl2_add_u32 s52, s84, s40
s_lshl_b32 s52, s52, 7
s_add_u32 s52, s52, 393152
v_lshl_add_u32 v65, v7, 2, s58
v_lshl_add_u32 v62, v7, 2, s52
v_cmp_gt_u32 vcc, 16, v7
s_lshl_b32 s52, s51, 2
v_lshl_add_u32 v57, v7, 2, s52
v_cndmask_b32 v65, v62, v65, vcc
s_mov_b32 s75, 0
s_mov_b32 s73, 0x05060100
s_mov_b32 s74, 0xffff
v_mov_b32 v55, 0x05040100
v_mov_b32 v62, 0x03020706
v_cmp_eq_u32 vcc, 1, v59
v_mov_b32 v68, 0xf0a0500
v_mov_b32 v69, 0x8f8a8580
v_mov_b32 v70, 0x1f1a1510
v_mov_b32 v71, 0x9f9a9590
v_mov_b32 v72, 0x2f2a2520
v_mov_b32 v73, 0xafaaa5a0
v_mov_b32 v74, 0x3f3a3530
v_mov_b32 v75, 0xbfbab5b0
v_cndmask_b32 v55, v55, v62, vcc
v_mov_b64 v[76:77], 0
v_mov_b64 v[78:79], 0
v_mov_b64 v[80:81], 0
v_mov_b32 v82, 0
s_mov_b32 s64, 0x5040500
s_mov_b32 s65, 0x5040501
s_mov_b32 s66, 0x5040502
s_mov_b32 s67, 0x5040503
s_mov_b32 s68, 0x7060700
s_mov_b32 s69, 0x7060701
s_mov_b32 s70, 0x7060702
s_mov_b32 s71, 0x7060703
s_mov_b32 s72, 0x05060102
s_waitcnt vmcnt(12)
v_perm_b32 v24, v8, v68, s64
v_perm_b32 v25, v9, v68, s65
v_perm_b32 v26, v10, v68, s66
v_perm_b32 v27, v11, v68, s67
v_max3_f32 v28, |v24|, |v25|, |v26|
v_med3_f32 v29, |v24|, |v25|, |v26|
v_min3_f32 v30, |v24|, |v25|, |v26|
v_med3_f32 v32, v28, v29, |v27|
v_med3_f32 v33, v29, v30, |v27|
v_max_f32 v31, v28, |v27|
v_perm_b32 v36, v31, v32, s72
v_bfi_b32 v44, 3, v32, v31
v_cmpx_eq_u32_sdwa vcc, v33, v32 src0_sel:WORD_1 src1_sel:WORD_1
v_mov_b32 v76, v33
v_min_f32 v77, v30, |v27|
s_mov_b64 exec, -1
v_perm_b32 v24, v8, v69, s68
v_perm_b32 v25, v9, v69, s69
v_perm_b32 v26, v10, v69, s70
v_perm_b32 v27, v11, v69, s71
v_max3_f32 v28, |v24|, |v25|, |v26|
v_med3_f32 v29, |v24|, |v25|, |v26|
v_min3_f32 v30, |v24|, |v25|, |v26|
v_med3_f32 v32, v28, v29, |v27|
v_med3_f32 v33, v29, v30, |v27|
v_max_f32 v31, v28, |v27|
v_perm_b32 v40, v31, v32, s72
v_bfi_b32 v46, 3, v32, v31
v_cmpx_eq_u32_sdwa vcc, v33, v32 src0_sel:WORD_1 src1_sel:WORD_1
v_mov_b64 v[78:79], v[76:77]
v_mov_b32 v76, v33
v_min_f32 v77, v30, |v27|
s_mov_b64 exec, -1
s_waitcnt vmcnt(8)
v_perm_b32 v24, v12, v70, s64
v_perm_b32 v25, v13, v70, s65
v_perm_b32 v26, v14, v70, s66
v_perm_b32 v27, v15, v70, s67
v_max3_f32 v28, |v24|, |v25|, |v26|
v_med3_f32 v29, |v24|, |v25|, |v26|
v_min3_f32 v30, |v24|, |v25|, |v26|
v_med3_f32 v32, v28, v29, |v27|
v_med3_f32 v33, v29, v30, |v27|
v_max_f32 v31, v28, |v27|
v_perm_b32 v37, v31, v32, s72
v_bfi_b32 v31, 3, v32, v31
v_lshlrev_b32 v31, 4, v31
v_bfi_b32 v44, 15, v44, v31
v_cmpx_eq_u32_sdwa vcc, v33, v32 src0_sel:WORD_1 src1_sel:WORD_1
v_mov_b64 v[80:81], v[78:79]
v_mov_b64 v[78:79], v[76:77]
v_mov_b32 v76, v33
v_min_f32 v77, v30, |v27|
s_mov_b64 exec, -1
v_perm_b32 v24, v12, v71, s68
v_perm_b32 v25, v13, v71, s69
v_perm_b32 v26, v14, v71, s70
v_perm_b32 v27, v15, v71, s71
v_max3_f32 v28, |v24|, |v25|, |v26|
v_med3_f32 v29, |v24|, |v25|, |v26|
v_min3_f32 v30, |v24|, |v25|, |v26|
v_med3_f32 v32, v28, v29, |v27|
v_med3_f32 v33, v29, v30, |v27|
v_max_f32 v31, v28, |v27|
v_perm_b32 v41, v31, v32, s72
v_bfi_b32 v31, 3, v32, v31
v_lshlrev_b32 v31, 4, v31
v_bfi_b32 v46, 15, v46, v31
v_cmpx_eq_u32_sdwa vcc, v33, v32 src0_sel:WORD_1 src1_sel:WORD_1
v_or_b32 v82, v82, v80
v_mov_b64 v[80:81], v[78:79]
v_mov_b64 v[78:79], v[76:77]
v_mov_b32 v76, v33
v_min_f32 v77, v30, |v27|
s_mov_b64 exec, -1
s_waitcnt vmcnt(4)
v_perm_b32 v24, v16, v72, s64
v_perm_b32 v25, v17, v72, s65
v_perm_b32 v26, v18, v72, s66
v_perm_b32 v27, v19, v72, s67
v_max3_f32 v28, |v24|, |v25|, |v26|
v_med3_f32 v29, |v24|, |v25|, |v26|
v_min3_f32 v30, |v24|, |v25|, |v26|
v_med3_f32 v32, v28, v29, |v27|
v_med3_f32 v33, v29, v30, |v27|
v_max_f32 v31, v28, |v27|
v_perm_b32 v38, v31, v32, s72
v_bfi_b32 v45, 3, v32, v31
v_cmpx_eq_u32_sdwa vcc, v33, v32 src0_sel:WORD_1 src1_sel:WORD_1
v_or_b32 v82, v82, v80
v_mov_b64 v[80:81], v[78:79]
v_mov_b64 v[78:79], v[76:77]
v_mov_b32 v76, v33
v_min_f32 v77, v30, |v27|
s_mov_b64 exec, -1
v_perm_b32 v24, v16, v73, s68
v_perm_b32 v25, v17, v73, s69
v_perm_b32 v26, v18, v73, s70
v_perm_b32 v27, v19, v73, s71
v_max3_f32 v28, |v24|, |v25|, |v26|
v_med3_f32 v29, |v24|, |v25|, |v26|
v_min3_f32 v30, |v24|, |v25|, |v26|
v_med3_f32 v32, v28, v29, |v27|
v_med3_f32 v33, v29, v30, |v27|
v_max_f32 v31, v28, |v27|
v_perm_b32 v42, v31, v32, s72
v_bfi_b32 v47, 3, v32, v31
v_cmpx_eq_u32_sdwa vcc, v33, v32 src0_sel:WORD_1 src1_sel:WORD_1
v_or_b32 v82, v82, v80
v_mov_b64 v[80:81], v[78:79]
v_mov_b64 v[78:79], v[76:77]
v_mov_b32 v76, v33
v_min_f32 v77, v30, |v27|
s_mov_b64 exec, -1
s_waitcnt vmcnt(0)
v_perm_b32 v24, v20, v74, s64
v_perm_b32 v25, v21, v74, s65
v_perm_b32 v26, v22, v74, s66
v_perm_b32 v27, v23, v74, s67
v_max3_f32 v28, |v24|, |v25|, |v26|
v_med3_f32 v29, |v24|, |v25|, |v26|
v_min3_f32 v30, |v24|, |v25|, |v26|
v_med3_f32 v32, v28, v29, |v27|
v_med3_f32 v33, v29, v30, |v27|
v_max_f32 v31, v28, |v27|
v_perm_b32 v39, v31, v32, s72
v_bfi_b32 v31, 3, v32, v31
v_lshlrev_b32 v31, 4, v31
v_bfi_b32 v45, 15, v45, v31
v_cmpx_eq_u32_sdwa vcc, v33, v32 src0_sel:WORD_1 src1_sel:WORD_1
v_or_b32 v82, v82, v80
v_mov_b64 v[80:81], v[78:79]
v_mov_b64 v[78:79], v[76:77]
v_mov_b32 v76, v33
v_min_f32 v77, v30, |v27|
s_mov_b64 exec, -1
v_perm_b32 v24, v20, v75, s68
v_perm_b32 v25, v21, v75, s69
v_perm_b32 v26, v22, v75, s70
v_perm_b32 v27, v23, v75, s71
v_max3_f32 v28, |v24|, |v25|, |v26|
v_med3_f32 v29, |v24|, |v25|, |v26|
v_min3_f32 v30, |v24|, |v25|, |v26|
v_med3_f32 v32, v28, v29, |v27|
v_med3_f32 v33, v29, v30, |v27|
v_max_f32 v31, v28, |v27|
v_perm_b32 v43, v31, v32, s72
v_bfi_b32 v31, 3, v32, v31
v_lshlrev_b32 v31, 4, v31
v_bfi_b32 v47, 15, v47, v31
v_cmpx_eq_u32_sdwa vcc, v33, v32 src0_sel:WORD_1 src1_sel:WORD_1
v_or_b32 v82, v82, v80
v_mov_b64 v[80:81], v[78:79]
v_mov_b64 v[78:79], v[76:77]
v_mov_b32 v76, v33
v_min_f32 v77, v30, |v27|
s_mov_b64 exec, -1
s_mov_b32 vcc_lo, 0x33333333
s_mov_b32 vcc_hi, 0x33333333
v_cndmask_b32_dpp v24, v40, v36, vcc quad_perm:[2,3,0,1] row_mask:0xf bank_mask:0xf
v_cndmask_b32_dpp v25, v41, v37, vcc quad_perm:[2,3,0,1] row_mask:0xf bank_mask:0xf
v_cndmask_b32_dpp v26, v42, v38, vcc quad_perm:[2,3,0,1] row_mask:0xf bank_mask:0xf
v_cndmask_b32_dpp v27, v43, v39, vcc quad_perm:[2,3,0,1] row_mask:0xf bank_mask:0xf
s_not_b64 vcc, vcc
buffer_store_dwordx4 v[24:27], v51, s[24:27], 0 offen sc1
v_cndmask_b32_dpp v40, v36, v40, vcc quad_perm:[2,3,0,1] row_mask:0xf bank_mask:0xf
v_cndmask_b32_dpp v41, v37, v41, vcc quad_perm:[2,3,0,1] row_mask:0xf bank_mask:0xf
v_cndmask_b32_dpp v42, v38, v42, vcc quad_perm:[2,3,0,1] row_mask:0xf bank_mask:0xf
v_cndmask_b32_dpp v43, v39, v43, vcc quad_perm:[2,3,0,1] row_mask:0xf bank_mask:0xf
s_mov_b32 s52, 0x0c0c0400
s_mov_b32 s53, 0x04000c0c
buffer_store_dwordx4 v[40:43], v66, s[24:27], 0 offen sc1
v_perm_b32 v48, v45, v44, s52
v_perm_b32 v49, v47, v46, s53
v_or_b32 v48, v48, v49
s_nop 1
v_mov_b32_dpp v49, v48 quad_perm:[2,3,0,1] row_mask:0xf bank_mask:0xf
v_perm_b32 v48, v49, v48, v55
ds_permute_b32 v48, v52, v48
v_cmp_lt_u32 s[54:55], s74, v82
L_emit:
v_cmp_lt_u32 vcc, s74, v76
v_cmp_eq_u32_sdwa s[48:49], v77, v76 src0_sel:WORD_1 src1_sel:WORD_1
v_perm_b32 v63, v76, v53, s73
v_bfe_u32 v62, v76, 2, 4
v_and_b32 v64, 0x80, v76
v_lshl_add_u32 v63, v62, 1, v63
v_mbcnt_lo_u32_b32 v62, vcc_lo, 0
v_mbcnt_hi_u32_b32 v62, vcc_hi, v62
v_add_u32 v63, v64, v63
v_add_u32 v62, s75, v62
s_bcnt1_i32_b64 s52, vcc
s_add_u32 s75, s75, s52
v_cmp_gt_u32 s[52:53], 15, v62
v_and_b32 v64, 12, v62
v_mad_u32_u24 v62, v64, 3, v62
v_lshl_add_u32 v62, v62, 2, s51
s_and_b64 s[48:49], s[48:49], vcc
s_and_b64 exec, s[52:53], vcc
ds_write_b32 v62, v63
s_mov_b64 exec, s[48:49]
v_mov_b32 v76, v77
v_mov_b32 v77, 0
s_not_b64 exec, exec
v_mov_b64 v[76:77], v[78:79]
v_mov_b64 v[78:79], v[80:81]
v_mov_b64 v[80:81], 0
s_mov_b64 exec, -1
v_or3_b32 v62, v76, v78, v80
v_cmp_lt_u32 vcc, s74, v62
s_cmp_lg_u64 s[54:55], 0
s_cselect_b32 s52, 99, s75
s_cmp_gt_u32 s52, 15
s_cselect_b32 s52, -1, 0
v_mov_b32 v63, s51
s_cbranch_vccnz L_emit
v_mov_b32 v62, s52
ds_write_b32 v63, v62 offset:204
v_lshlrev_b32 v11, 4, v63
s_waitcnt lgkmcnt(0)
s_barrier
s_mov_b64 exec, 0xffff
ds_read_b32 v67, v57
s_mov_b64 exec, -1
buffer_store_dword v48, v54, s[24:27], 0 offen sc1
s_mov_b32 exec_hi, 0xffff
s_waitcnt lgkmcnt(0)
buffer_store_dword v67, v65, s[24:27], 0 offen sc1
s_mov_b64 exec, 1
buffer_load_dword v8, v11, s[36:39], 0 offen sc1
s_mov_b64 exec, -1
s_lshl_b32 s52, s84, 7
s_add_u32 s52, s52, 458752
v_lshl_add_u32 v9, v7, 2, s52
v_mov_b32 v10, 1
s_waitcnt vmcnt(0)
s_mov_b32 s85, 0x230003c
s_barrier
s_cmp_lg_u32 s40, 0
s_cbranch_scc1 L_cons2
v_readfirstlane_b32 s47, v8
s_mov_b64 exec, 0xffff
s_cmp_lg_u32 s47, 1
s_cbranch_scc1 L_pwait
L_pset:
buffer_store_dword v10, v9, s[24:27], 0 offen sc1
L_notlast:
s_mov_b64 exec, -1
L_cons2:
v_lshrrev_b32 v72, 3, v7
v_and_b32 v73, 7, v7
v_xor_b32 v73, v73, v72
v_mul_u32_u24 v72, 1152, v72
s_and_b32 s47, s40, 1
s_mul_i32 s47, s47, 9216
s_lshr_b32 s3, s40, 1
s_lshl_b32 s3, s3, 7
s_add_u32 s47, s47, s3
v_lshl_add_u32 v72, v73, 4, v72
v_add_u32 v3, s47, v72
s_lshl_b32 s44, s40, 10
s_mul_i32 s45, s2, 18432
s_mov_b32 s46, s45
s_branch L_cons3
L_pwait:
s_mov_b32 s3, 20015
L_pwait1:
buffer_load_dword v8, off, s[36:39], 0 sc1
s_waitcnt vmcnt(0)
v_readfirstlane_b32 s47, v8
s_nop 3
s_cmp_eq_u32 s47, 1
s_cbranch_scc1 L_pset
s_sub_u32 s3, s3, 1
s_cbranch_scc0 L_pwait1
s_branch L_notlast
L_cons:
s_mov_b32 s85, 0x800020
s_mov_b32 s47, 0x800020
s_bitcmp1_b32 s2, 3
s_cselect_b32 s85, s85, 0x230003c
s_cselect_b32 s47, s47, 0x230003c
s_bitcmp1_b32 s2, 6
s_cselect_b32 s85, s47, s85
v_lshrrev_b32 v72, 3, v7
v_and_b32 v73, 7, v7
v_xor_b32 v73, v73, v72
v_mul_u32_u24 v72, 1152, v72
s_and_b32 s47, s40, 1
s_mul_i32 s47, s47, 9216
s_lshr_b32 s3, s40, 1
s_lshl_b32 s3, s3, 7
s_add_u32 s47, s47, s3
v_lshl_add_u32 v72, v73, 4, v72
v_add_u32 v3, s47, v72
s_lshl_b32 s44, s40, 10
s_mul_i32 s45, s2, 18432
s_mov_b32 s46, s45
s_waitcnt lgkmcnt(0)
s_mov_b32 s30, 663552
s_mov_b32 s31, 0x20000
s_mov_b32 s28, s6
s_and_b32 s29, s7, 0xffff
s_mov_b32 s18, 75497472
s_mov_b32 s19, 0x20000
s_mov_b32 s16, s4
s_and_b32 s17, s5, 0xffff
s_mov_b32 s26, 301989888
s_mov_b32 s27, 0x20000
s_mov_b32 s24, s14
s_and_b32 s25, s15, 0xffff
s_mov_b32 s34, 1152
s_mov_b32 s35, 0x20000
s_mov_b32 s32, s8
s_and_b32 s33, s9, 0xffff
s_mov_b32 s22, 0
s_mov_b32 s23, 0x20000
s_mov_b32 s20, s10
s_and_b32 s21, s11, 0xffff
s_mov_b32 s38, 256
s_mov_b32 s39, 0x20000
s_mov_b32 s36, s12
s_and_b32 s37, s13, 0xffff
s_cmp_lg_u32 s2, 200
s_cbranch_scc1 L_cons3
v_lshlrev_b32 v8, 4, v0
v_mov_b64 v[12:13], 0
v_mov_b64 v[14:15], 0
buffer_store_dwordx4 v[12:15], v8, s[36:39], 0 offen sc1
v_add_u32 v8, 458752, v8
v_add_u32 v9, 4096, v8
buffer_store_dwordx4 v[12:15], v8, s[24:27], 0 offen sc1
buffer_store_dwordx4 v[12:15], v9, s[24:27], 0 offen sc1
v_mov_b32 v10, 1
v_lshlrev_b32 v11, 2, v0
s_waitcnt vmcnt(0)
s_barrier
s_mov_b32 exec_hi, 0
buffer_store_dword v10, v11, s[36:39], 0 offen sc1
s_mov_b64 exec, -1
L_cons3:
s_lshr_b32 s47, s40, 1
s_lshl_b32 s3, s47, 11
s_sub_u32 s8, 15488, s3
s_lshl_b32 s3, s47, 7
s_add_u32 s7, s45, 128
s_sub_u32 s7, s7, s3
s_sub_u32 s10, s47, 1
s_sub_u32 s11, 0, s47
s_mov_b32 s9, s44
s_mov_b32 s13, 4718592
s_mov_b32 s15, 16
s_mov_b32 s14, s13
v_and_b32 v80, 3, v7
v_bfe_u32 v81, v7, 2, 2
v_bfe_u32 v82, v7, 4, 1
v_lshlrev_b32 v81, 3, v81
v_lshl_add_u32 v81, v80, 5, v81
v_lshl_add_u32 v81, v82, 7, v81
s_lshl_b32 s47, s40, 8
v_add_u32 v81, s47, v81
s_lshl_b32 s47, s40, 5
s_add_u32 s47, s47, 1024
v_lshl_add_u32 v80, v80, 3, s47
v_cmp_gt_u32 vcc, 32, v7
s_nop 1
v_cndmask_b32 v80, v80, v81, vcc
buffer_load_dwordx2 v[110:111], v80, s[32:35], 0 offen
s_cmp_lt_u32 s84, 41
s_cbranch_scc1 L_pfd
s_waitcnt vmcnt(0)
L_pfd:
s_bfe_u32 s88, s85, 0x40014
s_mov_b32 s3, 55680
s_cmp_ge_u32 s88, 6
s_cselect_b32 s3, s3, 0
s_cmp_ge_u32 s84, 41
s_cselect_b32 s3, s3, 0
L_pf:
s_add_u32 m0, s44, 0
s_nop 0
buffer_load_dwordx4 v3, s[16:19], s45 offen offset:0 nt lds
s_add_u32 m0, s44, 3840
s_nop 0
buffer_load_dwordx4 v3, s[16:19], s45 offen offset:256 nt lds
s_add_u32 m0, s44, 7680
s_nop 0
buffer_load_dwordx4 v3, s[16:19], s45 offen offset:512 nt lds
s_add_u32 m0, s44, 11520
s_nop 0
buffer_load_dwordx4 v3, s[16:19], s45 offen offset:768 nt lds
s_add_u32 m0, s44, s8
s_mov_b64 exec, s[10:11]
buffer_load_dwordx4 v3, s[16:19], s7 offen offset:896 nt lds
s_mov_b64 exec, -1
s_cmp_lg_u32 s44, 37120
s_cbranch_scc1 L_pf_f
s_mov_b64 exec, 1
buffer_load_dword v124, off, s[36:39], 0 sc1
s_mov_b64 exec, -1
L_pf_f:
s_cmp_ge_u32 s44, s3
s_cbranch_scc1 L_pf_n
s_waitcnt vmcnt(1)
L_pf_n:
s_add_u32 s7, s7, s13
s_add_u32 s44, s44, 18560
s_add_u32 s45, s45, s13
s_mov_b32 s13, 4718592
s_sub_u32 s88, s88, 1
s_cmp_lg_u32 s88, 0
s_cbranch_scc1 L_pf
L_pf_e:
L_rest:
s_mov_b32 s92, 0x80
s_mov_b32 s47, 0x80
s_bitcmp1_b32 s2, 3
s_cselect_b32 s92, s92, 0x88
s_cselect_b32 s47, s47, 0x88
s_bitcmp1_b32 s2, 6
s_cselect_b32 s92, s47, s92
s_mov_b32 s3, 0x88
s_cmp_lt_u32 s84, 41
s_cselect_b32 s92, s3, s92
s_mov_b32 s87, 0x80
s_mov_b32 s3, 0x80
s_cmp_lt_u32 s84, 41
s_cselect_b32 s87, s3, s87
v_and_b32 v72, 15, v7
v_lshrrev_b32 v73, 4, v7
v_and_b32 v74, 7, v7
v_xor_b32 v74, v74, v73
v_lshlrev_b32 v74, 4, v74
v_lshl_add_u32 v0, v72, 7, v74
v_xor_b32 v1, 64, v0
s_mul_i32 s93, s40, 3584
s_add_u32 s93, s93, 148480
v_lshl_add_u32 v2, v73, 4, s93
v_and_b32 v74, 14, v7
v_mul_u32_u24 v4, 1152, v74
v_and_b32 v74, 1, v7
v_lshl_add_u32 v4, v74, 4, v4
v_lshl_add_u32 v4, v73, 5, v4
s_lshl_b32 s47, s40, 8
v_add_u32 v4, s47, v4
s_lshl_b32 s47, s40, 5
s_add_u32 s47, s47, 1024
v_lshrrev_b32 v72, 2, v7
v_and_b32 v73, 3, v7
v_lshl_add_u32 v6, v73, 4, v72
v_lshlrev_b32 v6, 2, v6
v_mul_u32_u24 v5, 1152, v72
v_lshl_add_u32 v5, v73, 3, v5
v_add_u32 v5, s47, v5
s_mov_b32 s80, 0x55555555
s_mov_b32 s81, 0x55555555
s_mov_b32 s82, 0xaaaaaaaa
s_mov_b32 s83, 0xaaaaaaaa
v_lshl_add_u32 v109, v7, 4, s93
v_lshl_add_u32 v89, v7, 2, s93
v_mov_b32 v76, 0
v_mov_b32 v77, 0
v_mov_b32 v78, 0
v_mov_b32 v79, 0
v_mov_b32 v90, 0xdddddddd
ds_write_b128 v109, v[76:79]
ds_write_b32 v89, v90 offset:1792
ds_write_b32 v89, v90 offset:2048
ds_write_b32 v89, v90 offset:2304
ds_write_b32 v89, v90 offset:2560
ds_write_b32 v89, v90 offset:2816
ds_write_b32 v89, v90 offset:3072
ds_write_b32 v89, v90 offset:3328
s_lshl_b32 s47, s40, 2
s_add_u32 s47, s47, 163072
v_mov_b32 v88, s47
ds_write_b32 v88, v76
s_mul_i32 s47, s40, 2304
s_add_u32 s47, s47, 373760
v_and_b32 v73, 60, v7
v_mad_u32_u24 v73, v73, 3, v7
v_lshl_add_u32 v72, v73, 4, s47
s_mov_b32 s47, 380672
v_lshl_add_u32 v73, v73, 4, s47
v_lshrrev_b32 v74, 2, v7
v_cmp_gt_u32 vcc, 36, v7
v_lshlrev_b32 v90, 11, v74
v_subrev_u32 v74, 9, v74
v_lshlrev_b32 v74, 12, v74
v_cndmask_b32 v72, v73, v72, vcc
v_cndmask_b32 v90, v74, v90, vcc
s_lshl_b32 s47, s40, 12
s_add_u32 s47, s47, 0x8001
v_mov_b32 v88, 1
v_mov_b32 v94, 0xf001
v_mov_b32 v95, s47
v_cndmask_b32 v94, v94, v88, vcc
v_cndmask_b32 v95, v95, v88, vcc
v_cndmask_b32 v96, 0, 28, vcc
v_cndmask_b32 v97, 32, 0, vcc
v_add_u32 v97, s93, v97
v_cmp_gt_u32 vcc, 56, v7
v_mov_b32 v73, 0x40000000
s_lshr_b32 s47, s2, 3
s_lshl_b32 s47, s47, 2
s_add_u32 s47, s47, s40
s_mul_i32 s47, s47, 2944
v_cndmask_b32 v72, v73, v72, vcc
v_lshl_add_u32 v93, v7, 4, s47
s_mul_i32 s47, s40, 82944
s_add_u32 s47, s47, s86
v_lshl_add_u32 v112, v7, 4, s47
s_mul_i32 s47, s40, 9216
s_add_u32 s47, s47, s86
s_add_u32 s47, s47, 331776
v_lshl_add_u32 v113, v7, 4, s47
s_lshl_b32 s47, s40, 6
s_add_u32 s47, s47, s86
s_add_u32 s47, s47, 368640
v_and_b32 v106, 15, v7
v_lshl_add_u32 v106, v106, 2, s47
v_lshrrev_b32 v107, 4, v7
v_lshl_add_u32 v106, v107, 8, v106
v_and_b32 v74, 15, v7
v_and_b32 v73, 7, v7
v_lshlrev_b32 v100, 1, v73
v_lshlrev_b32 v100, v100, v88
v_lshlrev_b32 v73, 4, v73
v_lshl_add_u32 v92, v74, 7, v73
v_lshl_or_b32 v92, v92, 16, v92
v_lshrrev_b32 v98, 5, v7
v_bfe_u32 v99, v7, 3, 2
v_lshl_add_u32 v99, v99, 6, s93
v_lshl_add_u32 v101, v7, 1, s93
v_lshrrev_b32 v102, 4, v7
v_lshl_add_u32 v102, v102, 3, s93
v_lshrrev_b32 v103, 1, v7
v_lshlrev_b32 v103, 5, v103
s_mov_b32 s89, 0
s_cmp_lg_u32 s40, 0
s_cbranch_scc1 L_ready
s_mov_b32 s3, 20015
s_mov_b32 s47, 458752
v_lshl_add_u32 v9, v7, 7, s47
s_bfe_u32 s47, s85, 0x40014
s_cmp_ge_u32 s47, 6
s_waitcnt vmcnt(15)
s_cbranch_scc1 L_deep
s_waitcnt vmcnt(0)
L_deep:
v_readfirstlane_b32 s47, v124
s_mov_b32 exec_hi, 511
s_cmp_lg_u32 s47, 1
s_cbranch_scc1 L_cwait
L_poll:
buffer_load_dword v8, v9, s[24:27], 0 offen sc1
s_sub_u32 s3, s3, 1
s_cbranch_scc1 L_giveup
s_waitcnt vmcnt(0)
v_cmp_ne_u32 vcc, 1, v8
s_nop 4
s_cbranch_vccnz L_poll
L_polled:
s_mov_b64 exec, -1
L_ready:
s_waitcnt lgkmcnt(0)
s_barrier
buffer_load_dwordx4 v[8:11], v72, s[24:27], 0 offen offset:0 sc1
buffer_load_dwordx4 v[12:15], v72, s[24:27], 0 offen offset:64 sc1
buffer_load_dwordx4 v[16:19], v72, s[24:27], 0 offen offset:128 sc1
buffer_load_dwordx4 v[20:23], v72, s[24:27], 0 offen offset:192 sc1
buffer_load_dwordx4 v[76:79], v93, s[24:27], 0 offen offset:0 sc1
buffer_load_dwordx4 v[80:83], v93, s[24:27], 0 offen offset:1024 sc1
buffer_load_dwordx4 v[84:87], v93, s[24:27], 0 offen offset:2048 sc1
buffer_load_dword v174, v106, s[24:27], 0 offen offset:0 sc1
buffer_load_dword v175, v106, s[24:27], 0 offen offset:1024 sc1
buffer_load_dword v176, v106, s[24:27], 0 offen offset:2048 sc1
buffer_load_dword v177, v106, s[24:27], 0 offen offset:3072 sc1
s_mov_b32 s99, 4096
buffer_load_dword v178, v106, s[24:27], s99 offen offset:0 sc1
s_mov_b32 s98, 0
buffer_load_dwordx4 v[138:141], v113, s[24:27], s98 offen sc1
s_mov_b32 s99, 0
buffer_load_dwordx4 a[0:3], v112, s[24:27], s99 offen offset:0 sc1
buffer_load_dwordx4 a[4:7], v112, s[24:27], s99 offen offset:1024 sc1
buffer_load_dwordx4 a[8:11], v112, s[24:27], s99 offen offset:2048 sc1
s_waitcnt vmcnt(12)
v_cmp_ne_u32 s[90:91], 0, v23
v_cmp_ne_u32 s[78:79], 0, v16
v_and_b32 v73, v94, v8
v_lshrrev_b32 v72, 10, v8
v_cmp_eq_u32 s[48:49], v73, v95
v_and_or_b32 v24, v72, v96, v97
s_mov_b64 exec, s[48:49]
ds_add_rtn_u32 v40, v24, v88
s_mov_b64 exec, -1
buffer_load_dwordx4 a[12:15], v112, s[24:27], s99 offen offset:3072 sc1
v_and_b32 v73, v94, v9
v_lshrrev_b32 v72, 10, v9
v_cmp_eq_u32 s[50:51], v73, v95
v_and_or_b32 v25, v72, v96, v97
s_mov_b64 exec, s[50:51]
ds_add_rtn_u32 v41, v25, v88
s_mov_b64 exec, -1
v_and_b32 v73, v94, v10
v_lshrrev_b32 v72, 10, v10
v_cmp_eq_u32 s[52:53], v73, v95
v_and_or_b32 v26, v72, v96, v97
s_mov_b64 exec, s[52:53]
ds_add_rtn_u32 v42, v26, v88
s_mov_b64 exec, -1
s_mov_b32 s99, 4096
buffer_load_dwordx4 a[16:19], v112, s[24:27], s99 offen offset:0 sc1
v_and_b32 v73, v94, v11
v_lshrrev_b32 v72, 10, v11
v_cmp_eq_u32 s[54:55], v73, v95
v_and_or_b32 v27, v72, v96, v97
s_mov_b64 exec, s[54:55]
ds_add_rtn_u32 v43, v27, v88
s_mov_b64 exec, -1
buffer_load_dwordx4 a[20:23], v112, s[24:27], s99 offen offset:1024 sc1
v_and_b32 v73, v94, v12
v_lshrrev_b32 v72, 10, v12
v_cmp_eq_u32 s[56:57], v73, v95
v_and_or_b32 v28, v72, v96, v97
s_mov_b64 exec, s[56:57]
ds_add_rtn_u32 v44, v28, v88
s_mov_b64 exec, -1
buffer_load_dwordx4 a[24:27], v112, s[24:27], s99 offen offset:2048 sc1
v_and_b32 v73, v94, v13
v_lshrrev_b32 v72, 10, v13
v_cmp_eq_u32 s[58:59], v73, v95
v_and_or_b32 v29, v72, v96, v97
s_mov_b64 exec, s[58:59]
ds_add_rtn_u32 v45, v29, v88
s_mov_b64 exec, -1
v_and_b32 v73, v94, v14
v_lshrrev_b32 v72, 10, v14
v_cmp_eq_u32 s[60:61], v73, v95
v_and_or_b32 v30, v72, v96, v97
s_mov_b64 exec, s[60:61]
ds_add_rtn_u32 v46, v30, v88
s_mov_b64 exec, -1
buffer_load_dwordx4 a[28:31], v112, s[24:27], s99 offen offset:3072 sc1
v_and_b32 v73, v94, v15
v_lshrrev_b32 v72, 10, v15
v_cmp_eq_u32 s[62:63], v73, v95
v_and_or_b32 v31, v72, v96, v97
s_mov_b64 exec, s[62:63]
ds_add_rtn_u32 v47, v31, v88
s_mov_b64 exec, -1
s_mov_b32 s99, 8192
buffer_load_dwordx4 a[32:35], v112, s[24:27], s99 offen offset:0 sc1
s_cmp_lg_u64 s[78:79], 0
s_cbranch_scc1 L_more1
L_more1b:
ds_read_b32 v72, v89
v_mov_b32 v73, 0
s_mov_b32 s98, 1024
buffer_load_dwordx4 v[142:145], v113, s[24:27], s98 offen sc1
buffer_load_dwordx4 a[36:39], v112, s[24:27], s99 offen offset:1024 sc1
buffer_load_dwordx4 a[40:43], v112, s[24:27], s99 offen offset:2048 sc1
s_waitcnt lgkmcnt(0)
s_mov_b64 vcc, s[80:81]
v_cndmask_b32_dpp v73, v72, v73, vcc quad_perm:[0,0,2,2] row_mask:0xf bank_mask:0xf
v_add_u32 v91, v103, v73
v_add_u32 v73, v72, v73
v_cmp_lt_u32 vcc, 32, v73
s_or_b32 s90, s90, s91
s_and_b32 s47, vcc_lo, 0x1ff
s_or_b32 s47, s47, s90
s_cbranch_scc1 L_greedy
L_greedyb:
buffer_load_dwordx4 a[44:47], v112, s[24:27], s99 offen offset:3072 sc1
ds_bpermute_b32 v56, v24, v91
ds_bpermute_b32 v57, v25, v91
ds_bpermute_b32 v58, v26, v91
ds_bpermute_b32 v59, v27, v91
ds_bpermute_b32 v60, v28, v91
ds_bpermute_b32 v61, v29, v91
ds_bpermute_b32 v62, v30, v91
ds_bpermute_b32 v63, v31, v91
s_mov_b32 s99, 12288
buffer_load_dwordx4 a[48:51], v112, s[24:27], s99 offen offset:0 sc1
buffer_load_dwordx4 a[52:55], v112, s[24:27], s99 offen offset:1024 sc1
buffer_load_dwordx4 a[56:59], v112, s[24:27], s99 offen offset:2048 sc1
s_waitcnt lgkmcnt(7)
v_add_u32 v73, v40, v56
v_and_b32 v72, 0x87e, v8
v_lshl_add_u32 v73, v73, 1, s93
v_add_u32 v72, v90, v72
s_andn2_b64 exec, s[48:49], s[90:91]
ds_write_b16_d16_hi v73, v8 offset:64
ds_write_b16 v73, v72 offset:384
ds_write_b16 v73, v8 offset:704
s_mov_b64 exec, -1
buffer_load_dwordx4 a[60:63], v112, s[24:27], s99 offen offset:3072 sc1
s_waitcnt lgkmcnt(9)
v_add_u32 v73, v41, v57
v_and_b32 v72, 0x87e, v9
v_lshl_add_u32 v73, v73, 1, s93
v_add_u32 v72, v90, v72
s_andn2_b64 exec, s[50:51], s[90:91]
ds_write_b16_d16_hi v73, v9 offset:64
ds_write_b16 v73, v72 offset:384
ds_write_b16 v73, v9 offset:704
s_mov_b64 exec, -1
s_mov_b32 s99, 16384
buffer_load_dwordx4 a[64:67], v112, s[24:27], s99 offen offset:0 sc1
s_waitcnt lgkmcnt(11)
v_add_u32 v73, v42, v58
v_and_b32 v72, 0x87e, v10
v_lshl_add_u32 v73, v73, 1, s93
v_add_u32 v72, v90, v72
s_andn2_b64 exec, s[52:53], s[90:91]
ds_write_b16_d16_hi v73, v10 offset:64
ds_write_b16 v73, v72 offset:384
ds_write_b16 v73, v10 offset:704
s_mov_b64 exec, -1
buffer_load_dwordx4 a[68:71], v112, s[24:27], s99 offen offset:1024 sc1
s_waitcnt lgkmcnt(13)
v_add_u32 v73, v43, v59
v_and_b32 v72, 0x87e, v11
v_lshl_add_u32 v73, v73, 1, s93
v_add_u32 v72, v90, v72
s_andn2_b64 exec, s[54:55], s[90:91]
ds_write_b16_d16_hi v73, v11 offset:64
ds_write_b16 v73, v72 offset:384
ds_write_b16 v73, v11 offset:704
s_mov_b64 exec, -1
s_mov_b32 s98, 2048
buffer_load_dwordx4 v[146:149], v113, s[24:27], s98 offen sc1
s_waitcnt lgkmcnt(15)
v_add_u32 v73, v44, v60
v_and_b32 v72, 0x87e, v12
v_lshl_add_u32 v73, v73, 1, s93
v_add_u32 v72, v90, v72
s_andn2_b64 exec, s[56:57], s[90:91]
ds_write_b16_d16_hi v73, v12 offset:64
ds_write_b16 v73, v72 offset:384
ds_write_b16 v73, v12 offset:704
s_mov_b64 exec, -1
buffer_load_dwordx4 a[72:75], v112, s[24:27], s99 offen offset:2048 sc1
s_waitcnt lgkmcnt(15)
v_add_u32 v73, v45, v61
v_and_b32 v72, 0x87e, v13
v_lshl_add_u32 v73, v73, 1, s93
v_add_u32 v72, v90, v72
s_andn2_b64 exec, s[58:59], s[90:91]
ds_write_b16_d16_hi v73, v13 offset:64
ds_write_b16 v73, v72 offset:384
ds_write_b16 v73, v13 offset:704
s_mov_b64 exec, -1
buffer_load_dwordx4 a[76:79], v112, s[24:27], s99 offen offset:3072 sc1
s_waitcnt lgkmcnt(15)
v_add_u32 v73, v46, v62
v_and_b32 v72, 0x87e, v14
v_lshl_add_u32 v73, v73, 1, s93
v_add_u32 v72, v90, v72
s_andn2_b64 exec, s[60:61], s[90:91]
ds_write_b16_d16_hi v73, v14 offset:64
ds_write_b16 v73, v72 offset:384
ds_write_b16 v73, v14 offset:704
s_mov_b64 exec, -1
s_mov_b32 s99, 20480
buffer_load_dwordx4 a[80:83], v112, s[24:27], s99 offen offset:0 sc1
s_waitcnt lgkmcnt(15)
v_add_u32 v73, v47, v63
v_and_b32 v72, 0x87e, v15
v_lshl_add_u32 v73, v73, 1, s93
v_add_u32 v72, v90, v72
s_andn2_b64 exec, s[62:63], s[90:91]
ds_write_b16_d16_hi v73, v15 offset:64
ds_write_b16 v73, v72 offset:384
ds_write_b16 v73, v15 offset:704
s_mov_b64 exec, -1
buffer_load_dwordx4 a[84:87], v112, s[24:27], s99 offen offset:1024 sc1
buffer_load_dwordx4 a[88:91], v112, s[24:27], s99 offen offset:2048 sc1
s_cmp_lg_u64 s[78:79], 0
s_cbranch_scc1 L_more2
L_more2b:
ds_read_u16 v8, v101 offset:704
ds_read_u16 v9, v101 offset:832
ds_read_u16 v10, v101 offset:960
ds_read2_b64 v[118:121], v102 offset0:48 offset1:52
ds_read2_b64 v[122:125], v102 offset0:56 offset1:60
ds_read2_b64 v[126:129], v102 offset0:64 offset1:68
ds_read2_b64 v[130:133], v102 offset0:72 offset1:76
ds_read2_b64 v[134:137], v102 offset0:80 offset1:84
buffer_load_dwordx4 a[92:95], v112, s[24:27], s99 offen offset:3072 sc1
s_mov_b32 s99, 24576
buffer_load_dwordx4 a[96:99], v112, s[24:27], s99 offen offset:0 sc1
buffer_load_dwordx4 a[100:103], v112, s[24:27], s99 offen offset:1024 sc1
s_waitcnt lgkmcnt(5)
v_lshrrev_b32 v72, 12, v8
v_cmp_ne_u32 vcc, 0, v8
v_min_u32 v72, 8, v72
v_add3_u32 v72, v72, v98, 0
v_lshlrev_b32 v73, 4, v72
v_lshrrev_b32 v72, 1, v72
buffer_load_dwordx4 a[104:107], v112, s[24:27], s99 offen offset:2048 sc1
v_lshlrev_b32 v73, v73, v100
v_lshl_add_u32 v72, v72, 8, v99
v_bfe_u32 v74, v8, 7, 4
v_lshl_add_u32 v72, v74, 2, v72
s_mov_b64 exec, vcc
ds_xor_b32 v72, v73 offset:1792
s_mov_b64 exec, -1
v_lshrrev_b32 v72, 12, v9
v_cmp_ne_u32 vcc, 0, v9
v_min_u32 v72, 8, v72
v_add3_u32 v72, v72, v98, 2
v_lshlrev_b32 v73, 4, v72
v_lshrrev_b32 v72, 1, v72
s_mov_b32 s98, 3072
buffer_load_dwordx4 v[150:153], v113, s[24:27], s98 offen sc1
v_lshlrev_b32 v73, v73, v100
v_lshl_add_u32 v72, v72, 8, v99
v_bfe_u32 v74, v9, 7, 4
v_lshl_add_u32 v72, v74, 2, v72
s_mov_b64 exec, vcc
ds_xor_b32 v72, v73 offset:1792
s_mov_b64 exec, -1
buffer_load_dwordx4 a[108:111], v112, s[24:27], s99 offen offset:3072 sc1
v_lshrrev_b32 v72, 12, v10
v_cmp_ne_u32 vcc, 0, v10
v_min_u32 v72, 8, v72
v_add3_u32 v72, v72, v98, 4
v_lshlrev_b32 v73, 4, v72
v_lshrrev_b32 v72, 1, v72
v_lshlrev_b32 v73, v73, v100
v_lshl_add_u32 v72, v72, 8, v99
v_bfe_u32 v74, v10, 7, 4
v_lshl_add_u32 v72, v74, 2, v72
s_mov_b64 exec, vcc
s_mov_b32 exec_hi, 0
ds_xor_b32 v72, v73 offset:1792
s_mov_b64 exec, -1
s_mov_b32 s99, 28672
buffer_load_dwordx4 a[112:115], v112, s[24:27], s99 offen offset:0 sc1
ds_read_b32 v179, v89 offset:1792
ds_read_b32 v180, v89 offset:2048
ds_read_b32 v181, v89 offset:2304
ds_read_b32 v182, v89 offset:2560
ds_read_b32 v183, v89 offset:2816
ds_read_b32 v184, v89 offset:3072
ds_read_b32 v185, v89 offset:3328
buffer_load_dwordx4 a[116:119], v112, s[24:27], s99 offen offset:1024 sc1
s_waitcnt lgkmcnt(10)
v_xor_b32 v118, v92, v118
v_xor_b32 v119, v92, v119
v_xor_b32 v120, v92, v120
v_xor_b32 v121, v92, v121
buffer_load_dwordx4 a[120:123], v112, s[24:27], s99 offen offset:2048 sc1
v_xor_b32 v122, v92, v122
v_xor_b32 v123, v92, v123
v_xor_b32 v124, v92, v124
v_xor_b32 v125, v92, v125
v_xor_b32 v126, v92, v126
v_xor_b32 v127, v92, v127
v_xor_b32 v128, v92, v128
v_xor_b32 v129, v92, v129
buffer_load_dwordx4 a[124:127], v112, s[24:27], s99 offen offset:3072 sc1
v_xor_b32 v130, v92, v130
v_xor_b32 v131, v92, v131
v_xor_b32 v132, v92, v132
v_xor_b32 v133, v92, v133
v_xor_b32 v134, v92, v134
v_xor_b32 v135, v92, v135
v_xor_b32 v136, v92, v136
v_xor_b32 v137, v92, v137
v_lshlrev_b32 v114, 16, v110
v_and_b32 v115, 0xffff0000, v110
v_lshlrev_b32 v116, 16, v111
v_and_b32 v117, 0xffff0000, v111
s_mov_b32 exec_hi, 15
ds_write_b128 v109, v[114:117] offset:1024
s_mov_b64 exec, -1
s_mov_b32 s99, 32768
buffer_load_dwordx4 a[128:131], v112, s[24:27], s99 offen offset:0 sc1
s_mov_b32 s41, 2
s_mov_b32 s42, 0
s_mov_b32 s4, 37120
s_mov_b32 s22, 75497472
s_mov_b32 s5, 18560
s_mov_b32 s6, 4718592
s_mov_b64 vcc, s[80:81]
s_andn2_b32 s12, 63, s85
s_mov_b32 s59, 6
s_mov_b32 s56, 0
s_mov_b32 s64, 384
s_bitcmp1_b32 s2, 0
s_cselect_b32 s65, 288, -1
s_add_u32 s48, s46, 9437184
s_add_u32 s49, s48, 4718592
s_add_u32 s50, s49, 4718592
s_sub_u32 s58, s7, s45
s_bfe_u32 s47, s2, 0x20004
s_mul_i32 s57, s47, 294912
s_add_u32 s57, s57, 47185920
s_lshl_b32 s47, s47, 7
s_add_u32 s47, s47, 393216
s_add_u32 s32, s24, s47
s_addc_u32 s33, s25, 0
s_cmp_eq_u32 s40, 0
s_cselect_b32 s34, 4, 0
s_cselect_b64 s[62:63], 1, 0
s_waitcnt lgkmcnt(0)
v_mov_b32 v114, 163072
s_barrier
ds_read_b32 v114, v114
ds_read_b128 v[44:47], v0 offset:0
ds_read_b128 v[48:51], v1 offset:0
s_waitcnt vmcnt(18)
ds_read_b128 v[76:79], v2 offset:1024
ds_read_b128 v[80:83], v2 offset:1088
ds_read_b128 v[84:87], v2 offset:1152
ds_read_b128 v[88:91], v2 offset:1216
ds_read_b128 v[92:95], v2 offset:1280
ds_read_b128 v[96:99], v2 offset:1344
ds_read_b128 v[100:103], v2 offset:1408
ds_read_b128 v[104:107], v2 offset:1472
ds_read_b128 v[108:111], v2 offset:1536
buffer_load_dwordx4 a[132:135], v112, s[24:27], s99 offen offset:1024 sc1
ds_read_b128 v[8:11], v2 offset:1024
ds_read_b128 v[12:15], v2 offset:1088
ds_read_b128 v[16:19], v2 offset:1152
ds_read_b128 v[20:23], v2 offset:1216
ds_read_b128 v[24:27], v2 offset:1280
ds_read_b128 v[28:31], v2 offset:1344
ds_read_b128 v[32:35], v2 offset:1408
ds_read_b128 v[36:39], v2 offset:1472
ds_read_b128 v[40:43], v2 offset:1536
buffer_load_dwordx4 a[136:139], v112, s[24:27], s99 offen offset:2048 sc1
s_waitcnt lgkmcnt(15)
v_readfirstlane_b32 s47, v114
v_add_u32_sdwa v60, s42, v118 dst_sel:DWORD dst_unused:UNUSED_PAD src0_sel:DWORD src1_sel:WORD_0
s_cmp_lg_u32 s47, 0
s_cbranch_scc1 L_slow
v_smfmac_f32_16x16x64_bf16 v[76:79], a[0:3], v[44:51], v138
ds_read_b128 v[52:55], v0 offset:18560
ds_read_b128 v[56:59], v1 offset:18560
v_add_u32_sdwa v68, s42, v118 dst_sel:DWORD dst_unused:UNUSED_PAD src0_sel:DWORD src1_sel:WORD_0
v_smfmac_f32_16x16x64_bf16 v[80:83], a[4:7], v[44:51], v138 abid:1
ds_read_u16 v68, v68 offset:18560
v_add_u32_sdwa v69, s42, v118 dst_sel:DWORD dst_unused:UNUSED_PAD src0_sel:DWORD src1_sel:WORD_1
v_smfmac_f32_16x16x64_bf16 v[84:87], a[8:11], v[44:51], v139
s_waitcnt lgkmcnt(15)
buffer_load_dwordx4 a[140:143], v112, s[24:27], s99 offen offset:3072 sc1
ds_read_u16 v69, v69 offset:18560
v_add_u32_sdwa v70, s42, v119 dst_sel:DWORD dst_unused:UNUSED_PAD src0_sel:DWORD src1_sel:WORD_0
v_smfmac_f32_16x16x64_bf16 v[88:91], a[12:15], v[44:51], v139 abid:1
ds_read_u16 v70, v70 offset:18560
v_add_u32_sdwa v71, s42, v119 dst_sel:DWORD dst_unused:UNUSED_PAD src0_sel:DWORD src1_sel:WORD_1
v_smfmac_f32_16x16x64_bf16 v[92:95], a[16:19], v[44:51], v140
ds_read_u16 v71, v71 offset:18560
v_add_u32_sdwa v72, s42, v120 dst_sel:DWORD dst_unused:UNUSED_PAD src0_sel:DWORD src1_sel:WORD_0
v_smfmac_f32_16x16x64_bf16 v[96:99], a[20:23], v[44:51], v140 abid:1
s_waitcnt lgkmcnt(15)
s_mov_b32 s98, 4096
buffer_load_dwordx4 v[154:157], v113, s[24:27], s98 offen sc1
ds_read_u16 v72, v72 offset:18560
v_add_u32_sdwa v73, s42, v120 dst_sel:DWORD dst_unused:UNUSED_PAD src0_sel:DWORD src1_sel:WORD_1
v_smfmac_f32_16x16x64_bf16 v[100:103], a[24:27], v[44:51], v141
ds_read_u16 v73, v73 offset:18560
v_add_u32_sdwa v74, s42, v121 dst_sel:DWORD dst_unused:UNUSED_PAD src0_sel:DWORD src1_sel:WORD_0
v_smfmac_f32_16x16x64_bf16 v[104:107], a[28:31], v[44:51], v141 abid:1
ds_read_u16 v74, v74 offset:18560
v_add_u32_sdwa v75, s42, v121 dst_sel:DWORD dst_unused:UNUSED_PAD src0_sel:DWORD src1_sel:WORD_1
v_smfmac_f32_16x16x64_bf16 v[108:111], a[32:35], v[44:51], v174
s_waitcnt lgkmcnt(7)
s_mov_b32 s99, 36864
buffer_load_dwordx4 a[144:147], v112, s[24:27], s99 offen offset:0 sc1
ds_read_u16 v75, v75 offset:18560
v_smfmac_f32_16x16x64_bf16 v[8:11], a[0:3], v[52:59], v138
ds_read_b128 v[114:117], v2 offset:64
v_add_u32_sdwa v60, s42, v118 dst_sel:DWORD dst_unused:UNUSED_PAD src0_sel:DWORD src1_sel:WORD_0
v_smfmac_f32_16x16x64_bf16 v[12:15], a[4:7], v[52:59], v138 abid:1
ds_read_b128 v[44:47], v0 offset:2048
v_add_u32_sdwa v61, s42, v118 dst_sel:DWORD dst_unused:UNUSED_PAD src0_sel:DWORD src1_sel:WORD_1
v_smfmac_f32_16x16x64_bf16 v[16:19], a[8:11], v[52:59], v139
buffer_load_dwordx4 a[148:151], v112, s[24:27], s99 offen offset:1024 sc1
ds_read_b128 v[48:51], v1 offset:2048
v_add_u32_sdwa v62, s42, v119 dst_sel:DWORD dst_unused:UNUSED_PAD src0_sel:DWORD src1_sel:WORD_0
v_smfmac_f32_16x16x64_bf16 v[20:23], a[12:15], v[52:59], v139 abid:1
ds_read_u16 v60, v60 offset:0
v_add_u32_sdwa v63, s42, v119 dst_sel:DWORD dst_unused:UNUSED_PAD src0_sel:DWORD src1_sel:WORD_1
v_smfmac_f32_16x16x64_bf16 v[24:27], a[16:19], v[52:59], v140
ds_read_u16 v61, v61 offset:0
v_add_u32_sdwa v64, s42, v120 dst_sel:DWORD dst_unused:UNUSED_PAD src0_sel:DWORD src1_sel:WORD_0
v_smfmac_f32_16x16x64_bf16 v[28:31], a[20:23], v[52:59], v140 abid:1
buffer_load_dwordx4 a[152:155], v112, s[24:27], s99 offen offset:2048 sc1
ds_read_u16 v62, v62 offset:0
v_add_u32_sdwa v65, s42, v120 dst_sel:DWORD dst_unused:UNUSED_PAD src0_sel:DWORD src1_sel:WORD_1
v_smfmac_f32_16x16x64_bf16 v[32:35], a[24:27], v[52:59], v141
ds_read_u16 v63, v63 offset:0
v_add_u32_sdwa v66, s42, v121 dst_sel:DWORD dst_unused:UNUSED_PAD src0_sel:DWORD src1_sel:WORD_0
v_smfmac_f32_16x16x64_bf16 v[36:39], a[28:31], v[52:59], v141 abid:1
ds_read_u16 v64, v64 offset:0
v_add_u32_sdwa v67, s42, v121 dst_sel:DWORD dst_unused:UNUSED_PAD src0_sel:DWORD src1_sel:WORD_1
v_smfmac_f32_16x16x64_bf16 v[40:43], a[32:35], v[52:59], v174
s_waitcnt lgkmcnt(7)
buffer_load_dwordx4 a[156:159], v112, s[24:27], s99 offen offset:3072 sc1
ds_read_u16 v65, v65 offset:0
v_smfmac_f32_16x16x64_bf16 v[8:11], v[114:117], v[68:75], v179
ds_read_u16 v66, v66 offset:0
v_smfmac_f32_16x16x64_bf16 v[12:15], v[114:117], v[68:75], v179 abid:1
s_waitcnt lgkmcnt(7)
ds_read_u16 v67, v67 offset:0
v_smfmac_f32_16x16x64_bf16 v[76:79], a[36:39], v[44:51], v142
s_mov_b32 s99, 40960
buffer_load_dwordx4 a[160:163], v112, s[24:27], s99 offen offset:0 sc1
ds_read_b128 v[52:55], v0 offset:20608
v_add_u32_sdwa v68, s42, v122 dst_sel:DWORD dst_unused:UNUSED_PAD src0_sel:DWORD src1_sel:WORD_0
v_smfmac_f32_16x16x64_bf16 v[80:83], a[40:43], v[44:51], v142 abid:1
ds_read_b128 v[56:59], v1 offset:20608
v_add_u32_sdwa v69, s42, v122 dst_sel:DWORD dst_unused:UNUSED_PAD src0_sel:DWORD src1_sel:WORD_1
v_smfmac_f32_16x16x64_bf16 v[84:87], a[44:47], v[44:51], v143
ds_read_u16 v68, v68 offset:18560
v_add_u32_sdwa v70, s42, v123 dst_sel:DWORD dst_unused:UNUSED_PAD src0_sel:DWORD src1_sel:WORD_0
v_smfmac_f32_16x16x64_bf16 v[88:91], a[48:51], v[44:51], v143 abid:1
buffer_load_dwordx4 a[164:167], v112, s[24:27], s99 offen offset:1024 sc1
ds_read_u16 v69, v69 offset:18560
v_add_u32_sdwa v71, s42, v123 dst_sel:DWORD dst_unused:UNUSED_PAD src0_sel:DWORD src1_sel:WORD_1
v_smfmac_f32_16x16x64_bf16 v[92:95], a[52:55], v[44:51], v144
ds_read_u16 v70, v70 offset:18560
v_add_u32_sdwa v72, s42, v124 dst_sel:DWORD dst_unused:UNUSED_PAD src0_sel:DWORD src1_sel:WORD_0
v_smfmac_f32_16x16x64_bf16 v[96:99], a[56:59], v[44:51], v144 abid:1
ds_read_u16 v71, v71 offset:18560
v_add_u32_sdwa v73, s42, v124 dst_sel:DWORD dst_unused:UNUSED_PAD src0_sel:DWORD src1_sel:WORD_1
v_smfmac_f32_16x16x64_bf16 v[100:103], a[60:63], v[44:51], v145
buffer_load_dwordx4 a[168:171], v112, s[24:27], s99 offen offset:2048 sc1
ds_read_u16 v72, v72 offset:18560
v_add_u32_sdwa v74, s42, v125 dst_sel:DWORD dst_unused:UNUSED_PAD src0_sel:DWORD src1_sel:WORD_0
v_smfmac_f32_16x16x64_bf16 v[104:107], a[64:67], v[44:51], v145 abid:1
s_waitcnt vmcnt(18)
ds_read_u16 v73, v73 offset:18560
v_add_u32_sdwa v75, s42, v125 dst_sel:DWORD dst_unused:UNUSED_PAD src0_sel:DWORD src1_sel:WORD_1
v_smfmac_f32_16x16x64_bf16 v[108:111], a[68:71], v[44:51], v174 abid:1
s_waitcnt lgkmcnt(8)
ds_read_u16 v74, v74 offset:18560
v_smfmac_f32_16x16x64_bf16 v[76:79], v[114:117], v[60:67], v179
buffer_load_dwordx4 a[172:175], v112, s[24:27], s99 offen offset:3072 sc1
ds_read_u16 v75, v75 offset:18560
v_smfmac_f32_16x16x64_bf16 v[80:83], v[114:117], v[60:67], v179 abid:1
s_waitcnt lgkmcnt(8)
v_smfmac_f32_16x16x64_bf16 v[8:11], a[36:39], v[52:59], v142
ds_read_b128 v[114:117], v2 offset:128
v_add_u32_sdwa v60, s42, v122 dst_sel:DWORD dst_unused:UNUSED_PAD src0_sel:DWORD src1_sel:WORD_0
v_smfmac_f32_16x16x64_bf16 v[12:15], a[40:43], v[52:59], v142 abid:1
s_mov_b32 s99, 45056
buffer_load_dwordx4 a[176:179], v112, s[24:27], s99 offen offset:0 sc1
ds_read_b128 v[44:47], v0 offset:4096
v_add_u32_sdwa v61, s42, v122 dst_sel:DWORD dst_unused:UNUSED_PAD src0_sel:DWORD src1_sel:WORD_1
v_smfmac_f32_16x16x64_bf16 v[16:19], a[44:47], v[52:59], v143
ds_read_b128 v[48:51], v1 offset:4096
v_add_u32_sdwa v62, s42, v123 dst_sel:DWORD dst_unused:UNUSED_PAD src0_sel:DWORD src1_sel:WORD_0
v_smfmac_f32_16x16x64_bf16 v[20:23], a[48:51], v[52:59], v143 abid:1
ds_read_u16 v60, v60 offset:0
v_add_u32_sdwa v63, s42, v123 dst_sel:DWORD dst_unused:UNUSED_PAD src0_sel:DWORD src1_sel:WORD_1
v_smfmac_f32_16x16x64_bf16 v[24:27], a[52:55], v[52:59], v144
s_mov_b32 s98, 5120
buffer_load_dwordx4 v[158:161], v113, s[24:27], s98 offen sc1
ds_read_u16 v61, v61 offset:0
v_add_u32_sdwa v64, s42, v124 dst_sel:DWORD dst_unused:UNUSED_PAD src0_sel:DWORD src1_sel:WORD_0
v_smfmac_f32_16x16x64_bf16 v[28:31], a[56:59], v[52:59], v144 abid:1
ds_read_u16 v62, v62 offset:0
v_add_u32_sdwa v65, s42, v124 dst_sel:DWORD dst_unused:UNUSED_PAD src0_sel:DWORD src1_sel:WORD_1
v_smfmac_f32_16x16x64_bf16 v[32:35], a[60:63], v[52:59], v145
ds_read_u16 v63, v63 offset:0
v_add_u32_sdwa v66, s42, v125 dst_sel:DWORD dst_unused:UNUSED_PAD src0_sel:DWORD src1_sel:WORD_0
v_smfmac_f32_16x16x64_bf16 v[36:39], a[64:67], v[52:59], v145 abid:1
buffer_load_dwordx4 a[180:183], v112, s[24:27], s99 offen offset:1024 sc1
ds_read_u16 v64, v64 offset:0
v_add_u32_sdwa v67, s42, v125 dst_sel:DWORD dst_unused:UNUSED_PAD src0_sel:DWORD src1_sel:WORD_1
v_smfmac_f32_16x16x64_bf16 v[40:43], a[68:71], v[52:59], v174 abid:1
s_waitcnt lgkmcnt(7)
ds_read_u16 v65, v65 offset:0
v_smfmac_f32_16x16x64_bf16 v[12:15], v[114:117], v[68:75], v180
ds_read_u16 v66, v66 offset:0
v_smfmac_f32_16x16x64_bf16 v[16:19], v[114:117], v[68:75], v180 abid:1
buffer_load_dwordx4 a[184:187], v112, s[24:27], s99 offen offset:2048 sc1
ds_read_u16 v67, v67 offset:0
v_smfmac_f32_16x16x64_bf16 v[20:23], v[114:117], v[68:75], v181
s_waitcnt lgkmcnt(8)
v_smfmac_f32_16x16x64_bf16 v[76:79], a[72:75], v[44:51], v146
ds_read_b128 v[52:55], v0 offset:22656
v_add_u32_sdwa v68, s42, v126 dst_sel:DWORD dst_unused:UNUSED_PAD src0_sel:DWORD src1_sel:WORD_0
v_smfmac_f32_16x16x64_bf16 v[80:83], a[76:79], v[44:51], v146 abid:1
buffer_load_dwordx4 a[188:191], v112, s[24:27], s99 offen offset:3072 sc1
ds_read_b128 v[56:59], v1 offset:22656
v_add_u32_sdwa v69, s42, v126 dst_sel:DWORD dst_unused:UNUSED_PAD src0_sel:DWORD src1_sel:WORD_1
v_smfmac_f32_16x16x64_bf16 v[84:87], a[80:83], v[44:51], v147
ds_read_u16 v68, v68 offset:18560
v_add_u32_sdwa v70, s42, v127 dst_sel:DWORD dst_unused:UNUSED_PAD src0_sel:DWORD src1_sel:WORD_0
v_smfmac_f32_16x16x64_bf16 v[88:91], a[84:87], v[44:51], v147 abid:1
ds_read_u16 v69, v69 offset:18560
v_add_u32_sdwa v71, s42, v127 dst_sel:DWORD dst_unused:UNUSED_PAD src0_sel:DWORD src1_sel:WORD_1
v_smfmac_f32_16x16x64_bf16 v[92:95], a[88:91], v[44:51], v148
s_mov_b32 s99, 49152
buffer_load_dwordx4 a[192:195], v112, s[24:27], s99 offen offset:0 sc1
ds_read_u16 v70, v70 offset:18560
v_add_u32_sdwa v72, s42, v128 dst_sel:DWORD dst_unused:UNUSED_PAD src0_sel:DWORD src1_sel:WORD_0
v_smfmac_f32_16x16x64_bf16 v[96:99], a[92:95], v[44:51], v148 abid:1
ds_read_u16 v71, v71 offset:18560
v_add_u32_sdwa v73, s42, v128 dst_sel:DWORD dst_unused:UNUSED_PAD src0_sel:DWORD src1_sel:WORD_1
v_smfmac_f32_16x16x64_bf16 v[100:103], a[96:99], v[44:51], v149
ds_read_u16 v72, v72 offset:18560
v_add_u32_sdwa v74, s42, v129 dst_sel:DWORD dst_unused:UNUSED_PAD src0_sel:DWORD src1_sel:WORD_0
v_smfmac_f32_16x16x64_bf16 v[104:107], a[100:103], v[44:51], v149 abid:1
buffer_load_dwordx4 a[196:199], v112, s[24:27], s99 offen offset:1024 sc1
ds_read_u16 v73, v73 offset:18560
v_add_u32_sdwa v75, s42, v129 dst_sel:DWORD dst_unused:UNUSED_PAD src0_sel:DWORD src1_sel:WORD_1
v_smfmac_f32_16x16x64_bf16 v[108:111], a[104:107], v[44:51], v175
s_waitcnt lgkmcnt(8)
ds_read_u16 v74, v74 offset:18560
v_smfmac_f32_16x16x64_bf16 v[80:83], v[114:117], v[60:67], v180
ds_read_u16 v75, v75 offset:18560
v_smfmac_f32_16x16x64_bf16 v[84:87], v[114:117], v[60:67], v180 abid:1
buffer_load_dwordx4 a[200:203], v112, s[24:27], s99 offen offset:2048 sc1
v_smfmac_f32_16x16x64_bf16 v[88:91], v[114:117], v[60:67], v181
s_waitcnt lgkmcnt(8)
v_smfmac_f32_16x16x64_bf16 v[8:11], a[72:75], v[52:59], v146
ds_read_b128 v[114:117], v2 offset:192
v_add_u32_sdwa v60, s42, v126 dst_sel:DWORD dst_unused:UNUSED_PAD src0_sel:DWORD src1_sel:WORD_0
v_smfmac_f32_16x16x64_bf16 v[12:15], a[76:79], v[52:59], v146 abid:1
buffer_load_dwordx4 a[204:207], v112, s[24:27], s99 offen offset:3072 sc1
ds_read_b128 v[44:47], v0 offset:6144
v_add_u32_sdwa v61, s42, v126 dst_sel:DWORD dst_unused:UNUSED_PAD src0_sel:DWORD src1_sel:WORD_1
v_smfmac_f32_16x16x64_bf16 v[16:19], a[80:83], v[52:59], v147
ds_read_b128 v[48:51], v1 offset:6144
v_add_u32_sdwa v62, s42, v127 dst_sel:DWORD dst_unused:UNUSED_PAD src0_sel:DWORD src1_sel:WORD_0
v_smfmac_f32_16x16x64_bf16 v[20:23], a[84:87], v[52:59], v147 abid:1
ds_read_u16 v60, v60 offset:0
v_add_u32_sdwa v63, s42, v127 dst_sel:DWORD dst_unused:UNUSED_PAD src0_sel:DWORD src1_sel:WORD_1
v_smfmac_f32_16x16x64_bf16 v[24:27], a[88:91], v[52:59], v148
s_mov_b32 s99, 53248
buffer_load_dwordx4 a[208:211], v112, s[24:27], s99 offen offset:0 sc1
ds_read_u16 v61, v61 offset:0
v_add_u32_sdwa v64, s42, v128 dst_sel:DWORD dst_unused:UNUSED_PAD src0_sel:DWORD src1_sel:WORD_0
v_smfmac_f32_16x16x64_bf16 v[28:31], a[92:95], v[52:59], v148 abid:1
ds_read_u16 v62, v62 offset:0
v_add_u32_sdwa v65, s42, v128 dst_sel:DWORD dst_unused:UNUSED_PAD src0_sel:DWORD src1_sel:WORD_1
v_smfmac_f32_16x16x64_bf16 v[32:35], a[96:99], v[52:59], v149
ds_read_u16 v63, v63 offset:0
v_add_u32_sdwa v66, s42, v129 dst_sel:DWORD dst_unused:UNUSED_PAD src0_sel:DWORD src1_sel:WORD_0
v_smfmac_f32_16x16x64_bf16 v[36:39], a[100:103], v[52:59], v149 abid:1
buffer_load_dwordx4 a[212:215], v112, s[24:27], s99 offen offset:1024 sc1
ds_read_u16 v64, v64 offset:0
v_add_u32_sdwa v67, s42, v129 dst_sel:DWORD dst_unused:UNUSED_PAD src0_sel:DWORD src1_sel:WORD_1
v_smfmac_f32_16x16x64_bf16 v[40:43], a[104:107], v[52:59], v175
s_waitcnt lgkmcnt(7)
ds_read_u16 v65, v65 offset:0
v_smfmac_f32_16x16x64_bf16 v[20:23], v[114:117], v[68:75], v181 abid:1
ds_read_u16 v66, v66 offset:0
v_smfmac_f32_16x16x64_bf16 v[24:27], v[114:117], v[68:75], v182
s_mov_b32 s98, 6144
buffer_load_dwordx4 v[162:165], v113, s[24:27], s98 offen sc1
ds_read_u16 v67, v67 offset:0
v_smfmac_f32_16x16x64_bf16 v[28:31], v[114:117], v[68:75], v182 abid:1
s_waitcnt vmcnt(18) lgkmcnt(8)
v_smfmac_f32_16x16x64_bf16 v[76:79], a[108:111], v[44:51], v150
ds_read_b128 v[52:55], v0 offset:24704
v_add_u32_sdwa v68, s42, v130 dst_sel:DWORD dst_unused:UNUSED_PAD src0_sel:DWORD src1_sel:WORD_0
v_smfmac_f32_16x16x64_bf16 v[80:83], a[112:115], v[44:51], v150 abid:1
buffer_load_dwordx4 a[216:219], v112, s[24:27], s99 offen offset:2048 sc1
ds_read_b128 v[56:59], v1 offset:24704
v_add_u32_sdwa v69, s42, v130 dst_sel:DWORD dst_unused:UNUSED_PAD src0_sel:DWORD src1_sel:WORD_1
v_smfmac_f32_16x16x64_bf16 v[84:87], a[116:119], v[44:51], v151
ds_read_u16 v68, v68 offset:18560
v_add_u32_sdwa v70, s42, v131 dst_sel:DWORD dst_unused:UNUSED_PAD src0_sel:DWORD src1_sel:WORD_0
v_smfmac_f32_16x16x64_bf16 v[88:91], a[120:123], v[44:51], v151 abid:1
ds_read_u16 v69, v69 offset:18560
v_add_u32_sdwa v71, s42, v131 dst_sel:DWORD dst_unused:UNUSED_PAD src0_sel:DWORD src1_sel:WORD_1
v_smfmac_f32_16x16x64_bf16 v[92:95], a[124:127], v[44:51], v152
buffer_load_dwordx4 a[220:223], v112, s[24:27], s99 offen offset:3072 sc1
ds_read_u16 v70, v70 offset:18560
v_add_u32_sdwa v72, s42, v132 dst_sel:DWORD dst_unused:UNUSED_PAD src0_sel:DWORD src1_sel:WORD_0
v_smfmac_f32_16x16x64_bf16 v[96:99], a[128:131], v[44:51], v152 abid:1
ds_read_u16 v71, v71 offset:18560
v_add_u32_sdwa v73, s42, v132 dst_sel:DWORD dst_unused:UNUSED_PAD src0_sel:DWORD src1_sel:WORD_1
v_smfmac_f32_16x16x64_bf16 v[100:103], a[132:135], v[44:51], v153
ds_read_u16 v72, v72 offset:18560
v_add_u32_sdwa v74, s42, v133 dst_sel:DWORD dst_unused:UNUSED_PAD src0_sel:DWORD src1_sel:WORD_0
v_smfmac_f32_16x16x64_bf16 v[104:107], a[136:139], v[44:51], v153 abid:1
s_mov_b32 s99, 57344
buffer_load_dwordx4 a[224:227], v112, s[24:27], s99 offen offset:0 sc1
ds_read_u16 v73, v73 offset:18560
v_add_u32_sdwa v75, s42, v133 dst_sel:DWORD dst_unused:UNUSED_PAD src0_sel:DWORD src1_sel:WORD_1
v_smfmac_f32_16x16x64_bf16 v[108:111], a[140:143], v[44:51], v175 abid:1
s_waitcnt lgkmcnt(8)
ds_read_u16 v74, v74 offset:18560
v_smfmac_f32_16x16x64_bf16 v[88:91], v[114:117], v[60:67], v181 abid:1
buffer_load_dwordx4 a[228:231], v112, s[24:27], s99 offen offset:1024 sc1
ds_read_u16 v75, v75 offset:18560
v_smfmac_f32_16x16x64_bf16 v[92:95], v[114:117], v[60:67], v182
v_smfmac_f32_16x16x64_bf16 v[96:99], v[114:117], v[60:67], v182 abid:1
s_waitcnt lgkmcnt(8)
v_smfmac_f32_16x16x64_bf16 v[8:11], a[108:111], v[52:59], v150
buffer_load_dwordx4 a[232:235], v112, s[24:27], s99 offen offset:2048 sc1
ds_read_b128 v[114:117], v2 offset:256
v_add_u32_sdwa v60, s42, v130 dst_sel:DWORD dst_unused:UNUSED_PAD src0_sel:DWORD src1_sel:WORD_0
v_smfmac_f32_16x16x64_bf16 v[12:15], a[112:115], v[52:59], v150 abid:1
ds_read_b128 v[44:47], v0 offset:8192
v_add_u32_sdwa v61, s42, v130 dst_sel:DWORD dst_unused:UNUSED_PAD src0_sel:DWORD src1_sel:WORD_1
v_smfmac_f32_16x16x64_bf16 v[16:19], a[116:119], v[52:59], v151
ds_read_b128 v[48:51], v1 offset:8192
v_add_u32_sdwa v62, s42, v131 dst_sel:DWORD dst_unused:UNUSED_PAD src0_sel:DWORD src1_sel:WORD_0
v_smfmac_f32_16x16x64_bf16 v[20:23], a[120:123], v[52:59], v151 abid:1
buffer_load_dwordx4 a[236:239], v112, s[24:27], s99 offen offset:3072 sc1
ds_read_u16 v60, v60 offset:0
v_add_u32_sdwa v63, s42, v131 dst_sel:DWORD dst_unused:UNUSED_PAD src0_sel:DWORD src1_sel:WORD_1
v_smfmac_f32_16x16x64_bf16 v[24:27], a[124:127], v[52:59], v152
ds_read_u16 v61, v61 offset:0
v_add_u32_sdwa v64, s42, v132 dst_sel:DWORD dst_unused:UNUSED_PAD src0_sel:DWORD src1_sel:WORD_0
v_smfmac_f32_16x16x64_bf16 v[28:31], a[128:131], v[52:59], v152 abid:1
ds_read_u16 v62, v62 offset:0
v_add_u32_sdwa v65, s42, v132 dst_sel:DWORD dst_unused:UNUSED_PAD src0_sel:DWORD src1_sel:WORD_1
v_smfmac_f32_16x16x64_bf16 v[32:35], a[132:135], v[52:59], v153
s_mov_b32 s99, 61440
buffer_load_dwordx4 a[240:243], v112, s[24:27], s99 offen offset:0 sc1
ds_read_u16 v63, v63 offset:0
v_add_u32_sdwa v66, s42, v133 dst_sel:DWORD dst_unused:UNUSED_PAD src0_sel:DWORD src1_sel:WORD_0
v_smfmac_f32_16x16x64_bf16 v[36:39], a[136:139], v[52:59], v153 abid:1
ds_read_u16 v64, v64 offset:0
v_add_u32_sdwa v67, s42, v133 dst_sel:DWORD dst_unused:UNUSED_PAD src0_sel:DWORD src1_sel:WORD_1
v_smfmac_f32_16x16x64_bf16 v[40:43], a[140:143], v[52:59], v175 abid:1
s_waitcnt lgkmcnt(7)
ds_read_u16 v65, v65 offset:0
v_smfmac_f32_16x16x64_bf16 v[28:31], v[114:117], v[68:75], v183
buffer_load_dwordx4 a[244:247], v112, s[24:27], s99 offen offset:1024 sc1
ds_read_u16 v66, v66 offset:0
v_smfmac_f32_16x16x64_bf16 v[32:35], v[114:117], v[68:75], v183 abid:1
ds_read_u16 v67, v67 offset:0
v_smfmac_f32_16x16x64_bf16 v[36:39], v[114:117], v[68:75], v184
s_waitcnt lgkmcnt(8)
v_smfmac_f32_16x16x64_bf16 v[76:79], a[144:147], v[44:51], v154
buffer_load_dwordx4 a[248:251], v112, s[24:27], s99 offen offset:2048 sc1
ds_read_b128 v[52:55], v0 offset:26752
v_add_u32_sdwa v68, s42, v134 dst_sel:DWORD dst_unused:UNUSED_PAD src0_sel:DWORD src1_sel:WORD_0
v_smfmac_f32_16x16x64_bf16 v[80:83], a[148:151], v[44:51], v154 abid:1
s_waitcnt vmcnt(18)
ds_read_b128 v[56:59], v1 offset:26752
v_add_u32_sdwa v69, s42, v134 dst_sel:DWORD dst_unused:UNUSED_PAD src0_sel:DWORD src1_sel:WORD_1
v_smfmac_f32_16x16x64_bf16 v[84:87], a[152:155], v[44:51], v155
ds_read_u16 v68, v68 offset:18560
v_add_u32_sdwa v70, s42, v135 dst_sel:DWORD dst_unused:UNUSED_PAD src0_sel:DWORD src1_sel:WORD_0
v_smfmac_f32_16x16x64_bf16 v[88:91], a[156:159], v[44:51], v155 abid:1
s_mov_b32 s98, 7168
buffer_load_dwordx4 v[166:169], v113, s[24:27], s98 offen sc1
ds_read_u16 v69, v69 offset:18560
v_add_u32_sdwa v71, s42, v135 dst_sel:DWORD dst_unused:UNUSED_PAD src0_sel:DWORD src1_sel:WORD_1
v_smfmac_f32_16x16x64_bf16 v[92:95], a[160:163], v[44:51], v156
ds_read_u16 v70, v70 offset:18560
v_add_u32_sdwa v72, s42, v136 dst_sel:DWORD dst_unused:UNUSED_PAD src0_sel:DWORD src1_sel:WORD_0
v_smfmac_f32_16x16x64_bf16 v[96:99], a[164:167], v[44:51], v156 abid:1
ds_read_u16 v71, v71 offset:18560
v_add_u32_sdwa v73, s42, v136 dst_sel:DWORD dst_unused:UNUSED_PAD src0_sel:DWORD src1_sel:WORD_1
v_smfmac_f32_16x16x64_bf16 v[100:103], a[168:171], v[44:51], v157
s_mov_b32 s98, 8192
buffer_load_dwordx4 v[170:173], v113, s[24:27], s98 offen sc1
ds_read_u16 v72, v72 offset:18560
v_add_u32_sdwa v74, s42, v137 dst_sel:DWORD dst_unused:UNUSED_PAD src0_sel:DWORD src1_sel:WORD_0
v_smfmac_f32_16x16x64_bf16 v[104:107], a[172:175], v[44:51], v157 abid:1
ds_read_u16 v73, v73 offset:18560
v_add_u32_sdwa v75, s42, v137 dst_sel:DWORD dst_unused:UNUSED_PAD src0_sel:DWORD src1_sel:WORD_1
v_smfmac_f32_16x16x64_bf16 v[108:111], a[176:179], v[44:51], v176
s_waitcnt lgkmcnt(8)
ds_read_u16 v74, v74 offset:18560
v_smfmac_f32_16x16x64_bf16 v[96:99], v[114:117], v[60:67], v183
s_mov_b32 s99, 69632
buffer_load_dwordx4 v[214:217], v112, s[24:27], s99 offen offset:3072 sc1
ds_read_u16 v75, v75 offset:18560
v_smfmac_f32_16x16x64_bf16 v[100:103], v[114:117], v[60:67], v183 abid:1
v_smfmac_f32_16x16x64_bf16 v[104:107], v[114:117], v[60:67], v184
s_waitcnt lgkmcnt(8)
v_smfmac_f32_16x16x64_bf16 v[8:11], a[144:147], v[52:59], v154
s_mov_b32 s99, 81920
buffer_load_dwordx4 v[250:253], v112, s[24:27], s99 offen offset:0 sc1
ds_read_b128 v[114:117], v2 offset:320
v_add_u32_sdwa v60, s42, v134 dst_sel:DWORD dst_unused:UNUSED_PAD src0_sel:DWORD src1_sel:WORD_0
v_smfmac_f32_16x16x64_bf16 v[12:15], a[148:151], v[52:59], v154 abid:1
ds_read_b128 v[44:47], v0 offset:10240
v_add_u32_sdwa v61, s42, v134 dst_sel:DWORD dst_unused:UNUSED_PAD src0_sel:DWORD src1_sel:WORD_1
v_smfmac_f32_16x16x64_bf16 v[16:19], a[152:155], v[52:59], v155
ds_read_b128 v[48:51], v1 offset:10240
v_add_u32_sdwa v62, s42, v135 dst_sel:DWORD dst_unused:UNUSED_PAD src0_sel:DWORD src1_sel:WORD_0
v_smfmac_f32_16x16x64_bf16 v[20:23], a[156:159], v[52:59], v155 abid:1
s_mov_b32 s99, 61440
buffer_load_dwordx4 a[252:255], v112, s[24:27], s99 offen offset:3072 sc1
ds_read_u16 v60, v60 offset:0
v_add_u32_sdwa v63, s42, v135 dst_sel:DWORD dst_unused:UNUSED_PAD src0_sel:DWORD src1_sel:WORD_1
v_smfmac_f32_16x16x64_bf16 v[24:27], a[160:163], v[52:59], v156
ds_read_u16 v61, v61 offset:0
v_add_u32_sdwa v64, s42, v136 dst_sel:DWORD dst_unused:UNUSED_PAD src0_sel:DWORD src1_sel:WORD_0
v_smfmac_f32_16x16x64_bf16 v[28:31], a[164:167], v[52:59], v156 abid:1
ds_read_u16 v62, v62 offset:0
v_add_u32_sdwa v65, s42, v136 dst_sel:DWORD dst_unused:UNUSED_PAD src0_sel:DWORD src1_sel:WORD_1
v_smfmac_f32_16x16x64_bf16 v[32:35], a[168:171], v[52:59], v157
s_mov_b32 s99, 73728
buffer_load_dwordx4 v[218:221], v112, s[24:27], s99 offen offset:0 sc1
ds_read_u16 v63, v63 offset:0
v_add_u32_sdwa v66, s42, v137 dst_sel:DWORD dst_unused:UNUSED_PAD src0_sel:DWORD src1_sel:WORD_0
v_smfmac_f32_16x16x64_bf16 v[36:39], a[172:175], v[52:59], v157 abid:1
ds_read_u16 v64, v64 offset:0
v_add_u32_sdwa v67, s42, v137 dst_sel:DWORD dst_unused:UNUSED_PAD src0_sel:DWORD src1_sel:WORD_1
v_smfmac_f32_16x16x64_bf16 v[40:43], a[176:179], v[52:59], v176
s_waitcnt lgkmcnt(7)
ds_read_u16 v65, v65 offset:0
v_smfmac_f32_16x16x64_bf16 v[36:39], v[114:117], v[68:75], v184 abid:1
s_mov_b32 s99, 65536
buffer_load_dwordx4 v[186:189], v112, s[24:27], s99 offen offset:0 sc1
ds_read_u16 v66, v66 offset:0
v_smfmac_f32_16x16x64_bf16 v[40:43], v[114:117], v[68:75], v185
s_waitcnt lgkmcnt(7)
ds_read_u16 v67, v67 offset:0
v_smfmac_f32_16x16x64_bf16 v[76:79], a[180:183], v[44:51], v158
s_waitcnt vmcnt(18)
ds_read_b128 v[52:55], v0 offset:28800
v_smfmac_f32_16x16x64_bf16 v[80:83], a[184:187], v[44:51], v158 abid:1
s_mov_b32 s99, 73728
buffer_load_dwordx4 v[222:225], v112, s[24:27], s99 offen offset:1024 sc1
ds_read_b128 v[56:59], v1 offset:28800
v_smfmac_f32_16x16x64_bf16 v[84:87], a[188:191], v[44:51], v159
ds_read_b128 v[68:71], v0 offset:34944
v_smfmac_f32_16x16x64_bf16 v[88:91], a[192:195], v[44:51], v159 abid:1
ds_read_b128 v[72:75], v1 offset:34944
v_smfmac_f32_16x16x64_bf16 v[92:95], a[196:199], v[44:51], v160
s_mov_b32 s99, 65536
buffer_load_dwordx4 v[190:193], v112, s[24:27], s99 offen offset:1024 sc1
v_smfmac_f32_16x16x64_bf16 v[96:99], a[200:203], v[44:51], v160 abid:1
v_smfmac_f32_16x16x64_bf16 v[100:103], a[204:207], v[44:51], v161
v_smfmac_f32_16x16x64_bf16 v[104:107], a[208:211], v[44:51], v161 abid:1
s_waitcnt vmcnt(18)
s_mov_b32 s99, 73728
buffer_load_dwordx4 v[226:229], v112, s[24:27], s99 offen offset:2048 sc1
v_smfmac_f32_16x16x64_bf16 v[108:111], a[212:215], v[44:51], v176 abid:1
s_waitcnt lgkmcnt(4)
v_smfmac_f32_16x16x64_bf16 v[104:107], v[114:117], v[60:67], v184 abid:1
v_smfmac_f32_16x16x64_bf16 v[108:111], v[114:117], v[60:67], v185
s_waitcnt lgkmcnt(2)
s_mov_b32 s99, 65536
buffer_load_dwordx4 v[194:197], v112, s[24:27], s99 offen offset:2048 sc1
v_smfmac_f32_16x16x64_bf16 v[8:11], a[180:183], v[52:59], v158
ds_read_b128 v[44:47], v0 offset:12288
v_smfmac_f32_16x16x64_bf16 v[12:15], a[184:187], v[52:59], v158 abid:1
ds_read_b128 v[48:51], v1 offset:12288
v_smfmac_f32_16x16x64_bf16 v[16:19], a[188:191], v[52:59], v159
s_mov_b32 s99, 73728
buffer_load_dwordx4 v[230:233], v112, s[24:27], s99 offen offset:3072 sc1
ds_read_b128 v[60:63], v0 offset:32896
v_smfmac_f32_16x16x64_bf16 v[20:23], a[192:195], v[52:59], v159 abid:1
ds_read_b128 v[64:67], v1 offset:32896
v_smfmac_f32_16x16x64_bf16 v[24:27], a[196:199], v[52:59], v160
v_smfmac_f32_16x16x64_bf16 v[28:31], a[200:203], v[52:59], v160 abid:1
s_mov_b32 s99, 65536
buffer_load_dwordx4 v[198:201], v112, s[24:27], s99 offen offset:3072 sc1
v_smfmac_f32_16x16x64_bf16 v[32:35], a[204:207], v[52:59], v161
v_smfmac_f32_16x16x64_bf16 v[36:39], a[208:211], v[52:59], v161 abid:1
v_smfmac_f32_16x16x64_bf16 v[40:43], a[212:215], v[52:59], v176 abid:1
s_waitcnt vmcnt(18) lgkmcnt(2)
s_mov_b32 s99, 77824
buffer_load_dwordx4 v[234:237], v112, s[24:27], s99 offen offset:0 sc1
v_smfmac_f32_16x16x64_bf16 v[76:79], a[216:219], v[44:51], v162
ds_read_b128 v[52:55], v0 offset:30848
v_smfmac_f32_16x16x64_bf16 v[80:83], a[220:223], v[44:51], v162 abid:1
ds_read_b128 v[56:59], v1 offset:30848
v_smfmac_f32_16x16x64_bf16 v[84:87], a[224:227], v[44:51], v163
s_mov_b32 s99, 69632
buffer_load_dwordx4 v[202:205], v112, s[24:27], s99 offen offset:0 sc1
v_smfmac_f32_16x16x64_bf16 v[88:91], a[228:231], v[44:51], v163 abid:1
s_waitcnt vmcnt(18)
v_smfmac_f32_16x16x64_bf16 v[92:95], a[232:235], v[44:51], v164
v_smfmac_f32_16x16x64_bf16 v[96:99], a[236:239], v[44:51], v164 abid:1
s_waitcnt vmcnt(17)
s_mov_b32 s99, 77824
buffer_load_dwordx4 v[238:241], v112, s[24:27], s99 offen offset:1024 sc1
v_smfmac_f32_16x16x64_bf16 v[100:103], a[240:243], v[44:51], v165
s_waitcnt vmcnt(17)
v_smfmac_f32_16x16x64_bf16 v[104:107], a[244:247], v[44:51], v165 abid:1
s_waitcnt vmcnt(16)
v_smfmac_f32_16x16x64_bf16 v[108:111], a[248:251], v[44:51], v177
s_waitcnt lgkmcnt(0)
s_mov_b32 s99, 69632
buffer_load_dwordx4 v[206:209], v112, s[24:27], s99 offen offset:1024 sc1
v_smfmac_f32_16x16x64_bf16 v[8:11], a[216:219], v[52:59], v162
ds_read_b128 v[44:47], v0 offset:14336
v_smfmac_f32_16x16x64_bf16 v[12:15], a[220:223], v[52:59], v162 abid:1
ds_read_b128 v[48:51], v1 offset:14336
v_smfmac_f32_16x16x64_bf16 v[16:19], a[224:227], v[52:59], v163
s_mov_b32 s99, 77824
buffer_load_dwordx4 v[242:245], v112, s[24:27], s99 offen offset:2048 sc1
v_smfmac_f32_16x16x64_bf16 v[20:23], a[228:231], v[52:59], v163 abid:1
v_smfmac_f32_16x16x64_bf16 v[24:27], a[232:235], v[52:59], v164
v_smfmac_f32_16x16x64_bf16 v[28:31], a[236:239], v[52:59], v164 abid:1
s_mov_b32 s99, 69632
buffer_load_dwordx4 v[210:213], v112, s[24:27], s99 offen offset:2048 sc1
v_smfmac_f32_16x16x64_bf16 v[32:35], a[240:243], v[52:59], v165
v_smfmac_f32_16x16x64_bf16 v[36:39], a[244:247], v[52:59], v165 abid:1
v_smfmac_f32_16x16x64_bf16 v[40:43], a[248:251], v[52:59], v177
s_mov_b32 s99, 77824
buffer_load_dwordx4 v[246:249], v112, s[24:27], s99 offen offset:3072 sc1
s_bfe_u32 s47, s85, 0x40018
s_cbranch_scc0 L_ptail0
ds_read_b128 v[52:55], v0 offset:16384
ds_read_b128 v[56:59], v1 offset:16384
s_waitcnt vmcnt(17) lgkmcnt(2)
v_smfmac_f32_16x16x64_bf16 v[108:111], v[214:217], v[44:51], v177 abid:1
s_add_u32 m0, s44, 0
s_nop 0
buffer_load_dwordx4 v3, s[16:19], s45 offen offset:0 nt lds
s_waitcnt vmcnt(17) lgkmcnt(0)
v_smfmac_f32_16x16x64_bf16 v[108:111], v[250:253], v[52:59], v178
s_add_u32 m0, s44, 3840
s_nop 0
buffer_load_dwordx4 v3, s[16:19], s45 offen offset:256 nt lds
v_add_u32 v0, 37120, v0
v_add_u32 v1, 37120, v1
s_waitcnt vmcnt(17)
v_smfmac_f32_16x16x64_bf16 v[76:79], a[252:255], v[44:51], v166
s_add_u32 m0, s44, 7680
s_nop 0
buffer_load_dwordx4 v3, s[16:19], s45 offen offset:512 nt lds
s_waitcnt vmcnt(17)
v_smfmac_f32_16x16x64_bf16 v[76:79], v[218:221], v[52:59], v170
v_cvt_pk_bf16_f32 v108, v108, v109
v_cvt_pk_bf16_f32 v109, v110, v111
ds_bpermute_b32 v108, v6, v108
ds_bpermute_b32 v109, v6, v109
s_waitcnt vmcnt(16)
v_smfmac_f32_16x16x64_bf16 v[80:83], v[186:189], v[44:51], v166 abid:1
s_add_u32 m0, s44, 11520
s_nop 0
buffer_load_dwordx4 v3, s[16:19], s45 offen offset:768 nt lds
s_waitcnt vmcnt(16)
v_smfmac_f32_16x16x64_bf16 v[80:83], v[222:225], v[52:59], v170 abid:1
s_add_u32 m0, s44, s8
s_mov_b64 exec, s[10:11]
buffer_load_dwordx4 v3, s[16:19], s7 offen offset:896 nt lds
s_mov_b64 exec, -1
s_add_u32 s7, s7, 4718592
s_add_u32 s44, s44, 18560
s_add_u32 s45, s45, 4718592
v_cvt_pk_bf16_f32 v76, v76, v77
v_cvt_pk_bf16_f32 v77, v78, v79
s_waitcnt vmcnt(16)
v_smfmac_f32_16x16x64_bf16 v[84:87], v[190:193], v[44:51], v167
s_waitcnt vmcnt(15)
v_smfmac_f32_16x16x64_bf16 v[84:87], v[226:229], v[52:59], v171
s_add_u32 m0, s44, 0
s_nop 0
buffer_load_dwordx4 v3, s[16:19], s45 offen offset:0 nt lds
v_cvt_pk_bf16_f32 v78, v80, v81
v_cvt_pk_bf16_f32 v79, v82, v83
s_waitcnt lgkmcnt(0)
buffer_store_dwordx2 v[108:109], v5, s[20:23], s46 offen
s_waitcnt vmcnt(16)
v_smfmac_f32_16x16x64_bf16 v[88:91], v[194:197], v[44:51], v167 abid:1
s_add_u32 m0, s44, 3840
s_nop 0
buffer_load_dwordx4 v3, s[16:19], s45 offen offset:256 nt lds
s_waitcnt vmcnt(16)
v_smfmac_f32_16x16x64_bf16 v[88:91], v[230:233], v[52:59], v171 abid:1
s_add_u32 m0, s44, 7680
s_nop 0
buffer_load_dwordx4 v3, s[16:19], s45 offen offset:512 nt lds
v_cvt_pk_bf16_f32 v80, v84, v85
v_cvt_pk_bf16_f32 v81, v86, v87
s_waitcnt vmcnt(16)
v_smfmac_f32_16x16x64_bf16 v[92:95], v[198:201], v[44:51], v168
s_waitcnt vmcnt(15)
v_smfmac_f32_16x16x64_bf16 v[92:95], v[234:237], v[52:59], v172
s_add_u32 m0, s44, 11520
s_nop 0
buffer_load_dwordx4 v3, s[16:19], s45 offen offset:768 nt lds
v_cvt_pk_bf16_f32 v82, v88, v89
v_cvt_pk_bf16_f32 v83, v90, v91
v_cndmask_b32_dpp v114, v80, v76, vcc quad_perm:[1,0,3,2] row_mask:0xf bank_mask:0xf
v_cndmask_b32_dpp v115, v81, v77, vcc quad_perm:[1,0,3,2] row_mask:0xf bank_mask:0xf
v_cndmask_b32_dpp v116, v82, v78, vcc quad_perm:[1,0,3,2] row_mask:0xf bank_mask:0xf
v_cndmask_b32_dpp v117, v83, v79, vcc quad_perm:[1,0,3,2] row_mask:0xf bank_mask:0xf
buffer_store_dwordx4 v[114:117], v4, s[20:23], s46 offen offset:0 sc1
s_mov_b64 vcc, s[82:83]
s_waitcnt vmcnt(16)
v_smfmac_f32_16x16x64_bf16 v[96:99], v[202:205], v[44:51], v168 abid:1
s_add_u32 m0, s44, s8
s_mov_b64 exec, s[10:11]
buffer_load_dwordx4 v3, s[16:19], s7 offen offset:896 nt lds
s_mov_b64 exec, -1
s_add_u32 s7, s7, 4718592
s_add_u32 s44, s44, 18560
s_add_u32 s45, s45, 4718592
s_waitcnt vmcnt(16)
v_smfmac_f32_16x16x64_bf16 v[96:99], v[238:241], v[52:59], v172 abid:1
v_cvt_pk_bf16_f32 v84, v92, v93
v_cvt_pk_bf16_f32 v85, v94, v95
v_cndmask_b32_dpp v80, v76, v80, vcc quad_perm:[1,0,3,2] row_mask:0xf bank_mask:0xf
v_cndmask_b32_dpp v81, v77, v81, vcc quad_perm:[1,0,3,2] row_mask:0xf bank_mask:0xf
v_cndmask_b32_dpp v82, v78, v82, vcc quad_perm:[1,0,3,2] row_mask:0xf bank_mask:0xf
v_cndmask_b32_dpp v83, v79, v83, vcc quad_perm:[1,0,3,2] row_mask:0xf bank_mask:0xf
buffer_store_dwordx4 v[80:83], v4, s[20:23], s46 offen offset:1152 sc1
s_mov_b64 vcc, s[80:81]
s_waitcnt vmcnt(16)
v_smfmac_f32_16x16x64_bf16 v[100:103], v[206:209], v[44:51], v169
s_waitcnt vmcnt(15)
v_smfmac_f32_16x16x64_bf16 v[100:103], v[242:245], v[52:59], v173
v_cvt_pk_bf16_f32 v86, v96, v97
v_cvt_pk_bf16_f32 v87, v98, v99
v_add_u32_sdwa v76, s4, v118 dst_sel:DWORD dst_unused:UNUSED_PAD src0_sel:DWORD src1_sel:WORD_0
v_add_u32_sdwa v77, s4, v118 dst_sel:DWORD dst_unused:UNUSED_PAD src0_sel:DWORD src1_sel:WORD_1
v_add_u32_sdwa v78, s4, v119 dst_sel:DWORD dst_unused:UNUSED_PAD src0_sel:DWORD src1_sel:WORD_0
v_add_u32_sdwa v79, s4, v119 dst_sel:DWORD dst_unused:UNUSED_PAD src0_sel:DWORD src1_sel:WORD_1
s_waitcnt vmcnt(14)
v_smfmac_f32_16x16x64_bf16 v[104:107], v[210:213], v[44:51], v169 abid:1
s_waitcnt vmcnt(13)
v_smfmac_f32_16x16x64_bf16 v[104:107], v[246:249], v[52:59], v173 abid:1
v_cvt_pk_bf16_f32 v88, v100, v101
v_cvt_pk_bf16_f32 v89, v102, v103
v_add_u32_sdwa v80, s4, v120 dst_sel:DWORD dst_unused:UNUSED_PAD src0_sel:DWORD src1_sel:WORD_0
v_add_u32_sdwa v81, s4, v120 dst_sel:DWORD dst_unused:UNUSED_PAD src0_sel:DWORD src1_sel:WORD_1
v_add_u32_sdwa v82, s4, v121 dst_sel:DWORD dst_unused:UNUSED_PAD src0_sel:DWORD src1_sel:WORD_0
v_add_u32_sdwa v83, s4, v121 dst_sel:DWORD dst_unused:UNUSED_PAD src0_sel:DWORD src1_sel:WORD_1
s_nop 1
v_cvt_pk_bf16_f32 v90, v104, v105
v_cvt_pk_bf16_f32 v91, v106, v107
v_cndmask_b32_dpp v92, v88, v84, vcc quad_perm:[1,0,3,2] row_mask:0xf bank_mask:0xf
v_cndmask_b32_dpp v93, v89, v85, vcc quad_perm:[1,0,3,2] row_mask:0xf bank_mask:0xf
v_cndmask_b32_dpp v94, v90, v86, vcc quad_perm:[1,0,3,2] row_mask:0xf bank_mask:0xf
v_cndmask_b32_dpp v95, v91, v87, vcc quad_perm:[1,0,3,2] row_mask:0xf bank_mask:0xf
buffer_store_dwordx4 v[92:95], v4, s[20:23], s46 offen offset:128 sc1
s_mov_b64 vcc, s[82:83]
v_cndmask_b32_dpp v88, v84, v88, vcc quad_perm:[1,0,3,2] row_mask:0xf bank_mask:0xf
v_cndmask_b32_dpp v89, v85, v89, vcc quad_perm:[1,0,3,2] row_mask:0xf bank_mask:0xf
v_cndmask_b32_dpp v90, v86, v90, vcc quad_perm:[1,0,3,2] row_mask:0xf bank_mask:0xf
v_cndmask_b32_dpp v91, v87, v91, vcc quad_perm:[1,0,3,2] row_mask:0xf bank_mask:0xf
buffer_store_dwordx4 v[88:91], v4, s[20:23], s46 offen offset:1280 sc1
s_mov_b64 vcc, s[80:81]
s_branch L_ptail1
L_ptail0:
ds_read_b128 v[52:55], v0 offset:16384
ds_read_b128 v[56:59], v1 offset:16384
s_waitcnt vmcnt(17) lgkmcnt(2)
v_smfmac_f32_16x16x64_bf16 v[108:111], v[214:217], v[44:51], v177 abid:1
s_waitcnt vmcnt(16) lgkmcnt(0)
v_smfmac_f32_16x16x64_bf16 v[108:111], v[250:253], v[52:59], v178
v_add_u32 v0, 37120, v0
v_add_u32 v1, 37120, v1
s_waitcnt vmcnt(15)
v_smfmac_f32_16x16x64_bf16 v[76:79], a[252:255], v[44:51], v166
s_waitcnt vmcnt(14)
v_smfmac_f32_16x16x64_bf16 v[76:79], v[218:221], v[52:59], v170
s_nop 1
v_cvt_pk_bf16_f32 v108, v108, v109
v_cvt_pk_bf16_f32 v109, v110, v111
ds_bpermute_b32 v108, v6, v108
ds_bpermute_b32 v109, v6, v109
s_waitcnt vmcnt(13)
v_smfmac_f32_16x16x64_bf16 v[80:83], v[186:189], v[44:51], v166 abid:1
s_waitcnt vmcnt(12)
v_smfmac_f32_16x16x64_bf16 v[80:83], v[222:225], v[52:59], v170 abid:1
v_cvt_pk_bf16_f32 v76, v76, v77
v_cvt_pk_bf16_f32 v77, v78, v79
s_waitcnt vmcnt(11)
v_smfmac_f32_16x16x64_bf16 v[84:87], v[190:193], v[44:51], v167
s_waitcnt vmcnt(10)
v_smfmac_f32_16x16x64_bf16 v[84:87], v[226:229], v[52:59], v171
s_nop 1
v_cvt_pk_bf16_f32 v78, v80, v81
v_cvt_pk_bf16_f32 v79, v82, v83
s_waitcnt lgkmcnt(0)
buffer_store_dwordx2 v[108:109], v5, s[20:23], s46 offen
s_waitcnt vmcnt(10)
v_smfmac_f32_16x16x64_bf16 v[88:91], v[194:197], v[44:51], v167 abid:1
s_waitcnt vmcnt(9)
v_smfmac_f32_16x16x64_bf16 v[88:91], v[230:233], v[52:59], v171 abid:1
v_cvt_pk_bf16_f32 v80, v84, v85
v_cvt_pk_bf16_f32 v81, v86, v87
s_waitcnt vmcnt(8)
v_smfmac_f32_16x16x64_bf16 v[92:95], v[198:201], v[44:51], v168
s_waitcnt vmcnt(7)
v_smfmac_f32_16x16x64_bf16 v[92:95], v[234:237], v[52:59], v172
s_nop 1
v_cvt_pk_bf16_f32 v82, v88, v89
v_cvt_pk_bf16_f32 v83, v90, v91
v_cndmask_b32_dpp v114, v80, v76, vcc quad_perm:[1,0,3,2] row_mask:0xf bank_mask:0xf
v_cndmask_b32_dpp v115, v81, v77, vcc quad_perm:[1,0,3,2] row_mask:0xf bank_mask:0xf
v_cndmask_b32_dpp v116, v82, v78, vcc quad_perm:[1,0,3,2] row_mask:0xf bank_mask:0xf
v_cndmask_b32_dpp v117, v83, v79, vcc quad_perm:[1,0,3,2] row_mask:0xf bank_mask:0xf
buffer_store_dwordx4 v[114:117], v4, s[20:23], s46 offen offset:0 sc1
s_mov_b64 vcc, s[82:83]
s_waitcnt vmcnt(7)
v_smfmac_f32_16x16x64_bf16 v[96:99], v[202:205], v[44:51], v168 abid:1
s_waitcnt vmcnt(6)
v_smfmac_f32_16x16x64_bf16 v[96:99], v[238:241], v[52:59], v172 abid:1
v_cvt_pk_bf16_f32 v84, v92, v93
v_cvt_pk_bf16_f32 v85, v94, v95
v_cndmask_b32_dpp v80, v76, v80, vcc quad_perm:[1,0,3,2] row_mask:0xf bank_mask:0xf
v_cndmask_b32_dpp v81, v77, v81, vcc quad_perm:[1,0,3,2] row_mask:0xf bank_mask:0xf
v_cndmask_b32_dpp v82, v78, v82, vcc quad_perm:[1,0,3,2] row_mask:0xf bank_mask:0xf
v_cndmask_b32_dpp v83, v79, v83, vcc quad_perm:[1,0,3,2] row_mask:0xf bank_mask:0xf
buffer_store_dwordx4 v[80:83], v4, s[20:23], s46 offen offset:1152 sc1
s_mov_b64 vcc, s[80:81]
s_waitcnt vmcnt(6)
v_smfmac_f32_16x16x64_bf16 v[100:103], v[206:209], v[44:51], v169
s_waitcnt vmcnt(5)
v_smfmac_f32_16x16x64_bf16 v[100:103], v[242:245], v[52:59], v173
v_cvt_pk_bf16_f32 v86, v96, v97
v_cvt_pk_bf16_f32 v87, v98, v99
v_add_u32_sdwa v76, s4, v118 dst_sel:DWORD dst_unused:UNUSED_PAD src0_sel:DWORD src1_sel:WORD_0
v_add_u32_sdwa v77, s4, v118 dst_sel:DWORD dst_unused:UNUSED_PAD src0_sel:DWORD src1_sel:WORD_1
v_add_u32_sdwa v78, s4, v119 dst_sel:DWORD dst_unused:UNUSED_PAD src0_sel:DWORD src1_sel:WORD_0
v_add_u32_sdwa v79, s4, v119 dst_sel:DWORD dst_unused:UNUSED_PAD src0_sel:DWORD src1_sel:WORD_1
s_waitcnt vmcnt(4)
v_smfmac_f32_16x16x64_bf16 v[104:107], v[210:213], v[44:51], v169 abid:1
s_waitcnt vmcnt(3)
v_smfmac_f32_16x16x64_bf16 v[104:107], v[246:249], v[52:59], v173 abid:1
v_cvt_pk_bf16_f32 v88, v100, v101
v_cvt_pk_bf16_f32 v89, v102, v103
v_add_u32_sdwa v80, s4, v120 dst_sel:DWORD dst_unused:UNUSED_PAD src0_sel:DWORD src1_sel:WORD_0
v_add_u32_sdwa v81, s4, v120 dst_sel:DWORD dst_unused:UNUSED_PAD src0_sel:DWORD src1_sel:WORD_1
v_add_u32_sdwa v82, s4, v121 dst_sel:DWORD dst_unused:UNUSED_PAD src0_sel:DWORD src1_sel:WORD_0
v_add_u32_sdwa v83, s4, v121 dst_sel:DWORD dst_unused:UNUSED_PAD src0_sel:DWORD src1_sel:WORD_1
s_nop 1
v_cvt_pk_bf16_f32 v90, v104, v105
v_cvt_pk_bf16_f32 v91, v106, v107
v_cndmask_b32_dpp v92, v88, v84, vcc quad_perm:[1,0,3,2] row_mask:0xf bank_mask:0xf
v_cndmask_b32_dpp v93, v89, v85, vcc quad_perm:[1,0,3,2] row_mask:0xf bank_mask:0xf
v_cndmask_b32_dpp v94, v90, v86, vcc quad_perm:[1,0,3,2] row_mask:0xf bank_mask:0xf
v_cndmask_b32_dpp v95, v91, v87, vcc quad_perm:[1,0,3,2] row_mask:0xf bank_mask:0xf
buffer_store_dwordx4 v[92:95], v4, s[20:23], s46 offen offset:128 sc1
s_mov_b64 vcc, s[82:83]
v_cndmask_b32_dpp v88, v84, v88, vcc quad_perm:[1,0,3,2] row_mask:0xf bank_mask:0xf
v_cndmask_b32_dpp v89, v85, v89, vcc quad_perm:[1,0,3,2] row_mask:0xf bank_mask:0xf
v_cndmask_b32_dpp v90, v86, v90, vcc quad_perm:[1,0,3,2] row_mask:0xf bank_mask:0xf
v_cndmask_b32_dpp v91, v87, v91, vcc quad_perm:[1,0,3,2] row_mask:0xf bank_mask:0xf
buffer_store_dwordx4 v[88:91], v4, s[20:23], s46 offen offset:1280 sc1
s_mov_b64 vcc, s[80:81]
L_ptail1:
s_cmp_ge_u32 s44, 148480
s_cselect_b32 s44, s9, s44
s_add_u32 s46, s46, 4718592
s_waitcnt lgkmcnt(0)
s_barrier
s_cmp_lg_u32 s89, 0
s_cbranch_scc1 L_loopnk_p3
s_branch L_loopn_p3
.p2align 6
L_loop:
v_smfmac_f32_16x16x64_bf16 v[8:11], a[0:3], v[44:51], v138
ds_read_b128 v[32:35], v2 offset:1408
v_cvt_pk_bf16_f32 v106, v36, v37
v_smfmac_f32_16x16x64_bf16 v[8:11], a[36:39], v[52:59], v142
s_waitcnt lgkmcnt(9)
v_cvt_pk_bf16_f32 v107, v38, v39
v_smfmac_f32_16x16x64_bf16 v[12:15], a[4:7], v[44:51], v138 abid:1
ds_read_b128 v[36:39], v2 offset:1472
v_cvt_pk_bf16_f32 v112, v40, v41
v_smfmac_f32_16x16x64_bf16 v[12:15], a[40:43], v[52:59], v142 abid:1
s_waitcnt lgkmcnt(8)
ds_read_b128 v[60:63], v0 offset:4096
v_cvt_pk_bf16_f32 v113, v42, v43
v_smfmac_f32_16x16x64_bf16 v[16:19], a[8:11], v[44:51], v139
s_cmp_eq_u32 s4, 129920
ds_read_b128 v[40:43], v2 offset:1536
v_cndmask_b32_dpp v108, v96, v92, vcc quad_perm:[1,0,3,2] row_mask:0xf bank_mask:0xf
v_smfmac_f32_16x16x64_bf16 v[16:19], a[44:47], v[52:59], v143
s_waitcnt lgkmcnt(8)
ds_read_u16 v82, v82
v_cndmask_b32_dpp v109, v97, v93, vcc quad_perm:[1,0,3,2] row_mask:0xf bank_mask:0xf
v_smfmac_f32_16x16x64_bf16 v[20:23], a[12:15], v[44:51], v139 abid:1
s_cselect_b32 s43, -129920, s5
ds_read_u16 v84, v84
v_cndmask_b32_dpp v110, v98, v94, vcc quad_perm:[1,0,3,2] row_mask:0xf bank_mask:0xf
v_smfmac_f32_16x16x64_bf16 v[20:23], a[48:51], v[52:59], v143 abid:1
s_waitcnt lgkmcnt(8)
ds_read_b128 v[64:67], v1 offset:4096
v_cndmask_b32_dpp v111, v99, v95, vcc quad_perm:[1,0,3,2] row_mask:0xf bank_mask:0xf
v_smfmac_f32_16x16x64_bf16 v[24:27], a[16:19], v[44:51], v140
s_add_u32 s4, s4, s43
ds_read_b128 v[68:71], v0 offset:6144
v_add_u32_sdwa v87, s42, v123 dst_sel:DWORD dst_unused:UNUSED_PAD src0_sel:DWORD src1_sel:WORD_1
v_smfmac_f32_16x16x64_bf16 v[24:27], a[52:55], v[52:59], v144
buffer_store_dwordx4 v[108:111], v4, s[20:23], s46 offen offset:0 sc1
s_mov_b64 vcc, s[82:83]
s_waitcnt lgkmcnt(8)
ds_read_b128 v[72:75], v1 offset:6144
v_cndmask_b32_dpp v96, v92, v96, vcc quad_perm:[1,0,3,2] row_mask:0xf bank_mask:0xf
v_cndmask_b32_dpp v97, v93, v97, vcc quad_perm:[1,0,3,2] row_mask:0xf bank_mask:0xf
v_smfmac_f32_16x16x64_bf16 v[28:31], a[20:23], v[44:51], v140 abid:1
s_add_u32 s41, s41, 1
ds_read_u16 v83, v83
v_cndmask_b32_dpp v98, v94, v98, vcc quad_perm:[1,0,3,2] row_mask:0xf bank_mask:0xf
v_smfmac_f32_16x16x64_bf16 v[28:31], a[56:59], v[52:59], v144 abid:1
s_waitcnt lgkmcnt(9)
ds_read_b128 v[114:117], v2 offset:64
v_cndmask_b32_dpp v99, v95, v99, vcc quad_perm:[1,0,3,2] row_mask:0xf bank_mask:0xf
v_smfmac_f32_16x16x64_bf16 v[32:35], a[24:27], v[44:51], v141
ds_read_u16 v85, v85
v_add_u32_sdwa v88, s42, v124 dst_sel:DWORD dst_unused:UNUSED_PAD src0_sel:DWORD src1_sel:WORD_0
v_smfmac_f32_16x16x64_bf16 v[32:35], a[60:63], v[52:59], v145
s_waitcnt lgkmcnt(10)
ds_read_u16 v86, v86
v_add_u32_sdwa v89, s42, v124 dst_sel:DWORD dst_unused:UNUSED_PAD src0_sel:DWORD src1_sel:WORD_1
v_smfmac_f32_16x16x64_bf16 v[36:39], a[28:31], v[44:51], v141 abid:1
ds_read_u16 v87, v87
v_add_u32_sdwa v90, s42, v125 dst_sel:DWORD dst_unused:UNUSED_PAD src0_sel:DWORD src1_sel:WORD_0
v_smfmac_f32_16x16x64_bf16 v[36:39], a[64:67], v[52:59], v145 abid:1
s_waitcnt lgkmcnt(10)
ds_read_u16 v88, v88
v_add_u32_sdwa v91, s42, v125 dst_sel:DWORD dst_unused:UNUSED_PAD src0_sel:DWORD src1_sel:WORD_1
v_smfmac_f32_16x16x64_bf16 v[40:43], a[32:35], v[44:51], v174
buffer_store_dwordx4 v[96:99], v4, s[20:23], s46 offen offset:1152 sc1
s_mov_b64 vcc, s[80:81]
ds_read_u16 v89, v89
v_cndmask_b32_dpp v92, v104, v100, vcc quad_perm:[1,0,3,2] row_mask:0xf bank_mask:0xf
v_cndmask_b32_dpp v93, v105, v101, vcc quad_perm:[1,0,3,2] row_mask:0xf bank_mask:0xf
v_smfmac_f32_16x16x64_bf16 v[40:43], a[68:71], v[52:59], v174 abid:1
s_waitcnt lgkmcnt(9)
ds_read_u16 v90, v90
v_cndmask_b32_dpp v94, v106, v102, vcc quad_perm:[1,0,3,2] row_mask:0xf bank_mask:0xf
v_smfmac_f32_16x16x64_bf16 v[8:11], a[72:75], v[60:67], v146
s_waitcnt lgkmcnt(8)
ds_read_u16 v91, v91
v_cndmask_b32_dpp v95, v107, v103, vcc quad_perm:[1,0,3,2] row_mask:0xf bank_mask:0xf
v_smfmac_f32_16x16x64_bf16 v[8:11], a[108:111], v[68:75], v150
s_waitcnt lgkmcnt(7)
ds_bpermute_b32 v112, v6, v112
v_smfmac_f32_16x16x64_bf16 v[8:11], v[114:117], v[76:83], v179
s_waitcnt vmcnt(2)
ds_bpermute_b32 v113, v6, v113
v_smfmac_f32_16x16x64_bf16 v[12:15], v[114:117], v[76:83], v179 abid:1
ds_read_b128 v[114:117], v2 offset:128
v_add_u32_sdwa v76, s42, v126 dst_sel:DWORD dst_unused:UNUSED_PAD src0_sel:DWORD src1_sel:WORD_0
v_smfmac_f32_16x16x64_bf16 v[12:15], a[76:79], v[60:67], v146 abid:1
ds_read_u16 v76, v76
v_add_u32_sdwa v77, s42, v126 dst_sel:DWORD dst_unused:UNUSED_PAD src0_sel:DWORD src1_sel:WORD_1
v_smfmac_f32_16x16x64_bf16 v[12:15], a[112:115], v[68:75], v150 abid:1
buffer_store_dwordx4 v[92:95], v4, s[20:23], s46 offen offset:128 sc1
s_mov_b64 vcc, s[82:83]
ds_read_u16 v77, v77
v_cndmask_b32_dpp v104, v100, v104, vcc quad_perm:[1,0,3,2] row_mask:0xf bank_mask:0xf
v_add_u32_sdwa v78, s42, v127 dst_sel:DWORD dst_unused:UNUSED_PAD src0_sel:DWORD src1_sel:WORD_0
v_smfmac_f32_16x16x64_bf16 v[24:27], a[88:91], v[60:67], v148
ds_read_u16 v78, v78
v_cndmask_b32_dpp v105, v101, v105, vcc quad_perm:[1,0,3,2] row_mask:0xf bank_mask:0xf
v_smfmac_f32_16x16x64_bf16 v[24:27], a[124:127], v[68:75], v152
ds_read_b128 v[44:47], v0 offset:8192
v_cndmask_b32_dpp v106, v102, v106, vcc quad_perm:[1,0,3,2] row_mask:0xf bank_mask:0xf
v_smfmac_f32_16x16x64_bf16 v[28:31], a[92:95], v[60:67], v148 abid:1
ds_read_b128 v[48:51], v1 offset:8192
v_add_u32_sdwa v79, s42, v127 dst_sel:DWORD dst_unused:UNUSED_PAD src0_sel:DWORD src1_sel:WORD_1
v_smfmac_f32_16x16x64_bf16 v[28:31], a[128:131], v[68:75], v152 abid:1
ds_read_u16 v79, v79
v_cndmask_b32_dpp v107, v103, v107, vcc quad_perm:[1,0,3,2] row_mask:0xf bank_mask:0xf
v_smfmac_f32_16x16x64_bf16 v[32:35], a[96:99], v[60:67], v149
ds_read_b128 v[52:55], v0 offset:10240
v_add_u32_sdwa v80, s42, v128 dst_sel:DWORD dst_unused:UNUSED_PAD src0_sel:DWORD src1_sel:WORD_0
v_smfmac_f32_16x16x64_bf16 v[32:35], a[132:135], v[68:75], v153
ds_read_u16 v80, v80
v_add_u32_sdwa v81, s42, v128 dst_sel:DWORD dst_unused:UNUSED_PAD src0_sel:DWORD src1_sel:WORD_1
v_smfmac_f32_16x16x64_bf16 v[16:19], a[80:83], v[60:67], v147
buffer_store_dwordx4 v[104:107], v4, s[20:23], s46 offen offset:1280 sc1
s_mov_b64 vcc, s[80:81]
ds_read_b128 v[56:59], v1 offset:10240
v_add_u32_sdwa v82, s42, v129 dst_sel:DWORD dst_unused:UNUSED_PAD src0_sel:DWORD src1_sel:WORD_0
v_add_u32_sdwa v83, s42, v129 dst_sel:DWORD dst_unused:UNUSED_PAD src0_sel:DWORD src1_sel:WORD_1
v_smfmac_f32_16x16x64_bf16 v[16:19], a[116:119], v[68:75], v151
s_waitcnt lgkmcnt(9)
ds_read_b128 v[92:95], v0 offset:12288
v_add_u32_sdwa v100, s42, v130 dst_sel:DWORD dst_unused:UNUSED_PAD src0_sel:DWORD src1_sel:WORD_0
v_smfmac_f32_16x16x64_bf16 v[16:19], v[114:117], v[84:91], v180 abid:1
ds_read_u16 v81, v81
v_add_u32_sdwa v101, s42, v130 dst_sel:DWORD dst_unused:UNUSED_PAD src0_sel:DWORD src1_sel:WORD_1
v_smfmac_f32_16x16x64_bf16 v[20:23], v[114:117], v[84:91], v181
ds_read_b128 v[96:99], v1 offset:12288
v_add_u32_sdwa v102, s42, v131 dst_sel:DWORD dst_unused:UNUSED_PAD src0_sel:DWORD src1_sel:WORD_0
v_smfmac_f32_16x16x64_bf16 v[20:23], a[84:87], v[60:67], v147 abid:1
ds_read_u16 v100, v100
v_add_u32_sdwa v103, s42, v131 dst_sel:DWORD dst_unused:UNUSED_PAD src0_sel:DWORD src1_sel:WORD_1
v_smfmac_f32_16x16x64_bf16 v[20:23], a[120:123], v[68:75], v151 abid:1
ds_read_u16 v82, v82
v_add_u32_sdwa v104, s42, v132 dst_sel:DWORD dst_unused:UNUSED_PAD src0_sel:DWORD src1_sel:WORD_0
v_smfmac_f32_16x16x64_bf16 v[36:39], a[100:103], v[60:67], v149 abid:1
ds_read_u16 v101, v101
v_add_u32_sdwa v105, s42, v132 dst_sel:DWORD dst_unused:UNUSED_PAD src0_sel:DWORD src1_sel:WORD_1
v_smfmac_f32_16x16x64_bf16 v[36:39], a[136:139], v[68:75], v153 abid:1
buffer_store_dwordx2 v[112:113], v5, s[20:23], s46 offen
ds_read_u16 v83, v83
v_add_u32_sdwa v106, s42, v133 dst_sel:DWORD dst_unused:UNUSED_PAD src0_sel:DWORD src1_sel:WORD_0
v_smfmac_f32_16x16x64_bf16 v[40:43], a[104:107], v[60:67], v175
s_mov_b32 s22, 75497472
ds_read_b128 v[114:117], v2 offset:192
v_add_u32_sdwa v107, s42, v133 dst_sel:DWORD dst_unused:UNUSED_PAD src0_sel:DWORD src1_sel:WORD_1
v_smfmac_f32_16x16x64_bf16 v[40:43], a[140:143], v[68:75], v175 abid:1
s_waitcnt lgkmcnt(12)
ds_read_u16 v102, v102
v_add_u32_sdwa v84, s42, v134 dst_sel:DWORD dst_unused:UNUSED_PAD src0_sel:DWORD src1_sel:WORD_0
v_smfmac_f32_16x16x64_bf16 v[8:11], a[144:147], v[44:51], v154
s_waitcnt lgkmcnt(9)
ds_read_u16 v103, v103
v_add_u32_sdwa v85, s42, v134 dst_sel:DWORD dst_unused:UNUSED_PAD src0_sel:DWORD src1_sel:WORD_1
v_smfmac_f32_16x16x64_bf16 v[8:11], a[180:183], v[52:59], v158
s_waitcnt lgkmcnt(7)
ds_read_u16 v104, v104
v_add_u32_sdwa v86, s42, v135 dst_sel:DWORD dst_unused:UNUSED_PAD src0_sel:DWORD src1_sel:WORD_0
v_smfmac_f32_16x16x64_bf16 v[8:11], a[216:219], v[92:99], v162
s_mov_b32 s46, s48
ds_read_u16 v105, v105
v_add_u32_sdwa v87, s42, v135 dst_sel:DWORD dst_unused:UNUSED_PAD src0_sel:DWORD src1_sel:WORD_1
v_smfmac_f32_16x16x64_bf16 v[24:27], a[160:163], v[44:51], v156
s_add_u32 m0, s44, 0
ds_read_u16 v106, v106
v_add_u32_sdwa v88, s42, v136 dst_sel:DWORD dst_unused:UNUSED_PAD src0_sel:DWORD src1_sel:WORD_0
v_smfmac_f32_16x16x64_bf16 v[24:27], a[196:199], v[52:59], v160
buffer_load_dwordx4 v3, s[16:19], s45 offen offset:0 nt lds
v_add_u32_sdwa v89, s42, v136 dst_sel:DWORD dst_unused:UNUSED_PAD src0_sel:DWORD src1_sel:WORD_1
v_smfmac_f32_16x16x64_bf16 v[24:27], a[232:235], v[92:99], v164
s_waitcnt lgkmcnt(5)
ds_read_u16 v107, v107
v_add_u32_sdwa v90, s42, v137 dst_sel:DWORD dst_unused:UNUSED_PAD src0_sel:DWORD src1_sel:WORD_0
v_smfmac_f32_16x16x64_bf16 v[24:27], v[114:117], v[76:83], v182
s_mov_b32 s48, s49
ds_read_u16 v84, v84
v_add_u32_sdwa v91, s42, v137 dst_sel:DWORD dst_unused:UNUSED_PAD src0_sel:DWORD src1_sel:WORD_1
v_smfmac_f32_16x16x64_bf16 v[28:31], v[114:117], v[76:83], v182 abid:1
s_mov_b32 s49, s50
ds_read_b128 v[114:117], v2 offset:256
v_add_u32_sdwa v76, s4, v118 dst_sel:DWORD dst_unused:UNUSED_PAD src0_sel:DWORD src1_sel:WORD_0
v_smfmac_f32_16x16x64_bf16 v[28:31], a[164:167], v[44:51], v156 abid:1
s_add_u32 s50, s50, 4718592
ds_read_u16 v85, v85
v_add_u32_sdwa v77, s4, v118 dst_sel:DWORD dst_unused:UNUSED_PAD src0_sel:DWORD src1_sel:WORD_1
v_smfmac_f32_16x16x64_bf16 v[28:31], a[200:203], v[52:59], v160 abid:1
ds_read_u16 v86, v86
v_add_u32_sdwa v78, s4, v119 dst_sel:DWORD dst_unused:UNUSED_PAD src0_sel:DWORD src1_sel:WORD_0
v_smfmac_f32_16x16x64_bf16 v[28:31], a[236:239], v[92:99], v164 abid:1
ds_read_u16 v87, v87
v_add_u32_sdwa v79, s4, v119 dst_sel:DWORD dst_unused:UNUSED_PAD src0_sel:DWORD src1_sel:WORD_1
v_smfmac_f32_16x16x64_bf16 v[12:15], a[148:151], v[44:51], v154 abid:1
s_add_u32 m0, s44, 3840
ds_read_u16 v88, v88
v_add_u32_sdwa v80, s4, v120 dst_sel:DWORD dst_unused:UNUSED_PAD src0_sel:DWORD src1_sel:WORD_0
v_smfmac_f32_16x16x64_bf16 v[12:15], a[184:187], v[52:59], v158 abid:1
buffer_load_dwordx4 v3, s[16:19], s45 offen offset:256 nt lds
v_add_u32_sdwa v81, s4, v120 dst_sel:DWORD dst_unused:UNUSED_PAD src0_sel:DWORD src1_sel:WORD_1
v_smfmac_f32_16x16x64_bf16 v[12:15], a[220:223], v[92:99], v162 abid:1
ds_read_b128 v[60:63], v0 offset:14336
v_add_u32_sdwa v82, s4, v121 dst_sel:DWORD dst_unused:UNUSED_PAD src0_sel:DWORD src1_sel:WORD_0
v_smfmac_f32_16x16x64_bf16 v[32:35], a[168:171], v[44:51], v157
ds_read_u16 v89, v89
v_add_u32_sdwa v83, s4, v121 dst_sel:DWORD dst_unused:UNUSED_PAD src0_sel:DWORD src1_sel:WORD_1
v_smfmac_f32_16x16x64_bf16 v[32:35], a[204:207], v[52:59], v161
ds_read_b128 v[64:67], v1 offset:14336
v_smfmac_f32_16x16x64_bf16 v[32:35], a[240:243], v[92:99], v165
s_waitcnt lgkmcnt(7)
ds_read_b128 v[68:71], v0 offset:16384
v_smfmac_f32_16x16x64_bf16 v[32:35], v[114:117], v[100:107], v183 abid:1
ds_read_u16 v90, v90
v_smfmac_f32_16x16x64_bf16 v[36:39], v[114:117], v[100:107], v184
ds_read_b128 v[72:75], v1 offset:16384
v_add_u32 v0, s43, v0
v_smfmac_f32_16x16x64_bf16 v[36:39], a[172:175], v[44:51], v157 abid:1
s_add_u32 m0, s44, 7680
ds_read_u16 v91, v91
v_add_u32 v1, s43, v1
v_smfmac_f32_16x16x64_bf16 v[36:39], a[208:211], v[52:59], v161 abid:1
buffer_load_dwordx4 v3, s[16:19], s45 offen offset:512 nt lds
v_smfmac_f32_16x16x64_bf16 v[36:39], a[244:247], v[92:99], v165 abid:1
ds_read_b128 v[114:117], v2 offset:320
v_smfmac_f32_16x16x64_bf16 v[16:19], a[152:155], v[44:51], v155
s_add_u32 m0, s44, 11520
v_smfmac_f32_16x16x64_bf16 v[16:19], a[188:191], v[52:59], v159
buffer_load_dwordx4 v3, s[16:19], s45 offen offset:768 nt lds
v_smfmac_f32_16x16x64_bf16 v[16:19], a[224:227], v[92:99], v163
v_smfmac_f32_16x16x64_bf16 v[20:23], a[156:159], v[44:51], v155 abid:1
s_add_u32 m0, s44, s8
v_smfmac_f32_16x16x64_bf16 v[20:23], a[192:195], v[52:59], v159 abid:1
s_mov_b64 exec, s[10:11]
buffer_load_dwordx4 v3, s[16:19], s7 offen offset:896 nt lds
s_mov_b64 exec, -1
v_smfmac_f32_16x16x64_bf16 v[20:23], a[228:231], v[92:99], v163 abid:1
s_add_u32 s45, s45, 4718592
s_add_u32 s7, s7, 4718592
s_add_u32 s44, s44, s5
v_smfmac_f32_16x16x64_bf16 v[40:43], a[176:179], v[44:51], v176
s_cmp_ge_u32 s44, 148480
s_cselect_b32 s44, s9, s44
s_bitcmp1_b32 s92, s41
v_smfmac_f32_16x16x64_bf16 v[40:43], a[212:215], v[52:59], v176 abid:1
s_cbranch_scc1 L_loop_w
L_loop_wb:
v_smfmac_f32_16x16x64_bf16 v[40:43], a[248:251], v[92:99], v177
s_waitcnt lgkmcnt(0)
v_smfmac_f32_16x16x64_bf16 v[40:43], v[114:117], v[84:91], v185
s_waitcnt vmcnt(20)
s_barrier
v_smfmac_f32_16x16x64_bf16 v[8:11], a[252:255], v[60:67], v166
s_mov_b32 s42, s4
v_smfmac_f32_16x16x64_bf16 v[8:11], v[218:221], v[68:75], v170
ds_read_b128 v[44:47], v0 offset:0
v_add_u32_sdwa v84, s42, v122 dst_sel:DWORD dst_unused:UNUSED_PAD src0_sel:DWORD src1_sel:WORD_0
v_smfmac_f32_16x16x64_bf16 v[12:15], v[186:189], v[60:67], v166 abid:1
ds_read_b128 v[48:51], v1 offset:0
v_add_u32_sdwa v85, s42, v122 dst_sel:DWORD dst_unused:UNUSED_PAD src0_sel:DWORD src1_sel:WORD_1
v_smfmac_f32_16x16x64_bf16 v[12:15], v[222:225], v[68:75], v170 abid:1
ds_read_b128 v[52:55], v0 offset:2048
v_add_u32_sdwa v86, s42, v123 dst_sel:DWORD dst_unused:UNUSED_PAD src0_sel:DWORD src1_sel:WORD_0
v_smfmac_f32_16x16x64_bf16 v[16:19], v[190:193], v[60:67], v167
ds_read_b128 v[56:59], v1 offset:2048
v_cvt_pk_bf16_f32 v92, v8, v9
v_smfmac_f32_16x16x64_bf16 v[16:19], v[226:229], v[68:75], v171
ds_read_u16 v76, v76
v_cvt_pk_bf16_f32 v93, v10, v11
v_smfmac_f32_16x16x64_bf16 v[20:23], v[194:197], v[60:67], v167 abid:1
ds_read_b128 v[8:11], v2 offset:1024
v_cvt_pk_bf16_f32 v94, v12, v13
v_smfmac_f32_16x16x64_bf16 v[20:23], v[230:233], v[68:75], v171 abid:1
ds_read_u16 v77, v77
v_cvt_pk_bf16_f32 v95, v14, v15
v_smfmac_f32_16x16x64_bf16 v[24:27], v[198:201], v[60:67], v168
ds_read_b128 v[12:15], v2 offset:1088
v_cvt_pk_bf16_f32 v96, v16, v17
v_smfmac_f32_16x16x64_bf16 v[24:27], v[234:237], v[68:75], v172
ds_read_u16 v78, v78
v_cvt_pk_bf16_f32 v97, v18, v19
v_smfmac_f32_16x16x64_bf16 v[28:31], v[202:205], v[60:67], v168 abid:1
ds_read_b128 v[16:19], v2 offset:1152
v_cvt_pk_bf16_f32 v98, v20, v21
v_smfmac_f32_16x16x64_bf16 v[28:31], v[238:241], v[68:75], v172 abid:1
ds_read_u16 v79, v79
v_cvt_pk_bf16_f32 v99, v22, v23
v_smfmac_f32_16x16x64_bf16 v[32:35], v[206:209], v[60:67], v169
ds_read_b128 v[20:23], v2 offset:1216
v_cvt_pk_bf16_f32 v100, v24, v25
v_smfmac_f32_16x16x64_bf16 v[32:35], v[242:245], v[68:75], v173
ds_read_u16 v80, v80
v_cvt_pk_bf16_f32 v101, v26, v27
v_smfmac_f32_16x16x64_bf16 v[36:39], v[210:213], v[60:67], v169 abid:1
ds_read_b128 v[24:27], v2 offset:1280
v_cvt_pk_bf16_f32 v102, v28, v29
v_smfmac_f32_16x16x64_bf16 v[36:39], v[246:249], v[68:75], v173 abid:1
ds_read_u16 v81, v81
v_cvt_pk_bf16_f32 v103, v30, v31
v_smfmac_f32_16x16x64_bf16 v[40:43], v[214:217], v[60:67], v177 abid:1
s_bitcmp1_b32 s85, s41
ds_read_b128 v[28:31], v2 offset:1344
v_cvt_pk_bf16_f32 v104, v32, v33
v_smfmac_f32_16x16x64_bf16 v[40:43], v[250:253], v[68:75], v178
s_waitcnt lgkmcnt(10)
v_cvt_pk_bf16_f32 v105, v34, v35
s_cbranch_scc1 L_loop
s_cmp_lg_u32 s41, 6
s_cbranch_scc1 L_loopn
.p2align 3
L_loopc:
v_smfmac_f32_16x16x64_bf16 v[8:11], a[0:3], v[44:51], v138
s_cmp_lt_u32 s56, s65
s_cselect_b32 s34, s34, 0
s_cselect_b32 s64, s64, 0
ds_read_b128 v[32:35], v2 offset:1408
v_cvt_pk_bf16_f32 v106, v36, v37
v_mov_b32 v7, 1
v_smfmac_f32_16x16x64_bf16 v[8:11], a[36:39], v[52:59], v142
s_waitcnt lgkmcnt(9)
buffer_atomic_add v7, v6, s[32:35], 0 offen sc0 sc1
v_cvt_pk_bf16_f32 v107, v38, v39
v_smfmac_f32_16x16x64_bf16 v[12:15], a[4:7], v[44:51], v138 abid:1
ds_read_b128 v[36:39], v2 offset:1472
v_cvt_pk_bf16_f32 v112, v40, v41
v_smfmac_f32_16x16x64_bf16 v[12:15], a[40:43], v[52:59], v142 abid:1
s_waitcnt lgkmcnt(8)
ds_read_b128 v[60:63], v0 offset:4096
v_cvt_pk_bf16_f32 v113, v42, v43
v_smfmac_f32_16x16x64_bf16 v[16:19], a[8:11], v[44:51], v139
s_cmp_eq_u32 s4, 129920
ds_read_b128 v[40:43], v2 offset:1536
v_cndmask_b32_dpp v108, v96, v92, vcc quad_perm:[1,0,3,2] row_mask:0xf bank_mask:0xf
v_smfmac_f32_16x16x64_bf16 v[16:19], a[44:47], v[52:59], v143
s_waitcnt lgkmcnt(8)
ds_read_u16 v82, v82
v_cndmask_b32_dpp v109, v97, v93, vcc quad_perm:[1,0,3,2] row_mask:0xf bank_mask:0xf
v_smfmac_f32_16x16x64_bf16 v[20:23], a[12:15], v[44:51], v139 abid:1
s_cselect_b32 s43, -129920, s5
ds_read_u16 v84, v84
v_cndmask_b32_dpp v110, v98, v94, vcc quad_perm:[1,0,3,2] row_mask:0xf bank_mask:0xf
v_smfmac_f32_16x16x64_bf16 v[20:23], a[48:51], v[52:59], v143 abid:1
s_waitcnt lgkmcnt(8)
ds_read_b128 v[64:67], v1 offset:4096
v_cndmask_b32_dpp v111, v99, v95, vcc quad_perm:[1,0,3,2] row_mask:0xf bank_mask:0xf
v_smfmac_f32_16x16x64_bf16 v[24:27], a[16:19], v[44:51], v140
s_add_u32 s4, s4, s43
ds_read_b128 v[68:71], v0 offset:6144
v_add_u32_sdwa v87, s42, v123 dst_sel:DWORD dst_unused:UNUSED_PAD src0_sel:DWORD src1_sel:WORD_1
v_smfmac_f32_16x16x64_bf16 v[24:27], a[52:55], v[52:59], v144
buffer_store_dwordx4 v[108:111], v4, s[20:23], s46 offen offset:0 sc1
s_mov_b64 vcc, s[82:83]
s_waitcnt lgkmcnt(8)
ds_read_b128 v[72:75], v1 offset:6144
v_cndmask_b32_dpp v96, v92, v96, vcc quad_perm:[1,0,3,2] row_mask:0xf bank_mask:0xf
v_cndmask_b32_dpp v97, v93, v97, vcc quad_perm:[1,0,3,2] row_mask:0xf bank_mask:0xf
v_smfmac_f32_16x16x64_bf16 v[28:31], a[20:23], v[44:51], v140 abid:1
s_add_u32 s7, s45, s58
ds_read_u16 v83, v83
v_cndmask_b32_dpp v98, v94, v98, vcc quad_perm:[1,0,3,2] row_mask:0xf bank_mask:0xf
v_smfmac_f32_16x16x64_bf16 v[28:31], a[56:59], v[52:59], v144 abid:1
s_waitcnt lgkmcnt(9)
ds_read_b128 v[114:117], v2 offset:64
v_cndmask_b32_dpp v99, v95, v99, vcc quad_perm:[1,0,3,2] row_mask:0xf bank_mask:0xf
v_smfmac_f32_16x16x64_bf16 v[32:35], a[24:27], v[44:51], v141
ds_read_u16 v85, v85
v_add_u32_sdwa v88, s42, v124 dst_sel:DWORD dst_unused:UNUSED_PAD src0_sel:DWORD src1_sel:WORD_0
v_smfmac_f32_16x16x64_bf16 v[32:35], a[60:63], v[52:59], v145
s_waitcnt lgkmcnt(10)
ds_read_u16 v86, v86
v_add_u32_sdwa v89, s42, v124 dst_sel:DWORD dst_unused:UNUSED_PAD src0_sel:DWORD src1_sel:WORD_1
v_smfmac_f32_16x16x64_bf16 v[36:39], a[28:31], v[44:51], v141 abid:1
ds_read_u16 v87, v87
v_add_u32_sdwa v90, s42, v125 dst_sel:DWORD dst_unused:UNUSED_PAD src0_sel:DWORD src1_sel:WORD_0
v_smfmac_f32_16x16x64_bf16 v[36:39], a[64:67], v[52:59], v145 abid:1
s_waitcnt lgkmcnt(10)
ds_read_u16 v88, v88
v_add_u32_sdwa v91, s42, v125 dst_sel:DWORD dst_unused:UNUSED_PAD src0_sel:DWORD src1_sel:WORD_1
v_smfmac_f32_16x16x64_bf16 v[40:43], a[32:35], v[44:51], v174
buffer_store_dwordx4 v[96:99], v4, s[20:23], s46 offen offset:1152 sc1
s_mov_b64 vcc, s[80:81]
ds_read_u16 v89, v89
v_cndmask_b32_dpp v92, v104, v100, vcc quad_perm:[1,0,3,2] row_mask:0xf bank_mask:0xf
v_cndmask_b32_dpp v93, v105, v101, vcc quad_perm:[1,0,3,2] row_mask:0xf bank_mask:0xf
v_smfmac_f32_16x16x64_bf16 v[40:43], a[68:71], v[52:59], v174 abid:1
s_waitcnt lgkmcnt(9)
ds_read_u16 v90, v90
v_cndmask_b32_dpp v94, v106, v102, vcc quad_perm:[1,0,3,2] row_mask:0xf bank_mask:0xf
v_smfmac_f32_16x16x64_bf16 v[8:11], a[72:75], v[60:67], v146
s_waitcnt lgkmcnt(8)
ds_read_u16 v91, v91
v_cndmask_b32_dpp v95, v107, v103, vcc quad_perm:[1,0,3,2] row_mask:0xf bank_mask:0xf
v_smfmac_f32_16x16x64_bf16 v[8:11], a[108:111], v[68:75], v150
s_waitcnt lgkmcnt(7)
ds_bpermute_b32 v112, v6, v112
v_smfmac_f32_16x16x64_bf16 v[8:11], v[114:117], v[76:83], v179
ds_bpermute_b32 v113, v6, v113
v_smfmac_f32_16x16x64_bf16 v[12:15], v[114:117], v[76:83], v179 abid:1
ds_read_b128 v[114:117], v2 offset:128
v_add_u32_sdwa v76, s42, v126 dst_sel:DWORD dst_unused:UNUSED_PAD src0_sel:DWORD src1_sel:WORD_0
v_smfmac_f32_16x16x64_bf16 v[12:15], a[76:79], v[60:67], v146 abid:1
ds_read_u16 v76, v76
v_add_u32_sdwa v77, s42, v126 dst_sel:DWORD dst_unused:UNUSED_PAD src0_sel:DWORD src1_sel:WORD_1
v_smfmac_f32_16x16x64_bf16 v[12:15], a[112:115], v[68:75], v150 abid:1
buffer_store_dwordx4 v[92:95], v4, s[20:23], s46 offen offset:128 sc1
s_mov_b64 vcc, s[82:83]
ds_read_u16 v77, v77
v_cndmask_b32_dpp v104, v100, v104, vcc quad_perm:[1,0,3,2] row_mask:0xf bank_mask:0xf
v_add_u32_sdwa v78, s42, v127 dst_sel:DWORD dst_unused:UNUSED_PAD src0_sel:DWORD src1_sel:WORD_0
v_smfmac_f32_16x16x64_bf16 v[24:27], a[88:91], v[60:67], v148
ds_read_u16 v78, v78
v_cndmask_b32_dpp v105, v101, v105, vcc quad_perm:[1,0,3,2] row_mask:0xf bank_mask:0xf
v_smfmac_f32_16x16x64_bf16 v[24:27], a[124:127], v[68:75], v152
ds_read_b128 v[44:47], v0 offset:8192
v_cndmask_b32_dpp v106, v102, v106, vcc quad_perm:[1,0,3,2] row_mask:0xf bank_mask:0xf
v_smfmac_f32_16x16x64_bf16 v[28:31], a[92:95], v[60:67], v148 abid:1
ds_read_b128 v[48:51], v1 offset:8192
v_add_u32_sdwa v79, s42, v127 dst_sel:DWORD dst_unused:UNUSED_PAD src0_sel:DWORD src1_sel:WORD_1
v_smfmac_f32_16x16x64_bf16 v[28:31], a[128:131], v[68:75], v152 abid:1
ds_read_u16 v79, v79
v_cndmask_b32_dpp v107, v103, v107, vcc quad_perm:[1,0,3,2] row_mask:0xf bank_mask:0xf
v_smfmac_f32_16x16x64_bf16 v[32:35], a[96:99], v[60:67], v149
ds_read_b128 v[52:55], v0 offset:10240
v_add_u32_sdwa v80, s42, v128 dst_sel:DWORD dst_unused:UNUSED_PAD src0_sel:DWORD src1_sel:WORD_0
v_smfmac_f32_16x16x64_bf16 v[32:35], a[132:135], v[68:75], v153
ds_read_u16 v80, v80
v_add_u32_sdwa v81, s42, v128 dst_sel:DWORD dst_unused:UNUSED_PAD src0_sel:DWORD src1_sel:WORD_1
v_smfmac_f32_16x16x64_bf16 v[16:19], a[80:83], v[60:67], v147
buffer_store_dwordx4 v[104:107], v4, s[20:23], s46 offen offset:1280 sc1
s_mov_b64 vcc, s[80:81]
ds_read_b128 v[56:59], v1 offset:10240
v_add_u32_sdwa v82, s42, v129 dst_sel:DWORD dst_unused:UNUSED_PAD src0_sel:DWORD src1_sel:WORD_0
v_add_u32_sdwa v83, s42, v129 dst_sel:DWORD dst_unused:UNUSED_PAD src0_sel:DWORD src1_sel:WORD_1
v_smfmac_f32_16x16x64_bf16 v[16:19], a[116:119], v[68:75], v151
s_waitcnt lgkmcnt(9)
ds_read_b128 v[92:95], v0 offset:12288
v_add_u32_sdwa v100, s42, v130 dst_sel:DWORD dst_unused:UNUSED_PAD src0_sel:DWORD src1_sel:WORD_0
v_smfmac_f32_16x16x64_bf16 v[16:19], v[114:117], v[84:91], v180 abid:1
ds_read_u16 v81, v81
v_add_u32_sdwa v101, s42, v130 dst_sel:DWORD dst_unused:UNUSED_PAD src0_sel:DWORD src1_sel:WORD_1
v_smfmac_f32_16x16x64_bf16 v[20:23], v[114:117], v[84:91], v181
ds_read_b128 v[96:99], v1 offset:12288
v_add_u32_sdwa v102, s42, v131 dst_sel:DWORD dst_unused:UNUSED_PAD src0_sel:DWORD src1_sel:WORD_0
v_smfmac_f32_16x16x64_bf16 v[20:23], a[84:87], v[60:67], v147 abid:1
ds_read_u16 v100, v100
v_add_u32_sdwa v103, s42, v131 dst_sel:DWORD dst_unused:UNUSED_PAD src0_sel:DWORD src1_sel:WORD_1
v_smfmac_f32_16x16x64_bf16 v[20:23], a[120:123], v[68:75], v151 abid:1
ds_read_u16 v82, v82
v_add_u32_sdwa v104, s42, v132 dst_sel:DWORD dst_unused:UNUSED_PAD src0_sel:DWORD src1_sel:WORD_0
v_smfmac_f32_16x16x64_bf16 v[36:39], a[100:103], v[60:67], v149 abid:1
ds_read_u16 v101, v101
v_add_u32_sdwa v105, s42, v132 dst_sel:DWORD dst_unused:UNUSED_PAD src0_sel:DWORD src1_sel:WORD_1
v_smfmac_f32_16x16x64_bf16 v[36:39], a[136:139], v[68:75], v153 abid:1
buffer_store_dwordx2 v[112:113], v5, s[20:23], s46 offen
ds_read_u16 v83, v83
v_add_u32_sdwa v106, s42, v133 dst_sel:DWORD dst_unused:UNUSED_PAD src0_sel:DWORD src1_sel:WORD_0
v_smfmac_f32_16x16x64_bf16 v[40:43], a[104:107], v[60:67], v175
s_mov_b32 s46, s48
ds_read_b128 v[114:117], v2 offset:192
v_add_u32_sdwa v107, s42, v133 dst_sel:DWORD dst_unused:UNUSED_PAD src0_sel:DWORD src1_sel:WORD_1
v_smfmac_f32_16x16x64_bf16 v[40:43], a[140:143], v[68:75], v175 abid:1
s_waitcnt lgkmcnt(12)
ds_read_u16 v102, v102
v_add_u32_sdwa v84, s42, v134 dst_sel:DWORD dst_unused:UNUSED_PAD src0_sel:DWORD src1_sel:WORD_0
v_smfmac_f32_16x16x64_bf16 v[8:11], a[144:147], v[44:51], v154
s_waitcnt lgkmcnt(9)
ds_read_u16 v103, v103
v_add_u32_sdwa v85, s42, v134 dst_sel:DWORD dst_unused:UNUSED_PAD src0_sel:DWORD src1_sel:WORD_1
v_smfmac_f32_16x16x64_bf16 v[8:11], a[180:183], v[52:59], v158
s_waitcnt lgkmcnt(7)
ds_read_u16 v104, v104
v_add_u32_sdwa v86, s42, v135 dst_sel:DWORD dst_unused:UNUSED_PAD src0_sel:DWORD src1_sel:WORD_0
v_smfmac_f32_16x16x64_bf16 v[8:11], a[216:219], v[92:99], v162
s_mov_b32 s48, s49
ds_read_u16 v105, v105
v_add_u32_sdwa v87, s42, v135 dst_sel:DWORD dst_unused:UNUSED_PAD src0_sel:DWORD src1_sel:WORD_1
v_smfmac_f32_16x16x64_bf16 v[24:27], a[160:163], v[44:51], v156
s_add_u32 m0, s44, 0
ds_read_u16 v106, v106
v_add_u32_sdwa v88, s42, v136 dst_sel:DWORD dst_unused:UNUSED_PAD src0_sel:DWORD src1_sel:WORD_0
v_smfmac_f32_16x16x64_bf16 v[24:27], a[196:199], v[52:59], v160
buffer_load_dwordx4 v3, s[16:19], s45 offen offset:0 nt lds
v_add_u32_sdwa v89, s42, v136 dst_sel:DWORD dst_unused:UNUSED_PAD src0_sel:DWORD src1_sel:WORD_1
v_smfmac_f32_16x16x64_bf16 v[24:27], a[232:235], v[92:99], v164
s_waitcnt lgkmcnt(5)
ds_read_u16 v107, v107
v_add_u32_sdwa v90, s42, v137 dst_sel:DWORD dst_unused:UNUSED_PAD src0_sel:DWORD src1_sel:WORD_0
v_smfmac_f32_16x16x64_bf16 v[24:27], v[114:117], v[76:83], v182
s_waitcnt vmcnt(6)
ds_read_u16 v84, v84
v_add_u32_sdwa v91, s42, v137 dst_sel:DWORD dst_unused:UNUSED_PAD src0_sel:DWORD src1_sel:WORD_1
v_smfmac_f32_16x16x64_bf16 v[28:31], v[114:117], v[76:83], v182 abid:1
s_mov_b32 s49, s50
ds_read_b128 v[114:117], v2 offset:256
v_add_u32_sdwa v76, s4, v118 dst_sel:DWORD dst_unused:UNUSED_PAD src0_sel:DWORD src1_sel:WORD_0
v_smfmac_f32_16x16x64_bf16 v[28:31], a[164:167], v[44:51], v156 abid:1
s_mov_b32 s50, s45
ds_read_u16 v85, v85
v_add_u32_sdwa v77, s4, v118 dst_sel:DWORD dst_unused:UNUSED_PAD src0_sel:DWORD src1_sel:WORD_1
v_smfmac_f32_16x16x64_bf16 v[28:31], a[200:203], v[52:59], v160 abid:1
ds_read_u16 v86, v86
v_add_u32_sdwa v78, s4, v119 dst_sel:DWORD dst_unused:UNUSED_PAD src0_sel:DWORD src1_sel:WORD_0
v_smfmac_f32_16x16x64_bf16 v[28:31], a[236:239], v[92:99], v164 abid:1
ds_read_u16 v87, v87
v_add_u32_sdwa v79, s4, v119 dst_sel:DWORD dst_unused:UNUSED_PAD src0_sel:DWORD src1_sel:WORD_1
v_smfmac_f32_16x16x64_bf16 v[12:15], a[148:151], v[44:51], v154 abid:1
s_add_u32 m0, s44, 3840
ds_read_u16 v88, v88
v_add_u32_sdwa v80, s4, v120 dst_sel:DWORD dst_unused:UNUSED_PAD src0_sel:DWORD src1_sel:WORD_0
v_smfmac_f32_16x16x64_bf16 v[12:15], a[184:187], v[52:59], v158 abid:1
buffer_load_dwordx4 v3, s[16:19], s45 offen offset:256 nt lds
v_add_u32_sdwa v81, s4, v120 dst_sel:DWORD dst_unused:UNUSED_PAD src0_sel:DWORD src1_sel:WORD_1
v_smfmac_f32_16x16x64_bf16 v[12:15], a[220:223], v[92:99], v162 abid:1
ds_read_b128 v[60:63], v0 offset:14336
v_add_u32_sdwa v82, s4, v121 dst_sel:DWORD dst_unused:UNUSED_PAD src0_sel:DWORD src1_sel:WORD_0
v_smfmac_f32_16x16x64_bf16 v[32:35], a[168:171], v[44:51], v157
ds_read_u16 v89, v89
v_add_u32_sdwa v83, s4, v121 dst_sel:DWORD dst_unused:UNUSED_PAD src0_sel:DWORD src1_sel:WORD_1
v_smfmac_f32_16x16x64_bf16 v[32:35], a[204:207], v[52:59], v161
ds_read_b128 v[64:67], v1 offset:14336
v_smfmac_f32_16x16x64_bf16 v[32:35], a[240:243], v[92:99], v165
s_waitcnt lgkmcnt(7)
ds_read_b128 v[68:71], v0 offset:16384
v_smfmac_f32_16x16x64_bf16 v[32:35], v[114:117], v[100:107], v183 abid:1
ds_read_u16 v90, v90
v_smfmac_f32_16x16x64_bf16 v[36:39], v[114:117], v[100:107], v184
ds_read_b128 v[72:75], v1 offset:16384
v_add_u32 v0, s43, v0
v_smfmac_f32_16x16x64_bf16 v[36:39], a[172:175], v[44:51], v157 abid:1
s_add_u32 m0, s44, 7680
ds_read_u16 v91, v91
v_add_u32 v1, s43, v1
v_smfmac_f32_16x16x64_bf16 v[36:39], a[208:211], v[52:59], v161 abid:1
buffer_load_dwordx4 v3, s[16:19], s45 offen offset:512 nt lds
v_smfmac_f32_16x16x64_bf16 v[36:39], a[244:247], v[92:99], v165 abid:1
ds_read_b128 v[114:117], v2 offset:320
v_smfmac_f32_16x16x64_bf16 v[16:19], a[152:155], v[44:51], v155
s_add_u32 m0, s44, 11520
v_smfmac_f32_16x16x64_bf16 v[16:19], a[188:191], v[52:59], v159
buffer_load_dwordx4 v3, s[16:19], s45 offen offset:768 nt lds
v_smfmac_f32_16x16x64_bf16 v[16:19], a[224:227], v[92:99], v163
s_mov_b64 exec, s[62:63]
ds_write_b32 v0, v7 offset:18432
s_mov_b64 exec, -1
v_smfmac_f32_16x16x64_bf16 v[20:23], a[156:159], v[44:51], v155 abid:1
s_add_u32 m0, s44, s8
v_smfmac_f32_16x16x64_bf16 v[20:23], a[192:195], v[52:59], v159 abid:1
s_mov_b64 exec, s[10:11]
buffer_load_dwordx4 v3, s[16:19], s7 offen offset:896 nt lds
s_mov_b64 exec, -1
v_smfmac_f32_16x16x64_bf16 v[20:23], a[228:231], v[92:99], v163 abid:1
s_add_u32 s44, s44, s5
s_cmp_ge_u32 s44, 148480
s_cselect_b32 s44, s9, s44
v_smfmac_f32_16x16x64_bf16 v[40:43], a[176:179], v[44:51], v176
v_smfmac_f32_16x16x64_bf16 v[40:43], a[212:215], v[52:59], v176 abid:1
v_smfmac_f32_16x16x64_bf16 v[40:43], a[248:251], v[92:99], v177
s_waitcnt lgkmcnt(0)
v_smfmac_f32_16x16x64_bf16 v[40:43], v[114:117], v[84:91], v185
s_barrier
v_smfmac_f32_16x16x64_bf16 v[8:11], a[252:255], v[60:67], v166
s_mov_b32 s42, s4
ds_read_b32 v7, v0 offset:18432
v_smfmac_f32_16x16x64_bf16 v[8:11], v[218:221], v[68:75], v170
ds_read_b128 v[44:47], v0 offset:0
v_add_u32_sdwa v84, s42, v122 dst_sel:DWORD dst_unused:UNUSED_PAD src0_sel:DWORD src1_sel:WORD_0
v_smfmac_f32_16x16x64_bf16 v[12:15], v[186:189], v[60:67], v166 abid:1
ds_read_b128 v[48:51], v1 offset:0
v_add_u32_sdwa v85, s42, v122 dst_sel:DWORD dst_unused:UNUSED_PAD src0_sel:DWORD src1_sel:WORD_1
v_smfmac_f32_16x16x64_bf16 v[12:15], v[222:225], v[68:75], v170 abid:1
ds_read_b128 v[52:55], v0 offset:2048
v_add_u32_sdwa v86, s42, v123 dst_sel:DWORD dst_unused:UNUSED_PAD src0_sel:DWORD src1_sel:WORD_0
v_smfmac_f32_16x16x64_bf16 v[16:19], v[190:193], v[60:67], v167
ds_read_b128 v[56:59], v1 offset:2048
v_cvt_pk_bf16_f32 v92, v8, v9
v_smfmac_f32_16x16x64_bf16 v[16:19], v[226:229], v[68:75], v171
ds_read_u16 v76, v76
v_cvt_pk_bf16_f32 v93, v10, v11
v_smfmac_f32_16x16x64_bf16 v[20:23], v[194:197], v[60:67], v167 abid:1
ds_read_b128 v[8:11], v2 offset:1024
v_cvt_pk_bf16_f32 v94, v12, v13
v_smfmac_f32_16x16x64_bf16 v[20:23], v[230:233], v[68:75], v171 abid:1
ds_read_u16 v77, v77
v_cvt_pk_bf16_f32 v95, v14, v15
v_smfmac_f32_16x16x64_bf16 v[24:27], v[198:201], v[60:67], v168
ds_read_b128 v[12:15], v2 offset:1088
v_cvt_pk_bf16_f32 v96, v16, v17
v_smfmac_f32_16x16x64_bf16 v[24:27], v[234:237], v[68:75], v172
s_waitcnt lgkmcnt(8)
ds_read_u16 v78, v78
v_cvt_pk_bf16_f32 v97, v18, v19
v_readfirstlane_b32 s56, v7
v_smfmac_f32_16x16x64_bf16 v[28:31], v[202:205], v[60:67], v168 abid:1
s_lshr_b32 s60, s56, 4
ds_read_b128 v[16:19], v2 offset:1152
v_cvt_pk_bf16_f32 v98, v20, v21
v_smfmac_f32_16x16x64_bf16 v[28:31], v[238:241], v[68:75], v172 abid:1
s_mul_i32 s60, s60, 884736
ds_read_u16 v79, v79
v_cvt_pk_bf16_f32 v99, v22, v23
v_smfmac_f32_16x16x64_bf16 v[32:35], v[206:209], v[60:67], v169
s_mul_i32 s61, s56, 18432
ds_read_b128 v[20:23], v2 offset:1216
v_cvt_pk_bf16_f32 v100, v24, v25
v_smfmac_f32_16x16x64_bf16 v[32:35], v[242:245], v[68:75], v173
s_add_u32 s60, s60, s57
ds_read_u16 v80, v80
v_cvt_pk_bf16_f32 v101, v26, v27
v_smfmac_f32_16x16x64_bf16 v[36:39], v[210:213], v[60:67], v169 abid:1
s_add_u32 s45, s60, s61
ds_read_b128 v[24:27], v2 offset:1280
v_cvt_pk_bf16_f32 v102, v28, v29
v_smfmac_f32_16x16x64_bf16 v[36:39], v[246:249], v[68:75], v173 abid:1
ds_read_u16 v81, v81
v_cvt_pk_bf16_f32 v103, v30, v31
v_smfmac_f32_16x16x64_bf16 v[40:43], v[214:217], v[60:67], v177 abid:1
s_cmp_lt_u32 s56, s64
ds_read_b128 v[28:31], v2 offset:1344
v_cvt_pk_bf16_f32 v104, v32, v33
v_smfmac_f32_16x16x64_bf16 v[40:43], v[250:253], v[68:75], v178
s_waitcnt lgkmcnt(10)
v_cvt_pk_bf16_f32 v105, v34, v35
s_cbranch_scc1 L_loopc
s_mov_b32 s41, 0
s_mov_b32 s15, 3
s_mov_b32 s12, 7
s_mov_b32 s92, 4
s_mov_b32 s87, 4
s_mov_b32 s59, -1
.p2align 3
L_loopn:
v_smfmac_f32_16x16x64_bf16 v[8:11], a[0:3], v[44:51], v138
ds_read_b128 v[32:35], v2 offset:1408
v_cvt_pk_bf16_f32 v106, v36, v37
v_smfmac_f32_16x16x64_bf16 v[8:11], a[36:39], v[52:59], v142
s_waitcnt lgkmcnt(9)
v_cvt_pk_bf16_f32 v107, v38, v39
v_smfmac_f32_16x16x64_bf16 v[12:15], a[4:7], v[44:51], v138 abid:1
ds_read_b128 v[36:39], v2 offset:1472
v_cvt_pk_bf16_f32 v112, v40, v41
v_smfmac_f32_16x16x64_bf16 v[12:15], a[40:43], v[52:59], v142 abid:1
s_waitcnt lgkmcnt(8)
ds_read_b128 v[60:63], v0 offset:4096
v_cvt_pk_bf16_f32 v113, v42, v43
v_smfmac_f32_16x16x64_bf16 v[16:19], a[8:11], v[44:51], v139
s_cmp_eq_u32 s4, 129920
ds_read_b128 v[40:43], v2 offset:1536
v_cndmask_b32_dpp v108, v96, v92, vcc quad_perm:[1,0,3,2] row_mask:0xf bank_mask:0xf
v_smfmac_f32_16x16x64_bf16 v[16:19], a[44:47], v[52:59], v143
s_waitcnt lgkmcnt(8)
ds_read_u16 v82, v82
v_cndmask_b32_dpp v109, v97, v93, vcc quad_perm:[1,0,3,2] row_mask:0xf bank_mask:0xf
v_smfmac_f32_16x16x64_bf16 v[20:23], a[12:15], v[44:51], v139 abid:1
s_cselect_b32 s43, -129920, s5
ds_read_u16 v84, v84
v_cndmask_b32_dpp v110, v98, v94, vcc quad_perm:[1,0,3,2] row_mask:0xf bank_mask:0xf
v_smfmac_f32_16x16x64_bf16 v[20:23], a[48:51], v[52:59], v143 abid:1
s_waitcnt lgkmcnt(8)
ds_read_b128 v[64:67], v1 offset:4096
v_cndmask_b32_dpp v111, v99, v95, vcc quad_perm:[1,0,3,2] row_mask:0xf bank_mask:0xf
v_smfmac_f32_16x16x64_bf16 v[24:27], a[16:19], v[44:51], v140
s_add_u32 s4, s4, s43
ds_read_b128 v[68:71], v0 offset:6144
v_add_u32_sdwa v87, s42, v123 dst_sel:DWORD dst_unused:UNUSED_PAD src0_sel:DWORD src1_sel:WORD_1
v_smfmac_f32_16x16x64_bf16 v[24:27], a[52:55], v[52:59], v144
buffer_store_dwordx4 v[108:111], v4, s[20:23], s46 offen offset:0 sc1
s_mov_b64 vcc, s[82:83]
s_waitcnt lgkmcnt(8)
ds_read_b128 v[72:75], v1 offset:6144
v_cndmask_b32_dpp v96, v92, v96, vcc quad_perm:[1,0,3,2] row_mask:0xf bank_mask:0xf
v_cndmask_b32_dpp v97, v93, v97, vcc quad_perm:[1,0,3,2] row_mask:0xf bank_mask:0xf
v_smfmac_f32_16x16x64_bf16 v[28:31], a[20:23], v[44:51], v140 abid:1
s_add_u32 s41, s41, 1
ds_read_u16 v83, v83
v_cndmask_b32_dpp v98, v94, v98, vcc quad_perm:[1,0,3,2] row_mask:0xf bank_mask:0xf
v_smfmac_f32_16x16x64_bf16 v[28:31], a[56:59], v[52:59], v144 abid:1
s_waitcnt lgkmcnt(9)
ds_read_b128 v[114:117], v2 offset:64
v_cndmask_b32_dpp v99, v95, v99, vcc quad_perm:[1,0,3,2] row_mask:0xf bank_mask:0xf
v_smfmac_f32_16x16x64_bf16 v[32:35], a[24:27], v[44:51], v141
ds_read_u16 v85, v85
v_add_u32_sdwa v88, s42, v124 dst_sel:DWORD dst_unused:UNUSED_PAD src0_sel:DWORD src1_sel:WORD_0
v_smfmac_f32_16x16x64_bf16 v[32:35], a[60:63], v[52:59], v145
s_waitcnt lgkmcnt(10)
ds_read_u16 v86, v86
v_add_u32_sdwa v89, s42, v124 dst_sel:DWORD dst_unused:UNUSED_PAD src0_sel:DWORD src1_sel:WORD_1
v_smfmac_f32_16x16x64_bf16 v[36:39], a[28:31], v[44:51], v141 abid:1
ds_read_u16 v87, v87
v_add_u32_sdwa v90, s42, v125 dst_sel:DWORD dst_unused:UNUSED_PAD src0_sel:DWORD src1_sel:WORD_0
v_smfmac_f32_16x16x64_bf16 v[36:39], a[64:67], v[52:59], v145 abid:1
s_waitcnt lgkmcnt(10)
ds_read_u16 v88, v88
v_add_u32_sdwa v91, s42, v125 dst_sel:DWORD dst_unused:UNUSED_PAD src0_sel:DWORD src1_sel:WORD_1
v_smfmac_f32_16x16x64_bf16 v[40:43], a[32:35], v[44:51], v174
buffer_store_dwordx4 v[96:99], v4, s[20:23], s46 offen offset:1152 sc1
s_mov_b64 vcc, s[80:81]
ds_read_u16 v89, v89
v_cndmask_b32_dpp v92, v104, v100, vcc quad_perm:[1,0,3,2] row_mask:0xf bank_mask:0xf
v_cndmask_b32_dpp v93, v105, v101, vcc quad_perm:[1,0,3,2] row_mask:0xf bank_mask:0xf
v_smfmac_f32_16x16x64_bf16 v[40:43], a[68:71], v[52:59], v174 abid:1
s_waitcnt lgkmcnt(9)
ds_read_u16 v90, v90
v_cndmask_b32_dpp v94, v106, v102, vcc quad_perm:[1,0,3,2] row_mask:0xf bank_mask:0xf
v_smfmac_f32_16x16x64_bf16 v[8:11], a[72:75], v[60:67], v146
s_waitcnt lgkmcnt(8)
ds_read_u16 v91, v91
v_cndmask_b32_dpp v95, v107, v103, vcc quad_perm:[1,0,3,2] row_mask:0xf bank_mask:0xf
v_smfmac_f32_16x16x64_bf16 v[8:11], a[108:111], v[68:75], v150
s_waitcnt lgkmcnt(7)
ds_bpermute_b32 v112, v6, v112
v_smfmac_f32_16x16x64_bf16 v[8:11], v[114:117], v[76:83], v179
ds_bpermute_b32 v113, v6, v113
v_smfmac_f32_16x16x64_bf16 v[12:15], v[114:117], v[76:83], v179 abid:1
ds_read_b128 v[114:117], v2 offset:128
v_add_u32_sdwa v76, s42, v126 dst_sel:DWORD dst_unused:UNUSED_PAD src0_sel:DWORD src1_sel:WORD_0
v_smfmac_f32_16x16x64_bf16 v[12:15], a[76:79], v[60:67], v146 abid:1
ds_read_u16 v76, v76
v_add_u32_sdwa v77, s42, v126 dst_sel:DWORD dst_unused:UNUSED_PAD src0_sel:DWORD src1_sel:WORD_1
v_smfmac_f32_16x16x64_bf16 v[12:15], a[112:115], v[68:75], v150 abid:1
buffer_store_dwordx4 v[92:95], v4, s[20:23], s46 offen offset:128 sc1
s_mov_b64 vcc, s[82:83]
ds_read_u16 v77, v77
v_cndmask_b32_dpp v104, v100, v104, vcc quad_perm:[1,0,3,2] row_mask:0xf bank_mask:0xf
v_add_u32_sdwa v78, s42, v127 dst_sel:DWORD dst_unused:UNUSED_PAD src0_sel:DWORD src1_sel:WORD_0
v_smfmac_f32_16x16x64_bf16 v[24:27], a[88:91], v[60:67], v148
ds_read_u16 v78, v78
v_cndmask_b32_dpp v105, v101, v105, vcc quad_perm:[1,0,3,2] row_mask:0xf bank_mask:0xf
v_smfmac_f32_16x16x64_bf16 v[24:27], a[124:127], v[68:75], v152
ds_read_b128 v[44:47], v0 offset:8192
v_cndmask_b32_dpp v106, v102, v106, vcc quad_perm:[1,0,3,2] row_mask:0xf bank_mask:0xf
v_smfmac_f32_16x16x64_bf16 v[28:31], a[92:95], v[60:67], v148 abid:1
ds_read_b128 v[48:51], v1 offset:8192
v_add_u32_sdwa v79, s42, v127 dst_sel:DWORD dst_unused:UNUSED_PAD src0_sel:DWORD src1_sel:WORD_1
v_smfmac_f32_16x16x64_bf16 v[28:31], a[128:131], v[68:75], v152 abid:1
ds_read_u16 v79, v79
v_cndmask_b32_dpp v107, v103, v107, vcc quad_perm:[1,0,3,2] row_mask:0xf bank_mask:0xf
v_smfmac_f32_16x16x64_bf16 v[32:35], a[96:99], v[60:67], v149
ds_read_b128 v[52:55], v0 offset:10240
v_add_u32_sdwa v80, s42, v128 dst_sel:DWORD dst_unused:UNUSED_PAD src0_sel:DWORD src1_sel:WORD_0
v_smfmac_f32_16x16x64_bf16 v[32:35], a[132:135], v[68:75], v153
ds_read_u16 v80, v80
v_add_u32_sdwa v81, s42, v128 dst_sel:DWORD dst_unused:UNUSED_PAD src0_sel:DWORD src1_sel:WORD_1
v_smfmac_f32_16x16x64_bf16 v[16:19], a[80:83], v[60:67], v147
buffer_store_dwordx4 v[104:107], v4, s[20:23], s46 offen offset:1280 sc1
s_mov_b64 vcc, s[80:81]
ds_read_b128 v[56:59], v1 offset:10240
v_add_u32_sdwa v82, s42, v129 dst_sel:DWORD dst_unused:UNUSED_PAD src0_sel:DWORD src1_sel:WORD_0
v_add_u32_sdwa v83, s42, v129 dst_sel:DWORD dst_unused:UNUSED_PAD src0_sel:DWORD src1_sel:WORD_1
v_smfmac_f32_16x16x64_bf16 v[16:19], a[116:119], v[68:75], v151
s_waitcnt lgkmcnt(9)
ds_read_b128 v[92:95], v0 offset:12288
v_add_u32_sdwa v100, s42, v130 dst_sel:DWORD dst_unused:UNUSED_PAD src0_sel:DWORD src1_sel:WORD_0
v_smfmac_f32_16x16x64_bf16 v[16:19], v[114:117], v[84:91], v180 abid:1
ds_read_u16 v81, v81
v_add_u32_sdwa v101, s42, v130 dst_sel:DWORD dst_unused:UNUSED_PAD src0_sel:DWORD src1_sel:WORD_1
v_smfmac_f32_16x16x64_bf16 v[20:23], v[114:117], v[84:91], v181
ds_read_b128 v[96:99], v1 offset:12288
v_add_u32_sdwa v102, s42, v131 dst_sel:DWORD dst_unused:UNUSED_PAD src0_sel:DWORD src1_sel:WORD_0
v_smfmac_f32_16x16x64_bf16 v[20:23], a[84:87], v[60:67], v147 abid:1
ds_read_u16 v100, v100
v_add_u32_sdwa v103, s42, v131 dst_sel:DWORD dst_unused:UNUSED_PAD src0_sel:DWORD src1_sel:WORD_1
v_smfmac_f32_16x16x64_bf16 v[20:23], a[120:123], v[68:75], v151 abid:1
ds_read_u16 v82, v82
v_add_u32_sdwa v104, s42, v132 dst_sel:DWORD dst_unused:UNUSED_PAD src0_sel:DWORD src1_sel:WORD_0
v_smfmac_f32_16x16x64_bf16 v[36:39], a[100:103], v[60:67], v149 abid:1
ds_read_u16 v101, v101
v_add_u32_sdwa v105, s42, v132 dst_sel:DWORD dst_unused:UNUSED_PAD src0_sel:DWORD src1_sel:WORD_1
v_smfmac_f32_16x16x64_bf16 v[36:39], a[136:139], v[68:75], v153 abid:1
buffer_store_dwordx2 v[112:113], v5, s[20:23], s46 offen
ds_read_u16 v83, v83
v_add_u32_sdwa v106, s42, v133 dst_sel:DWORD dst_unused:UNUSED_PAD src0_sel:DWORD src1_sel:WORD_0
v_smfmac_f32_16x16x64_bf16 v[40:43], a[104:107], v[60:67], v175
s_mov_b32 s22, 75497472
ds_read_b128 v[114:117], v2 offset:192
v_add_u32_sdwa v107, s42, v133 dst_sel:DWORD dst_unused:UNUSED_PAD src0_sel:DWORD src1_sel:WORD_1
v_smfmac_f32_16x16x64_bf16 v[40:43], a[140:143], v[68:75], v175 abid:1
s_waitcnt lgkmcnt(12)
ds_read_u16 v102, v102
v_add_u32_sdwa v84, s42, v134 dst_sel:DWORD dst_unused:UNUSED_PAD src0_sel:DWORD src1_sel:WORD_0
v_smfmac_f32_16x16x64_bf16 v[8:11], a[144:147], v[44:51], v154
s_waitcnt lgkmcnt(9)
ds_read_u16 v103, v103
v_add_u32_sdwa v85, s42, v134 dst_sel:DWORD dst_unused:UNUSED_PAD src0_sel:DWORD src1_sel:WORD_1
v_smfmac_f32_16x16x64_bf16 v[8:11], a[180:183], v[52:59], v158
s_waitcnt lgkmcnt(7)
ds_read_u16 v104, v104
v_add_u32_sdwa v86, s42, v135 dst_sel:DWORD dst_unused:UNUSED_PAD src0_sel:DWORD src1_sel:WORD_0
v_smfmac_f32_16x16x64_bf16 v[8:11], a[216:219], v[92:99], v162
s_mov_b32 s46, s48
ds_read_u16 v105, v105
v_add_u32_sdwa v87, s42, v135 dst_sel:DWORD dst_unused:UNUSED_PAD src0_sel:DWORD src1_sel:WORD_1
v_smfmac_f32_16x16x64_bf16 v[24:27], a[160:163], v[44:51], v156
s_mov_b32 s48, s49
ds_read_u16 v106, v106
v_add_u32_sdwa v88, s42, v136 dst_sel:DWORD dst_unused:UNUSED_PAD src0_sel:DWORD src1_sel:WORD_0
v_smfmac_f32_16x16x64_bf16 v[24:27], a[196:199], v[52:59], v160
s_mov_b32 s49, s50
s_add_u32 s50, s50, 4718592
v_add_u32_sdwa v89, s42, v136 dst_sel:DWORD dst_unused:UNUSED_PAD src0_sel:DWORD src1_sel:WORD_1
v_smfmac_f32_16x16x64_bf16 v[24:27], a[232:235], v[92:99], v164
s_waitcnt lgkmcnt(5)
ds_read_u16 v107, v107
v_add_u32_sdwa v90, s42, v137 dst_sel:DWORD dst_unused:UNUSED_PAD src0_sel:DWORD src1_sel:WORD_0
v_smfmac_f32_16x16x64_bf16 v[24:27], v[114:117], v[76:83], v182
ds_read_u16 v84, v84
v_add_u32_sdwa v91, s42, v137 dst_sel:DWORD dst_unused:UNUSED_PAD src0_sel:DWORD src1_sel:WORD_1
v_smfmac_f32_16x16x64_bf16 v[28:31], v[114:117], v[76:83], v182 abid:1
ds_read_b128 v[114:117], v2 offset:256
v_add_u32_sdwa v76, s4, v118 dst_sel:DWORD dst_unused:UNUSED_PAD src0_sel:DWORD src1_sel:WORD_0
v_smfmac_f32_16x16x64_bf16 v[28:31], a[164:167], v[44:51], v156 abid:1
ds_read_u16 v85, v85
v_add_u32_sdwa v77, s4, v118 dst_sel:DWORD dst_unused:UNUSED_PAD src0_sel:DWORD src1_sel:WORD_1
v_smfmac_f32_16x16x64_bf16 v[28:31], a[200:203], v[52:59], v160 abid:1
ds_read_u16 v86, v86
v_add_u32_sdwa v78, s4, v119 dst_sel:DWORD dst_unused:UNUSED_PAD src0_sel:DWORD src1_sel:WORD_0
v_smfmac_f32_16x16x64_bf16 v[28:31], a[236:239], v[92:99], v164 abid:1
ds_read_u16 v87, v87
v_add_u32_sdwa v79, s4, v119 dst_sel:DWORD dst_unused:UNUSED_PAD src0_sel:DWORD src1_sel:WORD_1
v_smfmac_f32_16x16x64_bf16 v[12:15], a[148:151], v[44:51], v154 abid:1
ds_read_u16 v88, v88
v_add_u32_sdwa v80, s4, v120 dst_sel:DWORD dst_unused:UNUSED_PAD src0_sel:DWORD src1_sel:WORD_0
v_smfmac_f32_16x16x64_bf16 v[12:15], a[184:187], v[52:59], v158 abid:1
v_add_u32_sdwa v81, s4, v120 dst_sel:DWORD dst_unused:UNUSED_PAD src0_sel:DWORD src1_sel:WORD_1
v_smfmac_f32_16x16x64_bf16 v[12:15], a[220:223], v[92:99], v162 abid:1
ds_read_b128 v[60:63], v0 offset:14336
v_add_u32_sdwa v82, s4, v121 dst_sel:DWORD dst_unused:UNUSED_PAD src0_sel:DWORD src1_sel:WORD_0
v_smfmac_f32_16x16x64_bf16 v[32:35], a[168:171], v[44:51], v157
ds_read_u16 v89, v89
v_add_u32_sdwa v83, s4, v121 dst_sel:DWORD dst_unused:UNUSED_PAD src0_sel:DWORD src1_sel:WORD_1
v_smfmac_f32_16x16x64_bf16 v[32:35], a[204:207], v[52:59], v161
ds_read_b128 v[64:67], v1 offset:14336
v_smfmac_f32_16x16x64_bf16 v[32:35], a[240:243], v[92:99], v165
s_waitcnt lgkmcnt(7)
ds_read_b128 v[68:71], v0 offset:16384
v_smfmac_f32_16x16x64_bf16 v[32:35], v[114:117], v[100:107], v183 abid:1
ds_read_u16 v90, v90
v_smfmac_f32_16x16x64_bf16 v[36:39], v[114:117], v[100:107], v184
ds_read_b128 v[72:75], v1 offset:16384
v_add_u32 v0, s43, v0
v_smfmac_f32_16x16x64_bf16 v[36:39], a[172:175], v[44:51], v157 abid:1
ds_read_u16 v91, v91
v_add_u32 v1, s43, v1
v_smfmac_f32_16x16x64_bf16 v[36:39], a[208:211], v[52:59], v161 abid:1
v_smfmac_f32_16x16x64_bf16 v[36:39], a[244:247], v[92:99], v165 abid:1
ds_read_b128 v[114:117], v2 offset:320
v_smfmac_f32_16x16x64_bf16 v[16:19], a[152:155], v[44:51], v155
v_smfmac_f32_16x16x64_bf16 v[16:19], a[188:191], v[52:59], v159
v_smfmac_f32_16x16x64_bf16 v[16:19], a[224:227], v[92:99], v163
v_smfmac_f32_16x16x64_bf16 v[20:23], a[156:159], v[44:51], v155 abid:1
v_smfmac_f32_16x16x64_bf16 v[20:23], a[192:195], v[52:59], v159 abid:1
v_smfmac_f32_16x16x64_bf16 v[20:23], a[228:231], v[92:99], v163 abid:1
v_smfmac_f32_16x16x64_bf16 v[40:43], a[176:179], v[44:51], v176
s_bitcmp1_b32 s92, s41
v_smfmac_f32_16x16x64_bf16 v[40:43], a[212:215], v[52:59], v176 abid:1
s_cbranch_scc1 L_loopn_w
L_loopn_wb:
v_smfmac_f32_16x16x64_bf16 v[40:43], a[248:251], v[92:99], v177
s_waitcnt lgkmcnt(0)
v_smfmac_f32_16x16x64_bf16 v[40:43], v[114:117], v[84:91], v185
s_waitcnt vmcnt(20)
s_barrier
L_loopn_p3:
v_smfmac_f32_16x16x64_bf16 v[8:11], a[252:255], v[60:67], v166
s_mov_b32 s42, s4
v_smfmac_f32_16x16x64_bf16 v[8:11], v[218:221], v[68:75], v170
ds_read_b128 v[44:47], v0 offset:0
v_add_u32_sdwa v84, s42, v122 dst_sel:DWORD dst_unused:UNUSED_PAD src0_sel:DWORD src1_sel:WORD_0
v_smfmac_f32_16x16x64_bf16 v[12:15], v[186:189], v[60:67], v166 abid:1
ds_read_b128 v[48:51], v1 offset:0
v_add_u32_sdwa v85, s42, v122 dst_sel:DWORD dst_unused:UNUSED_PAD src0_sel:DWORD src1_sel:WORD_1
v_smfmac_f32_16x16x64_bf16 v[12:15], v[222:225], v[68:75], v170 abid:1
ds_read_b128 v[52:55], v0 offset:2048
v_add_u32_sdwa v86, s42, v123 dst_sel:DWORD dst_unused:UNUSED_PAD src0_sel:DWORD src1_sel:WORD_0
v_smfmac_f32_16x16x64_bf16 v[16:19], v[190:193], v[60:67], v167
ds_read_b128 v[56:59], v1 offset:2048
v_cvt_pk_bf16_f32 v92, v8, v9
v_smfmac_f32_16x16x64_bf16 v[16:19], v[226:229], v[68:75], v171
ds_read_u16 v76, v76
v_cvt_pk_bf16_f32 v93, v10, v11
v_smfmac_f32_16x16x64_bf16 v[20:23], v[194:197], v[60:67], v167 abid:1
ds_read_b128 v[8:11], v2 offset:1024
v_cvt_pk_bf16_f32 v94, v12, v13
v_smfmac_f32_16x16x64_bf16 v[20:23], v[230:233], v[68:75], v171 abid:1
ds_read_u16 v77, v77
v_cvt_pk_bf16_f32 v95, v14, v15
v_smfmac_f32_16x16x64_bf16 v[24:27], v[198:201], v[60:67], v168
ds_read_b128 v[12:15], v2 offset:1088
v_cvt_pk_bf16_f32 v96, v16, v17
v_smfmac_f32_16x16x64_bf16 v[24:27], v[234:237], v[68:75], v172
ds_read_u16 v78, v78
v_cvt_pk_bf16_f32 v97, v18, v19
v_smfmac_f32_16x16x64_bf16 v[28:31], v[202:205], v[60:67], v168 abid:1
ds_read_b128 v[16:19], v2 offset:1152
v_cvt_pk_bf16_f32 v98, v20, v21
v_smfmac_f32_16x16x64_bf16 v[28:31], v[238:241], v[68:75], v172 abid:1
ds_read_u16 v79, v79
v_cvt_pk_bf16_f32 v99, v22, v23
v_smfmac_f32_16x16x64_bf16 v[32:35], v[206:209], v[60:67], v169
ds_read_b128 v[20:23], v2 offset:1216
v_cvt_pk_bf16_f32 v100, v24, v25
v_smfmac_f32_16x16x64_bf16 v[32:35], v[242:245], v[68:75], v173
ds_read_u16 v80, v80
v_cvt_pk_bf16_f32 v101, v26, v27
v_smfmac_f32_16x16x64_bf16 v[36:39], v[210:213], v[60:67], v169 abid:1
ds_read_b128 v[24:27], v2 offset:1280
v_cvt_pk_bf16_f32 v102, v28, v29
v_smfmac_f32_16x16x64_bf16 v[36:39], v[246:249], v[68:75], v173 abid:1
ds_read_u16 v81, v81
v_cvt_pk_bf16_f32 v103, v30, v31
v_smfmac_f32_16x16x64_bf16 v[40:43], v[214:217], v[60:67], v177 abid:1
s_bitcmp1_b32 s12, s41
ds_read_b128 v[28:31], v2 offset:1344
v_cvt_pk_bf16_f32 v104, v32, v33
v_smfmac_f32_16x16x64_bf16 v[40:43], v[250:253], v[68:75], v178
s_waitcnt lgkmcnt(10)
v_cvt_pk_bf16_f32 v105, v34, v35
s_cbranch_scc1 L_loopn
s_cmp_eq_u32 s41, s59
s_cbranch_scc1 L_loopc
s_cmp_lt_u32 s41, s15
s_cbranch_scc1 L_loop
s_nop 0
v_cndmask_b32_dpp v108, v96, v92, vcc quad_perm:[1,0,3,2] row_mask:0xf bank_mask:0xf
v_cndmask_b32_dpp v109, v97, v93, vcc quad_perm:[1,0,3,2] row_mask:0xf bank_mask:0xf
v_cndmask_b32_dpp v110, v98, v94, vcc quad_perm:[1,0,3,2] row_mask:0xf bank_mask:0xf
v_cndmask_b32_dpp v111, v99, v95, vcc quad_perm:[1,0,3,2] row_mask:0xf bank_mask:0xf
buffer_store_dwordx4 v[108:111], v4, s[20:23], s46 offen offset:0 sc1
s_mov_b64 vcc, s[82:83]
v_cvt_pk_bf16_f32 v112, v40, v41
v_cvt_pk_bf16_f32 v113, v42, v43
ds_bpermute_b32 v112, v6, v112
ds_bpermute_b32 v113, v6, v113
v_cndmask_b32_dpp v96, v92, v96, vcc quad_perm:[1,0,3,2] row_mask:0xf bank_mask:0xf
v_cndmask_b32_dpp v97, v93, v97, vcc quad_perm:[1,0,3,2] row_mask:0xf bank_mask:0xf
v_cndmask_b32_dpp v98, v94, v98, vcc quad_perm:[1,0,3,2] row_mask:0xf bank_mask:0xf
v_cndmask_b32_dpp v99, v95, v99, vcc quad_perm:[1,0,3,2] row_mask:0xf bank_mask:0xf
buffer_store_dwordx4 v[96:99], v4, s[20:23], s46 offen offset:1152 sc1
s_mov_b64 vcc, s[80:81]
v_cvt_pk_bf16_f32 v106, v36, v37
v_cvt_pk_bf16_f32 v107, v38, v39
v_cndmask_b32_dpp v92, v104, v100, vcc quad_perm:[1,0,3,2] row_mask:0xf bank_mask:0xf
v_cndmask_b32_dpp v93, v105, v101, vcc quad_perm:[1,0,3,2] row_mask:0xf bank_mask:0xf
v_cndmask_b32_dpp v94, v106, v102, vcc quad_perm:[1,0,3,2] row_mask:0xf bank_mask:0xf
v_cndmask_b32_dpp v95, v107, v103, vcc quad_perm:[1,0,3,2] row_mask:0xf bank_mask:0xf
buffer_store_dwordx4 v[92:95], v4, s[20:23], s46 offen offset:128 sc1
s_mov_b64 vcc, s[82:83]
v_cndmask_b32_dpp v104, v100, v104, vcc quad_perm:[1,0,3,2] row_mask:0xf bank_mask:0xf
v_cndmask_b32_dpp v105, v101, v105, vcc quad_perm:[1,0,3,2] row_mask:0xf bank_mask:0xf
v_cndmask_b32_dpp v106, v102, v106, vcc quad_perm:[1,0,3,2] row_mask:0xf bank_mask:0xf
v_cndmask_b32_dpp v107, v103, v107, vcc quad_perm:[1,0,3,2] row_mask:0xf bank_mask:0xf
buffer_store_dwordx4 v[104:107], v4, s[20:23], s46 offen offset:1280 sc1
s_mov_b64 vcc, s[80:81]
s_waitcnt lgkmcnt(0)
buffer_store_dwordx2 v[112:113], v5, s[20:23], s46 offen
L_fin:
L_end_standalone__structured_sparse_n_m__ragged_kernel:
s_endpgm
L_more1:
v_and_b32 v73, v94, v16
v_lshrrev_b32 v72, 10, v16
v_cmp_eq_u32 s[64:65], v73, v95
v_and_or_b32 v32, v72, v96, v97
s_mov_b64 exec, s[64:65]
ds_add_rtn_u32 v48, v32, v88
s_mov_b64 exec, -1
v_and_b32 v73, v94, v17
v_lshrrev_b32 v72, 10, v17
v_cmp_eq_u32 s[66:67], v73, v95
v_and_or_b32 v33, v72, v96, v97
s_mov_b64 exec, s[66:67]
ds_add_rtn_u32 v49, v33, v88
s_mov_b64 exec, -1
v_and_b32 v73, v94, v18
v_lshrrev_b32 v72, 10, v18
v_cmp_eq_u32 s[68:69], v73, v95
v_and_or_b32 v34, v72, v96, v97
s_mov_b64 exec, s[68:69]
ds_add_rtn_u32 v50, v34, v88
s_mov_b64 exec, -1
v_and_b32 v73, v94, v19
v_lshrrev_b32 v72, 10, v19
v_cmp_eq_u32 s[70:71], v73, v95
v_and_or_b32 v35, v72, v96, v97
s_mov_b64 exec, s[70:71]
ds_add_rtn_u32 v51, v35, v88
s_mov_b64 exec, -1
v_and_b32 v73, v94, v20
v_lshrrev_b32 v72, 10, v20
v_cmp_eq_u32 s[72:73], v73, v95
v_and_or_b32 v36, v72, v96, v97
s_mov_b64 exec, s[72:73]
ds_add_rtn_u32 v52, v36, v88
s_mov_b64 exec, -1
v_and_b32 v73, v94, v21
v_lshrrev_b32 v72, 10, v21
v_cmp_eq_u32 s[74:75], v73, v95
v_and_or_b32 v37, v72, v96, v97
s_mov_b64 exec, s[74:75]
ds_add_rtn_u32 v53, v37, v88
s_mov_b64 exec, -1
v_and_b32 v73, v94, v22
v_lshrrev_b32 v72, 10, v22
v_cmp_eq_u32 s[76:77], v73, v95
v_and_or_b32 v38, v72, v96, v97
s_mov_b64 exec, s[76:77]
ds_add_rtn_u32 v54, v38, v88
s_mov_b64 exec, -1
s_branch L_more1b
L_greedy:
s_mov_b32 s47, 0
s_mov_b32 s89, 1
v_readlane_b32 s3, v72, 0
s_max_u32 s47, s47, 0
v_writelane_b32 v91, s47, 0
s_nop 1
s_add_u32 s47, s47, s3
s_cmp_gt_u32 s47, 32
s_cselect_b32 s90, 1, s90
v_readlane_b32 s3, v72, 1
s_max_u32 s47, s47, 0
v_writelane_b32 v91, s47, 1
s_nop 1
s_add_u32 s47, s47, s3
s_cmp_gt_u32 s47, 64
s_cselect_b32 s90, 1, s90
v_readlane_b32 s3, v72, 2
s_max_u32 s47, s47, 32
v_writelane_b32 v91, s47, 2
s_nop 1
s_add_u32 s47, s47, s3
s_cmp_gt_u32 s47, 64
s_cselect_b32 s90, 1, s90
v_readlane_b32 s3, v72, 3
s_max_u32 s47, s47, 32
v_writelane_b32 v91, s47, 3
s_nop 1
s_add_u32 s47, s47, s3
s_cmp_gt_u32 s47, 96
s_cselect_b32 s90, 1, s90
v_readlane_b32 s3, v72, 4
s_max_u32 s47, s47, 64
v_writelane_b32 v91, s47, 4
s_nop 1
s_add_u32 s47, s47, s3
s_cmp_gt_u32 s47, 96
s_cselect_b32 s90, 1, s90
v_readlane_b32 s3, v72, 5
s_max_u32 s47, s47, 64
v_writelane_b32 v91, s47, 5
s_nop 1
s_add_u32 s47, s47, s3
s_cmp_gt_u32 s47, 128
s_cselect_b32 s90, 1, s90
v_readlane_b32 s3, v72, 6
s_max_u32 s47, s47, 96
v_writelane_b32 v91, s47, 6
s_nop 1
s_add_u32 s47, s47, s3
s_cmp_gt_u32 s47, 128
s_cselect_b32 s90, 1, s90
v_readlane_b32 s3, v72, 7
s_max_u32 s47, s47, 96
v_writelane_b32 v91, s47, 7
s_nop 1
s_add_u32 s47, s47, s3
s_cmp_gt_u32 s47, 160
s_cselect_b32 s90, 1, s90
v_readlane_b32 s3, v72, 8
s_max_u32 s47, s47, 128
v_writelane_b32 v91, s47, 8
s_nop 1
s_add_u32 s47, s47, s3
s_cmp_gt_u32 s47, 160
s_cselect_b32 s90, 1, s90
s_cmp_lg_u32 s90, 0
s_cselect_b64 s[90:91], -1, 0
v_mov_b32 v73, 163072
s_mov_b64 exec, s[90:91]
ds_write_b32 v73, v88
s_mov_b64 exec, -1
s_branch L_greedyb
L_more2:
ds_bpermute_b32 v64, v32, v91
ds_bpermute_b32 v65, v33, v91
ds_bpermute_b32 v66, v34, v91
ds_bpermute_b32 v67, v35, v91
ds_bpermute_b32 v68, v36, v91
ds_bpermute_b32 v69, v37, v91
ds_bpermute_b32 v70, v38, v91
s_waitcnt lgkmcnt(0)
v_add_u32 v73, v48, v64
v_and_b32 v72, 0x87e, v16
v_lshl_add_u32 v73, v73, 1, s93
v_add_u32 v72, v90, v72
s_andn2_b64 exec, s[64:65], s[90:91]
ds_write_b16_d16_hi v73, v16 offset:64
ds_write_b16 v73, v72 offset:384
ds_write_b16 v73, v16 offset:704
s_mov_b64 exec, -1
v_add_u32 v73, v49, v65
v_and_b32 v72, 0x87e, v17
v_lshl_add_u32 v73, v73, 1, s93
v_add_u32 v72, v90, v72
s_andn2_b64 exec, s[66:67], s[90:91]
ds_write_b16_d16_hi v73, v17 offset:64
ds_write_b16 v73, v72 offset:384
ds_write_b16 v73, v17 offset:704
s_mov_b64 exec, -1
v_add_u32 v73, v50, v66
v_and_b32 v72, 0x87e, v18
v_lshl_add_u32 v73, v73, 1, s93
v_add_u32 v72, v90, v72
s_andn2_b64 exec, s[68:69], s[90:91]
ds_write_b16_d16_hi v73, v18 offset:64
ds_write_b16 v73, v72 offset:384
ds_write_b16 v73, v18 offset:704
s_mov_b64 exec, -1
v_add_u32 v73, v51, v67
v_and_b32 v72, 0x87e, v19
v_lshl_add_u32 v73, v73, 1, s93
v_add_u32 v72, v90, v72
s_andn2_b64 exec, s[70:71], s[90:91]
ds_write_b16_d16_hi v73, v19 offset:64
ds_write_b16 v73, v72 offset:384
ds_write_b16 v73, v19 offset:704
s_mov_b64 exec, -1
v_add_u32 v73, v52, v68
v_and_b32 v72, 0x87e, v20
v_lshl_add_u32 v73, v73, 1, s93
v_add_u32 v72, v90, v72
s_andn2_b64 exec, s[72:73], s[90:91]
ds_write_b16_d16_hi v73, v20 offset:64
ds_write_b16 v73, v72 offset:384
ds_write_b16 v73, v20 offset:704
s_mov_b64 exec, -1
v_add_u32 v73, v53, v69
v_and_b32 v72, 0x87e, v21
v_lshl_add_u32 v73, v73, 1, s93
v_add_u32 v72, v90, v72
s_andn2_b64 exec, s[74:75], s[90:91]
ds_write_b16_d16_hi v73, v21 offset:64
ds_write_b16 v73, v72 offset:384
ds_write_b16 v73, v21 offset:704
s_mov_b64 exec, -1
v_add_u32 v73, v54, v70
v_and_b32 v72, 0x87e, v22
v_lshl_add_u32 v73, v73, 1, s93
v_add_u32 v72, v90, v72
s_andn2_b64 exec, s[76:77], s[90:91]
ds_write_b16_d16_hi v73, v22 offset:64
ds_write_b16 v73, v72 offset:384
ds_write_b16 v73, v22 offset:704
s_mov_b64 exec, -1
s_branch L_more2b
L_cwait:
buffer_load_dword v8, off, s[36:39], 0 sc1
s_sub_u32 s3, s3, 1
s_cbranch_scc1 L_giveup
s_waitcnt vmcnt(0)
v_readfirstlane_b32 s47, v8
s_nop 3
s_cmp_lg_u32 s47, 1
s_cbranch_scc1 L_cwait
s_branch L_poll
L_giveup:
s_waitcnt vmcnt(0)
v_mov_b32 v8, 163072
v_mov_b32 v9, 1
ds_write_b32 v8, v9
s_branch L_polled
L_loop_w:
s_bitcmp1_b32 s87, s41
s_waitcnt vmcnt(15)
s_cbranch_scc0 L_loop_wb
s_waitcnt vmcnt(10)
s_branch L_loop_wb
L_loopn_w:
s_bitcmp1_b32 s87, s41
s_waitcnt vmcnt(15)
s_cbranch_scc0 L_loopn_wb
s_waitcnt vmcnt(10)
s_branch L_loopn_wb
L_linked:
.p2align 6
L_loopk:
v_smfmac_f32_16x16x64_bf16 v[8:11], a[0:3], v[44:51], v138
ds_read_b128 v[32:35], v2 offset:1408
v_cvt_pk_bf16_f32 v106, v36, v37
v_smfmac_f32_16x16x64_bf16 v[8:11], a[36:39], v[52:59], v142
s_waitcnt lgkmcnt(9)
v_cvt_pk_bf16_f32 v107, v38, v39
v_smfmac_f32_16x16x64_bf16 v[12:15], a[4:7], v[44:51], v138 abid:1
ds_read_b128 v[36:39], v2 offset:1472
v_cvt_pk_bf16_f32 v112, v40, v41
v_smfmac_f32_16x16x64_bf16 v[12:15], a[40:43], v[52:59], v142 abid:1
s_waitcnt lgkmcnt(8)
ds_read_b128 v[60:63], v0 offset:4096
v_cvt_pk_bf16_f32 v113, v42, v43
v_smfmac_f32_16x16x64_bf16 v[16:19], a[8:11], v[44:51], v139
s_cmp_eq_u32 s4, 129920
ds_read_b128 v[40:43], v2 offset:1536
v_cndmask_b32_dpp v108, v96, v92, vcc quad_perm:[1,0,3,2] row_mask:0xf bank_mask:0xf
v_smfmac_f32_16x16x64_bf16 v[16:19], a[44:47], v[52:59], v143
s_waitcnt lgkmcnt(8)
ds_read_u16 v82, v82
v_cndmask_b32_dpp v109, v97, v93, vcc quad_perm:[1,0,3,2] row_mask:0xf bank_mask:0xf
v_smfmac_f32_16x16x64_bf16 v[20:23], a[12:15], v[44:51], v139 abid:1
s_cselect_b32 s43, -129920, s5
ds_read_u16 v84, v84
v_cndmask_b32_dpp v110, v98, v94, vcc quad_perm:[1,0,3,2] row_mask:0xf bank_mask:0xf
v_smfmac_f32_16x16x64_bf16 v[20:23], a[48:51], v[52:59], v143 abid:1
s_waitcnt lgkmcnt(8)
ds_read_b128 v[64:67], v1 offset:4096
v_cndmask_b32_dpp v111, v99, v95, vcc quad_perm:[1,0,3,2] row_mask:0xf bank_mask:0xf
v_smfmac_f32_16x16x64_bf16 v[24:27], a[16:19], v[44:51], v140
s_add_u32 s4, s4, s43
ds_read_b128 v[68:71], v0 offset:6144
v_add_u32_sdwa v87, s42, v123 dst_sel:DWORD dst_unused:UNUSED_PAD src0_sel:DWORD src1_sel:WORD_1
v_smfmac_f32_16x16x64_bf16 v[24:27], a[52:55], v[52:59], v144
buffer_store_dwordx4 v[108:111], v4, s[20:23], s46 offen offset:0 sc1
s_mov_b64 vcc, s[82:83]
s_waitcnt lgkmcnt(8)
ds_read_b128 v[72:75], v1 offset:6144
v_cndmask_b32_dpp v96, v92, v96, vcc quad_perm:[1,0,3,2] row_mask:0xf bank_mask:0xf
v_cndmask_b32_dpp v97, v93, v97, vcc quad_perm:[1,0,3,2] row_mask:0xf bank_mask:0xf
v_smfmac_f32_16x16x64_bf16 v[28:31], a[20:23], v[44:51], v140 abid:1
s_add_u32 s41, s41, 1
ds_read_u16 v83, v83
v_cndmask_b32_dpp v98, v94, v98, vcc quad_perm:[1,0,3,2] row_mask:0xf bank_mask:0xf
v_smfmac_f32_16x16x64_bf16 v[28:31], a[56:59], v[52:59], v144 abid:1
s_waitcnt lgkmcnt(9)
ds_read_b128 v[114:117], v2 offset:64
v_cndmask_b32_dpp v99, v95, v99, vcc quad_perm:[1,0,3,2] row_mask:0xf bank_mask:0xf
v_smfmac_f32_16x16x64_bf16 v[32:35], a[24:27], v[44:51], v141
ds_read_u16 v85, v85
v_add_u32_sdwa v88, s42, v124 dst_sel:DWORD dst_unused:UNUSED_PAD src0_sel:DWORD src1_sel:WORD_0
v_smfmac_f32_16x16x64_bf16 v[32:35], a[60:63], v[52:59], v145
s_waitcnt lgkmcnt(10)
ds_read_u16 v86, v86
v_add_u32_sdwa v89, s42, v124 dst_sel:DWORD dst_unused:UNUSED_PAD src0_sel:DWORD src1_sel:WORD_1
v_smfmac_f32_16x16x64_bf16 v[36:39], a[28:31], v[44:51], v141 abid:1
ds_read_u16 v87, v87
v_add_u32_sdwa v90, s42, v125 dst_sel:DWORD dst_unused:UNUSED_PAD src0_sel:DWORD src1_sel:WORD_0
v_smfmac_f32_16x16x64_bf16 v[36:39], a[64:67], v[52:59], v145 abid:1
s_waitcnt lgkmcnt(10)
ds_read_u16 v88, v88
v_add_u32_sdwa v91, s42, v125 dst_sel:DWORD dst_unused:UNUSED_PAD src0_sel:DWORD src1_sel:WORD_1
v_smfmac_f32_16x16x64_bf16 v[40:43], a[32:35], v[44:51], v174
buffer_store_dwordx4 v[96:99], v4, s[20:23], s46 offen offset:1152 sc1
s_mov_b64 vcc, s[80:81]
ds_read_u16 v89, v89
v_cndmask_b32_dpp v92, v104, v100, vcc quad_perm:[1,0,3,2] row_mask:0xf bank_mask:0xf
v_cndmask_b32_dpp v93, v105, v101, vcc quad_perm:[1,0,3,2] row_mask:0xf bank_mask:0xf
v_smfmac_f32_16x16x64_bf16 v[40:43], a[68:71], v[52:59], v174 abid:1
s_waitcnt lgkmcnt(9)
ds_read_u16 v90, v90
v_cndmask_b32_dpp v94, v106, v102, vcc quad_perm:[1,0,3,2] row_mask:0xf bank_mask:0xf
v_smfmac_f32_16x16x64_bf16 v[8:11], a[72:75], v[60:67], v146
s_waitcnt lgkmcnt(8)
ds_read_u16 v91, v91
v_cndmask_b32_dpp v95, v107, v103, vcc quad_perm:[1,0,3,2] row_mask:0xf bank_mask:0xf
v_smfmac_f32_16x16x64_bf16 v[8:11], a[108:111], v[68:75], v150
s_waitcnt lgkmcnt(7)
ds_bpermute_b32 v112, v6, v112
v_smfmac_f32_16x16x64_bf16 v[8:11], v[114:117], v[76:83], v179
s_waitcnt vmcnt(2)
ds_bpermute_b32 v113, v6, v113
v_smfmac_f32_16x16x64_bf16 v[12:15], v[114:117], v[76:83], v179 abid:1
ds_read_b128 v[114:117], v2 offset:128
v_add_u32_sdwa v76, s42, v126 dst_sel:DWORD dst_unused:UNUSED_PAD src0_sel:DWORD src1_sel:WORD_0
v_smfmac_f32_16x16x64_bf16 v[12:15], a[76:79], v[60:67], v146 abid:1
ds_read_u16 v76, v76
v_add_u32_sdwa v77, s42, v126 dst_sel:DWORD dst_unused:UNUSED_PAD src0_sel:DWORD src1_sel:WORD_1
v_smfmac_f32_16x16x64_bf16 v[12:15], a[112:115], v[68:75], v150 abid:1
buffer_store_dwordx4 v[92:95], v4, s[20:23], s46 offen offset:128 sc1
s_mov_b64 vcc, s[82:83]
ds_read_u16 v77, v77
v_cndmask_b32_dpp v104, v100, v104, vcc quad_perm:[1,0,3,2] row_mask:0xf bank_mask:0xf
v_cndmask_b32_dpp v105, v101, v105, vcc quad_perm:[1,0,3,2] row_mask:0xf bank_mask:0xf
v_smfmac_f32_16x16x64_bf16 v[24:27], a[88:91], v[60:67], v148
ds_read_b128 v[44:47], v0 offset:8192
v_add_u32_sdwa v78, s42, v127 dst_sel:DWORD dst_unused:UNUSED_PAD src0_sel:DWORD src1_sel:WORD_0
v_smfmac_f32_16x16x64_bf16 v[24:27], a[124:127], v[68:75], v152
ds_read_u16 v78, v78
v_cndmask_b32_dpp v106, v102, v106, vcc quad_perm:[1,0,3,2] row_mask:0xf bank_mask:0xf
v_smfmac_f32_16x16x64_bf16 v[28:31], a[92:95], v[60:67], v148 abid:1
ds_read_b128 v[48:51], v1 offset:8192
v_cndmask_b32_dpp v107, v103, v107, vcc quad_perm:[1,0,3,2] row_mask:0xf bank_mask:0xf
v_smfmac_f32_16x16x64_bf16 v[28:31], a[128:131], v[68:75], v152 abid:1
ds_read_b128 v[52:55], v0 offset:10240
v_add_u32_sdwa v79, s42, v127 dst_sel:DWORD dst_unused:UNUSED_PAD src0_sel:DWORD src1_sel:WORD_1
v_smfmac_f32_16x16x64_bf16 v[32:35], a[96:99], v[60:67], v149
ds_read_u16 v79, v79
v_add_u32_sdwa v80, s42, v128 dst_sel:DWORD dst_unused:UNUSED_PAD src0_sel:DWORD src1_sel:WORD_0
v_smfmac_f32_16x16x64_bf16 v[32:35], a[132:135], v[68:75], v153
ds_read_u16 v80, v80
v_add_u32_sdwa v81, s42, v128 dst_sel:DWORD dst_unused:UNUSED_PAD src0_sel:DWORD src1_sel:WORD_1
v_smfmac_f32_16x16x64_bf16 v[16:19], a[80:83], v[60:67], v147
buffer_store_dwordx4 v[104:107], v4, s[20:23], s46 offen offset:1280 sc1
s_mov_b64 vcc, s[80:81]
ds_read_b128 v[56:59], v1 offset:10240
v_add_u32_sdwa v82, s42, v129 dst_sel:DWORD dst_unused:UNUSED_PAD src0_sel:DWORD src1_sel:WORD_0
v_add_u32_sdwa v83, s42, v129 dst_sel:DWORD dst_unused:UNUSED_PAD src0_sel:DWORD src1_sel:WORD_1
v_smfmac_f32_16x16x64_bf16 v[16:19], a[116:119], v[68:75], v151
s_waitcnt lgkmcnt(9)
ds_read_b128 v[92:95], v0 offset:12288
v_add_u32_sdwa v100, s42, v130 dst_sel:DWORD dst_unused:UNUSED_PAD src0_sel:DWORD src1_sel:WORD_0
v_smfmac_f32_16x16x64_bf16 v[16:19], v[114:117], v[84:91], v180 abid:1
ds_read_u16 v81, v81
v_add_u32_sdwa v101, s42, v130 dst_sel:DWORD dst_unused:UNUSED_PAD src0_sel:DWORD src1_sel:WORD_1
v_smfmac_f32_16x16x64_bf16 v[12:15], v[114:117], v[84:91], v180
ds_read_b128 v[96:99], v1 offset:12288
v_add_u32_sdwa v102, s42, v131 dst_sel:DWORD dst_unused:UNUSED_PAD src0_sel:DWORD src1_sel:WORD_0
v_smfmac_f32_16x16x64_bf16 v[20:23], v[114:117], v[84:91], v181
ds_read_u16 v82, v82
v_add_u32_sdwa v103, s42, v131 dst_sel:DWORD dst_unused:UNUSED_PAD src0_sel:DWORD src1_sel:WORD_1
v_smfmac_f32_16x16x64_bf16 v[20:23], a[84:87], v[60:67], v147 abid:1
ds_read_u16 v100, v100
v_add_u32_sdwa v104, s42, v132 dst_sel:DWORD dst_unused:UNUSED_PAD src0_sel:DWORD src1_sel:WORD_0
v_smfmac_f32_16x16x64_bf16 v[20:23], a[120:123], v[68:75], v151 abid:1
ds_read_u16 v83, v83
v_add_u32_sdwa v105, s42, v132 dst_sel:DWORD dst_unused:UNUSED_PAD src0_sel:DWORD src1_sel:WORD_1
v_smfmac_f32_16x16x64_bf16 v[36:39], a[100:103], v[60:67], v149 abid:1
buffer_store_dwordx2 v[112:113], v5, s[20:23], s46 offen
ds_read_b128 v[114:117], v2 offset:192
v_add_u32_sdwa v106, s42, v133 dst_sel:DWORD dst_unused:UNUSED_PAD src0_sel:DWORD src1_sel:WORD_0
v_smfmac_f32_16x16x64_bf16 v[36:39], a[136:139], v[68:75], v153 abid:1
s_mov_b32 s22, 75497472
ds_read_u16 v101, v101
v_add_u32_sdwa v107, s42, v133 dst_sel:DWORD dst_unused:UNUSED_PAD src0_sel:DWORD src1_sel:WORD_1
v_smfmac_f32_16x16x64_bf16 v[40:43], a[104:107], v[60:67], v175
s_mov_b32 s46, s48
ds_read_u16 v102, v102
v_add_u32_sdwa v84, s42, v134 dst_sel:DWORD dst_unused:UNUSED_PAD src0_sel:DWORD src1_sel:WORD_0
v_smfmac_f32_16x16x64_bf16 v[40:43], a[140:143], v[68:75], v175 abid:1
s_waitcnt lgkmcnt(13)
ds_read_u16 v103, v103
v_add_u32_sdwa v85, s42, v134 dst_sel:DWORD dst_unused:UNUSED_PAD src0_sel:DWORD src1_sel:WORD_1
v_smfmac_f32_16x16x64_bf16 v[8:11], a[144:147], v[44:51], v154
s_waitcnt lgkmcnt(10)
ds_read_u16 v104, v104
v_add_u32_sdwa v86, s42, v135 dst_sel:DWORD dst_unused:UNUSED_PAD src0_sel:DWORD src1_sel:WORD_0
v_smfmac_f32_16x16x64_bf16 v[8:11], a[180:183], v[52:59], v158
s_waitcnt lgkmcnt(8)
ds_read_u16 v105, v105
v_add_u32_sdwa v87, s42, v135 dst_sel:DWORD dst_unused:UNUSED_PAD src0_sel:DWORD src1_sel:WORD_1
v_smfmac_f32_16x16x64_bf16 v[8:11], a[216:219], v[92:99], v162
s_add_u32 m0, s44, 0
ds_read_u16 v106, v106
v_add_u32_sdwa v88, s42, v136 dst_sel:DWORD dst_unused:UNUSED_PAD src0_sel:DWORD src1_sel:WORD_0
v_smfmac_f32_16x16x64_bf16 v[24:27], a[160:163], v[44:51], v156
buffer_load_dwordx4 v3, s[16:19], s45 offen offset:0 nt lds
v_add_u32_sdwa v89, s42, v136 dst_sel:DWORD dst_unused:UNUSED_PAD src0_sel:DWORD src1_sel:WORD_1
v_smfmac_f32_16x16x64_bf16 v[24:27], a[196:199], v[52:59], v160
s_mov_b32 s48, s49
ds_read_u16 v107, v107
v_add_u32_sdwa v90, s42, v137 dst_sel:DWORD dst_unused:UNUSED_PAD src0_sel:DWORD src1_sel:WORD_0
v_smfmac_f32_16x16x64_bf16 v[24:27], a[232:235], v[92:99], v164
s_waitcnt lgkmcnt(7)
ds_read_u16 v84, v84
v_add_u32_sdwa v91, s42, v137 dst_sel:DWORD dst_unused:UNUSED_PAD src0_sel:DWORD src1_sel:WORD_1
v_smfmac_f32_16x16x64_bf16 v[24:27], v[114:117], v[76:83], v182
s_mov_b32 s49, s50
ds_read_u16 v85, v85
v_smfmac_f32_16x16x64_bf16 v[20:23], v[114:117], v[76:83], v181 abid:1
s_add_u32 s50, s50, 4718592
ds_read_u16 v86, v86
v_smfmac_f32_16x16x64_bf16 v[28:31], v[114:117], v[76:83], v182 abid:1
ds_read_b128 v[114:117], v2 offset:256
v_add_u32_sdwa v76, s4, v118 dst_sel:DWORD dst_unused:UNUSED_PAD src0_sel:DWORD src1_sel:WORD_0
v_smfmac_f32_16x16x64_bf16 v[28:31], a[164:167], v[44:51], v156 abid:1
ds_read_u16 v87, v87
v_add_u32_sdwa v77, s4, v118 dst_sel:DWORD dst_unused:UNUSED_PAD src0_sel:DWORD src1_sel:WORD_1
v_smfmac_f32_16x16x64_bf16 v[28:31], a[200:203], v[52:59], v160 abid:1
ds_read_u16 v88, v88
v_add_u32_sdwa v78, s4, v119 dst_sel:DWORD dst_unused:UNUSED_PAD src0_sel:DWORD src1_sel:WORD_0
v_smfmac_f32_16x16x64_bf16 v[28:31], a[236:239], v[92:99], v164 abid:1
ds_read_b128 v[60:63], v0 offset:14336
v_add_u32_sdwa v79, s4, v119 dst_sel:DWORD dst_unused:UNUSED_PAD src0_sel:DWORD src1_sel:WORD_1
v_smfmac_f32_16x16x64_bf16 v[12:15], a[148:151], v[44:51], v154 abid:1
ds_read_u16 v89, v89
v_add_u32_sdwa v80, s4, v120 dst_sel:DWORD dst_unused:UNUSED_PAD src0_sel:DWORD src1_sel:WORD_0
v_smfmac_f32_16x16x64_bf16 v[12:15], a[184:187], v[52:59], v158 abid:1
s_add_u32 m0, s44, 3840
ds_read_b128 v[64:67], v1 offset:14336
v_add_u32_sdwa v81, s4, v120 dst_sel:DWORD dst_unused:UNUSED_PAD src0_sel:DWORD src1_sel:WORD_1
v_smfmac_f32_16x16x64_bf16 v[12:15], a[220:223], v[92:99], v162 abid:1
buffer_load_dwordx4 v3, s[16:19], s45 offen offset:256 nt lds
v_add_u32_sdwa v82, s4, v121 dst_sel:DWORD dst_unused:UNUSED_PAD src0_sel:DWORD src1_sel:WORD_0
v_smfmac_f32_16x16x64_bf16 v[32:35], a[168:171], v[44:51], v157
ds_read_b128 v[68:71], v0 offset:16384
v_add_u32_sdwa v83, s4, v121 dst_sel:DWORD dst_unused:UNUSED_PAD src0_sel:DWORD src1_sel:WORD_1
v_smfmac_f32_16x16x64_bf16 v[32:35], a[204:207], v[52:59], v161
ds_read_u16 v90, v90
v_smfmac_f32_16x16x64_bf16 v[32:35], a[240:243], v[92:99], v165
s_waitcnt lgkmcnt(7)
ds_read_b128 v[72:75], v1 offset:16384
v_add_u32 v0, s43, v0
v_smfmac_f32_16x16x64_bf16 v[32:35], v[114:117], v[100:107], v183 abid:1
ds_read_u16 v91, v91
v_add_u32 v1, s43, v1
v_smfmac_f32_16x16x64_bf16 v[28:31], v[114:117], v[100:107], v183
v_smfmac_f32_16x16x64_bf16 v[36:39], v[114:117], v[100:107], v184
ds_read_b128 v[114:117], v2 offset:320
v_smfmac_f32_16x16x64_bf16 v[36:39], a[172:175], v[44:51], v157 abid:1
s_add_u32 m0, s44, 7680
v_smfmac_f32_16x16x64_bf16 v[36:39], a[208:211], v[52:59], v161 abid:1
buffer_load_dwordx4 v3, s[16:19], s45 offen offset:512 nt lds
v_smfmac_f32_16x16x64_bf16 v[36:39], a[244:247], v[92:99], v165 abid:1
v_smfmac_f32_16x16x64_bf16 v[16:19], a[152:155], v[44:51], v155
s_add_u32 m0, s44, 11520
v_smfmac_f32_16x16x64_bf16 v[16:19], a[188:191], v[52:59], v159
buffer_load_dwordx4 v3, s[16:19], s45 offen offset:768 nt lds
v_smfmac_f32_16x16x64_bf16 v[16:19], a[224:227], v[92:99], v163
v_smfmac_f32_16x16x64_bf16 v[20:23], a[156:159], v[44:51], v155 abid:1
s_add_u32 m0, s44, s8
v_smfmac_f32_16x16x64_bf16 v[20:23], a[192:195], v[52:59], v159 abid:1
s_mov_b64 exec, s[10:11]
buffer_load_dwordx4 v3, s[16:19], s7 offen offset:896 nt lds
s_mov_b64 exec, -1
v_smfmac_f32_16x16x64_bf16 v[20:23], a[228:231], v[92:99], v163 abid:1
s_add_u32 s45, s45, 4718592
s_add_u32 s7, s7, 4718592
s_add_u32 s44, s44, s5
v_smfmac_f32_16x16x64_bf16 v[40:43], a[176:179], v[44:51], v176
s_cmp_ge_u32 s44, 148480
s_cselect_b32 s44, s9, s44
s_bitcmp1_b32 s92, s41
v_smfmac_f32_16x16x64_bf16 v[40:43], a[212:215], v[52:59], v176 abid:1
s_cbranch_scc1 L_loopk_w
L_loopk_wb:
v_smfmac_f32_16x16x64_bf16 v[40:43], a[248:251], v[92:99], v177
s_waitcnt lgkmcnt(0)
v_smfmac_f32_16x16x64_bf16 v[40:43], v[114:117], v[84:91], v185
v_smfmac_f32_16x16x64_bf16 v[36:39], v[114:117], v[84:91], v184 abid:1
s_waitcnt vmcnt(20)
s_barrier
v_smfmac_f32_16x16x64_bf16 v[8:11], a[252:255], v[60:67], v166
s_mov_b32 s42, s4
v_smfmac_f32_16x16x64_bf16 v[8:11], v[218:221], v[68:75], v170
ds_read_b128 v[44:47], v0 offset:0
v_add_u32_sdwa v84, s42, v122 dst_sel:DWORD dst_unused:UNUSED_PAD src0_sel:DWORD src1_sel:WORD_0
v_smfmac_f32_16x16x64_bf16 v[12:15], v[186:189], v[60:67], v166 abid:1
ds_read_b128 v[48:51], v1 offset:0
v_add_u32_sdwa v85, s42, v122 dst_sel:DWORD dst_unused:UNUSED_PAD src0_sel:DWORD src1_sel:WORD_1
v_smfmac_f32_16x16x64_bf16 v[12:15], v[222:225], v[68:75], v170 abid:1
ds_read_b128 v[52:55], v0 offset:2048
v_add_u32_sdwa v86, s42, v123 dst_sel:DWORD dst_unused:UNUSED_PAD src0_sel:DWORD src1_sel:WORD_0
v_smfmac_f32_16x16x64_bf16 v[16:19], v[190:193], v[60:67], v167
ds_read_b128 v[56:59], v1 offset:2048
v_cvt_pk_bf16_f32 v92, v8, v9
v_smfmac_f32_16x16x64_bf16 v[16:19], v[226:229], v[68:75], v171
ds_read_u16 v76, v76
v_cvt_pk_bf16_f32 v93, v10, v11
v_smfmac_f32_16x16x64_bf16 v[20:23], v[194:197], v[60:67], v167 abid:1
ds_read_b128 v[8:11], v2 offset:1024
v_cvt_pk_bf16_f32 v94, v12, v13
v_smfmac_f32_16x16x64_bf16 v[20:23], v[230:233], v[68:75], v171 abid:1
ds_read_u16 v77, v77
v_cvt_pk_bf16_f32 v95, v14, v15
v_smfmac_f32_16x16x64_bf16 v[24:27], v[198:201], v[60:67], v168
ds_read_b128 v[12:15], v2 offset:1088
v_cvt_pk_bf16_f32 v96, v16, v17
v_smfmac_f32_16x16x64_bf16 v[24:27], v[234:237], v[68:75], v172
ds_read_u16 v78, v78
v_cvt_pk_bf16_f32 v97, v18, v19
v_smfmac_f32_16x16x64_bf16 v[28:31], v[202:205], v[60:67], v168 abid:1
ds_read_b128 v[16:19], v2 offset:1152
v_cvt_pk_bf16_f32 v98, v20, v21
v_smfmac_f32_16x16x64_bf16 v[28:31], v[238:241], v[68:75], v172 abid:1
ds_read_u16 v79, v79
v_cvt_pk_bf16_f32 v99, v22, v23
v_smfmac_f32_16x16x64_bf16 v[32:35], v[206:209], v[60:67], v169
ds_read_b128 v[20:23], v2 offset:1216
v_cvt_pk_bf16_f32 v100, v24, v25
v_smfmac_f32_16x16x64_bf16 v[32:35], v[242:245], v[68:75], v173
ds_read_u16 v80, v80
v_cvt_pk_bf16_f32 v101, v26, v27
v_smfmac_f32_16x16x64_bf16 v[36:39], v[210:213], v[60:67], v169 abid:1
ds_read_b128 v[24:27], v2 offset:1280
v_cvt_pk_bf16_f32 v102, v28, v29
v_smfmac_f32_16x16x64_bf16 v[36:39], v[246:249], v[68:75], v173 abid:1
ds_read_u16 v81, v81
v_cvt_pk_bf16_f32 v103, v30, v31
v_smfmac_f32_16x16x64_bf16 v[40:43], v[214:217], v[60:67], v177 abid:1
s_bitcmp1_b32 s85, s41
ds_read_b128 v[28:31], v2 offset:1344
v_cvt_pk_bf16_f32 v104, v32, v33
v_smfmac_f32_16x16x64_bf16 v[40:43], v[250:253], v[68:75], v178
s_waitcnt lgkmcnt(10)
v_cvt_pk_bf16_f32 v105, v34, v35
s_cbranch_scc1 L_loopk
s_cmp_lg_u32 s41, 6
s_cbranch_scc1 L_loopnk
.p2align 3
L_loopck:
v_smfmac_f32_16x16x64_bf16 v[8:11], a[0:3], v[44:51], v138
s_cmp_lt_u32 s56, s65
s_cselect_b32 s34, s34, 0
s_cselect_b32 s64, s64, 0
ds_read_b128 v[32:35], v2 offset:1408
v_cvt_pk_bf16_f32 v106, v36, v37
v_mov_b32 v7, 1
v_smfmac_f32_16x16x64_bf16 v[8:11], a[36:39], v[52:59], v142
s_waitcnt lgkmcnt(9)
buffer_atomic_add v7, v6, s[32:35], 0 offen sc0 sc1
v_cvt_pk_bf16_f32 v107, v38, v39
v_smfmac_f32_16x16x64_bf16 v[12:15], a[4:7], v[44:51], v138 abid:1
ds_read_b128 v[36:39], v2 offset:1472
v_cvt_pk_bf16_f32 v112, v40, v41
v_smfmac_f32_16x16x64_bf16 v[12:15], a[40:43], v[52:59], v142 abid:1
s_waitcnt lgkmcnt(8)
ds_read_b128 v[60:63], v0 offset:4096
v_cvt_pk_bf16_f32 v113, v42, v43
v_smfmac_f32_16x16x64_bf16 v[16:19], a[8:11], v[44:51], v139
s_cmp_eq_u32 s4, 129920
ds_read_b128 v[40:43], v2 offset:1536
v_cndmask_b32_dpp v108, v96, v92, vcc quad_perm:[1,0,3,2] row_mask:0xf bank_mask:0xf
v_smfmac_f32_16x16x64_bf16 v[16:19], a[44:47], v[52:59], v143
s_waitcnt lgkmcnt(8)
ds_read_u16 v82, v82
v_cndmask_b32_dpp v109, v97, v93, vcc quad_perm:[1,0,3,2] row_mask:0xf bank_mask:0xf
v_smfmac_f32_16x16x64_bf16 v[20:23], a[12:15], v[44:51], v139 abid:1
s_cselect_b32 s43, -129920, s5
ds_read_u16 v84, v84
v_cndmask_b32_dpp v110, v98, v94, vcc quad_perm:[1,0,3,2] row_mask:0xf bank_mask:0xf
v_smfmac_f32_16x16x64_bf16 v[20:23], a[48:51], v[52:59], v143 abid:1
s_waitcnt lgkmcnt(8)
ds_read_b128 v[64:67], v1 offset:4096
v_cndmask_b32_dpp v111, v99, v95, vcc quad_perm:[1,0,3,2] row_mask:0xf bank_mask:0xf
v_smfmac_f32_16x16x64_bf16 v[24:27], a[16:19], v[44:51], v140
s_add_u32 s4, s4, s43
ds_read_b128 v[68:71], v0 offset:6144
v_add_u32_sdwa v87, s42, v123 dst_sel:DWORD dst_unused:UNUSED_PAD src0_sel:DWORD src1_sel:WORD_1
v_smfmac_f32_16x16x64_bf16 v[24:27], a[52:55], v[52:59], v144
buffer_store_dwordx4 v[108:111], v4, s[20:23], s46 offen offset:0 sc1
s_mov_b64 vcc, s[82:83]
s_waitcnt lgkmcnt(8)
ds_read_b128 v[72:75], v1 offset:6144
v_cndmask_b32_dpp v96, v92, v96, vcc quad_perm:[1,0,3,2] row_mask:0xf bank_mask:0xf
v_cndmask_b32_dpp v97, v93, v97, vcc quad_perm:[1,0,3,2] row_mask:0xf bank_mask:0xf
v_smfmac_f32_16x16x64_bf16 v[28:31], a[20:23], v[44:51], v140 abid:1
s_add_u32 s7, s45, s58
ds_read_u16 v83, v83
v_cndmask_b32_dpp v98, v94, v98, vcc quad_perm:[1,0,3,2] row_mask:0xf bank_mask:0xf
v_smfmac_f32_16x16x64_bf16 v[28:31], a[56:59], v[52:59], v144 abid:1
s_waitcnt lgkmcnt(9)
ds_read_b128 v[114:117], v2 offset:64
v_cndmask_b32_dpp v99, v95, v99, vcc quad_perm:[1,0,3,2] row_mask:0xf bank_mask:0xf
v_smfmac_f32_16x16x64_bf16 v[32:35], a[24:27], v[44:51], v141
ds_read_u16 v85, v85
v_add_u32_sdwa v88, s42, v124 dst_sel:DWORD dst_unused:UNUSED_PAD src0_sel:DWORD src1_sel:WORD_0
v_smfmac_f32_16x16x64_bf16 v[32:35], a[60:63], v[52:59], v145
s_waitcnt lgkmcnt(10)
ds_read_u16 v86, v86
v_add_u32_sdwa v89, s42, v124 dst_sel:DWORD dst_unused:UNUSED_PAD src0_sel:DWORD src1_sel:WORD_1
v_smfmac_f32_16x16x64_bf16 v[36:39], a[28:31], v[44:51], v141 abid:1
ds_read_u16 v87, v87
v_add_u32_sdwa v90, s42, v125 dst_sel:DWORD dst_unused:UNUSED_PAD src0_sel:DWORD src1_sel:WORD_0
v_smfmac_f32_16x16x64_bf16 v[36:39], a[64:67], v[52:59], v145 abid:1
s_waitcnt lgkmcnt(10)
ds_read_u16 v88, v88
v_add_u32_sdwa v91, s42, v125 dst_sel:DWORD dst_unused:UNUSED_PAD src0_sel:DWORD src1_sel:WORD_1
v_smfmac_f32_16x16x64_bf16 v[40:43], a[32:35], v[44:51], v174
buffer_store_dwordx4 v[96:99], v4, s[20:23], s46 offen offset:1152 sc1
s_mov_b64 vcc, s[80:81]
ds_read_u16 v89, v89
v_cndmask_b32_dpp v92, v104, v100, vcc quad_perm:[1,0,3,2] row_mask:0xf bank_mask:0xf
v_cndmask_b32_dpp v93, v105, v101, vcc quad_perm:[1,0,3,2] row_mask:0xf bank_mask:0xf
v_smfmac_f32_16x16x64_bf16 v[40:43], a[68:71], v[52:59], v174 abid:1
s_waitcnt lgkmcnt(9)
ds_read_u16 v90, v90
v_cndmask_b32_dpp v94, v106, v102, vcc quad_perm:[1,0,3,2] row_mask:0xf bank_mask:0xf
v_smfmac_f32_16x16x64_bf16 v[8:11], a[72:75], v[60:67], v146
s_waitcnt lgkmcnt(8)
ds_read_u16 v91, v91
v_cndmask_b32_dpp v95, v107, v103, vcc quad_perm:[1,0,3,2] row_mask:0xf bank_mask:0xf
v_smfmac_f32_16x16x64_bf16 v[8:11], a[108:111], v[68:75], v150
s_waitcnt lgkmcnt(7)
ds_bpermute_b32 v112, v6, v112
v_smfmac_f32_16x16x64_bf16 v[8:11], v[114:117], v[76:83], v179
ds_bpermute_b32 v113, v6, v113
v_smfmac_f32_16x16x64_bf16 v[12:15], v[114:117], v[76:83], v179 abid:1
ds_read_b128 v[114:117], v2 offset:128
v_add_u32_sdwa v76, s42, v126 dst_sel:DWORD dst_unused:UNUSED_PAD src0_sel:DWORD src1_sel:WORD_0
v_smfmac_f32_16x16x64_bf16 v[12:15], a[76:79], v[60:67], v146 abid:1
ds_read_u16 v76, v76
v_add_u32_sdwa v77, s42, v126 dst_sel:DWORD dst_unused:UNUSED_PAD src0_sel:DWORD src1_sel:WORD_1
v_smfmac_f32_16x16x64_bf16 v[12:15], a[112:115], v[68:75], v150 abid:1
buffer_store_dwordx4 v[92:95], v4, s[20:23], s46 offen offset:128 sc1
s_mov_b64 vcc, s[82:83]
ds_read_u16 v77, v77
v_cndmask_b32_dpp v104, v100, v104, vcc quad_perm:[1,0,3,2] row_mask:0xf bank_mask:0xf
v_cndmask_b32_dpp v105, v101, v105, vcc quad_perm:[1,0,3,2] row_mask:0xf bank_mask:0xf
v_smfmac_f32_16x16x64_bf16 v[24:27], a[88:91], v[60:67], v148
ds_read_b128 v[44:47], v0 offset:8192
v_add_u32_sdwa v78, s42, v127 dst_sel:DWORD dst_unused:UNUSED_PAD src0_sel:DWORD src1_sel:WORD_0
v_smfmac_f32_16x16x64_bf16 v[24:27], a[124:127], v[68:75], v152
ds_read_u16 v78, v78
v_cndmask_b32_dpp v106, v102, v106, vcc quad_perm:[1,0,3,2] row_mask:0xf bank_mask:0xf
v_smfmac_f32_16x16x64_bf16 v[28:31], a[92:95], v[60:67], v148 abid:1
ds_read_b128 v[48:51], v1 offset:8192
v_cndmask_b32_dpp v107, v103, v107, vcc quad_perm:[1,0,3,2] row_mask:0xf bank_mask:0xf
v_smfmac_f32_16x16x64_bf16 v[28:31], a[128:131], v[68:75], v152 abid:1
ds_read_b128 v[52:55], v0 offset:10240
v_add_u32_sdwa v79, s42, v127 dst_sel:DWORD dst_unused:UNUSED_PAD src0_sel:DWORD src1_sel:WORD_1
v_smfmac_f32_16x16x64_bf16 v[32:35], a[96:99], v[60:67], v149
ds_read_u16 v79, v79
v_add_u32_sdwa v80, s42, v128 dst_sel:DWORD dst_unused:UNUSED_PAD src0_sel:DWORD src1_sel:WORD_0
v_smfmac_f32_16x16x64_bf16 v[32:35], a[132:135], v[68:75], v153
ds_read_u16 v80, v80
v_add_u32_sdwa v81, s42, v128 dst_sel:DWORD dst_unused:UNUSED_PAD src0_sel:DWORD src1_sel:WORD_1
v_smfmac_f32_16x16x64_bf16 v[16:19], a[80:83], v[60:67], v147
buffer_store_dwordx4 v[104:107], v4, s[20:23], s46 offen offset:1280 sc1
s_mov_b64 vcc, s[80:81]
ds_read_b128 v[56:59], v1 offset:10240
v_add_u32_sdwa v82, s42, v129 dst_sel:DWORD dst_unused:UNUSED_PAD src0_sel:DWORD src1_sel:WORD_0
v_add_u32_sdwa v83, s42, v129 dst_sel:DWORD dst_unused:UNUSED_PAD src0_sel:DWORD src1_sel:WORD_1
v_smfmac_f32_16x16x64_bf16 v[16:19], a[116:119], v[68:75], v151
s_waitcnt lgkmcnt(9)
ds_read_b128 v[92:95], v0 offset:12288
v_add_u32_sdwa v100, s42, v130 dst_sel:DWORD dst_unused:UNUSED_PAD src0_sel:DWORD src1_sel:WORD_0
v_smfmac_f32_16x16x64_bf16 v[16:19], v[114:117], v[84:91], v180 abid:1
ds_read_u16 v81, v81
v_add_u32_sdwa v101, s42, v130 dst_sel:DWORD dst_unused:UNUSED_PAD src0_sel:DWORD src1_sel:WORD_1
v_smfmac_f32_16x16x64_bf16 v[12:15], v[114:117], v[84:91], v180
ds_read_b128 v[96:99], v1 offset:12288
v_add_u32_sdwa v102, s42, v131 dst_sel:DWORD dst_unused:UNUSED_PAD src0_sel:DWORD src1_sel:WORD_0
v_smfmac_f32_16x16x64_bf16 v[20:23], v[114:117], v[84:91], v181
ds_read_u16 v82, v82
v_add_u32_sdwa v103, s42, v131 dst_sel:DWORD dst_unused:UNUSED_PAD src0_sel:DWORD src1_sel:WORD_1
v_smfmac_f32_16x16x64_bf16 v[20:23], a[84:87], v[60:67], v147 abid:1
ds_read_u16 v100, v100
v_add_u32_sdwa v104, s42, v132 dst_sel:DWORD dst_unused:UNUSED_PAD src0_sel:DWORD src1_sel:WORD_0
v_smfmac_f32_16x16x64_bf16 v[20:23], a[120:123], v[68:75], v151 abid:1
ds_read_u16 v83, v83
v_add_u32_sdwa v105, s42, v132 dst_sel:DWORD dst_unused:UNUSED_PAD src0_sel:DWORD src1_sel:WORD_1
v_smfmac_f32_16x16x64_bf16 v[36:39], a[100:103], v[60:67], v149 abid:1
buffer_store_dwordx2 v[112:113], v5, s[20:23], s46 offen
ds_read_b128 v[114:117], v2 offset:192
v_add_u32_sdwa v106, s42, v133 dst_sel:DWORD dst_unused:UNUSED_PAD src0_sel:DWORD src1_sel:WORD_0
v_smfmac_f32_16x16x64_bf16 v[36:39], a[136:139], v[68:75], v153 abid:1
s_mov_b32 s46, s48
ds_read_u16 v101, v101
v_add_u32_sdwa v107, s42, v133 dst_sel:DWORD dst_unused:UNUSED_PAD src0_sel:DWORD src1_sel:WORD_1
v_smfmac_f32_16x16x64_bf16 v[40:43], a[104:107], v[60:67], v175
s_mov_b32 s48, s49
ds_read_u16 v102, v102
v_add_u32_sdwa v84, s42, v134 dst_sel:DWORD dst_unused:UNUSED_PAD src0_sel:DWORD src1_sel:WORD_0
v_smfmac_f32_16x16x64_bf16 v[40:43], a[140:143], v[68:75], v175 abid:1
s_waitcnt lgkmcnt(13)
ds_read_u16 v103, v103
v_add_u32_sdwa v85, s42, v134 dst_sel:DWORD dst_unused:UNUSED_PAD src0_sel:DWORD src1_sel:WORD_1
v_smfmac_f32_16x16x64_bf16 v[8:11], a[144:147], v[44:51], v154
s_waitcnt lgkmcnt(10)
ds_read_u16 v104, v104
v_add_u32_sdwa v86, s42, v135 dst_sel:DWORD dst_unused:UNUSED_PAD src0_sel:DWORD src1_sel:WORD_0
v_smfmac_f32_16x16x64_bf16 v[8:11], a[180:183], v[52:59], v158
s_waitcnt lgkmcnt(8)
ds_read_u16 v105, v105
v_add_u32_sdwa v87, s42, v135 dst_sel:DWORD dst_unused:UNUSED_PAD src0_sel:DWORD src1_sel:WORD_1
v_smfmac_f32_16x16x64_bf16 v[8:11], a[216:219], v[92:99], v162
s_add_u32 m0, s44, 0
ds_read_u16 v106, v106
v_add_u32_sdwa v88, s42, v136 dst_sel:DWORD dst_unused:UNUSED_PAD src0_sel:DWORD src1_sel:WORD_0
v_smfmac_f32_16x16x64_bf16 v[24:27], a[160:163], v[44:51], v156
buffer_load_dwordx4 v3, s[16:19], s45 offen offset:0 nt lds
v_add_u32_sdwa v89, s42, v136 dst_sel:DWORD dst_unused:UNUSED_PAD src0_sel:DWORD src1_sel:WORD_1
v_smfmac_f32_16x16x64_bf16 v[24:27], a[196:199], v[52:59], v160
s_mov_b32 s49, s50
ds_read_u16 v107, v107
v_add_u32_sdwa v90, s42, v137 dst_sel:DWORD dst_unused:UNUSED_PAD src0_sel:DWORD src1_sel:WORD_0
v_smfmac_f32_16x16x64_bf16 v[24:27], a[232:235], v[92:99], v164
s_waitcnt lgkmcnt(7)
s_waitcnt vmcnt(6)
ds_read_u16 v84, v84
v_add_u32_sdwa v91, s42, v137 dst_sel:DWORD dst_unused:UNUSED_PAD src0_sel:DWORD src1_sel:WORD_1
v_smfmac_f32_16x16x64_bf16 v[24:27], v[114:117], v[76:83], v182
s_mov_b32 s50, s45
ds_read_u16 v85, v85
v_smfmac_f32_16x16x64_bf16 v[20:23], v[114:117], v[76:83], v181 abid:1
ds_read_u16 v86, v86
v_smfmac_f32_16x16x64_bf16 v[28:31], v[114:117], v[76:83], v182 abid:1
ds_read_b128 v[114:117], v2 offset:256
v_add_u32_sdwa v76, s4, v118 dst_sel:DWORD dst_unused:UNUSED_PAD src0_sel:DWORD src1_sel:WORD_0
v_smfmac_f32_16x16x64_bf16 v[28:31], a[164:167], v[44:51], v156 abid:1
ds_read_u16 v87, v87
v_add_u32_sdwa v77, s4, v118 dst_sel:DWORD dst_unused:UNUSED_PAD src0_sel:DWORD src1_sel:WORD_1
v_smfmac_f32_16x16x64_bf16 v[28:31], a[200:203], v[52:59], v160 abid:1
ds_read_u16 v88, v88
v_add_u32_sdwa v78, s4, v119 dst_sel:DWORD dst_unused:UNUSED_PAD src0_sel:DWORD src1_sel:WORD_0
v_smfmac_f32_16x16x64_bf16 v[28:31], a[236:239], v[92:99], v164 abid:1
ds_read_b128 v[60:63], v0 offset:14336
v_add_u32_sdwa v79, s4, v119 dst_sel:DWORD dst_unused:UNUSED_PAD src0_sel:DWORD src1_sel:WORD_1
v_smfmac_f32_16x16x64_bf16 v[12:15], a[148:151], v[44:51], v154 abid:1
ds_read_u16 v89, v89
v_add_u32_sdwa v80, s4, v120 dst_sel:DWORD dst_unused:UNUSED_PAD src0_sel:DWORD src1_sel:WORD_0
v_smfmac_f32_16x16x64_bf16 v[12:15], a[184:187], v[52:59], v158 abid:1
s_add_u32 m0, s44, 3840
ds_read_b128 v[64:67], v1 offset:14336
v_add_u32_sdwa v81, s4, v120 dst_sel:DWORD dst_unused:UNUSED_PAD src0_sel:DWORD src1_sel:WORD_1
v_smfmac_f32_16x16x64_bf16 v[12:15], a[220:223], v[92:99], v162 abid:1
buffer_load_dwordx4 v3, s[16:19], s45 offen offset:256 nt lds
v_add_u32_sdwa v82, s4, v121 dst_sel:DWORD dst_unused:UNUSED_PAD src0_sel:DWORD src1_sel:WORD_0
v_smfmac_f32_16x16x64_bf16 v[32:35], a[168:171], v[44:51], v157
ds_read_b128 v[68:71], v0 offset:16384
v_add_u32_sdwa v83, s4, v121 dst_sel:DWORD dst_unused:UNUSED_PAD src0_sel:DWORD src1_sel:WORD_1
v_smfmac_f32_16x16x64_bf16 v[32:35], a[204:207], v[52:59], v161
ds_read_u16 v90, v90
v_smfmac_f32_16x16x64_bf16 v[32:35], a[240:243], v[92:99], v165
s_waitcnt lgkmcnt(7)
ds_read_b128 v[72:75], v1 offset:16384
v_add_u32 v0, s43, v0
v_smfmac_f32_16x16x64_bf16 v[32:35], v[114:117], v[100:107], v183 abid:1
ds_read_u16 v91, v91
v_add_u32 v1, s43, v1
v_smfmac_f32_16x16x64_bf16 v[28:31], v[114:117], v[100:107], v183
v_smfmac_f32_16x16x64_bf16 v[36:39], v[114:117], v[100:107], v184
ds_read_b128 v[114:117], v2 offset:320
v_smfmac_f32_16x16x64_bf16 v[36:39], a[172:175], v[44:51], v157 abid:1
s_add_u32 m0, s44, 7680
v_smfmac_f32_16x16x64_bf16 v[36:39], a[208:211], v[52:59], v161 abid:1
buffer_load_dwordx4 v3, s[16:19], s45 offen offset:512 nt lds
v_smfmac_f32_16x16x64_bf16 v[36:39], a[244:247], v[92:99], v165 abid:1
v_smfmac_f32_16x16x64_bf16 v[16:19], a[152:155], v[44:51], v155
s_add_u32 m0, s44, 11520
v_smfmac_f32_16x16x64_bf16 v[16:19], a[188:191], v[52:59], v159
buffer_load_dwordx4 v3, s[16:19], s45 offen offset:768 nt lds
v_smfmac_f32_16x16x64_bf16 v[16:19], a[224:227], v[92:99], v163
s_mov_b64 exec, s[62:63]
ds_write_b32 v0, v7 offset:18432
s_mov_b64 exec, -1
v_smfmac_f32_16x16x64_bf16 v[20:23], a[156:159], v[44:51], v155 abid:1
s_add_u32 m0, s44, s8
v_smfmac_f32_16x16x64_bf16 v[20:23], a[192:195], v[52:59], v159 abid:1
s_mov_b64 exec, s[10:11]
buffer_load_dwordx4 v3, s[16:19], s7 offen offset:896 nt lds
s_mov_b64 exec, -1
v_smfmac_f32_16x16x64_bf16 v[20:23], a[228:231], v[92:99], v163 abid:1
s_add_u32 s44, s44, s5
s_cmp_ge_u32 s44, 148480
s_cselect_b32 s44, s9, s44
v_smfmac_f32_16x16x64_bf16 v[40:43], a[176:179], v[44:51], v176
v_smfmac_f32_16x16x64_bf16 v[40:43], a[212:215], v[52:59], v176 abid:1
v_smfmac_f32_16x16x64_bf16 v[40:43], a[248:251], v[92:99], v177
s_waitcnt lgkmcnt(0)
v_smfmac_f32_16x16x64_bf16 v[40:43], v[114:117], v[84:91], v185
v_smfmac_f32_16x16x64_bf16 v[36:39], v[114:117], v[84:91], v184 abid:1
s_barrier
v_smfmac_f32_16x16x64_bf16 v[8:11], a[252:255], v[60:67], v166
s_mov_b32 s42, s4
ds_read_b32 v7, v0 offset:18432
v_smfmac_f32_16x16x64_bf16 v[8:11], v[218:221], v[68:75], v170
ds_read_b128 v[44:47], v0 offset:0
v_add_u32_sdwa v84, s42, v122 dst_sel:DWORD dst_unused:UNUSED_PAD src0_sel:DWORD src1_sel:WORD_0
v_smfmac_f32_16x16x64_bf16 v[12:15], v[186:189], v[60:67], v166 abid:1
ds_read_b128 v[48:51], v1 offset:0
v_add_u32_sdwa v85, s42, v122 dst_sel:DWORD dst_unused:UNUSED_PAD src0_sel:DWORD src1_sel:WORD_1
v_smfmac_f32_16x16x64_bf16 v[12:15], v[222:225], v[68:75], v170 abid:1
ds_read_b128 v[52:55], v0 offset:2048
v_add_u32_sdwa v86, s42, v123 dst_sel:DWORD dst_unused:UNUSED_PAD src0_sel:DWORD src1_sel:WORD_0
v_smfmac_f32_16x16x64_bf16 v[16:19], v[190:193], v[60:67], v167
ds_read_b128 v[56:59], v1 offset:2048
v_cvt_pk_bf16_f32 v92, v8, v9
v_smfmac_f32_16x16x64_bf16 v[16:19], v[226:229], v[68:75], v171
ds_read_u16 v76, v76
v_cvt_pk_bf16_f32 v93, v10, v11
v_smfmac_f32_16x16x64_bf16 v[20:23], v[194:197], v[60:67], v167 abid:1
ds_read_b128 v[8:11], v2 offset:1024
v_cvt_pk_bf16_f32 v94, v12, v13
v_smfmac_f32_16x16x64_bf16 v[20:23], v[230:233], v[68:75], v171 abid:1
ds_read_u16 v77, v77
v_cvt_pk_bf16_f32 v95, v14, v15
v_smfmac_f32_16x16x64_bf16 v[24:27], v[198:201], v[60:67], v168
ds_read_b128 v[12:15], v2 offset:1088
v_cvt_pk_bf16_f32 v96, v16, v17
v_smfmac_f32_16x16x64_bf16 v[24:27], v[234:237], v[68:75], v172
s_waitcnt lgkmcnt(8)
ds_read_u16 v78, v78
v_cvt_pk_bf16_f32 v97, v18, v19
v_readfirstlane_b32 s56, v7
v_smfmac_f32_16x16x64_bf16 v[28:31], v[202:205], v[60:67], v168 abid:1
s_lshr_b32 s60, s56, 4
ds_read_b128 v[16:19], v2 offset:1152
v_cvt_pk_bf16_f32 v98, v20, v21
v_smfmac_f32_16x16x64_bf16 v[28:31], v[238:241], v[68:75], v172 abid:1
s_mul_i32 s60, s60, 884736
ds_read_u16 v79, v79
v_cvt_pk_bf16_f32 v99, v22, v23
v_smfmac_f32_16x16x64_bf16 v[32:35], v[206:209], v[60:67], v169
s_mul_i32 s61, s56, 18432
ds_read_b128 v[20:23], v2 offset:1216
v_cvt_pk_bf16_f32 v100, v24, v25
v_smfmac_f32_16x16x64_bf16 v[32:35], v[242:245], v[68:75], v173
s_add_u32 s60, s60, s57
ds_read_u16 v80, v80
v_cvt_pk_bf16_f32 v101, v26, v27
v_smfmac_f32_16x16x64_bf16 v[36:39], v[210:213], v[60:67], v169 abid:1
s_add_u32 s45, s60, s61
ds_read_b128 v[24:27], v2 offset:1280
v_cvt_pk_bf16_f32 v102, v28, v29
v_smfmac_f32_16x16x64_bf16 v[36:39], v[246:249], v[68:75], v173 abid:1
ds_read_u16 v81, v81
v_cvt_pk_bf16_f32 v103, v30, v31
v_smfmac_f32_16x16x64_bf16 v[40:43], v[214:217], v[60:67], v177 abid:1
s_cmp_lt_u32 s56, s64
ds_read_b128 v[28:31], v2 offset:1344
v_cvt_pk_bf16_f32 v104, v32, v33
v_smfmac_f32_16x16x64_bf16 v[40:43], v[250:253], v[68:75], v178
s_waitcnt lgkmcnt(10)
v_cvt_pk_bf16_f32 v105, v34, v35
s_cbranch_scc1 L_loopck
s_mov_b32 s41, 0
s_mov_b32 s15, 3
s_mov_b32 s12, 7
s_mov_b32 s92, 4
s_mov_b32 s87, 4
s_mov_b32 s59, -1
.p2align 3
L_loopnk:
v_smfmac_f32_16x16x64_bf16 v[8:11], a[0:3], v[44:51], v138
ds_read_b128 v[32:35], v2 offset:1408
v_cvt_pk_bf16_f32 v106, v36, v37
v_smfmac_f32_16x16x64_bf16 v[8:11], a[36:39], v[52:59], v142
s_waitcnt lgkmcnt(9)
v_cvt_pk_bf16_f32 v107, v38, v39
v_smfmac_f32_16x16x64_bf16 v[12:15], a[4:7], v[44:51], v138 abid:1
ds_read_b128 v[36:39], v2 offset:1472
v_cvt_pk_bf16_f32 v112, v40, v41
v_smfmac_f32_16x16x64_bf16 v[12:15], a[40:43], v[52:59], v142 abid:1
s_waitcnt lgkmcnt(8)
ds_read_b128 v[60:63], v0 offset:4096
v_cvt_pk_bf16_f32 v113, v42, v43
v_smfmac_f32_16x16x64_bf16 v[16:19], a[8:11], v[44:51], v139
s_cmp_eq_u32 s4, 129920
ds_read_b128 v[40:43], v2 offset:1536
v_cndmask_b32_dpp v108, v96, v92, vcc quad_perm:[1,0,3,2] row_mask:0xf bank_mask:0xf
v_smfmac_f32_16x16x64_bf16 v[16:19], a[44:47], v[52:59], v143
s_waitcnt lgkmcnt(8)
ds_read_u16 v82, v82
v_cndmask_b32_dpp v109, v97, v93, vcc quad_perm:[1,0,3,2] row_mask:0xf bank_mask:0xf
v_smfmac_f32_16x16x64_bf16 v[20:23], a[12:15], v[44:51], v139 abid:1
s_cselect_b32 s43, -129920, s5
ds_read_u16 v84, v84
v_cndmask_b32_dpp v110, v98, v94, vcc quad_perm:[1,0,3,2] row_mask:0xf bank_mask:0xf
v_smfmac_f32_16x16x64_bf16 v[20:23], a[48:51], v[52:59], v143 abid:1
s_waitcnt lgkmcnt(8)
ds_read_b128 v[64:67], v1 offset:4096
v_cndmask_b32_dpp v111, v99, v95, vcc quad_perm:[1,0,3,2] row_mask:0xf bank_mask:0xf
v_smfmac_f32_16x16x64_bf16 v[24:27], a[16:19], v[44:51], v140
s_add_u32 s4, s4, s43
ds_read_b128 v[68:71], v0 offset:6144
v_add_u32_sdwa v87, s42, v123 dst_sel:DWORD dst_unused:UNUSED_PAD src0_sel:DWORD src1_sel:WORD_1
v_smfmac_f32_16x16x64_bf16 v[24:27], a[52:55], v[52:59], v144
buffer_store_dwordx4 v[108:111], v4, s[20:23], s46 offen offset:0 sc1
s_mov_b64 vcc, s[82:83]
s_waitcnt lgkmcnt(8)
ds_read_b128 v[72:75], v1 offset:6144
v_cndmask_b32_dpp v96, v92, v96, vcc quad_perm:[1,0,3,2] row_mask:0xf bank_mask:0xf
v_cndmask_b32_dpp v97, v93, v97, vcc quad_perm:[1,0,3,2] row_mask:0xf bank_mask:0xf
v_smfmac_f32_16x16x64_bf16 v[28:31], a[20:23], v[44:51], v140 abid:1
s_add_u32 s41, s41, 1
ds_read_u16 v83, v83
v_cndmask_b32_dpp v98, v94, v98, vcc quad_perm:[1,0,3,2] row_mask:0xf bank_mask:0xf
v_smfmac_f32_16x16x64_bf16 v[28:31], a[56:59], v[52:59], v144 abid:1
s_waitcnt lgkmcnt(9)
ds_read_b128 v[114:117], v2 offset:64
v_cndmask_b32_dpp v99, v95, v99, vcc quad_perm:[1,0,3,2] row_mask:0xf bank_mask:0xf
v_smfmac_f32_16x16x64_bf16 v[32:35], a[24:27], v[44:51], v141
ds_read_u16 v85, v85
v_add_u32_sdwa v88, s42, v124 dst_sel:DWORD dst_unused:UNUSED_PAD src0_sel:DWORD src1_sel:WORD_0
v_smfmac_f32_16x16x64_bf16 v[32:35], a[60:63], v[52:59], v145
s_waitcnt lgkmcnt(10)
ds_read_u16 v86, v86
v_add_u32_sdwa v89, s42, v124 dst_sel:DWORD dst_unused:UNUSED_PAD src0_sel:DWORD src1_sel:WORD_1
v_smfmac_f32_16x16x64_bf16 v[36:39], a[28:31], v[44:51], v141 abid:1
ds_read_u16 v87, v87
v_add_u32_sdwa v90, s42, v125 dst_sel:DWORD dst_unused:UNUSED_PAD src0_sel:DWORD src1_sel:WORD_0
v_smfmac_f32_16x16x64_bf16 v[36:39], a[64:67], v[52:59], v145 abid:1
s_waitcnt lgkmcnt(10)
ds_read_u16 v88, v88
v_add_u32_sdwa v91, s42, v125 dst_sel:DWORD dst_unused:UNUSED_PAD src0_sel:DWORD src1_sel:WORD_1
v_smfmac_f32_16x16x64_bf16 v[40:43], a[32:35], v[44:51], v174
buffer_store_dwordx4 v[96:99], v4, s[20:23], s46 offen offset:1152 sc1
s_mov_b64 vcc, s[80:81]
ds_read_u16 v89, v89
v_cndmask_b32_dpp v92, v104, v100, vcc quad_perm:[1,0,3,2] row_mask:0xf bank_mask:0xf
v_cndmask_b32_dpp v93, v105, v101, vcc quad_perm:[1,0,3,2] row_mask:0xf bank_mask:0xf
v_smfmac_f32_16x16x64_bf16 v[40:43], a[68:71], v[52:59], v174 abid:1
s_waitcnt lgkmcnt(9)
ds_read_u16 v90, v90
v_cndmask_b32_dpp v94, v106, v102, vcc quad_perm:[1,0,3,2] row_mask:0xf bank_mask:0xf
v_smfmac_f32_16x16x64_bf16 v[8:11], a[72:75], v[60:67], v146
s_waitcnt lgkmcnt(8)
ds_read_u16 v91, v91
v_cndmask_b32_dpp v95, v107, v103, vcc quad_perm:[1,0,3,2] row_mask:0xf bank_mask:0xf
v_smfmac_f32_16x16x64_bf16 v[8:11], a[108:111], v[68:75], v150
s_waitcnt lgkmcnt(7)
ds_bpermute_b32 v112, v6, v112
v_smfmac_f32_16x16x64_bf16 v[8:11], v[114:117], v[76:83], v179
ds_bpermute_b32 v113, v6, v113
v_smfmac_f32_16x16x64_bf16 v[12:15], v[114:117], v[76:83], v179 abid:1
ds_read_b128 v[114:117], v2 offset:128
v_add_u32_sdwa v76, s42, v126 dst_sel:DWORD dst_unused:UNUSED_PAD src0_sel:DWORD src1_sel:WORD_0
v_smfmac_f32_16x16x64_bf16 v[12:15], a[76:79], v[60:67], v146 abid:1
ds_read_u16 v76, v76
v_add_u32_sdwa v77, s42, v126 dst_sel:DWORD dst_unused:UNUSED_PAD src0_sel:DWORD src1_sel:WORD_1
v_smfmac_f32_16x16x64_bf16 v[12:15], a[112:115], v[68:75], v150 abid:1
buffer_store_dwordx4 v[92:95], v4, s[20:23], s46 offen offset:128 sc1
s_mov_b64 vcc, s[82:83]
ds_read_u16 v77, v77
v_cndmask_b32_dpp v104, v100, v104, vcc quad_perm:[1,0,3,2] row_mask:0xf bank_mask:0xf
v_cndmask_b32_dpp v105, v101, v105, vcc quad_perm:[1,0,3,2] row_mask:0xf bank_mask:0xf
v_smfmac_f32_16x16x64_bf16 v[24:27], a[88:91], v[60:67], v148
ds_read_b128 v[44:47], v0 offset:8192
v_add_u32_sdwa v78, s42, v127 dst_sel:DWORD dst_unused:UNUSED_PAD src0_sel:DWORD src1_sel:WORD_0
v_smfmac_f32_16x16x64_bf16 v[24:27], a[124:127], v[68:75], v152
ds_read_u16 v78, v78
v_cndmask_b32_dpp v106, v102, v106, vcc quad_perm:[1,0,3,2] row_mask:0xf bank_mask:0xf
v_smfmac_f32_16x16x64_bf16 v[28:31], a[92:95], v[60:67], v148 abid:1
ds_read_b128 v[48:51], v1 offset:8192
v_cndmask_b32_dpp v107, v103, v107, vcc quad_perm:[1,0,3,2] row_mask:0xf bank_mask:0xf
v_smfmac_f32_16x16x64_bf16 v[28:31], a[128:131], v[68:75], v152 abid:1
ds_read_b128 v[52:55], v0 offset:10240
v_add_u32_sdwa v79, s42, v127 dst_sel:DWORD dst_unused:UNUSED_PAD src0_sel:DWORD src1_sel:WORD_1
v_smfmac_f32_16x16x64_bf16 v[32:35], a[96:99], v[60:67], v149
ds_read_u16 v79, v79
v_add_u32_sdwa v80, s42, v128 dst_sel:DWORD dst_unused:UNUSED_PAD src0_sel:DWORD src1_sel:WORD_0
v_smfmac_f32_16x16x64_bf16 v[32:35], a[132:135], v[68:75], v153
ds_read_u16 v80, v80
v_add_u32_sdwa v81, s42, v128 dst_sel:DWORD dst_unused:UNUSED_PAD src0_sel:DWORD src1_sel:WORD_1
v_smfmac_f32_16x16x64_bf16 v[16:19], a[80:83], v[60:67], v147
buffer_store_dwordx4 v[104:107], v4, s[20:23], s46 offen offset:1280 sc1
s_mov_b64 vcc, s[80:81]
ds_read_b128 v[56:59], v1 offset:10240
v_add_u32_sdwa v82, s42, v129 dst_sel:DWORD dst_unused:UNUSED_PAD src0_sel:DWORD src1_sel:WORD_0
v_add_u32_sdwa v83, s42, v129 dst_sel:DWORD dst_unused:UNUSED_PAD src0_sel:DWORD src1_sel:WORD_1
v_smfmac_f32_16x16x64_bf16 v[16:19], a[116:119], v[68:75], v151
s_waitcnt lgkmcnt(9)
ds_read_b128 v[92:95], v0 offset:12288
v_add_u32_sdwa v100, s42, v130 dst_sel:DWORD dst_unused:UNUSED_PAD src0_sel:DWORD src1_sel:WORD_0
v_smfmac_f32_16x16x64_bf16 v[16:19], v[114:117], v[84:91], v180 abid:1
ds_read_u16 v81, v81
v_add_u32_sdwa v101, s42, v130 dst_sel:DWORD dst_unused:UNUSED_PAD src0_sel:DWORD src1_sel:WORD_1
v_smfmac_f32_16x16x64_bf16 v[12:15], v[114:117], v[84:91], v180
ds_read_b128 v[96:99], v1 offset:12288
v_add_u32_sdwa v102, s42, v131 dst_sel:DWORD dst_unused:UNUSED_PAD src0_sel:DWORD src1_sel:WORD_0
v_smfmac_f32_16x16x64_bf16 v[20:23], v[114:117], v[84:91], v181
ds_read_u16 v82, v82
v_add_u32_sdwa v103, s42, v131 dst_sel:DWORD dst_unused:UNUSED_PAD src0_sel:DWORD src1_sel:WORD_1
v_smfmac_f32_16x16x64_bf16 v[20:23], a[84:87], v[60:67], v147 abid:1
ds_read_u16 v100, v100
v_add_u32_sdwa v104, s42, v132 dst_sel:DWORD dst_unused:UNUSED_PAD src0_sel:DWORD src1_sel:WORD_0
v_smfmac_f32_16x16x64_bf16 v[20:23], a[120:123], v[68:75], v151 abid:1
ds_read_u16 v83, v83
v_add_u32_sdwa v105, s42, v132 dst_sel:DWORD dst_unused:UNUSED_PAD src0_sel:DWORD src1_sel:WORD_1
v_smfmac_f32_16x16x64_bf16 v[36:39], a[100:103], v[60:67], v149 abid:1
buffer_store_dwordx2 v[112:113], v5, s[20:23], s46 offen
ds_read_b128 v[114:117], v2 offset:192
v_add_u32_sdwa v106, s42, v133 dst_sel:DWORD dst_unused:UNUSED_PAD src0_sel:DWORD src1_sel:WORD_0
v_smfmac_f32_16x16x64_bf16 v[36:39], a[136:139], v[68:75], v153 abid:1
s_mov_b32 s22, 75497472
ds_read_u16 v101, v101
v_add_u32_sdwa v107, s42, v133 dst_sel:DWORD dst_unused:UNUSED_PAD src0_sel:DWORD src1_sel:WORD_1
v_smfmac_f32_16x16x64_bf16 v[40:43], a[104:107], v[60:67], v175
s_mov_b32 s46, s48
ds_read_u16 v102, v102
v_add_u32_sdwa v84, s42, v134 dst_sel:DWORD dst_unused:UNUSED_PAD src0_sel:DWORD src1_sel:WORD_0
v_smfmac_f32_16x16x64_bf16 v[40:43], a[140:143], v[68:75], v175 abid:1
s_waitcnt lgkmcnt(13)
ds_read_u16 v103, v103
v_add_u32_sdwa v85, s42, v134 dst_sel:DWORD dst_unused:UNUSED_PAD src0_sel:DWORD src1_sel:WORD_1
v_smfmac_f32_16x16x64_bf16 v[8:11], a[144:147], v[44:51], v154
s_waitcnt lgkmcnt(10)
ds_read_u16 v104, v104
v_add_u32_sdwa v86, s42, v135 dst_sel:DWORD dst_unused:UNUSED_PAD src0_sel:DWORD src1_sel:WORD_0
v_smfmac_f32_16x16x64_bf16 v[8:11], a[180:183], v[52:59], v158
s_waitcnt lgkmcnt(8)
ds_read_u16 v105, v105
v_add_u32_sdwa v87, s42, v135 dst_sel:DWORD dst_unused:UNUSED_PAD src0_sel:DWORD src1_sel:WORD_1
v_smfmac_f32_16x16x64_bf16 v[8:11], a[216:219], v[92:99], v162
s_mov_b32 s48, s49
ds_read_u16 v106, v106
v_add_u32_sdwa v88, s42, v136 dst_sel:DWORD dst_unused:UNUSED_PAD src0_sel:DWORD src1_sel:WORD_0
v_smfmac_f32_16x16x64_bf16 v[24:27], a[160:163], v[44:51], v156
s_mov_b32 s49, s50
s_add_u32 s50, s50, 4718592
v_add_u32_sdwa v89, s42, v136 dst_sel:DWORD dst_unused:UNUSED_PAD src0_sel:DWORD src1_sel:WORD_1
v_smfmac_f32_16x16x64_bf16 v[24:27], a[196:199], v[52:59], v160
ds_read_u16 v107, v107
v_add_u32_sdwa v90, s42, v137 dst_sel:DWORD dst_unused:UNUSED_PAD src0_sel:DWORD src1_sel:WORD_0
v_smfmac_f32_16x16x64_bf16 v[24:27], a[232:235], v[92:99], v164
s_waitcnt lgkmcnt(7)
ds_read_u16 v84, v84
v_add_u32_sdwa v91, s42, v137 dst_sel:DWORD dst_unused:UNUSED_PAD src0_sel:DWORD src1_sel:WORD_1
v_smfmac_f32_16x16x64_bf16 v[24:27], v[114:117], v[76:83], v182
ds_read_u16 v85, v85
v_smfmac_f32_16x16x64_bf16 v[20:23], v[114:117], v[76:83], v181 abid:1
ds_read_u16 v86, v86
v_smfmac_f32_16x16x64_bf16 v[28:31], v[114:117], v[76:83], v182 abid:1
ds_read_b128 v[114:117], v2 offset:256
v_add_u32_sdwa v76, s4, v118 dst_sel:DWORD dst_unused:UNUSED_PAD src0_sel:DWORD src1_sel:WORD_0
v_smfmac_f32_16x16x64_bf16 v[28:31], a[164:167], v[44:51], v156 abid:1
ds_read_u16 v87, v87
v_add_u32_sdwa v77, s4, v118 dst_sel:DWORD dst_unused:UNUSED_PAD src0_sel:DWORD src1_sel:WORD_1
v_smfmac_f32_16x16x64_bf16 v[28:31], a[200:203], v[52:59], v160 abid:1
ds_read_u16 v88, v88
v_add_u32_sdwa v78, s4, v119 dst_sel:DWORD dst_unused:UNUSED_PAD src0_sel:DWORD src1_sel:WORD_0
v_smfmac_f32_16x16x64_bf16 v[28:31], a[236:239], v[92:99], v164 abid:1
ds_read_b128 v[60:63], v0 offset:14336
v_add_u32_sdwa v79, s4, v119 dst_sel:DWORD dst_unused:UNUSED_PAD src0_sel:DWORD src1_sel:WORD_1
v_smfmac_f32_16x16x64_bf16 v[12:15], a[148:151], v[44:51], v154 abid:1
ds_read_u16 v89, v89
v_add_u32_sdwa v80, s4, v120 dst_sel:DWORD dst_unused:UNUSED_PAD src0_sel:DWORD src1_sel:WORD_0
v_smfmac_f32_16x16x64_bf16 v[12:15], a[184:187], v[52:59], v158 abid:1
ds_read_b128 v[64:67], v1 offset:14336
v_add_u32_sdwa v81, s4, v120 dst_sel:DWORD dst_unused:UNUSED_PAD src0_sel:DWORD src1_sel:WORD_1
v_smfmac_f32_16x16x64_bf16 v[12:15], a[220:223], v[92:99], v162 abid:1
v_add_u32_sdwa v82, s4, v121 dst_sel:DWORD dst_unused:UNUSED_PAD src0_sel:DWORD src1_sel:WORD_0
v_smfmac_f32_16x16x64_bf16 v[32:35], a[168:171], v[44:51], v157
ds_read_b128 v[68:71], v0 offset:16384
v_add_u32_sdwa v83, s4, v121 dst_sel:DWORD dst_unused:UNUSED_PAD src0_sel:DWORD src1_sel:WORD_1
v_smfmac_f32_16x16x64_bf16 v[32:35], a[204:207], v[52:59], v161
ds_read_u16 v90, v90
v_smfmac_f32_16x16x64_bf16 v[32:35], a[240:243], v[92:99], v165
s_waitcnt lgkmcnt(7)
ds_read_b128 v[72:75], v1 offset:16384
v_add_u32 v0, s43, v0
v_smfmac_f32_16x16x64_bf16 v[32:35], v[114:117], v[100:107], v183 abid:1
ds_read_u16 v91, v91
v_add_u32 v1, s43, v1
v_smfmac_f32_16x16x64_bf16 v[28:31], v[114:117], v[100:107], v183
v_smfmac_f32_16x16x64_bf16 v[36:39], v[114:117], v[100:107], v184
ds_read_b128 v[114:117], v2 offset:320
v_smfmac_f32_16x16x64_bf16 v[36:39], a[172:175], v[44:51], v157 abid:1
v_smfmac_f32_16x16x64_bf16 v[36:39], a[208:211], v[52:59], v161 abid:1
v_smfmac_f32_16x16x64_bf16 v[36:39], a[244:247], v[92:99], v165 abid:1
v_smfmac_f32_16x16x64_bf16 v[16:19], a[152:155], v[44:51], v155
v_smfmac_f32_16x16x64_bf16 v[16:19], a[188:191], v[52:59], v159
v_smfmac_f32_16x16x64_bf16 v[16:19], a[224:227], v[92:99], v163
v_smfmac_f32_16x16x64_bf16 v[20:23], a[156:159], v[44:51], v155 abid:1
v_smfmac_f32_16x16x64_bf16 v[20:23], a[192:195], v[52:59], v159 abid:1
v_smfmac_f32_16x16x64_bf16 v[20:23], a[228:231], v[92:99], v163 abid:1
v_smfmac_f32_16x16x64_bf16 v[40:43], a[176:179], v[44:51], v176
s_bitcmp1_b32 s92, s41
v_smfmac_f32_16x16x64_bf16 v[40:43], a[212:215], v[52:59], v176 abid:1
s_cbranch_scc1 L_loopnk_w
L_loopnk_wb:
v_smfmac_f32_16x16x64_bf16 v[40:43], a[248:251], v[92:99], v177
s_waitcnt lgkmcnt(0)
v_smfmac_f32_16x16x64_bf16 v[40:43], v[114:117], v[84:91], v185
v_smfmac_f32_16x16x64_bf16 v[36:39], v[114:117], v[84:91], v184 abid:1
s_waitcnt vmcnt(20)
s_barrier
L_loopnk_p3:
v_smfmac_f32_16x16x64_bf16 v[8:11], a[252:255], v[60:67], v166
s_mov_b32 s42, s4
v_smfmac_f32_16x16x64_bf16 v[8:11], v[218:221], v[68:75], v170
ds_read_b128 v[44:47], v0 offset:0
v_add_u32_sdwa v84, s42, v122 dst_sel:DWORD dst_unused:UNUSED_PAD src0_sel:DWORD src1_sel:WORD_0
v_smfmac_f32_16x16x64_bf16 v[12:15], v[186:189], v[60:67], v166 abid:1
ds_read_b128 v[48:51], v1 offset:0
v_add_u32_sdwa v85, s42, v122 dst_sel:DWORD dst_unused:UNUSED_PAD src0_sel:DWORD src1_sel:WORD_1
v_smfmac_f32_16x16x64_bf16 v[12:15], v[222:225], v[68:75], v170 abid:1
ds_read_b128 v[52:55], v0 offset:2048
v_add_u32_sdwa v86, s42, v123 dst_sel:DWORD dst_unused:UNUSED_PAD src0_sel:DWORD src1_sel:WORD_0
v_smfmac_f32_16x16x64_bf16 v[16:19], v[190:193], v[60:67], v167
ds_read_b128 v[56:59], v1 offset:2048
v_cvt_pk_bf16_f32 v92, v8, v9
v_smfmac_f32_16x16x64_bf16 v[16:19], v[226:229], v[68:75], v171
ds_read_u16 v76, v76
v_cvt_pk_bf16_f32 v93, v10, v11
v_smfmac_f32_16x16x64_bf16 v[20:23], v[194:197], v[60:67], v167 abid:1
ds_read_b128 v[8:11], v2 offset:1024
v_cvt_pk_bf16_f32 v94, v12, v13
v_smfmac_f32_16x16x64_bf16 v[20:23], v[230:233], v[68:75], v171 abid:1
ds_read_u16 v77, v77
v_cvt_pk_bf16_f32 v95, v14, v15
v_smfmac_f32_16x16x64_bf16 v[24:27], v[198:201], v[60:67], v168
ds_read_b128 v[12:15], v2 offset:1088
v_cvt_pk_bf16_f32 v96, v16, v17
v_smfmac_f32_16x16x64_bf16 v[24:27], v[234:237], v[68:75], v172
ds_read_u16 v78, v78
v_cvt_pk_bf16_f32 v97, v18, v19
v_smfmac_f32_16x16x64_bf16 v[28:31], v[202:205], v[60:67], v168 abid:1
ds_read_b128 v[16:19], v2 offset:1152
v_cvt_pk_bf16_f32 v98, v20, v21
v_smfmac_f32_16x16x64_bf16 v[28:31], v[238:241], v[68:75], v172 abid:1
ds_read_u16 v79, v79
v_cvt_pk_bf16_f32 v99, v22, v23
v_smfmac_f32_16x16x64_bf16 v[32:35], v[206:209], v[60:67], v169
ds_read_b128 v[20:23], v2 offset:1216
v_cvt_pk_bf16_f32 v100, v24, v25
v_smfmac_f32_16x16x64_bf16 v[32:35], v[242:245], v[68:75], v173
ds_read_u16 v80, v80
v_cvt_pk_bf16_f32 v101, v26, v27
v_smfmac_f32_16x16x64_bf16 v[36:39], v[210:213], v[60:67], v169 abid:1
ds_read_b128 v[24:27], v2 offset:1280
v_cvt_pk_bf16_f32 v102, v28, v29
v_smfmac_f32_16x16x64_bf16 v[36:39], v[246:249], v[68:75], v173 abid:1
ds_read_u16 v81, v81
v_cvt_pk_bf16_f32 v103, v30, v31
v_smfmac_f32_16x16x64_bf16 v[40:43], v[214:217], v[60:67], v177 abid:1
s_bitcmp1_b32 s12, s41
ds_read_b128 v[28:31], v2 offset:1344
v_cvt_pk_bf16_f32 v104, v32, v33
v_smfmac_f32_16x16x64_bf16 v[40:43], v[250:253], v[68:75], v178
s_waitcnt lgkmcnt(10)
v_cvt_pk_bf16_f32 v105, v34, v35
s_cbranch_scc1 L_loopnk
s_cmp_eq_u32 s41, s59
s_cbranch_scc1 L_loopck
s_cmp_lt_u32 s41, s15
s_cbranch_scc1 L_loopk
s_nop 0
v_cndmask_b32_dpp v108, v96, v92, vcc quad_perm:[1,0,3,2] row_mask:0xf bank_mask:0xf
v_cndmask_b32_dpp v109, v97, v93, vcc quad_perm:[1,0,3,2] row_mask:0xf bank_mask:0xf
v_cndmask_b32_dpp v110, v98, v94, vcc quad_perm:[1,0,3,2] row_mask:0xf bank_mask:0xf
v_cndmask_b32_dpp v111, v99, v95, vcc quad_perm:[1,0,3,2] row_mask:0xf bank_mask:0xf
buffer_store_dwordx4 v[108:111], v4, s[20:23], s46 offen offset:0 sc1
s_mov_b64 vcc, s[82:83]
v_cvt_pk_bf16_f32 v112, v40, v41
v_cvt_pk_bf16_f32 v113, v42, v43
ds_bpermute_b32 v112, v6, v112
ds_bpermute_b32 v113, v6, v113
v_cndmask_b32_dpp v96, v92, v96, vcc quad_perm:[1,0,3,2] row_mask:0xf bank_mask:0xf
v_cndmask_b32_dpp v97, v93, v97, vcc quad_perm:[1,0,3,2] row_mask:0xf bank_mask:0xf
v_cndmask_b32_dpp v98, v94, v98, vcc quad_perm:[1,0,3,2] row_mask:0xf bank_mask:0xf
v_cndmask_b32_dpp v99, v95, v99, vcc quad_perm:[1,0,3,2] row_mask:0xf bank_mask:0xf
buffer_store_dwordx4 v[96:99], v4, s[20:23], s46 offen offset:1152 sc1
s_mov_b64 vcc, s[80:81]
v_cvt_pk_bf16_f32 v106, v36, v37
v_cvt_pk_bf16_f32 v107, v38, v39
v_cndmask_b32_dpp v92, v104, v100, vcc quad_perm:[1,0,3,2] row_mask:0xf bank_mask:0xf
v_cndmask_b32_dpp v93, v105, v101, vcc quad_perm:[1,0,3,2] row_mask:0xf bank_mask:0xf
v_cndmask_b32_dpp v94, v106, v102, vcc quad_perm:[1,0,3,2] row_mask:0xf bank_mask:0xf
v_cndmask_b32_dpp v95, v107, v103, vcc quad_perm:[1,0,3,2] row_mask:0xf bank_mask:0xf
buffer_store_dwordx4 v[92:95], v4, s[20:23], s46 offen offset:128 sc1
s_mov_b64 vcc, s[82:83]
v_cndmask_b32_dpp v104, v100, v104, vcc quad_perm:[1,0,3,2] row_mask:0xf bank_mask:0xf
v_cndmask_b32_dpp v105, v101, v105, vcc quad_perm:[1,0,3,2] row_mask:0xf bank_mask:0xf
v_cndmask_b32_dpp v106, v102, v106, vcc quad_perm:[1,0,3,2] row_mask:0xf bank_mask:0xf
v_cndmask_b32_dpp v107, v103, v107, vcc quad_perm:[1,0,3,2] row_mask:0xf bank_mask:0xf
buffer_store_dwordx4 v[104:107], v4, s[20:23], s46 offen offset:1280 sc1
s_mov_b64 vcc, s[80:81]
s_waitcnt lgkmcnt(0)
buffer_store_dwordx2 v[112:113], v5, s[20:23], s46 offen
s_branch L_fin
L_loopk_w:
s_bitcmp1_b32 s87, s41
s_waitcnt vmcnt(15)
s_cbranch_scc0 L_loopk_wb
s_waitcnt vmcnt(10)
s_branch L_loopk_wb
L_loopnk_w:
s_bitcmp1_b32 s87, s41
s_waitcnt vmcnt(15)
s_cbranch_scc0 L_loopnk_wb
s_waitcnt vmcnt(10)
s_branch L_loopnk_wb
L_slow:
s_waitcnt vmcnt(0) lgkmcnt(0)
s_mov_b32 s87, 0
L_sm:
s_lshl_b32 s86, s2, 1
s_add_u32 s86, s86, s87
s_add_u32 s86, s86, 2
s_mul_i32 s86, s86, 393216
s_mov_b32 s84, 0
L_st:
s_and_b32 s48, s84, 3
s_lshr_b32 s49, s84, 2
s_sub_u32 s50, s84, 36
s_lshl_b32 s51, s40, 4
s_lshl_b32 s52, s50, 1
s_lshl_b32 s53, s48, 8
s_cmp_lt_u32 s84, 36
s_cselect_b32 s52, s49, s52
s_cselect_b32 s53, s53, 1024
s_cselect_b32 s54, 8, 73728
s_cselect_b32 s55, 32, 8
s_cselect_b32 s56, 16, 32
s_cselect_b32 s57, 128, 64
s_mul_i32 s52, s52, 73728
s_mul_i32 s58, s40, 18432
v_and_b32 v58, 1, v7
v_bfe_u32 v59, v7, 1, 1
v_bfe_u32 v60, v7, 2, 2
v_bfe_u32 v62, v7, 4, 1
v_lshrrev_b32 v63, 5, v7
v_lshl_add_u32 v50, v58, 2, s52
v_mad_u32_u24 v50, v59, s54, v50
v_mad_u32_u24 v50, v60, s55, v50
v_mad_u32_u24 v50, v62, s56, v50
v_mad_u32_u24 v50, v63, s57, v50
v_add_u32 v50, s53, v50
v_add_u32 v50, s58, v50
v_add_u32 v62, 4608, v50
v_add_u32 v63, 9216, v50
v_add_u32 v64, 13824, v50
buffer_load_dword v8, v50, s[28:31], 0 offen offset:0
buffer_load_dword v9, v50, s[28:31], 0 offen offset:1152
buffer_load_dword v10, v50, s[28:31], 0 offen offset:2304
buffer_load_dword v11, v50, s[28:31], 0 offen offset:3456
buffer_load_dword v12, v62, s[28:31], 0 offen offset:0
buffer_load_dword v13, v62, s[28:31], 0 offen offset:1152
buffer_load_dword v14, v62, s[28:31], 0 offen offset:2304
buffer_load_dword v15, v62, s[28:31], 0 offen offset:3456
buffer_load_dword v16, v63, s[28:31], 0 offen offset:0
buffer_load_dword v17, v63, s[28:31], 0 offen offset:1152
buffer_load_dword v18, v63, s[28:31], 0 offen offset:2304
buffer_load_dword v19, v63, s[28:31], 0 offen offset:3456
buffer_load_dword v20, v64, s[28:31], 0 offen offset:0
buffer_load_dword v21, v64, s[28:31], 0 offen offset:1152
buffer_load_dword v22, v64, s[28:31], 0 offen offset:2304
buffer_load_dword v23, v64, s[28:31], 0 offen offset:3456
s_mul_i32 s52, s48, 9
s_add_u32 s52, s52, s49
s_mul_i32 s53, s52, 9
s_mul_i32 s54, s50, 18
s_add_u32 s54, s54, 8
s_lshl_b32 s55, s52, 2
s_add_u32 s55, s55, s40
s_lshl_b32 s56, s50, 2
s_add_u32 s56, s56, s40
s_cmp_eq_u32 s84, 40
s_cselect_b32 s57, 0x100000, 9
s_cmp_lt_u32 s84, 36
s_cselect_b32 s53, s53, s54
s_cselect_b32 s54, 2, 81
s_cselect_b32 s57, 1, s57
s_cselect_b32 s55, s55, s56
s_mov_b32 s56, 331776
s_cselect_b32 s56, s56, 368640
s_mov_b32 s58, 373760
s_cselect_b32 s58, s58, 382976
s_cselect_b32 s59, 16, 4
s_cselect_b32 s60, 4, 64
s_cselect_b32 s61, 12, 11
s_cselect_b32 s62, 1, 0x8001
v_lshrrev_b32 v61, 4, v7
v_lshlrev_b32 v62, 1, v58
v_lshl_add_u32 v60, v60, 2, v62
v_add_u32 v62, v60, v59
v_mul_u32_u24 v51, s54, v61
v_add_lshl_u32 v51, v51, s53, 6
v_add3_u32 v51, v51, v62, s51
v_lshl_add_u32 v51, v51, 4, s86
s_lshl_b32 s57, s57, 10
v_add_u32 v66, s57, v51
s_lshl_b32 s52, s55, 8
s_add_u32 s52, s52, s56
s_add_u32 s52, s52, s86
v_mul_u32_u24 v52, s59, v62
v_mad_u32_u24 v52, v61, s60, v52
v_lshl_add_u32 v54, v7, 2, s52
v_mov_b32 v55, 0x05040100
v_mov_b32 v62, 0x03020706
v_cmp_eq_u32 vcc, 1, v59
v_mov_b32 v68, 0xf0a0500
v_mov_b32 v69, 0x8f8a8580
v_mov_b32 v70, 0x1f1a1510
v_mov_b32 v71, 0x9f9a9590
v_mov_b32 v72, 0x2f2a2520
v_mov_b32 v73, 0xafaaa5a0
v_mov_b32 v74, 0x3f3a3530
v_mov_b32 v75, 0xbfbab5b0
v_cndmask_b32 v55, v55, v62, vcc
s_mov_b32 s64, 0x5040500
s_mov_b32 s65, 0x5040501
s_mov_b32 s66, 0x5040502
s_mov_b32 s67, 0x5040503
s_mov_b32 s68, 0x7060700
s_mov_b32 s69, 0x7060701
s_mov_b32 s70, 0x7060702
s_mov_b32 s71, 0x7060703
s_mov_b32 s72, 0x05060102
s_cmp_lg_u32 s87, 0
s_waitcnt vmcnt(12)
v_perm_b32 v24, v8, v68, s64
v_perm_b32 v25, v9, v68, s65
v_perm_b32 v26, v10, v68, s66
v_perm_b32 v27, v11, v68, s67
v_max3_f32 v28, |v24|, |v25|, |v26|
v_med3_f32 v29, |v24|, |v25|, |v26|
v_min3_f32 v30, |v24|, |v25|, |v26|
v_med3_f32 v32, v28, v29, |v27|
v_med3_f32 v33, v29, v30, |v27|
v_max_f32 v31, v28, |v27|
v_cmp_eq_u32_sdwa vcc, v33, v32 src0_sel:WORD_1 src1_sel:WORD_1
s_cbranch_scc0 L_rb0g
v_min_f32 v30, v30, |v27|
v_cndmask_b32 v31, 0, v33, vcc
v_cmp_eq_u32_sdwa vcc, v30, v32 src0_sel:WORD_1 src1_sel:WORD_1
s_nop 1
v_cndmask_b32 v32, 0, v30, vcc
L_rb0g:
v_perm_b32 v36, v31, v32, s72
v_bfi_b32 v44, 3, v32, v31
v_perm_b32 v24, v8, v69, s68
v_perm_b32 v25, v9, v69, s69
v_perm_b32 v26, v10, v69, s70
v_perm_b32 v27, v11, v69, s71
v_max3_f32 v28, |v24|, |v25|, |v26|
v_med3_f32 v29, |v24|, |v25|, |v26|
v_min3_f32 v30, |v24|, |v25|, |v26|
v_med3_f32 v32, v28, v29, |v27|
v_med3_f32 v33, v29, v30, |v27|
v_max_f32 v31, v28, |v27|
v_cmp_eq_u32_sdwa vcc, v33, v32 src0_sel:WORD_1 src1_sel:WORD_1
s_cbranch_scc0 L_rb1g
v_min_f32 v30, v30, |v27|
v_cndmask_b32 v31, 0, v33, vcc
v_cmp_eq_u32_sdwa vcc, v30, v32 src0_sel:WORD_1 src1_sel:WORD_1
s_nop 1
v_cndmask_b32 v32, 0, v30, vcc
L_rb1g:
v_perm_b32 v40, v31, v32, s72
v_bfi_b32 v46, 3, v32, v31
s_waitcnt vmcnt(8)
v_perm_b32 v24, v12, v70, s64
v_perm_b32 v25, v13, v70, s65
v_perm_b32 v26, v14, v70, s66
v_perm_b32 v27, v15, v70, s67
v_max3_f32 v28, |v24|, |v25|, |v26|
v_med3_f32 v29, |v24|, |v25|, |v26|
v_min3_f32 v30, |v24|, |v25|, |v26|
v_med3_f32 v32, v28, v29, |v27|
v_med3_f32 v33, v29, v30, |v27|
v_max_f32 v31, v28, |v27|
v_cmp_eq_u32_sdwa vcc, v33, v32 src0_sel:WORD_1 src1_sel:WORD_1
s_cbranch_scc0 L_rb2g
v_min_f32 v30, v30, |v27|
v_cndmask_b32 v31, 0, v33, vcc
v_cmp_eq_u32_sdwa vcc, v30, v32 src0_sel:WORD_1 src1_sel:WORD_1
s_nop 1
v_cndmask_b32 v32, 0, v30, vcc
L_rb2g:
v_perm_b32 v37, v31, v32, s72
v_bfi_b32 v31, 3, v32, v31
v_lshlrev_b32 v31, 4, v31
v_bfi_b32 v44, 15, v44, v31
v_perm_b32 v24, v12, v71, s68
v_perm_b32 v25, v13, v71, s69
v_perm_b32 v26, v14, v71, s70
v_perm_b32 v27, v15, v71, s71
v_max3_f32 v28, |v24|, |v25|, |v26|
v_med3_f32 v29, |v24|, |v25|, |v26|
v_min3_f32 v30, |v24|, |v25|, |v26|
v_med3_f32 v32, v28, v29, |v27|
v_med3_f32 v33, v29, v30, |v27|
v_max_f32 v31, v28, |v27|
v_cmp_eq_u32_sdwa vcc, v33, v32 src0_sel:WORD_1 src1_sel:WORD_1
s_cbranch_scc0 L_rb3g
v_min_f32 v30, v30, |v27|
v_cndmask_b32 v31, 0, v33, vcc
v_cmp_eq_u32_sdwa vcc, v30, v32 src0_sel:WORD_1 src1_sel:WORD_1
s_nop 1
v_cndmask_b32 v32, 0, v30, vcc
L_rb3g:
v_perm_b32 v41, v31, v32, s72
v_bfi_b32 v31, 3, v32, v31
v_lshlrev_b32 v31, 4, v31
v_bfi_b32 v46, 15, v46, v31
s_waitcnt vmcnt(4)
v_perm_b32 v24, v16, v72, s64
v_perm_b32 v25, v17, v72, s65
v_perm_b32 v26, v18, v72, s66
v_perm_b32 v27, v19, v72, s67
v_max3_f32 v28, |v24|, |v25|, |v26|
v_med3_f32 v29, |v24|, |v25|, |v26|
v_min3_f32 v30, |v24|, |v25|, |v26|
v_med3_f32 v32, v28, v29, |v27|
v_med3_f32 v33, v29, v30, |v27|
v_max_f32 v31, v28, |v27|
v_cmp_eq_u32_sdwa vcc, v33, v32 src0_sel:WORD_1 src1_sel:WORD_1
s_cbranch_scc0 L_rb4g
v_min_f32 v30, v30, |v27|
v_cndmask_b32 v31, 0, v33, vcc
v_cmp_eq_u32_sdwa vcc, v30, v32 src0_sel:WORD_1 src1_sel:WORD_1
s_nop 1
v_cndmask_b32 v32, 0, v30, vcc
L_rb4g:
v_perm_b32 v38, v31, v32, s72
v_bfi_b32 v45, 3, v32, v31
v_perm_b32 v24, v16, v73, s68
v_perm_b32 v25, v17, v73, s69
v_perm_b32 v26, v18, v73, s70
v_perm_b32 v27, v19, v73, s71
v_max3_f32 v28, |v24|, |v25|, |v26|
v_med3_f32 v29, |v24|, |v25|, |v26|
v_min3_f32 v30, |v24|, |v25|, |v26|
v_med3_f32 v32, v28, v29, |v27|
v_med3_f32 v33, v29, v30, |v27|
v_max_f32 v31, v28, |v27|
v_cmp_eq_u32_sdwa vcc, v33, v32 src0_sel:WORD_1 src1_sel:WORD_1
s_cbranch_scc0 L_rb5g
v_min_f32 v30, v30, |v27|
v_cndmask_b32 v31, 0, v33, vcc
v_cmp_eq_u32_sdwa vcc, v30, v32 src0_sel:WORD_1 src1_sel:WORD_1
s_nop 1
v_cndmask_b32 v32, 0, v30, vcc
L_rb5g:
v_perm_b32 v42, v31, v32, s72
v_bfi_b32 v47, 3, v32, v31
s_waitcnt vmcnt(0)
v_perm_b32 v24, v20, v74, s64
v_perm_b32 v25, v21, v74, s65
v_perm_b32 v26, v22, v74, s66
v_perm_b32 v27, v23, v74, s67
v_max3_f32 v28, |v24|, |v25|, |v26|
v_med3_f32 v29, |v24|, |v25|, |v26|
v_min3_f32 v30, |v24|, |v25|, |v26|
v_med3_f32 v32, v28, v29, |v27|
v_med3_f32 v33, v29, v30, |v27|
v_max_f32 v31, v28, |v27|
v_cmp_eq_u32_sdwa vcc, v33, v32 src0_sel:WORD_1 src1_sel:WORD_1
s_cbranch_scc0 L_rb6g
v_min_f32 v30, v30, |v27|
v_cndmask_b32 v31, 0, v33, vcc
v_cmp_eq_u32_sdwa vcc, v30, v32 src0_sel:WORD_1 src1_sel:WORD_1
s_nop 1
v_cndmask_b32 v32, 0, v30, vcc
L_rb6g:
v_perm_b32 v39, v31, v32, s72
v_bfi_b32 v31, 3, v32, v31
v_lshlrev_b32 v31, 4, v31
v_bfi_b32 v45, 15, v45, v31
v_perm_b32 v24, v20, v75, s68
v_perm_b32 v25, v21, v75, s69
v_perm_b32 v26, v22, v75, s70
v_perm_b32 v27, v23, v75, s71
v_max3_f32 v28, |v24|, |v25|, |v26|
v_med3_f32 v29, |v24|, |v25|, |v26|
v_min3_f32 v30, |v24|, |v25|, |v26|
v_med3_f32 v32, v28, v29, |v27|
v_med3_f32 v33, v29, v30, |v27|
v_max_f32 v31, v28, |v27|
v_cmp_eq_u32_sdwa vcc, v33, v32 src0_sel:WORD_1 src1_sel:WORD_1
s_cbranch_scc0 L_rb7g
v_min_f32 v30, v30, |v27|
v_cndmask_b32 v31, 0, v33, vcc
v_cmp_eq_u32_sdwa vcc, v30, v32 src0_sel:WORD_1 src1_sel:WORD_1
s_nop 1
v_cndmask_b32 v32, 0, v30, vcc
L_rb7g:
v_perm_b32 v43, v31, v32, s72
v_bfi_b32 v31, 3, v32, v31
v_lshlrev_b32 v31, 4, v31
v_bfi_b32 v47, 15, v47, v31
s_mov_b32 vcc_lo, 0x33333333
s_mov_b32 vcc_hi, 0x33333333
v_cndmask_b32_dpp v24, v40, v36, vcc quad_perm:[2,3,0,1] row_mask:0xf bank_mask:0xf
v_cndmask_b32_dpp v25, v41, v37, vcc quad_perm:[2,3,0,1] row_mask:0xf bank_mask:0xf
v_cndmask_b32_dpp v26, v42, v38, vcc quad_perm:[2,3,0,1] row_mask:0xf bank_mask:0xf
v_cndmask_b32_dpp v27, v43, v39, vcc quad_perm:[2,3,0,1] row_mask:0xf bank_mask:0xf
s_not_b64 vcc, vcc
buffer_store_dwordx4 v[24:27], v51, s[24:27], 0 offen sc1
v_cndmask_b32_dpp v40, v36, v40, vcc quad_perm:[2,3,0,1] row_mask:0xf bank_mask:0xf
v_cndmask_b32_dpp v41, v37, v41, vcc quad_perm:[2,3,0,1] row_mask:0xf bank_mask:0xf
v_cndmask_b32_dpp v42, v38, v42, vcc quad_perm:[2,3,0,1] row_mask:0xf bank_mask:0xf
v_cndmask_b32_dpp v43, v39, v43, vcc quad_perm:[2,3,0,1] row_mask:0xf bank_mask:0xf
s_mov_b32 s52, 0x0c0c0400
s_mov_b32 s53, 0x04000c0c
buffer_store_dwordx4 v[40:43], v66, s[24:27], 0 offen sc1
v_perm_b32 v48, v45, v44, s52
v_perm_b32 v49, v47, v46, s53
v_or_b32 v48, v48, v49
s_nop 1
v_mov_b32_dpp v49, v48 quad_perm:[2,3,0,1] row_mask:0xf bank_mask:0xf
v_perm_b32 v48, v49, v48, v55
ds_permute_b32 v48, v52, v48
s_waitcnt lgkmcnt(0)
buffer_store_dword v48, v54, s[24:27], 0 offen sc1
s_waitcnt vmcnt(0)
s_add_u32 s84, s84, 1
s_cmp_lt_u32 s84, 41
s_cbranch_scc1 L_st
s_add_u32 s87, s87, 1
s_cmp_lt_u32 s87, 2
s_cbranch_scc1 L_sm
v_lshrrev_b32 v72, 3, v7
v_and_b32 v73, 7, v7
v_xor_b32 v73, v73, v72
v_mul_u32_u24 v72, 1152, v72
s_and_b32 s47, s40, 1
s_mul_i32 s47, s47, 9216
s_lshr_b32 s3, s40, 1
s_lshl_b32 s3, s3, 7
s_add_u32 s47, s47, s3
v_lshl_add_u32 v72, v73, 4, v72
v_add_u32 v3, s47, v72
s_lshl_b32 s44, s40, 10
s_mul_i32 s45, s2, 18432
s_mov_b32 s46, s45
s_lshr_b32 s47, s40, 1
s_lshl_b32 s3, s47, 11
s_sub_u32 s8, 15488, s3
s_lshl_b32 s3, s47, 7
s_add_u32 s7, s45, 128
s_sub_u32 s7, s7, s3
s_sub_u32 s10, s47, 1
s_sub_u32 s11, 0, s47
s_mov_b32 s9, s44
s_mov_b32 s13, 4718592
s_mov_b32 s15, 16
s_mov_b32 s14, s13
s_mov_b32 s22, 75497472
s_mov_b32 s18, 75497472
s_mov_b32 s41, 0
s_bitcmp1_b32 s2, 0
s_cselect_b32 s15, 16, 22
L_stile:
s_barrier
s_add_u32 m0, s44, 0
s_nop 0
buffer_load_dwordx4 v3, s[16:19], s45 offen offset:0 nt lds
s_add_u32 m0, s44, 3840
s_nop 0
buffer_load_dwordx4 v3, s[16:19], s45 offen offset:256 nt lds
s_add_u32 m0, s44, 7680
s_nop 0
buffer_load_dwordx4 v3, s[16:19], s45 offen offset:512 nt lds
s_add_u32 m0, s44, 11520
s_nop 0
buffer_load_dwordx4 v3, s[16:19], s45 offen offset:768 nt lds
s_add_u32 m0, s44, s8
s_mov_b64 exec, s[10:11]
buffer_load_dwordx4 v3, s[16:19], s7 offen offset:896 nt lds
s_mov_b64 exec, -1
ds_read_b128 v[8:11], v2 offset:1024
ds_read_b128 v[12:15], v2 offset:1088
ds_read_b128 v[16:19], v2 offset:1152
ds_read_b128 v[20:23], v2 offset:1216
ds_read_b128 v[24:27], v2 offset:1280
ds_read_b128 v[28:31], v2 offset:1344
ds_read_b128 v[32:35], v2 offset:1408
ds_read_b128 v[36:39], v2 offset:1472
ds_read_b128 v[40:43], v2 offset:1536
s_mov_b32 s87, 0
L_spass:
s_lshl_b32 s86, s2, 1
s_add_u32 s86, s86, s87
s_add_u32 s86, s86, 2
s_mul_i32 s86, s86, 393216
s_mul_i32 s47, s40, 82944
s_add_u32 s47, s47, s86
v_lshl_add_u32 v104, v7, 4, s47
s_mul_i32 s47, s40, 9216
s_add_u32 s47, s47, s86
s_add_u32 s47, s47, 331776
v_lshl_add_u32 v105, v7, 4, s47
s_lshl_b32 s47, s40, 6
s_add_u32 s47, s47, s86
s_add_u32 s47, s47, 368640
v_and_b32 v106, 15, v7
v_lshl_add_u32 v106, v106, 2, s47
v_lshrrev_b32 v107, 4, v7
v_lshl_add_u32 v106, v107, 8, v106
buffer_load_dword v174, v106, s[24:27], 0 offen offset:0 sc1
buffer_load_dword v175, v106, s[24:27], 0 offen offset:1024 sc1
buffer_load_dword v176, v106, s[24:27], 0 offen offset:2048 sc1
buffer_load_dword v177, v106, s[24:27], 0 offen offset:3072 sc1
s_mov_b32 s99, 4096
buffer_load_dword v178, v106, s[24:27], s99 offen offset:0 sc1
s_mov_b32 s98, 0
buffer_load_dwordx4 v[138:141], v105, s[24:27], s98 offen sc1
s_mov_b32 s99, 0
buffer_load_dwordx4 a[0:3], v104, s[24:27], s99 offen offset:0 sc1
buffer_load_dwordx4 a[4:7], v104, s[24:27], s99 offen offset:1024 sc1
buffer_load_dwordx4 a[8:11], v104, s[24:27], s99 offen offset:2048 sc1
buffer_load_dwordx4 a[12:15], v104, s[24:27], s99 offen offset:3072 sc1
s_mov_b32 s99, 4096
buffer_load_dwordx4 a[16:19], v104, s[24:27], s99 offen offset:0 sc1
buffer_load_dwordx4 a[20:23], v104, s[24:27], s99 offen offset:1024 sc1
buffer_load_dwordx4 a[24:27], v104, s[24:27], s99 offen offset:2048 sc1
buffer_load_dwordx4 a[28:31], v104, s[24:27], s99 offen offset:3072 sc1
s_mov_b32 s99, 8192
buffer_load_dwordx4 a[32:35], v104, s[24:27], s99 offen offset:0 sc1
s_mov_b32 s98, 1024
buffer_load_dwordx4 v[142:145], v105, s[24:27], s98 offen sc1
buffer_load_dwordx4 a[36:39], v104, s[24:27], s99 offen offset:1024 sc1
buffer_load_dwordx4 a[40:43], v104, s[24:27], s99 offen offset:2048 sc1
buffer_load_dwordx4 a[44:47], v104, s[24:27], s99 offen offset:3072 sc1
s_mov_b32 s99, 12288
buffer_load_dwordx4 a[48:51], v104, s[24:27], s99 offen offset:0 sc1
buffer_load_dwordx4 a[52:55], v104, s[24:27], s99 offen offset:1024 sc1
buffer_load_dwordx4 a[56:59], v104, s[24:27], s99 offen offset:2048 sc1
buffer_load_dwordx4 a[60:63], v104, s[24:27], s99 offen offset:3072 sc1
s_mov_b32 s99, 16384
buffer_load_dwordx4 a[64:67], v104, s[24:27], s99 offen offset:0 sc1
buffer_load_dwordx4 a[68:71], v104, s[24:27], s99 offen offset:1024 sc1
s_mov_b32 s98, 2048
buffer_load_dwordx4 v[146:149], v105, s[24:27], s98 offen sc1
buffer_load_dwordx4 a[72:75], v104, s[24:27], s99 offen offset:2048 sc1
buffer_load_dwordx4 a[76:79], v104, s[24:27], s99 offen offset:3072 sc1
s_mov_b32 s99, 20480
buffer_load_dwordx4 a[80:83], v104, s[24:27], s99 offen offset:0 sc1
buffer_load_dwordx4 a[84:87], v104, s[24:27], s99 offen offset:1024 sc1
buffer_load_dwordx4 a[88:91], v104, s[24:27], s99 offen offset:2048 sc1
buffer_load_dwordx4 a[92:95], v104, s[24:27], s99 offen offset:3072 sc1
s_mov_b32 s99, 24576
buffer_load_dwordx4 a[96:99], v104, s[24:27], s99 offen offset:0 sc1
buffer_load_dwordx4 a[100:103], v104, s[24:27], s99 offen offset:1024 sc1
buffer_load_dwordx4 a[104:107], v104, s[24:27], s99 offen offset:2048 sc1
s_mov_b32 s98, 3072
buffer_load_dwordx4 v[150:153], v105, s[24:27], s98 offen sc1
buffer_load_dwordx4 a[108:111], v104, s[24:27], s99 offen offset:3072 sc1
s_mov_b32 s99, 28672
buffer_load_dwordx4 a[112:115], v104, s[24:27], s99 offen offset:0 sc1
buffer_load_dwordx4 a[116:119], v104, s[24:27], s99 offen offset:1024 sc1
buffer_load_dwordx4 a[120:123], v104, s[24:27], s99 offen offset:2048 sc1
buffer_load_dwordx4 a[124:127], v104, s[24:27], s99 offen offset:3072 sc1
s_mov_b32 s99, 32768
buffer_load_dwordx4 a[128:131], v104, s[24:27], s99 offen offset:0 sc1
buffer_load_dwordx4 a[132:135], v104, s[24:27], s99 offen offset:1024 sc1
buffer_load_dwordx4 a[136:139], v104, s[24:27], s99 offen offset:2048 sc1
buffer_load_dwordx4 a[140:143], v104, s[24:27], s99 offen offset:3072 sc1
s_mov_b32 s98, 4096
buffer_load_dwordx4 v[154:157], v105, s[24:27], s98 offen sc1
s_mov_b32 s99, 36864
buffer_load_dwordx4 a[144:147], v104, s[24:27], s99 offen offset:0 sc1
buffer_load_dwordx4 a[148:151], v104, s[24:27], s99 offen offset:1024 sc1
buffer_load_dwordx4 a[152:155], v104, s[24:27], s99 offen offset:2048 sc1
buffer_load_dwordx4 a[156:159], v104, s[24:27], s99 offen offset:3072 sc1
s_mov_b32 s99, 40960
buffer_load_dwordx4 a[160:163], v104, s[24:27], s99 offen offset:0 sc1
buffer_load_dwordx4 a[164:167], v104, s[24:27], s99 offen offset:1024 sc1
buffer_load_dwordx4 a[168:171], v104, s[24:27], s99 offen offset:2048 sc1
buffer_load_dwordx4 a[172:175], v104, s[24:27], s99 offen offset:3072 sc1
s_mov_b32 s99, 45056
buffer_load_dwordx4 a[176:179], v104, s[24:27], s99 offen offset:0 sc1
s_mov_b32 s98, 5120
buffer_load_dwordx4 v[158:161], v105, s[24:27], s98 offen sc1
buffer_load_dwordx4 a[180:183], v104, s[24:27], s99 offen offset:1024 sc1
buffer_load_dwordx4 a[184:187], v104, s[24:27], s99 offen offset:2048 sc1
buffer_load_dwordx4 a[188:191], v104, s[24:27], s99 offen offset:3072 sc1
s_mov_b32 s99, 49152
buffer_load_dwordx4 a[192:195], v104, s[24:27], s99 offen offset:0 sc1
buffer_load_dwordx4 a[196:199], v104, s[24:27], s99 offen offset:1024 sc1
buffer_load_dwordx4 a[200:203], v104, s[24:27], s99 offen offset:2048 sc1
buffer_load_dwordx4 a[204:207], v104, s[24:27], s99 offen offset:3072 sc1
s_mov_b32 s99, 53248
buffer_load_dwordx4 a[208:211], v104, s[24:27], s99 offen offset:0 sc1
buffer_load_dwordx4 a[212:215], v104, s[24:27], s99 offen offset:1024 sc1
s_mov_b32 s98, 6144
buffer_load_dwordx4 v[162:165], v105, s[24:27], s98 offen sc1
buffer_load_dwordx4 a[216:219], v104, s[24:27], s99 offen offset:2048 sc1
buffer_load_dwordx4 a[220:223], v104, s[24:27], s99 offen offset:3072 sc1
s_mov_b32 s99, 57344
buffer_load_dwordx4 a[224:227], v104, s[24:27], s99 offen offset:0 sc1
buffer_load_dwordx4 a[228:231], v104, s[24:27], s99 offen offset:1024 sc1
buffer_load_dwordx4 a[232:235], v104, s[24:27], s99 offen offset:2048 sc1
buffer_load_dwordx4 a[236:239], v104, s[24:27], s99 offen offset:3072 sc1
s_mov_b32 s99, 61440
buffer_load_dwordx4 a[240:243], v104, s[24:27], s99 offen offset:0 sc1
buffer_load_dwordx4 a[244:247], v104, s[24:27], s99 offen offset:1024 sc1
buffer_load_dwordx4 a[248:251], v104, s[24:27], s99 offen offset:2048 sc1
s_mov_b32 s98, 7168
buffer_load_dwordx4 v[166:169], v105, s[24:27], s98 offen sc1
buffer_load_dwordx4 a[252:255], v104, s[24:27], s99 offen offset:3072 sc1
s_mov_b32 s99, 65536
buffer_load_dwordx4 v[186:189], v104, s[24:27], s99 offen offset:0 sc1
buffer_load_dwordx4 v[190:193], v104, s[24:27], s99 offen offset:1024 sc1
buffer_load_dwordx4 v[194:197], v104, s[24:27], s99 offen offset:2048 sc1
buffer_load_dwordx4 v[198:201], v104, s[24:27], s99 offen offset:3072 sc1
s_mov_b32 s99, 69632
buffer_load_dwordx4 v[202:205], v104, s[24:27], s99 offen offset:0 sc1
buffer_load_dwordx4 v[206:209], v104, s[24:27], s99 offen offset:1024 sc1
buffer_load_dwordx4 v[210:213], v104, s[24:27], s99 offen offset:2048 sc1
buffer_load_dwordx4 v[214:217], v104, s[24:27], s99 offen offset:3072 sc1
s_mov_b32 s98, 8192
buffer_load_dwordx4 v[170:173], v105, s[24:27], s98 offen sc1
s_mov_b32 s99, 73728
buffer_load_dwordx4 v[218:221], v104, s[24:27], s99 offen offset:0 sc1
buffer_load_dwordx4 v[222:225], v104, s[24:27], s99 offen offset:1024 sc1
buffer_load_dwordx4 v[226:229], v104, s[24:27], s99 offen offset:2048 sc1
buffer_load_dwordx4 v[230:233], v104, s[24:27], s99 offen offset:3072 sc1
s_mov_b32 s99, 77824
buffer_load_dwordx4 v[234:237], v104, s[24:27], s99 offen offset:0 sc1
buffer_load_dwordx4 v[238:241], v104, s[24:27], s99 offen offset:1024 sc1
buffer_load_dwordx4 v[242:245], v104, s[24:27], s99 offen offset:2048 sc1
buffer_load_dwordx4 v[246:249], v104, s[24:27], s99 offen offset:3072 sc1
s_mov_b32 s99, 81920
buffer_load_dwordx4 v[250:253], v104, s[24:27], s99 offen offset:0 sc1
s_waitcnt vmcnt(0)
s_barrier
ds_read_b128 v[44:47], v0 offset:0
ds_read_b128 v[48:51], v1 offset:0
s_waitcnt lgkmcnt(0)
v_smfmac_f32_16x16x64_bf16 v[8:11], a[0:3], v[44:51], v138
v_smfmac_f32_16x16x64_bf16 v[12:15], a[4:7], v[44:51], v138 abid:1
v_smfmac_f32_16x16x64_bf16 v[16:19], a[8:11], v[44:51], v139
v_smfmac_f32_16x16x64_bf16 v[20:23], a[12:15], v[44:51], v139 abid:1
v_smfmac_f32_16x16x64_bf16 v[24:27], a[16:19], v[44:51], v140
v_smfmac_f32_16x16x64_bf16 v[28:31], a[20:23], v[44:51], v140 abid:1
v_smfmac_f32_16x16x64_bf16 v[32:35], a[24:27], v[44:51], v141
v_smfmac_f32_16x16x64_bf16 v[36:39], a[28:31], v[44:51], v141 abid:1
v_smfmac_f32_16x16x64_bf16 v[40:43], a[32:35], v[44:51], v174
s_nop 7
ds_read_b128 v[44:47], v0 offset:2048
ds_read_b128 v[48:51], v1 offset:2048
s_waitcnt lgkmcnt(0)
v_smfmac_f32_16x16x64_bf16 v[8:11], a[36:39], v[44:51], v142
v_smfmac_f32_16x16x64_bf16 v[12:15], a[40:43], v[44:51], v142 abid:1
v_smfmac_f32_16x16x64_bf16 v[16:19], a[44:47], v[44:51], v143
v_smfmac_f32_16x16x64_bf16 v[20:23], a[48:51], v[44:51], v143 abid:1
v_smfmac_f32_16x16x64_bf16 v[24:27], a[52:55], v[44:51], v144
v_smfmac_f32_16x16x64_bf16 v[28:31], a[56:59], v[44:51], v144 abid:1
v_smfmac_f32_16x16x64_bf16 v[32:35], a[60:63], v[44:51], v145
v_smfmac_f32_16x16x64_bf16 v[36:39], a[64:67], v[44:51], v145 abid:1
v_smfmac_f32_16x16x64_bf16 v[40:43], a[68:71], v[44:51], v174 abid:1
s_nop 7
ds_read_b128 v[44:47], v0 offset:4096
ds_read_b128 v[48:51], v1 offset:4096
s_waitcnt lgkmcnt(0)
v_smfmac_f32_16x16x64_bf16 v[8:11], a[72:75], v[44:51], v146
v_smfmac_f32_16x16x64_bf16 v[12:15], a[76:79], v[44:51], v146 abid:1
v_smfmac_f32_16x16x64_bf16 v[16:19], a[80:83], v[44:51], v147
v_smfmac_f32_16x16x64_bf16 v[20:23], a[84:87], v[44:51], v147 abid:1
v_smfmac_f32_16x16x64_bf16 v[24:27], a[88:91], v[44:51], v148
v_smfmac_f32_16x16x64_bf16 v[28:31], a[92:95], v[44:51], v148 abid:1
v_smfmac_f32_16x16x64_bf16 v[32:35], a[96:99], v[44:51], v149
v_smfmac_f32_16x16x64_bf16 v[36:39], a[100:103], v[44:51], v149 abid:1
v_smfmac_f32_16x16x64_bf16 v[40:43], a[104:107], v[44:51], v175
s_nop 7
ds_read_b128 v[44:47], v0 offset:6144
ds_read_b128 v[48:51], v1 offset:6144
s_waitcnt lgkmcnt(0)
v_smfmac_f32_16x16x64_bf16 v[8:11], a[108:111], v[44:51], v150
v_smfmac_f32_16x16x64_bf16 v[12:15], a[112:115], v[44:51], v150 abid:1
v_smfmac_f32_16x16x64_bf16 v[16:19], a[116:119], v[44:51], v151
v_smfmac_f32_16x16x64_bf16 v[20:23], a[120:123], v[44:51], v151 abid:1
v_smfmac_f32_16x16x64_bf16 v[24:27], a[124:127], v[44:51], v152
v_smfmac_f32_16x16x64_bf16 v[28:31], a[128:131], v[44:51], v152 abid:1
v_smfmac_f32_16x16x64_bf16 v[32:35], a[132:135], v[44:51], v153
v_smfmac_f32_16x16x64_bf16 v[36:39], a[136:139], v[44:51], v153 abid:1
v_smfmac_f32_16x16x64_bf16 v[40:43], a[140:143], v[44:51], v175 abid:1
s_nop 7
ds_read_b128 v[44:47], v0 offset:8192
ds_read_b128 v[48:51], v1 offset:8192
s_waitcnt lgkmcnt(0)
v_smfmac_f32_16x16x64_bf16 v[8:11], a[144:147], v[44:51], v154
v_smfmac_f32_16x16x64_bf16 v[12:15], a[148:151], v[44:51], v154 abid:1
v_smfmac_f32_16x16x64_bf16 v[16:19], a[152:155], v[44:51], v155
v_smfmac_f32_16x16x64_bf16 v[20:23], a[156:159], v[44:51], v155 abid:1
v_smfmac_f32_16x16x64_bf16 v[24:27], a[160:163], v[44:51], v156
v_smfmac_f32_16x16x64_bf16 v[28:31], a[164:167], v[44:51], v156 abid:1
v_smfmac_f32_16x16x64_bf16 v[32:35], a[168:171], v[44:51], v157
v_smfmac_f32_16x16x64_bf16 v[36:39], a[172:175], v[44:51], v157 abid:1
v_smfmac_f32_16x16x64_bf16 v[40:43], a[176:179], v[44:51], v176
s_nop 7
ds_read_b128 v[44:47], v0 offset:10240
ds_read_b128 v[48:51], v1 offset:10240
s_waitcnt lgkmcnt(0)
v_smfmac_f32_16x16x64_bf16 v[8:11], a[180:183], v[44:51], v158
v_smfmac_f32_16x16x64_bf16 v[12:15], a[184:187], v[44:51], v158 abid:1
v_smfmac_f32_16x16x64_bf16 v[16:19], a[188:191], v[44:51], v159
v_smfmac_f32_16x16x64_bf16 v[20:23], a[192:195], v[44:51], v159 abid:1
v_smfmac_f32_16x16x64_bf16 v[24:27], a[196:199], v[44:51], v160
v_smfmac_f32_16x16x64_bf16 v[28:31], a[200:203], v[44:51], v160 abid:1
v_smfmac_f32_16x16x64_bf16 v[32:35], a[204:207], v[44:51], v161
v_smfmac_f32_16x16x64_bf16 v[36:39], a[208:211], v[44:51], v161 abid:1
v_smfmac_f32_16x16x64_bf16 v[40:43], a[212:215], v[44:51], v176 abid:1
s_nop 7
ds_read_b128 v[44:47], v0 offset:12288
ds_read_b128 v[48:51], v1 offset:12288
s_waitcnt lgkmcnt(0)
v_smfmac_f32_16x16x64_bf16 v[8:11], a[216:219], v[44:51], v162
v_smfmac_f32_16x16x64_bf16 v[12:15], a[220:223], v[44:51], v162 abid:1
v_smfmac_f32_16x16x64_bf16 v[16:19], a[224:227], v[44:51], v163
v_smfmac_f32_16x16x64_bf16 v[20:23], a[228:231], v[44:51], v163 abid:1
v_smfmac_f32_16x16x64_bf16 v[24:27], a[232:235], v[44:51], v164
v_smfmac_f32_16x16x64_bf16 v[28:31], a[236:239], v[44:51], v164 abid:1
v_smfmac_f32_16x16x64_bf16 v[32:35], a[240:243], v[44:51], v165
v_smfmac_f32_16x16x64_bf16 v[36:39], a[244:247], v[44:51], v165 abid:1
v_smfmac_f32_16x16x64_bf16 v[40:43], a[248:251], v[44:51], v177
s_nop 7
ds_read_b128 v[44:47], v0 offset:14336
ds_read_b128 v[48:51], v1 offset:14336
s_waitcnt lgkmcnt(0)
v_smfmac_f32_16x16x64_bf16 v[8:11], a[252:255], v[44:51], v166
v_smfmac_f32_16x16x64_bf16 v[12:15], v[186:189], v[44:51], v166 abid:1
v_smfmac_f32_16x16x64_bf16 v[16:19], v[190:193], v[44:51], v167
v_smfmac_f32_16x16x64_bf16 v[20:23], v[194:197], v[44:51], v167 abid:1
v_smfmac_f32_16x16x64_bf16 v[24:27], v[198:201], v[44:51], v168
v_smfmac_f32_16x16x64_bf16 v[28:31], v[202:205], v[44:51], v168 abid:1
v_smfmac_f32_16x16x64_bf16 v[32:35], v[206:209], v[44:51], v169
v_smfmac_f32_16x16x64_bf16 v[36:39], v[210:213], v[44:51], v169 abid:1
v_smfmac_f32_16x16x64_bf16 v[40:43], v[214:217], v[44:51], v177 abid:1
s_nop 7
ds_read_b128 v[44:47], v0 offset:16384
ds_read_b128 v[48:51], v1 offset:16384
s_waitcnt lgkmcnt(0)
v_smfmac_f32_16x16x64_bf16 v[8:11], v[218:221], v[44:51], v170
v_smfmac_f32_16x16x64_bf16 v[12:15], v[222:225], v[44:51], v170 abid:1
v_smfmac_f32_16x16x64_bf16 v[16:19], v[226:229], v[44:51], v171
v_smfmac_f32_16x16x64_bf16 v[20:23], v[230:233], v[44:51], v171 abid:1
v_smfmac_f32_16x16x64_bf16 v[24:27], v[234:237], v[44:51], v172
v_smfmac_f32_16x16x64_bf16 v[28:31], v[238:241], v[44:51], v172 abid:1
v_smfmac_f32_16x16x64_bf16 v[32:35], v[242:245], v[44:51], v173
v_smfmac_f32_16x16x64_bf16 v[36:39], v[246:249], v[44:51], v173 abid:1
v_smfmac_f32_16x16x64_bf16 v[40:43], v[250:253], v[44:51], v178
s_nop 7
s_add_u32 s87, s87, 1
s_cmp_lt_u32 s87, 2
s_cbranch_scc1 L_spass
v_cvt_pk_bf16_f32 v92, v8, v9
v_cvt_pk_bf16_f32 v93, v10, v11
v_cvt_pk_bf16_f32 v94, v12, v13
v_cvt_pk_bf16_f32 v95, v14, v15
v_cvt_pk_bf16_f32 v96, v16, v17
v_cvt_pk_bf16_f32 v97, v18, v19
v_cvt_pk_bf16_f32 v98, v20, v21
v_cvt_pk_bf16_f32 v99, v22, v23
v_cvt_pk_bf16_f32 v100, v24, v25
v_cvt_pk_bf16_f32 v101, v26, v27
v_cvt_pk_bf16_f32 v102, v28, v29
v_cvt_pk_bf16_f32 v103, v30, v31
v_cvt_pk_bf16_f32 v104, v32, v33
v_cvt_pk_bf16_f32 v105, v34, v35
s_mov_b64 vcc, s[80:81]
s_nop 0
v_cndmask_b32_dpp v108, v96, v92, vcc quad_perm:[1,0,3,2] row_mask:0xf bank_mask:0xf
v_cndmask_b32_dpp v109, v97, v93, vcc quad_perm:[1,0,3,2] row_mask:0xf bank_mask:0xf
v_cndmask_b32_dpp v110, v98, v94, vcc quad_perm:[1,0,3,2] row_mask:0xf bank_mask:0xf
v_cndmask_b32_dpp v111, v99, v95, vcc quad_perm:[1,0,3,2] row_mask:0xf bank_mask:0xf
buffer_store_dwordx4 v[108:111], v4, s[20:23], s46 offen offset:0 sc1
s_mov_b64 vcc, s[82:83]
v_cvt_pk_bf16_f32 v112, v40, v41
v_cvt_pk_bf16_f32 v113, v42, v43
ds_bpermute_b32 v112, v6, v112
ds_bpermute_b32 v113, v6, v113
v_cndmask_b32_dpp v96, v92, v96, vcc quad_perm:[1,0,3,2] row_mask:0xf bank_mask:0xf
v_cndmask_b32_dpp v97, v93, v97, vcc quad_perm:[1,0,3,2] row_mask:0xf bank_mask:0xf
v_cndmask_b32_dpp v98, v94, v98, vcc quad_perm:[1,0,3,2] row_mask:0xf bank_mask:0xf
v_cndmask_b32_dpp v99, v95, v99, vcc quad_perm:[1,0,3,2] row_mask:0xf bank_mask:0xf
buffer_store_dwordx4 v[96:99], v4, s[20:23], s46 offen offset:1152 sc1
s_mov_b64 vcc, s[80:81]
v_cvt_pk_bf16_f32 v106, v36, v37
v_cvt_pk_bf16_f32 v107, v38, v39
v_cndmask_b32_dpp v92, v104, v100, vcc quad_perm:[1,0,3,2] row_mask:0xf bank_mask:0xf
v_cndmask_b32_dpp v93, v105, v101, vcc quad_perm:[1,0,3,2] row_mask:0xf bank_mask:0xf
v_cndmask_b32_dpp v94, v106, v102, vcc quad_perm:[1,0,3,2] row_mask:0xf bank_mask:0xf
v_cndmask_b32_dpp v95, v107, v103, vcc quad_perm:[1,0,3,2] row_mask:0xf bank_mask:0xf
buffer_store_dwordx4 v[92:95], v4, s[20:23], s46 offen offset:128 sc1
s_mov_b64 vcc, s[82:83]
v_cndmask_b32_dpp v104, v100, v104, vcc quad_perm:[1,0,3,2] row_mask:0xf bank_mask:0xf
v_cndmask_b32_dpp v105, v101, v105, vcc quad_perm:[1,0,3,2] row_mask:0xf bank_mask:0xf
v_cndmask_b32_dpp v106, v102, v106, vcc quad_perm:[1,0,3,2] row_mask:0xf bank_mask:0xf
v_cndmask_b32_dpp v107, v103, v107, vcc quad_perm:[1,0,3,2] row_mask:0xf bank_mask:0xf
buffer_store_dwordx4 v[104:107], v4, s[20:23], s46 offen offset:1280 sc1
s_mov_b64 vcc, s[80:81]
s_waitcnt lgkmcnt(0)
buffer_store_dwordx2 v[112:113], v5, s[20:23], s46 offen
s_cmp_eq_u32 s41, 15
s_cselect_b32 s13, -23574528, s13
s_add_u32 s45, s45, s13
s_add_u32 s7, s7, s13
s_add_u32 s46, s46, s13
s_mov_b32 s13, 4718592
s_add_u32 s41, s41, 1
s_cmp_lt_u32 s41, s15
s_cbranch_scc1 L_stile
s_branch L_fin
.section .rodata,"a"
.p2align 6
.amdhsa_kernel standalone__structured_sparse_n_m__ragged_kernel
  .amdhsa_next_free_vgpr 512
  .amdhsa_next_free_sgpr 102
  .amdhsa_accum_offset 256
  .amdhsa_group_segment_fixed_size 0
  .amdhsa_float_denorm_mode_32 3
  .amdhsa_kernarg_size 48
  .amdhsa_user_sgpr_count 2
  .amdhsa_user_sgpr_kernarg_segment_ptr 1
  .amdhsa_system_sgpr_workgroup_id_x 1
.end_amdhsa_kernel
```

```asm
; @launch grid=(256,1,1) block=(256,1,1) lds=163840
.amdgcn_target "amdgcn-amd-amdhsa--gfx950"
.text
.globl standalone__structured_sparse_n_m__ragged_kernel
.p2align 8
.type standalone__structured_sparse_n_m__ragged_kernel,@function
standalone__structured_sparse_n_m__ragged_kernel:
s_load_dwordx8 s[4:11], s[0:1], 0
s_load_dwordx4 s[12:15], s[0:1], 32
s_cmp_ge_u32 s2, 256
s_cbranch_scc1 L_end_standalone__structured_sparse_n_m__ragged_kernel
v_lshrrev_b32 v1, 6, v0
v_and_b32 v7, 63, v0
v_readfirstlane_b32 s40, v1
s_mov_b32 s86, 0
s_lshr_b32 s84, s2, 6
s_and_b32 s47, s2, 9
s_lshl1_add_u32 s84, s84, s47
s_bfe_u32 s3, s2, 0x20004
s_lshl2_add_u32 s84, s84, s3
s_and_b32 s47, s2, 7
s_cmp_lt_u32 s47, 2
s_cselect_b32 s84, s84, 63
s_cmp_lt_u32 s84, 41
s_cbranch_scc1 L_prod
v_lshlrev_b32 v3, 7, v0
s_getpc_b64 s[96:97]
v_min_u32 v2, L_slow-standalone__structured_sparse_n_m__ragged_kernel, v3
global_load_dword v120, v2, s[96:97]
s_branch L_cons
L_prod:
s_and_b32 s48, s84, 3
s_lshr_b32 s49, s84, 2
s_sub_u32 s50, s84, 36
s_lshl_b32 s51, s40, 4
s_lshl_b32 s52, s50, 1
s_lshl_b32 s53, s48, 8
s_cmp_lt_u32 s84, 36
s_cselect_b32 s52, s49, s52
s_cselect_b32 s53, s53, 1024
s_cselect_b32 s54, 8, 73728
s_cselect_b32 s55, 32, 8
s_cselect_b32 s56, 16, 32
s_cselect_b32 s57, 128, 64
s_mul_i32 s52, s52, 73728
s_mul_i32 s58, s40, 18432
v_and_b32 v58, 1, v7
v_bfe_u32 v59, v7, 1, 1
v_bfe_u32 v60, v7, 2, 2
v_bfe_u32 v62, v7, 4, 1
v_lshrrev_b32 v63, 5, v7
v_lshl_add_u32 v50, v58, 2, s52
v_mad_u32_u24 v50, v59, s54, v50
v_mad_u32_u24 v50, v60, s55, v50
v_mad_u32_u24 v50, v62, s56, v50
v_mad_u32_u24 v50, v63, s57, v50
v_add_u32 v50, s53, v50
v_add_u32 v50, s58, v50
v_add_u32 v62, 4608, v50
v_add_u32 v63, 9216, v50
v_add_u32 v64, 13824, v50
s_waitcnt lgkmcnt(0)
s_mov_b32 s30, 663552
s_mov_b32 s31, 0x20000
s_mov_b32 s28, s6
s_and_b32 s29, s7, 0xffff
buffer_load_dword v8, v50, s[28:31], 0 offen offset:0 nt
buffer_load_dword v9, v50, s[28:31], 0 offen offset:1152 nt
buffer_load_dword v10, v50, s[28:31], 0 offen offset:2304 nt
buffer_load_dword v11, v50, s[28:31], 0 offen offset:3456 nt
buffer_load_dword v12, v62, s[28:31], 0 offen offset:0 nt
buffer_load_dword v13, v62, s[28:31], 0 offen offset:1152 nt
buffer_load_dword v14, v62, s[28:31], 0 offen offset:2304 nt
buffer_load_dword v15, v62, s[28:31], 0 offen offset:3456 nt
buffer_load_dword v16, v63, s[28:31], 0 offen offset:0 nt
buffer_load_dword v17, v63, s[28:31], 0 offen offset:1152 nt
buffer_load_dword v18, v63, s[28:31], 0 offen offset:2304 nt
buffer_load_dword v19, v63, s[28:31], 0 offen offset:3456 nt
buffer_load_dword v20, v64, s[28:31], 0 offen offset:0 nt
buffer_load_dword v21, v64, s[28:31], 0 offen offset:1152 nt
buffer_load_dword v22, v64, s[28:31], 0 offen offset:2304 nt
buffer_load_dword v23, v64, s[28:31], 0 offen offset:3456 nt
s_mov_b32 s18, 75497472
s_mov_b32 s19, 0x20000
s_mov_b32 s16, s4
s_and_b32 s17, s5, 0xffff
s_mov_b32 s26, 301989888
s_mov_b32 s27, 0x20000
s_mov_b32 s24, s14
s_and_b32 s25, s15, 0xffff
s_mov_b32 s34, 1152
s_mov_b32 s35, 0x20000
s_mov_b32 s32, s8
s_and_b32 s33, s9, 0xffff
s_mov_b32 s22, 0
s_mov_b32 s23, 0x20000
s_mov_b32 s20, s10
s_and_b32 s21, s11, 0xffff
s_mov_b32 s38, 256
s_mov_b32 s39, 0x20000
s_mov_b32 s36, s12
s_and_b32 s37, s13, 0xffff
s_mul_i32 s52, s48, 9
s_add_u32 s52, s52, s49
s_mul_i32 s53, s52, 9
s_mul_i32 s54, s50, 18
s_add_u32 s54, s54, 8
s_lshl_b32 s55, s52, 2
s_add_u32 s55, s55, s40
s_lshl_b32 s56, s50, 2
s_add_u32 s56, s56, s40
s_cmp_eq_u32 s84, 40
s_cselect_b32 s57, 0x100000, 9
s_cmp_lt_u32 s84, 36
s_cselect_b32 s53, s53, s54
s_cselect_b32 s54, 2, 81
s_cselect_b32 s57, 1, s57
s_cselect_b32 s55, s55, s56
s_mov_b32 s56, 331776
s_cselect_b32 s56, s56, 368640
s_mov_b32 s58, 373760
s_cselect_b32 s58, s58, 382976
s_cselect_b32 s59, 16, 4
s_cselect_b32 s60, 4, 64
s_cselect_b32 s61, 12, 11
s_cselect_b32 s62, 1, 0x8001
v_lshrrev_b32 v61, 4, v7
v_lshlrev_b32 v62, 1, v58
v_lshl_add_u32 v60, v60, 2, v62
v_add_u32 v62, v60, v59
v_mul_u32_u24 v51, s54, v61
v_add_lshl_u32 v51, v51, s53, 6
v_add3_u32 v51, v51, v62, s51
v_lshl_add_u32 v51, v51, 4, s86
s_lshl_b32 s57, s57, 10
v_add_u32 v66, s57, v51
s_lshl_b32 s52, s55, 8
s_add_u32 s52, s52, s56
s_add_u32 s52, s52, s86
v_mul_u32_u24 v52, s59, v62
v_mad_u32_u24 v52, v61, s60, v52
v_lshl_add_u32 v54, v7, 2, s52
s_lshr_b32 s52, s55, 2
s_lshl_b32 s52, s52, 8
s_add_u32 s58, s58, s52
s_lshl2_add_u32 s58, s51, s58
s_lshl_b32 s52, s51, 1
s_add_u32 s52, s52, s62
v_lshl_add_u32 v62, v61, 1, v59
v_lshlrev_b32 v62, s61, v62
v_lshl_add_u32 v53, v60, 7, v62
v_add_u32 v53, s52, v53
v_and_b32 v62, 12, v7
v_and_b32 v63, 15, v7
v_mad_u32_u24 v62, v62, 3, v63
v_lshl_add_u32 v62, v62, 2, s51
v_mov_b32 v67, 0
ds_write_b32 v62, v67
s_lshl2_add_u32 s52, s84, s40
s_lshl_b32 s52, s52, 7
s_add_u32 s52, s52, 393152
v_lshl_add_u32 v65, v7, 2, s58
v_lshl_add_u32 v62, v7, 2, s52
v_cmp_gt_u32 vcc, 16, v7
s_lshl_b32 s52, s51, 2
v_lshl_add_u32 v57, v7, 2, s52
v_cndmask_b32 v65, v62, v65, vcc
s_mov_b32 s75, 0
s_mov_b32 s73, 0x05060100
s_mov_b32 s74, 0xffff
v_mov_b32 v55, 0x05040100
v_mov_b32 v62, 0x03020706
v_cmp_eq_u32 vcc, 1, v59
v_mov_b32 v68, 0xf0a0500
v_mov_b32 v69, 0x8f8a8580
v_mov_b32 v70, 0x1f1a1510
v_mov_b32 v71, 0x9f9a9590
v_mov_b32 v72, 0x2f2a2520
v_mov_b32 v73, 0xafaaa5a0
v_mov_b32 v74, 0x3f3a3530
v_mov_b32 v75, 0xbfbab5b0
v_cndmask_b32 v55, v55, v62, vcc
v_mov_b64 v[76:77], 0
v_mov_b64 v[78:79], 0
v_mov_b64 v[80:81], 0
v_mov_b32 v82, 0
s_mov_b32 s64, 0x5040500
s_mov_b32 s65, 0x5040501
s_mov_b32 s66, 0x5040502
s_mov_b32 s67, 0x5040503
s_mov_b32 s68, 0x7060700
s_mov_b32 s69, 0x7060701
s_mov_b32 s70, 0x7060702
s_mov_b32 s71, 0x7060703
s_mov_b32 s72, 0x05060102
s_waitcnt vmcnt(12)
v_perm_b32 v24, v8, v68, s64
v_perm_b32 v25, v9, v68, s65
v_perm_b32 v26, v10, v68, s66
v_perm_b32 v27, v11, v68, s67
v_max3_f32 v28, |v24|, |v25|, |v26|
v_med3_f32 v29, |v24|, |v25|, |v26|
v_min3_f32 v30, |v24|, |v25|, |v26|
v_med3_f32 v32, v28, v29, |v27|
v_med3_f32 v33, v29, v30, |v27|
v_max_f32 v31, v28, |v27|
v_perm_b32 v36, v31, v32, s72
v_bfi_b32 v44, 3, v32, v31
v_cmpx_eq_u32_sdwa vcc, v33, v32 src0_sel:WORD_1 src1_sel:WORD_1
v_mov_b32 v76, v33
v_min_f32 v77, v30, |v27|
s_mov_b64 exec, -1
v_perm_b32 v24, v8, v69, s68
v_perm_b32 v25, v9, v69, s69
v_perm_b32 v26, v10, v69, s70
v_perm_b32 v27, v11, v69, s71
v_max3_f32 v28, |v24|, |v25|, |v26|
v_med3_f32 v29, |v24|, |v25|, |v26|
v_min3_f32 v30, |v24|, |v25|, |v26|
v_med3_f32 v32, v28, v29, |v27|
v_med3_f32 v33, v29, v30, |v27|
v_max_f32 v31, v28, |v27|
v_perm_b32 v40, v31, v32, s72
v_bfi_b32 v46, 3, v32, v31
v_cmpx_eq_u32_sdwa vcc, v33, v32 src0_sel:WORD_1 src1_sel:WORD_1
v_mov_b64 v[78:79], v[76:77]
v_mov_b32 v76, v33
v_min_f32 v77, v30, |v27|
s_mov_b64 exec, -1
s_waitcnt vmcnt(8)
v_perm_b32 v24, v12, v70, s64
v_perm_b32 v25, v13, v70, s65
v_perm_b32 v26, v14, v70, s66
v_perm_b32 v27, v15, v70, s67
v_max3_f32 v28, |v24|, |v25|, |v26|
v_med3_f32 v29, |v24|, |v25|, |v26|
v_min3_f32 v30, |v24|, |v25|, |v26|
v_med3_f32 v32, v28, v29, |v27|
v_med3_f32 v33, v29, v30, |v27|
v_max_f32 v31, v28, |v27|
v_perm_b32 v37, v31, v32, s72
v_bfi_b32 v31, 3, v32, v31
v_lshlrev_b32 v31, 4, v31
v_bfi_b32 v44, 15, v44, v31
v_cmpx_eq_u32_sdwa vcc, v33, v32 src0_sel:WORD_1 src1_sel:WORD_1
v_mov_b64 v[80:81], v[78:79]
v_mov_b64 v[78:79], v[76:77]
v_mov_b32 v76, v33
v_min_f32 v77, v30, |v27|
s_mov_b64 exec, -1
v_perm_b32 v24, v12, v71, s68
v_perm_b32 v25, v13, v71, s69
v_perm_b32 v26, v14, v71, s70
v_perm_b32 v27, v15, v71, s71
v_max3_f32 v28, |v24|, |v25|, |v26|
v_med3_f32 v29, |v24|, |v25|, |v26|
v_min3_f32 v30, |v24|, |v25|, |v26|
v_med3_f32 v32, v28, v29, |v27|
v_med3_f32 v33, v29, v30, |v27|
v_max_f32 v31, v28, |v27|
v_perm_b32 v41, v31, v32, s72
v_bfi_b32 v31, 3, v32, v31
v_lshlrev_b32 v31, 4, v31
v_bfi_b32 v46, 15, v46, v31
v_cmpx_eq_u32_sdwa vcc, v33, v32 src0_sel:WORD_1 src1_sel:WORD_1
v_or_b32 v82, v82, v80
v_mov_b64 v[80:81], v[78:79]
v_mov_b64 v[78:79], v[76:77]
v_mov_b32 v76, v33
v_min_f32 v77, v30, |v27|
s_mov_b64 exec, -1
s_waitcnt vmcnt(4)
v_perm_b32 v24, v16, v72, s64
v_perm_b32 v25, v17, v72, s65
v_perm_b32 v26, v18, v72, s66
v_perm_b32 v27, v19, v72, s67
v_max3_f32 v28, |v24|, |v25|, |v26|
v_med3_f32 v29, |v24|, |v25|, |v26|
v_min3_f32 v30, |v24|, |v25|, |v26|
v_med3_f32 v32, v28, v29, |v27|
v_med3_f32 v33, v29, v30, |v27|
v_max_f32 v31, v28, |v27|
v_perm_b32 v38, v31, v32, s72
v_bfi_b32 v45, 3, v32, v31
v_cmpx_eq_u32_sdwa vcc, v33, v32 src0_sel:WORD_1 src1_sel:WORD_1
v_or_b32 v82, v82, v80
v_mov_b64 v[80:81], v[78:79]
v_mov_b64 v[78:79], v[76:77]
v_mov_b32 v76, v33
v_min_f32 v77, v30, |v27|
s_mov_b64 exec, -1
v_perm_b32 v24, v16, v73, s68
v_perm_b32 v25, v17, v73, s69
v_perm_b32 v26, v18, v73, s70
v_perm_b32 v27, v19, v73, s71
v_max3_f32 v28, |v24|, |v25|, |v26|
v_med3_f32 v29, |v24|, |v25|, |v26|
v_min3_f32 v30, |v24|, |v25|, |v26|
v_med3_f32 v32, v28, v29, |v27|
v_med3_f32 v33, v29, v30, |v27|
v_max_f32 v31, v28, |v27|
v_perm_b32 v42, v31, v32, s72
v_bfi_b32 v47, 3, v32, v31
v_cmpx_eq_u32_sdwa vcc, v33, v32 src0_sel:WORD_1 src1_sel:WORD_1
v_or_b32 v82, v82, v80
v_mov_b64 v[80:81], v[78:79]
v_mov_b64 v[78:79], v[76:77]
v_mov_b32 v76, v33
v_min_f32 v77, v30, |v27|
s_mov_b64 exec, -1
s_waitcnt vmcnt(0)
v_perm_b32 v24, v20, v74, s64
v_perm_b32 v25, v21, v74, s65
v_perm_b32 v26, v22, v74, s66
v_perm_b32 v27, v23, v74, s67
v_max3_f32 v28, |v24|, |v25|, |v26|
v_med3_f32 v29, |v24|, |v25|, |v26|
v_min3_f32 v30, |v24|, |v25|, |v26|
v_med3_f32 v32, v28, v29, |v27|
v_med3_f32 v33, v29, v30, |v27|
v_max_f32 v31, v28, |v27|
v_perm_b32 v39, v31, v32, s72
v_bfi_b32 v31, 3, v32, v31
v_lshlrev_b32 v31, 4, v31
v_bfi_b32 v45, 15, v45, v31
v_cmpx_eq_u32_sdwa vcc, v33, v32 src0_sel:WORD_1 src1_sel:WORD_1
v_or_b32 v82, v82, v80
v_mov_b64 v[80:81], v[78:79]
v_mov_b64 v[78:79], v[76:77]
v_mov_b32 v76, v33
v_min_f32 v77, v30, |v27|
s_mov_b64 exec, -1
v_perm_b32 v24, v20, v75, s68
v_perm_b32 v25, v21, v75, s69
v_perm_b32 v26, v22, v75, s70
v_perm_b32 v27, v23, v75, s71
v_max3_f32 v28, |v24|, |v25|, |v26|
v_med3_f32 v29, |v24|, |v25|, |v26|
v_min3_f32 v30, |v24|, |v25|, |v26|
v_med3_f32 v32, v28, v29, |v27|
v_med3_f32 v33, v29, v30, |v27|
v_max_f32 v31, v28, |v27|
v_perm_b32 v43, v31, v32, s72
v_bfi_b32 v31, 3, v32, v31
v_lshlrev_b32 v31, 4, v31
v_bfi_b32 v47, 15, v47, v31
v_cmpx_eq_u32_sdwa vcc, v33, v32 src0_sel:WORD_1 src1_sel:WORD_1
v_or_b32 v82, v82, v80
v_mov_b64 v[80:81], v[78:79]
v_mov_b64 v[78:79], v[76:77]
v_mov_b32 v76, v33
v_min_f32 v77, v30, |v27|
s_mov_b64 exec, -1
s_mov_b32 vcc_lo, 0x33333333
s_mov_b32 vcc_hi, 0x33333333
v_cndmask_b32_dpp v24, v40, v36, vcc quad_perm:[2,3,0,1] row_mask:0xf bank_mask:0xf
v_cndmask_b32_dpp v25, v41, v37, vcc quad_perm:[2,3,0,1] row_mask:0xf bank_mask:0xf
v_cndmask_b32_dpp v26, v42, v38, vcc quad_perm:[2,3,0,1] row_mask:0xf bank_mask:0xf
v_cndmask_b32_dpp v27, v43, v39, vcc quad_perm:[2,3,0,1] row_mask:0xf bank_mask:0xf
s_not_b64 vcc, vcc
buffer_store_dwordx4 v[24:27], v51, s[24:27], 0 offen sc1
v_cndmask_b32_dpp v40, v36, v40, vcc quad_perm:[2,3,0,1] row_mask:0xf bank_mask:0xf
v_cndmask_b32_dpp v41, v37, v41, vcc quad_perm:[2,3,0,1] row_mask:0xf bank_mask:0xf
v_cndmask_b32_dpp v42, v38, v42, vcc quad_perm:[2,3,0,1] row_mask:0xf bank_mask:0xf
v_cndmask_b32_dpp v43, v39, v43, vcc quad_perm:[2,3,0,1] row_mask:0xf bank_mask:0xf
s_mov_b32 s52, 0x0c0c0400
s_mov_b32 s53, 0x04000c0c
buffer_store_dwordx4 v[40:43], v66, s[24:27], 0 offen sc1
v_perm_b32 v48, v45, v44, s52
v_perm_b32 v49, v47, v46, s53
v_or_b32 v48, v48, v49
s_nop 1
v_mov_b32_dpp v49, v48 quad_perm:[2,3,0,1] row_mask:0xf bank_mask:0xf
v_perm_b32 v48, v49, v48, v55
ds_permute_b32 v48, v52, v48
v_cmp_lt_u32 s[54:55], s74, v82
L_emit:
v_cmp_lt_u32 vcc, s74, v76
v_cmp_eq_u32_sdwa s[48:49], v77, v76 src0_sel:WORD_1 src1_sel:WORD_1
v_perm_b32 v63, v76, v53, s73
v_bfe_u32 v62, v76, 2, 4
v_and_b32 v64, 0x80, v76
v_lshl_add_u32 v63, v62, 1, v63
v_mbcnt_lo_u32_b32 v62, vcc_lo, 0
v_mbcnt_hi_u32_b32 v62, vcc_hi, v62
v_add_u32 v63, v64, v63
v_add_u32 v62, s75, v62
s_bcnt1_i32_b64 s52, vcc
s_add_u32 s75, s75, s52
v_cmp_gt_u32 s[52:53], 15, v62
v_and_b32 v64, 12, v62
v_mad_u32_u24 v62, v64, 3, v62
v_lshl_add_u32 v62, v62, 2, s51
s_and_b64 s[48:49], s[48:49], vcc
s_and_b64 exec, s[52:53], vcc
ds_write_b32 v62, v63
s_mov_b64 exec, s[48:49]
v_mov_b32 v76, v77
v_mov_b32 v77, 0
s_not_b64 exec, exec
v_mov_b64 v[76:77], v[78:79]
v_mov_b64 v[78:79], v[80:81]
v_mov_b64 v[80:81], 0
s_mov_b64 exec, -1
v_or3_b32 v62, v76, v78, v80
v_cmp_lt_u32 vcc, s74, v62
s_cmp_lg_u64 s[54:55], 0
s_cselect_b32 s52, 99, s75
s_cmp_gt_u32 s52, 15
s_cselect_b32 s52, -1, 0
v_mov_b32 v63, s51
s_cbranch_vccnz L_emit
v_mov_b32 v62, s52
ds_write_b32 v63, v62 offset:204
v_lshlrev_b32 v11, 4, v63
s_waitcnt lgkmcnt(0)
s_barrier
s_mov_b64 exec, 0xffff
ds_read_b32 v67, v57
s_mov_b64 exec, -1
buffer_store_dword v48, v54, s[24:27], 0 offen sc1
s_mov_b32 exec_hi, 0xffff
s_waitcnt lgkmcnt(0)
buffer_store_dword v67, v65, s[24:27], 0 offen sc1
s_mov_b64 exec, 1
buffer_load_dword v8, v11, s[36:39], 0 offen sc1
s_mov_b64 exec, -1
s_lshl_b32 s52, s84, 7
s_add_u32 s52, s52, 458752
v_lshl_add_u32 v9, v7, 2, s52
v_mov_b32 v10, 1
s_waitcnt vmcnt(0)
s_mov_b32 s85, 0x230003c
s_barrier
s_cmp_lg_u32 s40, 0
s_cbranch_scc1 L_cons2
v_readfirstlane_b32 s47, v8
s_mov_b64 exec, 0xffff
s_cmp_lg_u32 s47, 1
s_cbranch_scc1 L_pwait
L_pset:
buffer_store_dword v10, v9, s[24:27], 0 offen sc1
L_notlast:
s_mov_b64 exec, -1
L_cons2:
v_lshrrev_b32 v72, 3, v7
v_and_b32 v73, 7, v7
v_xor_b32 v73, v73, v72
v_mul_u32_u24 v72, 1152, v72
s_and_b32 s47, s40, 1
s_mul_i32 s47, s47, 9216
s_lshr_b32 s3, s40, 1
s_lshl_b32 s3, s3, 7
s_add_u32 s47, s47, s3
v_lshl_add_u32 v72, v73, 4, v72
v_add_u32 v3, s47, v72
s_lshl_b32 s44, s40, 10
s_mul_i32 s45, s2, 18432
s_mov_b32 s46, s45
s_branch L_cons3
L_pwait:
s_mov_b32 s3, 20015
L_pwait1:
buffer_load_dword v8, off, s[36:39], 0 sc1
s_waitcnt vmcnt(0)
v_readfirstlane_b32 s47, v8
s_nop 3
s_cmp_eq_u32 s47, 1
s_cbranch_scc1 L_pset
s_sub_u32 s3, s3, 1
s_cbranch_scc0 L_pwait1
s_branch L_notlast
L_cons:
s_mov_b32 s85, 0x800020
s_mov_b32 s47, 0x800020
s_bitcmp1_b32 s2, 3
s_cselect_b32 s85, s85, 0x230003c
s_cselect_b32 s47, s47, 0x230003c
s_bitcmp1_b32 s2, 6
s_cselect_b32 s85, s47, s85
v_lshrrev_b32 v72, 3, v7
v_and_b32 v73, 7, v7
v_xor_b32 v73, v73, v72
v_mul_u32_u24 v72, 1152, v72
s_and_b32 s47, s40, 1
s_mul_i32 s47, s47, 9216
s_lshr_b32 s3, s40, 1
s_lshl_b32 s3, s3, 7
s_add_u32 s47, s47, s3
v_lshl_add_u32 v72, v73, 4, v72
v_add_u32 v3, s47, v72
s_lshl_b32 s44, s40, 10
s_mul_i32 s45, s2, 18432
s_mov_b32 s46, s45
s_waitcnt lgkmcnt(0)
s_mov_b32 s30, 663552
s_mov_b32 s31, 0x20000
s_mov_b32 s28, s6
s_and_b32 s29, s7, 0xffff
s_mov_b32 s18, 75497472
s_mov_b32 s19, 0x20000
s_mov_b32 s16, s4
s_and_b32 s17, s5, 0xffff
s_mov_b32 s26, 301989888
s_mov_b32 s27, 0x20000
s_mov_b32 s24, s14
s_and_b32 s25, s15, 0xffff
s_mov_b32 s34, 1152
s_mov_b32 s35, 0x20000
s_mov_b32 s32, s8
s_and_b32 s33, s9, 0xffff
s_mov_b32 s22, 0
s_mov_b32 s23, 0x20000
s_mov_b32 s20, s10
s_and_b32 s21, s11, 0xffff
s_mov_b32 s38, 256
s_mov_b32 s39, 0x20000
s_mov_b32 s36, s12
s_and_b32 s37, s13, 0xffff
s_cmp_lg_u32 s2, 200
s_cbranch_scc1 L_cons3
v_lshlrev_b32 v8, 4, v0
v_mov_b64 v[12:13], 0
v_mov_b64 v[14:15], 0
buffer_store_dwordx4 v[12:15], v8, s[36:39], 0 offen sc1
v_add_u32 v8, 458752, v8
v_add_u32 v9, 4096, v8
buffer_store_dwordx4 v[12:15], v8, s[24:27], 0 offen sc1
buffer_store_dwordx4 v[12:15], v9, s[24:27], 0 offen sc1
v_mov_b32 v10, 1
v_lshlrev_b32 v11, 2, v0
s_waitcnt vmcnt(0)
s_barrier
s_mov_b32 exec_hi, 0
buffer_store_dword v10, v11, s[36:39], 0 offen sc1
s_mov_b64 exec, -1
L_cons3:
s_lshr_b32 s47, s40, 1
s_lshl_b32 s3, s47, 11
s_sub_u32 s8, 15488, s3
s_lshl_b32 s3, s47, 7
s_add_u32 s7, s45, 128
s_sub_u32 s7, s7, s3
s_sub_u32 s10, s47, 1
s_sub_u32 s11, 0, s47
s_mov_b32 s9, s44
s_mov_b32 s13, 4718592
s_mov_b32 s15, 16
s_mov_b32 s14, s13
v_and_b32 v80, 3, v7
v_bfe_u32 v81, v7, 2, 2
v_bfe_u32 v82, v7, 4, 1
v_lshlrev_b32 v81, 3, v81
v_lshl_add_u32 v81, v80, 5, v81
v_lshl_add_u32 v81, v82, 7, v81
s_lshl_b32 s47, s40, 8
v_add_u32 v81, s47, v81
s_lshl_b32 s47, s40, 5
s_add_u32 s47, s47, 1024
v_lshl_add_u32 v80, v80, 3, s47
v_cmp_gt_u32 vcc, 32, v7
s_nop 1
v_cndmask_b32 v80, v80, v81, vcc
buffer_load_dwordx2 v[110:111], v80, s[32:35], 0 offen
s_cmp_lt_u32 s84, 41
s_cbranch_scc1 L_pfd
s_waitcnt vmcnt(0)
L_pfd:
s_bfe_u32 s88, s85, 0x40014
s_mov_b32 s3, 55680
s_cmp_ge_u32 s88, 6
s_cselect_b32 s3, s3, 0
s_cmp_ge_u32 s84, 41
s_cselect_b32 s3, s3, 0
L_pf:
s_add_u32 m0, s44, 0
s_nop 0
buffer_load_dwordx4 v3, s[16:19], s45 offen offset:0 nt lds
s_add_u32 m0, s44, 3840
s_nop 0
buffer_load_dwordx4 v3, s[16:19], s45 offen offset:256 nt lds
s_add_u32 m0, s44, 7680
s_nop 0
buffer_load_dwordx4 v3, s[16:19], s45 offen offset:512 nt lds
s_add_u32 m0, s44, 11520
s_nop 0
buffer_load_dwordx4 v3, s[16:19], s45 offen offset:768 nt lds
s_add_u32 m0, s44, s8
s_mov_b64 exec, s[10:11]
buffer_load_dwordx4 v3, s[16:19], s7 offen offset:896 nt lds
s_mov_b64 exec, -1
s_cmp_lg_u32 s44, 37120
s_cbranch_scc1 L_pf_f
s_mov_b64 exec, 1
buffer_load_dword v124, off, s[36:39], 0 sc1
s_mov_b64 exec, -1
L_pf_f:
s_cmp_ge_u32 s44, s3
s_cbranch_scc1 L_pf_n
s_waitcnt vmcnt(1)
L_pf_n:
s_add_u32 s7, s7, s13
s_add_u32 s44, s44, 18560
s_add_u32 s45, s45, s13
s_mov_b32 s13, 4718592
s_sub_u32 s88, s88, 1
s_cmp_lg_u32 s88, 0
s_cbranch_scc1 L_pf
L_pf_e:
L_rest:
s_mov_b32 s92, 0x80
s_mov_b32 s47, 0x80
s_bitcmp1_b32 s2, 3
s_cselect_b32 s92, s92, 0x88
s_cselect_b32 s47, s47, 0x88
s_bitcmp1_b32 s2, 6
s_cselect_b32 s92, s47, s92
s_mov_b32 s3, 0x88
s_cmp_lt_u32 s84, 41
s_cselect_b32 s92, s3, s92
s_mov_b32 s87, 0x80
s_mov_b32 s3, 0x80
s_cmp_lt_u32 s84, 41
s_cselect_b32 s87, s3, s87
v_and_b32 v72, 15, v7
v_lshrrev_b32 v73, 4, v7
v_and_b32 v74, 7, v7
v_xor_b32 v74, v74, v73
v_lshlrev_b32 v74, 4, v74
v_lshl_add_u32 v0, v72, 7, v74
v_xor_b32 v1, 64, v0
s_mul_i32 s93, s40, 3584
s_add_u32 s93, s93, 148480
v_lshl_add_u32 v2, v73, 4, s93
v_and_b32 v74, 14, v7
v_mul_u32_u24 v4, 1152, v74
v_and_b32 v74, 1, v7
v_lshl_add_u32 v4, v74, 4, v4
v_lshl_add_u32 v4, v73, 5, v4
s_lshl_b32 s47, s40, 8
v_add_u32 v4, s47, v4
s_lshl_b32 s47, s40, 5
s_add_u32 s47, s47, 1024
v_lshrrev_b32 v72, 2, v7
v_and_b32 v73, 3, v7
v_lshl_add_u32 v6, v73, 4, v72
v_lshlrev_b32 v6, 2, v6
v_mul_u32_u24 v5, 1152, v72
v_lshl_add_u32 v5, v73, 3, v5
v_add_u32 v5, s47, v5
s_mov_b32 s80, 0x55555555
s_mov_b32 s81, 0x55555555
s_mov_b32 s82, 0xaaaaaaaa
s_mov_b32 s83, 0xaaaaaaaa
v_lshl_add_u32 v109, v7, 4, s93
v_lshl_add_u32 v89, v7, 2, s93
v_mov_b32 v76, 0
v_mov_b32 v77, 0
v_mov_b32 v78, 0
v_mov_b32 v79, 0
v_mov_b32 v90, 0xdddddddd
ds_write_b128 v109, v[76:79]
ds_write_b32 v89, v90 offset:1792
ds_write_b32 v89, v90 offset:2048
ds_write_b32 v89, v90 offset:2304
ds_write_b32 v89, v90 offset:2560
ds_write_b32 v89, v90 offset:2816
ds_write_b32 v89, v90 offset:3072
ds_write_b32 v89, v90 offset:3328
s_lshl_b32 s47, s40, 2
s_add_u32 s47, s47, 163072
v_mov_b32 v88, s47
ds_write_b32 v88, v76
s_mul_i32 s47, s40, 2304
s_add_u32 s47, s47, 373760
v_and_b32 v73, 60, v7
v_mad_u32_u24 v73, v73, 3, v7
v_lshl_add_u32 v72, v73, 4, s47
s_mov_b32 s47, 380672
v_lshl_add_u32 v73, v73, 4, s47
v_lshrrev_b32 v74, 2, v7
v_cmp_gt_u32 vcc, 36, v7
v_lshlrev_b32 v90, 11, v74
v_subrev_u32 v74, 9, v74
v_lshlrev_b32 v74, 12, v74
v_cndmask_b32 v72, v73, v72, vcc
v_cndmask_b32 v90, v74, v90, vcc
s_lshl_b32 s47, s40, 12
s_add_u32 s47, s47, 0x8001
v_mov_b32 v88, 1
v_mov_b32 v94, 0xf001
v_mov_b32 v95, s47
v_cndmask_b32 v94, v94, v88, vcc
v_cndmask_b32 v95, v95, v88, vcc
v_cndmask_b32 v96, 0, 28, vcc
v_cndmask_b32 v97, 32, 0, vcc
v_add_u32 v97, s93, v97
v_cmp_gt_u32 vcc, 56, v7
v_mov_b32 v73, 0x40000000
s_lshr_b32 s47, s2, 3
s_lshl_b32 s47, s47, 2
s_add_u32 s47, s47, s40
s_mul_i32 s47, s47, 2944
v_cndmask_b32 v72, v73, v72, vcc
v_lshl_add_u32 v93, v7, 4, s47
s_mul_i32 s47, s40, 82944
s_add_u32 s47, s47, s86
v_lshl_add_u32 v112, v7, 4, s47
s_mul_i32 s47, s40, 9216
s_add_u32 s47, s47, s86
s_add_u32 s47, s47, 331776
v_lshl_add_u32 v113, v7, 4, s47
s_lshl_b32 s47, s40, 6
s_add_u32 s47, s47, s86
s_add_u32 s47, s47, 368640
v_and_b32 v106, 15, v7
v_lshl_add_u32 v106, v106, 2, s47
v_lshrrev_b32 v107, 4, v7
v_lshl_add_u32 v106, v107, 8, v106
v_and_b32 v74, 15, v7
v_and_b32 v73, 7, v7
v_lshlrev_b32 v100, 1, v73
v_lshlrev_b32 v100, v100, v88
v_lshlrev_b32 v73, 4, v73
v_lshl_add_u32 v92, v74, 7, v73
v_lshl_or_b32 v92, v92, 16, v92
v_lshrrev_b32 v98, 5, v7
v_bfe_u32 v99, v7, 3, 2
v_lshl_add_u32 v99, v99, 6, s93
v_lshl_add_u32 v101, v7, 1, s93
v_lshrrev_b32 v102, 4, v7
v_lshl_add_u32 v102, v102, 3, s93
v_lshrrev_b32 v103, 1, v7
v_lshlrev_b32 v103, 5, v103
s_mov_b32 s89, 0
s_cmp_lg_u32 s40, 0
s_cbranch_scc1 L_ready
s_mov_b32 s3, 20015
s_mov_b32 s47, 458752
v_lshl_add_u32 v9, v7, 7, s47
s_bfe_u32 s47, s85, 0x40014
s_cmp_ge_u32 s47, 6
s_waitcnt vmcnt(15)
s_cbranch_scc1 L_deep
s_waitcnt vmcnt(0)
L_deep:
v_readfirstlane_b32 s47, v124
s_mov_b32 exec_hi, 511
s_cmp_lg_u32 s47, 1
s_cbranch_scc1 L_cwait
L_poll:
buffer_load_dword v8, v9, s[24:27], 0 offen sc1
s_sub_u32 s3, s3, 1
s_cbranch_scc1 L_giveup
s_waitcnt vmcnt(0)
v_cmp_ne_u32 vcc, 1, v8
s_nop 4
s_cbranch_vccnz L_poll
L_polled:
s_mov_b64 exec, -1
L_ready:
s_waitcnt lgkmcnt(0)
s_barrier
buffer_load_dwordx4 v[8:11], v72, s[24:27], 0 offen offset:0 sc1
buffer_load_dwordx4 v[12:15], v72, s[24:27], 0 offen offset:64 sc1
buffer_load_dwordx4 v[16:19], v72, s[24:27], 0 offen offset:128 sc1
buffer_load_dwordx4 v[20:23], v72, s[24:27], 0 offen offset:192 sc1
buffer_load_dwordx4 v[76:79], v93, s[24:27], 0 offen offset:0 sc1
buffer_load_dwordx4 v[80:83], v93, s[24:27], 0 offen offset:1024 sc1
buffer_load_dwordx4 v[84:87], v93, s[24:27], 0 offen offset:2048 sc1
buffer_load_dword v174, v106, s[24:27], 0 offen offset:0 sc1
buffer_load_dword v175, v106, s[24:27], 0 offen offset:1024 sc1
buffer_load_dword v176, v106, s[24:27], 0 offen offset:2048 sc1
buffer_load_dword v177, v106, s[24:27], 0 offen offset:3072 sc1
s_mov_b32 s99, 4096
buffer_load_dword v178, v106, s[24:27], s99 offen offset:0 sc1
s_mov_b32 s98, 0
buffer_load_dwordx4 v[138:141], v113, s[24:27], s98 offen sc1
s_mov_b32 s99, 0
buffer_load_dwordx4 a[0:3], v112, s[24:27], s99 offen offset:0 sc1
buffer_load_dwordx4 a[4:7], v112, s[24:27], s99 offen offset:1024 sc1
buffer_load_dwordx4 a[8:11], v112, s[24:27], s99 offen offset:2048 sc1
s_waitcnt vmcnt(12)
v_cmp_ne_u32 s[90:91], 0, v23
v_cmp_ne_u32 s[78:79], 0, v16
v_and_b32 v73, v94, v8
v_lshrrev_b32 v72, 10, v8
v_cmp_eq_u32 s[48:49], v73, v95
v_and_or_b32 v24, v72, v96, v97
s_mov_b64 exec, s[48:49]
ds_add_rtn_u32 v40, v24, v88
s_mov_b64 exec, -1
buffer_load_dwordx4 a[12:15], v112, s[24:27], s99 offen offset:3072 sc1
v_and_b32 v73, v94, v9
v_lshrrev_b32 v72, 10, v9
v_cmp_eq_u32 s[50:51], v73, v95
v_and_or_b32 v25, v72, v96, v97
s_mov_b64 exec, s[50:51]
ds_add_rtn_u32 v41, v25, v88
s_mov_b64 exec, -1
v_and_b32 v73, v94, v10
v_lshrrev_b32 v72, 10, v10
v_cmp_eq_u32 s[52:53], v73, v95
v_and_or_b32 v26, v72, v96, v97
s_mov_b64 exec, s[52:53]
ds_add_rtn_u32 v42, v26, v88
s_mov_b64 exec, -1
s_mov_b32 s99, 4096
buffer_load_dwordx4 a[16:19], v112, s[24:27], s99 offen offset:0 sc1
v_and_b32 v73, v94, v11
v_lshrrev_b32 v72, 10, v11
v_cmp_eq_u32 s[54:55], v73, v95
v_and_or_b32 v27, v72, v96, v97
s_mov_b64 exec, s[54:55]
ds_add_rtn_u32 v43, v27, v88
s_mov_b64 exec, -1
buffer_load_dwordx4 a[20:23], v112, s[24:27], s99 offen offset:1024 sc1
v_and_b32 v73, v94, v12
v_lshrrev_b32 v72, 10, v12
v_cmp_eq_u32 s[56:57], v73, v95
v_and_or_b32 v28, v72, v96, v97
s_mov_b64 exec, s[56:57]
ds_add_rtn_u32 v44, v28, v88
s_mov_b64 exec, -1
buffer_load_dwordx4 a[24:27], v112, s[24:27], s99 offen offset:2048 sc1
v_and_b32 v73, v94, v13
v_lshrrev_b32 v72, 10, v13
v_cmp_eq_u32 s[58:59], v73, v95
v_and_or_b32 v29, v72, v96, v97
s_mov_b64 exec, s[58:59]
ds_add_rtn_u32 v45, v29, v88
s_mov_b64 exec, -1
v_and_b32 v73, v94, v14
v_lshrrev_b32 v72, 10, v14
v_cmp_eq_u32 s[60:61], v73, v95
v_and_or_b32 v30, v72, v96, v97
s_mov_b64 exec, s[60:61]
ds_add_rtn_u32 v46, v30, v88
s_mov_b64 exec, -1
buffer_load_dwordx4 a[28:31], v112, s[24:27], s99 offen offset:3072 sc1
v_and_b32 v73, v94, v15
v_lshrrev_b32 v72, 10, v15
v_cmp_eq_u32 s[62:63], v73, v95
v_and_or_b32 v31, v72, v96, v97
s_mov_b64 exec, s[62:63]
ds_add_rtn_u32 v47, v31, v88
s_mov_b64 exec, -1
s_mov_b32 s99, 8192
buffer_load_dwordx4 a[32:35], v112, s[24:27], s99 offen offset:0 sc1
s_cmp_lg_u64 s[78:79], 0
s_cbranch_scc1 L_more1
L_more1b:
ds_read_b32 v72, v89
v_mov_b32 v73, 0
s_mov_b32 s98, 1024
buffer_load_dwordx4 v[142:145], v113, s[24:27], s98 offen sc1
buffer_load_dwordx4 a[36:39], v112, s[24:27], s99 offen offset:1024 sc1
buffer_load_dwordx4 a[40:43], v112, s[24:27], s99 offen offset:2048 sc1
s_waitcnt lgkmcnt(0)
s_mov_b64 vcc, s[80:81]
v_cndmask_b32_dpp v73, v72, v73, vcc quad_perm:[0,0,2,2] row_mask:0xf bank_mask:0xf
v_add_u32 v91, v103, v73
v_add_u32 v73, v72, v73
v_cmp_lt_u32 vcc, 32, v73
s_or_b32 s90, s90, s91
s_and_b32 s47, vcc_lo, 0x1ff
s_or_b32 s47, s47, s90
s_cbranch_scc1 L_greedy
L_greedyb:
buffer_load_dwordx4 a[44:47], v112, s[24:27], s99 offen offset:3072 sc1
ds_bpermute_b32 v56, v24, v91
ds_bpermute_b32 v57, v25, v91
ds_bpermute_b32 v58, v26, v91
ds_bpermute_b32 v59, v27, v91
ds_bpermute_b32 v60, v28, v91
ds_bpermute_b32 v61, v29, v91
ds_bpermute_b32 v62, v30, v91
ds_bpermute_b32 v63, v31, v91
s_mov_b32 s99, 12288
buffer_load_dwordx4 a[48:51], v112, s[24:27], s99 offen offset:0 sc1
buffer_load_dwordx4 a[52:55], v112, s[24:27], s99 offen offset:1024 sc1
buffer_load_dwordx4 a[56:59], v112, s[24:27], s99 offen offset:2048 sc1
s_waitcnt lgkmcnt(7)
v_add_u32 v73, v40, v56
v_and_b32 v72, 0x87e, v8
v_lshl_add_u32 v73, v73, 1, s93
v_add_u32 v72, v90, v72
s_andn2_b64 exec, s[48:49], s[90:91]
ds_write_b16_d16_hi v73, v8 offset:64
ds_write_b16 v73, v72 offset:384
ds_write_b16 v73, v8 offset:704
s_mov_b64 exec, -1
buffer_load_dwordx4 a[60:63], v112, s[24:27], s99 offen offset:3072 sc1
s_waitcnt lgkmcnt(9)
v_add_u32 v73, v41, v57
v_and_b32 v72, 0x87e, v9
v_lshl_add_u32 v73, v73, 1, s93
v_add_u32 v72, v90, v72
s_andn2_b64 exec, s[50:51], s[90:91]
ds_write_b16_d16_hi v73, v9 offset:64
ds_write_b16 v73, v72 offset:384
ds_write_b16 v73, v9 offset:704
s_mov_b64 exec, -1
s_mov_b32 s99, 16384
buffer_load_dwordx4 a[64:67], v112, s[24:27], s99 offen offset:0 sc1
s_waitcnt lgkmcnt(11)
v_add_u32 v73, v42, v58
v_and_b32 v72, 0x87e, v10
v_lshl_add_u32 v73, v73, 1, s93
v_add_u32 v72, v90, v72
s_andn2_b64 exec, s[52:53], s[90:91]
ds_write_b16_d16_hi v73, v10 offset:64
ds_write_b16 v73, v72 offset:384
ds_write_b16 v73, v10 offset:704
s_mov_b64 exec, -1
buffer_load_dwordx4 a[68:71], v112, s[24:27], s99 offen offset:1024 sc1
s_waitcnt lgkmcnt(13)
v_add_u32 v73, v43, v59
v_and_b32 v72, 0x87e, v11
v_lshl_add_u32 v73, v73, 1, s93
v_add_u32 v72, v90, v72
s_andn2_b64 exec, s[54:55], s[90:91]
ds_write_b16_d16_hi v73, v11 offset:64
ds_write_b16 v73, v72 offset:384
ds_write_b16 v73, v11 offset:704
s_mov_b64 exec, -1
s_mov_b32 s98, 2048
buffer_load_dwordx4 v[146:149], v113, s[24:27], s98 offen sc1
s_waitcnt lgkmcnt(15)
v_add_u32 v73, v44, v60
v_and_b32 v72, 0x87e, v12
v_lshl_add_u32 v73, v73, 1, s93
v_add_u32 v72, v90, v72
s_andn2_b64 exec, s[56:57], s[90:91]
ds_write_b16_d16_hi v73, v12 offset:64
ds_write_b16 v73, v72 offset:384
ds_write_b16 v73, v12 offset:704
s_mov_b64 exec, -1
buffer_load_dwordx4 a[72:75], v112, s[24:27], s99 offen offset:2048 sc1
s_waitcnt lgkmcnt(15)
v_add_u32 v73, v45, v61
v_and_b32 v72, 0x87e, v13
v_lshl_add_u32 v73, v73, 1, s93
v_add_u32 v72, v90, v72
s_andn2_b64 exec, s[58:59], s[90:91]
ds_write_b16_d16_hi v73, v13 offset:64
ds_write_b16 v73, v72 offset:384
ds_write_b16 v73, v13 offset:704
s_mov_b64 exec, -1
buffer_load_dwordx4 a[76:79], v112, s[24:27], s99 offen offset:3072 sc1
s_waitcnt lgkmcnt(15)
v_add_u32 v73, v46, v62
v_and_b32 v72, 0x87e, v14
v_lshl_add_u32 v73, v73, 1, s93
v_add_u32 v72, v90, v72
s_andn2_b64 exec, s[60:61], s[90:91]
ds_write_b16_d16_hi v73, v14 offset:64
ds_write_b16 v73, v72 offset:384
ds_write_b16 v73, v14 offset:704
s_mov_b64 exec, -1
s_mov_b32 s99, 20480
buffer_load_dwordx4 a[80:83], v112, s[24:27], s99 offen offset:0 sc1
s_waitcnt lgkmcnt(15)
v_add_u32 v73, v47, v63
v_and_b32 v72, 0x87e, v15
v_lshl_add_u32 v73, v73, 1, s93
v_add_u32 v72, v90, v72
s_andn2_b64 exec, s[62:63], s[90:91]
ds_write_b16_d16_hi v73, v15 offset:64
ds_write_b16 v73, v72 offset:384
ds_write_b16 v73, v15 offset:704
s_mov_b64 exec, -1
buffer_load_dwordx4 a[84:87], v112, s[24:27], s99 offen offset:1024 sc1
buffer_load_dwordx4 a[88:91], v112, s[24:27], s99 offen offset:2048 sc1
s_cmp_lg_u64 s[78:79], 0
s_cbranch_scc1 L_more2
L_more2b:
ds_read_u16 v8, v101 offset:704
ds_read_u16 v9, v101 offset:832
ds_read_u16 v10, v101 offset:960
ds_read2_b64 v[118:121], v102 offset0:48 offset1:52
ds_read2_b64 v[122:125], v102 offset0:56 offset1:60
ds_read2_b64 v[126:129], v102 offset0:64 offset1:68
ds_read2_b64 v[130:133], v102 offset0:72 offset1:76
ds_read2_b64 v[134:137], v102 offset0:80 offset1:84
buffer_load_dwordx4 a[92:95], v112, s[24:27], s99 offen offset:3072 sc1
s_mov_b32 s99, 24576
buffer_load_dwordx4 a[96:99], v112, s[24:27], s99 offen offset:0 sc1
buffer_load_dwordx4 a[100:103], v112, s[24:27], s99 offen offset:1024 sc1
s_waitcnt lgkmcnt(5)
v_lshrrev_b32 v72, 12, v8
v_cmp_ne_u32 vcc, 0, v8
v_min_u32 v72, 8, v72
v_add3_u32 v72, v72, v98, 0
v_lshlrev_b32 v73, 4, v72
v_lshrrev_b32 v72, 1, v72
buffer_load_dwordx4 a[104:107], v112, s[24:27], s99 offen offset:2048 sc1
v_lshlrev_b32 v73, v73, v100
v_lshl_add_u32 v72, v72, 8, v99
v_bfe_u32 v74, v8, 7, 4
v_lshl_add_u32 v72, v74, 2, v72
s_mov_b64 exec, vcc
ds_xor_b32 v72, v73 offset:1792
s_mov_b64 exec, -1
v_lshrrev_b32 v72, 12, v9
v_cmp_ne_u32 vcc, 0, v9
v_min_u32 v72, 8, v72
v_add3_u32 v72, v72, v98, 2
v_lshlrev_b32 v73, 4, v72
v_lshrrev_b32 v72, 1, v72
s_mov_b32 s98, 3072
buffer_load_dwordx4 v[150:153], v113, s[24:27], s98 offen sc1
v_lshlrev_b32 v73, v73, v100
v_lshl_add_u32 v72, v72, 8, v99
v_bfe_u32 v74, v9, 7, 4
v_lshl_add_u32 v72, v74, 2, v72
s_mov_b64 exec, vcc
ds_xor_b32 v72, v73 offset:1792
s_mov_b64 exec, -1
buffer_load_dwordx4 a[108:111], v112, s[24:27], s99 offen offset:3072 sc1
v_lshrrev_b32 v72, 12, v10
v_cmp_ne_u32 vcc, 0, v10
v_min_u32 v72, 8, v72
v_add3_u32 v72, v72, v98, 4
v_lshlrev_b32 v73, 4, v72
v_lshrrev_b32 v72, 1, v72
v_lshlrev_b32 v73, v73, v100
v_lshl_add_u32 v72, v72, 8, v99
v_bfe_u32 v74, v10, 7, 4
v_lshl_add_u32 v72, v74, 2, v72
s_mov_b64 exec, vcc
s_mov_b32 exec_hi, 0
ds_xor_b32 v72, v73 offset:1792
s_mov_b64 exec, -1
s_mov_b32 s99, 28672
buffer_load_dwordx4 a[112:115], v112, s[24:27], s99 offen offset:0 sc1
ds_read_b32 v179, v89 offset:1792
ds_read_b32 v180, v89 offset:2048
ds_read_b32 v181, v89 offset:2304
ds_read_b32 v182, v89 offset:2560
ds_read_b32 v183, v89 offset:2816
ds_read_b32 v184, v89 offset:3072
ds_read_b32 v185, v89 offset:3328
buffer_load_dwordx4 a[116:119], v112, s[24:27], s99 offen offset:1024 sc1
s_waitcnt lgkmcnt(10)
v_xor_b32 v118, v92, v118
v_xor_b32 v119, v92, v119
v_xor_b32 v120, v92, v120
v_xor_b32 v121, v92, v121
buffer_load_dwordx4 a[120:123], v112, s[24:27], s99 offen offset:2048 sc1
v_xor_b32 v122, v92, v122
v_xor_b32 v123, v92, v123
v_xor_b32 v124, v92, v124
v_xor_b32 v125, v92, v125
v_xor_b32 v126, v92, v126
v_xor_b32 v127, v92, v127
v_xor_b32 v128, v92, v128
v_xor_b32 v129, v92, v129
buffer_load_dwordx4 a[124:127], v112, s[24:27], s99 offen offset:3072 sc1
v_xor_b32 v130, v92, v130
v_xor_b32 v131, v92, v131
v_xor_b32 v132, v92, v132
v_xor_b32 v133, v92, v133
v_xor_b32 v134, v92, v134
v_xor_b32 v135, v92, v135
v_xor_b32 v136, v92, v136
v_xor_b32 v137, v92, v137
v_lshlrev_b32 v114, 16, v110
v_and_b32 v115, 0xffff0000, v110
v_lshlrev_b32 v116, 16, v111
v_and_b32 v117, 0xffff0000, v111
s_mov_b32 exec_hi, 15
ds_write_b128 v109, v[114:117] offset:1024
s_mov_b64 exec, -1
s_mov_b32 s99, 32768
buffer_load_dwordx4 a[128:131], v112, s[24:27], s99 offen offset:0 sc1
s_mov_b32 s41, 2
s_mov_b32 s42, 0
s_mov_b32 s4, 37120
s_mov_b32 s22, 75497472
s_mov_b32 s5, 18560
s_mov_b32 s6, 4718592
s_mov_b64 vcc, s[80:81]
s_andn2_b32 s12, 63, s85
s_mov_b32 s59, 6
s_mov_b32 s56, 0
s_mov_b32 s64, 384
s_bitcmp1_b32 s2, 0
s_cselect_b32 s65, 288, -1
s_add_u32 s48, s46, 9437184
s_add_u32 s49, s48, 4718592
s_add_u32 s50, s49, 4718592
s_sub_u32 s58, s7, s45
s_bfe_u32 s47, s2, 0x20004
s_mul_i32 s57, s47, 294912
s_add_u32 s57, s57, 47185920
s_lshl_b32 s47, s47, 7
s_add_u32 s47, s47, 393216
s_add_u32 s32, s24, s47
s_addc_u32 s33, s25, 0
s_cmp_eq_u32 s40, 0
s_cselect_b32 s34, 4, 0
s_cselect_b64 s[62:63], 1, 0
s_waitcnt lgkmcnt(0)
v_mov_b32 v114, 163072
s_barrier
ds_read_b32 v114, v114
ds_read_b128 v[44:47], v0 offset:0
ds_read_b128 v[48:51], v1 offset:0
s_waitcnt vmcnt(18)
ds_read_b128 v[76:79], v2 offset:1024
ds_read_b128 v[80:83], v2 offset:1088
ds_read_b128 v[84:87], v2 offset:1152
ds_read_b128 v[88:91], v2 offset:1216
ds_read_b128 v[92:95], v2 offset:1280
ds_read_b128 v[96:99], v2 offset:1344
ds_read_b128 v[100:103], v2 offset:1408
ds_read_b128 v[104:107], v2 offset:1472
ds_read_b128 v[108:111], v2 offset:1536
buffer_load_dwordx4 a[132:135], v112, s[24:27], s99 offen offset:1024 sc1
ds_read_b128 v[8:11], v2 offset:1024
ds_read_b128 v[12:15], v2 offset:1088
ds_read_b128 v[16:19], v2 offset:1152
ds_read_b128 v[20:23], v2 offset:1216
ds_read_b128 v[24:27], v2 offset:1280
ds_read_b128 v[28:31], v2 offset:1344
ds_read_b128 v[32:35], v2 offset:1408
ds_read_b128 v[36:39], v2 offset:1472
ds_read_b128 v[40:43], v2 offset:1536
buffer_load_dwordx4 a[136:139], v112, s[24:27], s99 offen offset:2048 sc1
s_waitcnt lgkmcnt(15)
v_readfirstlane_b32 s47, v114
v_add_u32_sdwa v60, s42, v118 dst_sel:DWORD dst_unused:UNUSED_PAD src0_sel:DWORD src1_sel:WORD_0
s_cmp_lg_u32 s47, 0
s_cbranch_scc1 L_slow
v_smfmac_f32_16x16x64_bf16 v[76:79], a[0:3], v[44:51], v138
ds_read_b128 v[52:55], v0 offset:18560
ds_read_b128 v[56:59], v1 offset:18560
v_add_u32_sdwa v68, s42, v118 dst_sel:DWORD dst_unused:UNUSED_PAD src0_sel:DWORD src1_sel:WORD_0
v_smfmac_f32_16x16x64_bf16 v[80:83], a[4:7], v[44:51], v138 abid:1
ds_read_u16 v68, v68 offset:18560
v_add_u32_sdwa v69, s42, v118 dst_sel:DWORD dst_unused:UNUSED_PAD src0_sel:DWORD src1_sel:WORD_1
v_smfmac_f32_16x16x64_bf16 v[84:87], a[8:11], v[44:51], v139
s_waitcnt lgkmcnt(15)
buffer_load_dwordx4 a[140:143], v112, s[24:27], s99 offen offset:3072 sc1
ds_read_u16 v69, v69 offset:18560
v_add_u32_sdwa v70, s42, v119 dst_sel:DWORD dst_unused:UNUSED_PAD src0_sel:DWORD src1_sel:WORD_0
v_smfmac_f32_16x16x64_bf16 v[88:91], a[12:15], v[44:51], v139 abid:1
ds_read_u16 v70, v70 offset:18560
v_add_u32_sdwa v71, s42, v119 dst_sel:DWORD dst_unused:UNUSED_PAD src0_sel:DWORD src1_sel:WORD_1
v_smfmac_f32_16x16x64_bf16 v[92:95], a[16:19], v[44:51], v140
ds_read_u16 v71, v71 offset:18560
v_add_u32_sdwa v72, s42, v120 dst_sel:DWORD dst_unused:UNUSED_PAD src0_sel:DWORD src1_sel:WORD_0
v_smfmac_f32_16x16x64_bf16 v[96:99], a[20:23], v[44:51], v140 abid:1
s_waitcnt lgkmcnt(15)
s_mov_b32 s98, 4096
buffer_load_dwordx4 v[154:157], v113, s[24:27], s98 offen sc1
ds_read_u16 v72, v72 offset:18560
v_add_u32_sdwa v73, s42, v120 dst_sel:DWORD dst_unused:UNUSED_PAD src0_sel:DWORD src1_sel:WORD_1
v_smfmac_f32_16x16x64_bf16 v[100:103], a[24:27], v[44:51], v141
ds_read_u16 v73, v73 offset:18560
v_add_u32_sdwa v74, s42, v121 dst_sel:DWORD dst_unused:UNUSED_PAD src0_sel:DWORD src1_sel:WORD_0
v_smfmac_f32_16x16x64_bf16 v[104:107], a[28:31], v[44:51], v141 abid:1
ds_read_u16 v74, v74 offset:18560
v_add_u32_sdwa v75, s42, v121 dst_sel:DWORD dst_unused:UNUSED_PAD src0_sel:DWORD src1_sel:WORD_1
v_smfmac_f32_16x16x64_bf16 v[108:111], a[32:35], v[44:51], v174
s_waitcnt lgkmcnt(7)
s_mov_b32 s99, 36864
buffer_load_dwordx4 a[144:147], v112, s[24:27], s99 offen offset:0 sc1
ds_read_u16 v75, v75 offset:18560
v_smfmac_f32_16x16x64_bf16 v[8:11], a[0:3], v[52:59], v138
ds_read_b128 v[114:117], v2 offset:64
v_add_u32_sdwa v60, s42, v118 dst_sel:DWORD dst_unused:UNUSED_PAD src0_sel:DWORD src1_sel:WORD_0
v_smfmac_f32_16x16x64_bf16 v[12:15], a[4:7], v[52:59], v138 abid:1
ds_read_b128 v[44:47], v0 offset:2048
v_add_u32_sdwa v61, s42, v118 dst_sel:DWORD dst_unused:UNUSED_PAD src0_sel:DWORD src1_sel:WORD_1
v_smfmac_f32_16x16x64_bf16 v[16:19], a[8:11], v[52:59], v139
buffer_load_dwordx4 a[148:151], v112, s[24:27], s99 offen offset:1024 sc1
ds_read_b128 v[48:51], v1 offset:2048
v_add_u32_sdwa v62, s42, v119 dst_sel:DWORD dst_unused:UNUSED_PAD src0_sel:DWORD src1_sel:WORD_0
v_smfmac_f32_16x16x64_bf16 v[20:23], a[12:15], v[52:59], v139 abid:1
ds_read_u16 v60, v60 offset:0
v_add_u32_sdwa v63, s42, v119 dst_sel:DWORD dst_unused:UNUSED_PAD src0_sel:DWORD src1_sel:WORD_1
v_smfmac_f32_16x16x64_bf16 v[24:27], a[16:19], v[52:59], v140
ds_read_u16 v61, v61 offset:0
v_add_u32_sdwa v64, s42, v120 dst_sel:DWORD dst_unused:UNUSED_PAD src0_sel:DWORD src1_sel:WORD_0
v_smfmac_f32_16x16x64_bf16 v[28:31], a[20:23], v[52:59], v140 abid:1
buffer_load_dwordx4 a[152:155], v112, s[24:27], s99 offen offset:2048 sc1
ds_read_u16 v62, v62 offset:0
v_add_u32_sdwa v65, s42, v120 dst_sel:DWORD dst_unused:UNUSED_PAD src0_sel:DWORD src1_sel:WORD_1
v_smfmac_f32_16x16x64_bf16 v[32:35], a[24:27], v[52:59], v141
ds_read_u16 v63, v63 offset:0
v_add_u32_sdwa v66, s42, v121 dst_sel:DWORD dst_unused:UNUSED_PAD src0_sel:DWORD src1_sel:WORD_0
v_smfmac_f32_16x16x64_bf16 v[36:39], a[28:31], v[52:59], v141 abid:1
ds_read_u16 v64, v64 offset:0
v_add_u32_sdwa v67, s42, v121 dst_sel:DWORD dst_unused:UNUSED_PAD src0_sel:DWORD src1_sel:WORD_1
v_smfmac_f32_16x16x64_bf16 v[40:43], a[32:35], v[52:59], v174
s_waitcnt lgkmcnt(7)
buffer_load_dwordx4 a[156:159], v112, s[24:27], s99 offen offset:3072 sc1
ds_read_u16 v65, v65 offset:0
v_smfmac_f32_16x16x64_bf16 v[8:11], v[114:117], v[68:75], v179
ds_read_u16 v66, v66 offset:0
v_smfmac_f32_16x16x64_bf16 v[12:15], v[114:117], v[68:75], v179 abid:1
s_waitcnt lgkmcnt(7)
ds_read_u16 v67, v67 offset:0
v_smfmac_f32_16x16x64_bf16 v[76:79], a[36:39], v[44:51], v142
s_mov_b32 s99, 40960
buffer_load_dwordx4 a[160:163], v112, s[24:27], s99 offen offset:0 sc1
ds_read_b128 v[52:55], v0 offset:20608
v_add_u32_sdwa v68, s42, v122 dst_sel:DWORD dst_unused:UNUSED_PAD src0_sel:DWORD src1_sel:WORD_0
v_smfmac_f32_16x16x64_bf16 v[80:83], a[40:43], v[44:51], v142 abid:1
ds_read_b128 v[56:59], v1 offset:20608
v_add_u32_sdwa v69, s42, v122 dst_sel:DWORD dst_unused:UNUSED_PAD src0_sel:DWORD src1_sel:WORD_1
v_smfmac_f32_16x16x64_bf16 v[84:87], a[44:47], v[44:51], v143
ds_read_u16 v68, v68 offset:18560
v_add_u32_sdwa v70, s42, v123 dst_sel:DWORD dst_unused:UNUSED_PAD src0_sel:DWORD src1_sel:WORD_0
v_smfmac_f32_16x16x64_bf16 v[88:91], a[48:51], v[44:51], v143 abid:1
buffer_load_dwordx4 a[164:167], v112, s[24:27], s99 offen offset:1024 sc1
ds_read_u16 v69, v69 offset:18560
v_add_u32_sdwa v71, s42, v123 dst_sel:DWORD dst_unused:UNUSED_PAD src0_sel:DWORD src1_sel:WORD_1
v_smfmac_f32_16x16x64_bf16 v[92:95], a[52:55], v[44:51], v144
ds_read_u16 v70, v70 offset:18560
v_add_u32_sdwa v72, s42, v124 dst_sel:DWORD dst_unused:UNUSED_PAD src0_sel:DWORD src1_sel:WORD_0
v_smfmac_f32_16x16x64_bf16 v[96:99], a[56:59], v[44:51], v144 abid:1
ds_read_u16 v71, v71 offset:18560
v_add_u32_sdwa v73, s42, v124 dst_sel:DWORD dst_unused:UNUSED_PAD src0_sel:DWORD src1_sel:WORD_1
v_smfmac_f32_16x16x64_bf16 v[100:103], a[60:63], v[44:51], v145
buffer_load_dwordx4 a[168:171], v112, s[24:27], s99 offen offset:2048 sc1
ds_read_u16 v72, v72 offset:18560
v_add_u32_sdwa v74, s42, v125 dst_sel:DWORD dst_unused:UNUSED_PAD src0_sel:DWORD src1_sel:WORD_0
v_smfmac_f32_16x16x64_bf16 v[104:107], a[64:67], v[44:51], v145 abid:1
s_waitcnt vmcnt(18)
ds_read_u16 v73, v73 offset:18560
v_add_u32_sdwa v75, s42, v125 dst_sel:DWORD dst_unused:UNUSED_PAD src0_sel:DWORD src1_sel:WORD_1
v_smfmac_f32_16x16x64_bf16 v[108:111], a[68:71], v[44:51], v174 abid:1
s_waitcnt lgkmcnt(8)
ds_read_u16 v74, v74 offset:18560
v_smfmac_f32_16x16x64_bf16 v[76:79], v[114:117], v[60:67], v179
buffer_load_dwordx4 a[172:175], v112, s[24:27], s99 offen offset:3072 sc1
ds_read_u16 v75, v75 offset:18560
v_smfmac_f32_16x16x64_bf16 v[80:83], v[114:117], v[60:67], v179 abid:1
s_waitcnt lgkmcnt(8)
v_smfmac_f32_16x16x64_bf16 v[8:11], a[36:39], v[52:59], v142
ds_read_b128 v[114:117], v2 offset:128
v_add_u32_sdwa v60, s42, v122 dst_sel:DWORD dst_unused:UNUSED_PAD src0_sel:DWORD src1_sel:WORD_0
v_smfmac_f32_16x16x64_bf16 v[12:15], a[40:43], v[52:59], v142 abid:1
s_mov_b32 s99, 45056
buffer_load_dwordx4 a[176:179], v112, s[24:27], s99 offen offset:0 sc1
ds_read_b128 v[44:47], v0 offset:4096
v_add_u32_sdwa v61, s42, v122 dst_sel:DWORD dst_unused:UNUSED_PAD src0_sel:DWORD src1_sel:WORD_1
v_smfmac_f32_16x16x64_bf16 v[16:19], a[44:47], v[52:59], v143
ds_read_b128 v[48:51], v1 offset:4096
v_add_u32_sdwa v62, s42, v123 dst_sel:DWORD dst_unused:UNUSED_PAD src0_sel:DWORD src1_sel:WORD_0
v_smfmac_f32_16x16x64_bf16 v[20:23], a[48:51], v[52:59], v143 abid:1
ds_read_u16 v60, v60 offset:0
v_add_u32_sdwa v63, s42, v123 dst_sel:DWORD dst_unused:UNUSED_PAD src0_sel:DWORD src1_sel:WORD_1
v_smfmac_f32_16x16x64_bf16 v[24:27], a[52:55], v[52:59], v144
s_mov_b32 s98, 5120
buffer_load_dwordx4 v[158:161], v113, s[24:27], s98 offen sc1
ds_read_u16 v61, v61 offset:0
v_add_u32_sdwa v64, s42, v124 dst_sel:DWORD dst_unused:UNUSED_PAD src0_sel:DWORD src1_sel:WORD_0
v_smfmac_f32_16x16x64_bf16 v[28:31], a[56:59], v[52:59], v144 abid:1
ds_read_u16 v62, v62 offset:0
v_add_u32_sdwa v65, s42, v124 dst_sel:DWORD dst_unused:UNUSED_PAD src0_sel:DWORD src1_sel:WORD_1
v_smfmac_f32_16x16x64_bf16 v[32:35], a[60:63], v[52:59], v145
ds_read_u16 v63, v63 offset:0
v_add_u32_sdwa v66, s42, v125 dst_sel:DWORD dst_unused:UNUSED_PAD src0_sel:DWORD src1_sel:WORD_0
v_smfmac_f32_16x16x64_bf16 v[36:39], a[64:67], v[52:59], v145 abid:1
buffer_load_dwordx4 a[180:183], v112, s[24:27], s99 offen offset:1024 sc1
ds_read_u16 v64, v64 offset:0
v_add_u32_sdwa v67, s42, v125 dst_sel:DWORD dst_unused:UNUSED_PAD src0_sel:DWORD src1_sel:WORD_1
v_smfmac_f32_16x16x64_bf16 v[40:43], a[68:71], v[52:59], v174 abid:1
s_waitcnt lgkmcnt(7)
ds_read_u16 v65, v65 offset:0
v_smfmac_f32_16x16x64_bf16 v[12:15], v[114:117], v[68:75], v180
ds_read_u16 v66, v66 offset:0
v_smfmac_f32_16x16x64_bf16 v[16:19], v[114:117], v[68:75], v180 abid:1
buffer_load_dwordx4 a[184:187], v112, s[24:27], s99 offen offset:2048 sc1
ds_read_u16 v67, v67 offset:0
v_smfmac_f32_16x16x64_bf16 v[20:23], v[114:117], v[68:75], v181
s_waitcnt lgkmcnt(8)
v_smfmac_f32_16x16x64_bf16 v[76:79], a[72:75], v[44:51], v146
ds_read_b128 v[52:55], v0 offset:22656
v_add_u32_sdwa v68, s42, v126 dst_sel:DWORD dst_unused:UNUSED_PAD src0_sel:DWORD src1_sel:WORD_0
v_smfmac_f32_16x16x64_bf16 v[80:83], a[76:79], v[44:51], v146 abid:1
buffer_load_dwordx4 a[188:191], v112, s[24:27], s99 offen offset:3072 sc1
ds_read_b128 v[56:59], v1 offset:22656
v_add_u32_sdwa v69, s42, v126 dst_sel:DWORD dst_unused:UNUSED_PAD src0_sel:DWORD src1_sel:WORD_1
v_smfmac_f32_16x16x64_bf16 v[84:87], a[80:83], v[44:51], v147
ds_read_u16 v68, v68 offset:18560
v_add_u32_sdwa v70, s42, v127 dst_sel:DWORD dst_unused:UNUSED_PAD src0_sel:DWORD src1_sel:WORD_0
v_smfmac_f32_16x16x64_bf16 v[88:91], a[84:87], v[44:51], v147 abid:1
ds_read_u16 v69, v69 offset:18560
v_add_u32_sdwa v71, s42, v127 dst_sel:DWORD dst_unused:UNUSED_PAD src0_sel:DWORD src1_sel:WORD_1
v_smfmac_f32_16x16x64_bf16 v[92:95], a[88:91], v[44:51], v148
s_mov_b32 s99, 49152
buffer_load_dwordx4 a[192:195], v112, s[24:27], s99 offen offset:0 sc1
ds_read_u16 v70, v70 offset:18560
v_add_u32_sdwa v72, s42, v128 dst_sel:DWORD dst_unused:UNUSED_PAD src0_sel:DWORD src1_sel:WORD_0
v_smfmac_f32_16x16x64_bf16 v[96:99], a[92:95], v[44:51], v148 abid:1
ds_read_u16 v71, v71 offset:18560
v_add_u32_sdwa v73, s42, v128 dst_sel:DWORD dst_unused:UNUSED_PAD src0_sel:DWORD src1_sel:WORD_1
v_smfmac_f32_16x16x64_bf16 v[100:103], a[96:99], v[44:51], v149
ds_read_u16 v72, v72 offset:18560
v_add_u32_sdwa v74, s42, v129 dst_sel:DWORD dst_unused:UNUSED_PAD src0_sel:DWORD src1_sel:WORD_0
v_smfmac_f32_16x16x64_bf16 v[104:107], a[100:103], v[44:51], v149 abid:1
buffer_load_dwordx4 a[196:199], v112, s[24:27], s99 offen offset:1024 sc1
ds_read_u16 v73, v73 offset:18560
v_add_u32_sdwa v75, s42, v129 dst_sel:DWORD dst_unused:UNUSED_PAD src0_sel:DWORD src1_sel:WORD_1
v_smfmac_f32_16x16x64_bf16 v[108:111], a[104:107], v[44:51], v175
s_waitcnt lgkmcnt(8)
ds_read_u16 v74, v74 offset:18560
v_smfmac_f32_16x16x64_bf16 v[80:83], v[114:117], v[60:67], v180
ds_read_u16 v75, v75 offset:18560
v_smfmac_f32_16x16x64_bf16 v[84:87], v[114:117], v[60:67], v180 abid:1
buffer_load_dwordx4 a[200:203], v112, s[24:27], s99 offen offset:2048 sc1
v_smfmac_f32_16x16x64_bf16 v[88:91], v[114:117], v[60:67], v181
s_waitcnt lgkmcnt(8)
v_smfmac_f32_16x16x64_bf16 v[8:11], a[72:75], v[52:59], v146
ds_read_b128 v[114:117], v2 offset:192
v_add_u32_sdwa v60, s42, v126 dst_sel:DWORD dst_unused:UNUSED_PAD src0_sel:DWORD src1_sel:WORD_0
v_smfmac_f32_16x16x64_bf16 v[12:15], a[76:79], v[52:59], v146 abid:1
buffer_load_dwordx4 a[204:207], v112, s[24:27], s99 offen offset:3072 sc1
ds_read_b128 v[44:47], v0 offset:6144
v_add_u32_sdwa v61, s42, v126 dst_sel:DWORD dst_unused:UNUSED_PAD src0_sel:DWORD src1_sel:WORD_1
v_smfmac_f32_16x16x64_bf16 v[16:19], a[80:83], v[52:59], v147
ds_read_b128 v[48:51], v1 offset:6144
v_add_u32_sdwa v62, s42, v127 dst_sel:DWORD dst_unused:UNUSED_PAD src0_sel:DWORD src1_sel:WORD_0
v_smfmac_f32_16x16x64_bf16 v[20:23], a[84:87], v[52:59], v147 abid:1
ds_read_u16 v60, v60 offset:0
v_add_u32_sdwa v63, s42, v127 dst_sel:DWORD dst_unused:UNUSED_PAD src0_sel:DWORD src1_sel:WORD_1
v_smfmac_f32_16x16x64_bf16 v[24:27], a[88:91], v[52:59], v148
s_mov_b32 s99, 53248
buffer_load_dwordx4 a[208:211], v112, s[24:27], s99 offen offset:0 sc1
ds_read_u16 v61, v61 offset:0
v_add_u32_sdwa v64, s42, v128 dst_sel:DWORD dst_unused:UNUSED_PAD src0_sel:DWORD src1_sel:WORD_0
v_smfmac_f32_16x16x64_bf16 v[28:31], a[92:95], v[52:59], v148 abid:1
ds_read_u16 v62, v62 offset:0
v_add_u32_sdwa v65, s42, v128 dst_sel:DWORD dst_unused:UNUSED_PAD src0_sel:DWORD src1_sel:WORD_1
v_smfmac_f32_16x16x64_bf16 v[32:35], a[96:99], v[52:59], v149
ds_read_u16 v63, v63 offset:0
v_add_u32_sdwa v66, s42, v129 dst_sel:DWORD dst_unused:UNUSED_PAD src0_sel:DWORD src1_sel:WORD_0
v_smfmac_f32_16x16x64_bf16 v[36:39], a[100:103], v[52:59], v149 abid:1
buffer_load_dwordx4 a[212:215], v112, s[24:27], s99 offen offset:1024 sc1
ds_read_u16 v64, v64 offset:0
v_add_u32_sdwa v67, s42, v129 dst_sel:DWORD dst_unused:UNUSED_PAD src0_sel:DWORD src1_sel:WORD_1
v_smfmac_f32_16x16x64_bf16 v[40:43], a[104:107], v[52:59], v175
s_waitcnt lgkmcnt(7)
ds_read_u16 v65, v65 offset:0
v_smfmac_f32_16x16x64_bf16 v[20:23], v[114:117], v[68:75], v181 abid:1
ds_read_u16 v66, v66 offset:0
v_smfmac_f32_16x16x64_bf16 v[24:27], v[114:117], v[68:75], v182
s_mov_b32 s98, 6144
buffer_load_dwordx4 v[162:165], v113, s[24:27], s98 offen sc1
ds_read_u16 v67, v67 offset:0
v_smfmac_f32_16x16x64_bf16 v[28:31], v[114:117], v[68:75], v182 abid:1
s_waitcnt vmcnt(18) lgkmcnt(8)
v_smfmac_f32_16x16x64_bf16 v[76:79], a[108:111], v[44:51], v150
ds_read_b128 v[52:55], v0 offset:24704
v_add_u32_sdwa v68, s42, v130 dst_sel:DWORD dst_unused:UNUSED_PAD src0_sel:DWORD src1_sel:WORD_0
v_smfmac_f32_16x16x64_bf16 v[80:83], a[112:115], v[44:51], v150 abid:1
buffer_load_dwordx4 a[216:219], v112, s[24:27], s99 offen offset:2048 sc1
ds_read_b128 v[56:59], v1 offset:24704
v_add_u32_sdwa v69, s42, v130 dst_sel:DWORD dst_unused:UNUSED_PAD src0_sel:DWORD src1_sel:WORD_1
v_smfmac_f32_16x16x64_bf16 v[84:87], a[116:119], v[44:51], v151
ds_read_u16 v68, v68 offset:18560
v_add_u32_sdwa v70, s42, v131 dst_sel:DWORD dst_unused:UNUSED_PAD src0_sel:DWORD src1_sel:WORD_0
v_smfmac_f32_16x16x64_bf16 v[88:91], a[120:123], v[44:51], v151 abid:1
ds_read_u16 v69, v69 offset:18560
v_add_u32_sdwa v71, s42, v131 dst_sel:DWORD dst_unused:UNUSED_PAD src0_sel:DWORD src1_sel:WORD_1
v_smfmac_f32_16x16x64_bf16 v[92:95], a[124:127], v[44:51], v152
buffer_load_dwordx4 a[220:223], v112, s[24:27], s99 offen offset:3072 sc1
ds_read_u16 v70, v70 offset:18560
v_add_u32_sdwa v72, s42, v132 dst_sel:DWORD dst_unused:UNUSED_PAD src0_sel:DWORD src1_sel:WORD_0
v_smfmac_f32_16x16x64_bf16 v[96:99], a[128:131], v[44:51], v152 abid:1
ds_read_u16 v71, v71 offset:18560
v_add_u32_sdwa v73, s42, v132 dst_sel:DWORD dst_unused:UNUSED_PAD src0_sel:DWORD src1_sel:WORD_1
v_smfmac_f32_16x16x64_bf16 v[100:103], a[132:135], v[44:51], v153
ds_read_u16 v72, v72 offset:18560
v_add_u32_sdwa v74, s42, v133 dst_sel:DWORD dst_unused:UNUSED_PAD src0_sel:DWORD src1_sel:WORD_0
v_smfmac_f32_16x16x64_bf16 v[104:107], a[136:139], v[44:51], v153 abid:1
s_mov_b32 s99, 57344
buffer_load_dwordx4 a[224:227], v112, s[24:27], s99 offen offset:0 sc1
ds_read_u16 v73, v73 offset:18560
v_add_u32_sdwa v75, s42, v133 dst_sel:DWORD dst_unused:UNUSED_PAD src0_sel:DWORD src1_sel:WORD_1
v_smfmac_f32_16x16x64_bf16 v[108:111], a[140:143], v[44:51], v175 abid:1
s_waitcnt lgkmcnt(8)
ds_read_u16 v74, v74 offset:18560
v_smfmac_f32_16x16x64_bf16 v[88:91], v[114:117], v[60:67], v181 abid:1
buffer_load_dwordx4 a[228:231], v112, s[24:27], s99 offen offset:1024 sc1
ds_read_u16 v75, v75 offset:18560
v_smfmac_f32_16x16x64_bf16 v[92:95], v[114:117], v[60:67], v182
v_smfmac_f32_16x16x64_bf16 v[96:99], v[114:117], v[60:67], v182 abid:1
s_waitcnt lgkmcnt(8)
v_smfmac_f32_16x16x64_bf16 v[8:11], a[108:111], v[52:59], v150
buffer_load_dwordx4 a[232:235], v112, s[24:27], s99 offen offset:2048 sc1
ds_read_b128 v[114:117], v2 offset:256
v_add_u32_sdwa v60, s42, v130 dst_sel:DWORD dst_unused:UNUSED_PAD src0_sel:DWORD src1_sel:WORD_0
v_smfmac_f32_16x16x64_bf16 v[12:15], a[112:115], v[52:59], v150 abid:1
ds_read_b128 v[44:47], v0 offset:8192
v_add_u32_sdwa v61, s42, v130 dst_sel:DWORD dst_unused:UNUSED_PAD src0_sel:DWORD src1_sel:WORD_1
v_smfmac_f32_16x16x64_bf16 v[16:19], a[116:119], v[52:59], v151
ds_read_b128 v[48:51], v1 offset:8192
v_add_u32_sdwa v62, s42, v131 dst_sel:DWORD dst_unused:UNUSED_PAD src0_sel:DWORD src1_sel:WORD_0
v_smfmac_f32_16x16x64_bf16 v[20:23], a[120:123], v[52:59], v151 abid:1
buffer_load_dwordx4 a[236:239], v112, s[24:27], s99 offen offset:3072 sc1
ds_read_u16 v60, v60 offset:0
v_add_u32_sdwa v63, s42, v131 dst_sel:DWORD dst_unused:UNUSED_PAD src0_sel:DWORD src1_sel:WORD_1
v_smfmac_f32_16x16x64_bf16 v[24:27], a[124:127], v[52:59], v152
ds_read_u16 v61, v61 offset:0
v_add_u32_sdwa v64, s42, v132 dst_sel:DWORD dst_unused:UNUSED_PAD src0_sel:DWORD src1_sel:WORD_0
v_smfmac_f32_16x16x64_bf16 v[28:31], a[128:131], v[52:59], v152 abid:1
ds_read_u16 v62, v62 offset:0
v_add_u32_sdwa v65, s42, v132 dst_sel:DWORD dst_unused:UNUSED_PAD src0_sel:DWORD src1_sel:WORD_1
v_smfmac_f32_16x16x64_bf16 v[32:35], a[132:135], v[52:59], v153
s_mov_b32 s99, 61440
buffer_load_dwordx4 a[240:243], v112, s[24:27], s99 offen offset:0 sc1
ds_read_u16 v63, v63 offset:0
v_add_u32_sdwa v66, s42, v133 dst_sel:DWORD dst_unused:UNUSED_PAD src0_sel:DWORD src1_sel:WORD_0
v_smfmac_f32_16x16x64_bf16 v[36:39], a[136:139], v[52:59], v153 abid:1
ds_read_u16 v64, v64 offset:0
v_add_u32_sdwa v67, s42, v133 dst_sel:DWORD dst_unused:UNUSED_PAD src0_sel:DWORD src1_sel:WORD_1
v_smfmac_f32_16x16x64_bf16 v[40:43], a[140:143], v[52:59], v175 abid:1
s_waitcnt lgkmcnt(7)
ds_read_u16 v65, v65 offset:0
v_smfmac_f32_16x16x64_bf16 v[28:31], v[114:117], v[68:75], v183
buffer_load_dwordx4 a[244:247], v112, s[24:27], s99 offen offset:1024 sc1
ds_read_u16 v66, v66 offset:0
v_smfmac_f32_16x16x64_bf16 v[32:35], v[114:117], v[68:75], v183 abid:1
ds_read_u16 v67, v67 offset:0
v_smfmac_f32_16x16x64_bf16 v[36:39], v[114:117], v[68:75], v184
s_waitcnt lgkmcnt(8)
v_smfmac_f32_16x16x64_bf16 v[76:79], a[144:147], v[44:51], v154
buffer_load_dwordx4 a[248:251], v112, s[24:27], s99 offen offset:2048 sc1
ds_read_b128 v[52:55], v0 offset:26752
v_add_u32_sdwa v68, s42, v134 dst_sel:DWORD dst_unused:UNUSED_PAD src0_sel:DWORD src1_sel:WORD_0
v_smfmac_f32_16x16x64_bf16 v[80:83], a[148:151], v[44:51], v154 abid:1
s_waitcnt vmcnt(18)
ds_read_b128 v[56:59], v1 offset:26752
v_add_u32_sdwa v69, s42, v134 dst_sel:DWORD dst_unused:UNUSED_PAD src0_sel:DWORD src1_sel:WORD_1
v_smfmac_f32_16x16x64_bf16 v[84:87], a[152:155], v[44:51], v155
ds_read_u16 v68, v68 offset:18560
v_add_u32_sdwa v70, s42, v135 dst_sel:DWORD dst_unused:UNUSED_PAD src0_sel:DWORD src1_sel:WORD_0
v_smfmac_f32_16x16x64_bf16 v[88:91], a[156:159], v[44:51], v155 abid:1
s_mov_b32 s98, 7168
buffer_load_dwordx4 v[166:169], v113, s[24:27], s98 offen sc1
ds_read_u16 v69, v69 offset:18560
v_add_u32_sdwa v71, s42, v135 dst_sel:DWORD dst_unused:UNUSED_PAD src0_sel:DWORD src1_sel:WORD_1
v_smfmac_f32_16x16x64_bf16 v[92:95], a[160:163], v[44:51], v156
ds_read_u16 v70, v70 offset:18560
v_add_u32_sdwa v72, s42, v136 dst_sel:DWORD dst_unused:UNUSED_PAD src0_sel:DWORD src1_sel:WORD_0
v_smfmac_f32_16x16x64_bf16 v[96:99], a[164:167], v[44:51], v156 abid:1
ds_read_u16 v71, v71 offset:18560
v_add_u32_sdwa v73, s42, v136 dst_sel:DWORD dst_unused:UNUSED_PAD src0_sel:DWORD src1_sel:WORD_1
v_smfmac_f32_16x16x64_bf16 v[100:103], a[168:171], v[44:51], v157
s_mov_b32 s98, 8192
buffer_load_dwordx4 v[170:173], v113, s[24:27], s98 offen sc1
ds_read_u16 v72, v72 offset:18560
v_add_u32_sdwa v74, s42, v137 dst_sel:DWORD dst_unused:UNUSED_PAD src0_sel:DWORD src1_sel:WORD_0
v_smfmac_f32_16x16x64_bf16 v[104:107], a[172:175], v[44:51], v157 abid:1
ds_read_u16 v73, v73 offset:18560
v_add_u32_sdwa v75, s42, v137 dst_sel:DWORD dst_unused:UNUSED_PAD src0_sel:DWORD src1_sel:WORD_1
v_smfmac_f32_16x16x64_bf16 v[108:111], a[176:179], v[44:51], v176
s_waitcnt lgkmcnt(8)
ds_read_u16 v74, v74 offset:18560
v_smfmac_f32_16x16x64_bf16 v[96:99], v[114:117], v[60:67], v183
s_mov_b32 s99, 69632
buffer_load_dwordx4 v[214:217], v112, s[24:27], s99 offen offset:3072 sc1
ds_read_u16 v75, v75 offset:18560
v_smfmac_f32_16x16x64_bf16 v[100:103], v[114:117], v[60:67], v183 abid:1
v_smfmac_f32_16x16x64_bf16 v[104:107], v[114:117], v[60:67], v184
s_waitcnt lgkmcnt(8)
v_smfmac_f32_16x16x64_bf16 v[8:11], a[144:147], v[52:59], v154
s_mov_b32 s99, 81920
buffer_load_dwordx4 v[250:253], v112, s[24:27], s99 offen offset:0 sc1
ds_read_b128 v[114:117], v2 offset:320
v_add_u32_sdwa v60, s42, v134 dst_sel:DWORD dst_unused:UNUSED_PAD src0_sel:DWORD src1_sel:WORD_0
v_smfmac_f32_16x16x64_bf16 v[12:15], a[148:151], v[52:59], v154 abid:1
ds_read_b128 v[44:47], v0 offset:10240
v_add_u32_sdwa v61, s42, v134 dst_sel:DWORD dst_unused:UNUSED_PAD src0_sel:DWORD src1_sel:WORD_1
v_smfmac_f32_16x16x64_bf16 v[16:19], a[152:155], v[52:59], v155
ds_read_b128 v[48:51], v1 offset:10240
v_add_u32_sdwa v62, s42, v135 dst_sel:DWORD dst_unused:UNUSED_PAD src0_sel:DWORD src1_sel:WORD_0
v_smfmac_f32_16x16x64_bf16 v[20:23], a[156:159], v[52:59], v155 abid:1
s_mov_b32 s99, 61440
buffer_load_dwordx4 a[252:255], v112, s[24:27], s99 offen offset:3072 sc1
ds_read_u16 v60, v60 offset:0
v_add_u32_sdwa v63, s42, v135 dst_sel:DWORD dst_unused:UNUSED_PAD src0_sel:DWORD src1_sel:WORD_1
v_smfmac_f32_16x16x64_bf16 v[24:27], a[160:163], v[52:59], v156
ds_read_u16 v61, v61 offset:0
v_add_u32_sdwa v64, s42, v136 dst_sel:DWORD dst_unused:UNUSED_PAD src0_sel:DWORD src1_sel:WORD_0
v_smfmac_f32_16x16x64_bf16 v[28:31], a[164:167], v[52:59], v156 abid:1
ds_read_u16 v62, v62 offset:0
v_add_u32_sdwa v65, s42, v136 dst_sel:DWORD dst_unused:UNUSED_PAD src0_sel:DWORD src1_sel:WORD_1
v_smfmac_f32_16x16x64_bf16 v[32:35], a[168:171], v[52:59], v157
s_mov_b32 s99, 73728
buffer_load_dwordx4 v[218:221], v112, s[24:27], s99 offen offset:0 sc1
ds_read_u16 v63, v63 offset:0
v_add_u32_sdwa v66, s42, v137 dst_sel:DWORD dst_unused:UNUSED_PAD src0_sel:DWORD src1_sel:WORD_0
v_smfmac_f32_16x16x64_bf16 v[36:39], a[172:175], v[52:59], v157 abid:1
ds_read_u16 v64, v64 offset:0
v_add_u32_sdwa v67, s42, v137 dst_sel:DWORD dst_unused:UNUSED_PAD src0_sel:DWORD src1_sel:WORD_1
v_smfmac_f32_16x16x64_bf16 v[40:43], a[176:179], v[52:59], v176
s_waitcnt lgkmcnt(7)
ds_read_u16 v65, v65 offset:0
v_smfmac_f32_16x16x64_bf16 v[36:39], v[114:117], v[68:75], v184 abid:1
s_mov_b32 s99, 65536
buffer_load_dwordx4 v[186:189], v112, s[24:27], s99 offen offset:0 sc1
ds_read_u16 v66, v66 offset:0
v_smfmac_f32_16x16x64_bf16 v[40:43], v[114:117], v[68:75], v185
s_waitcnt lgkmcnt(7)
ds_read_u16 v67, v67 offset:0
v_smfmac_f32_16x16x64_bf16 v[76:79], a[180:183], v[44:51], v158
s_waitcnt vmcnt(18)
ds_read_b128 v[52:55], v0 offset:28800
v_smfmac_f32_16x16x64_bf16 v[80:83], a[184:187], v[44:51], v158 abid:1
s_mov_b32 s99, 73728
buffer_load_dwordx4 v[222:225], v112, s[24:27], s99 offen offset:1024 sc1
ds_read_b128 v[56:59], v1 offset:28800
v_smfmac_f32_16x16x64_bf16 v[84:87], a[188:191], v[44:51], v159
ds_read_b128 v[68:71], v0 offset:34944
v_smfmac_f32_16x16x64_bf16 v[88:91], a[192:195], v[44:51], v159 abid:1
ds_read_b128 v[72:75], v1 offset:34944
v_smfmac_f32_16x16x64_bf16 v[92:95], a[196:199], v[44:51], v160
s_mov_b32 s99, 65536
buffer_load_dwordx4 v[190:193], v112, s[24:27], s99 offen offset:1024 sc1
v_smfmac_f32_16x16x64_bf16 v[96:99], a[200:203], v[44:51], v160 abid:1
v_smfmac_f32_16x16x64_bf16 v[100:103], a[204:207], v[44:51], v161
v_smfmac_f32_16x16x64_bf16 v[104:107], a[208:211], v[44:51], v161 abid:1
s_waitcnt vmcnt(18)
s_mov_b32 s99, 73728
buffer_load_dwordx4 v[226:229], v112, s[24:27], s99 offen offset:2048 sc1
v_smfmac_f32_16x16x64_bf16 v[108:111], a[212:215], v[44:51], v176 abid:1
s_waitcnt lgkmcnt(4)
v_smfmac_f32_16x16x64_bf16 v[104:107], v[114:117], v[60:67], v184 abid:1
v_smfmac_f32_16x16x64_bf16 v[108:111], v[114:117], v[60:67], v185
s_waitcnt lgkmcnt(2)
s_mov_b32 s99, 65536
buffer_load_dwordx4 v[194:197], v112, s[24:27], s99 offen offset:2048 sc1
v_smfmac_f32_16x16x64_bf16 v[8:11], a[180:183], v[52:59], v158
ds_read_b128 v[44:47], v0 offset:12288
v_smfmac_f32_16x16x64_bf16 v[12:15], a[184:187], v[52:59], v158 abid:1
ds_read_b128 v[48:51], v1 offset:12288
v_smfmac_f32_16x16x64_bf16 v[16:19], a[188:191], v[52:59], v159
s_mov_b32 s99, 73728
buffer_load_dwordx4 v[230:233], v112, s[24:27], s99 offen offset:3072 sc1
ds_read_b128 v[60:63], v0 offset:32896
v_smfmac_f32_16x16x64_bf16 v[20:23], a[192:195], v[52:59], v159 abid:1
ds_read_b128 v[64:67], v1 offset:32896
v_smfmac_f32_16x16x64_bf16 v[24:27], a[196:199], v[52:59], v160
v_smfmac_f32_16x16x64_bf16 v[28:31], a[200:203], v[52:59], v160 abid:1
s_mov_b32 s99, 65536
buffer_load_dwordx4 v[198:201], v112, s[24:27], s99 offen offset:3072 sc1
v_smfmac_f32_16x16x64_bf16 v[32:35], a[204:207], v[52:59], v161
v_smfmac_f32_16x16x64_bf16 v[36:39], a[208:211], v[52:59], v161 abid:1
v_smfmac_f32_16x16x64_bf16 v[40:43], a[212:215], v[52:59], v176 abid:1
s_waitcnt vmcnt(18) lgkmcnt(2)
s_mov_b32 s99, 77824
buffer_load_dwordx4 v[234:237], v112, s[24:27], s99 offen offset:0 sc1
v_smfmac_f32_16x16x64_bf16 v[76:79], a[216:219], v[44:51], v162
ds_read_b128 v[52:55], v0 offset:30848
v_smfmac_f32_16x16x64_bf16 v[80:83], a[220:223], v[44:51], v162 abid:1
ds_read_b128 v[56:59], v1 offset:30848
v_smfmac_f32_16x16x64_bf16 v[84:87], a[224:227], v[44:51], v163
s_mov_b32 s99, 69632
buffer_load_dwordx4 v[202:205], v112, s[24:27], s99 offen offset:0 sc1
v_smfmac_f32_16x16x64_bf16 v[88:91], a[228:231], v[44:51], v163 abid:1
s_waitcnt vmcnt(18)
v_smfmac_f32_16x16x64_bf16 v[92:95], a[232:235], v[44:51], v164
v_smfmac_f32_16x16x64_bf16 v[96:99], a[236:239], v[44:51], v164 abid:1
s_waitcnt vmcnt(17)
s_mov_b32 s99, 77824
buffer_load_dwordx4 v[238:241], v112, s[24:27], s99 offen offset:1024 sc1
v_smfmac_f32_16x16x64_bf16 v[100:103], a[240:243], v[44:51], v165
s_waitcnt vmcnt(17)
v_smfmac_f32_16x16x64_bf16 v[104:107], a[244:247], v[44:51], v165 abid:1
s_waitcnt vmcnt(16)
v_smfmac_f32_16x16x64_bf16 v[108:111], a[248:251], v[44:51], v177
s_waitcnt lgkmcnt(0)
s_mov_b32 s99, 69632
buffer_load_dwordx4 v[206:209], v112, s[24:27], s99 offen offset:1024 sc1
v_smfmac_f32_16x16x64_bf16 v[8:11], a[216:219], v[52:59], v162
ds_read_b128 v[44:47], v0 offset:14336
v_smfmac_f32_16x16x64_bf16 v[12:15], a[220:223], v[52:59], v162 abid:1
ds_read_b128 v[48:51], v1 offset:14336
v_smfmac_f32_16x16x64_bf16 v[16:19], a[224:227], v[52:59], v163
s_mov_b32 s99, 77824
buffer_load_dwordx4 v[242:245], v112, s[24:27], s99 offen offset:2048 sc1
v_smfmac_f32_16x16x64_bf16 v[20:23], a[228:231], v[52:59], v163 abid:1
v_smfmac_f32_16x16x64_bf16 v[24:27], a[232:235], v[52:59], v164
v_smfmac_f32_16x16x64_bf16 v[28:31], a[236:239], v[52:59], v164 abid:1
s_mov_b32 s99, 69632
buffer_load_dwordx4 v[210:213], v112, s[24:27], s99 offen offset:2048 sc1
v_smfmac_f32_16x16x64_bf16 v[32:35], a[240:243], v[52:59], v165
v_smfmac_f32_16x16x64_bf16 v[36:39], a[244:247], v[52:59], v165 abid:1
v_smfmac_f32_16x16x64_bf16 v[40:43], a[248:251], v[52:59], v177
s_mov_b32 s99, 77824
buffer_load_dwordx4 v[246:249], v112, s[24:27], s99 offen offset:3072 sc1
s_bfe_u32 s47, s85, 0x40018
s_cbranch_scc0 L_ptail0
ds_read_b128 v[52:55], v0 offset:16384
ds_read_b128 v[56:59], v1 offset:16384
s_waitcnt vmcnt(17) lgkmcnt(2)
v_smfmac_f32_16x16x64_bf16 v[108:111], v[214:217], v[44:51], v177 abid:1
s_add_u32 m0, s44, 0
s_nop 0
buffer_load_dwordx4 v3, s[16:19], s45 offen offset:0 nt lds
s_waitcnt vmcnt(17) lgkmcnt(0)
v_smfmac_f32_16x16x64_bf16 v[108:111], v[250:253], v[52:59], v178
s_add_u32 m0, s44, 3840
s_nop 0
buffer_load_dwordx4 v3, s[16:19], s45 offen offset:256 nt lds
v_add_u32 v0, 37120, v0
v_add_u32 v1, 37120, v1
s_waitcnt vmcnt(17)
v_smfmac_f32_16x16x64_bf16 v[76:79], a[252:255], v[44:51], v166
s_add_u32 m0, s44, 7680
s_nop 0
buffer_load_dwordx4 v3, s[16:19], s45 offen offset:512 nt lds
s_waitcnt vmcnt(17)
v_smfmac_f32_16x16x64_bf16 v[76:79], v[218:221], v[52:59], v170
v_cvt_pk_bf16_f32 v108, v108, v109
v_cvt_pk_bf16_f32 v109, v110, v111
ds_bpermute_b32 v108, v6, v108
ds_bpermute_b32 v109, v6, v109
s_waitcnt vmcnt(16)
v_smfmac_f32_16x16x64_bf16 v[80:83], v[186:189], v[44:51], v166 abid:1
s_add_u32 m0, s44, 11520
s_nop 0
buffer_load_dwordx4 v3, s[16:19], s45 offen offset:768 nt lds
s_waitcnt vmcnt(16)
v_smfmac_f32_16x16x64_bf16 v[80:83], v[222:225], v[52:59], v170 abid:1
s_add_u32 m0, s44, s8
s_mov_b64 exec, s[10:11]
buffer_load_dwordx4 v3, s[16:19], s7 offen offset:896 nt lds
s_mov_b64 exec, -1
s_add_u32 s7, s7, 4718592
s_add_u32 s44, s44, 18560
s_add_u32 s45, s45, 4718592
v_cvt_pk_bf16_f32 v76, v76, v77
v_cvt_pk_bf16_f32 v77, v78, v79
s_waitcnt vmcnt(16)
v_smfmac_f32_16x16x64_bf16 v[84:87], v[190:193], v[44:51], v167
s_waitcnt vmcnt(15)
v_smfmac_f32_16x16x64_bf16 v[84:87], v[226:229], v[52:59], v171
s_add_u32 m0, s44, 0
s_nop 0
buffer_load_dwordx4 v3, s[16:19], s45 offen offset:0 nt lds
v_cvt_pk_bf16_f32 v78, v80, v81
v_cvt_pk_bf16_f32 v79, v82, v83
s_waitcnt lgkmcnt(0)
buffer_store_dwordx2 v[108:109], v5, s[20:23], s46 offen
s_waitcnt vmcnt(16)
v_smfmac_f32_16x16x64_bf16 v[88:91], v[194:197], v[44:51], v167 abid:1
s_add_u32 m0, s44, 3840
s_nop 0
buffer_load_dwordx4 v3, s[16:19], s45 offen offset:256 nt lds
s_waitcnt vmcnt(16)
v_smfmac_f32_16x16x64_bf16 v[88:91], v[230:233], v[52:59], v171 abid:1
s_add_u32 m0, s44, 7680
s_nop 0
buffer_load_dwordx4 v3, s[16:19], s45 offen offset:512 nt lds
v_cvt_pk_bf16_f32 v80, v84, v85
v_cvt_pk_bf16_f32 v81, v86, v87
s_waitcnt vmcnt(16)
v_smfmac_f32_16x16x64_bf16 v[92:95], v[198:201], v[44:51], v168
s_waitcnt vmcnt(15)
v_smfmac_f32_16x16x64_bf16 v[92:95], v[234:237], v[52:59], v172
s_add_u32 m0, s44, 11520
s_nop 0
buffer_load_dwordx4 v3, s[16:19], s45 offen offset:768 nt lds
v_cvt_pk_bf16_f32 v82, v88, v89
v_cvt_pk_bf16_f32 v83, v90, v91
v_cndmask_b32_dpp v114, v80, v76, vcc quad_perm:[1,0,3,2] row_mask:0xf bank_mask:0xf
v_cndmask_b32_dpp v115, v81, v77, vcc quad_perm:[1,0,3,2] row_mask:0xf bank_mask:0xf
v_cndmask_b32_dpp v116, v82, v78, vcc quad_perm:[1,0,3,2] row_mask:0xf bank_mask:0xf
v_cndmask_b32_dpp v117, v83, v79, vcc quad_perm:[1,0,3,2] row_mask:0xf bank_mask:0xf
buffer_store_dwordx4 v[114:117], v4, s[20:23], s46 offen offset:0 sc1
s_mov_b64 vcc, s[82:83]
s_waitcnt vmcnt(16)
v_smfmac_f32_16x16x64_bf16 v[96:99], v[202:205], v[44:51], v168 abid:1
s_add_u32 m0, s44, s8
s_mov_b64 exec, s[10:11]
buffer_load_dwordx4 v3, s[16:19], s7 offen offset:896 nt lds
s_mov_b64 exec, -1
s_add_u32 s7, s7, 4718592
s_add_u32 s44, s44, 18560
s_add_u32 s45, s45, 4718592
s_waitcnt vmcnt(16)
v_smfmac_f32_16x16x64_bf16 v[96:99], v[238:241], v[52:59], v172 abid:1
v_cvt_pk_bf16_f32 v84, v92, v93
v_cvt_pk_bf16_f32 v85, v94, v95
v_cndmask_b32_dpp v80, v76, v80, vcc quad_perm:[1,0,3,2] row_mask:0xf bank_mask:0xf
v_cndmask_b32_dpp v81, v77, v81, vcc quad_perm:[1,0,3,2] row_mask:0xf bank_mask:0xf
v_cndmask_b32_dpp v82, v78, v82, vcc quad_perm:[1,0,3,2] row_mask:0xf bank_mask:0xf
v_cndmask_b32_dpp v83, v79, v83, vcc quad_perm:[1,0,3,2] row_mask:0xf bank_mask:0xf
buffer_store_dwordx4 v[80:83], v4, s[20:23], s46 offen offset:1152 sc1
s_mov_b64 vcc, s[80:81]
s_waitcnt vmcnt(16)
v_smfmac_f32_16x16x64_bf16 v[100:103], v[206:209], v[44:51], v169
s_waitcnt vmcnt(15)
v_smfmac_f32_16x16x64_bf16 v[100:103], v[242:245], v[52:59], v173
v_cvt_pk_bf16_f32 v86, v96, v97
v_cvt_pk_bf16_f32 v87, v98, v99
v_add_u32_sdwa v76, s4, v118 dst_sel:DWORD dst_unused:UNUSED_PAD src0_sel:DWORD src1_sel:WORD_0
v_add_u32_sdwa v77, s4, v118 dst_sel:DWORD dst_unused:UNUSED_PAD src0_sel:DWORD src1_sel:WORD_1
v_add_u32_sdwa v78, s4, v119 dst_sel:DWORD dst_unused:UNUSED_PAD src0_sel:DWORD src1_sel:WORD_0
v_add_u32_sdwa v79, s4, v119 dst_sel:DWORD dst_unused:UNUSED_PAD src0_sel:DWORD src1_sel:WORD_1
s_waitcnt vmcnt(14)
v_smfmac_f32_16x16x64_bf16 v[104:107], v[210:213], v[44:51], v169 abid:1
s_waitcnt vmcnt(13)
v_smfmac_f32_16x16x64_bf16 v[104:107], v[246:249], v[52:59], v173 abid:1
v_cvt_pk_bf16_f32 v88, v100, v101
v_cvt_pk_bf16_f32 v89, v102, v103
v_add_u32_sdwa v80, s4, v120 dst_sel:DWORD dst_unused:UNUSED_PAD src0_sel:DWORD src1_sel:WORD_0
v_add_u32_sdwa v81, s4, v120 dst_sel:DWORD dst_unused:UNUSED_PAD src0_sel:DWORD src1_sel:WORD_1
v_add_u32_sdwa v82, s4, v121 dst_sel:DWORD dst_unused:UNUSED_PAD src0_sel:DWORD src1_sel:WORD_0
v_add_u32_sdwa v83, s4, v121 dst_sel:DWORD dst_unused:UNUSED_PAD src0_sel:DWORD src1_sel:WORD_1
s_nop 1
v_cvt_pk_bf16_f32 v90, v104, v105
v_cvt_pk_bf16_f32 v91, v106, v107
v_cndmask_b32_dpp v92, v88, v84, vcc quad_perm:[1,0,3,2] row_mask:0xf bank_mask:0xf
v_cndmask_b32_dpp v93, v89, v85, vcc quad_perm:[1,0,3,2] row_mask:0xf bank_mask:0xf
v_cndmask_b32_dpp v94, v90, v86, vcc quad_perm:[1,0,3,2] row_mask:0xf bank_mask:0xf
v_cndmask_b32_dpp v95, v91, v87, vcc quad_perm:[1,0,3,2] row_mask:0xf bank_mask:0xf
buffer_store_dwordx4 v[92:95], v4, s[20:23], s46 offen offset:128 sc1
s_mov_b64 vcc, s[82:83]
v_cndmask_b32_dpp v88, v84, v88, vcc quad_perm:[1,0,3,2] row_mask:0xf bank_mask:0xf
v_cndmask_b32_dpp v89, v85, v89, vcc quad_perm:[1,0,3,2] row_mask:0xf bank_mask:0xf
v_cndmask_b32_dpp v90, v86, v90, vcc quad_perm:[1,0,3,2] row_mask:0xf bank_mask:0xf
v_cndmask_b32_dpp v91, v87, v91, vcc quad_perm:[1,0,3,2] row_mask:0xf bank_mask:0xf
buffer_store_dwordx4 v[88:91], v4, s[20:23], s46 offen offset:1280 sc1
s_mov_b64 vcc, s[80:81]
s_branch L_ptail1
L_ptail0:
ds_read_b128 v[52:55], v0 offset:16384
ds_read_b128 v[56:59], v1 offset:16384
s_waitcnt vmcnt(17) lgkmcnt(2)
v_smfmac_f32_16x16x64_bf16 v[108:111], v[214:217], v[44:51], v177 abid:1
s_waitcnt vmcnt(16) lgkmcnt(0)
v_smfmac_f32_16x16x64_bf16 v[108:111], v[250:253], v[52:59], v178
v_add_u32 v0, 37120, v0
v_add_u32 v1, 37120, v1
s_waitcnt vmcnt(15)
v_smfmac_f32_16x16x64_bf16 v[76:79], a[252:255], v[44:51], v166
s_waitcnt vmcnt(14)
v_smfmac_f32_16x16x64_bf16 v[76:79], v[218:221], v[52:59], v170
s_nop 1
v_cvt_pk_bf16_f32 v108, v108, v109
v_cvt_pk_bf16_f32 v109, v110, v111
ds_bpermute_b32 v108, v6, v108
ds_bpermute_b32 v109, v6, v109
s_waitcnt vmcnt(13)
v_smfmac_f32_16x16x64_bf16 v[80:83], v[186:189], v[44:51], v166 abid:1
s_waitcnt vmcnt(12)
v_smfmac_f32_16x16x64_bf16 v[80:83], v[222:225], v[52:59], v170 abid:1
v_cvt_pk_bf16_f32 v76, v76, v77
v_cvt_pk_bf16_f32 v77, v78, v79
s_waitcnt vmcnt(11)
v_smfmac_f32_16x16x64_bf16 v[84:87], v[190:193], v[44:51], v167
s_waitcnt vmcnt(10)
v_smfmac_f32_16x16x64_bf16 v[84:87], v[226:229], v[52:59], v171
s_nop 1
v_cvt_pk_bf16_f32 v78, v80, v81
v_cvt_pk_bf16_f32 v79, v82, v83
s_waitcnt lgkmcnt(0)
buffer_store_dwordx2 v[108:109], v5, s[20:23], s46 offen
s_waitcnt vmcnt(10)
v_smfmac_f32_16x16x64_bf16 v[88:91], v[194:197], v[44:51], v167 abid:1
s_waitcnt vmcnt(9)
v_smfmac_f32_16x16x64_bf16 v[88:91], v[230:233], v[52:59], v171 abid:1
v_cvt_pk_bf16_f32 v80, v84, v85
v_cvt_pk_bf16_f32 v81, v86, v87
s_waitcnt vmcnt(8)
v_smfmac_f32_16x16x64_bf16 v[92:95], v[198:201], v[44:51], v168
s_waitcnt vmcnt(7)
v_smfmac_f32_16x16x64_bf16 v[92:95], v[234:237], v[52:59], v172
s_nop 1
v_cvt_pk_bf16_f32 v82, v88, v89
v_cvt_pk_bf16_f32 v83, v90, v91
v_cndmask_b32_dpp v114, v80, v76, vcc quad_perm:[1,0,3,2] row_mask:0xf bank_mask:0xf
v_cndmask_b32_dpp v115, v81, v77, vcc quad_perm:[1,0,3,2] row_mask:0xf bank_mask:0xf
v_cndmask_b32_dpp v116, v82, v78, vcc quad_perm:[1,0,3,2] row_mask:0xf bank_mask:0xf
v_cndmask_b32_dpp v117, v83, v79, vcc quad_perm:[1,0,3,2] row_mask:0xf bank_mask:0xf
buffer_store_dwordx4 v[114:117], v4, s[20:23], s46 offen offset:0 sc1
s_mov_b64 vcc, s[82:83]
s_waitcnt vmcnt(7)
v_smfmac_f32_16x16x64_bf16 v[96:99], v[202:205], v[44:51], v168 abid:1
s_waitcnt vmcnt(6)
v_smfmac_f32_16x16x64_bf16 v[96:99], v[238:241], v[52:59], v172 abid:1
v_cvt_pk_bf16_f32 v84, v92, v93
v_cvt_pk_bf16_f32 v85, v94, v95
v_cndmask_b32_dpp v80, v76, v80, vcc quad_perm:[1,0,3,2] row_mask:0xf bank_mask:0xf
v_cndmask_b32_dpp v81, v77, v81, vcc quad_perm:[1,0,3,2] row_mask:0xf bank_mask:0xf
v_cndmask_b32_dpp v82, v78, v82, vcc quad_perm:[1,0,3,2] row_mask:0xf bank_mask:0xf
v_cndmask_b32_dpp v83, v79, v83, vcc quad_perm:[1,0,3,2] row_mask:0xf bank_mask:0xf
buffer_store_dwordx4 v[80:83], v4, s[20:23], s46 offen offset:1152 sc1
s_mov_b64 vcc, s[80:81]
s_waitcnt vmcnt(6)
v_smfmac_f32_16x16x64_bf16 v[100:103], v[206:209], v[44:51], v169
s_waitcnt vmcnt(5)
v_smfmac_f32_16x16x64_bf16 v[100:103], v[242:245], v[52:59], v173
v_cvt_pk_bf16_f32 v86, v96, v97
v_cvt_pk_bf16_f32 v87, v98, v99
v_add_u32_sdwa v76, s4, v118 dst_sel:DWORD dst_unused:UNUSED_PAD src0_sel:DWORD src1_sel:WORD_0
v_add_u32_sdwa v77, s4, v118 dst_sel:DWORD dst_unused:UNUSED_PAD src0_sel:DWORD src1_sel:WORD_1
v_add_u32_sdwa v78, s4, v119 dst_sel:DWORD dst_unused:UNUSED_PAD src0_sel:DWORD src1_sel:WORD_0
v_add_u32_sdwa v79, s4, v119 dst_sel:DWORD dst_unused:UNUSED_PAD src0_sel:DWORD src1_sel:WORD_1
s_waitcnt vmcnt(4)
v_smfmac_f32_16x16x64_bf16 v[104:107], v[210:213], v[44:51], v169 abid:1
s_waitcnt vmcnt(3)
v_smfmac_f32_16x16x64_bf16 v[104:107], v[246:249], v[52:59], v173 abid:1
v_cvt_pk_bf16_f32 v88, v100, v101
v_cvt_pk_bf16_f32 v89, v102, v103
v_add_u32_sdwa v80, s4, v120 dst_sel:DWORD dst_unused:UNUSED_PAD src0_sel:DWORD src1_sel:WORD_0
v_add_u32_sdwa v81, s4, v120 dst_sel:DWORD dst_unused:UNUSED_PAD src0_sel:DWORD src1_sel:WORD_1
v_add_u32_sdwa v82, s4, v121 dst_sel:DWORD dst_unused:UNUSED_PAD src0_sel:DWORD src1_sel:WORD_0
v_add_u32_sdwa v83, s4, v121 dst_sel:DWORD dst_unused:UNUSED_PAD src0_sel:DWORD src1_sel:WORD_1
s_nop 1
v_cvt_pk_bf16_f32 v90, v104, v105
v_cvt_pk_bf16_f32 v91, v106, v107
v_cndmask_b32_dpp v92, v88, v84, vcc quad_perm:[1,0,3,2] row_mask:0xf bank_mask:0xf
v_cndmask_b32_dpp v93, v89, v85, vcc quad_perm:[1,0,3,2] row_mask:0xf bank_mask:0xf
v_cndmask_b32_dpp v94, v90, v86, vcc quad_perm:[1,0,3,2] row_mask:0xf bank_mask:0xf
v_cndmask_b32_dpp v95, v91, v87, vcc quad_perm:[1,0,3,2] row_mask:0xf bank_mask:0xf
buffer_store_dwordx4 v[92:95], v4, s[20:23], s46 offen offset:128 sc1
s_mov_b64 vcc, s[82:83]
v_cndmask_b32_dpp v88, v84, v88, vcc quad_perm:[1,0,3,2] row_mask:0xf bank_mask:0xf
v_cndmask_b32_dpp v89, v85, v89, vcc quad_perm:[1,0,3,2] row_mask:0xf bank_mask:0xf
v_cndmask_b32_dpp v90, v86, v90, vcc quad_perm:[1,0,3,2] row_mask:0xf bank_mask:0xf
v_cndmask_b32_dpp v91, v87, v91, vcc quad_perm:[1,0,3,2] row_mask:0xf bank_mask:0xf
buffer_store_dwordx4 v[88:91], v4, s[20:23], s46 offen offset:1280 sc1
s_mov_b64 vcc, s[80:81]
L_ptail1:
s_cmp_ge_u32 s44, 148480
s_cselect_b32 s44, s9, s44
s_add_u32 s46, s46, 4718592
s_waitcnt lgkmcnt(0)
s_barrier
s_cmp_lg_u32 s89, 0
s_cbranch_scc1 L_loopnk_p3
s_branch L_loopn_p3
.p2align 6
L_loop:
v_smfmac_f32_16x16x64_bf16 v[8:11], a[0:3], v[44:51], v138
ds_read_b128 v[32:35], v2 offset:1408
v_cvt_pk_bf16_f32 v106, v36, v37
v_smfmac_f32_16x16x64_bf16 v[8:11], a[36:39], v[52:59], v142
s_waitcnt lgkmcnt(9)
v_cvt_pk_bf16_f32 v107, v38, v39
v_smfmac_f32_16x16x64_bf16 v[12:15], a[4:7], v[44:51], v138 abid:1
ds_read_b128 v[36:39], v2 offset:1472
v_cvt_pk_bf16_f32 v112, v40, v41
v_smfmac_f32_16x16x64_bf16 v[12:15], a[40:43], v[52:59], v142 abid:1
s_waitcnt lgkmcnt(8)
ds_read_b128 v[60:63], v0 offset:4096
v_cvt_pk_bf16_f32 v113, v42, v43
v_smfmac_f32_16x16x64_bf16 v[16:19], a[8:11], v[44:51], v139
s_cmp_eq_u32 s4, 129920
ds_read_b128 v[40:43], v2 offset:1536
v_cndmask_b32_dpp v108, v96, v92, vcc quad_perm:[1,0,3,2] row_mask:0xf bank_mask:0xf
v_smfmac_f32_16x16x64_bf16 v[16:19], a[44:47], v[52:59], v143
s_waitcnt lgkmcnt(8)
ds_read_u16 v82, v82
v_cndmask_b32_dpp v109, v97, v93, vcc quad_perm:[1,0,3,2] row_mask:0xf bank_mask:0xf
v_smfmac_f32_16x16x64_bf16 v[20:23], a[12:15], v[44:51], v139 abid:1
s_cselect_b32 s43, -129920, s5
ds_read_u16 v84, v84
v_cndmask_b32_dpp v110, v98, v94, vcc quad_perm:[1,0,3,2] row_mask:0xf bank_mask:0xf
v_smfmac_f32_16x16x64_bf16 v[20:23], a[48:51], v[52:59], v143 abid:1
s_waitcnt lgkmcnt(8)
ds_read_b128 v[64:67], v1 offset:4096
v_cndmask_b32_dpp v111, v99, v95, vcc quad_perm:[1,0,3,2] row_mask:0xf bank_mask:0xf
v_smfmac_f32_16x16x64_bf16 v[24:27], a[16:19], v[44:51], v140
s_add_u32 s4, s4, s43
ds_read_b128 v[68:71], v0 offset:6144
v_add_u32_sdwa v87, s42, v123 dst_sel:DWORD dst_unused:UNUSED_PAD src0_sel:DWORD src1_sel:WORD_1
v_smfmac_f32_16x16x64_bf16 v[24:27], a[52:55], v[52:59], v144
buffer_store_dwordx4 v[108:111], v4, s[20:23], s46 offen offset:0 sc1
s_mov_b64 vcc, s[82:83]
s_waitcnt lgkmcnt(8)
ds_read_b128 v[72:75], v1 offset:6144
v_cndmask_b32_dpp v96, v92, v96, vcc quad_perm:[1,0,3,2] row_mask:0xf bank_mask:0xf
v_cndmask_b32_dpp v97, v93, v97, vcc quad_perm:[1,0,3,2] row_mask:0xf bank_mask:0xf
v_smfmac_f32_16x16x64_bf16 v[28:31], a[20:23], v[44:51], v140 abid:1
s_add_u32 s41, s41, 1
ds_read_u16 v83, v83
v_cndmask_b32_dpp v98, v94, v98, vcc quad_perm:[1,0,3,2] row_mask:0xf bank_mask:0xf
v_smfmac_f32_16x16x64_bf16 v[28:31], a[56:59], v[52:59], v144 abid:1
s_waitcnt lgkmcnt(9)
ds_read_b128 v[114:117], v2 offset:64
v_cndmask_b32_dpp v99, v95, v99, vcc quad_perm:[1,0,3,2] row_mask:0xf bank_mask:0xf
v_smfmac_f32_16x16x64_bf16 v[32:35], a[24:27], v[44:51], v141
ds_read_u16 v85, v85
v_add_u32_sdwa v88, s42, v124 dst_sel:DWORD dst_unused:UNUSED_PAD src0_sel:DWORD src1_sel:WORD_0
v_smfmac_f32_16x16x64_bf16 v[32:35], a[60:63], v[52:59], v145
s_waitcnt lgkmcnt(10)
ds_read_u16 v86, v86
v_add_u32_sdwa v89, s42, v124 dst_sel:DWORD dst_unused:UNUSED_PAD src0_sel:DWORD src1_sel:WORD_1
v_smfmac_f32_16x16x64_bf16 v[36:39], a[28:31], v[44:51], v141 abid:1
ds_read_u16 v87, v87
v_add_u32_sdwa v90, s42, v125 dst_sel:DWORD dst_unused:UNUSED_PAD src0_sel:DWORD src1_sel:WORD_0
v_smfmac_f32_16x16x64_bf16 v[36:39], a[64:67], v[52:59], v145 abid:1
s_waitcnt lgkmcnt(10)
ds_read_u16 v88, v88
v_add_u32_sdwa v91, s42, v125 dst_sel:DWORD dst_unused:UNUSED_PAD src0_sel:DWORD src1_sel:WORD_1
v_smfmac_f32_16x16x64_bf16 v[40:43], a[32:35], v[44:51], v174
buffer_store_dwordx4 v[96:99], v4, s[20:23], s46 offen offset:1152 sc1
s_mov_b64 vcc, s[80:81]
ds_read_u16 v89, v89
v_cndmask_b32_dpp v92, v104, v100, vcc quad_perm:[1,0,3,2] row_mask:0xf bank_mask:0xf
v_cndmask_b32_dpp v93, v105, v101, vcc quad_perm:[1,0,3,2] row_mask:0xf bank_mask:0xf
v_smfmac_f32_16x16x64_bf16 v[40:43], a[68:71], v[52:59], v174 abid:1
s_waitcnt lgkmcnt(9)
ds_read_u16 v90, v90
v_cndmask_b32_dpp v94, v106, v102, vcc quad_perm:[1,0,3,2] row_mask:0xf bank_mask:0xf
v_smfmac_f32_16x16x64_bf16 v[8:11], a[72:75], v[60:67], v146
s_waitcnt lgkmcnt(8)
ds_read_u16 v91, v91
v_cndmask_b32_dpp v95, v107, v103, vcc quad_perm:[1,0,3,2] row_mask:0xf bank_mask:0xf
v_smfmac_f32_16x16x64_bf16 v[8:11], a[108:111], v[68:75], v150
s_waitcnt lgkmcnt(7)
ds_bpermute_b32 v112, v6, v112
v_smfmac_f32_16x16x64_bf16 v[8:11], v[114:117], v[76:83], v179
ds_bpermute_b32 v113, v6, v113
v_smfmac_f32_16x16x64_bf16 v[12:15], v[114:117], v[76:83], v179 abid:1
ds_read_b128 v[114:117], v2 offset:128
v_add_u32_sdwa v76, s42, v126 dst_sel:DWORD dst_unused:UNUSED_PAD src0_sel:DWORD src1_sel:WORD_0
v_smfmac_f32_16x16x64_bf16 v[12:15], a[76:79], v[60:67], v146 abid:1
ds_read_u16 v76, v76
v_add_u32_sdwa v77, s42, v126 dst_sel:DWORD dst_unused:UNUSED_PAD src0_sel:DWORD src1_sel:WORD_1
v_smfmac_f32_16x16x64_bf16 v[12:15], a[112:115], v[68:75], v150 abid:1
buffer_store_dwordx4 v[92:95], v4, s[20:23], s46 offen offset:128 sc1
s_mov_b64 vcc, s[82:83]
ds_read_u16 v77, v77
v_cndmask_b32_dpp v104, v100, v104, vcc quad_perm:[1,0,3,2] row_mask:0xf bank_mask:0xf
v_add_u32_sdwa v78, s42, v127 dst_sel:DWORD dst_unused:UNUSED_PAD src0_sel:DWORD src1_sel:WORD_0
v_smfmac_f32_16x16x64_bf16 v[24:27], a[88:91], v[60:67], v148
ds_read_u16 v78, v78
v_cndmask_b32_dpp v105, v101, v105, vcc quad_perm:[1,0,3,2] row_mask:0xf bank_mask:0xf
v_smfmac_f32_16x16x64_bf16 v[24:27], a[124:127], v[68:75], v152
ds_read_b128 v[44:47], v0 offset:8192
v_cndmask_b32_dpp v106, v102, v106, vcc quad_perm:[1,0,3,2] row_mask:0xf bank_mask:0xf
v_smfmac_f32_16x16x64_bf16 v[28:31], a[92:95], v[60:67], v148 abid:1
ds_read_b128 v[48:51], v1 offset:8192
v_add_u32_sdwa v79, s42, v127 dst_sel:DWORD dst_unused:UNUSED_PAD src0_sel:DWORD src1_sel:WORD_1
v_smfmac_f32_16x16x64_bf16 v[28:31], a[128:131], v[68:75], v152 abid:1
ds_read_u16 v79, v79
v_cndmask_b32_dpp v107, v103, v107, vcc quad_perm:[1,0,3,2] row_mask:0xf bank_mask:0xf
v_smfmac_f32_16x16x64_bf16 v[32:35], a[96:99], v[60:67], v149
ds_read_b128 v[52:55], v0 offset:10240
v_add_u32_sdwa v80, s42, v128 dst_sel:DWORD dst_unused:UNUSED_PAD src0_sel:DWORD src1_sel:WORD_0
v_smfmac_f32_16x16x64_bf16 v[32:35], a[132:135], v[68:75], v153
ds_read_u16 v80, v80
v_add_u32_sdwa v81, s42, v128 dst_sel:DWORD dst_unused:UNUSED_PAD src0_sel:DWORD src1_sel:WORD_1
v_smfmac_f32_16x16x64_bf16 v[16:19], a[80:83], v[60:67], v147
buffer_store_dwordx4 v[104:107], v4, s[20:23], s46 offen offset:1280 sc1
s_mov_b64 vcc, s[80:81]
ds_read_b128 v[56:59], v1 offset:10240
v_add_u32_sdwa v82, s42, v129 dst_sel:DWORD dst_unused:UNUSED_PAD src0_sel:DWORD src1_sel:WORD_0
v_add_u32_sdwa v83, s42, v129 dst_sel:DWORD dst_unused:UNUSED_PAD src0_sel:DWORD src1_sel:WORD_1
v_smfmac_f32_16x16x64_bf16 v[16:19], a[116:119], v[68:75], v151
s_waitcnt lgkmcnt(9)
ds_read_b128 v[92:95], v0 offset:12288
v_add_u32_sdwa v100, s42, v130 dst_sel:DWORD dst_unused:UNUSED_PAD src0_sel:DWORD src1_sel:WORD_0
v_smfmac_f32_16x16x64_bf16 v[16:19], v[114:117], v[84:91], v180 abid:1
s_waitcnt vmcnt(4)
ds_read_u16 v81, v81
v_add_u32_sdwa v101, s42, v130 dst_sel:DWORD dst_unused:UNUSED_PAD src0_sel:DWORD src1_sel:WORD_1
v_smfmac_f32_16x16x64_bf16 v[20:23], v[114:117], v[84:91], v181
ds_read_b128 v[96:99], v1 offset:12288
v_add_u32_sdwa v102, s42, v131 dst_sel:DWORD dst_unused:UNUSED_PAD src0_sel:DWORD src1_sel:WORD_0
v_smfmac_f32_16x16x64_bf16 v[20:23], a[84:87], v[60:67], v147 abid:1
ds_read_u16 v100, v100
v_add_u32_sdwa v103, s42, v131 dst_sel:DWORD dst_unused:UNUSED_PAD src0_sel:DWORD src1_sel:WORD_1
v_smfmac_f32_16x16x64_bf16 v[20:23], a[120:123], v[68:75], v151 abid:1
ds_read_u16 v82, v82
v_add_u32_sdwa v104, s42, v132 dst_sel:DWORD dst_unused:UNUSED_PAD src0_sel:DWORD src1_sel:WORD_0
v_smfmac_f32_16x16x64_bf16 v[36:39], a[100:103], v[60:67], v149 abid:1
ds_read_u16 v101, v101
v_add_u32_sdwa v105, s42, v132 dst_sel:DWORD dst_unused:UNUSED_PAD src0_sel:DWORD src1_sel:WORD_1
v_smfmac_f32_16x16x64_bf16 v[36:39], a[136:139], v[68:75], v153 abid:1
buffer_store_dwordx2 v[112:113], v5, s[20:23], s46 offen
ds_read_u16 v83, v83
v_add_u32_sdwa v106, s42, v133 dst_sel:DWORD dst_unused:UNUSED_PAD src0_sel:DWORD src1_sel:WORD_0
v_smfmac_f32_16x16x64_bf16 v[40:43], a[104:107], v[60:67], v175
s_mov_b32 s22, 75497472
ds_read_b128 v[114:117], v2 offset:192
v_add_u32_sdwa v107, s42, v133 dst_sel:DWORD dst_unused:UNUSED_PAD src0_sel:DWORD src1_sel:WORD_1
v_smfmac_f32_16x16x64_bf16 v[40:43], a[140:143], v[68:75], v175 abid:1
s_waitcnt lgkmcnt(12)
ds_read_u16 v102, v102
v_add_u32_sdwa v84, s42, v134 dst_sel:DWORD dst_unused:UNUSED_PAD src0_sel:DWORD src1_sel:WORD_0
v_smfmac_f32_16x16x64_bf16 v[8:11], a[144:147], v[44:51], v154
s_waitcnt lgkmcnt(9)
ds_read_u16 v103, v103
v_add_u32_sdwa v85, s42, v134 dst_sel:DWORD dst_unused:UNUSED_PAD src0_sel:DWORD src1_sel:WORD_1
v_smfmac_f32_16x16x64_bf16 v[8:11], a[180:183], v[52:59], v158
s_waitcnt lgkmcnt(7)
ds_read_u16 v104, v104
v_add_u32_sdwa v86, s42, v135 dst_sel:DWORD dst_unused:UNUSED_PAD src0_sel:DWORD src1_sel:WORD_0
v_smfmac_f32_16x16x64_bf16 v[8:11], a[216:219], v[92:99], v162
s_mov_b32 s46, s48
ds_read_u16 v105, v105
v_add_u32_sdwa v87, s42, v135 dst_sel:DWORD dst_unused:UNUSED_PAD src0_sel:DWORD src1_sel:WORD_1
v_smfmac_f32_16x16x64_bf16 v[24:27], a[160:163], v[44:51], v156
s_add_u32 m0, s44, 0
ds_read_u16 v106, v106
v_add_u32_sdwa v88, s42, v136 dst_sel:DWORD dst_unused:UNUSED_PAD src0_sel:DWORD src1_sel:WORD_0
v_smfmac_f32_16x16x64_bf16 v[24:27], a[196:199], v[52:59], v160
buffer_load_dwordx4 v3, s[16:19], s45 offen offset:0 nt lds
v_add_u32_sdwa v89, s42, v136 dst_sel:DWORD dst_unused:UNUSED_PAD src0_sel:DWORD src1_sel:WORD_1
v_smfmac_f32_16x16x64_bf16 v[24:27], a[232:235], v[92:99], v164
s_waitcnt lgkmcnt(5)
ds_read_u16 v107, v107
v_add_u32_sdwa v90, s42, v137 dst_sel:DWORD dst_unused:UNUSED_PAD src0_sel:DWORD src1_sel:WORD_0
v_smfmac_f32_16x16x64_bf16 v[24:27], v[114:117], v[76:83], v182
s_mov_b32 s48, s49
ds_read_u16 v84, v84
v_add_u32_sdwa v91, s42, v137 dst_sel:DWORD dst_unused:UNUSED_PAD src0_sel:DWORD src1_sel:WORD_1
v_smfmac_f32_16x16x64_bf16 v[28:31], v[114:117], v[76:83], v182 abid:1
s_mov_b32 s49, s50
ds_read_b128 v[114:117], v2 offset:256
v_add_u32_sdwa v76, s4, v118 dst_sel:DWORD dst_unused:UNUSED_PAD src0_sel:DWORD src1_sel:WORD_0
v_smfmac_f32_16x16x64_bf16 v[28:31], a[164:167], v[44:51], v156 abid:1
s_add_u32 s50, s50, 4718592
ds_read_u16 v85, v85
v_add_u32_sdwa v77, s4, v118 dst_sel:DWORD dst_unused:UNUSED_PAD src0_sel:DWORD src1_sel:WORD_1
v_smfmac_f32_16x16x64_bf16 v[28:31], a[200:203], v[52:59], v160 abid:1
ds_read_u16 v86, v86
v_add_u32_sdwa v78, s4, v119 dst_sel:DWORD dst_unused:UNUSED_PAD src0_sel:DWORD src1_sel:WORD_0
v_smfmac_f32_16x16x64_bf16 v[28:31], a[236:239], v[92:99], v164 abid:1
ds_read_u16 v87, v87
v_add_u32_sdwa v79, s4, v119 dst_sel:DWORD dst_unused:UNUSED_PAD src0_sel:DWORD src1_sel:WORD_1
v_smfmac_f32_16x16x64_bf16 v[12:15], a[148:151], v[44:51], v154 abid:1
s_add_u32 m0, s44, 3840
ds_read_u16 v88, v88
v_add_u32_sdwa v80, s4, v120 dst_sel:DWORD dst_unused:UNUSED_PAD src0_sel:DWORD src1_sel:WORD_0
v_smfmac_f32_16x16x64_bf16 v[12:15], a[184:187], v[52:59], v158 abid:1
buffer_load_dwordx4 v3, s[16:19], s45 offen offset:256 nt lds
v_add_u32_sdwa v81, s4, v120 dst_sel:DWORD dst_unused:UNUSED_PAD src0_sel:DWORD src1_sel:WORD_1
v_smfmac_f32_16x16x64_bf16 v[12:15], a[220:223], v[92:99], v162 abid:1
ds_read_b128 v[60:63], v0 offset:14336
v_add_u32_sdwa v82, s4, v121 dst_sel:DWORD dst_unused:UNUSED_PAD src0_sel:DWORD src1_sel:WORD_0
v_smfmac_f32_16x16x64_bf16 v[32:35], a[168:171], v[44:51], v157
ds_read_u16 v89, v89
v_add_u32_sdwa v83, s4, v121 dst_sel:DWORD dst_unused:UNUSED_PAD src0_sel:DWORD src1_sel:WORD_1
v_smfmac_f32_16x16x64_bf16 v[32:35], a[204:207], v[52:59], v161
ds_read_b128 v[64:67], v1 offset:14336
v_smfmac_f32_16x16x64_bf16 v[32:35], a[240:243], v[92:99], v165
s_waitcnt lgkmcnt(7)
ds_read_b128 v[68:71], v0 offset:16384
v_smfmac_f32_16x16x64_bf16 v[32:35], v[114:117], v[100:107], v183 abid:1
ds_read_u16 v90, v90
v_smfmac_f32_16x16x64_bf16 v[36:39], v[114:117], v[100:107], v184
ds_read_b128 v[72:75], v1 offset:16384
v_add_u32 v0, s43, v0
v_smfmac_f32_16x16x64_bf16 v[36:39], a[172:175], v[44:51], v157 abid:1
s_add_u32 m0, s44, 7680
ds_read_u16 v91, v91
v_add_u32 v1, s43, v1
v_smfmac_f32_16x16x64_bf16 v[36:39], a[208:211], v[52:59], v161 abid:1
buffer_load_dwordx4 v3, s[16:19], s45 offen offset:512 nt lds
v_smfmac_f32_16x16x64_bf16 v[36:39], a[244:247], v[92:99], v165 abid:1
ds_read_b128 v[114:117], v2 offset:320
v_smfmac_f32_16x16x64_bf16 v[16:19], a[152:155], v[44:51], v155
s_add_u32 m0, s44, 11520
v_smfmac_f32_16x16x64_bf16 v[16:19], a[188:191], v[52:59], v159
buffer_load_dwordx4 v3, s[16:19], s45 offen offset:768 nt lds
v_smfmac_f32_16x16x64_bf16 v[16:19], a[224:227], v[92:99], v163
v_smfmac_f32_16x16x64_bf16 v[20:23], a[156:159], v[44:51], v155 abid:1
s_add_u32 m0, s44, s8
v_smfmac_f32_16x16x64_bf16 v[20:23], a[192:195], v[52:59], v159 abid:1
s_mov_b64 exec, s[10:11]
buffer_load_dwordx4 v3, s[16:19], s7 offen offset:896 nt lds
s_mov_b64 exec, -1
v_smfmac_f32_16x16x64_bf16 v[20:23], a[228:231], v[92:99], v163 abid:1
s_add_u32 s45, s45, 4718592
s_add_u32 s7, s7, 4718592
s_add_u32 s44, s44, s5
v_smfmac_f32_16x16x64_bf16 v[40:43], a[176:179], v[44:51], v176
s_cmp_ge_u32 s44, 148480
s_cselect_b32 s44, s9, s44
s_bitcmp1_b32 s92, s41
v_smfmac_f32_16x16x64_bf16 v[40:43], a[212:215], v[52:59], v176 abid:1
s_cbranch_scc1 L_loop_w
L_loop_wb:
v_smfmac_f32_16x16x64_bf16 v[40:43], a[248:251], v[92:99], v177
s_waitcnt lgkmcnt(0)
v_smfmac_f32_16x16x64_bf16 v[40:43], v[114:117], v[84:91], v185
s_waitcnt vmcnt(20)
s_barrier
v_smfmac_f32_16x16x64_bf16 v[8:11], a[252:255], v[60:67], v166
s_mov_b32 s42, s4
v_smfmac_f32_16x16x64_bf16 v[8:11], v[218:221], v[68:75], v170
ds_read_b128 v[44:47], v0 offset:0
v_add_u32_sdwa v84, s42, v122 dst_sel:DWORD dst_unused:UNUSED_PAD src0_sel:DWORD src1_sel:WORD_0
v_smfmac_f32_16x16x64_bf16 v[12:15], v[186:189], v[60:67], v166 abid:1
ds_read_b128 v[48:51], v1 offset:0
v_add_u32_sdwa v85, s42, v122 dst_sel:DWORD dst_unused:UNUSED_PAD src0_sel:DWORD src1_sel:WORD_1
v_smfmac_f32_16x16x64_bf16 v[12:15], v[222:225], v[68:75], v170 abid:1
ds_read_b128 v[52:55], v0 offset:2048
v_add_u32_sdwa v86, s42, v123 dst_sel:DWORD dst_unused:UNUSED_PAD src0_sel:DWORD src1_sel:WORD_0
v_smfmac_f32_16x16x64_bf16 v[16:19], v[190:193], v[60:67], v167
ds_read_b128 v[56:59], v1 offset:2048
v_cvt_pk_bf16_f32 v92, v8, v9
v_smfmac_f32_16x16x64_bf16 v[16:19], v[226:229], v[68:75], v171
ds_read_u16 v76, v76
v_cvt_pk_bf16_f32 v93, v10, v11
v_smfmac_f32_16x16x64_bf16 v[20:23], v[194:197], v[60:67], v167 abid:1
ds_read_b128 v[8:11], v2 offset:1024
v_cvt_pk_bf16_f32 v94, v12, v13
v_smfmac_f32_16x16x64_bf16 v[20:23], v[230:233], v[68:75], v171 abid:1
ds_read_u16 v77, v77
v_cvt_pk_bf16_f32 v95, v14, v15
v_smfmac_f32_16x16x64_bf16 v[24:27], v[198:201], v[60:67], v168
ds_read_b128 v[12:15], v2 offset:1088
v_cvt_pk_bf16_f32 v96, v16, v17
v_smfmac_f32_16x16x64_bf16 v[24:27], v[234:237], v[68:75], v172
ds_read_u16 v78, v78
v_cvt_pk_bf16_f32 v97, v18, v19
v_smfmac_f32_16x16x64_bf16 v[28:31], v[202:205], v[60:67], v168 abid:1
ds_read_b128 v[16:19], v2 offset:1152
v_cvt_pk_bf16_f32 v98, v20, v21
v_smfmac_f32_16x16x64_bf16 v[28:31], v[238:241], v[68:75], v172 abid:1
ds_read_u16 v79, v79
v_cvt_pk_bf16_f32 v99, v22, v23
v_smfmac_f32_16x16x64_bf16 v[32:35], v[206:209], v[60:67], v169
ds_read_b128 v[20:23], v2 offset:1216
v_cvt_pk_bf16_f32 v100, v24, v25
v_smfmac_f32_16x16x64_bf16 v[32:35], v[242:245], v[68:75], v173
ds_read_u16 v80, v80
v_cvt_pk_bf16_f32 v101, v26, v27
v_smfmac_f32_16x16x64_bf16 v[36:39], v[210:213], v[60:67], v169 abid:1
ds_read_b128 v[24:27], v2 offset:1280
v_cvt_pk_bf16_f32 v102, v28, v29
v_smfmac_f32_16x16x64_bf16 v[36:39], v[246:249], v[68:75], v173 abid:1
ds_read_u16 v81, v81
v_cvt_pk_bf16_f32 v103, v30, v31
v_smfmac_f32_16x16x64_bf16 v[40:43], v[214:217], v[60:67], v177 abid:1
s_bitcmp1_b32 s85, s41
ds_read_b128 v[28:31], v2 offset:1344
v_cvt_pk_bf16_f32 v104, v32, v33
v_smfmac_f32_16x16x64_bf16 v[40:43], v[250:253], v[68:75], v178
s_waitcnt lgkmcnt(10)
v_cvt_pk_bf16_f32 v105, v34, v35
s_cbranch_scc1 L_loop
s_cmp_lg_u32 s41, 6
s_cbranch_scc1 L_loopn
.p2align 3
L_loopc:
v_smfmac_f32_16x16x64_bf16 v[8:11], a[0:3], v[44:51], v138
s_cmp_lt_u32 s56, s65
s_cselect_b32 s34, s34, 0
s_cselect_b32 s64, s64, 0
ds_read_b128 v[32:35], v2 offset:1408
v_cvt_pk_bf16_f32 v106, v36, v37
v_mov_b32 v7, 1
v_smfmac_f32_16x16x64_bf16 v[8:11], a[36:39], v[52:59], v142
s_waitcnt lgkmcnt(9)
buffer_atomic_add v7, v6, s[32:35], 0 offen sc0 sc1
v_cvt_pk_bf16_f32 v107, v38, v39
v_smfmac_f32_16x16x64_bf16 v[12:15], a[4:7], v[44:51], v138 abid:1
ds_read_b128 v[36:39], v2 offset:1472
v_cvt_pk_bf16_f32 v112, v40, v41
v_smfmac_f32_16x16x64_bf16 v[12:15], a[40:43], v[52:59], v142 abid:1
s_waitcnt lgkmcnt(8)
ds_read_b128 v[60:63], v0 offset:4096
v_cvt_pk_bf16_f32 v113, v42, v43
v_smfmac_f32_16x16x64_bf16 v[16:19], a[8:11], v[44:51], v139
s_cmp_eq_u32 s4, 129920
ds_read_b128 v[40:43], v2 offset:1536
v_cndmask_b32_dpp v108, v96, v92, vcc quad_perm:[1,0,3,2] row_mask:0xf bank_mask:0xf
v_smfmac_f32_16x16x64_bf16 v[16:19], a[44:47], v[52:59], v143
s_waitcnt lgkmcnt(8)
ds_read_u16 v82, v82
v_cndmask_b32_dpp v109, v97, v93, vcc quad_perm:[1,0,3,2] row_mask:0xf bank_mask:0xf
v_smfmac_f32_16x16x64_bf16 v[20:23], a[12:15], v[44:51], v139 abid:1
s_cselect_b32 s43, -129920, s5
ds_read_u16 v84, v84
v_cndmask_b32_dpp v110, v98, v94, vcc quad_perm:[1,0,3,2] row_mask:0xf bank_mask:0xf
v_smfmac_f32_16x16x64_bf16 v[20:23], a[48:51], v[52:59], v143 abid:1
s_waitcnt lgkmcnt(8)
ds_read_b128 v[64:67], v1 offset:4096
v_cndmask_b32_dpp v111, v99, v95, vcc quad_perm:[1,0,3,2] row_mask:0xf bank_mask:0xf
v_smfmac_f32_16x16x64_bf16 v[24:27], a[16:19], v[44:51], v140
s_add_u32 s4, s4, s43
ds_read_b128 v[68:71], v0 offset:6144
v_add_u32_sdwa v87, s42, v123 dst_sel:DWORD dst_unused:UNUSED_PAD src0_sel:DWORD src1_sel:WORD_1
v_smfmac_f32_16x16x64_bf16 v[24:27], a[52:55], v[52:59], v144
buffer_store_dwordx4 v[108:111], v4, s[20:23], s46 offen offset:0 sc1
s_mov_b64 vcc, s[82:83]
s_waitcnt lgkmcnt(8)
ds_read_b128 v[72:75], v1 offset:6144
v_cndmask_b32_dpp v96, v92, v96, vcc quad_perm:[1,0,3,2] row_mask:0xf bank_mask:0xf
v_cndmask_b32_dpp v97, v93, v97, vcc quad_perm:[1,0,3,2] row_mask:0xf bank_mask:0xf
v_smfmac_f32_16x16x64_bf16 v[28:31], a[20:23], v[44:51], v140 abid:1
s_add_u32 s7, s45, s58
ds_read_u16 v83, v83
v_cndmask_b32_dpp v98, v94, v98, vcc quad_perm:[1,0,3,2] row_mask:0xf bank_mask:0xf
v_smfmac_f32_16x16x64_bf16 v[28:31], a[56:59], v[52:59], v144 abid:1
s_waitcnt lgkmcnt(9)
ds_read_b128 v[114:117], v2 offset:64
v_cndmask_b32_dpp v99, v95, v99, vcc quad_perm:[1,0,3,2] row_mask:0xf bank_mask:0xf
v_smfmac_f32_16x16x64_bf16 v[32:35], a[24:27], v[44:51], v141
ds_read_u16 v85, v85
v_add_u32_sdwa v88, s42, v124 dst_sel:DWORD dst_unused:UNUSED_PAD src0_sel:DWORD src1_sel:WORD_0
v_smfmac_f32_16x16x64_bf16 v[32:35], a[60:63], v[52:59], v145
s_waitcnt lgkmcnt(10)
ds_read_u16 v86, v86
v_add_u32_sdwa v89, s42, v124 dst_sel:DWORD dst_unused:UNUSED_PAD src0_sel:DWORD src1_sel:WORD_1
v_smfmac_f32_16x16x64_bf16 v[36:39], a[28:31], v[44:51], v141 abid:1
ds_read_u16 v87, v87
v_add_u32_sdwa v90, s42, v125 dst_sel:DWORD dst_unused:UNUSED_PAD src0_sel:DWORD src1_sel:WORD_0
v_smfmac_f32_16x16x64_bf16 v[36:39], a[64:67], v[52:59], v145 abid:1
s_waitcnt lgkmcnt(10)
ds_read_u16 v88, v88
v_add_u32_sdwa v91, s42, v125 dst_sel:DWORD dst_unused:UNUSED_PAD src0_sel:DWORD src1_sel:WORD_1
v_smfmac_f32_16x16x64_bf16 v[40:43], a[32:35], v[44:51], v174
buffer_store_dwordx4 v[96:99], v4, s[20:23], s46 offen offset:1152 sc1
s_mov_b64 vcc, s[80:81]
ds_read_u16 v89, v89
v_cndmask_b32_dpp v92, v104, v100, vcc quad_perm:[1,0,3,2] row_mask:0xf bank_mask:0xf
v_cndmask_b32_dpp v93, v105, v101, vcc quad_perm:[1,0,3,2] row_mask:0xf bank_mask:0xf
v_smfmac_f32_16x16x64_bf16 v[40:43], a[68:71], v[52:59], v174 abid:1
s_waitcnt lgkmcnt(9)
ds_read_u16 v90, v90
v_cndmask_b32_dpp v94, v106, v102, vcc quad_perm:[1,0,3,2] row_mask:0xf bank_mask:0xf
v_smfmac_f32_16x16x64_bf16 v[8:11], a[72:75], v[60:67], v146
s_waitcnt lgkmcnt(8)
ds_read_u16 v91, v91
v_cndmask_b32_dpp v95, v107, v103, vcc quad_perm:[1,0,3,2] row_mask:0xf bank_mask:0xf
v_smfmac_f32_16x16x64_bf16 v[8:11], a[108:111], v[68:75], v150
s_waitcnt lgkmcnt(7)
ds_bpermute_b32 v112, v6, v112
v_smfmac_f32_16x16x64_bf16 v[8:11], v[114:117], v[76:83], v179
ds_bpermute_b32 v113, v6, v113
v_smfmac_f32_16x16x64_bf16 v[12:15], v[114:117], v[76:83], v179 abid:1
ds_read_b128 v[114:117], v2 offset:128
v_add_u32_sdwa v76, s42, v126 dst_sel:DWORD dst_unused:UNUSED_PAD src0_sel:DWORD src1_sel:WORD_0
v_smfmac_f32_16x16x64_bf16 v[12:15], a[76:79], v[60:67], v146 abid:1
ds_read_u16 v76, v76
v_add_u32_sdwa v77, s42, v126 dst_sel:DWORD dst_unused:UNUSED_PAD src0_sel:DWORD src1_sel:WORD_1
v_smfmac_f32_16x16x64_bf16 v[12:15], a[112:115], v[68:75], v150 abid:1
buffer_store_dwordx4 v[92:95], v4, s[20:23], s46 offen offset:128 sc1
s_mov_b64 vcc, s[82:83]
ds_read_u16 v77, v77
v_cndmask_b32_dpp v104, v100, v104, vcc quad_perm:[1,0,3,2] row_mask:0xf bank_mask:0xf
v_add_u32_sdwa v78, s42, v127 dst_sel:DWORD dst_unused:UNUSED_PAD src0_sel:DWORD src1_sel:WORD_0
v_smfmac_f32_16x16x64_bf16 v[24:27], a[88:91], v[60:67], v148
ds_read_u16 v78, v78
v_cndmask_b32_dpp v105, v101, v105, vcc quad_perm:[1,0,3,2] row_mask:0xf bank_mask:0xf
v_smfmac_f32_16x16x64_bf16 v[24:27], a[124:127], v[68:75], v152
ds_read_b128 v[44:47], v0 offset:8192
v_cndmask_b32_dpp v106, v102, v106, vcc quad_perm:[1,0,3,2] row_mask:0xf bank_mask:0xf
v_smfmac_f32_16x16x64_bf16 v[28:31], a[92:95], v[60:67], v148 abid:1
ds_read_b128 v[48:51], v1 offset:8192
v_add_u32_sdwa v79, s42, v127 dst_sel:DWORD dst_unused:UNUSED_PAD src0_sel:DWORD src1_sel:WORD_1
v_smfmac_f32_16x16x64_bf16 v[28:31], a[128:131], v[68:75], v152 abid:1
ds_read_u16 v79, v79
v_cndmask_b32_dpp v107, v103, v107, vcc quad_perm:[1,0,3,2] row_mask:0xf bank_mask:0xf
v_smfmac_f32_16x16x64_bf16 v[32:35], a[96:99], v[60:67], v149
ds_read_b128 v[52:55], v0 offset:10240
v_add_u32_sdwa v80, s42, v128 dst_sel:DWORD dst_unused:UNUSED_PAD src0_sel:DWORD src1_sel:WORD_0
v_smfmac_f32_16x16x64_bf16 v[32:35], a[132:135], v[68:75], v153
ds_read_u16 v80, v80
v_add_u32_sdwa v81, s42, v128 dst_sel:DWORD dst_unused:UNUSED_PAD src0_sel:DWORD src1_sel:WORD_1
v_smfmac_f32_16x16x64_bf16 v[16:19], a[80:83], v[60:67], v147
buffer_store_dwordx4 v[104:107], v4, s[20:23], s46 offen offset:1280 sc1
s_mov_b64 vcc, s[80:81]
ds_read_b128 v[56:59], v1 offset:10240
v_add_u32_sdwa v82, s42, v129 dst_sel:DWORD dst_unused:UNUSED_PAD src0_sel:DWORD src1_sel:WORD_0
v_add_u32_sdwa v83, s42, v129 dst_sel:DWORD dst_unused:UNUSED_PAD src0_sel:DWORD src1_sel:WORD_1
v_smfmac_f32_16x16x64_bf16 v[16:19], a[116:119], v[68:75], v151
s_waitcnt lgkmcnt(9)
ds_read_b128 v[92:95], v0 offset:12288
v_add_u32_sdwa v100, s42, v130 dst_sel:DWORD dst_unused:UNUSED_PAD src0_sel:DWORD src1_sel:WORD_0
v_smfmac_f32_16x16x64_bf16 v[16:19], v[114:117], v[84:91], v180 abid:1
ds_read_u16 v81, v81
v_add_u32_sdwa v101, s42, v130 dst_sel:DWORD dst_unused:UNUSED_PAD src0_sel:DWORD src1_sel:WORD_1
v_smfmac_f32_16x16x64_bf16 v[20:23], v[114:117], v[84:91], v181
ds_read_b128 v[96:99], v1 offset:12288
v_add_u32_sdwa v102, s42, v131 dst_sel:DWORD dst_unused:UNUSED_PAD src0_sel:DWORD src1_sel:WORD_0
v_smfmac_f32_16x16x64_bf16 v[20:23], a[84:87], v[60:67], v147 abid:1
ds_read_u16 v100, v100
v_add_u32_sdwa v103, s42, v131 dst_sel:DWORD dst_unused:UNUSED_PAD src0_sel:DWORD src1_sel:WORD_1
v_smfmac_f32_16x16x64_bf16 v[20:23], a[120:123], v[68:75], v151 abid:1
ds_read_u16 v82, v82
v_add_u32_sdwa v104, s42, v132 dst_sel:DWORD dst_unused:UNUSED_PAD src0_sel:DWORD src1_sel:WORD_0
v_smfmac_f32_16x16x64_bf16 v[36:39], a[100:103], v[60:67], v149 abid:1
ds_read_u16 v101, v101
v_add_u32_sdwa v105, s42, v132 dst_sel:DWORD dst_unused:UNUSED_PAD src0_sel:DWORD src1_sel:WORD_1
v_smfmac_f32_16x16x64_bf16 v[36:39], a[136:139], v[68:75], v153 abid:1
buffer_store_dwordx2 v[112:113], v5, s[20:23], s46 offen
ds_read_u16 v83, v83
v_add_u32_sdwa v106, s42, v133 dst_sel:DWORD dst_unused:UNUSED_PAD src0_sel:DWORD src1_sel:WORD_0
v_smfmac_f32_16x16x64_bf16 v[40:43], a[104:107], v[60:67], v175
s_mov_b32 s46, s48
ds_read_b128 v[114:117], v2 offset:192
v_add_u32_sdwa v107, s42, v133 dst_sel:DWORD dst_unused:UNUSED_PAD src0_sel:DWORD src1_sel:WORD_1
v_smfmac_f32_16x16x64_bf16 v[40:43], a[140:143], v[68:75], v175 abid:1
s_waitcnt lgkmcnt(12)
ds_read_u16 v102, v102
v_add_u32_sdwa v84, s42, v134 dst_sel:DWORD dst_unused:UNUSED_PAD src0_sel:DWORD src1_sel:WORD_0
v_smfmac_f32_16x16x64_bf16 v[8:11], a[144:147], v[44:51], v154
s_waitcnt lgkmcnt(9)
ds_read_u16 v103, v103
v_add_u32_sdwa v85, s42, v134 dst_sel:DWORD dst_unused:UNUSED_PAD src0_sel:DWORD src1_sel:WORD_1
v_smfmac_f32_16x16x64_bf16 v[8:11], a[180:183], v[52:59], v158
s_waitcnt lgkmcnt(7)
ds_read_u16 v104, v104
v_add_u32_sdwa v86, s42, v135 dst_sel:DWORD dst_unused:UNUSED_PAD src0_sel:DWORD src1_sel:WORD_0
v_smfmac_f32_16x16x64_bf16 v[8:11], a[216:219], v[92:99], v162
s_mov_b32 s48, s49
ds_read_u16 v105, v105
v_add_u32_sdwa v87, s42, v135 dst_sel:DWORD dst_unused:UNUSED_PAD src0_sel:DWORD src1_sel:WORD_1
v_smfmac_f32_16x16x64_bf16 v[24:27], a[160:163], v[44:51], v156
s_add_u32 m0, s44, 0
ds_read_u16 v106, v106
v_add_u32_sdwa v88, s42, v136 dst_sel:DWORD dst_unused:UNUSED_PAD src0_sel:DWORD src1_sel:WORD_0
v_smfmac_f32_16x16x64_bf16 v[24:27], a[196:199], v[52:59], v160
buffer_load_dwordx4 v3, s[16:19], s45 offen offset:0 nt lds
v_add_u32_sdwa v89, s42, v136 dst_sel:DWORD dst_unused:UNUSED_PAD src0_sel:DWORD src1_sel:WORD_1
v_smfmac_f32_16x16x64_bf16 v[24:27], a[232:235], v[92:99], v164
s_waitcnt lgkmcnt(5)
ds_read_u16 v107, v107
v_add_u32_sdwa v90, s42, v137 dst_sel:DWORD dst_unused:UNUSED_PAD src0_sel:DWORD src1_sel:WORD_0
v_smfmac_f32_16x16x64_bf16 v[24:27], v[114:117], v[76:83], v182
s_mov_b32 s49, s50
ds_read_u16 v84, v84
v_add_u32_sdwa v91, s42, v137 dst_sel:DWORD dst_unused:UNUSED_PAD src0_sel:DWORD src1_sel:WORD_1
v_smfmac_f32_16x16x64_bf16 v[28:31], v[114:117], v[76:83], v182 abid:1
s_mov_b32 s50, s45
ds_read_b128 v[114:117], v2 offset:256
v_add_u32_sdwa v76, s4, v118 dst_sel:DWORD dst_unused:UNUSED_PAD src0_sel:DWORD src1_sel:WORD_0
v_smfmac_f32_16x16x64_bf16 v[28:31], a[164:167], v[44:51], v156 abid:1
ds_read_u16 v85, v85
v_add_u32_sdwa v77, s4, v118 dst_sel:DWORD dst_unused:UNUSED_PAD src0_sel:DWORD src1_sel:WORD_1
v_smfmac_f32_16x16x64_bf16 v[28:31], a[200:203], v[52:59], v160 abid:1
ds_read_u16 v86, v86
v_add_u32_sdwa v78, s4, v119 dst_sel:DWORD dst_unused:UNUSED_PAD src0_sel:DWORD src1_sel:WORD_0
v_smfmac_f32_16x16x64_bf16 v[28:31], a[236:239], v[92:99], v164 abid:1
ds_read_u16 v87, v87
v_add_u32_sdwa v79, s4, v119 dst_sel:DWORD dst_unused:UNUSED_PAD src0_sel:DWORD src1_sel:WORD_1
v_smfmac_f32_16x16x64_bf16 v[12:15], a[148:151], v[44:51], v154 abid:1
s_add_u32 m0, s44, 3840
ds_read_u16 v88, v88
v_add_u32_sdwa v80, s4, v120 dst_sel:DWORD dst_unused:UNUSED_PAD src0_sel:DWORD src1_sel:WORD_0
v_smfmac_f32_16x16x64_bf16 v[12:15], a[184:187], v[52:59], v158 abid:1
buffer_load_dwordx4 v3, s[16:19], s45 offen offset:256 nt lds
v_add_u32_sdwa v81, s4, v120 dst_sel:DWORD dst_unused:UNUSED_PAD src0_sel:DWORD src1_sel:WORD_1
v_smfmac_f32_16x16x64_bf16 v[12:15], a[220:223], v[92:99], v162 abid:1
ds_read_b128 v[60:63], v0 offset:14336
v_add_u32_sdwa v82, s4, v121 dst_sel:DWORD dst_unused:UNUSED_PAD src0_sel:DWORD src1_sel:WORD_0
v_smfmac_f32_16x16x64_bf16 v[32:35], a[168:171], v[44:51], v157
s_waitcnt vmcnt(7)
ds_read_u16 v89, v89
v_add_u32_sdwa v83, s4, v121 dst_sel:DWORD dst_unused:UNUSED_PAD src0_sel:DWORD src1_sel:WORD_1
v_smfmac_f32_16x16x64_bf16 v[32:35], a[204:207], v[52:59], v161
ds_read_b128 v[64:67], v1 offset:14336
v_smfmac_f32_16x16x64_bf16 v[32:35], a[240:243], v[92:99], v165
s_waitcnt lgkmcnt(7)
ds_read_b128 v[68:71], v0 offset:16384
v_smfmac_f32_16x16x64_bf16 v[32:35], v[114:117], v[100:107], v183 abid:1
ds_read_u16 v90, v90
v_smfmac_f32_16x16x64_bf16 v[36:39], v[114:117], v[100:107], v184
ds_read_b128 v[72:75], v1 offset:16384
v_add_u32 v0, s43, v0
v_smfmac_f32_16x16x64_bf16 v[36:39], a[172:175], v[44:51], v157 abid:1
s_add_u32 m0, s44, 7680
ds_read_u16 v91, v91
v_add_u32 v1, s43, v1
v_smfmac_f32_16x16x64_bf16 v[36:39], a[208:211], v[52:59], v161 abid:1
buffer_load_dwordx4 v3, s[16:19], s45 offen offset:512 nt lds
v_smfmac_f32_16x16x64_bf16 v[36:39], a[244:247], v[92:99], v165 abid:1
ds_read_b128 v[114:117], v2 offset:320
v_smfmac_f32_16x16x64_bf16 v[16:19], a[152:155], v[44:51], v155
s_add_u32 m0, s44, 11520
v_smfmac_f32_16x16x64_bf16 v[16:19], a[188:191], v[52:59], v159
buffer_load_dwordx4 v3, s[16:19], s45 offen offset:768 nt lds
v_smfmac_f32_16x16x64_bf16 v[16:19], a[224:227], v[92:99], v163
s_mov_b64 exec, s[62:63]
ds_write_b32 v0, v7 offset:18432
s_mov_b64 exec, -1
v_smfmac_f32_16x16x64_bf16 v[20:23], a[156:159], v[44:51], v155 abid:1
s_add_u32 m0, s44, s8
v_smfmac_f32_16x16x64_bf16 v[20:23], a[192:195], v[52:59], v159 abid:1
s_mov_b64 exec, s[10:11]
buffer_load_dwordx4 v3, s[16:19], s7 offen offset:896 nt lds
s_mov_b64 exec, -1
v_smfmac_f32_16x16x64_bf16 v[20:23], a[228:231], v[92:99], v163 abid:1
s_add_u32 s44, s44, s5
s_cmp_ge_u32 s44, 148480
s_cselect_b32 s44, s9, s44
v_smfmac_f32_16x16x64_bf16 v[40:43], a[176:179], v[44:51], v176
v_smfmac_f32_16x16x64_bf16 v[40:43], a[212:215], v[52:59], v176 abid:1
v_smfmac_f32_16x16x64_bf16 v[40:43], a[248:251], v[92:99], v177
s_waitcnt lgkmcnt(0)
v_smfmac_f32_16x16x64_bf16 v[40:43], v[114:117], v[84:91], v185
s_barrier
v_smfmac_f32_16x16x64_bf16 v[8:11], a[252:255], v[60:67], v166
s_mov_b32 s42, s4
ds_read_b32 v7, v0 offset:18432
v_smfmac_f32_16x16x64_bf16 v[8:11], v[218:221], v[68:75], v170
ds_read_b128 v[44:47], v0 offset:0
v_add_u32_sdwa v84, s42, v122 dst_sel:DWORD dst_unused:UNUSED_PAD src0_sel:DWORD src1_sel:WORD_0
v_smfmac_f32_16x16x64_bf16 v[12:15], v[186:189], v[60:67], v166 abid:1
ds_read_b128 v[48:51], v1 offset:0
v_add_u32_sdwa v85, s42, v122 dst_sel:DWORD dst_unused:UNUSED_PAD src0_sel:DWORD src1_sel:WORD_1
v_smfmac_f32_16x16x64_bf16 v[12:15], v[222:225], v[68:75], v170 abid:1
ds_read_b128 v[52:55], v0 offset:2048
v_add_u32_sdwa v86, s42, v123 dst_sel:DWORD dst_unused:UNUSED_PAD src0_sel:DWORD src1_sel:WORD_0
v_smfmac_f32_16x16x64_bf16 v[16:19], v[190:193], v[60:67], v167
ds_read_b128 v[56:59], v1 offset:2048
v_cvt_pk_bf16_f32 v92, v8, v9
v_smfmac_f32_16x16x64_bf16 v[16:19], v[226:229], v[68:75], v171
ds_read_u16 v76, v76
v_cvt_pk_bf16_f32 v93, v10, v11
v_smfmac_f32_16x16x64_bf16 v[20:23], v[194:197], v[60:67], v167 abid:1
ds_read_b128 v[8:11], v2 offset:1024
v_cvt_pk_bf16_f32 v94, v12, v13
v_smfmac_f32_16x16x64_bf16 v[20:23], v[230:233], v[68:75], v171 abid:1
ds_read_u16 v77, v77
v_cvt_pk_bf16_f32 v95, v14, v15
v_smfmac_f32_16x16x64_bf16 v[24:27], v[198:201], v[60:67], v168
ds_read_b128 v[12:15], v2 offset:1088
v_cvt_pk_bf16_f32 v96, v16, v17
v_smfmac_f32_16x16x64_bf16 v[24:27], v[234:237], v[68:75], v172
s_waitcnt lgkmcnt(8)
ds_read_u16 v78, v78
v_cvt_pk_bf16_f32 v97, v18, v19
v_readfirstlane_b32 s56, v7
v_smfmac_f32_16x16x64_bf16 v[28:31], v[202:205], v[60:67], v168 abid:1
s_lshr_b32 s60, s56, 4
ds_read_b128 v[16:19], v2 offset:1152
v_cvt_pk_bf16_f32 v98, v20, v21
v_smfmac_f32_16x16x64_bf16 v[28:31], v[238:241], v[68:75], v172 abid:1
s_mul_i32 s60, s60, 884736
ds_read_u16 v79, v79
v_cvt_pk_bf16_f32 v99, v22, v23
v_smfmac_f32_16x16x64_bf16 v[32:35], v[206:209], v[60:67], v169
s_mul_i32 s61, s56, 18432
ds_read_b128 v[20:23], v2 offset:1216
v_cvt_pk_bf16_f32 v100, v24, v25
v_smfmac_f32_16x16x64_bf16 v[32:35], v[242:245], v[68:75], v173
s_add_u32 s60, s60, s57
ds_read_u16 v80, v80
v_cvt_pk_bf16_f32 v101, v26, v27
v_smfmac_f32_16x16x64_bf16 v[36:39], v[210:213], v[60:67], v169 abid:1
s_add_u32 s45, s60, s61
ds_read_b128 v[24:27], v2 offset:1280
v_cvt_pk_bf16_f32 v102, v28, v29
v_smfmac_f32_16x16x64_bf16 v[36:39], v[246:249], v[68:75], v173 abid:1
ds_read_u16 v81, v81
v_cvt_pk_bf16_f32 v103, v30, v31
v_smfmac_f32_16x16x64_bf16 v[40:43], v[214:217], v[60:67], v177 abid:1
s_cmp_lt_u32 s56, s64
ds_read_b128 v[28:31], v2 offset:1344
v_cvt_pk_bf16_f32 v104, v32, v33
v_smfmac_f32_16x16x64_bf16 v[40:43], v[250:253], v[68:75], v178
s_waitcnt lgkmcnt(10)
v_cvt_pk_bf16_f32 v105, v34, v35
s_cbranch_scc1 L_loopc
s_mov_b32 s41, 0
s_mov_b32 s15, 3
s_mov_b32 s12, 7
s_mov_b32 s92, 4
s_mov_b32 s87, 4
s_mov_b32 s59, -1
.p2align 3
L_loopn:
v_smfmac_f32_16x16x64_bf16 v[8:11], a[0:3], v[44:51], v138
ds_read_b128 v[32:35], v2 offset:1408
v_cvt_pk_bf16_f32 v106, v36, v37
v_smfmac_f32_16x16x64_bf16 v[8:11], a[36:39], v[52:59], v142
s_waitcnt lgkmcnt(9)
v_cvt_pk_bf16_f32 v107, v38, v39
v_smfmac_f32_16x16x64_bf16 v[12:15], a[4:7], v[44:51], v138 abid:1
ds_read_b128 v[36:39], v2 offset:1472
v_cvt_pk_bf16_f32 v112, v40, v41
v_smfmac_f32_16x16x64_bf16 v[12:15], a[40:43], v[52:59], v142 abid:1
s_waitcnt lgkmcnt(8)
ds_read_b128 v[60:63], v0 offset:4096
v_cvt_pk_bf16_f32 v113, v42, v43
v_smfmac_f32_16x16x64_bf16 v[16:19], a[8:11], v[44:51], v139
s_cmp_eq_u32 s4, 129920
ds_read_b128 v[40:43], v2 offset:1536
v_cndmask_b32_dpp v108, v96, v92, vcc quad_perm:[1,0,3,2] row_mask:0xf bank_mask:0xf
v_smfmac_f32_16x16x64_bf16 v[16:19], a[44:47], v[52:59], v143
s_waitcnt lgkmcnt(8)
ds_read_u16 v82, v82
v_cndmask_b32_dpp v109, v97, v93, vcc quad_perm:[1,0,3,2] row_mask:0xf bank_mask:0xf
v_smfmac_f32_16x16x64_bf16 v[20:23], a[12:15], v[44:51], v139 abid:1
s_cselect_b32 s43, -129920, s5
ds_read_u16 v84, v84
v_cndmask_b32_dpp v110, v98, v94, vcc quad_perm:[1,0,3,2] row_mask:0xf bank_mask:0xf
v_smfmac_f32_16x16x64_bf16 v[20:23], a[48:51], v[52:59], v143 abid:1
s_waitcnt lgkmcnt(8)
ds_read_b128 v[64:67], v1 offset:4096
v_cndmask_b32_dpp v111, v99, v95, vcc quad_perm:[1,0,3,2] row_mask:0xf bank_mask:0xf
v_smfmac_f32_16x16x64_bf16 v[24:27], a[16:19], v[44:51], v140
s_add_u32 s4, s4, s43
ds_read_b128 v[68:71], v0 offset:6144
v_add_u32_sdwa v87, s42, v123 dst_sel:DWORD dst_unused:UNUSED_PAD src0_sel:DWORD src1_sel:WORD_1
v_smfmac_f32_16x16x64_bf16 v[24:27], a[52:55], v[52:59], v144
buffer_store_dwordx4 v[108:111], v4, s[20:23], s46 offen offset:0 sc1
s_mov_b64 vcc, s[82:83]
s_waitcnt lgkmcnt(8)
ds_read_b128 v[72:75], v1 offset:6144
v_cndmask_b32_dpp v96, v92, v96, vcc quad_perm:[1,0,3,2] row_mask:0xf bank_mask:0xf
v_cndmask_b32_dpp v97, v93, v97, vcc quad_perm:[1,0,3,2] row_mask:0xf bank_mask:0xf
v_smfmac_f32_16x16x64_bf16 v[28:31], a[20:23], v[44:51], v140 abid:1
s_add_u32 s41, s41, 1
ds_read_u16 v83, v83
v_cndmask_b32_dpp v98, v94, v98, vcc quad_perm:[1,0,3,2] row_mask:0xf bank_mask:0xf
v_smfmac_f32_16x16x64_bf16 v[28:31], a[56:59], v[52:59], v144 abid:1
s_waitcnt lgkmcnt(9)
ds_read_b128 v[114:117], v2 offset:64
v_cndmask_b32_dpp v99, v95, v99, vcc quad_perm:[1,0,3,2] row_mask:0xf bank_mask:0xf
v_smfmac_f32_16x16x64_bf16 v[32:35], a[24:27], v[44:51], v141
ds_read_u16 v85, v85
v_add_u32_sdwa v88, s42, v124 dst_sel:DWORD dst_unused:UNUSED_PAD src0_sel:DWORD src1_sel:WORD_0
v_smfmac_f32_16x16x64_bf16 v[32:35], a[60:63], v[52:59], v145
s_waitcnt lgkmcnt(10)
ds_read_u16 v86, v86
v_add_u32_sdwa v89, s42, v124 dst_sel:DWORD dst_unused:UNUSED_PAD src0_sel:DWORD src1_sel:WORD_1
v_smfmac_f32_16x16x64_bf16 v[36:39], a[28:31], v[44:51], v141 abid:1
ds_read_u16 v87, v87
v_add_u32_sdwa v90, s42, v125 dst_sel:DWORD dst_unused:UNUSED_PAD src0_sel:DWORD src1_sel:WORD_0
v_smfmac_f32_16x16x64_bf16 v[36:39], a[64:67], v[52:59], v145 abid:1
s_waitcnt lgkmcnt(10)
ds_read_u16 v88, v88
v_add_u32_sdwa v91, s42, v125 dst_sel:DWORD dst_unused:UNUSED_PAD src0_sel:DWORD src1_sel:WORD_1
v_smfmac_f32_16x16x64_bf16 v[40:43], a[32:35], v[44:51], v174
buffer_store_dwordx4 v[96:99], v4, s[20:23], s46 offen offset:1152 sc1
s_mov_b64 vcc, s[80:81]
ds_read_u16 v89, v89
v_cndmask_b32_dpp v92, v104, v100, vcc quad_perm:[1,0,3,2] row_mask:0xf bank_mask:0xf
v_cndmask_b32_dpp v93, v105, v101, vcc quad_perm:[1,0,3,2] row_mask:0xf bank_mask:0xf
v_smfmac_f32_16x16x64_bf16 v[40:43], a[68:71], v[52:59], v174 abid:1
s_waitcnt lgkmcnt(9)
ds_read_u16 v90, v90
v_cndmask_b32_dpp v94, v106, v102, vcc quad_perm:[1,0,3,2] row_mask:0xf bank_mask:0xf
v_smfmac_f32_16x16x64_bf16 v[8:11], a[72:75], v[60:67], v146
s_waitcnt lgkmcnt(8)
ds_read_u16 v91, v91
v_cndmask_b32_dpp v95, v107, v103, vcc quad_perm:[1,0,3,2] row_mask:0xf bank_mask:0xf
v_smfmac_f32_16x16x64_bf16 v[8:11], a[108:111], v[68:75], v150
s_waitcnt lgkmcnt(7)
ds_bpermute_b32 v112, v6, v112
v_smfmac_f32_16x16x64_bf16 v[8:11], v[114:117], v[76:83], v179
ds_bpermute_b32 v113, v6, v113
v_smfmac_f32_16x16x64_bf16 v[12:15], v[114:117], v[76:83], v179 abid:1
ds_read_b128 v[114:117], v2 offset:128
v_add_u32_sdwa v76, s42, v126 dst_sel:DWORD dst_unused:UNUSED_PAD src0_sel:DWORD src1_sel:WORD_0
v_smfmac_f32_16x16x64_bf16 v[12:15], a[76:79], v[60:67], v146 abid:1
ds_read_u16 v76, v76
v_add_u32_sdwa v77, s42, v126 dst_sel:DWORD dst_unused:UNUSED_PAD src0_sel:DWORD src1_sel:WORD_1
v_smfmac_f32_16x16x64_bf16 v[12:15], a[112:115], v[68:75], v150 abid:1
buffer_store_dwordx4 v[92:95], v4, s[20:23], s46 offen offset:128 sc1
s_mov_b64 vcc, s[82:83]
ds_read_u16 v77, v77
v_cndmask_b32_dpp v104, v100, v104, vcc quad_perm:[1,0,3,2] row_mask:0xf bank_mask:0xf
v_add_u32_sdwa v78, s42, v127 dst_sel:DWORD dst_unused:UNUSED_PAD src0_sel:DWORD src1_sel:WORD_0
v_smfmac_f32_16x16x64_bf16 v[24:27], a[88:91], v[60:67], v148
ds_read_u16 v78, v78
v_cndmask_b32_dpp v105, v101, v105, vcc quad_perm:[1,0,3,2] row_mask:0xf bank_mask:0xf
v_smfmac_f32_16x16x64_bf16 v[24:27], a[124:127], v[68:75], v152
ds_read_b128 v[44:47], v0 offset:8192
v_cndmask_b32_dpp v106, v102, v106, vcc quad_perm:[1,0,3,2] row_mask:0xf bank_mask:0xf
v_smfmac_f32_16x16x64_bf16 v[28:31], a[92:95], v[60:67], v148 abid:1
ds_read_b128 v[48:51], v1 offset:8192
v_add_u32_sdwa v79, s42, v127 dst_sel:DWORD dst_unused:UNUSED_PAD src0_sel:DWORD src1_sel:WORD_1
v_smfmac_f32_16x16x64_bf16 v[28:31], a[128:131], v[68:75], v152 abid:1
ds_read_u16 v79, v79
v_cndmask_b32_dpp v107, v103, v107, vcc quad_perm:[1,0,3,2] row_mask:0xf bank_mask:0xf
v_smfmac_f32_16x16x64_bf16 v[32:35], a[96:99], v[60:67], v149
ds_read_b128 v[52:55], v0 offset:10240
v_add_u32_sdwa v80, s42, v128 dst_sel:DWORD dst_unused:UNUSED_PAD src0_sel:DWORD src1_sel:WORD_0
v_smfmac_f32_16x16x64_bf16 v[32:35], a[132:135], v[68:75], v153
ds_read_u16 v80, v80
v_add_u32_sdwa v81, s42, v128 dst_sel:DWORD dst_unused:UNUSED_PAD src0_sel:DWORD src1_sel:WORD_1
v_smfmac_f32_16x16x64_bf16 v[16:19], a[80:83], v[60:67], v147
buffer_store_dwordx4 v[104:107], v4, s[20:23], s46 offen offset:1280 sc1
s_mov_b64 vcc, s[80:81]
ds_read_b128 v[56:59], v1 offset:10240
v_add_u32_sdwa v82, s42, v129 dst_sel:DWORD dst_unused:UNUSED_PAD src0_sel:DWORD src1_sel:WORD_0
v_add_u32_sdwa v83, s42, v129 dst_sel:DWORD dst_unused:UNUSED_PAD src0_sel:DWORD src1_sel:WORD_1
v_smfmac_f32_16x16x64_bf16 v[16:19], a[116:119], v[68:75], v151
s_waitcnt lgkmcnt(9)
ds_read_b128 v[92:95], v0 offset:12288
v_add_u32_sdwa v100, s42, v130 dst_sel:DWORD dst_unused:UNUSED_PAD src0_sel:DWORD src1_sel:WORD_0
v_smfmac_f32_16x16x64_bf16 v[16:19], v[114:117], v[84:91], v180 abid:1
ds_read_u16 v81, v81
v_add_u32_sdwa v101, s42, v130 dst_sel:DWORD dst_unused:UNUSED_PAD src0_sel:DWORD src1_sel:WORD_1
v_smfmac_f32_16x16x64_bf16 v[20:23], v[114:117], v[84:91], v181
ds_read_b128 v[96:99], v1 offset:12288
v_add_u32_sdwa v102, s42, v131 dst_sel:DWORD dst_unused:UNUSED_PAD src0_sel:DWORD src1_sel:WORD_0
v_smfmac_f32_16x16x64_bf16 v[20:23], a[84:87], v[60:67], v147 abid:1
ds_read_u16 v100, v100
v_add_u32_sdwa v103, s42, v131 dst_sel:DWORD dst_unused:UNUSED_PAD src0_sel:DWORD src1_sel:WORD_1
v_smfmac_f32_16x16x64_bf16 v[20:23], a[120:123], v[68:75], v151 abid:1
ds_read_u16 v82, v82
v_add_u32_sdwa v104, s42, v132 dst_sel:DWORD dst_unused:UNUSED_PAD src0_sel:DWORD src1_sel:WORD_0
v_smfmac_f32_16x16x64_bf16 v[36:39], a[100:103], v[60:67], v149 abid:1
ds_read_u16 v101, v101
v_add_u32_sdwa v105, s42, v132 dst_sel:DWORD dst_unused:UNUSED_PAD src0_sel:DWORD src1_sel:WORD_1
v_smfmac_f32_16x16x64_bf16 v[36:39], a[136:139], v[68:75], v153 abid:1
buffer_store_dwordx2 v[112:113], v5, s[20:23], s46 offen
ds_read_u16 v83, v83
v_add_u32_sdwa v106, s42, v133 dst_sel:DWORD dst_unused:UNUSED_PAD src0_sel:DWORD src1_sel:WORD_0
v_smfmac_f32_16x16x64_bf16 v[40:43], a[104:107], v[60:67], v175
s_mov_b32 s22, 75497472
ds_read_b128 v[114:117], v2 offset:192
v_add_u32_sdwa v107, s42, v133 dst_sel:DWORD dst_unused:UNUSED_PAD src0_sel:DWORD src1_sel:WORD_1
v_smfmac_f32_16x16x64_bf16 v[40:43], a[140:143], v[68:75], v175 abid:1
s_waitcnt lgkmcnt(12)
ds_read_u16 v102, v102
v_add_u32_sdwa v84, s42, v134 dst_sel:DWORD dst_unused:UNUSED_PAD src0_sel:DWORD src1_sel:WORD_0
v_smfmac_f32_16x16x64_bf16 v[8:11], a[144:147], v[44:51], v154
s_waitcnt lgkmcnt(9)
ds_read_u16 v103, v103
v_add_u32_sdwa v85, s42, v134 dst_sel:DWORD dst_unused:UNUSED_PAD src0_sel:DWORD src1_sel:WORD_1
v_smfmac_f32_16x16x64_bf16 v[8:11], a[180:183], v[52:59], v158
s_waitcnt lgkmcnt(7)
ds_read_u16 v104, v104
v_add_u32_sdwa v86, s42, v135 dst_sel:DWORD dst_unused:UNUSED_PAD src0_sel:DWORD src1_sel:WORD_0
v_smfmac_f32_16x16x64_bf16 v[8:11], a[216:219], v[92:99], v162
s_mov_b32 s46, s48
ds_read_u16 v105, v105
v_add_u32_sdwa v87, s42, v135 dst_sel:DWORD dst_unused:UNUSED_PAD src0_sel:DWORD src1_sel:WORD_1
v_smfmac_f32_16x16x64_bf16 v[24:27], a[160:163], v[44:51], v156
s_mov_b32 s48, s49
ds_read_u16 v106, v106
v_add_u32_sdwa v88, s42, v136 dst_sel:DWORD dst_unused:UNUSED_PAD src0_sel:DWORD src1_sel:WORD_0
v_smfmac_f32_16x16x64_bf16 v[24:27], a[196:199], v[52:59], v160
s_mov_b32 s49, s50
s_add_u32 s50, s50, 4718592
v_add_u32_sdwa v89, s42, v136 dst_sel:DWORD dst_unused:UNUSED_PAD src0_sel:DWORD src1_sel:WORD_1
v_smfmac_f32_16x16x64_bf16 v[24:27], a[232:235], v[92:99], v164
s_waitcnt lgkmcnt(5)
ds_read_u16 v107, v107
v_add_u32_sdwa v90, s42, v137 dst_sel:DWORD dst_unused:UNUSED_PAD src0_sel:DWORD src1_sel:WORD_0
v_smfmac_f32_16x16x64_bf16 v[24:27], v[114:117], v[76:83], v182
ds_read_u16 v84, v84
v_add_u32_sdwa v91, s42, v137 dst_sel:DWORD dst_unused:UNUSED_PAD src0_sel:DWORD src1_sel:WORD_1
v_smfmac_f32_16x16x64_bf16 v[28:31], v[114:117], v[76:83], v182 abid:1
ds_read_b128 v[114:117], v2 offset:256
v_add_u32_sdwa v76, s4, v118 dst_sel:DWORD dst_unused:UNUSED_PAD src0_sel:DWORD src1_sel:WORD_0
v_smfmac_f32_16x16x64_bf16 v[28:31], a[164:167], v[44:51], v156 abid:1
ds_read_u16 v85, v85
v_add_u32_sdwa v77, s4, v118 dst_sel:DWORD dst_unused:UNUSED_PAD src0_sel:DWORD src1_sel:WORD_1
v_smfmac_f32_16x16x64_bf16 v[28:31], a[200:203], v[52:59], v160 abid:1
ds_read_u16 v86, v86
v_add_u32_sdwa v78, s4, v119 dst_sel:DWORD dst_unused:UNUSED_PAD src0_sel:DWORD src1_sel:WORD_0
v_smfmac_f32_16x16x64_bf16 v[28:31], a[236:239], v[92:99], v164 abid:1
ds_read_u16 v87, v87
v_add_u32_sdwa v79, s4, v119 dst_sel:DWORD dst_unused:UNUSED_PAD src0_sel:DWORD src1_sel:WORD_1
v_smfmac_f32_16x16x64_bf16 v[12:15], a[148:151], v[44:51], v154 abid:1
ds_read_u16 v88, v88
v_add_u32_sdwa v80, s4, v120 dst_sel:DWORD dst_unused:UNUSED_PAD src0_sel:DWORD src1_sel:WORD_0
v_smfmac_f32_16x16x64_bf16 v[12:15], a[184:187], v[52:59], v158 abid:1
v_add_u32_sdwa v81, s4, v120 dst_sel:DWORD dst_unused:UNUSED_PAD src0_sel:DWORD src1_sel:WORD_1
v_smfmac_f32_16x16x64_bf16 v[12:15], a[220:223], v[92:99], v162 abid:1
ds_read_b128 v[60:63], v0 offset:14336
v_add_u32_sdwa v82, s4, v121 dst_sel:DWORD dst_unused:UNUSED_PAD src0_sel:DWORD src1_sel:WORD_0
v_smfmac_f32_16x16x64_bf16 v[32:35], a[168:171], v[44:51], v157
ds_read_u16 v89, v89
v_add_u32_sdwa v83, s4, v121 dst_sel:DWORD dst_unused:UNUSED_PAD src0_sel:DWORD src1_sel:WORD_1
v_smfmac_f32_16x16x64_bf16 v[32:35], a[204:207], v[52:59], v161
ds_read_b128 v[64:67], v1 offset:14336
v_smfmac_f32_16x16x64_bf16 v[32:35], a[240:243], v[92:99], v165
s_waitcnt lgkmcnt(7)
ds_read_b128 v[68:71], v0 offset:16384
v_smfmac_f32_16x16x64_bf16 v[32:35], v[114:117], v[100:107], v183 abid:1
ds_read_u16 v90, v90
v_smfmac_f32_16x16x64_bf16 v[36:39], v[114:117], v[100:107], v184
ds_read_b128 v[72:75], v1 offset:16384
v_add_u32 v0, s43, v0
v_smfmac_f32_16x16x64_bf16 v[36:39], a[172:175], v[44:51], v157 abid:1
ds_read_u16 v91, v91
v_add_u32 v1, s43, v1
v_smfmac_f32_16x16x64_bf16 v[36:39], a[208:211], v[52:59], v161 abid:1
v_smfmac_f32_16x16x64_bf16 v[36:39], a[244:247], v[92:99], v165 abid:1
ds_read_b128 v[114:117], v2 offset:320
v_smfmac_f32_16x16x64_bf16 v[16:19], a[152:155], v[44:51], v155
v_smfmac_f32_16x16x64_bf16 v[16:19], a[188:191], v[52:59], v159
v_smfmac_f32_16x16x64_bf16 v[16:19], a[224:227], v[92:99], v163
v_smfmac_f32_16x16x64_bf16 v[20:23], a[156:159], v[44:51], v155 abid:1
v_smfmac_f32_16x16x64_bf16 v[20:23], a[192:195], v[52:59], v159 abid:1
v_smfmac_f32_16x16x64_bf16 v[20:23], a[228:231], v[92:99], v163 abid:1
v_smfmac_f32_16x16x64_bf16 v[40:43], a[176:179], v[44:51], v176
s_bitcmp1_b32 s92, s41
v_smfmac_f32_16x16x64_bf16 v[40:43], a[212:215], v[52:59], v176 abid:1
s_cbranch_scc1 L_loopn_w
L_loopn_wb:
v_smfmac_f32_16x16x64_bf16 v[40:43], a[248:251], v[92:99], v177
s_waitcnt lgkmcnt(0)
v_smfmac_f32_16x16x64_bf16 v[40:43], v[114:117], v[84:91], v185
s_waitcnt vmcnt(20)
s_barrier
L_loopn_p3:
v_smfmac_f32_16x16x64_bf16 v[8:11], a[252:255], v[60:67], v166
s_mov_b32 s42, s4
v_smfmac_f32_16x16x64_bf16 v[8:11], v[218:221], v[68:75], v170
ds_read_b128 v[44:47], v0 offset:0
v_add_u32_sdwa v84, s42, v122 dst_sel:DWORD dst_unused:UNUSED_PAD src0_sel:DWORD src1_sel:WORD_0
v_smfmac_f32_16x16x64_bf16 v[12:15], v[186:189], v[60:67], v166 abid:1
ds_read_b128 v[48:51], v1 offset:0
v_add_u32_sdwa v85, s42, v122 dst_sel:DWORD dst_unused:UNUSED_PAD src0_sel:DWORD src1_sel:WORD_1
v_smfmac_f32_16x16x64_bf16 v[12:15], v[222:225], v[68:75], v170 abid:1
ds_read_b128 v[52:55], v0 offset:2048
v_add_u32_sdwa v86, s42, v123 dst_sel:DWORD dst_unused:UNUSED_PAD src0_sel:DWORD src1_sel:WORD_0
v_smfmac_f32_16x16x64_bf16 v[16:19], v[190:193], v[60:67], v167
ds_read_b128 v[56:59], v1 offset:2048
v_cvt_pk_bf16_f32 v92, v8, v9
v_smfmac_f32_16x16x64_bf16 v[16:19], v[226:229], v[68:75], v171
ds_read_u16 v76, v76
v_cvt_pk_bf16_f32 v93, v10, v11
v_smfmac_f32_16x16x64_bf16 v[20:23], v[194:197], v[60:67], v167 abid:1
ds_read_b128 v[8:11], v2 offset:1024
v_cvt_pk_bf16_f32 v94, v12, v13
v_smfmac_f32_16x16x64_bf16 v[20:23], v[230:233], v[68:75], v171 abid:1
ds_read_u16 v77, v77
v_cvt_pk_bf16_f32 v95, v14, v15
v_smfmac_f32_16x16x64_bf16 v[24:27], v[198:201], v[60:67], v168
ds_read_b128 v[12:15], v2 offset:1088
v_cvt_pk_bf16_f32 v96, v16, v17
v_smfmac_f32_16x16x64_bf16 v[24:27], v[234:237], v[68:75], v172
ds_read_u16 v78, v78
v_cvt_pk_bf16_f32 v97, v18, v19
v_smfmac_f32_16x16x64_bf16 v[28:31], v[202:205], v[60:67], v168 abid:1
ds_read_b128 v[16:19], v2 offset:1152
v_cvt_pk_bf16_f32 v98, v20, v21
v_smfmac_f32_16x16x64_bf16 v[28:31], v[238:241], v[68:75], v172 abid:1
ds_read_u16 v79, v79
v_cvt_pk_bf16_f32 v99, v22, v23
v_smfmac_f32_16x16x64_bf16 v[32:35], v[206:209], v[60:67], v169
ds_read_b128 v[20:23], v2 offset:1216
v_cvt_pk_bf16_f32 v100, v24, v25
v_smfmac_f32_16x16x64_bf16 v[32:35], v[242:245], v[68:75], v173
ds_read_u16 v80, v80
v_cvt_pk_bf16_f32 v101, v26, v27
v_smfmac_f32_16x16x64_bf16 v[36:39], v[210:213], v[60:67], v169 abid:1
ds_read_b128 v[24:27], v2 offset:1280
v_cvt_pk_bf16_f32 v102, v28, v29
v_smfmac_f32_16x16x64_bf16 v[36:39], v[246:249], v[68:75], v173 abid:1
ds_read_u16 v81, v81
v_cvt_pk_bf16_f32 v103, v30, v31
v_smfmac_f32_16x16x64_bf16 v[40:43], v[214:217], v[60:67], v177 abid:1
s_bitcmp1_b32 s12, s41
ds_read_b128 v[28:31], v2 offset:1344
v_cvt_pk_bf16_f32 v104, v32, v33
v_smfmac_f32_16x16x64_bf16 v[40:43], v[250:253], v[68:75], v178
s_waitcnt lgkmcnt(10)
v_cvt_pk_bf16_f32 v105, v34, v35
s_cbranch_scc1 L_loopn
s_cmp_eq_u32 s41, s59
s_cbranch_scc1 L_loopc
s_cmp_lt_u32 s41, s15
s_cbranch_scc1 L_loop
s_nop 0
v_cndmask_b32_dpp v108, v96, v92, vcc quad_perm:[1,0,3,2] row_mask:0xf bank_mask:0xf
v_cndmask_b32_dpp v109, v97, v93, vcc quad_perm:[1,0,3,2] row_mask:0xf bank_mask:0xf
v_cndmask_b32_dpp v110, v98, v94, vcc quad_perm:[1,0,3,2] row_mask:0xf bank_mask:0xf
v_cndmask_b32_dpp v111, v99, v95, vcc quad_perm:[1,0,3,2] row_mask:0xf bank_mask:0xf
buffer_store_dwordx4 v[108:111], v4, s[20:23], s46 offen offset:0 sc1
s_mov_b64 vcc, s[82:83]
v_cvt_pk_bf16_f32 v112, v40, v41
v_cvt_pk_bf16_f32 v113, v42, v43
ds_bpermute_b32 v112, v6, v112
ds_bpermute_b32 v113, v6, v113
v_cndmask_b32_dpp v96, v92, v96, vcc quad_perm:[1,0,3,2] row_mask:0xf bank_mask:0xf
v_cndmask_b32_dpp v97, v93, v97, vcc quad_perm:[1,0,3,2] row_mask:0xf bank_mask:0xf
v_cndmask_b32_dpp v98, v94, v98, vcc quad_perm:[1,0,3,2] row_mask:0xf bank_mask:0xf
v_cndmask_b32_dpp v99, v95, v99, vcc quad_perm:[1,0,3,2] row_mask:0xf bank_mask:0xf
buffer_store_dwordx4 v[96:99], v4, s[20:23], s46 offen offset:1152 sc1
s_mov_b64 vcc, s[80:81]
v_cvt_pk_bf16_f32 v106, v36, v37
v_cvt_pk_bf16_f32 v107, v38, v39
v_cndmask_b32_dpp v92, v104, v100, vcc quad_perm:[1,0,3,2] row_mask:0xf bank_mask:0xf
v_cndmask_b32_dpp v93, v105, v101, vcc quad_perm:[1,0,3,2] row_mask:0xf bank_mask:0xf
v_cndmask_b32_dpp v94, v106, v102, vcc quad_perm:[1,0,3,2] row_mask:0xf bank_mask:0xf
v_cndmask_b32_dpp v95, v107, v103, vcc quad_perm:[1,0,3,2] row_mask:0xf bank_mask:0xf
buffer_store_dwordx4 v[92:95], v4, s[20:23], s46 offen offset:128 sc1
s_mov_b64 vcc, s[82:83]
v_cndmask_b32_dpp v104, v100, v104, vcc quad_perm:[1,0,3,2] row_mask:0xf bank_mask:0xf
v_cndmask_b32_dpp v105, v101, v105, vcc quad_perm:[1,0,3,2] row_mask:0xf bank_mask:0xf
v_cndmask_b32_dpp v106, v102, v106, vcc quad_perm:[1,0,3,2] row_mask:0xf bank_mask:0xf
v_cndmask_b32_dpp v107, v103, v107, vcc quad_perm:[1,0,3,2] row_mask:0xf bank_mask:0xf
buffer_store_dwordx4 v[104:107], v4, s[20:23], s46 offen offset:1280 sc1
s_mov_b64 vcc, s[80:81]
s_waitcnt lgkmcnt(0)
buffer_store_dwordx2 v[112:113], v5, s[20:23], s46 offen
L_fin:
L_end_standalone__structured_sparse_n_m__ragged_kernel:
s_endpgm
L_more1:
v_and_b32 v73, v94, v16
v_lshrrev_b32 v72, 10, v16
v_cmp_eq_u32 s[64:65], v73, v95
v_and_or_b32 v32, v72, v96, v97
s_mov_b64 exec, s[64:65]
ds_add_rtn_u32 v48, v32, v88
s_mov_b64 exec, -1
v_and_b32 v73, v94, v17
v_lshrrev_b32 v72, 10, v17
v_cmp_eq_u32 s[66:67], v73, v95
v_and_or_b32 v33, v72, v96, v97
s_mov_b64 exec, s[66:67]
ds_add_rtn_u32 v49, v33, v88
s_mov_b64 exec, -1
v_and_b32 v73, v94, v18
v_lshrrev_b32 v72, 10, v18
v_cmp_eq_u32 s[68:69], v73, v95
v_and_or_b32 v34, v72, v96, v97
s_mov_b64 exec, s[68:69]
ds_add_rtn_u32 v50, v34, v88
s_mov_b64 exec, -1
v_and_b32 v73, v94, v19
v_lshrrev_b32 v72, 10, v19
v_cmp_eq_u32 s[70:71], v73, v95
v_and_or_b32 v35, v72, v96, v97
s_mov_b64 exec, s[70:71]
ds_add_rtn_u32 v51, v35, v88
s_mov_b64 exec, -1
v_and_b32 v73, v94, v20
v_lshrrev_b32 v72, 10, v20
v_cmp_eq_u32 s[72:73], v73, v95
v_and_or_b32 v36, v72, v96, v97
s_mov_b64 exec, s[72:73]
ds_add_rtn_u32 v52, v36, v88
s_mov_b64 exec, -1
v_and_b32 v73, v94, v21
v_lshrrev_b32 v72, 10, v21
v_cmp_eq_u32 s[74:75], v73, v95
v_and_or_b32 v37, v72, v96, v97
s_mov_b64 exec, s[74:75]
ds_add_rtn_u32 v53, v37, v88
s_mov_b64 exec, -1
v_and_b32 v73, v94, v22
v_lshrrev_b32 v72, 10, v22
v_cmp_eq_u32 s[76:77], v73, v95
v_and_or_b32 v38, v72, v96, v97
s_mov_b64 exec, s[76:77]
ds_add_rtn_u32 v54, v38, v88
s_mov_b64 exec, -1
s_branch L_more1b
L_greedy:
s_mov_b32 s47, 0
s_mov_b32 s89, 1
v_readlane_b32 s3, v72, 0
s_max_u32 s47, s47, 0
v_writelane_b32 v91, s47, 0
s_nop 1
s_add_u32 s47, s47, s3
s_cmp_gt_u32 s47, 32
s_cselect_b32 s90, 1, s90
v_readlane_b32 s3, v72, 1
s_max_u32 s47, s47, 0
v_writelane_b32 v91, s47, 1
s_nop 1
s_add_u32 s47, s47, s3
s_cmp_gt_u32 s47, 64
s_cselect_b32 s90, 1, s90
v_readlane_b32 s3, v72, 2
s_max_u32 s47, s47, 32
v_writelane_b32 v91, s47, 2
s_nop 1
s_add_u32 s47, s47, s3
s_cmp_gt_u32 s47, 64
s_cselect_b32 s90, 1, s90
v_readlane_b32 s3, v72, 3
s_max_u32 s47, s47, 32
v_writelane_b32 v91, s47, 3
s_nop 1
s_add_u32 s47, s47, s3
s_cmp_gt_u32 s47, 96
s_cselect_b32 s90, 1, s90
v_readlane_b32 s3, v72, 4
s_max_u32 s47, s47, 64
v_writelane_b32 v91, s47, 4
s_nop 1
s_add_u32 s47, s47, s3
s_cmp_gt_u32 s47, 96
s_cselect_b32 s90, 1, s90
v_readlane_b32 s3, v72, 5
s_max_u32 s47, s47, 64
v_writelane_b32 v91, s47, 5
s_nop 1
s_add_u32 s47, s47, s3
s_cmp_gt_u32 s47, 128
s_cselect_b32 s90, 1, s90
v_readlane_b32 s3, v72, 6
s_max_u32 s47, s47, 96
v_writelane_b32 v91, s47, 6
s_nop 1
s_add_u32 s47, s47, s3
s_cmp_gt_u32 s47, 128
s_cselect_b32 s90, 1, s90
v_readlane_b32 s3, v72, 7
s_max_u32 s47, s47, 96
v_writelane_b32 v91, s47, 7
s_nop 1
s_add_u32 s47, s47, s3
s_cmp_gt_u32 s47, 160
s_cselect_b32 s90, 1, s90
v_readlane_b32 s3, v72, 8
s_max_u32 s47, s47, 128
v_writelane_b32 v91, s47, 8
s_nop 1
s_add_u32 s47, s47, s3
s_cmp_gt_u32 s47, 160
s_cselect_b32 s90, 1, s90
s_cmp_lg_u32 s90, 0
s_cselect_b64 s[90:91], -1, 0
v_mov_b32 v73, 163072
s_mov_b64 exec, s[90:91]
ds_write_b32 v73, v88
s_mov_b64 exec, -1
s_branch L_greedyb
L_more2:
ds_bpermute_b32 v64, v32, v91
ds_bpermute_b32 v65, v33, v91
ds_bpermute_b32 v66, v34, v91
ds_bpermute_b32 v67, v35, v91
ds_bpermute_b32 v68, v36, v91
ds_bpermute_b32 v69, v37, v91
ds_bpermute_b32 v70, v38, v91
s_waitcnt lgkmcnt(0)
v_add_u32 v73, v48, v64
v_and_b32 v72, 0x87e, v16
v_lshl_add_u32 v73, v73, 1, s93
v_add_u32 v72, v90, v72
s_andn2_b64 exec, s[64:65], s[90:91]
ds_write_b16_d16_hi v73, v16 offset:64
ds_write_b16 v73, v72 offset:384
ds_write_b16 v73, v16 offset:704
s_mov_b64 exec, -1
v_add_u32 v73, v49, v65
v_and_b32 v72, 0x87e, v17
v_lshl_add_u32 v73, v73, 1, s93
v_add_u32 v72, v90, v72
s_andn2_b64 exec, s[66:67], s[90:91]
ds_write_b16_d16_hi v73, v17 offset:64
ds_write_b16 v73, v72 offset:384
ds_write_b16 v73, v17 offset:704
s_mov_b64 exec, -1
v_add_u32 v73, v50, v66
v_and_b32 v72, 0x87e, v18
v_lshl_add_u32 v73, v73, 1, s93
v_add_u32 v72, v90, v72
s_andn2_b64 exec, s[68:69], s[90:91]
ds_write_b16_d16_hi v73, v18 offset:64
ds_write_b16 v73, v72 offset:384
ds_write_b16 v73, v18 offset:704
s_mov_b64 exec, -1
v_add_u32 v73, v51, v67
v_and_b32 v72, 0x87e, v19
v_lshl_add_u32 v73, v73, 1, s93
v_add_u32 v72, v90, v72
s_andn2_b64 exec, s[70:71], s[90:91]
ds_write_b16_d16_hi v73, v19 offset:64
ds_write_b16 v73, v72 offset:384
ds_write_b16 v73, v19 offset:704
s_mov_b64 exec, -1
v_add_u32 v73, v52, v68
v_and_b32 v72, 0x87e, v20
v_lshl_add_u32 v73, v73, 1, s93
v_add_u32 v72, v90, v72
s_andn2_b64 exec, s[72:73], s[90:91]
ds_write_b16_d16_hi v73, v20 offset:64
ds_write_b16 v73, v72 offset:384
ds_write_b16 v73, v20 offset:704
s_mov_b64 exec, -1
v_add_u32 v73, v53, v69
v_and_b32 v72, 0x87e, v21
v_lshl_add_u32 v73, v73, 1, s93
v_add_u32 v72, v90, v72
s_andn2_b64 exec, s[74:75], s[90:91]
ds_write_b16_d16_hi v73, v21 offset:64
ds_write_b16 v73, v72 offset:384
ds_write_b16 v73, v21 offset:704
s_mov_b64 exec, -1
v_add_u32 v73, v54, v70
v_and_b32 v72, 0x87e, v22
v_lshl_add_u32 v73, v73, 1, s93
v_add_u32 v72, v90, v72
s_andn2_b64 exec, s[76:77], s[90:91]
ds_write_b16_d16_hi v73, v22 offset:64
ds_write_b16 v73, v72 offset:384
ds_write_b16 v73, v22 offset:704
s_mov_b64 exec, -1
s_branch L_more2b
L_cwait:
buffer_load_dword v8, off, s[36:39], 0 sc1
s_sub_u32 s3, s3, 1
s_cbranch_scc1 L_giveup
s_waitcnt vmcnt(0)
v_readfirstlane_b32 s47, v8
s_nop 3
s_cmp_lg_u32 s47, 1
s_cbranch_scc1 L_cwait
s_branch L_poll
L_giveup:
s_waitcnt vmcnt(0)
v_mov_b32 v8, 163072
v_mov_b32 v9, 1
ds_write_b32 v8, v9
s_branch L_polled
L_loop_w:
s_bitcmp1_b32 s87, s41
s_waitcnt vmcnt(15)
s_cbranch_scc0 L_loop_wb
s_waitcnt vmcnt(10)
s_branch L_loop_wb
L_loopn_w:
s_bitcmp1_b32 s87, s41
s_waitcnt vmcnt(15)
s_cbranch_scc0 L_loopn_wb
s_waitcnt vmcnt(10)
s_branch L_loopn_wb
L_linked:
.p2align 6
L_loopk:
v_smfmac_f32_16x16x64_bf16 v[8:11], a[0:3], v[44:51], v138
ds_read_b128 v[32:35], v2 offset:1408
v_cvt_pk_bf16_f32 v106, v36, v37
v_smfmac_f32_16x16x64_bf16 v[8:11], a[36:39], v[52:59], v142
s_waitcnt lgkmcnt(9)
v_cvt_pk_bf16_f32 v107, v38, v39
v_smfmac_f32_16x16x64_bf16 v[12:15], a[4:7], v[44:51], v138 abid:1
ds_read_b128 v[36:39], v2 offset:1472
v_cvt_pk_bf16_f32 v112, v40, v41
v_smfmac_f32_16x16x64_bf16 v[12:15], a[40:43], v[52:59], v142 abid:1
s_waitcnt lgkmcnt(8)
ds_read_b128 v[60:63], v0 offset:4096
v_cvt_pk_bf16_f32 v113, v42, v43
v_smfmac_f32_16x16x64_bf16 v[16:19], a[8:11], v[44:51], v139
s_cmp_eq_u32 s4, 129920
ds_read_b128 v[40:43], v2 offset:1536
v_cndmask_b32_dpp v108, v96, v92, vcc quad_perm:[1,0,3,2] row_mask:0xf bank_mask:0xf
v_smfmac_f32_16x16x64_bf16 v[16:19], a[44:47], v[52:59], v143
s_waitcnt lgkmcnt(8)
ds_read_u16 v82, v82
v_cndmask_b32_dpp v109, v97, v93, vcc quad_perm:[1,0,3,2] row_mask:0xf bank_mask:0xf
v_smfmac_f32_16x16x64_bf16 v[20:23], a[12:15], v[44:51], v139 abid:1
s_cselect_b32 s43, -129920, s5
ds_read_u16 v84, v84
v_cndmask_b32_dpp v110, v98, v94, vcc quad_perm:[1,0,3,2] row_mask:0xf bank_mask:0xf
v_smfmac_f32_16x16x64_bf16 v[20:23], a[48:51], v[52:59], v143 abid:1
s_waitcnt lgkmcnt(8)
ds_read_b128 v[64:67], v1 offset:4096
v_cndmask_b32_dpp v111, v99, v95, vcc quad_perm:[1,0,3,2] row_mask:0xf bank_mask:0xf
v_smfmac_f32_16x16x64_bf16 v[24:27], a[16:19], v[44:51], v140
s_add_u32 s4, s4, s43
ds_read_b128 v[68:71], v0 offset:6144
v_add_u32_sdwa v87, s42, v123 dst_sel:DWORD dst_unused:UNUSED_PAD src0_sel:DWORD src1_sel:WORD_1
v_smfmac_f32_16x16x64_bf16 v[24:27], a[52:55], v[52:59], v144
buffer_store_dwordx4 v[108:111], v4, s[20:23], s46 offen offset:0 sc1
s_mov_b64 vcc, s[82:83]
s_waitcnt lgkmcnt(8)
ds_read_b128 v[72:75], v1 offset:6144
v_cndmask_b32_dpp v96, v92, v96, vcc quad_perm:[1,0,3,2] row_mask:0xf bank_mask:0xf
v_cndmask_b32_dpp v97, v93, v97, vcc quad_perm:[1,0,3,2] row_mask:0xf bank_mask:0xf
v_smfmac_f32_16x16x64_bf16 v[28:31], a[20:23], v[44:51], v140 abid:1
s_add_u32 s41, s41, 1
ds_read_u16 v83, v83
v_cndmask_b32_dpp v98, v94, v98, vcc quad_perm:[1,0,3,2] row_mask:0xf bank_mask:0xf
v_smfmac_f32_16x16x64_bf16 v[28:31], a[56:59], v[52:59], v144 abid:1
s_waitcnt lgkmcnt(9)
ds_read_b128 v[114:117], v2 offset:64
v_cndmask_b32_dpp v99, v95, v99, vcc quad_perm:[1,0,3,2] row_mask:0xf bank_mask:0xf
v_smfmac_f32_16x16x64_bf16 v[32:35], a[24:27], v[44:51], v141
ds_read_u16 v85, v85
v_add_u32_sdwa v88, s42, v124 dst_sel:DWORD dst_unused:UNUSED_PAD src0_sel:DWORD src1_sel:WORD_0
v_smfmac_f32_16x16x64_bf16 v[32:35], a[60:63], v[52:59], v145
s_waitcnt lgkmcnt(10)
ds_read_u16 v86, v86
v_add_u32_sdwa v89, s42, v124 dst_sel:DWORD dst_unused:UNUSED_PAD src0_sel:DWORD src1_sel:WORD_1
v_smfmac_f32_16x16x64_bf16 v[36:39], a[28:31], v[44:51], v141 abid:1
ds_read_u16 v87, v87
v_add_u32_sdwa v90, s42, v125 dst_sel:DWORD dst_unused:UNUSED_PAD src0_sel:DWORD src1_sel:WORD_0
v_smfmac_f32_16x16x64_bf16 v[36:39], a[64:67], v[52:59], v145 abid:1
s_waitcnt lgkmcnt(10)
ds_read_u16 v88, v88
v_add_u32_sdwa v91, s42, v125 dst_sel:DWORD dst_unused:UNUSED_PAD src0_sel:DWORD src1_sel:WORD_1
v_smfmac_f32_16x16x64_bf16 v[40:43], a[32:35], v[44:51], v174
buffer_store_dwordx4 v[96:99], v4, s[20:23], s46 offen offset:1152 sc1
s_mov_b64 vcc, s[80:81]
ds_read_u16 v89, v89
v_cndmask_b32_dpp v92, v104, v100, vcc quad_perm:[1,0,3,2] row_mask:0xf bank_mask:0xf
v_cndmask_b32_dpp v93, v105, v101, vcc quad_perm:[1,0,3,2] row_mask:0xf bank_mask:0xf
v_smfmac_f32_16x16x64_bf16 v[40:43], a[68:71], v[52:59], v174 abid:1
s_waitcnt lgkmcnt(9)
ds_read_u16 v90, v90
v_cndmask_b32_dpp v94, v106, v102, vcc quad_perm:[1,0,3,2] row_mask:0xf bank_mask:0xf
v_smfmac_f32_16x16x64_bf16 v[8:11], a[72:75], v[60:67], v146
s_waitcnt lgkmcnt(8)
ds_read_u16 v91, v91
v_cndmask_b32_dpp v95, v107, v103, vcc quad_perm:[1,0,3,2] row_mask:0xf bank_mask:0xf
v_smfmac_f32_16x16x64_bf16 v[8:11], a[108:111], v[68:75], v150
s_waitcnt lgkmcnt(7)
ds_bpermute_b32 v112, v6, v112
v_smfmac_f32_16x16x64_bf16 v[8:11], v[114:117], v[76:83], v179
ds_bpermute_b32 v113, v6, v113
v_smfmac_f32_16x16x64_bf16 v[12:15], v[114:117], v[76:83], v179 abid:1
ds_read_b128 v[114:117], v2 offset:128
v_add_u32_sdwa v76, s42, v126 dst_sel:DWORD dst_unused:UNUSED_PAD src0_sel:DWORD src1_sel:WORD_0
v_smfmac_f32_16x16x64_bf16 v[12:15], a[76:79], v[60:67], v146 abid:1
ds_read_u16 v76, v76
v_add_u32_sdwa v77, s42, v126 dst_sel:DWORD dst_unused:UNUSED_PAD src0_sel:DWORD src1_sel:WORD_1
v_smfmac_f32_16x16x64_bf16 v[12:15], a[112:115], v[68:75], v150 abid:1
buffer_store_dwordx4 v[92:95], v4, s[20:23], s46 offen offset:128 sc1
s_mov_b64 vcc, s[82:83]
ds_read_u16 v77, v77
v_cndmask_b32_dpp v104, v100, v104, vcc quad_perm:[1,0,3,2] row_mask:0xf bank_mask:0xf
v_cndmask_b32_dpp v105, v101, v105, vcc quad_perm:[1,0,3,2] row_mask:0xf bank_mask:0xf
v_smfmac_f32_16x16x64_bf16 v[24:27], a[88:91], v[60:67], v148
ds_read_b128 v[44:47], v0 offset:8192
v_add_u32_sdwa v78, s42, v127 dst_sel:DWORD dst_unused:UNUSED_PAD src0_sel:DWORD src1_sel:WORD_0
v_smfmac_f32_16x16x64_bf16 v[24:27], a[124:127], v[68:75], v152
ds_read_u16 v78, v78
v_cndmask_b32_dpp v106, v102, v106, vcc quad_perm:[1,0,3,2] row_mask:0xf bank_mask:0xf
v_smfmac_f32_16x16x64_bf16 v[28:31], a[92:95], v[60:67], v148 abid:1
ds_read_b128 v[48:51], v1 offset:8192
v_cndmask_b32_dpp v107, v103, v107, vcc quad_perm:[1,0,3,2] row_mask:0xf bank_mask:0xf
v_smfmac_f32_16x16x64_bf16 v[28:31], a[128:131], v[68:75], v152 abid:1
ds_read_b128 v[52:55], v0 offset:10240
v_add_u32_sdwa v79, s42, v127 dst_sel:DWORD dst_unused:UNUSED_PAD src0_sel:DWORD src1_sel:WORD_1
v_smfmac_f32_16x16x64_bf16 v[32:35], a[96:99], v[60:67], v149
ds_read_u16 v79, v79
v_add_u32_sdwa v80, s42, v128 dst_sel:DWORD dst_unused:UNUSED_PAD src0_sel:DWORD src1_sel:WORD_0
v_smfmac_f32_16x16x64_bf16 v[32:35], a[132:135], v[68:75], v153
ds_read_u16 v80, v80
v_add_u32_sdwa v81, s42, v128 dst_sel:DWORD dst_unused:UNUSED_PAD src0_sel:DWORD src1_sel:WORD_1
v_smfmac_f32_16x16x64_bf16 v[16:19], a[80:83], v[60:67], v147
buffer_store_dwordx4 v[104:107], v4, s[20:23], s46 offen offset:1280 sc1
s_mov_b64 vcc, s[80:81]
ds_read_b128 v[56:59], v1 offset:10240
v_add_u32_sdwa v82, s42, v129 dst_sel:DWORD dst_unused:UNUSED_PAD src0_sel:DWORD src1_sel:WORD_0
v_add_u32_sdwa v83, s42, v129 dst_sel:DWORD dst_unused:UNUSED_PAD src0_sel:DWORD src1_sel:WORD_1
v_smfmac_f32_16x16x64_bf16 v[16:19], a[116:119], v[68:75], v151
s_waitcnt lgkmcnt(9)
ds_read_b128 v[92:95], v0 offset:12288
v_add_u32_sdwa v100, s42, v130 dst_sel:DWORD dst_unused:UNUSED_PAD src0_sel:DWORD src1_sel:WORD_0
v_smfmac_f32_16x16x64_bf16 v[16:19], v[114:117], v[84:91], v180 abid:1
s_waitcnt vmcnt(4)
ds_read_u16 v81, v81
v_add_u32_sdwa v101, s42, v130 dst_sel:DWORD dst_unused:UNUSED_PAD src0_sel:DWORD src1_sel:WORD_1
v_smfmac_f32_16x16x64_bf16 v[12:15], v[114:117], v[84:91], v180
ds_read_b128 v[96:99], v1 offset:12288
v_add_u32_sdwa v102, s42, v131 dst_sel:DWORD dst_unused:UNUSED_PAD src0_sel:DWORD src1_sel:WORD_0
v_smfmac_f32_16x16x64_bf16 v[20:23], v[114:117], v[84:91], v181
ds_read_u16 v82, v82
v_add_u32_sdwa v103, s42, v131 dst_sel:DWORD dst_unused:UNUSED_PAD src0_sel:DWORD src1_sel:WORD_1
v_smfmac_f32_16x16x64_bf16 v[20:23], a[84:87], v[60:67], v147 abid:1
ds_read_u16 v100, v100
v_add_u32_sdwa v104, s42, v132 dst_sel:DWORD dst_unused:UNUSED_PAD src0_sel:DWORD src1_sel:WORD_0
v_smfmac_f32_16x16x64_bf16 v[20:23], a[120:123], v[68:75], v151 abid:1
ds_read_u16 v83, v83
v_add_u32_sdwa v105, s42, v132 dst_sel:DWORD dst_unused:UNUSED_PAD src0_sel:DWORD src1_sel:WORD_1
v_smfmac_f32_16x16x64_bf16 v[36:39], a[100:103], v[60:67], v149 abid:1
buffer_store_dwordx2 v[112:113], v5, s[20:23], s46 offen
ds_read_b128 v[114:117], v2 offset:192
v_add_u32_sdwa v106, s42, v133 dst_sel:DWORD dst_unused:UNUSED_PAD src0_sel:DWORD src1_sel:WORD_0
v_smfmac_f32_16x16x64_bf16 v[36:39], a[136:139], v[68:75], v153 abid:1
s_mov_b32 s22, 75497472
ds_read_u16 v101, v101
v_add_u32_sdwa v107, s42, v133 dst_sel:DWORD dst_unused:UNUSED_PAD src0_sel:DWORD src1_sel:WORD_1
v_smfmac_f32_16x16x64_bf16 v[40:43], a[104:107], v[60:67], v175
s_mov_b32 s46, s48
ds_read_u16 v102, v102
v_add_u32_sdwa v84, s42, v134 dst_sel:DWORD dst_unused:UNUSED_PAD src0_sel:DWORD src1_sel:WORD_0
v_smfmac_f32_16x16x64_bf16 v[40:43], a[140:143], v[68:75], v175 abid:1
s_waitcnt lgkmcnt(13)
ds_read_u16 v103, v103
v_add_u32_sdwa v85, s42, v134 dst_sel:DWORD dst_unused:UNUSED_PAD src0_sel:DWORD src1_sel:WORD_1
v_smfmac_f32_16x16x64_bf16 v[8:11], a[144:147], v[44:51], v154
s_waitcnt lgkmcnt(10)
ds_read_u16 v104, v104
v_add_u32_sdwa v86, s42, v135 dst_sel:DWORD dst_unused:UNUSED_PAD src0_sel:DWORD src1_sel:WORD_0
v_smfmac_f32_16x16x64_bf16 v[8:11], a[180:183], v[52:59], v158
s_waitcnt lgkmcnt(8)
ds_read_u16 v105, v105
v_add_u32_sdwa v87, s42, v135 dst_sel:DWORD dst_unused:UNUSED_PAD src0_sel:DWORD src1_sel:WORD_1
v_smfmac_f32_16x16x64_bf16 v[8:11], a[216:219], v[92:99], v162
s_add_u32 m0, s44, 0
ds_read_u16 v106, v106
v_add_u32_sdwa v88, s42, v136 dst_sel:DWORD dst_unused:UNUSED_PAD src0_sel:DWORD src1_sel:WORD_0
v_smfmac_f32_16x16x64_bf16 v[24:27], a[160:163], v[44:51], v156
buffer_load_dwordx4 v3, s[16:19], s45 offen offset:0 nt lds
v_add_u32_sdwa v89, s42, v136 dst_sel:DWORD dst_unused:UNUSED_PAD src0_sel:DWORD src1_sel:WORD_1
v_smfmac_f32_16x16x64_bf16 v[24:27], a[196:199], v[52:59], v160
s_mov_b32 s48, s49
ds_read_u16 v107, v107
v_add_u32_sdwa v90, s42, v137 dst_sel:DWORD dst_unused:UNUSED_PAD src0_sel:DWORD src1_sel:WORD_0
v_smfmac_f32_16x16x64_bf16 v[24:27], a[232:235], v[92:99], v164
s_waitcnt lgkmcnt(7)
ds_read_u16 v84, v84
v_add_u32_sdwa v91, s42, v137 dst_sel:DWORD dst_unused:UNUSED_PAD src0_sel:DWORD src1_sel:WORD_1
v_smfmac_f32_16x16x64_bf16 v[24:27], v[114:117], v[76:83], v182
s_mov_b32 s49, s50
ds_read_u16 v85, v85
v_smfmac_f32_16x16x64_bf16 v[20:23], v[114:117], v[76:83], v181 abid:1
s_add_u32 s50, s50, 4718592
ds_read_u16 v86, v86
v_smfmac_f32_16x16x64_bf16 v[28:31], v[114:117], v[76:83], v182 abid:1
ds_read_b128 v[114:117], v2 offset:256
v_add_u32_sdwa v76, s4, v118 dst_sel:DWORD dst_unused:UNUSED_PAD src0_sel:DWORD src1_sel:WORD_0
v_smfmac_f32_16x16x64_bf16 v[28:31], a[164:167], v[44:51], v156 abid:1
ds_read_u16 v87, v87
v_add_u32_sdwa v77, s4, v118 dst_sel:DWORD dst_unused:UNUSED_PAD src0_sel:DWORD src1_sel:WORD_1
v_smfmac_f32_16x16x64_bf16 v[28:31], a[200:203], v[52:59], v160 abid:1
ds_read_u16 v88, v88
v_add_u32_sdwa v78, s4, v119 dst_sel:DWORD dst_unused:UNUSED_PAD src0_sel:DWORD src1_sel:WORD_0
v_smfmac_f32_16x16x64_bf16 v[28:31], a[236:239], v[92:99], v164 abid:1
ds_read_b128 v[60:63], v0 offset:14336
v_add_u32_sdwa v79, s4, v119 dst_sel:DWORD dst_unused:UNUSED_PAD src0_sel:DWORD src1_sel:WORD_1
v_smfmac_f32_16x16x64_bf16 v[12:15], a[148:151], v[44:51], v154 abid:1
ds_read_u16 v89, v89
v_add_u32_sdwa v80, s4, v120 dst_sel:DWORD dst_unused:UNUSED_PAD src0_sel:DWORD src1_sel:WORD_0
v_smfmac_f32_16x16x64_bf16 v[12:15], a[184:187], v[52:59], v158 abid:1
s_add_u32 m0, s44, 3840
ds_read_b128 v[64:67], v1 offset:14336
v_add_u32_sdwa v81, s4, v120 dst_sel:DWORD dst_unused:UNUSED_PAD src0_sel:DWORD src1_sel:WORD_1
v_smfmac_f32_16x16x64_bf16 v[12:15], a[220:223], v[92:99], v162 abid:1
buffer_load_dwordx4 v3, s[16:19], s45 offen offset:256 nt lds
v_add_u32_sdwa v82, s4, v121 dst_sel:DWORD dst_unused:UNUSED_PAD src0_sel:DWORD src1_sel:WORD_0
v_smfmac_f32_16x16x64_bf16 v[32:35], a[168:171], v[44:51], v157
ds_read_b128 v[68:71], v0 offset:16384
v_add_u32_sdwa v83, s4, v121 dst_sel:DWORD dst_unused:UNUSED_PAD src0_sel:DWORD src1_sel:WORD_1
v_smfmac_f32_16x16x64_bf16 v[32:35], a[204:207], v[52:59], v161
ds_read_u16 v90, v90
v_smfmac_f32_16x16x64_bf16 v[32:35], a[240:243], v[92:99], v165
s_waitcnt lgkmcnt(7)
ds_read_b128 v[72:75], v1 offset:16384
v_add_u32 v0, s43, v0
v_smfmac_f32_16x16x64_bf16 v[32:35], v[114:117], v[100:107], v183 abid:1
ds_read_u16 v91, v91
v_add_u32 v1, s43, v1
v_smfmac_f32_16x16x64_bf16 v[28:31], v[114:117], v[100:107], v183
v_smfmac_f32_16x16x64_bf16 v[36:39], v[114:117], v[100:107], v184
ds_read_b128 v[114:117], v2 offset:320
v_smfmac_f32_16x16x64_bf16 v[36:39], a[172:175], v[44:51], v157 abid:1
s_add_u32 m0, s44, 7680
v_smfmac_f32_16x16x64_bf16 v[36:39], a[208:211], v[52:59], v161 abid:1
buffer_load_dwordx4 v3, s[16:19], s45 offen offset:512 nt lds
v_smfmac_f32_16x16x64_bf16 v[36:39], a[244:247], v[92:99], v165 abid:1
v_smfmac_f32_16x16x64_bf16 v[16:19], a[152:155], v[44:51], v155
s_add_u32 m0, s44, 11520
v_smfmac_f32_16x16x64_bf16 v[16:19], a[188:191], v[52:59], v159
buffer_load_dwordx4 v3, s[16:19], s45 offen offset:768 nt lds
v_smfmac_f32_16x16x64_bf16 v[16:19], a[224:227], v[92:99], v163
v_smfmac_f32_16x16x64_bf16 v[20:23], a[156:159], v[44:51], v155 abid:1
s_add_u32 m0, s44, s8
v_smfmac_f32_16x16x64_bf16 v[20:23], a[192:195], v[52:59], v159 abid:1
s_mov_b64 exec, s[10:11]
buffer_load_dwordx4 v3, s[16:19], s7 offen offset:896 nt lds
s_mov_b64 exec, -1
v_smfmac_f32_16x16x64_bf16 v[20:23], a[228:231], v[92:99], v163 abid:1
s_add_u32 s45, s45, 4718592
s_add_u32 s7, s7, 4718592
s_add_u32 s44, s44, s5
v_smfmac_f32_16x16x64_bf16 v[40:43], a[176:179], v[44:51], v176
s_cmp_ge_u32 s44, 148480
s_cselect_b32 s44, s9, s44
s_bitcmp1_b32 s92, s41
v_smfmac_f32_16x16x64_bf16 v[40:43], a[212:215], v[52:59], v176 abid:1
s_cbranch_scc1 L_loopk_w
L_loopk_wb:
v_smfmac_f32_16x16x64_bf16 v[40:43], a[248:251], v[92:99], v177
s_waitcnt lgkmcnt(0)
v_smfmac_f32_16x16x64_bf16 v[40:43], v[114:117], v[84:91], v185
v_smfmac_f32_16x16x64_bf16 v[36:39], v[114:117], v[84:91], v184 abid:1
s_waitcnt vmcnt(20)
s_barrier
v_smfmac_f32_16x16x64_bf16 v[8:11], a[252:255], v[60:67], v166
s_mov_b32 s42, s4
v_smfmac_f32_16x16x64_bf16 v[8:11], v[218:221], v[68:75], v170
ds_read_b128 v[44:47], v0 offset:0
v_add_u32_sdwa v84, s42, v122 dst_sel:DWORD dst_unused:UNUSED_PAD src0_sel:DWORD src1_sel:WORD_0
v_smfmac_f32_16x16x64_bf16 v[12:15], v[186:189], v[60:67], v166 abid:1
ds_read_b128 v[48:51], v1 offset:0
v_add_u32_sdwa v85, s42, v122 dst_sel:DWORD dst_unused:UNUSED_PAD src0_sel:DWORD src1_sel:WORD_1
v_smfmac_f32_16x16x64_bf16 v[12:15], v[222:225], v[68:75], v170 abid:1
ds_read_b128 v[52:55], v0 offset:2048
v_add_u32_sdwa v86, s42, v123 dst_sel:DWORD dst_unused:UNUSED_PAD src0_sel:DWORD src1_sel:WORD_0
v_smfmac_f32_16x16x64_bf16 v[16:19], v[190:193], v[60:67], v167
ds_read_b128 v[56:59], v1 offset:2048
v_cvt_pk_bf16_f32 v92, v8, v9
v_smfmac_f32_16x16x64_bf16 v[16:19], v[226:229], v[68:75], v171
ds_read_u16 v76, v76
v_cvt_pk_bf16_f32 v93, v10, v11
v_smfmac_f32_16x16x64_bf16 v[20:23], v[194:197], v[60:67], v167 abid:1
ds_read_b128 v[8:11], v2 offset:1024
v_cvt_pk_bf16_f32 v94, v12, v13
v_smfmac_f32_16x16x64_bf16 v[20:23], v[230:233], v[68:75], v171 abid:1
ds_read_u16 v77, v77
v_cvt_pk_bf16_f32 v95, v14, v15
v_smfmac_f32_16x16x64_bf16 v[24:27], v[198:201], v[60:67], v168
ds_read_b128 v[12:15], v2 offset:1088
v_cvt_pk_bf16_f32 v96, v16, v17
v_smfmac_f32_16x16x64_bf16 v[24:27], v[234:237], v[68:75], v172
ds_read_u16 v78, v78
v_cvt_pk_bf16_f32 v97, v18, v19
v_smfmac_f32_16x16x64_bf16 v[28:31], v[202:205], v[60:67], v168 abid:1
ds_read_b128 v[16:19], v2 offset:1152
v_cvt_pk_bf16_f32 v98, v20, v21
v_smfmac_f32_16x16x64_bf16 v[28:31], v[238:241], v[68:75], v172 abid:1
ds_read_u16 v79, v79
v_cvt_pk_bf16_f32 v99, v22, v23
v_smfmac_f32_16x16x64_bf16 v[32:35], v[206:209], v[60:67], v169
ds_read_b128 v[20:23], v2 offset:1216
v_cvt_pk_bf16_f32 v100, v24, v25
v_smfmac_f32_16x16x64_bf16 v[32:35], v[242:245], v[68:75], v173
ds_read_u16 v80, v80
v_cvt_pk_bf16_f32 v101, v26, v27
v_smfmac_f32_16x16x64_bf16 v[36:39], v[210:213], v[60:67], v169 abid:1
ds_read_b128 v[24:27], v2 offset:1280
v_cvt_pk_bf16_f32 v102, v28, v29
v_smfmac_f32_16x16x64_bf16 v[36:39], v[246:249], v[68:75], v173 abid:1
ds_read_u16 v81, v81
v_cvt_pk_bf16_f32 v103, v30, v31
v_smfmac_f32_16x16x64_bf16 v[40:43], v[214:217], v[60:67], v177 abid:1
s_bitcmp1_b32 s85, s41
ds_read_b128 v[28:31], v2 offset:1344
v_cvt_pk_bf16_f32 v104, v32, v33
v_smfmac_f32_16x16x64_bf16 v[40:43], v[250:253], v[68:75], v178
s_waitcnt lgkmcnt(10)
v_cvt_pk_bf16_f32 v105, v34, v35
s_cbranch_scc1 L_loopk
s_cmp_lg_u32 s41, 6
s_cbranch_scc1 L_loopnk
.p2align 3
L_loopck:
v_smfmac_f32_16x16x64_bf16 v[8:11], a[0:3], v[44:51], v138
s_cmp_lt_u32 s56, s65
s_cselect_b32 s34, s34, 0
s_cselect_b32 s64, s64, 0
ds_read_b128 v[32:35], v2 offset:1408
v_cvt_pk_bf16_f32 v106, v36, v37
v_mov_b32 v7, 1
v_smfmac_f32_16x16x64_bf16 v[8:11], a[36:39], v[52:59], v142
s_waitcnt lgkmcnt(9)
buffer_atomic_add v7, v6, s[32:35], 0 offen sc0 sc1
v_cvt_pk_bf16_f32 v107, v38, v39
v_smfmac_f32_16x16x64_bf16 v[12:15], a[4:7], v[44:51], v138 abid:1
ds_read_b128 v[36:39], v2 offset:1472
v_cvt_pk_bf16_f32 v112, v40, v41
v_smfmac_f32_16x16x64_bf16 v[12:15], a[40:43], v[52:59], v142 abid:1
s_waitcnt lgkmcnt(8)
ds_read_b128 v[60:63], v0 offset:4096
v_cvt_pk_bf16_f32 v113, v42, v43
v_smfmac_f32_16x16x64_bf16 v[16:19], a[8:11], v[44:51], v139
s_cmp_eq_u32 s4, 129920
ds_read_b128 v[40:43], v2 offset:1536
v_cndmask_b32_dpp v108, v96, v92, vcc quad_perm:[1,0,3,2] row_mask:0xf bank_mask:0xf
v_smfmac_f32_16x16x64_bf16 v[16:19], a[44:47], v[52:59], v143
s_waitcnt lgkmcnt(8)
ds_read_u16 v82, v82
v_cndmask_b32_dpp v109, v97, v93, vcc quad_perm:[1,0,3,2] row_mask:0xf bank_mask:0xf
v_smfmac_f32_16x16x64_bf16 v[20:23], a[12:15], v[44:51], v139 abid:1
s_cselect_b32 s43, -129920, s5
ds_read_u16 v84, v84
v_cndmask_b32_dpp v110, v98, v94, vcc quad_perm:[1,0,3,2] row_mask:0xf bank_mask:0xf
v_smfmac_f32_16x16x64_bf16 v[20:23], a[48:51], v[52:59], v143 abid:1
s_waitcnt lgkmcnt(8)
ds_read_b128 v[64:67], v1 offset:4096
v_cndmask_b32_dpp v111, v99, v95, vcc quad_perm:[1,0,3,2] row_mask:0xf bank_mask:0xf
v_smfmac_f32_16x16x64_bf16 v[24:27], a[16:19], v[44:51], v140
s_add_u32 s4, s4, s43
ds_read_b128 v[68:71], v0 offset:6144
v_add_u32_sdwa v87, s42, v123 dst_sel:DWORD dst_unused:UNUSED_PAD src0_sel:DWORD src1_sel:WORD_1
v_smfmac_f32_16x16x64_bf16 v[24:27], a[52:55], v[52:59], v144
buffer_store_dwordx4 v[108:111], v4, s[20:23], s46 offen offset:0 sc1
s_mov_b64 vcc, s[82:83]
s_waitcnt lgkmcnt(8)
ds_read_b128 v[72:75], v1 offset:6144
v_cndmask_b32_dpp v96, v92, v96, vcc quad_perm:[1,0,3,2] row_mask:0xf bank_mask:0xf
v_cndmask_b32_dpp v97, v93, v97, vcc quad_perm:[1,0,3,2] row_mask:0xf bank_mask:0xf
v_smfmac_f32_16x16x64_bf16 v[28:31], a[20:23], v[44:51], v140 abid:1
s_add_u32 s7, s45, s58
ds_read_u16 v83, v83
v_cndmask_b32_dpp v98, v94, v98, vcc quad_perm:[1,0,3,2] row_mask:0xf bank_mask:0xf
v_smfmac_f32_16x16x64_bf16 v[28:31], a[56:59], v[52:59], v144 abid:1
s_waitcnt lgkmcnt(9)
ds_read_b128 v[114:117], v2 offset:64
v_cndmask_b32_dpp v99, v95, v99, vcc quad_perm:[1,0,3,2] row_mask:0xf bank_mask:0xf
v_smfmac_f32_16x16x64_bf16 v[32:35], a[24:27], v[44:51], v141
ds_read_u16 v85, v85
v_add_u32_sdwa v88, s42, v124 dst_sel:DWORD dst_unused:UNUSED_PAD src0_sel:DWORD src1_sel:WORD_0
v_smfmac_f32_16x16x64_bf16 v[32:35], a[60:63], v[52:59], v145
s_waitcnt lgkmcnt(10)
ds_read_u16 v86, v86
v_add_u32_sdwa v89, s42, v124 dst_sel:DWORD dst_unused:UNUSED_PAD src0_sel:DWORD src1_sel:WORD_1
v_smfmac_f32_16x16x64_bf16 v[36:39], a[28:31], v[44:51], v141 abid:1
ds_read_u16 v87, v87
v_add_u32_sdwa v90, s42, v125 dst_sel:DWORD dst_unused:UNUSED_PAD src0_sel:DWORD src1_sel:WORD_0
v_smfmac_f32_16x16x64_bf16 v[36:39], a[64:67], v[52:59], v145 abid:1
s_waitcnt lgkmcnt(10)
ds_read_u16 v88, v88
v_add_u32_sdwa v91, s42, v125 dst_sel:DWORD dst_unused:UNUSED_PAD src0_sel:DWORD src1_sel:WORD_1
v_smfmac_f32_16x16x64_bf16 v[40:43], a[32:35], v[44:51], v174
buffer_store_dwordx4 v[96:99], v4, s[20:23], s46 offen offset:1152 sc1
s_mov_b64 vcc, s[80:81]
ds_read_u16 v89, v89
v_cndmask_b32_dpp v92, v104, v100, vcc quad_perm:[1,0,3,2] row_mask:0xf bank_mask:0xf
v_cndmask_b32_dpp v93, v105, v101, vcc quad_perm:[1,0,3,2] row_mask:0xf bank_mask:0xf
v_smfmac_f32_16x16x64_bf16 v[40:43], a[68:71], v[52:59], v174 abid:1
s_waitcnt lgkmcnt(9)
ds_read_u16 v90, v90
v_cndmask_b32_dpp v94, v106, v102, vcc quad_perm:[1,0,3,2] row_mask:0xf bank_mask:0xf
v_smfmac_f32_16x16x64_bf16 v[8:11], a[72:75], v[60:67], v146
s_waitcnt lgkmcnt(8)
ds_read_u16 v91, v91
v_cndmask_b32_dpp v95, v107, v103, vcc quad_perm:[1,0,3,2] row_mask:0xf bank_mask:0xf
v_smfmac_f32_16x16x64_bf16 v[8:11], a[108:111], v[68:75], v150
s_waitcnt lgkmcnt(7)
ds_bpermute_b32 v112, v6, v112
v_smfmac_f32_16x16x64_bf16 v[8:11], v[114:117], v[76:83], v179
ds_bpermute_b32 v113, v6, v113
v_smfmac_f32_16x16x64_bf16 v[12:15], v[114:117], v[76:83], v179 abid:1
ds_read_b128 v[114:117], v2 offset:128
v_add_u32_sdwa v76, s42, v126 dst_sel:DWORD dst_unused:UNUSED_PAD src0_sel:DWORD src1_sel:WORD_0
v_smfmac_f32_16x16x64_bf16 v[12:15], a[76:79], v[60:67], v146 abid:1
ds_read_u16 v76, v76
v_add_u32_sdwa v77, s42, v126 dst_sel:DWORD dst_unused:UNUSED_PAD src0_sel:DWORD src1_sel:WORD_1
v_smfmac_f32_16x16x64_bf16 v[12:15], a[112:115], v[68:75], v150 abid:1
buffer_store_dwordx4 v[92:95], v4, s[20:23], s46 offen offset:128 sc1
s_mov_b64 vcc, s[82:83]
ds_read_u16 v77, v77
v_cndmask_b32_dpp v104, v100, v104, vcc quad_perm:[1,0,3,2] row_mask:0xf bank_mask:0xf
v_cndmask_b32_dpp v105, v101, v105, vcc quad_perm:[1,0,3,2] row_mask:0xf bank_mask:0xf
v_smfmac_f32_16x16x64_bf16 v[24:27], a[88:91], v[60:67], v148
ds_read_b128 v[44:47], v0 offset:8192
v_add_u32_sdwa v78, s42, v127 dst_sel:DWORD dst_unused:UNUSED_PAD src0_sel:DWORD src1_sel:WORD_0
v_smfmac_f32_16x16x64_bf16 v[24:27], a[124:127], v[68:75], v152
ds_read_u16 v78, v78
v_cndmask_b32_dpp v106, v102, v106, vcc quad_perm:[1,0,3,2] row_mask:0xf bank_mask:0xf
v_smfmac_f32_16x16x64_bf16 v[28:31], a[92:95], v[60:67], v148 abid:1
ds_read_b128 v[48:51], v1 offset:8192
v_cndmask_b32_dpp v107, v103, v107, vcc quad_perm:[1,0,3,2] row_mask:0xf bank_mask:0xf
v_smfmac_f32_16x16x64_bf16 v[28:31], a[128:131], v[68:75], v152 abid:1
ds_read_b128 v[52:55], v0 offset:10240
v_add_u32_sdwa v79, s42, v127 dst_sel:DWORD dst_unused:UNUSED_PAD src0_sel:DWORD src1_sel:WORD_1
v_smfmac_f32_16x16x64_bf16 v[32:35], a[96:99], v[60:67], v149
ds_read_u16 v79, v79
v_add_u32_sdwa v80, s42, v128 dst_sel:DWORD dst_unused:UNUSED_PAD src0_sel:DWORD src1_sel:WORD_0
v_smfmac_f32_16x16x64_bf16 v[32:35], a[132:135], v[68:75], v153
ds_read_u16 v80, v80
v_add_u32_sdwa v81, s42, v128 dst_sel:DWORD dst_unused:UNUSED_PAD src0_sel:DWORD src1_sel:WORD_1
v_smfmac_f32_16x16x64_bf16 v[16:19], a[80:83], v[60:67], v147
buffer_store_dwordx4 v[104:107], v4, s[20:23], s46 offen offset:1280 sc1
s_mov_b64 vcc, s[80:81]
ds_read_b128 v[56:59], v1 offset:10240
v_add_u32_sdwa v82, s42, v129 dst_sel:DWORD dst_unused:UNUSED_PAD src0_sel:DWORD src1_sel:WORD_0
v_add_u32_sdwa v83, s42, v129 dst_sel:DWORD dst_unused:UNUSED_PAD src0_sel:DWORD src1_sel:WORD_1
v_smfmac_f32_16x16x64_bf16 v[16:19], a[116:119], v[68:75], v151
s_waitcnt lgkmcnt(9)
ds_read_b128 v[92:95], v0 offset:12288
v_add_u32_sdwa v100, s42, v130 dst_sel:DWORD dst_unused:UNUSED_PAD src0_sel:DWORD src1_sel:WORD_0
v_smfmac_f32_16x16x64_bf16 v[16:19], v[114:117], v[84:91], v180 abid:1
ds_read_u16 v81, v81
v_add_u32_sdwa v101, s42, v130 dst_sel:DWORD dst_unused:UNUSED_PAD src0_sel:DWORD src1_sel:WORD_1
v_smfmac_f32_16x16x64_bf16 v[12:15], v[114:117], v[84:91], v180
ds_read_b128 v[96:99], v1 offset:12288
v_add_u32_sdwa v102, s42, v131 dst_sel:DWORD dst_unused:UNUSED_PAD src0_sel:DWORD src1_sel:WORD_0
v_smfmac_f32_16x16x64_bf16 v[20:23], v[114:117], v[84:91], v181
ds_read_u16 v82, v82
v_add_u32_sdwa v103, s42, v131 dst_sel:DWORD dst_unused:UNUSED_PAD src0_sel:DWORD src1_sel:WORD_1
v_smfmac_f32_16x16x64_bf16 v[20:23], a[84:87], v[60:67], v147 abid:1
ds_read_u16 v100, v100
v_add_u32_sdwa v104, s42, v132 dst_sel:DWORD dst_unused:UNUSED_PAD src0_sel:DWORD src1_sel:WORD_0
v_smfmac_f32_16x16x64_bf16 v[20:23], a[120:123], v[68:75], v151 abid:1
ds_read_u16 v83, v83
v_add_u32_sdwa v105, s42, v132 dst_sel:DWORD dst_unused:UNUSED_PAD src0_sel:DWORD src1_sel:WORD_1
v_smfmac_f32_16x16x64_bf16 v[36:39], a[100:103], v[60:67], v149 abid:1
buffer_store_dwordx2 v[112:113], v5, s[20:23], s46 offen
ds_read_b128 v[114:117], v2 offset:192
v_add_u32_sdwa v106, s42, v133 dst_sel:DWORD dst_unused:UNUSED_PAD src0_sel:DWORD src1_sel:WORD_0
v_smfmac_f32_16x16x64_bf16 v[36:39], a[136:139], v[68:75], v153 abid:1
s_mov_b32 s46, s48
ds_read_u16 v101, v101
v_add_u32_sdwa v107, s42, v133 dst_sel:DWORD dst_unused:UNUSED_PAD src0_sel:DWORD src1_sel:WORD_1
v_smfmac_f32_16x16x64_bf16 v[40:43], a[104:107], v[60:67], v175
s_mov_b32 s48, s49
ds_read_u16 v102, v102
v_add_u32_sdwa v84, s42, v134 dst_sel:DWORD dst_unused:UNUSED_PAD src0_sel:DWORD src1_sel:WORD_0
v_smfmac_f32_16x16x64_bf16 v[40:43], a[140:143], v[68:75], v175 abid:1
s_waitcnt lgkmcnt(13)
ds_read_u16 v103, v103
v_add_u32_sdwa v85, s42, v134 dst_sel:DWORD dst_unused:UNUSED_PAD src0_sel:DWORD src1_sel:WORD_1
v_smfmac_f32_16x16x64_bf16 v[8:11], a[144:147], v[44:51], v154
s_waitcnt lgkmcnt(10)
ds_read_u16 v104, v104
v_add_u32_sdwa v86, s42, v135 dst_sel:DWORD dst_unused:UNUSED_PAD src0_sel:DWORD src1_sel:WORD_0
v_smfmac_f32_16x16x64_bf16 v[8:11], a[180:183], v[52:59], v158
s_waitcnt lgkmcnt(8)
ds_read_u16 v105, v105
v_add_u32_sdwa v87, s42, v135 dst_sel:DWORD dst_unused:UNUSED_PAD src0_sel:DWORD src1_sel:WORD_1
v_smfmac_f32_16x16x64_bf16 v[8:11], a[216:219], v[92:99], v162
s_add_u32 m0, s44, 0
ds_read_u16 v106, v106
v_add_u32_sdwa v88, s42, v136 dst_sel:DWORD dst_unused:UNUSED_PAD src0_sel:DWORD src1_sel:WORD_0
v_smfmac_f32_16x16x64_bf16 v[24:27], a[160:163], v[44:51], v156
buffer_load_dwordx4 v3, s[16:19], s45 offen offset:0 nt lds
v_add_u32_sdwa v89, s42, v136 dst_sel:DWORD dst_unused:UNUSED_PAD src0_sel:DWORD src1_sel:WORD_1
v_smfmac_f32_16x16x64_bf16 v[24:27], a[196:199], v[52:59], v160
s_mov_b32 s49, s50
ds_read_u16 v107, v107
v_add_u32_sdwa v90, s42, v137 dst_sel:DWORD dst_unused:UNUSED_PAD src0_sel:DWORD src1_sel:WORD_0
v_smfmac_f32_16x16x64_bf16 v[24:27], a[232:235], v[92:99], v164
s_waitcnt lgkmcnt(7)
ds_read_u16 v84, v84
v_add_u32_sdwa v91, s42, v137 dst_sel:DWORD dst_unused:UNUSED_PAD src0_sel:DWORD src1_sel:WORD_1
v_smfmac_f32_16x16x64_bf16 v[24:27], v[114:117], v[76:83], v182
s_mov_b32 s50, s45
ds_read_u16 v85, v85
v_smfmac_f32_16x16x64_bf16 v[20:23], v[114:117], v[76:83], v181 abid:1
ds_read_u16 v86, v86
v_smfmac_f32_16x16x64_bf16 v[28:31], v[114:117], v[76:83], v182 abid:1
ds_read_b128 v[114:117], v2 offset:256
v_add_u32_sdwa v76, s4, v118 dst_sel:DWORD dst_unused:UNUSED_PAD src0_sel:DWORD src1_sel:WORD_0
v_smfmac_f32_16x16x64_bf16 v[28:31], a[164:167], v[44:51], v156 abid:1
ds_read_u16 v87, v87
v_add_u32_sdwa v77, s4, v118 dst_sel:DWORD dst_unused:UNUSED_PAD src0_sel:DWORD src1_sel:WORD_1
v_smfmac_f32_16x16x64_bf16 v[28:31], a[200:203], v[52:59], v160 abid:1
ds_read_u16 v88, v88
v_add_u32_sdwa v78, s4, v119 dst_sel:DWORD dst_unused:UNUSED_PAD src0_sel:DWORD src1_sel:WORD_0
v_smfmac_f32_16x16x64_bf16 v[28:31], a[236:239], v[92:99], v164 abid:1
ds_read_b128 v[60:63], v0 offset:14336
v_add_u32_sdwa v79, s4, v119 dst_sel:DWORD dst_unused:UNUSED_PAD src0_sel:DWORD src1_sel:WORD_1
v_smfmac_f32_16x16x64_bf16 v[12:15], a[148:151], v[44:51], v154 abid:1
ds_read_u16 v89, v89
v_add_u32_sdwa v80, s4, v120 dst_sel:DWORD dst_unused:UNUSED_PAD src0_sel:DWORD src1_sel:WORD_0
v_smfmac_f32_16x16x64_bf16 v[12:15], a[184:187], v[52:59], v158 abid:1
s_add_u32 m0, s44, 3840
s_waitcnt vmcnt(6)
ds_read_b128 v[64:67], v1 offset:14336
v_add_u32_sdwa v81, s4, v120 dst_sel:DWORD dst_unused:UNUSED_PAD src0_sel:DWORD src1_sel:WORD_1
v_smfmac_f32_16x16x64_bf16 v[12:15], a[220:223], v[92:99], v162 abid:1
buffer_load_dwordx4 v3, s[16:19], s45 offen offset:256 nt lds
v_add_u32_sdwa v82, s4, v121 dst_sel:DWORD dst_unused:UNUSED_PAD src0_sel:DWORD src1_sel:WORD_0
v_smfmac_f32_16x16x64_bf16 v[32:35], a[168:171], v[44:51], v157
ds_read_b128 v[68:71], v0 offset:16384
v_add_u32_sdwa v83, s4, v121 dst_sel:DWORD dst_unused:UNUSED_PAD src0_sel:DWORD src1_sel:WORD_1
v_smfmac_f32_16x16x64_bf16 v[32:35], a[204:207], v[52:59], v161
ds_read_u16 v90, v90
v_smfmac_f32_16x16x64_bf16 v[32:35], a[240:243], v[92:99], v165
s_waitcnt lgkmcnt(7)
ds_read_b128 v[72:75], v1 offset:16384
v_add_u32 v0, s43, v0
v_smfmac_f32_16x16x64_bf16 v[32:35], v[114:117], v[100:107], v183 abid:1
ds_read_u16 v91, v91
v_add_u32 v1, s43, v1
v_smfmac_f32_16x16x64_bf16 v[28:31], v[114:117], v[100:107], v183
v_smfmac_f32_16x16x64_bf16 v[36:39], v[114:117], v[100:107], v184
ds_read_b128 v[114:117], v2 offset:320
v_smfmac_f32_16x16x64_bf16 v[36:39], a[172:175], v[44:51], v157 abid:1
s_add_u32 m0, s44, 7680
v_smfmac_f32_16x16x64_bf16 v[36:39], a[208:211], v[52:59], v161 abid:1
buffer_load_dwordx4 v3, s[16:19], s45 offen offset:512 nt lds
v_smfmac_f32_16x16x64_bf16 v[36:39], a[244:247], v[92:99], v165 abid:1
v_smfmac_f32_16x16x64_bf16 v[16:19], a[152:155], v[44:51], v155
s_add_u32 m0, s44, 11520
v_smfmac_f32_16x16x64_bf16 v[16:19], a[188:191], v[52:59], v159
buffer_load_dwordx4 v3, s[16:19], s45 offen offset:768 nt lds
v_smfmac_f32_16x16x64_bf16 v[16:19], a[224:227], v[92:99], v163
s_mov_b64 exec, s[62:63]
ds_write_b32 v0, v7 offset:18432
s_mov_b64 exec, -1
v_smfmac_f32_16x16x64_bf16 v[20:23], a[156:159], v[44:51], v155 abid:1
s_add_u32 m0, s44, s8
v_smfmac_f32_16x16x64_bf16 v[20:23], a[192:195], v[52:59], v159 abid:1
s_mov_b64 exec, s[10:11]
buffer_load_dwordx4 v3, s[16:19], s7 offen offset:896 nt lds
s_mov_b64 exec, -1
v_smfmac_f32_16x16x64_bf16 v[20:23], a[228:231], v[92:99], v163 abid:1
s_add_u32 s44, s44, s5
s_cmp_ge_u32 s44, 148480
s_cselect_b32 s44, s9, s44
v_smfmac_f32_16x16x64_bf16 v[40:43], a[176:179], v[44:51], v176
v_smfmac_f32_16x16x64_bf16 v[40:43], a[212:215], v[52:59], v176 abid:1
v_smfmac_f32_16x16x64_bf16 v[40:43], a[248:251], v[92:99], v177
s_waitcnt lgkmcnt(0)
v_smfmac_f32_16x16x64_bf16 v[40:43], v[114:117], v[84:91], v185
v_smfmac_f32_16x16x64_bf16 v[36:39], v[114:117], v[84:91], v184 abid:1
s_barrier
v_smfmac_f32_16x16x64_bf16 v[8:11], a[252:255], v[60:67], v166
s_mov_b32 s42, s4
ds_read_b32 v7, v0 offset:18432
v_smfmac_f32_16x16x64_bf16 v[8:11], v[218:221], v[68:75], v170
ds_read_b128 v[44:47], v0 offset:0
v_add_u32_sdwa v84, s42, v122 dst_sel:DWORD dst_unused:UNUSED_PAD src0_sel:DWORD src1_sel:WORD_0
v_smfmac_f32_16x16x64_bf16 v[12:15], v[186:189], v[60:67], v166 abid:1
ds_read_b128 v[48:51], v1 offset:0
v_add_u32_sdwa v85, s42, v122 dst_sel:DWORD dst_unused:UNUSED_PAD src0_sel:DWORD src1_sel:WORD_1
v_smfmac_f32_16x16x64_bf16 v[12:15], v[222:225], v[68:75], v170 abid:1
ds_read_b128 v[52:55], v0 offset:2048
v_add_u32_sdwa v86, s42, v123 dst_sel:DWORD dst_unused:UNUSED_PAD src0_sel:DWORD src1_sel:WORD_0
v_smfmac_f32_16x16x64_bf16 v[16:19], v[190:193], v[60:67], v167
ds_read_b128 v[56:59], v1 offset:2048
v_cvt_pk_bf16_f32 v92, v8, v9
v_smfmac_f32_16x16x64_bf16 v[16:19], v[226:229], v[68:75], v171
ds_read_u16 v76, v76
v_cvt_pk_bf16_f32 v93, v10, v11
v_smfmac_f32_16x16x64_bf16 v[20:23], v[194:197], v[60:67], v167 abid:1
ds_read_b128 v[8:11], v2 offset:1024
v_cvt_pk_bf16_f32 v94, v12, v13
v_smfmac_f32_16x16x64_bf16 v[20:23], v[230:233], v[68:75], v171 abid:1
ds_read_u16 v77, v77
v_cvt_pk_bf16_f32 v95, v14, v15
v_smfmac_f32_16x16x64_bf16 v[24:27], v[198:201], v[60:67], v168
ds_read_b128 v[12:15], v2 offset:1088
v_cvt_pk_bf16_f32 v96, v16, v17
v_smfmac_f32_16x16x64_bf16 v[24:27], v[234:237], v[68:75], v172
s_waitcnt lgkmcnt(8)
ds_read_u16 v78, v78
v_cvt_pk_bf16_f32 v97, v18, v19
v_readfirstlane_b32 s56, v7
v_smfmac_f32_16x16x64_bf16 v[28:31], v[202:205], v[60:67], v168 abid:1
s_lshr_b32 s60, s56, 4
ds_read_b128 v[16:19], v2 offset:1152
v_cvt_pk_bf16_f32 v98, v20, v21
v_smfmac_f32_16x16x64_bf16 v[28:31], v[238:241], v[68:75], v172 abid:1
s_mul_i32 s60, s60, 884736
ds_read_u16 v79, v79
v_cvt_pk_bf16_f32 v99, v22, v23
v_smfmac_f32_16x16x64_bf16 v[32:35], v[206:209], v[60:67], v169
s_mul_i32 s61, s56, 18432
ds_read_b128 v[20:23], v2 offset:1216
v_cvt_pk_bf16_f32 v100, v24, v25
v_smfmac_f32_16x16x64_bf16 v[32:35], v[242:245], v[68:75], v173
s_add_u32 s60, s60, s57
ds_read_u16 v80, v80
v_cvt_pk_bf16_f32 v101, v26, v27
v_smfmac_f32_16x16x64_bf16 v[36:39], v[210:213], v[60:67], v169 abid:1
s_add_u32 s45, s60, s61
ds_read_b128 v[24:27], v2 offset:1280
v_cvt_pk_bf16_f32 v102, v28, v29
v_smfmac_f32_16x16x64_bf16 v[36:39], v[246:249], v[68:75], v173 abid:1
ds_read_u16 v81, v81
v_cvt_pk_bf16_f32 v103, v30, v31
v_smfmac_f32_16x16x64_bf16 v[40:43], v[214:217], v[60:67], v177 abid:1
s_cmp_lt_u32 s56, s64
ds_read_b128 v[28:31], v2 offset:1344
v_cvt_pk_bf16_f32 v104, v32, v33
v_smfmac_f32_16x16x64_bf16 v[40:43], v[250:253], v[68:75], v178
s_waitcnt lgkmcnt(10)
v_cvt_pk_bf16_f32 v105, v34, v35
s_cbranch_scc1 L_loopck
s_mov_b32 s41, 0
s_mov_b32 s15, 3
s_mov_b32 s12, 7
s_mov_b32 s92, 4
s_mov_b32 s87, 4
s_mov_b32 s59, -1
.p2align 3
L_loopnk:
v_smfmac_f32_16x16x64_bf16 v[8:11], a[0:3], v[44:51], v138
ds_read_b128 v[32:35], v2 offset:1408
v_cvt_pk_bf16_f32 v106, v36, v37
v_smfmac_f32_16x16x64_bf16 v[8:11], a[36:39], v[52:59], v142
s_waitcnt lgkmcnt(9)
v_cvt_pk_bf16_f32 v107, v38, v39
v_smfmac_f32_16x16x64_bf16 v[12:15], a[4:7], v[44:51], v138 abid:1
ds_read_b128 v[36:39], v2 offset:1472
v_cvt_pk_bf16_f32 v112, v40, v41
v_smfmac_f32_16x16x64_bf16 v[12:15], a[40:43], v[52:59], v142 abid:1
s_waitcnt lgkmcnt(8)
ds_read_b128 v[60:63], v0 offset:4096
v_cvt_pk_bf16_f32 v113, v42, v43
v_smfmac_f32_16x16x64_bf16 v[16:19], a[8:11], v[44:51], v139
s_cmp_eq_u32 s4, 129920
ds_read_b128 v[40:43], v2 offset:1536
v_cndmask_b32_dpp v108, v96, v92, vcc quad_perm:[1,0,3,2] row_mask:0xf bank_mask:0xf
v_smfmac_f32_16x16x64_bf16 v[16:19], a[44:47], v[52:59], v143
s_waitcnt lgkmcnt(8)
ds_read_u16 v82, v82
v_cndmask_b32_dpp v109, v97, v93, vcc quad_perm:[1,0,3,2] row_mask:0xf bank_mask:0xf
v_smfmac_f32_16x16x64_bf16 v[20:23], a[12:15], v[44:51], v139 abid:1
s_cselect_b32 s43, -129920, s5
ds_read_u16 v84, v84
v_cndmask_b32_dpp v110, v98, v94, vcc quad_perm:[1,0,3,2] row_mask:0xf bank_mask:0xf
v_smfmac_f32_16x16x64_bf16 v[20:23], a[48:51], v[52:59], v143 abid:1
s_waitcnt lgkmcnt(8)
ds_read_b128 v[64:67], v1 offset:4096
v_cndmask_b32_dpp v111, v99, v95, vcc quad_perm:[1,0,3,2] row_mask:0xf bank_mask:0xf
v_smfmac_f32_16x16x64_bf16 v[24:27], a[16:19], v[44:51], v140
s_add_u32 s4, s4, s43
ds_read_b128 v[68:71], v0 offset:6144
v_add_u32_sdwa v87, s42, v123 dst_sel:DWORD dst_unused:UNUSED_PAD src0_sel:DWORD src1_sel:WORD_1
v_smfmac_f32_16x16x64_bf16 v[24:27], a[52:55], v[52:59], v144
buffer_store_dwordx4 v[108:111], v4, s[20:23], s46 offen offset:0 sc1
s_mov_b64 vcc, s[82:83]
s_waitcnt lgkmcnt(8)
ds_read_b128 v[72:75], v1 offset:6144
v_cndmask_b32_dpp v96, v92, v96, vcc quad_perm:[1,0,3,2] row_mask:0xf bank_mask:0xf
v_cndmask_b32_dpp v97, v93, v97, vcc quad_perm:[1,0,3,2] row_mask:0xf bank_mask:0xf
v_smfmac_f32_16x16x64_bf16 v[28:31], a[20:23], v[44:51], v140 abid:1
s_add_u32 s41, s41, 1
ds_read_u16 v83, v83
v_cndmask_b32_dpp v98, v94, v98, vcc quad_perm:[1,0,3,2] row_mask:0xf bank_mask:0xf
v_smfmac_f32_16x16x64_bf16 v[28:31], a[56:59], v[52:59], v144 abid:1
s_waitcnt lgkmcnt(9)
ds_read_b128 v[114:117], v2 offset:64
v_cndmask_b32_dpp v99, v95, v99, vcc quad_perm:[1,0,3,2] row_mask:0xf bank_mask:0xf
v_smfmac_f32_16x16x64_bf16 v[32:35], a[24:27], v[44:51], v141
ds_read_u16 v85, v85
v_add_u32_sdwa v88, s42, v124 dst_sel:DWORD dst_unused:UNUSED_PAD src0_sel:DWORD src1_sel:WORD_0
v_smfmac_f32_16x16x64_bf16 v[32:35], a[60:63], v[52:59], v145
s_waitcnt lgkmcnt(10)
ds_read_u16 v86, v86
v_add_u32_sdwa v89, s42, v124 dst_sel:DWORD dst_unused:UNUSED_PAD src0_sel:DWORD src1_sel:WORD_1
v_smfmac_f32_16x16x64_bf16 v[36:39], a[28:31], v[44:51], v141 abid:1
ds_read_u16 v87, v87
v_add_u32_sdwa v90, s42, v125 dst_sel:DWORD dst_unused:UNUSED_PAD src0_sel:DWORD src1_sel:WORD_0
v_smfmac_f32_16x16x64_bf16 v[36:39], a[64:67], v[52:59], v145 abid:1
s_waitcnt lgkmcnt(10)
ds_read_u16 v88, v88
v_add_u32_sdwa v91, s42, v125 dst_sel:DWORD dst_unused:UNUSED_PAD src0_sel:DWORD src1_sel:WORD_1
v_smfmac_f32_16x16x64_bf16 v[40:43], a[32:35], v[44:51], v174
buffer_store_dwordx4 v[96:99], v4, s[20:23], s46 offen offset:1152 sc1
s_mov_b64 vcc, s[80:81]
ds_read_u16 v89, v89
v_cndmask_b32_dpp v92, v104, v100, vcc quad_perm:[1,0,3,2] row_mask:0xf bank_mask:0xf
v_cndmask_b32_dpp v93, v105, v101, vcc quad_perm:[1,0,3,2] row_mask:0xf bank_mask:0xf
v_smfmac_f32_16x16x64_bf16 v[40:43], a[68:71], v[52:59], v174 abid:1
s_waitcnt lgkmcnt(9)
ds_read_u16 v90, v90
v_cndmask_b32_dpp v94, v106, v102, vcc quad_perm:[1,0,3,2] row_mask:0xf bank_mask:0xf
v_smfmac_f32_16x16x64_bf16 v[8:11], a[72:75], v[60:67], v146
s_waitcnt lgkmcnt(8)
ds_read_u16 v91, v91
v_cndmask_b32_dpp v95, v107, v103, vcc quad_perm:[1,0,3,2] row_mask:0xf bank_mask:0xf
v_smfmac_f32_16x16x64_bf16 v[8:11], a[108:111], v[68:75], v150
s_waitcnt lgkmcnt(7)
ds_bpermute_b32 v112, v6, v112
v_smfmac_f32_16x16x64_bf16 v[8:11], v[114:117], v[76:83], v179
ds_bpermute_b32 v113, v6, v113
v_smfmac_f32_16x16x64_bf16 v[12:15], v[114:117], v[76:83], v179 abid:1
ds_read_b128 v[114:117], v2 offset:128
v_add_u32_sdwa v76, s42, v126 dst_sel:DWORD dst_unused:UNUSED_PAD src0_sel:DWORD src1_sel:WORD_0
v_smfmac_f32_16x16x64_bf16 v[12:15], a[76:79], v[60:67], v146 abid:1
ds_read_u16 v76, v76
v_add_u32_sdwa v77, s42, v126 dst_sel:DWORD dst_unused:UNUSED_PAD src0_sel:DWORD src1_sel:WORD_1
v_smfmac_f32_16x16x64_bf16 v[12:15], a[112:115], v[68:75], v150 abid:1
buffer_store_dwordx4 v[92:95], v4, s[20:23], s46 offen offset:128 sc1
s_mov_b64 vcc, s[82:83]
ds_read_u16 v77, v77
v_cndmask_b32_dpp v104, v100, v104, vcc quad_perm:[1,0,3,2] row_mask:0xf bank_mask:0xf
v_cndmask_b32_dpp v105, v101, v105, vcc quad_perm:[1,0,3,2] row_mask:0xf bank_mask:0xf
v_smfmac_f32_16x16x64_bf16 v[24:27], a[88:91], v[60:67], v148
ds_read_b128 v[44:47], v0 offset:8192
v_add_u32_sdwa v78, s42, v127 dst_sel:DWORD dst_unused:UNUSED_PAD src0_sel:DWORD src1_sel:WORD_0
v_smfmac_f32_16x16x64_bf16 v[24:27], a[124:127], v[68:75], v152
ds_read_u16 v78, v78
v_cndmask_b32_dpp v106, v102, v106, vcc quad_perm:[1,0,3,2] row_mask:0xf bank_mask:0xf
v_smfmac_f32_16x16x64_bf16 v[28:31], a[92:95], v[60:67], v148 abid:1
ds_read_b128 v[48:51], v1 offset:8192
v_cndmask_b32_dpp v107, v103, v107, vcc quad_perm:[1,0,3,2] row_mask:0xf bank_mask:0xf
v_smfmac_f32_16x16x64_bf16 v[28:31], a[128:131], v[68:75], v152 abid:1
ds_read_b128 v[52:55], v0 offset:10240
v_add_u32_sdwa v79, s42, v127 dst_sel:DWORD dst_unused:UNUSED_PAD src0_sel:DWORD src1_sel:WORD_1
v_smfmac_f32_16x16x64_bf16 v[32:35], a[96:99], v[60:67], v149
ds_read_u16 v79, v79
v_add_u32_sdwa v80, s42, v128 dst_sel:DWORD dst_unused:UNUSED_PAD src0_sel:DWORD src1_sel:WORD_0
v_smfmac_f32_16x16x64_bf16 v[32:35], a[132:135], v[68:75], v153
ds_read_u16 v80, v80
v_add_u32_sdwa v81, s42, v128 dst_sel:DWORD dst_unused:UNUSED_PAD src0_sel:DWORD src1_sel:WORD_1
v_smfmac_f32_16x16x64_bf16 v[16:19], a[80:83], v[60:67], v147
buffer_store_dwordx4 v[104:107], v4, s[20:23], s46 offen offset:1280 sc1
s_mov_b64 vcc, s[80:81]
ds_read_b128 v[56:59], v1 offset:10240
v_add_u32_sdwa v82, s42, v129 dst_sel:DWORD dst_unused:UNUSED_PAD src0_sel:DWORD src1_sel:WORD_0
v_add_u32_sdwa v83, s42, v129 dst_sel:DWORD dst_unused:UNUSED_PAD src0_sel:DWORD src1_sel:WORD_1
v_smfmac_f32_16x16x64_bf16 v[16:19], a[116:119], v[68:75], v151
s_waitcnt lgkmcnt(9)
ds_read_b128 v[92:95], v0 offset:12288
v_add_u32_sdwa v100, s42, v130 dst_sel:DWORD dst_unused:UNUSED_PAD src0_sel:DWORD src1_sel:WORD_0
v_smfmac_f32_16x16x64_bf16 v[16:19], v[114:117], v[84:91], v180 abid:1
ds_read_u16 v81, v81
v_add_u32_sdwa v101, s42, v130 dst_sel:DWORD dst_unused:UNUSED_PAD src0_sel:DWORD src1_sel:WORD_1
v_smfmac_f32_16x16x64_bf16 v[12:15], v[114:117], v[84:91], v180
ds_read_b128 v[96:99], v1 offset:12288
v_add_u32_sdwa v102, s42, v131 dst_sel:DWORD dst_unused:UNUSED_PAD src0_sel:DWORD src1_sel:WORD_0
v_smfmac_f32_16x16x64_bf16 v[20:23], v[114:117], v[84:91], v181
ds_read_u16 v82, v82
v_add_u32_sdwa v103, s42, v131 dst_sel:DWORD dst_unused:UNUSED_PAD src0_sel:DWORD src1_sel:WORD_1
v_smfmac_f32_16x16x64_bf16 v[20:23], a[84:87], v[60:67], v147 abid:1
ds_read_u16 v100, v100
v_add_u32_sdwa v104, s42, v132 dst_sel:DWORD dst_unused:UNUSED_PAD src0_sel:DWORD src1_sel:WORD_0
v_smfmac_f32_16x16x64_bf16 v[20:23], a[120:123], v[68:75], v151 abid:1
ds_read_u16 v83, v83
v_add_u32_sdwa v105, s42, v132 dst_sel:DWORD dst_unused:UNUSED_PAD src0_sel:DWORD src1_sel:WORD_1
v_smfmac_f32_16x16x64_bf16 v[36:39], a[100:103], v[60:67], v149 abid:1
buffer_store_dwordx2 v[112:113], v5, s[20:23], s46 offen
ds_read_b128 v[114:117], v2 offset:192
v_add_u32_sdwa v106, s42, v133 dst_sel:DWORD dst_unused:UNUSED_PAD src0_sel:DWORD src1_sel:WORD_0
v_smfmac_f32_16x16x64_bf16 v[36:39], a[136:139], v[68:75], v153 abid:1
s_mov_b32 s22, 75497472
ds_read_u16 v101, v101
v_add_u32_sdwa v107, s42, v133 dst_sel:DWORD dst_unused:UNUSED_PAD src0_sel:DWORD src1_sel:WORD_1
v_smfmac_f32_16x16x64_bf16 v[40:43], a[104:107], v[60:67], v175
s_mov_b32 s46, s48
ds_read_u16 v102, v102
v_add_u32_sdwa v84, s42, v134 dst_sel:DWORD dst_unused:UNUSED_PAD src0_sel:DWORD src1_sel:WORD_0
v_smfmac_f32_16x16x64_bf16 v[40:43], a[140:143], v[68:75], v175 abid:1
s_waitcnt lgkmcnt(13)
ds_read_u16 v103, v103
v_add_u32_sdwa v85, s42, v134 dst_sel:DWORD dst_unused:UNUSED_PAD src0_sel:DWORD src1_sel:WORD_1
v_smfmac_f32_16x16x64_bf16 v[8:11], a[144:147], v[44:51], v154
s_waitcnt lgkmcnt(10)
ds_read_u16 v104, v104
v_add_u32_sdwa v86, s42, v135 dst_sel:DWORD dst_unused:UNUSED_PAD src0_sel:DWORD src1_sel:WORD_0
v_smfmac_f32_16x16x64_bf16 v[8:11], a[180:183], v[52:59], v158
s_waitcnt lgkmcnt(8)
ds_read_u16 v105, v105
v_add_u32_sdwa v87, s42, v135 dst_sel:DWORD dst_unused:UNUSED_PAD src0_sel:DWORD src1_sel:WORD_1
v_smfmac_f32_16x16x64_bf16 v[8:11], a[216:219], v[92:99], v162
s_mov_b32 s48, s49
ds_read_u16 v106, v106
v_add_u32_sdwa v88, s42, v136 dst_sel:DWORD dst_unused:UNUSED_PAD src0_sel:DWORD src1_sel:WORD_0
v_smfmac_f32_16x16x64_bf16 v[24:27], a[160:163], v[44:51], v156
s_mov_b32 s49, s50
s_add_u32 s50, s50, 4718592
v_add_u32_sdwa v89, s42, v136 dst_sel:DWORD dst_unused:UNUSED_PAD src0_sel:DWORD src1_sel:WORD_1
v_smfmac_f32_16x16x64_bf16 v[24:27], a[196:199], v[52:59], v160
ds_read_u16 v107, v107
v_add_u32_sdwa v90, s42, v137 dst_sel:DWORD dst_unused:UNUSED_PAD src0_sel:DWORD src1_sel:WORD_0
v_smfmac_f32_16x16x64_bf16 v[24:27], a[232:235], v[92:99], v164
s_waitcnt lgkmcnt(7)
ds_read_u16 v84, v84
v_add_u32_sdwa v91, s42, v137 dst_sel:DWORD dst_unused:UNUSED_PAD src0_sel:DWORD src1_sel:WORD_1
v_smfmac_f32_16x16x64_bf16 v[24:27], v[114:117], v[76:83], v182
ds_read_u16 v85, v85
v_smfmac_f32_16x16x64_bf16 v[20:23], v[114:117], v[76:83], v181 abid:1
ds_read_u16 v86, v86
v_smfmac_f32_16x16x64_bf16 v[28:31], v[114:117], v[76:83], v182 abid:1
ds_read_b128 v[114:117], v2 offset:256
v_add_u32_sdwa v76, s4, v118 dst_sel:DWORD dst_unused:UNUSED_PAD src0_sel:DWORD src1_sel:WORD_0
v_smfmac_f32_16x16x64_bf16 v[28:31], a[164:167], v[44:51], v156 abid:1
ds_read_u16 v87, v87
v_add_u32_sdwa v77, s4, v118 dst_sel:DWORD dst_unused:UNUSED_PAD src0_sel:DWORD src1_sel:WORD_1
v_smfmac_f32_16x16x64_bf16 v[28:31], a[200:203], v[52:59], v160 abid:1
ds_read_u16 v88, v88
v_add_u32_sdwa v78, s4, v119 dst_sel:DWORD dst_unused:UNUSED_PAD src0_sel:DWORD src1_sel:WORD_0
v_smfmac_f32_16x16x64_bf16 v[28:31], a[236:239], v[92:99], v164 abid:1
ds_read_b128 v[60:63], v0 offset:14336
v_add_u32_sdwa v79, s4, v119 dst_sel:DWORD dst_unused:UNUSED_PAD src0_sel:DWORD src1_sel:WORD_1
v_smfmac_f32_16x16x64_bf16 v[12:15], a[148:151], v[44:51], v154 abid:1
ds_read_u16 v89, v89
v_add_u32_sdwa v80, s4, v120 dst_sel:DWORD dst_unused:UNUSED_PAD src0_sel:DWORD src1_sel:WORD_0
v_smfmac_f32_16x16x64_bf16 v[12:15], a[184:187], v[52:59], v158 abid:1
ds_read_b128 v[64:67], v1 offset:14336
v_add_u32_sdwa v81, s4, v120 dst_sel:DWORD dst_unused:UNUSED_PAD src0_sel:DWORD src1_sel:WORD_1
v_smfmac_f32_16x16x64_bf16 v[12:15], a[220:223], v[92:99], v162 abid:1
v_add_u32_sdwa v82, s4, v121 dst_sel:DWORD dst_unused:UNUSED_PAD src0_sel:DWORD src1_sel:WORD_0
v_smfmac_f32_16x16x64_bf16 v[32:35], a[168:171], v[44:51], v157
ds_read_b128 v[68:71], v0 offset:16384
v_add_u32_sdwa v83, s4, v121 dst_sel:DWORD dst_unused:UNUSED_PAD src0_sel:DWORD src1_sel:WORD_1
v_smfmac_f32_16x16x64_bf16 v[32:35], a[204:207], v[52:59], v161
ds_read_u16 v90, v90
v_smfmac_f32_16x16x64_bf16 v[32:35], a[240:243], v[92:99], v165
s_waitcnt lgkmcnt(7)
ds_read_b128 v[72:75], v1 offset:16384
v_add_u32 v0, s43, v0
v_smfmac_f32_16x16x64_bf16 v[32:35], v[114:117], v[100:107], v183 abid:1
ds_read_u16 v91, v91
v_add_u32 v1, s43, v1
v_smfmac_f32_16x16x64_bf16 v[28:31], v[114:117], v[100:107], v183
v_smfmac_f32_16x16x64_bf16 v[36:39], v[114:117], v[100:107], v184
ds_read_b128 v[114:117], v2 offset:320
v_smfmac_f32_16x16x64_bf16 v[36:39], a[172:175], v[44:51], v157 abid:1
v_smfmac_f32_16x16x64_bf16 v[36:39], a[208:211], v[52:59], v161 abid:1
v_smfmac_f32_16x16x64_bf16 v[36:39], a[244:247], v[92:99], v165 abid:1
v_smfmac_f32_16x16x64_bf16 v[16:19], a[152:155], v[44:51], v155
v_smfmac_f32_16x16x64_bf16 v[16:19], a[188:191], v[52:59], v159
v_smfmac_f32_16x16x64_bf16 v[16:19], a[224:227], v[92:99], v163
v_smfmac_f32_16x16x64_bf16 v[20:23], a[156:159], v[44:51], v155 abid:1
v_smfmac_f32_16x16x64_bf16 v[20:23], a[192:195], v[52:59], v159 abid:1
v_smfmac_f32_16x16x64_bf16 v[20:23], a[228:231], v[92:99], v163 abid:1
v_smfmac_f32_16x16x64_bf16 v[40:43], a[176:179], v[44:51], v176
s_bitcmp1_b32 s92, s41
v_smfmac_f32_16x16x64_bf16 v[40:43], a[212:215], v[52:59], v176 abid:1
s_cbranch_scc1 L_loopnk_w
L_loopnk_wb:
v_smfmac_f32_16x16x64_bf16 v[40:43], a[248:251], v[92:99], v177
s_waitcnt lgkmcnt(0)
v_smfmac_f32_16x16x64_bf16 v[40:43], v[114:117], v[84:91], v185
v_smfmac_f32_16x16x64_bf16 v[36:39], v[114:117], v[84:91], v184 abid:1
s_waitcnt vmcnt(20)
s_barrier
L_loopnk_p3:
v_smfmac_f32_16x16x64_bf16 v[8:11], a[252:255], v[60:67], v166
s_mov_b32 s42, s4
v_smfmac_f32_16x16x64_bf16 v[8:11], v[218:221], v[68:75], v170
ds_read_b128 v[44:47], v0 offset:0
v_add_u32_sdwa v84, s42, v122 dst_sel:DWORD dst_unused:UNUSED_PAD src0_sel:DWORD src1_sel:WORD_0
v_smfmac_f32_16x16x64_bf16 v[12:15], v[186:189], v[60:67], v166 abid:1
ds_read_b128 v[48:51], v1 offset:0
v_add_u32_sdwa v85, s42, v122 dst_sel:DWORD dst_unused:UNUSED_PAD src0_sel:DWORD src1_sel:WORD_1
v_smfmac_f32_16x16x64_bf16 v[12:15], v[222:225], v[68:75], v170 abid:1
ds_read_b128 v[52:55], v0 offset:2048
v_add_u32_sdwa v86, s42, v123 dst_sel:DWORD dst_unused:UNUSED_PAD src0_sel:DWORD src1_sel:WORD_0
v_smfmac_f32_16x16x64_bf16 v[16:19], v[190:193], v[60:67], v167
ds_read_b128 v[56:59], v1 offset:2048
v_cvt_pk_bf16_f32 v92, v8, v9
v_smfmac_f32_16x16x64_bf16 v[16:19], v[226:229], v[68:75], v171
ds_read_u16 v76, v76
v_cvt_pk_bf16_f32 v93, v10, v11
v_smfmac_f32_16x16x64_bf16 v[20:23], v[194:197], v[60:67], v167 abid:1
ds_read_b128 v[8:11], v2 offset:1024
v_cvt_pk_bf16_f32 v94, v12, v13
v_smfmac_f32_16x16x64_bf16 v[20:23], v[230:233], v[68:75], v171 abid:1
ds_read_u16 v77, v77
v_cvt_pk_bf16_f32 v95, v14, v15
v_smfmac_f32_16x16x64_bf16 v[24:27], v[198:201], v[60:67], v168
ds_read_b128 v[12:15], v2 offset:1088
v_cvt_pk_bf16_f32 v96, v16, v17
v_smfmac_f32_16x16x64_bf16 v[24:27], v[234:237], v[68:75], v172
ds_read_u16 v78, v78
v_cvt_pk_bf16_f32 v97, v18, v19
v_smfmac_f32_16x16x64_bf16 v[28:31], v[202:205], v[60:67], v168 abid:1
ds_read_b128 v[16:19], v2 offset:1152
v_cvt_pk_bf16_f32 v98, v20, v21
v_smfmac_f32_16x16x64_bf16 v[28:31], v[238:241], v[68:75], v172 abid:1
ds_read_u16 v79, v79
v_cvt_pk_bf16_f32 v99, v22, v23
v_smfmac_f32_16x16x64_bf16 v[32:35], v[206:209], v[60:67], v169
ds_read_b128 v[20:23], v2 offset:1216
v_cvt_pk_bf16_f32 v100, v24, v25
v_smfmac_f32_16x16x64_bf16 v[32:35], v[242:245], v[68:75], v173
ds_read_u16 v80, v80
v_cvt_pk_bf16_f32 v101, v26, v27
v_smfmac_f32_16x16x64_bf16 v[36:39], v[210:213], v[60:67], v169 abid:1
ds_read_b128 v[24:27], v2 offset:1280
v_cvt_pk_bf16_f32 v102, v28, v29
v_smfmac_f32_16x16x64_bf16 v[36:39], v[246:249], v[68:75], v173 abid:1
ds_read_u16 v81, v81
v_cvt_pk_bf16_f32 v103, v30, v31
v_smfmac_f32_16x16x64_bf16 v[40:43], v[214:217], v[60:67], v177 abid:1
s_bitcmp1_b32 s12, s41
ds_read_b128 v[28:31], v2 offset:1344
v_cvt_pk_bf16_f32 v104, v32, v33
v_smfmac_f32_16x16x64_bf16 v[40:43], v[250:253], v[68:75], v178
s_waitcnt lgkmcnt(10)
v_cvt_pk_bf16_f32 v105, v34, v35
s_cbranch_scc1 L_loopnk
s_cmp_eq_u32 s41, s59
s_cbranch_scc1 L_loopck
s_cmp_lt_u32 s41, s15
s_cbranch_scc1 L_loopk
s_nop 0
v_cndmask_b32_dpp v108, v96, v92, vcc quad_perm:[1,0,3,2] row_mask:0xf bank_mask:0xf
v_cndmask_b32_dpp v109, v97, v93, vcc quad_perm:[1,0,3,2] row_mask:0xf bank_mask:0xf
v_cndmask_b32_dpp v110, v98, v94, vcc quad_perm:[1,0,3,2] row_mask:0xf bank_mask:0xf
v_cndmask_b32_dpp v111, v99, v95, vcc quad_perm:[1,0,3,2] row_mask:0xf bank_mask:0xf
buffer_store_dwordx4 v[108:111], v4, s[20:23], s46 offen offset:0 sc1
s_mov_b64 vcc, s[82:83]
v_cvt_pk_bf16_f32 v112, v40, v41
v_cvt_pk_bf16_f32 v113, v42, v43
ds_bpermute_b32 v112, v6, v112
ds_bpermute_b32 v113, v6, v113
v_cndmask_b32_dpp v96, v92, v96, vcc quad_perm:[1,0,3,2] row_mask:0xf bank_mask:0xf
v_cndmask_b32_dpp v97, v93, v97, vcc quad_perm:[1,0,3,2] row_mask:0xf bank_mask:0xf
v_cndmask_b32_dpp v98, v94, v98, vcc quad_perm:[1,0,3,2] row_mask:0xf bank_mask:0xf
v_cndmask_b32_dpp v99, v95, v99, vcc quad_perm:[1,0,3,2] row_mask:0xf bank_mask:0xf
buffer_store_dwordx4 v[96:99], v4, s[20:23], s46 offen offset:1152 sc1
s_mov_b64 vcc, s[80:81]
v_cvt_pk_bf16_f32 v106, v36, v37
v_cvt_pk_bf16_f32 v107, v38, v39
v_cndmask_b32_dpp v92, v104, v100, vcc quad_perm:[1,0,3,2] row_mask:0xf bank_mask:0xf
v_cndmask_b32_dpp v93, v105, v101, vcc quad_perm:[1,0,3,2] row_mask:0xf bank_mask:0xf
v_cndmask_b32_dpp v94, v106, v102, vcc quad_perm:[1,0,3,2] row_mask:0xf bank_mask:0xf
v_cndmask_b32_dpp v95, v107, v103, vcc quad_perm:[1,0,3,2] row_mask:0xf bank_mask:0xf
buffer_store_dwordx4 v[92:95], v4, s[20:23], s46 offen offset:128 sc1
s_mov_b64 vcc, s[82:83]
v_cndmask_b32_dpp v104, v100, v104, vcc quad_perm:[1,0,3,2] row_mask:0xf bank_mask:0xf
v_cndmask_b32_dpp v105, v101, v105, vcc quad_perm:[1,0,3,2] row_mask:0xf bank_mask:0xf
v_cndmask_b32_dpp v106, v102, v106, vcc quad_perm:[1,0,3,2] row_mask:0xf bank_mask:0xf
v_cndmask_b32_dpp v107, v103, v107, vcc quad_perm:[1,0,3,2] row_mask:0xf bank_mask:0xf
buffer_store_dwordx4 v[104:107], v4, s[20:23], s46 offen offset:1280 sc1
s_mov_b64 vcc, s[80:81]
s_waitcnt lgkmcnt(0)
buffer_store_dwordx2 v[112:113], v5, s[20:23], s46 offen
s_branch L_fin
L_loopk_w:
s_bitcmp1_b32 s87, s41
s_waitcnt vmcnt(15)
s_cbranch_scc0 L_loopk_wb
s_waitcnt vmcnt(10)
s_branch L_loopk_wb
L_loopnk_w:
s_bitcmp1_b32 s87, s41
s_waitcnt vmcnt(15)
s_cbranch_scc0 L_loopnk_wb
s_waitcnt vmcnt(10)
s_branch L_loopnk_wb
L_slow:
s_waitcnt vmcnt(0) lgkmcnt(0)
s_mov_b32 s87, 0
L_sm:
s_lshl_b32 s86, s2, 1
s_add_u32 s86, s86, s87
s_add_u32 s86, s86, 2
s_mul_i32 s86, s86, 393216
s_mov_b32 s84, 0
L_st:
s_and_b32 s48, s84, 3
s_lshr_b32 s49, s84, 2
s_sub_u32 s50, s84, 36
s_lshl_b32 s51, s40, 4
s_lshl_b32 s52, s50, 1
s_lshl_b32 s53, s48, 8
s_cmp_lt_u32 s84, 36
s_cselect_b32 s52, s49, s52
s_cselect_b32 s53, s53, 1024
s_cselect_b32 s54, 8, 73728
s_cselect_b32 s55, 32, 8
s_cselect_b32 s56, 16, 32
s_cselect_b32 s57, 128, 64
s_mul_i32 s52, s52, 73728
s_mul_i32 s58, s40, 18432
v_and_b32 v58, 1, v7
v_bfe_u32 v59, v7, 1, 1
v_bfe_u32 v60, v7, 2, 2
v_bfe_u32 v62, v7, 4, 1
v_lshrrev_b32 v63, 5, v7
v_lshl_add_u32 v50, v58, 2, s52
v_mad_u32_u24 v50, v59, s54, v50
v_mad_u32_u24 v50, v60, s55, v50
v_mad_u32_u24 v50, v62, s56, v50
v_mad_u32_u24 v50, v63, s57, v50
v_add_u32 v50, s53, v50
v_add_u32 v50, s58, v50
v_add_u32 v62, 4608, v50
v_add_u32 v63, 9216, v50
v_add_u32 v64, 13824, v50
buffer_load_dword v8, v50, s[28:31], 0 offen offset:0
buffer_load_dword v9, v50, s[28:31], 0 offen offset:1152
buffer_load_dword v10, v50, s[28:31], 0 offen offset:2304
buffer_load_dword v11, v50, s[28:31], 0 offen offset:3456
buffer_load_dword v12, v62, s[28:31], 0 offen offset:0
buffer_load_dword v13, v62, s[28:31], 0 offen offset:1152
buffer_load_dword v14, v62, s[28:31], 0 offen offset:2304
buffer_load_dword v15, v62, s[28:31], 0 offen offset:3456
buffer_load_dword v16, v63, s[28:31], 0 offen offset:0
buffer_load_dword v17, v63, s[28:31], 0 offen offset:1152
buffer_load_dword v18, v63, s[28:31], 0 offen offset:2304
buffer_load_dword v19, v63, s[28:31], 0 offen offset:3456
buffer_load_dword v20, v64, s[28:31], 0 offen offset:0
buffer_load_dword v21, v64, s[28:31], 0 offen offset:1152
buffer_load_dword v22, v64, s[28:31], 0 offen offset:2304
buffer_load_dword v23, v64, s[28:31], 0 offen offset:3456
s_mul_i32 s52, s48, 9
s_add_u32 s52, s52, s49
s_mul_i32 s53, s52, 9
s_mul_i32 s54, s50, 18
s_add_u32 s54, s54, 8
s_lshl_b32 s55, s52, 2
s_add_u32 s55, s55, s40
s_lshl_b32 s56, s50, 2
s_add_u32 s56, s56, s40
s_cmp_eq_u32 s84, 40
s_cselect_b32 s57, 0x100000, 9
s_cmp_lt_u32 s84, 36
s_cselect_b32 s53, s53, s54
s_cselect_b32 s54, 2, 81
s_cselect_b32 s57, 1, s57
s_cselect_b32 s55, s55, s56
s_mov_b32 s56, 331776
s_cselect_b32 s56, s56, 368640
s_mov_b32 s58, 373760
s_cselect_b32 s58, s58, 382976
s_cselect_b32 s59, 16, 4
s_cselect_b32 s60, 4, 64
s_cselect_b32 s61, 12, 11
s_cselect_b32 s62, 1, 0x8001
v_lshrrev_b32 v61, 4, v7
v_lshlrev_b32 v62, 1, v58
v_lshl_add_u32 v60, v60, 2, v62
v_add_u32 v62, v60, v59
v_mul_u32_u24 v51, s54, v61
v_add_lshl_u32 v51, v51, s53, 6
v_add3_u32 v51, v51, v62, s51
v_lshl_add_u32 v51, v51, 4, s86
s_lshl_b32 s57, s57, 10
v_add_u32 v66, s57, v51
s_lshl_b32 s52, s55, 8
s_add_u32 s52, s52, s56
s_add_u32 s52, s52, s86
v_mul_u32_u24 v52, s59, v62
v_mad_u32_u24 v52, v61, s60, v52
v_lshl_add_u32 v54, v7, 2, s52
v_mov_b32 v55, 0x05040100
v_mov_b32 v62, 0x03020706
v_cmp_eq_u32 vcc, 1, v59
v_mov_b32 v68, 0xf0a0500
v_mov_b32 v69, 0x8f8a8580
v_mov_b32 v70, 0x1f1a1510
v_mov_b32 v71, 0x9f9a9590
v_mov_b32 v72, 0x2f2a2520
v_mov_b32 v73, 0xafaaa5a0
v_mov_b32 v74, 0x3f3a3530
v_mov_b32 v75, 0xbfbab5b0
v_cndmask_b32 v55, v55, v62, vcc
s_mov_b32 s64, 0x5040500
s_mov_b32 s65, 0x5040501
s_mov_b32 s66, 0x5040502
s_mov_b32 s67, 0x5040503
s_mov_b32 s68, 0x7060700
s_mov_b32 s69, 0x7060701
s_mov_b32 s70, 0x7060702
s_mov_b32 s71, 0x7060703
s_mov_b32 s72, 0x05060102
s_cmp_lg_u32 s87, 0
s_waitcnt vmcnt(12)
v_perm_b32 v24, v8, v68, s64
v_perm_b32 v25, v9, v68, s65
v_perm_b32 v26, v10, v68, s66
v_perm_b32 v27, v11, v68, s67
v_max3_f32 v28, |v24|, |v25|, |v26|
v_med3_f32 v29, |v24|, |v25|, |v26|
v_min3_f32 v30, |v24|, |v25|, |v26|
v_med3_f32 v32, v28, v29, |v27|
v_med3_f32 v33, v29, v30, |v27|
v_max_f32 v31, v28, |v27|
v_cmp_eq_u32_sdwa vcc, v33, v32 src0_sel:WORD_1 src1_sel:WORD_1
s_cbranch_scc0 L_rb0g
v_min_f32 v30, v30, |v27|
v_cndmask_b32 v31, 0, v33, vcc
v_cmp_eq_u32_sdwa vcc, v30, v32 src0_sel:WORD_1 src1_sel:WORD_1
s_nop 1
v_cndmask_b32 v32, 0, v30, vcc
L_rb0g:
v_perm_b32 v36, v31, v32, s72
v_bfi_b32 v44, 3, v32, v31
v_perm_b32 v24, v8, v69, s68
v_perm_b32 v25, v9, v69, s69
v_perm_b32 v26, v10, v69, s70
v_perm_b32 v27, v11, v69, s71
v_max3_f32 v28, |v24|, |v25|, |v26|
v_med3_f32 v29, |v24|, |v25|, |v26|
v_min3_f32 v30, |v24|, |v25|, |v26|
v_med3_f32 v32, v28, v29, |v27|
v_med3_f32 v33, v29, v30, |v27|
v_max_f32 v31, v28, |v27|
v_cmp_eq_u32_sdwa vcc, v33, v32 src0_sel:WORD_1 src1_sel:WORD_1
s_cbranch_scc0 L_rb1g
v_min_f32 v30, v30, |v27|
v_cndmask_b32 v31, 0, v33, vcc
v_cmp_eq_u32_sdwa vcc, v30, v32 src0_sel:WORD_1 src1_sel:WORD_1
s_nop 1
v_cndmask_b32 v32, 0, v30, vcc
L_rb1g:
v_perm_b32 v40, v31, v32, s72
v_bfi_b32 v46, 3, v32, v31
s_waitcnt vmcnt(8)
v_perm_b32 v24, v12, v70, s64
v_perm_b32 v25, v13, v70, s65
v_perm_b32 v26, v14, v70, s66
v_perm_b32 v27, v15, v70, s67
v_max3_f32 v28, |v24|, |v25|, |v26|
v_med3_f32 v29, |v24|, |v25|, |v26|
v_min3_f32 v30, |v24|, |v25|, |v26|
v_med3_f32 v32, v28, v29, |v27|
v_med3_f32 v33, v29, v30, |v27|
v_max_f32 v31, v28, |v27|
v_cmp_eq_u32_sdwa vcc, v33, v32 src0_sel:WORD_1 src1_sel:WORD_1
s_cbranch_scc0 L_rb2g
v_min_f32 v30, v30, |v27|
v_cndmask_b32 v31, 0, v33, vcc
v_cmp_eq_u32_sdwa vcc, v30, v32 src0_sel:WORD_1 src1_sel:WORD_1
s_nop 1
v_cndmask_b32 v32, 0, v30, vcc
L_rb2g:
v_perm_b32 v37, v31, v32, s72
v_bfi_b32 v31, 3, v32, v31
v_lshlrev_b32 v31, 4, v31
v_bfi_b32 v44, 15, v44, v31
v_perm_b32 v24, v12, v71, s68
v_perm_b32 v25, v13, v71, s69
v_perm_b32 v26, v14, v71, s70
v_perm_b32 v27, v15, v71, s71
v_max3_f32 v28, |v24|, |v25|, |v26|
v_med3_f32 v29, |v24|, |v25|, |v26|
v_min3_f32 v30, |v24|, |v25|, |v26|
v_med3_f32 v32, v28, v29, |v27|
v_med3_f32 v33, v29, v30, |v27|
v_max_f32 v31, v28, |v27|
v_cmp_eq_u32_sdwa vcc, v33, v32 src0_sel:WORD_1 src1_sel:WORD_1
s_cbranch_scc0 L_rb3g
v_min_f32 v30, v30, |v27|
v_cndmask_b32 v31, 0, v33, vcc
v_cmp_eq_u32_sdwa vcc, v30, v32 src0_sel:WORD_1 src1_sel:WORD_1
s_nop 1
v_cndmask_b32 v32, 0, v30, vcc
L_rb3g:
v_perm_b32 v41, v31, v32, s72
v_bfi_b32 v31, 3, v32, v31
v_lshlrev_b32 v31, 4, v31
v_bfi_b32 v46, 15, v46, v31
s_waitcnt vmcnt(4)
v_perm_b32 v24, v16, v72, s64
v_perm_b32 v25, v17, v72, s65
v_perm_b32 v26, v18, v72, s66
v_perm_b32 v27, v19, v72, s67
v_max3_f32 v28, |v24|, |v25|, |v26|
v_med3_f32 v29, |v24|, |v25|, |v26|
v_min3_f32 v30, |v24|, |v25|, |v26|
v_med3_f32 v32, v28, v29, |v27|
v_med3_f32 v33, v29, v30, |v27|
v_max_f32 v31, v28, |v27|
v_cmp_eq_u32_sdwa vcc, v33, v32 src0_sel:WORD_1 src1_sel:WORD_1
s_cbranch_scc0 L_rb4g
v_min_f32 v30, v30, |v27|
v_cndmask_b32 v31, 0, v33, vcc
v_cmp_eq_u32_sdwa vcc, v30, v32 src0_sel:WORD_1 src1_sel:WORD_1
s_nop 1
v_cndmask_b32 v32, 0, v30, vcc
L_rb4g:
v_perm_b32 v38, v31, v32, s72
v_bfi_b32 v45, 3, v32, v31
v_perm_b32 v24, v16, v73, s68
v_perm_b32 v25, v17, v73, s69
v_perm_b32 v26, v18, v73, s70
v_perm_b32 v27, v19, v73, s71
v_max3_f32 v28, |v24|, |v25|, |v26|
v_med3_f32 v29, |v24|, |v25|, |v26|
v_min3_f32 v30, |v24|, |v25|, |v26|
v_med3_f32 v32, v28, v29, |v27|
v_med3_f32 v33, v29, v30, |v27|
v_max_f32 v31, v28, |v27|
v_cmp_eq_u32_sdwa vcc, v33, v32 src0_sel:WORD_1 src1_sel:WORD_1
s_cbranch_scc0 L_rb5g
v_min_f32 v30, v30, |v27|
v_cndmask_b32 v31, 0, v33, vcc
v_cmp_eq_u32_sdwa vcc, v30, v32 src0_sel:WORD_1 src1_sel:WORD_1
s_nop 1
v_cndmask_b32 v32, 0, v30, vcc
L_rb5g:
v_perm_b32 v42, v31, v32, s72
v_bfi_b32 v47, 3, v32, v31
s_waitcnt vmcnt(0)
v_perm_b32 v24, v20, v74, s64
v_perm_b32 v25, v21, v74, s65
v_perm_b32 v26, v22, v74, s66
v_perm_b32 v27, v23, v74, s67
v_max3_f32 v28, |v24|, |v25|, |v26|
v_med3_f32 v29, |v24|, |v25|, |v26|
v_min3_f32 v30, |v24|, |v25|, |v26|
v_med3_f32 v32, v28, v29, |v27|
v_med3_f32 v33, v29, v30, |v27|
v_max_f32 v31, v28, |v27|
v_cmp_eq_u32_sdwa vcc, v33, v32 src0_sel:WORD_1 src1_sel:WORD_1
s_cbranch_scc0 L_rb6g
v_min_f32 v30, v30, |v27|
v_cndmask_b32 v31, 0, v33, vcc
v_cmp_eq_u32_sdwa vcc, v30, v32 src0_sel:WORD_1 src1_sel:WORD_1
s_nop 1
v_cndmask_b32 v32, 0, v30, vcc
L_rb6g:
v_perm_b32 v39, v31, v32, s72
v_bfi_b32 v31, 3, v32, v31
v_lshlrev_b32 v31, 4, v31
v_bfi_b32 v45, 15, v45, v31
v_perm_b32 v24, v20, v75, s68
v_perm_b32 v25, v21, v75, s69
v_perm_b32 v26, v22, v75, s70
v_perm_b32 v27, v23, v75, s71
v_max3_f32 v28, |v24|, |v25|, |v26|
v_med3_f32 v29, |v24|, |v25|, |v26|
v_min3_f32 v30, |v24|, |v25|, |v26|
v_med3_f32 v32, v28, v29, |v27|
v_med3_f32 v33, v29, v30, |v27|
v_max_f32 v31, v28, |v27|
v_cmp_eq_u32_sdwa vcc, v33, v32 src0_sel:WORD_1 src1_sel:WORD_1
s_cbranch_scc0 L_rb7g
v_min_f32 v30, v30, |v27|
v_cndmask_b32 v31, 0, v33, vcc
v_cmp_eq_u32_sdwa vcc, v30, v32 src0_sel:WORD_1 src1_sel:WORD_1
s_nop 1
v_cndmask_b32 v32, 0, v30, vcc
L_rb7g:
v_perm_b32 v43, v31, v32, s72
v_bfi_b32 v31, 3, v32, v31
v_lshlrev_b32 v31, 4, v31
v_bfi_b32 v47, 15, v47, v31
s_mov_b32 vcc_lo, 0x33333333
s_mov_b32 vcc_hi, 0x33333333
v_cndmask_b32_dpp v24, v40, v36, vcc quad_perm:[2,3,0,1] row_mask:0xf bank_mask:0xf
v_cndmask_b32_dpp v25, v41, v37, vcc quad_perm:[2,3,0,1] row_mask:0xf bank_mask:0xf
v_cndmask_b32_dpp v26, v42, v38, vcc quad_perm:[2,3,0,1] row_mask:0xf bank_mask:0xf
v_cndmask_b32_dpp v27, v43, v39, vcc quad_perm:[2,3,0,1] row_mask:0xf bank_mask:0xf
s_not_b64 vcc, vcc
buffer_store_dwordx4 v[24:27], v51, s[24:27], 0 offen sc1
v_cndmask_b32_dpp v40, v36, v40, vcc quad_perm:[2,3,0,1] row_mask:0xf bank_mask:0xf
v_cndmask_b32_dpp v41, v37, v41, vcc quad_perm:[2,3,0,1] row_mask:0xf bank_mask:0xf
v_cndmask_b32_dpp v42, v38, v42, vcc quad_perm:[2,3,0,1] row_mask:0xf bank_mask:0xf
v_cndmask_b32_dpp v43, v39, v43, vcc quad_perm:[2,3,0,1] row_mask:0xf bank_mask:0xf
s_mov_b32 s52, 0x0c0c0400
s_mov_b32 s53, 0x04000c0c
buffer_store_dwordx4 v[40:43], v66, s[24:27], 0 offen sc1
v_perm_b32 v48, v45, v44, s52
v_perm_b32 v49, v47, v46, s53
v_or_b32 v48, v48, v49
s_nop 1
v_mov_b32_dpp v49, v48 quad_perm:[2,3,0,1] row_mask:0xf bank_mask:0xf
v_perm_b32 v48, v49, v48, v55
ds_permute_b32 v48, v52, v48
s_waitcnt lgkmcnt(0)
buffer_store_dword v48, v54, s[24:27], 0 offen sc1
s_waitcnt vmcnt(0)
s_add_u32 s84, s84, 1
s_cmp_lt_u32 s84, 41
s_cbranch_scc1 L_st
s_add_u32 s87, s87, 1
s_cmp_lt_u32 s87, 2
s_cbranch_scc1 L_sm
v_lshrrev_b32 v72, 3, v7
v_and_b32 v73, 7, v7
v_xor_b32 v73, v73, v72
v_mul_u32_u24 v72, 1152, v72
s_and_b32 s47, s40, 1
s_mul_i32 s47, s47, 9216
s_lshr_b32 s3, s40, 1
s_lshl_b32 s3, s3, 7
s_add_u32 s47, s47, s3
v_lshl_add_u32 v72, v73, 4, v72
v_add_u32 v3, s47, v72
s_lshl_b32 s44, s40, 10
s_mul_i32 s45, s2, 18432
s_mov_b32 s46, s45
s_lshr_b32 s47, s40, 1
s_lshl_b32 s3, s47, 11
s_sub_u32 s8, 15488, s3
s_lshl_b32 s3, s47, 7
s_add_u32 s7, s45, 128
s_sub_u32 s7, s7, s3
s_sub_u32 s10, s47, 1
s_sub_u32 s11, 0, s47
s_mov_b32 s9, s44
s_mov_b32 s13, 4718592
s_mov_b32 s15, 16
s_mov_b32 s14, s13
s_mov_b32 s22, 75497472
s_mov_b32 s18, 75497472
s_mov_b32 s41, 0
s_bitcmp1_b32 s2, 0
s_cselect_b32 s15, 16, 22
L_stile:
s_barrier
s_add_u32 m0, s44, 0
s_nop 0
buffer_load_dwordx4 v3, s[16:19], s45 offen offset:0 nt lds
s_add_u32 m0, s44, 3840
s_nop 0
buffer_load_dwordx4 v3, s[16:19], s45 offen offset:256 nt lds
s_add_u32 m0, s44, 7680
s_nop 0
buffer_load_dwordx4 v3, s[16:19], s45 offen offset:512 nt lds
s_add_u32 m0, s44, 11520
s_nop 0
buffer_load_dwordx4 v3, s[16:19], s45 offen offset:768 nt lds
s_add_u32 m0, s44, s8
s_mov_b64 exec, s[10:11]
buffer_load_dwordx4 v3, s[16:19], s7 offen offset:896 nt lds
s_mov_b64 exec, -1
ds_read_b128 v[8:11], v2 offset:1024
ds_read_b128 v[12:15], v2 offset:1088
ds_read_b128 v[16:19], v2 offset:1152
ds_read_b128 v[20:23], v2 offset:1216
ds_read_b128 v[24:27], v2 offset:1280
ds_read_b128 v[28:31], v2 offset:1344
ds_read_b128 v[32:35], v2 offset:1408
ds_read_b128 v[36:39], v2 offset:1472
ds_read_b128 v[40:43], v2 offset:1536
s_mov_b32 s87, 0
L_spass:
s_lshl_b32 s86, s2, 1
s_add_u32 s86, s86, s87
s_add_u32 s86, s86, 2
s_mul_i32 s86, s86, 393216
s_mul_i32 s47, s40, 82944
s_add_u32 s47, s47, s86
v_lshl_add_u32 v104, v7, 4, s47
s_mul_i32 s47, s40, 9216
s_add_u32 s47, s47, s86
s_add_u32 s47, s47, 331776
v_lshl_add_u32 v105, v7, 4, s47
s_lshl_b32 s47, s40, 6
s_add_u32 s47, s47, s86
s_add_u32 s47, s47, 368640
v_and_b32 v106, 15, v7
v_lshl_add_u32 v106, v106, 2, s47
v_lshrrev_b32 v107, 4, v7
v_lshl_add_u32 v106, v107, 8, v106
buffer_load_dword v174, v106, s[24:27], 0 offen offset:0 sc1
buffer_load_dword v175, v106, s[24:27], 0 offen offset:1024 sc1
buffer_load_dword v176, v106, s[24:27], 0 offen offset:2048 sc1
buffer_load_dword v177, v106, s[24:27], 0 offen offset:3072 sc1
s_mov_b32 s99, 4096
buffer_load_dword v178, v106, s[24:27], s99 offen offset:0 sc1
s_mov_b32 s98, 0
buffer_load_dwordx4 v[138:141], v105, s[24:27], s98 offen sc1
s_mov_b32 s99, 0
buffer_load_dwordx4 a[0:3], v104, s[24:27], s99 offen offset:0 sc1
buffer_load_dwordx4 a[4:7], v104, s[24:27], s99 offen offset:1024 sc1
buffer_load_dwordx4 a[8:11], v104, s[24:27], s99 offen offset:2048 sc1
buffer_load_dwordx4 a[12:15], v104, s[24:27], s99 offen offset:3072 sc1
s_mov_b32 s99, 4096
buffer_load_dwordx4 a[16:19], v104, s[24:27], s99 offen offset:0 sc1
buffer_load_dwordx4 a[20:23], v104, s[24:27], s99 offen offset:1024 sc1
buffer_load_dwordx4 a[24:27], v104, s[24:27], s99 offen offset:2048 sc1
buffer_load_dwordx4 a[28:31], v104, s[24:27], s99 offen offset:3072 sc1
s_mov_b32 s99, 8192
buffer_load_dwordx4 a[32:35], v104, s[24:27], s99 offen offset:0 sc1
s_mov_b32 s98, 1024
buffer_load_dwordx4 v[142:145], v105, s[24:27], s98 offen sc1
buffer_load_dwordx4 a[36:39], v104, s[24:27], s99 offen offset:1024 sc1
buffer_load_dwordx4 a[40:43], v104, s[24:27], s99 offen offset:2048 sc1
buffer_load_dwordx4 a[44:47], v104, s[24:27], s99 offen offset:3072 sc1
s_mov_b32 s99, 12288
buffer_load_dwordx4 a[48:51], v104, s[24:27], s99 offen offset:0 sc1
buffer_load_dwordx4 a[52:55], v104, s[24:27], s99 offen offset:1024 sc1
buffer_load_dwordx4 a[56:59], v104, s[24:27], s99 offen offset:2048 sc1
buffer_load_dwordx4 a[60:63], v104, s[24:27], s99 offen offset:3072 sc1
s_mov_b32 s99, 16384
buffer_load_dwordx4 a[64:67], v104, s[24:27], s99 offen offset:0 sc1
buffer_load_dwordx4 a[68:71], v104, s[24:27], s99 offen offset:1024 sc1
s_mov_b32 s98, 2048
buffer_load_dwordx4 v[146:149], v105, s[24:27], s98 offen sc1
buffer_load_dwordx4 a[72:75], v104, s[24:27], s99 offen offset:2048 sc1
buffer_load_dwordx4 a[76:79], v104, s[24:27], s99 offen offset:3072 sc1
s_mov_b32 s99, 20480
buffer_load_dwordx4 a[80:83], v104, s[24:27], s99 offen offset:0 sc1
buffer_load_dwordx4 a[84:87], v104, s[24:27], s99 offen offset:1024 sc1
buffer_load_dwordx4 a[88:91], v104, s[24:27], s99 offen offset:2048 sc1
buffer_load_dwordx4 a[92:95], v104, s[24:27], s99 offen offset:3072 sc1
s_mov_b32 s99, 24576
buffer_load_dwordx4 a[96:99], v104, s[24:27], s99 offen offset:0 sc1
buffer_load_dwordx4 a[100:103], v104, s[24:27], s99 offen offset:1024 sc1
buffer_load_dwordx4 a[104:107], v104, s[24:27], s99 offen offset:2048 sc1
s_mov_b32 s98, 3072
buffer_load_dwordx4 v[150:153], v105, s[24:27], s98 offen sc1
buffer_load_dwordx4 a[108:111], v104, s[24:27], s99 offen offset:3072 sc1
s_mov_b32 s99, 28672
buffer_load_dwordx4 a[112:115], v104, s[24:27], s99 offen offset:0 sc1
buffer_load_dwordx4 a[116:119], v104, s[24:27], s99 offen offset:1024 sc1
buffer_load_dwordx4 a[120:123], v104, s[24:27], s99 offen offset:2048 sc1
buffer_load_dwordx4 a[124:127], v104, s[24:27], s99 offen offset:3072 sc1
s_mov_b32 s99, 32768
buffer_load_dwordx4 a[128:131], v104, s[24:27], s99 offen offset:0 sc1
buffer_load_dwordx4 a[132:135], v104, s[24:27], s99 offen offset:1024 sc1
buffer_load_dwordx4 a[136:139], v104, s[24:27], s99 offen offset:2048 sc1
buffer_load_dwordx4 a[140:143], v104, s[24:27], s99 offen offset:3072 sc1
s_mov_b32 s98, 4096
buffer_load_dwordx4 v[154:157], v105, s[24:27], s98 offen sc1
s_mov_b32 s99, 36864
buffer_load_dwordx4 a[144:147], v104, s[24:27], s99 offen offset:0 sc1
buffer_load_dwordx4 a[148:151], v104, s[24:27], s99 offen offset:1024 sc1
buffer_load_dwordx4 a[152:155], v104, s[24:27], s99 offen offset:2048 sc1
buffer_load_dwordx4 a[156:159], v104, s[24:27], s99 offen offset:3072 sc1
s_mov_b32 s99, 40960
buffer_load_dwordx4 a[160:163], v104, s[24:27], s99 offen offset:0 sc1
buffer_load_dwordx4 a[164:167], v104, s[24:27], s99 offen offset:1024 sc1
buffer_load_dwordx4 a[168:171], v104, s[24:27], s99 offen offset:2048 sc1
buffer_load_dwordx4 a[172:175], v104, s[24:27], s99 offen offset:3072 sc1
s_mov_b32 s99, 45056
buffer_load_dwordx4 a[176:179], v104, s[24:27], s99 offen offset:0 sc1
s_mov_b32 s98, 5120
buffer_load_dwordx4 v[158:161], v105, s[24:27], s98 offen sc1
buffer_load_dwordx4 a[180:183], v104, s[24:27], s99 offen offset:1024 sc1
buffer_load_dwordx4 a[184:187], v104, s[24:27], s99 offen offset:2048 sc1
buffer_load_dwordx4 a[188:191], v104, s[24:27], s99 offen offset:3072 sc1
s_mov_b32 s99, 49152
buffer_load_dwordx4 a[192:195], v104, s[24:27], s99 offen offset:0 sc1
buffer_load_dwordx4 a[196:199], v104, s[24:27], s99 offen offset:1024 sc1
buffer_load_dwordx4 a[200:203], v104, s[24:27], s99 offen offset:2048 sc1
buffer_load_dwordx4 a[204:207], v104, s[24:27], s99 offen offset:3072 sc1
s_mov_b32 s99, 53248
buffer_load_dwordx4 a[208:211], v104, s[24:27], s99 offen offset:0 sc1
buffer_load_dwordx4 a[212:215], v104, s[24:27], s99 offen offset:1024 sc1
s_mov_b32 s98, 6144
buffer_load_dwordx4 v[162:165], v105, s[24:27], s98 offen sc1
buffer_load_dwordx4 a[216:219], v104, s[24:27], s99 offen offset:2048 sc1
buffer_load_dwordx4 a[220:223], v104, s[24:27], s99 offen offset:3072 sc1
s_mov_b32 s99, 57344
buffer_load_dwordx4 a[224:227], v104, s[24:27], s99 offen offset:0 sc1
buffer_load_dwordx4 a[228:231], v104, s[24:27], s99 offen offset:1024 sc1
buffer_load_dwordx4 a[232:235], v104, s[24:27], s99 offen offset:2048 sc1
buffer_load_dwordx4 a[236:239], v104, s[24:27], s99 offen offset:3072 sc1
s_mov_b32 s99, 61440
buffer_load_dwordx4 a[240:243], v104, s[24:27], s99 offen offset:0 sc1
buffer_load_dwordx4 a[244:247], v104, s[24:27], s99 offen offset:1024 sc1
buffer_load_dwordx4 a[248:251], v104, s[24:27], s99 offen offset:2048 sc1
s_mov_b32 s98, 7168
buffer_load_dwordx4 v[166:169], v105, s[24:27], s98 offen sc1
buffer_load_dwordx4 a[252:255], v104, s[24:27], s99 offen offset:3072 sc1
s_mov_b32 s99, 65536
buffer_load_dwordx4 v[186:189], v104, s[24:27], s99 offen offset:0 sc1
buffer_load_dwordx4 v[190:193], v104, s[24:27], s99 offen offset:1024 sc1
buffer_load_dwordx4 v[194:197], v104, s[24:27], s99 offen offset:2048 sc1
buffer_load_dwordx4 v[198:201], v104, s[24:27], s99 offen offset:3072 sc1
s_mov_b32 s99, 69632
buffer_load_dwordx4 v[202:205], v104, s[24:27], s99 offen offset:0 sc1
buffer_load_dwordx4 v[206:209], v104, s[24:27], s99 offen offset:1024 sc1
buffer_load_dwordx4 v[210:213], v104, s[24:27], s99 offen offset:2048 sc1
buffer_load_dwordx4 v[214:217], v104, s[24:27], s99 offen offset:3072 sc1
s_mov_b32 s98, 8192
buffer_load_dwordx4 v[170:173], v105, s[24:27], s98 offen sc1
s_mov_b32 s99, 73728
buffer_load_dwordx4 v[218:221], v104, s[24:27], s99 offen offset:0 sc1
buffer_load_dwordx4 v[222:225], v104, s[24:27], s99 offen offset:1024 sc1
buffer_load_dwordx4 v[226:229], v104, s[24:27], s99 offen offset:2048 sc1
buffer_load_dwordx4 v[230:233], v104, s[24:27], s99 offen offset:3072 sc1
s_mov_b32 s99, 77824
buffer_load_dwordx4 v[234:237], v104, s[24:27], s99 offen offset:0 sc1
buffer_load_dwordx4 v[238:241], v104, s[24:27], s99 offen offset:1024 sc1
buffer_load_dwordx4 v[242:245], v104, s[24:27], s99 offen offset:2048 sc1
buffer_load_dwordx4 v[246:249], v104, s[24:27], s99 offen offset:3072 sc1
s_mov_b32 s99, 81920
buffer_load_dwordx4 v[250:253], v104, s[24:27], s99 offen offset:0 sc1
s_waitcnt vmcnt(0)
s_barrier
ds_read_b128 v[44:47], v0 offset:0
ds_read_b128 v[48:51], v1 offset:0
s_waitcnt lgkmcnt(0)
v_smfmac_f32_16x16x64_bf16 v[8:11], a[0:3], v[44:51], v138
v_smfmac_f32_16x16x64_bf16 v[12:15], a[4:7], v[44:51], v138 abid:1
v_smfmac_f32_16x16x64_bf16 v[16:19], a[8:11], v[44:51], v139
v_smfmac_f32_16x16x64_bf16 v[20:23], a[12:15], v[44:51], v139 abid:1
v_smfmac_f32_16x16x64_bf16 v[24:27], a[16:19], v[44:51], v140
v_smfmac_f32_16x16x64_bf16 v[28:31], a[20:23], v[44:51], v140 abid:1
v_smfmac_f32_16x16x64_bf16 v[32:35], a[24:27], v[44:51], v141
v_smfmac_f32_16x16x64_bf16 v[36:39], a[28:31], v[44:51], v141 abid:1
v_smfmac_f32_16x16x64_bf16 v[40:43], a[32:35], v[44:51], v174
s_nop 7
ds_read_b128 v[44:47], v0 offset:2048
ds_read_b128 v[48:51], v1 offset:2048
s_waitcnt lgkmcnt(0)
v_smfmac_f32_16x16x64_bf16 v[8:11], a[36:39], v[44:51], v142
v_smfmac_f32_16x16x64_bf16 v[12:15], a[40:43], v[44:51], v142 abid:1
v_smfmac_f32_16x16x64_bf16 v[16:19], a[44:47], v[44:51], v143
v_smfmac_f32_16x16x64_bf16 v[20:23], a[48:51], v[44:51], v143 abid:1
v_smfmac_f32_16x16x64_bf16 v[24:27], a[52:55], v[44:51], v144
v_smfmac_f32_16x16x64_bf16 v[28:31], a[56:59], v[44:51], v144 abid:1
v_smfmac_f32_16x16x64_bf16 v[32:35], a[60:63], v[44:51], v145
v_smfmac_f32_16x16x64_bf16 v[36:39], a[64:67], v[44:51], v145 abid:1
v_smfmac_f32_16x16x64_bf16 v[40:43], a[68:71], v[44:51], v174 abid:1
s_nop 7
ds_read_b128 v[44:47], v0 offset:4096
ds_read_b128 v[48:51], v1 offset:4096
s_waitcnt lgkmcnt(0)
v_smfmac_f32_16x16x64_bf16 v[8:11], a[72:75], v[44:51], v146
v_smfmac_f32_16x16x64_bf16 v[12:15], a[76:79], v[44:51], v146 abid:1
v_smfmac_f32_16x16x64_bf16 v[16:19], a[80:83], v[44:51], v147
v_smfmac_f32_16x16x64_bf16 v[20:23], a[84:87], v[44:51], v147 abid:1
v_smfmac_f32_16x16x64_bf16 v[24:27], a[88:91], v[44:51], v148
v_smfmac_f32_16x16x64_bf16 v[28:31], a[92:95], v[44:51], v148 abid:1
v_smfmac_f32_16x16x64_bf16 v[32:35], a[96:99], v[44:51], v149
v_smfmac_f32_16x16x64_bf16 v[36:39], a[100:103], v[44:51], v149 abid:1
v_smfmac_f32_16x16x64_bf16 v[40:43], a[104:107], v[44:51], v175
s_nop 7
ds_read_b128 v[44:47], v0 offset:6144
ds_read_b128 v[48:51], v1 offset:6144
s_waitcnt lgkmcnt(0)
v_smfmac_f32_16x16x64_bf16 v[8:11], a[108:111], v[44:51], v150
v_smfmac_f32_16x16x64_bf16 v[12:15], a[112:115], v[44:51], v150 abid:1
v_smfmac_f32_16x16x64_bf16 v[16:19], a[116:119], v[44:51], v151
v_smfmac_f32_16x16x64_bf16 v[20:23], a[120:123], v[44:51], v151 abid:1
v_smfmac_f32_16x16x64_bf16 v[24:27], a[124:127], v[44:51], v152
v_smfmac_f32_16x16x64_bf16 v[28:31], a[128:131], v[44:51], v152 abid:1
v_smfmac_f32_16x16x64_bf16 v[32:35], a[132:135], v[44:51], v153
v_smfmac_f32_16x16x64_bf16 v[36:39], a[136:139], v[44:51], v153 abid:1
v_smfmac_f32_16x16x64_bf16 v[40:43], a[140:143], v[44:51], v175 abid:1
s_nop 7
ds_read_b128 v[44:47], v0 offset:8192
ds_read_b128 v[48:51], v1 offset:8192
s_waitcnt lgkmcnt(0)
v_smfmac_f32_16x16x64_bf16 v[8:11], a[144:147], v[44:51], v154
v_smfmac_f32_16x16x64_bf16 v[12:15], a[148:151], v[44:51], v154 abid:1
v_smfmac_f32_16x16x64_bf16 v[16:19], a[152:155], v[44:51], v155
v_smfmac_f32_16x16x64_bf16 v[20:23], a[156:159], v[44:51], v155 abid:1
v_smfmac_f32_16x16x64_bf16 v[24:27], a[160:163], v[44:51], v156
v_smfmac_f32_16x16x64_bf16 v[28:31], a[164:167], v[44:51], v156 abid:1
v_smfmac_f32_16x16x64_bf16 v[32:35], a[168:171], v[44:51], v157
v_smfmac_f32_16x16x64_bf16 v[36:39], a[172:175], v[44:51], v157 abid:1
v_smfmac_f32_16x16x64_bf16 v[40:43], a[176:179], v[44:51], v176
s_nop 7
ds_read_b128 v[44:47], v0 offset:10240
ds_read_b128 v[48:51], v1 offset:10240
s_waitcnt lgkmcnt(0)
v_smfmac_f32_16x16x64_bf16 v[8:11], a[180:183], v[44:51], v158
v_smfmac_f32_16x16x64_bf16 v[12:15], a[184:187], v[44:51], v158 abid:1
v_smfmac_f32_16x16x64_bf16 v[16:19], a[188:191], v[44:51], v159
v_smfmac_f32_16x16x64_bf16 v[20:23], a[192:195], v[44:51], v159 abid:1
v_smfmac_f32_16x16x64_bf16 v[24:27], a[196:199], v[44:51], v160
v_smfmac_f32_16x16x64_bf16 v[28:31], a[200:203], v[44:51], v160 abid:1
v_smfmac_f32_16x16x64_bf16 v[32:35], a[204:207], v[44:51], v161
v_smfmac_f32_16x16x64_bf16 v[36:39], a[208:211], v[44:51], v161 abid:1
v_smfmac_f32_16x16x64_bf16 v[40:43], a[212:215], v[44:51], v176 abid:1
s_nop 7
ds_read_b128 v[44:47], v0 offset:12288
ds_read_b128 v[48:51], v1 offset:12288
s_waitcnt lgkmcnt(0)
v_smfmac_f32_16x16x64_bf16 v[8:11], a[216:219], v[44:51], v162
v_smfmac_f32_16x16x64_bf16 v[12:15], a[220:223], v[44:51], v162 abid:1
v_smfmac_f32_16x16x64_bf16 v[16:19], a[224:227], v[44:51], v163
v_smfmac_f32_16x16x64_bf16 v[20:23], a[228:231], v[44:51], v163 abid:1
v_smfmac_f32_16x16x64_bf16 v[24:27], a[232:235], v[44:51], v164
v_smfmac_f32_16x16x64_bf16 v[28:31], a[236:239], v[44:51], v164 abid:1
v_smfmac_f32_16x16x64_bf16 v[32:35], a[240:243], v[44:51], v165
v_smfmac_f32_16x16x64_bf16 v[36:39], a[244:247], v[44:51], v165 abid:1
v_smfmac_f32_16x16x64_bf16 v[40:43], a[248:251], v[44:51], v177
s_nop 7
ds_read_b128 v[44:47], v0 offset:14336
ds_read_b128 v[48:51], v1 offset:14336
s_waitcnt lgkmcnt(0)
v_smfmac_f32_16x16x64_bf16 v[8:11], a[252:255], v[44:51], v166
v_smfmac_f32_16x16x64_bf16 v[12:15], v[186:189], v[44:51], v166 abid:1
v_smfmac_f32_16x16x64_bf16 v[16:19], v[190:193], v[44:51], v167
v_smfmac_f32_16x16x64_bf16 v[20:23], v[194:197], v[44:51], v167 abid:1
v_smfmac_f32_16x16x64_bf16 v[24:27], v[198:201], v[44:51], v168
v_smfmac_f32_16x16x64_bf16 v[28:31], v[202:205], v[44:51], v168 abid:1
v_smfmac_f32_16x16x64_bf16 v[32:35], v[206:209], v[44:51], v169
v_smfmac_f32_16x16x64_bf16 v[36:39], v[210:213], v[44:51], v169 abid:1
v_smfmac_f32_16x16x64_bf16 v[40:43], v[214:217], v[44:51], v177 abid:1
s_nop 7
ds_read_b128 v[44:47], v0 offset:16384
ds_read_b128 v[48:51], v1 offset:16384
s_waitcnt lgkmcnt(0)
v_smfmac_f32_16x16x64_bf16 v[8:11], v[218:221], v[44:51], v170
v_smfmac_f32_16x16x64_bf16 v[12:15], v[222:225], v[44:51], v170 abid:1
v_smfmac_f32_16x16x64_bf16 v[16:19], v[226:229], v[44:51], v171
v_smfmac_f32_16x16x64_bf16 v[20:23], v[230:233], v[44:51], v171 abid:1
v_smfmac_f32_16x16x64_bf16 v[24:27], v[234:237], v[44:51], v172
v_smfmac_f32_16x16x64_bf16 v[28:31], v[238:241], v[44:51], v172 abid:1
v_smfmac_f32_16x16x64_bf16 v[32:35], v[242:245], v[44:51], v173
v_smfmac_f32_16x16x64_bf16 v[36:39], v[246:249], v[44:51], v173 abid:1
v_smfmac_f32_16x16x64_bf16 v[40:43], v[250:253], v[44:51], v178
s_nop 7
s_add_u32 s87, s87, 1
s_cmp_lt_u32 s87, 2
s_cbranch_scc1 L_spass
v_cvt_pk_bf16_f32 v92, v8, v9
v_cvt_pk_bf16_f32 v93, v10, v11
v_cvt_pk_bf16_f32 v94, v12, v13
v_cvt_pk_bf16_f32 v95, v14, v15
v_cvt_pk_bf16_f32 v96, v16, v17
v_cvt_pk_bf16_f32 v97, v18, v19
v_cvt_pk_bf16_f32 v98, v20, v21
v_cvt_pk_bf16_f32 v99, v22, v23
v_cvt_pk_bf16_f32 v100, v24, v25
v_cvt_pk_bf16_f32 v101, v26, v27
v_cvt_pk_bf16_f32 v102, v28, v29
v_cvt_pk_bf16_f32 v103, v30, v31
v_cvt_pk_bf16_f32 v104, v32, v33
v_cvt_pk_bf16_f32 v105, v34, v35
s_mov_b64 vcc, s[80:81]
s_nop 0
v_cndmask_b32_dpp v108, v96, v92, vcc quad_perm:[1,0,3,2] row_mask:0xf bank_mask:0xf
v_cndmask_b32_dpp v109, v97, v93, vcc quad_perm:[1,0,3,2] row_mask:0xf bank_mask:0xf
v_cndmask_b32_dpp v110, v98, v94, vcc quad_perm:[1,0,3,2] row_mask:0xf bank_mask:0xf
v_cndmask_b32_dpp v111, v99, v95, vcc quad_perm:[1,0,3,2] row_mask:0xf bank_mask:0xf
buffer_store_dwordx4 v[108:111], v4, s[20:23], s46 offen offset:0 sc1
s_mov_b64 vcc, s[82:83]
v_cvt_pk_bf16_f32 v112, v40, v41
v_cvt_pk_bf16_f32 v113, v42, v43
ds_bpermute_b32 v112, v6, v112
ds_bpermute_b32 v113, v6, v113
v_cndmask_b32_dpp v96, v92, v96, vcc quad_perm:[1,0,3,2] row_mask:0xf bank_mask:0xf
v_cndmask_b32_dpp v97, v93, v97, vcc quad_perm:[1,0,3,2] row_mask:0xf bank_mask:0xf
v_cndmask_b32_dpp v98, v94, v98, vcc quad_perm:[1,0,3,2] row_mask:0xf bank_mask:0xf
v_cndmask_b32_dpp v99, v95, v99, vcc quad_perm:[1,0,3,2] row_mask:0xf bank_mask:0xf
buffer_store_dwordx4 v[96:99], v4, s[20:23], s46 offen offset:1152 sc1
s_mov_b64 vcc, s[80:81]
v_cvt_pk_bf16_f32 v106, v36, v37
v_cvt_pk_bf16_f32 v107, v38, v39
v_cndmask_b32_dpp v92, v104, v100, vcc quad_perm:[1,0,3,2] row_mask:0xf bank_mask:0xf
v_cndmask_b32_dpp v93, v105, v101, vcc quad_perm:[1,0,3,2] row_mask:0xf bank_mask:0xf
v_cndmask_b32_dpp v94, v106, v102, vcc quad_perm:[1,0,3,2] row_mask:0xf bank_mask:0xf
v_cndmask_b32_dpp v95, v107, v103, vcc quad_perm:[1,0,3,2] row_mask:0xf bank_mask:0xf
buffer_store_dwordx4 v[92:95], v4, s[20:23], s46 offen offset:128 sc1
s_mov_b64 vcc, s[82:83]
v_cndmask_b32_dpp v104, v100, v104, vcc quad_perm:[1,0,3,2] row_mask:0xf bank_mask:0xf
v_cndmask_b32_dpp v105, v101, v105, vcc quad_perm:[1,0,3,2] row_mask:0xf bank_mask:0xf
v_cndmask_b32_dpp v106, v102, v106, vcc quad_perm:[1,0,3,2] row_mask:0xf bank_mask:0xf
v_cndmask_b32_dpp v107, v103, v107, vcc quad_perm:[1,0,3,2] row_mask:0xf bank_mask:0xf
buffer_store_dwordx4 v[104:107], v4, s[20:23], s46 offen offset:1280 sc1
s_mov_b64 vcc, s[80:81]
s_waitcnt lgkmcnt(0)
buffer_store_dwordx2 v[112:113], v5, s[20:23], s46 offen
s_cmp_eq_u32 s41, 15
s_cselect_b32 s13, -23574528, s13
s_add_u32 s45, s45, s13
s_add_u32 s7, s7, s13
s_add_u32 s46, s46, s13
s_mov_b32 s13, 4718592
s_add_u32 s41, s41, 1
s_cmp_lt_u32 s41, s15
s_cbranch_scc1 L_stile
s_branch L_fin
.section .rodata,"a"
.p2align 6
.amdhsa_kernel standalone__structured_sparse_n_m__ragged_kernel
  .amdhsa_next_free_vgpr 512
  .amdhsa_next_free_sgpr 102
  .amdhsa_accum_offset 256
  .amdhsa_group_segment_fixed_size 0
  .amdhsa_float_denorm_mode_32 3
  .amdhsa_kernarg_size 48
  .amdhsa_user_sgpr_count 2
  .amdhsa_user_sgpr_kernarg_segment_ptr 1
  .amdhsa_system_sgpr_workgroup_id_x 1
.end_amdhsa_kernel
```

```asm
; @launch grid=(256,1,1) block=(256,1,1) lds=163840
.amdgcn_target "amdgcn-amd-amdhsa--gfx950"
.text
.globl standalone__structured_sparse_n_m__ragged_kernel
.p2align 8
.type standalone__structured_sparse_n_m__ragged_kernel,@function
standalone__structured_sparse_n_m__ragged_kernel:
s_load_dwordx8 s[4:11], s[0:1], 0
s_load_dwordx4 s[12:15], s[0:1], 32
s_cmp_ge_u32 s2, 256
s_cbranch_scc1 L_end_standalone__structured_sparse_n_m__ragged_kernel
v_lshrrev_b32 v1, 6, v0
v_and_b32 v7, 63, v0
v_readfirstlane_b32 s40, v1
s_mov_b32 s86, 0
s_lshr_b32 s84, s2, 6
s_and_b32 s47, s2, 9
s_lshl1_add_u32 s84, s84, s47
s_bfe_u32 s3, s2, 0x20004
s_lshl2_add_u32 s84, s84, s3
s_and_b32 s47, s2, 7
s_cmp_lt_u32 s47, 2
s_cselect_b32 s84, s84, 63
s_cmp_lt_u32 s84, 41
s_cbranch_scc1 L_prod
v_lshlrev_b32 v3, 7, v0
s_getpc_b64 s[96:97]
v_min_u32 v2, L_slow-standalone__structured_sparse_n_m__ragged_kernel, v3
global_load_dword v120, v2, s[96:97]
s_branch L_cons
L_prod:
s_and_b32 s48, s84, 3
s_lshr_b32 s49, s84, 2
s_sub_u32 s50, s84, 36
s_lshl_b32 s51, s40, 4
s_lshl_b32 s52, s50, 1
s_lshl_b32 s53, s48, 8
s_cmp_lt_u32 s84, 36
s_cselect_b32 s52, s49, s52
s_cselect_b32 s53, s53, 1024
s_cselect_b32 s54, 8, 73728
s_cselect_b32 s55, 32, 8
s_cselect_b32 s56, 16, 32
s_cselect_b32 s57, 128, 64
s_mul_i32 s52, s52, 73728
s_mul_i32 s58, s40, 18432
v_and_b32 v58, 1, v7
v_bfe_u32 v59, v7, 1, 1
v_bfe_u32 v60, v7, 2, 2
v_bfe_u32 v62, v7, 4, 1
v_lshrrev_b32 v63, 5, v7
v_lshl_add_u32 v50, v58, 2, s52
v_mad_u32_u24 v50, v59, s54, v50
v_mad_u32_u24 v50, v60, s55, v50
v_mad_u32_u24 v50, v62, s56, v50
v_mad_u32_u24 v50, v63, s57, v50
v_add_u32 v50, s53, v50
v_add_u32 v50, s58, v50
v_add_u32 v62, 4608, v50
v_add_u32 v63, 9216, v50
v_add_u32 v64, 13824, v50
s_waitcnt lgkmcnt(0)
s_mov_b32 s30, 663552
s_mov_b32 s31, 0x20000
s_mov_b32 s28, s6
s_and_b32 s29, s7, 0xffff
buffer_load_dword v8, v50, s[28:31], 0 offen offset:0 nt
buffer_load_dword v9, v50, s[28:31], 0 offen offset:1152 nt
buffer_load_dword v10, v50, s[28:31], 0 offen offset:2304 nt
buffer_load_dword v11, v50, s[28:31], 0 offen offset:3456 nt
buffer_load_dword v12, v62, s[28:31], 0 offen offset:0 nt
buffer_load_dword v13, v62, s[28:31], 0 offen offset:1152 nt
buffer_load_dword v14, v62, s[28:31], 0 offen offset:2304 nt
buffer_load_dword v15, v62, s[28:31], 0 offen offset:3456 nt
buffer_load_dword v16, v63, s[28:31], 0 offen offset:0 nt
buffer_load_dword v17, v63, s[28:31], 0 offen offset:1152 nt
buffer_load_dword v18, v63, s[28:31], 0 offen offset:2304 nt
buffer_load_dword v19, v63, s[28:31], 0 offen offset:3456 nt
buffer_load_dword v20, v64, s[28:31], 0 offen offset:0 nt
buffer_load_dword v21, v64, s[28:31], 0 offen offset:1152 nt
buffer_load_dword v22, v64, s[28:31], 0 offen offset:2304 nt
buffer_load_dword v23, v64, s[28:31], 0 offen offset:3456 nt
s_mov_b32 s18, 75497472
s_mov_b32 s19, 0x20000
s_mov_b32 s16, s4
s_and_b32 s17, s5, 0xffff
s_mov_b32 s26, 301989888
s_mov_b32 s27, 0x20000
s_mov_b32 s24, s14
s_and_b32 s25, s15, 0xffff
s_mov_b32 s34, 1152
s_mov_b32 s35, 0x20000
s_mov_b32 s32, s8
s_and_b32 s33, s9, 0xffff
s_mov_b32 s22, 0
s_mov_b32 s23, 0x20000
s_mov_b32 s20, s10
s_and_b32 s21, s11, 0xffff
s_mov_b32 s38, 256
s_mov_b32 s39, 0x20000
s_mov_b32 s36, s12
s_and_b32 s37, s13, 0xffff
s_mul_i32 s52, s48, 9
s_add_u32 s52, s52, s49
s_mul_i32 s53, s52, 9
s_mul_i32 s54, s50, 18
s_add_u32 s54, s54, 8
s_lshl_b32 s55, s52, 2
s_add_u32 s55, s55, s40
s_lshl_b32 s56, s50, 2
s_add_u32 s56, s56, s40
s_cmp_eq_u32 s84, 40
s_cselect_b32 s57, 0x100000, 9
s_cmp_lt_u32 s84, 36
s_cselect_b32 s53, s53, s54
s_cselect_b32 s54, 2, 81
s_cselect_b32 s57, 1, s57
s_cselect_b32 s55, s55, s56
s_mov_b32 s56, 331776
s_cselect_b32 s56, s56, 368640
s_mov_b32 s58, 373760
s_cselect_b32 s58, s58, 382976
s_cselect_b32 s59, 16, 4
s_cselect_b32 s60, 4, 64
s_cselect_b32 s61, 12, 11
s_cselect_b32 s62, 1, 0x8001
v_lshrrev_b32 v61, 4, v7
v_lshlrev_b32 v62, 1, v58
v_lshl_add_u32 v60, v60, 2, v62
v_add_u32 v62, v60, v59
v_mul_u32_u24 v51, s54, v61
v_add_lshl_u32 v51, v51, s53, 6
v_add3_u32 v51, v51, v62, s51
v_lshl_add_u32 v51, v51, 4, s86
s_lshl_b32 s57, s57, 10
v_add_u32 v66, s57, v51
s_lshl_b32 s52, s55, 8
s_add_u32 s52, s52, s56
s_add_u32 s52, s52, s86
v_mul_u32_u24 v52, s59, v62
v_mad_u32_u24 v52, v61, s60, v52
v_lshl_add_u32 v54, v7, 2, s52
s_lshr_b32 s52, s55, 2
s_lshl_b32 s52, s52, 8
s_add_u32 s58, s58, s52
s_lshl2_add_u32 s58, s51, s58
s_lshl_b32 s52, s51, 1
s_add_u32 s52, s52, s62
v_lshl_add_u32 v62, v61, 1, v59
v_lshlrev_b32 v62, s61, v62
v_lshl_add_u32 v53, v60, 7, v62
v_add_u32 v53, s52, v53
v_and_b32 v62, 12, v7
v_and_b32 v63, 15, v7
v_mad_u32_u24 v62, v62, 3, v63
v_lshl_add_u32 v62, v62, 2, s51
v_mov_b32 v67, 0
ds_write_b32 v62, v67
s_lshl2_add_u32 s52, s84, s40
s_lshl_b32 s52, s52, 7
s_add_u32 s52, s52, 393152
v_lshl_add_u32 v65, v7, 2, s58
v_lshl_add_u32 v62, v7, 2, s52
v_cmp_gt_u32 vcc, 16, v7
s_lshl_b32 s52, s51, 2
v_lshl_add_u32 v57, v7, 2, s52
v_cndmask_b32 v65, v62, v65, vcc
s_mov_b32 s75, 0
s_mov_b32 s73, 0x05060100
s_mov_b32 s74, 0xffff
v_mov_b32 v55, 0x05040100
v_mov_b32 v62, 0x03020706
v_cmp_eq_u32 vcc, 1, v59
v_mov_b32 v68, 0xf0a0500
v_mov_b32 v69, 0x8f8a8580
v_mov_b32 v70, 0x1f1a1510
v_mov_b32 v71, 0x9f9a9590
v_mov_b32 v72, 0x2f2a2520
v_mov_b32 v73, 0xafaaa5a0
v_mov_b32 v74, 0x3f3a3530
v_mov_b32 v75, 0xbfbab5b0
v_cndmask_b32 v55, v55, v62, vcc
v_mov_b64 v[76:77], 0
v_mov_b64 v[78:79], 0
v_mov_b64 v[80:81], 0
v_mov_b32 v82, 0
s_mov_b32 s64, 0x5040500
s_mov_b32 s65, 0x5040501
s_mov_b32 s66, 0x5040502
s_mov_b32 s67, 0x5040503
s_mov_b32 s68, 0x7060700
s_mov_b32 s69, 0x7060701
s_mov_b32 s70, 0x7060702
s_mov_b32 s71, 0x7060703
s_mov_b32 s72, 0x05060102
s_waitcnt vmcnt(12)
v_perm_b32 v24, v8, v68, s64
v_perm_b32 v25, v9, v68, s65
v_perm_b32 v26, v10, v68, s66
v_perm_b32 v27, v11, v68, s67
v_max3_f32 v28, |v24|, |v25|, |v26|
v_med3_f32 v29, |v24|, |v25|, |v26|
v_min3_f32 v30, |v24|, |v25|, |v26|
v_med3_f32 v32, v28, v29, |v27|
v_med3_f32 v33, v29, v30, |v27|
v_max_f32 v31, v28, |v27|
v_perm_b32 v36, v31, v32, s72
v_bfi_b32 v44, 3, v32, v31
v_cmpx_eq_u32_sdwa vcc, v33, v32 src0_sel:WORD_1 src1_sel:WORD_1
v_mov_b32 v76, v33
v_min_f32 v77, v30, |v27|
s_mov_b64 exec, -1
v_perm_b32 v24, v8, v69, s68
v_perm_b32 v25, v9, v69, s69
v_perm_b32 v26, v10, v69, s70
v_perm_b32 v27, v11, v69, s71
v_max3_f32 v28, |v24|, |v25|, |v26|
v_med3_f32 v29, |v24|, |v25|, |v26|
v_min3_f32 v30, |v24|, |v25|, |v26|
v_med3_f32 v32, v28, v29, |v27|
v_med3_f32 v33, v29, v30, |v27|
v_max_f32 v31, v28, |v27|
v_perm_b32 v40, v31, v32, s72
v_bfi_b32 v46, 3, v32, v31
v_cmpx_eq_u32_sdwa vcc, v33, v32 src0_sel:WORD_1 src1_sel:WORD_1
v_mov_b64 v[78:79], v[76:77]
v_mov_b32 v76, v33
v_min_f32 v77, v30, |v27|
s_mov_b64 exec, -1
s_waitcnt vmcnt(8)
v_perm_b32 v24, v12, v70, s64
v_perm_b32 v25, v13, v70, s65
v_perm_b32 v26, v14, v70, s66
v_perm_b32 v27, v15, v70, s67
v_max3_f32 v28, |v24|, |v25|, |v26|
v_med3_f32 v29, |v24|, |v25|, |v26|
v_min3_f32 v30, |v24|, |v25|, |v26|
v_med3_f32 v32, v28, v29, |v27|
v_med3_f32 v33, v29, v30, |v27|
v_max_f32 v31, v28, |v27|
v_perm_b32 v37, v31, v32, s72
v_bfi_b32 v31, 3, v32, v31
v_lshlrev_b32 v31, 4, v31
v_bfi_b32 v44, 15, v44, v31
v_cmpx_eq_u32_sdwa vcc, v33, v32 src0_sel:WORD_1 src1_sel:WORD_1
v_mov_b64 v[80:81], v[78:79]
v_mov_b64 v[78:79], v[76:77]
v_mov_b32 v76, v33
v_min_f32 v77, v30, |v27|
s_mov_b64 exec, -1
v_perm_b32 v24, v12, v71, s68
v_perm_b32 v25, v13, v71, s69
v_perm_b32 v26, v14, v71, s70
v_perm_b32 v27, v15, v71, s71
v_max3_f32 v28, |v24|, |v25|, |v26|
v_med3_f32 v29, |v24|, |v25|, |v26|
v_min3_f32 v30, |v24|, |v25|, |v26|
v_med3_f32 v32, v28, v29, |v27|
v_med3_f32 v33, v29, v30, |v27|
v_max_f32 v31, v28, |v27|
v_perm_b32 v41, v31, v32, s72
v_bfi_b32 v31, 3, v32, v31
v_lshlrev_b32 v31, 4, v31
v_bfi_b32 v46, 15, v46, v31
v_cmpx_eq_u32_sdwa vcc, v33, v32 src0_sel:WORD_1 src1_sel:WORD_1
v_or_b32 v82, v82, v80
v_mov_b64 v[80:81], v[78:79]
v_mov_b64 v[78:79], v[76:77]
v_mov_b32 v76, v33
v_min_f32 v77, v30, |v27|
s_mov_b64 exec, -1
s_waitcnt vmcnt(4)
v_perm_b32 v24, v16, v72, s64
v_perm_b32 v25, v17, v72, s65
v_perm_b32 v26, v18, v72, s66
v_perm_b32 v27, v19, v72, s67
v_max3_f32 v28, |v24|, |v25|, |v26|
v_med3_f32 v29, |v24|, |v25|, |v26|
v_min3_f32 v30, |v24|, |v25|, |v26|
v_med3_f32 v32, v28, v29, |v27|
v_med3_f32 v33, v29, v30, |v27|
v_max_f32 v31, v28, |v27|
v_perm_b32 v38, v31, v32, s72
v_bfi_b32 v45, 3, v32, v31
v_cmpx_eq_u32_sdwa vcc, v33, v32 src0_sel:WORD_1 src1_sel:WORD_1
v_or_b32 v82, v82, v80
v_mov_b64 v[80:81], v[78:79]
v_mov_b64 v[78:79], v[76:77]
v_mov_b32 v76, v33
v_min_f32 v77, v30, |v27|
s_mov_b64 exec, -1
v_perm_b32 v24, v16, v73, s68
v_perm_b32 v25, v17, v73, s69
v_perm_b32 v26, v18, v73, s70
v_perm_b32 v27, v19, v73, s71
v_max3_f32 v28, |v24|, |v25|, |v26|
v_med3_f32 v29, |v24|, |v25|, |v26|
v_min3_f32 v30, |v24|, |v25|, |v26|
v_med3_f32 v32, v28, v29, |v27|
v_med3_f32 v33, v29, v30, |v27|
v_max_f32 v31, v28, |v27|
v_perm_b32 v42, v31, v32, s72
v_bfi_b32 v47, 3, v32, v31
v_cmpx_eq_u32_sdwa vcc, v33, v32 src0_sel:WORD_1 src1_sel:WORD_1
v_or_b32 v82, v82, v80
v_mov_b64 v[80:81], v[78:79]
v_mov_b64 v[78:79], v[76:77]
v_mov_b32 v76, v33
v_min_f32 v77, v30, |v27|
s_mov_b64 exec, -1
s_waitcnt vmcnt(0)
v_perm_b32 v24, v20, v74, s64
v_perm_b32 v25, v21, v74, s65
v_perm_b32 v26, v22, v74, s66
v_perm_b32 v27, v23, v74, s67
v_max3_f32 v28, |v24|, |v25|, |v26|
v_med3_f32 v29, |v24|, |v25|, |v26|
v_min3_f32 v30, |v24|, |v25|, |v26|
v_med3_f32 v32, v28, v29, |v27|
v_med3_f32 v33, v29, v30, |v27|
v_max_f32 v31, v28, |v27|
v_perm_b32 v39, v31, v32, s72
v_bfi_b32 v31, 3, v32, v31
v_lshlrev_b32 v31, 4, v31
v_bfi_b32 v45, 15, v45, v31
v_cmpx_eq_u32_sdwa vcc, v33, v32 src0_sel:WORD_1 src1_sel:WORD_1
v_or_b32 v82, v82, v80
v_mov_b64 v[80:81], v[78:79]
v_mov_b64 v[78:79], v[76:77]
v_mov_b32 v76, v33
v_min_f32 v77, v30, |v27|
s_mov_b64 exec, -1
v_perm_b32 v24, v20, v75, s68
v_perm_b32 v25, v21, v75, s69
v_perm_b32 v26, v22, v75, s70
v_perm_b32 v27, v23, v75, s71
v_max3_f32 v28, |v24|, |v25|, |v26|
v_med3_f32 v29, |v24|, |v25|, |v26|
v_min3_f32 v30, |v24|, |v25|, |v26|
v_med3_f32 v32, v28, v29, |v27|
v_med3_f32 v33, v29, v30, |v27|
v_max_f32 v31, v28, |v27|
v_perm_b32 v43, v31, v32, s72
v_bfi_b32 v31, 3, v32, v31
v_lshlrev_b32 v31, 4, v31
v_bfi_b32 v47, 15, v47, v31
v_cmpx_eq_u32_sdwa vcc, v33, v32 src0_sel:WORD_1 src1_sel:WORD_1
v_or_b32 v82, v82, v80
v_mov_b64 v[80:81], v[78:79]
v_mov_b64 v[78:79], v[76:77]
v_mov_b32 v76, v33
v_min_f32 v77, v30, |v27|
s_mov_b64 exec, -1
s_mov_b32 vcc_lo, 0x33333333
s_mov_b32 vcc_hi, 0x33333333
v_cndmask_b32_dpp v24, v40, v36, vcc quad_perm:[2,3,0,1] row_mask:0xf bank_mask:0xf
v_cndmask_b32_dpp v25, v41, v37, vcc quad_perm:[2,3,0,1] row_mask:0xf bank_mask:0xf
v_cndmask_b32_dpp v26, v42, v38, vcc quad_perm:[2,3,0,1] row_mask:0xf bank_mask:0xf
v_cndmask_b32_dpp v27, v43, v39, vcc quad_perm:[2,3,0,1] row_mask:0xf bank_mask:0xf
s_not_b64 vcc, vcc
buffer_store_dwordx4 v[24:27], v51, s[24:27], 0 offen sc1
v_cndmask_b32_dpp v40, v36, v40, vcc quad_perm:[2,3,0,1] row_mask:0xf bank_mask:0xf
v_cndmask_b32_dpp v41, v37, v41, vcc quad_perm:[2,3,0,1] row_mask:0xf bank_mask:0xf
v_cndmask_b32_dpp v42, v38, v42, vcc quad_perm:[2,3,0,1] row_mask:0xf bank_mask:0xf
v_cndmask_b32_dpp v43, v39, v43, vcc quad_perm:[2,3,0,1] row_mask:0xf bank_mask:0xf
s_mov_b32 s52, 0x0c0c0400
s_mov_b32 s53, 0x04000c0c
buffer_store_dwordx4 v[40:43], v66, s[24:27], 0 offen sc1
v_perm_b32 v48, v45, v44, s52
v_perm_b32 v49, v47, v46, s53
v_or_b32 v48, v48, v49
s_nop 1
v_mov_b32_dpp v49, v48 quad_perm:[2,3,0,1] row_mask:0xf bank_mask:0xf
v_perm_b32 v48, v49, v48, v55
ds_permute_b32 v48, v52, v48
v_cmp_lt_u32 s[54:55], s74, v82
L_emit:
v_cmp_lt_u32 vcc, s74, v76
v_cmp_eq_u32_sdwa s[48:49], v77, v76 src0_sel:WORD_1 src1_sel:WORD_1
v_perm_b32 v63, v76, v53, s73
v_bfe_u32 v62, v76, 2, 4
v_and_b32 v64, 0x80, v76
v_lshl_add_u32 v63, v62, 1, v63
v_mbcnt_lo_u32_b32 v62, vcc_lo, 0
v_mbcnt_hi_u32_b32 v62, vcc_hi, v62
v_add_u32 v63, v64, v63
v_add_u32 v62, s75, v62
s_bcnt1_i32_b64 s52, vcc
s_add_u32 s75, s75, s52
v_cmp_gt_u32 s[52:53], 15, v62
v_and_b32 v64, 12, v62
v_mad_u32_u24 v62, v64, 3, v62
v_lshl_add_u32 v62, v62, 2, s51
s_and_b64 s[48:49], s[48:49], vcc
s_and_b64 exec, s[52:53], vcc
ds_write_b32 v62, v63
s_mov_b64 exec, s[48:49]
v_mov_b32 v76, v77
v_mov_b32 v77, 0
s_not_b64 exec, exec
v_mov_b64 v[76:77], v[78:79]
v_mov_b64 v[78:79], v[80:81]
v_mov_b64 v[80:81], 0
s_mov_b64 exec, -1
v_or3_b32 v62, v76, v78, v80
v_cmp_lt_u32 vcc, s74, v62
s_cmp_lg_u64 s[54:55], 0
s_cselect_b32 s52, 99, s75
s_cmp_gt_u32 s52, 15
s_cselect_b32 s52, -1, 0
v_mov_b32 v63, s51
s_cbranch_vccnz L_emit
v_mov_b32 v62, s52
ds_write_b32 v63, v62 offset:204
v_lshlrev_b32 v11, 4, v63
s_waitcnt lgkmcnt(0)
s_barrier
s_mov_b64 exec, 0xffff
ds_read_b32 v67, v57
s_mov_b64 exec, -1
buffer_store_dword v48, v54, s[24:27], 0 offen sc1
s_mov_b32 exec_hi, 0xffff
s_waitcnt lgkmcnt(0)
buffer_store_dword v67, v65, s[24:27], 0 offen sc1
s_mov_b64 exec, 1
buffer_load_dword v8, v11, s[36:39], 0 offen sc1
s_mov_b64 exec, -1
s_lshl_b32 s52, s84, 7
s_add_u32 s52, s52, 458752
v_lshl_add_u32 v9, v7, 2, s52
v_mov_b32 v10, 1
s_waitcnt vmcnt(0)
s_mov_b32 s85, 0x230003c
s_barrier
s_cmp_lg_u32 s40, 0
s_cbranch_scc1 L_cons2
v_readfirstlane_b32 s47, v8
s_mov_b64 exec, 0xffff
s_cmp_lg_u32 s47, 1
s_cbranch_scc1 L_pwait
L_pset:
buffer_store_dword v10, v9, s[24:27], 0 offen sc1
L_notlast:
s_mov_b64 exec, -1
L_cons2:
v_lshrrev_b32 v72, 3, v7
v_and_b32 v73, 7, v7
v_xor_b32 v73, v73, v72
v_mul_u32_u24 v72, 1152, v72
s_and_b32 s47, s40, 1
s_mul_i32 s47, s47, 9216
s_lshr_b32 s3, s40, 1
s_lshl_b32 s3, s3, 7
s_add_u32 s47, s47, s3
v_lshl_add_u32 v72, v73, 4, v72
v_add_u32 v3, s47, v72
s_lshl_b32 s44, s40, 10
s_mul_i32 s45, s2, 18432
s_mov_b32 s46, s45
s_branch L_cons3
L_pwait:
s_mov_b32 s3, 20015
L_pwait1:
buffer_load_dword v8, off, s[36:39], 0 sc1
s_waitcnt vmcnt(0)
v_readfirstlane_b32 s47, v8
s_nop 3
s_cmp_eq_u32 s47, 1
s_cbranch_scc1 L_pset
s_sub_u32 s3, s3, 1
s_cbranch_scc0 L_pwait1
s_branch L_notlast
L_cons:
s_mov_b32 s85, 0x700030
s_mov_b32 s47, 0x700030
s_bitcmp1_b32 s2, 3
s_cselect_b32 s85, s85, 0x230003c
s_cselect_b32 s47, s47, 0x230003c
s_bitcmp1_b32 s2, 6
s_cselect_b32 s85, s47, s85
v_lshrrev_b32 v72, 3, v7
v_and_b32 v73, 7, v7
v_xor_b32 v73, v73, v72
v_mul_u32_u24 v72, 1152, v72
s_and_b32 s47, s40, 1
s_mul_i32 s47, s47, 9216
s_lshr_b32 s3, s40, 1
s_lshl_b32 s3, s3, 7
s_add_u32 s47, s47, s3
v_lshl_add_u32 v72, v73, 4, v72
v_add_u32 v3, s47, v72
s_lshl_b32 s44, s40, 10
s_mul_i32 s45, s2, 18432
s_mov_b32 s46, s45
s_waitcnt lgkmcnt(0)
s_mov_b32 s30, 663552
s_mov_b32 s31, 0x20000
s_mov_b32 s28, s6
s_and_b32 s29, s7, 0xffff
s_mov_b32 s18, 75497472
s_mov_b32 s19, 0x20000
s_mov_b32 s16, s4
s_and_b32 s17, s5, 0xffff
s_mov_b32 s26, 301989888
s_mov_b32 s27, 0x20000
s_mov_b32 s24, s14
s_and_b32 s25, s15, 0xffff
s_mov_b32 s34, 1152
s_mov_b32 s35, 0x20000
s_mov_b32 s32, s8
s_and_b32 s33, s9, 0xffff
s_mov_b32 s22, 0
s_mov_b32 s23, 0x20000
s_mov_b32 s20, s10
s_and_b32 s21, s11, 0xffff
s_mov_b32 s38, 256
s_mov_b32 s39, 0x20000
s_mov_b32 s36, s12
s_and_b32 s37, s13, 0xffff
s_cmp_lg_u32 s2, 200
s_cbranch_scc1 L_cons3
v_lshlrev_b32 v8, 4, v0
v_mov_b64 v[12:13], 0
v_mov_b64 v[14:15], 0
buffer_store_dwordx4 v[12:15], v8, s[36:39], 0 offen sc1
v_add_u32 v8, 458752, v8
v_add_u32 v9, 4096, v8
buffer_store_dwordx4 v[12:15], v8, s[24:27], 0 offen sc1
buffer_store_dwordx4 v[12:15], v9, s[24:27], 0 offen sc1
v_mov_b32 v10, 1
v_lshlrev_b32 v11, 2, v0
s_waitcnt vmcnt(0)
s_barrier
s_mov_b32 exec_hi, 0
buffer_store_dword v10, v11, s[36:39], 0 offen sc1
s_mov_b64 exec, -1
L_cons3:
s_lshr_b32 s47, s40, 1
s_lshl_b32 s3, s47, 11
s_sub_u32 s8, 15488, s3
s_lshl_b32 s3, s47, 7
s_add_u32 s7, s45, 128
s_sub_u32 s7, s7, s3
s_sub_u32 s10, s47, 1
s_sub_u32 s11, 0, s47
s_mov_b32 s9, s44
s_mov_b32 s13, 4718592
s_mov_b32 s15, 16
s_mov_b32 s14, s13
v_and_b32 v80, 3, v7
v_bfe_u32 v81, v7, 2, 2
v_bfe_u32 v82, v7, 4, 1
v_lshlrev_b32 v81, 3, v81
v_lshl_add_u32 v81, v80, 5, v81
v_lshl_add_u32 v81, v82, 7, v81
s_lshl_b32 s47, s40, 8
v_add_u32 v81, s47, v81
s_lshl_b32 s47, s40, 5
s_add_u32 s47, s47, 1024
v_lshl_add_u32 v80, v80, 3, s47
v_cmp_gt_u32 vcc, 32, v7
s_nop 1
v_cndmask_b32 v80, v80, v81, vcc
buffer_load_dwordx2 v[110:111], v80, s[32:35], 0 offen
s_cmp_lt_u32 s84, 41
s_cbranch_scc1 L_pfd
s_waitcnt vmcnt(0)
L_pfd:
s_bfe_u32 s88, s85, 0x40014
s_mov_b32 s3, 55680
s_cmp_ge_u32 s88, 6
s_cselect_b32 s3, s3, 0
s_cmp_ge_u32 s84, 41
s_cselect_b32 s3, s3, 0
L_pf:
s_add_u32 m0, s44, 0
s_nop 0
buffer_load_dwordx4 v3, s[16:19], s45 offen offset:0 nt lds
s_add_u32 m0, s44, 3840
s_nop 0
buffer_load_dwordx4 v3, s[16:19], s45 offen offset:256 nt lds
s_add_u32 m0, s44, 7680
s_nop 0
buffer_load_dwordx4 v3, s[16:19], s45 offen offset:512 nt lds
s_add_u32 m0, s44, 11520
s_nop 0
buffer_load_dwordx4 v3, s[16:19], s45 offen offset:768 nt lds
s_add_u32 m0, s44, s8
s_mov_b64 exec, s[10:11]
buffer_load_dwordx4 v3, s[16:19], s7 offen offset:896 nt lds
s_mov_b64 exec, -1
s_cmp_lg_u32 s44, 37120
s_cbranch_scc1 L_pf_f
s_mov_b64 exec, 1
buffer_load_dword v124, off, s[36:39], 0 sc1
s_mov_b64 exec, -1
L_pf_f:
s_cmp_ge_u32 s44, s3
s_cbranch_scc1 L_pf_n
s_waitcnt vmcnt(1)
L_pf_n:
s_add_u32 s7, s7, s13
s_add_u32 s44, s44, 18560
s_add_u32 s45, s45, s13
s_mov_b32 s13, 4718592
s_sub_u32 s88, s88, 1
s_cmp_lg_u32 s88, 0
s_cbranch_scc1 L_pf
L_pf_e:
L_rest:
s_mov_b32 s92, 0x80
s_mov_b32 s47, 0x80
s_bitcmp1_b32 s2, 3
s_cselect_b32 s92, s92, 0x88
s_cselect_b32 s47, s47, 0x88
s_bitcmp1_b32 s2, 6
s_cselect_b32 s92, s47, s92
s_mov_b32 s3, 0x88
s_cmp_lt_u32 s84, 41
s_cselect_b32 s92, s3, s92
s_mov_b32 s87, 0x80
s_mov_b32 s3, 0x80
s_cmp_lt_u32 s84, 41
s_cselect_b32 s87, s3, s87
v_and_b32 v72, 15, v7
v_lshrrev_b32 v73, 4, v7
v_and_b32 v74, 7, v7
v_xor_b32 v74, v74, v73
v_lshlrev_b32 v74, 4, v74
v_lshl_add_u32 v0, v72, 7, v74
v_xor_b32 v1, 64, v0
s_mul_i32 s93, s40, 3584
s_add_u32 s93, s93, 148480
v_lshl_add_u32 v2, v73, 4, s93
v_and_b32 v74, 14, v7
v_mul_u32_u24 v4, 1152, v74
v_and_b32 v74, 1, v7
v_lshl_add_u32 v4, v74, 4, v4
v_lshl_add_u32 v4, v73, 5, v4
s_lshl_b32 s47, s40, 8
v_add_u32 v4, s47, v4
s_lshl_b32 s47, s40, 5
s_add_u32 s47, s47, 1024
v_lshrrev_b32 v72, 2, v7
v_and_b32 v73, 3, v7
v_lshl_add_u32 v6, v73, 4, v72
v_lshlrev_b32 v6, 2, v6
v_mul_u32_u24 v5, 1152, v72
v_lshl_add_u32 v5, v73, 3, v5
v_add_u32 v5, s47, v5
s_mov_b32 s80, 0x55555555
s_mov_b32 s81, 0x55555555
s_mov_b32 s82, 0xaaaaaaaa
s_mov_b32 s83, 0xaaaaaaaa
v_lshl_add_u32 v109, v7, 4, s93
v_lshl_add_u32 v89, v7, 2, s93
v_mov_b32 v76, 0
v_mov_b32 v77, 0
v_mov_b32 v78, 0
v_mov_b32 v79, 0
v_mov_b32 v90, 0xdddddddd
ds_write_b128 v109, v[76:79]
ds_write_b32 v89, v90 offset:1792
ds_write_b32 v89, v90 offset:2048
ds_write_b32 v89, v90 offset:2304
ds_write_b32 v89, v90 offset:2560
ds_write_b32 v89, v90 offset:2816
ds_write_b32 v89, v90 offset:3072
ds_write_b32 v89, v90 offset:3328
s_lshl_b32 s47, s40, 2
s_add_u32 s47, s47, 163072
v_mov_b32 v88, s47
ds_write_b32 v88, v76
s_mul_i32 s47, s40, 2304
s_add_u32 s47, s47, 373760
v_and_b32 v73, 60, v7
v_mad_u32_u24 v73, v73, 3, v7
v_lshl_add_u32 v72, v73, 4, s47
s_mov_b32 s47, 380672
v_lshl_add_u32 v73, v73, 4, s47
v_lshrrev_b32 v74, 2, v7
v_cmp_gt_u32 vcc, 36, v7
v_lshlrev_b32 v90, 11, v74
v_subrev_u32 v74, 9, v74
v_lshlrev_b32 v74, 12, v74
v_cndmask_b32 v72, v73, v72, vcc
v_cndmask_b32 v90, v74, v90, vcc
s_lshl_b32 s47, s40, 12
s_add_u32 s47, s47, 0x8001
v_mov_b32 v88, 1
v_mov_b32 v94, 0xf001
v_mov_b32 v95, s47
v_cndmask_b32 v94, v94, v88, vcc
v_cndmask_b32 v95, v95, v88, vcc
v_cndmask_b32 v96, 0, 28, vcc
v_cndmask_b32 v97, 32, 0, vcc
v_add_u32 v97, s93, v97
v_cmp_gt_u32 vcc, 56, v7
v_mov_b32 v73, 0x40000000
s_lshr_b32 s47, s2, 3
s_lshl_b32 s47, s47, 2
s_add_u32 s47, s47, s40
s_mul_i32 s47, s47, 2944
v_cndmask_b32 v72, v73, v72, vcc
v_lshl_add_u32 v93, v7, 4, s47
s_mul_i32 s47, s40, 82944
s_add_u32 s47, s47, s86
v_lshl_add_u32 v112, v7, 4, s47
s_mul_i32 s47, s40, 9216
s_add_u32 s47, s47, s86
s_add_u32 s47, s47, 331776
v_lshl_add_u32 v113, v7, 4, s47
s_lshl_b32 s47, s40, 6
s_add_u32 s47, s47, s86
s_add_u32 s47, s47, 368640
v_and_b32 v106, 15, v7
v_lshl_add_u32 v106, v106, 2, s47
v_lshrrev_b32 v107, 4, v7
v_lshl_add_u32 v106, v107, 8, v106
v_and_b32 v74, 15, v7
v_and_b32 v73, 7, v7
v_lshlrev_b32 v100, 1, v73
v_lshlrev_b32 v100, v100, v88
v_lshlrev_b32 v73, 4, v73
v_lshl_add_u32 v92, v74, 7, v73
v_lshl_or_b32 v92, v92, 16, v92
v_lshrrev_b32 v98, 5, v7
v_bfe_u32 v99, v7, 3, 2
v_lshl_add_u32 v99, v99, 6, s93
v_lshl_add_u32 v101, v7, 1, s93
v_lshrrev_b32 v102, 4, v7
v_lshl_add_u32 v102, v102, 3, s93
v_lshrrev_b32 v103, 1, v7
v_lshlrev_b32 v103, 5, v103
s_mov_b32 s89, 0
s_cmp_lg_u32 s40, 0
s_cbranch_scc1 L_ready
s_mov_b32 s3, 20015
s_mov_b32 s47, 458752
v_lshl_add_u32 v9, v7, 7, s47
s_bfe_u32 s47, s85, 0x40014
s_cmp_ge_u32 s47, 6
s_waitcnt vmcnt(15)
s_cbranch_scc1 L_deep
s_waitcnt vmcnt(0)
L_deep:
v_readfirstlane_b32 s47, v124
s_mov_b32 exec_hi, 511
s_cmp_lg_u32 s47, 1
s_cbranch_scc1 L_cwait
L_poll:
buffer_load_dword v8, v9, s[24:27], 0 offen sc1
s_sub_u32 s3, s3, 1
s_cbranch_scc1 L_giveup
s_waitcnt vmcnt(0)
v_cmp_ne_u32 vcc, 1, v8
s_nop 4
s_cbranch_vccnz L_poll
L_polled:
s_mov_b64 exec, -1
L_ready:
s_waitcnt lgkmcnt(0)
s_barrier
buffer_load_dwordx4 v[8:11], v72, s[24:27], 0 offen offset:0 sc1
buffer_load_dwordx4 v[12:15], v72, s[24:27], 0 offen offset:64 sc1
buffer_load_dwordx4 v[16:19], v72, s[24:27], 0 offen offset:128 sc1
buffer_load_dwordx4 v[20:23], v72, s[24:27], 0 offen offset:192 sc1
buffer_load_dwordx4 v[76:79], v93, s[24:27], 0 offen offset:0 sc1
buffer_load_dwordx4 v[80:83], v93, s[24:27], 0 offen offset:1024 sc1
buffer_load_dwordx4 v[84:87], v93, s[24:27], 0 offen offset:2048 sc1
buffer_load_dword v174, v106, s[24:27], 0 offen offset:0 sc1
buffer_load_dword v175, v106, s[24:27], 0 offen offset:1024 sc1
buffer_load_dword v176, v106, s[24:27], 0 offen offset:2048 sc1
buffer_load_dword v177, v106, s[24:27], 0 offen offset:3072 sc1
s_mov_b32 s99, 4096
buffer_load_dword v178, v106, s[24:27], s99 offen offset:0 sc1
s_mov_b32 s98, 0
buffer_load_dwordx4 v[138:141], v113, s[24:27], s98 offen sc1
s_mov_b32 s99, 0
buffer_load_dwordx4 a[0:3], v112, s[24:27], s99 offen offset:0 sc1
buffer_load_dwordx4 a[4:7], v112, s[24:27], s99 offen offset:1024 sc1
buffer_load_dwordx4 a[8:11], v112, s[24:27], s99 offen offset:2048 sc1
s_waitcnt vmcnt(12)
v_cmp_ne_u32 s[90:91], 0, v23
v_cmp_ne_u32 s[78:79], 0, v16
v_and_b32 v73, v94, v8
v_lshrrev_b32 v72, 10, v8
v_cmp_eq_u32 s[48:49], v73, v95
v_and_or_b32 v24, v72, v96, v97
s_mov_b64 exec, s[48:49]
ds_add_rtn_u32 v40, v24, v88
s_mov_b64 exec, -1
buffer_load_dwordx4 a[12:15], v112, s[24:27], s99 offen offset:3072 sc1
v_and_b32 v73, v94, v9
v_lshrrev_b32 v72, 10, v9
v_cmp_eq_u32 s[50:51], v73, v95
v_and_or_b32 v25, v72, v96, v97
s_mov_b64 exec, s[50:51]
ds_add_rtn_u32 v41, v25, v88
s_mov_b64 exec, -1
v_and_b32 v73, v94, v10
v_lshrrev_b32 v72, 10, v10
v_cmp_eq_u32 s[52:53], v73, v95
v_and_or_b32 v26, v72, v96, v97
s_mov_b64 exec, s[52:53]
ds_add_rtn_u32 v42, v26, v88
s_mov_b64 exec, -1
s_mov_b32 s99, 4096
buffer_load_dwordx4 a[16:19], v112, s[24:27], s99 offen offset:0 sc1
v_and_b32 v73, v94, v11
v_lshrrev_b32 v72, 10, v11
v_cmp_eq_u32 s[54:55], v73, v95
v_and_or_b32 v27, v72, v96, v97
s_mov_b64 exec, s[54:55]
ds_add_rtn_u32 v43, v27, v88
s_mov_b64 exec, -1
buffer_load_dwordx4 a[20:23], v112, s[24:27], s99 offen offset:1024 sc1
v_and_b32 v73, v94, v12
v_lshrrev_b32 v72, 10, v12
v_cmp_eq_u32 s[56:57], v73, v95
v_and_or_b32 v28, v72, v96, v97
s_mov_b64 exec, s[56:57]
ds_add_rtn_u32 v44, v28, v88
s_mov_b64 exec, -1
buffer_load_dwordx4 a[24:27], v112, s[24:27], s99 offen offset:2048 sc1
v_and_b32 v73, v94, v13
v_lshrrev_b32 v72, 10, v13
v_cmp_eq_u32 s[58:59], v73, v95
v_and_or_b32 v29, v72, v96, v97
s_mov_b64 exec, s[58:59]
ds_add_rtn_u32 v45, v29, v88
s_mov_b64 exec, -1
v_and_b32 v73, v94, v14
v_lshrrev_b32 v72, 10, v14
v_cmp_eq_u32 s[60:61], v73, v95
v_and_or_b32 v30, v72, v96, v97
s_mov_b64 exec, s[60:61]
ds_add_rtn_u32 v46, v30, v88
s_mov_b64 exec, -1
buffer_load_dwordx4 a[28:31], v112, s[24:27], s99 offen offset:3072 sc1
v_and_b32 v73, v94, v15
v_lshrrev_b32 v72, 10, v15
v_cmp_eq_u32 s[62:63], v73, v95
v_and_or_b32 v31, v72, v96, v97
s_mov_b64 exec, s[62:63]
ds_add_rtn_u32 v47, v31, v88
s_mov_b64 exec, -1
s_mov_b32 s99, 8192
buffer_load_dwordx4 a[32:35], v112, s[24:27], s99 offen offset:0 sc1
s_cmp_lg_u64 s[78:79], 0
s_cbranch_scc1 L_more1
L_more1b:
ds_read_b32 v72, v89
v_mov_b32 v73, 0
s_mov_b32 s98, 1024
buffer_load_dwordx4 v[142:145], v113, s[24:27], s98 offen sc1
buffer_load_dwordx4 a[36:39], v112, s[24:27], s99 offen offset:1024 sc1
buffer_load_dwordx4 a[40:43], v112, s[24:27], s99 offen offset:2048 sc1
s_waitcnt lgkmcnt(0)
s_mov_b64 vcc, s[80:81]
v_cndmask_b32_dpp v73, v72, v73, vcc quad_perm:[0,0,2,2] row_mask:0xf bank_mask:0xf
v_add_u32 v91, v103, v73
v_add_u32 v73, v72, v73
v_cmp_lt_u32 vcc, 32, v73
s_or_b32 s90, s90, s91
s_and_b32 s47, vcc_lo, 0x1ff
s_or_b32 s47, s47, s90
s_cbranch_scc1 L_greedy
L_greedyb:
buffer_load_dwordx4 a[44:47], v112, s[24:27], s99 offen offset:3072 sc1
ds_bpermute_b32 v56, v24, v91
ds_bpermute_b32 v57, v25, v91
ds_bpermute_b32 v58, v26, v91
ds_bpermute_b32 v59, v27, v91
ds_bpermute_b32 v60, v28, v91
ds_bpermute_b32 v61, v29, v91
ds_bpermute_b32 v62, v30, v91
ds_bpermute_b32 v63, v31, v91
s_mov_b32 s99, 12288
buffer_load_dwordx4 a[48:51], v112, s[24:27], s99 offen offset:0 sc1
buffer_load_dwordx4 a[52:55], v112, s[24:27], s99 offen offset:1024 sc1
buffer_load_dwordx4 a[56:59], v112, s[24:27], s99 offen offset:2048 sc1
s_waitcnt lgkmcnt(7)
v_add_u32 v73, v40, v56
v_and_b32 v72, 0x87e, v8
v_lshl_add_u32 v73, v73, 1, s93
v_add_u32 v72, v90, v72
s_andn2_b64 exec, s[48:49], s[90:91]
ds_write_b16_d16_hi v73, v8 offset:64
ds_write_b16 v73, v72 offset:384
ds_write_b16 v73, v8 offset:704
s_mov_b64 exec, -1
buffer_load_dwordx4 a[60:63], v112, s[24:27], s99 offen offset:3072 sc1
s_waitcnt lgkmcnt(9)
v_add_u32 v73, v41, v57
v_and_b32 v72, 0x87e, v9
v_lshl_add_u32 v73, v73, 1, s93
v_add_u32 v72, v90, v72
s_andn2_b64 exec, s[50:51], s[90:91]
ds_write_b16_d16_hi v73, v9 offset:64
ds_write_b16 v73, v72 offset:384
ds_write_b16 v73, v9 offset:704
s_mov_b64 exec, -1
s_mov_b32 s99, 16384
buffer_load_dwordx4 a[64:67], v112, s[24:27], s99 offen offset:0 sc1
s_waitcnt lgkmcnt(11)
v_add_u32 v73, v42, v58
v_and_b32 v72, 0x87e, v10
v_lshl_add_u32 v73, v73, 1, s93
v_add_u32 v72, v90, v72
s_andn2_b64 exec, s[52:53], s[90:91]
ds_write_b16_d16_hi v73, v10 offset:64
ds_write_b16 v73, v72 offset:384
ds_write_b16 v73, v10 offset:704
s_mov_b64 exec, -1
buffer_load_dwordx4 a[68:71], v112, s[24:27], s99 offen offset:1024 sc1
s_waitcnt lgkmcnt(13)
v_add_u32 v73, v43, v59
v_and_b32 v72, 0x87e, v11
v_lshl_add_u32 v73, v73, 1, s93
v_add_u32 v72, v90, v72
s_andn2_b64 exec, s[54:55], s[90:91]
ds_write_b16_d16_hi v73, v11 offset:64
ds_write_b16 v73, v72 offset:384
ds_write_b16 v73, v11 offset:704
s_mov_b64 exec, -1
s_mov_b32 s98, 2048
buffer_load_dwordx4 v[146:149], v113, s[24:27], s98 offen sc1
s_waitcnt lgkmcnt(15)
v_add_u32 v73, v44, v60
v_and_b32 v72, 0x87e, v12
v_lshl_add_u32 v73, v73, 1, s93
v_add_u32 v72, v90, v72
s_andn2_b64 exec, s[56:57], s[90:91]
ds_write_b16_d16_hi v73, v12 offset:64
ds_write_b16 v73, v72 offset:384
ds_write_b16 v73, v12 offset:704
s_mov_b64 exec, -1
buffer_load_dwordx4 a[72:75], v112, s[24:27], s99 offen offset:2048 sc1
s_waitcnt lgkmcnt(15)
v_add_u32 v73, v45, v61
v_and_b32 v72, 0x87e, v13
v_lshl_add_u32 v73, v73, 1, s93
v_add_u32 v72, v90, v72
s_andn2_b64 exec, s[58:59], s[90:91]
ds_write_b16_d16_hi v73, v13 offset:64
ds_write_b16 v73, v72 offset:384
ds_write_b16 v73, v13 offset:704
s_mov_b64 exec, -1
buffer_load_dwordx4 a[76:79], v112, s[24:27], s99 offen offset:3072 sc1
s_waitcnt lgkmcnt(15)
v_add_u32 v73, v46, v62
v_and_b32 v72, 0x87e, v14
v_lshl_add_u32 v73, v73, 1, s93
v_add_u32 v72, v90, v72
s_andn2_b64 exec, s[60:61], s[90:91]
ds_write_b16_d16_hi v73, v14 offset:64
ds_write_b16 v73, v72 offset:384
ds_write_b16 v73, v14 offset:704
s_mov_b64 exec, -1
s_mov_b32 s99, 20480
buffer_load_dwordx4 a[80:83], v112, s[24:27], s99 offen offset:0 sc1
s_waitcnt lgkmcnt(15)
v_add_u32 v73, v47, v63
v_and_b32 v72, 0x87e, v15
v_lshl_add_u32 v73, v73, 1, s93
v_add_u32 v72, v90, v72
s_andn2_b64 exec, s[62:63], s[90:91]
ds_write_b16_d16_hi v73, v15 offset:64
ds_write_b16 v73, v72 offset:384
ds_write_b16 v73, v15 offset:704
s_mov_b64 exec, -1
buffer_load_dwordx4 a[84:87], v112, s[24:27], s99 offen offset:1024 sc1
buffer_load_dwordx4 a[88:91], v112, s[24:27], s99 offen offset:2048 sc1
s_cmp_lg_u64 s[78:79], 0
s_cbranch_scc1 L_more2
L_more2b:
ds_read_u16 v8, v101 offset:704
ds_read_u16 v9, v101 offset:832
ds_read_u16 v10, v101 offset:960
ds_read2_b64 v[118:121], v102 offset0:48 offset1:52
ds_read2_b64 v[122:125], v102 offset0:56 offset1:60
ds_read2_b64 v[126:129], v102 offset0:64 offset1:68
ds_read2_b64 v[130:133], v102 offset0:72 offset1:76
ds_read2_b64 v[134:137], v102 offset0:80 offset1:84
buffer_load_dwordx4 a[92:95], v112, s[24:27], s99 offen offset:3072 sc1
s_mov_b32 s99, 24576
buffer_load_dwordx4 a[96:99], v112, s[24:27], s99 offen offset:0 sc1
buffer_load_dwordx4 a[100:103], v112, s[24:27], s99 offen offset:1024 sc1
s_waitcnt lgkmcnt(5)
v_lshrrev_b32 v72, 12, v8
v_cmp_ne_u32 vcc, 0, v8
v_min_u32 v72, 8, v72
v_add3_u32 v72, v72, v98, 0
v_lshlrev_b32 v73, 4, v72
v_lshrrev_b32 v72, 1, v72
buffer_load_dwordx4 a[104:107], v112, s[24:27], s99 offen offset:2048 sc1
v_lshlrev_b32 v73, v73, v100
v_lshl_add_u32 v72, v72, 8, v99
v_bfe_u32 v74, v8, 7, 4
v_lshl_add_u32 v72, v74, 2, v72
s_mov_b64 exec, vcc
ds_xor_b32 v72, v73 offset:1792
s_mov_b64 exec, -1
v_lshrrev_b32 v72, 12, v9
v_cmp_ne_u32 vcc, 0, v9
v_min_u32 v72, 8, v72
v_add3_u32 v72, v72, v98, 2
v_lshlrev_b32 v73, 4, v72
v_lshrrev_b32 v72, 1, v72
s_mov_b32 s98, 3072
buffer_load_dwordx4 v[150:153], v113, s[24:27], s98 offen sc1
v_lshlrev_b32 v73, v73, v100
v_lshl_add_u32 v72, v72, 8, v99
v_bfe_u32 v74, v9, 7, 4
v_lshl_add_u32 v72, v74, 2, v72
s_mov_b64 exec, vcc
ds_xor_b32 v72, v73 offset:1792
s_mov_b64 exec, -1
buffer_load_dwordx4 a[108:111], v112, s[24:27], s99 offen offset:3072 sc1
v_lshrrev_b32 v72, 12, v10
v_cmp_ne_u32 vcc, 0, v10
v_min_u32 v72, 8, v72
v_add3_u32 v72, v72, v98, 4
v_lshlrev_b32 v73, 4, v72
v_lshrrev_b32 v72, 1, v72
v_lshlrev_b32 v73, v73, v100
v_lshl_add_u32 v72, v72, 8, v99
v_bfe_u32 v74, v10, 7, 4
v_lshl_add_u32 v72, v74, 2, v72
s_mov_b64 exec, vcc
s_mov_b32 exec_hi, 0
ds_xor_b32 v72, v73 offset:1792
s_mov_b64 exec, -1
s_mov_b32 s99, 28672
buffer_load_dwordx4 a[112:115], v112, s[24:27], s99 offen offset:0 sc1
ds_read_b32 v179, v89 offset:1792
ds_read_b32 v180, v89 offset:2048
ds_read_b32 v181, v89 offset:2304
ds_read_b32 v182, v89 offset:2560
ds_read_b32 v183, v89 offset:2816
ds_read_b32 v184, v89 offset:3072
ds_read_b32 v185, v89 offset:3328
buffer_load_dwordx4 a[116:119], v112, s[24:27], s99 offen offset:1024 sc1
s_waitcnt lgkmcnt(10)
v_xor_b32 v118, v92, v118
v_xor_b32 v119, v92, v119
v_xor_b32 v120, v92, v120
v_xor_b32 v121, v92, v121
buffer_load_dwordx4 a[120:123], v112, s[24:27], s99 offen offset:2048 sc1
v_xor_b32 v122, v92, v122
v_xor_b32 v123, v92, v123
v_xor_b32 v124, v92, v124
v_xor_b32 v125, v92, v125
v_xor_b32 v126, v92, v126
v_xor_b32 v127, v92, v127
v_xor_b32 v128, v92, v128
v_xor_b32 v129, v92, v129
buffer_load_dwordx4 a[124:127], v112, s[24:27], s99 offen offset:3072 sc1
v_xor_b32 v130, v92, v130
v_xor_b32 v131, v92, v131
v_xor_b32 v132, v92, v132
v_xor_b32 v133, v92, v133
v_xor_b32 v134, v92, v134
v_xor_b32 v135, v92, v135
v_xor_b32 v136, v92, v136
v_xor_b32 v137, v92, v137
v_lshlrev_b32 v114, 16, v110
v_and_b32 v115, 0xffff0000, v110
v_lshlrev_b32 v116, 16, v111
v_and_b32 v117, 0xffff0000, v111
s_mov_b32 exec_hi, 15
ds_write_b128 v109, v[114:117] offset:1024
s_mov_b64 exec, -1
s_mov_b32 s99, 32768
buffer_load_dwordx4 a[128:131], v112, s[24:27], s99 offen offset:0 sc1
s_mov_b32 s41, 2
s_mov_b32 s42, 0
s_mov_b32 s4, 37120
s_mov_b32 s22, 75497472
s_mov_b32 s5, 18560
s_mov_b32 s6, 4718592
s_mov_b64 vcc, s[80:81]
s_andn2_b32 s12, 63, s85
s_mov_b32 s59, 6
s_mov_b32 s56, 0
s_mov_b32 s64, 384
s_bitcmp1_b32 s2, 0
s_cselect_b32 s65, 288, -1
s_add_u32 s48, s46, 9437184
s_add_u32 s49, s48, 4718592
s_add_u32 s50, s49, 4718592
s_sub_u32 s58, s7, s45
s_bfe_u32 s47, s2, 0x20004
s_mul_i32 s57, s47, 294912
s_add_u32 s57, s57, 47185920
s_lshl_b32 s47, s47, 7
s_add_u32 s47, s47, 393216
s_add_u32 s32, s24, s47
s_addc_u32 s33, s25, 0
s_cmp_eq_u32 s40, 0
s_cselect_b32 s34, 4, 0
s_cselect_b64 s[62:63], 1, 0
s_waitcnt lgkmcnt(0)
v_mov_b32 v114, 163072
s_barrier
ds_read_b32 v114, v114
ds_read_b128 v[44:47], v0 offset:0
ds_read_b128 v[48:51], v1 offset:0
s_waitcnt vmcnt(18)
ds_read_b128 v[76:79], v2 offset:1024
ds_read_b128 v[80:83], v2 offset:1088
ds_read_b128 v[84:87], v2 offset:1152
ds_read_b128 v[88:91], v2 offset:1216
ds_read_b128 v[92:95], v2 offset:1280
ds_read_b128 v[96:99], v2 offset:1344
ds_read_b128 v[100:103], v2 offset:1408
ds_read_b128 v[104:107], v2 offset:1472
ds_read_b128 v[108:111], v2 offset:1536
buffer_load_dwordx4 a[132:135], v112, s[24:27], s99 offen offset:1024 sc1
ds_read_b128 v[8:11], v2 offset:1024
ds_read_b128 v[12:15], v2 offset:1088
ds_read_b128 v[16:19], v2 offset:1152
ds_read_b128 v[20:23], v2 offset:1216
ds_read_b128 v[24:27], v2 offset:1280
ds_read_b128 v[28:31], v2 offset:1344
ds_read_b128 v[32:35], v2 offset:1408
ds_read_b128 v[36:39], v2 offset:1472
ds_read_b128 v[40:43], v2 offset:1536
buffer_load_dwordx4 a[136:139], v112, s[24:27], s99 offen offset:2048 sc1
s_waitcnt lgkmcnt(15)
v_readfirstlane_b32 s47, v114
v_add_u32_sdwa v60, s42, v118 dst_sel:DWORD dst_unused:UNUSED_PAD src0_sel:DWORD src1_sel:WORD_0
s_cmp_lg_u32 s47, 0
s_cbranch_scc1 L_slow
v_smfmac_f32_16x16x64_bf16 v[76:79], a[0:3], v[44:51], v138
ds_read_b128 v[52:55], v0 offset:18560
ds_read_b128 v[56:59], v1 offset:18560
v_add_u32_sdwa v68, s42, v118 dst_sel:DWORD dst_unused:UNUSED_PAD src0_sel:DWORD src1_sel:WORD_0
v_smfmac_f32_16x16x64_bf16 v[80:83], a[4:7], v[44:51], v138 abid:1
ds_read_u16 v68, v68 offset:18560
v_add_u32_sdwa v69, s42, v118 dst_sel:DWORD dst_unused:UNUSED_PAD src0_sel:DWORD src1_sel:WORD_1
v_smfmac_f32_16x16x64_bf16 v[84:87], a[8:11], v[44:51], v139
s_waitcnt lgkmcnt(15)
buffer_load_dwordx4 a[140:143], v112, s[24:27], s99 offen offset:3072 sc1
ds_read_u16 v69, v69 offset:18560
v_add_u32_sdwa v70, s42, v119 dst_sel:DWORD dst_unused:UNUSED_PAD src0_sel:DWORD src1_sel:WORD_0
v_smfmac_f32_16x16x64_bf16 v[88:91], a[12:15], v[44:51], v139 abid:1
ds_read_u16 v70, v70 offset:18560
v_add_u32_sdwa v71, s42, v119 dst_sel:DWORD dst_unused:UNUSED_PAD src0_sel:DWORD src1_sel:WORD_1
v_smfmac_f32_16x16x64_bf16 v[92:95], a[16:19], v[44:51], v140
ds_read_u16 v71, v71 offset:18560
v_add_u32_sdwa v72, s42, v120 dst_sel:DWORD dst_unused:UNUSED_PAD src0_sel:DWORD src1_sel:WORD_0
v_smfmac_f32_16x16x64_bf16 v[96:99], a[20:23], v[44:51], v140 abid:1
s_waitcnt lgkmcnt(15)
s_mov_b32 s98, 4096
buffer_load_dwordx4 v[154:157], v113, s[24:27], s98 offen sc1
ds_read_u16 v72, v72 offset:18560
v_add_u32_sdwa v73, s42, v120 dst_sel:DWORD dst_unused:UNUSED_PAD src0_sel:DWORD src1_sel:WORD_1
v_smfmac_f32_16x16x64_bf16 v[100:103], a[24:27], v[44:51], v141
ds_read_u16 v73, v73 offset:18560
v_add_u32_sdwa v74, s42, v121 dst_sel:DWORD dst_unused:UNUSED_PAD src0_sel:DWORD src1_sel:WORD_0
v_smfmac_f32_16x16x64_bf16 v[104:107], a[28:31], v[44:51], v141 abid:1
ds_read_u16 v74, v74 offset:18560
v_add_u32_sdwa v75, s42, v121 dst_sel:DWORD dst_unused:UNUSED_PAD src0_sel:DWORD src1_sel:WORD_1
v_smfmac_f32_16x16x64_bf16 v[108:111], a[32:35], v[44:51], v174
s_waitcnt lgkmcnt(7)
s_mov_b32 s99, 36864
buffer_load_dwordx4 a[144:147], v112, s[24:27], s99 offen offset:0 sc1
ds_read_u16 v75, v75 offset:18560
v_smfmac_f32_16x16x64_bf16 v[8:11], a[0:3], v[52:59], v138
ds_read_b128 v[114:117], v2 offset:64
v_add_u32_sdwa v60, s42, v118 dst_sel:DWORD dst_unused:UNUSED_PAD src0_sel:DWORD src1_sel:WORD_0
v_smfmac_f32_16x16x64_bf16 v[12:15], a[4:7], v[52:59], v138 abid:1
ds_read_b128 v[44:47], v0 offset:2048
v_add_u32_sdwa v61, s42, v118 dst_sel:DWORD dst_unused:UNUSED_PAD src0_sel:DWORD src1_sel:WORD_1
v_smfmac_f32_16x16x64_bf16 v[16:19], a[8:11], v[52:59], v139
buffer_load_dwordx4 a[148:151], v112, s[24:27], s99 offen offset:1024 sc1
ds_read_b128 v[48:51], v1 offset:2048
v_add_u32_sdwa v62, s42, v119 dst_sel:DWORD dst_unused:UNUSED_PAD src0_sel:DWORD src1_sel:WORD_0
v_smfmac_f32_16x16x64_bf16 v[20:23], a[12:15], v[52:59], v139 abid:1
ds_read_u16 v60, v60 offset:0
v_add_u32_sdwa v63, s42, v119 dst_sel:DWORD dst_unused:UNUSED_PAD src0_sel:DWORD src1_sel:WORD_1
v_smfmac_f32_16x16x64_bf16 v[24:27], a[16:19], v[52:59], v140
ds_read_u16 v61, v61 offset:0
v_add_u32_sdwa v64, s42, v120 dst_sel:DWORD dst_unused:UNUSED_PAD src0_sel:DWORD src1_sel:WORD_0
v_smfmac_f32_16x16x64_bf16 v[28:31], a[20:23], v[52:59], v140 abid:1
buffer_load_dwordx4 a[152:155], v112, s[24:27], s99 offen offset:2048 sc1
ds_read_u16 v62, v62 offset:0
v_add_u32_sdwa v65, s42, v120 dst_sel:DWORD dst_unused:UNUSED_PAD src0_sel:DWORD src1_sel:WORD_1
v_smfmac_f32_16x16x64_bf16 v[32:35], a[24:27], v[52:59], v141
ds_read_u16 v63, v63 offset:0
v_add_u32_sdwa v66, s42, v121 dst_sel:DWORD dst_unused:UNUSED_PAD src0_sel:DWORD src1_sel:WORD_0
v_smfmac_f32_16x16x64_bf16 v[36:39], a[28:31], v[52:59], v141 abid:1
ds_read_u16 v64, v64 offset:0
v_add_u32_sdwa v67, s42, v121 dst_sel:DWORD dst_unused:UNUSED_PAD src0_sel:DWORD src1_sel:WORD_1
v_smfmac_f32_16x16x64_bf16 v[40:43], a[32:35], v[52:59], v174
s_waitcnt lgkmcnt(7)
buffer_load_dwordx4 a[156:159], v112, s[24:27], s99 offen offset:3072 sc1
ds_read_u16 v65, v65 offset:0
v_smfmac_f32_16x16x64_bf16 v[8:11], v[114:117], v[68:75], v179
ds_read_u16 v66, v66 offset:0
v_smfmac_f32_16x16x64_bf16 v[12:15], v[114:117], v[68:75], v179 abid:1
s_waitcnt lgkmcnt(7)
ds_read_u16 v67, v67 offset:0
v_smfmac_f32_16x16x64_bf16 v[76:79], a[36:39], v[44:51], v142
s_mov_b32 s99, 40960
buffer_load_dwordx4 a[160:163], v112, s[24:27], s99 offen offset:0 sc1
ds_read_b128 v[52:55], v0 offset:20608
v_add_u32_sdwa v68, s42, v122 dst_sel:DWORD dst_unused:UNUSED_PAD src0_sel:DWORD src1_sel:WORD_0
v_smfmac_f32_16x16x64_bf16 v[80:83], a[40:43], v[44:51], v142 abid:1
ds_read_b128 v[56:59], v1 offset:20608
v_add_u32_sdwa v69, s42, v122 dst_sel:DWORD dst_unused:UNUSED_PAD src0_sel:DWORD src1_sel:WORD_1
v_smfmac_f32_16x16x64_bf16 v[84:87], a[44:47], v[44:51], v143
ds_read_u16 v68, v68 offset:18560
v_add_u32_sdwa v70, s42, v123 dst_sel:DWORD dst_unused:UNUSED_PAD src0_sel:DWORD src1_sel:WORD_0
v_smfmac_f32_16x16x64_bf16 v[88:91], a[48:51], v[44:51], v143 abid:1
buffer_load_dwordx4 a[164:167], v112, s[24:27], s99 offen offset:1024 sc1
ds_read_u16 v69, v69 offset:18560
v_add_u32_sdwa v71, s42, v123 dst_sel:DWORD dst_unused:UNUSED_PAD src0_sel:DWORD src1_sel:WORD_1
v_smfmac_f32_16x16x64_bf16 v[92:95], a[52:55], v[44:51], v144
ds_read_u16 v70, v70 offset:18560
v_add_u32_sdwa v72, s42, v124 dst_sel:DWORD dst_unused:UNUSED_PAD src0_sel:DWORD src1_sel:WORD_0
v_smfmac_f32_16x16x64_bf16 v[96:99], a[56:59], v[44:51], v144 abid:1
ds_read_u16 v71, v71 offset:18560
v_add_u32_sdwa v73, s42, v124 dst_sel:DWORD dst_unused:UNUSED_PAD src0_sel:DWORD src1_sel:WORD_1
v_smfmac_f32_16x16x64_bf16 v[100:103], a[60:63], v[44:51], v145
buffer_load_dwordx4 a[168:171], v112, s[24:27], s99 offen offset:2048 sc1
ds_read_u16 v72, v72 offset:18560
v_add_u32_sdwa v74, s42, v125 dst_sel:DWORD dst_unused:UNUSED_PAD src0_sel:DWORD src1_sel:WORD_0
v_smfmac_f32_16x16x64_bf16 v[104:107], a[64:67], v[44:51], v145 abid:1
s_waitcnt vmcnt(18)
ds_read_u16 v73, v73 offset:18560
v_add_u32_sdwa v75, s42, v125 dst_sel:DWORD dst_unused:UNUSED_PAD src0_sel:DWORD src1_sel:WORD_1
v_smfmac_f32_16x16x64_bf16 v[108:111], a[68:71], v[44:51], v174 abid:1
s_waitcnt lgkmcnt(8)
ds_read_u16 v74, v74 offset:18560
v_smfmac_f32_16x16x64_bf16 v[76:79], v[114:117], v[60:67], v179
buffer_load_dwordx4 a[172:175], v112, s[24:27], s99 offen offset:3072 sc1
ds_read_u16 v75, v75 offset:18560
v_smfmac_f32_16x16x64_bf16 v[80:83], v[114:117], v[60:67], v179 abid:1
s_waitcnt lgkmcnt(8)
v_smfmac_f32_16x16x64_bf16 v[8:11], a[36:39], v[52:59], v142
ds_read_b128 v[114:117], v2 offset:128
v_add_u32_sdwa v60, s42, v122 dst_sel:DWORD dst_unused:UNUSED_PAD src0_sel:DWORD src1_sel:WORD_0
v_smfmac_f32_16x16x64_bf16 v[12:15], a[40:43], v[52:59], v142 abid:1
s_mov_b32 s99, 45056
buffer_load_dwordx4 a[176:179], v112, s[24:27], s99 offen offset:0 sc1
ds_read_b128 v[44:47], v0 offset:4096
v_add_u32_sdwa v61, s42, v122 dst_sel:DWORD dst_unused:UNUSED_PAD src0_sel:DWORD src1_sel:WORD_1
v_smfmac_f32_16x16x64_bf16 v[16:19], a[44:47], v[52:59], v143
ds_read_b128 v[48:51], v1 offset:4096
v_add_u32_sdwa v62, s42, v123 dst_sel:DWORD dst_unused:UNUSED_PAD src0_sel:DWORD src1_sel:WORD_0
v_smfmac_f32_16x16x64_bf16 v[20:23], a[48:51], v[52:59], v143 abid:1
ds_read_u16 v60, v60 offset:0
v_add_u32_sdwa v63, s42, v123 dst_sel:DWORD dst_unused:UNUSED_PAD src0_sel:DWORD src1_sel:WORD_1
v_smfmac_f32_16x16x64_bf16 v[24:27], a[52:55], v[52:59], v144
s_mov_b32 s98, 5120
buffer_load_dwordx4 v[158:161], v113, s[24:27], s98 offen sc1
ds_read_u16 v61, v61 offset:0
v_add_u32_sdwa v64, s42, v124 dst_sel:DWORD dst_unused:UNUSED_PAD src0_sel:DWORD src1_sel:WORD_0
v_smfmac_f32_16x16x64_bf16 v[28:31], a[56:59], v[52:59], v144 abid:1
ds_read_u16 v62, v62 offset:0
v_add_u32_sdwa v65, s42, v124 dst_sel:DWORD dst_unused:UNUSED_PAD src0_sel:DWORD src1_sel:WORD_1
v_smfmac_f32_16x16x64_bf16 v[32:35], a[60:63], v[52:59], v145
ds_read_u16 v63, v63 offset:0
v_add_u32_sdwa v66, s42, v125 dst_sel:DWORD dst_unused:UNUSED_PAD src0_sel:DWORD src1_sel:WORD_0
v_smfmac_f32_16x16x64_bf16 v[36:39], a[64:67], v[52:59], v145 abid:1
buffer_load_dwordx4 a[180:183], v112, s[24:27], s99 offen offset:1024 sc1
ds_read_u16 v64, v64 offset:0
v_add_u32_sdwa v67, s42, v125 dst_sel:DWORD dst_unused:UNUSED_PAD src0_sel:DWORD src1_sel:WORD_1
v_smfmac_f32_16x16x64_bf16 v[40:43], a[68:71], v[52:59], v174 abid:1
s_waitcnt lgkmcnt(7)
ds_read_u16 v65, v65 offset:0
v_smfmac_f32_16x16x64_bf16 v[12:15], v[114:117], v[68:75], v180
ds_read_u16 v66, v66 offset:0
v_smfmac_f32_16x16x64_bf16 v[16:19], v[114:117], v[68:75], v180 abid:1
buffer_load_dwordx4 a[184:187], v112, s[24:27], s99 offen offset:2048 sc1
ds_read_u16 v67, v67 offset:0
v_smfmac_f32_16x16x64_bf16 v[20:23], v[114:117], v[68:75], v181
s_waitcnt lgkmcnt(8)
v_smfmac_f32_16x16x64_bf16 v[76:79], a[72:75], v[44:51], v146
ds_read_b128 v[52:55], v0 offset:22656
v_add_u32_sdwa v68, s42, v126 dst_sel:DWORD dst_unused:UNUSED_PAD src0_sel:DWORD src1_sel:WORD_0
v_smfmac_f32_16x16x64_bf16 v[80:83], a[76:79], v[44:51], v146 abid:1
buffer_load_dwordx4 a[188:191], v112, s[24:27], s99 offen offset:3072 sc1
ds_read_b128 v[56:59], v1 offset:22656
v_add_u32_sdwa v69, s42, v126 dst_sel:DWORD dst_unused:UNUSED_PAD src0_sel:DWORD src1_sel:WORD_1
v_smfmac_f32_16x16x64_bf16 v[84:87], a[80:83], v[44:51], v147
ds_read_u16 v68, v68 offset:18560
v_add_u32_sdwa v70, s42, v127 dst_sel:DWORD dst_unused:UNUSED_PAD src0_sel:DWORD src1_sel:WORD_0
v_smfmac_f32_16x16x64_bf16 v[88:91], a[84:87], v[44:51], v147 abid:1
ds_read_u16 v69, v69 offset:18560
v_add_u32_sdwa v71, s42, v127 dst_sel:DWORD dst_unused:UNUSED_PAD src0_sel:DWORD src1_sel:WORD_1
v_smfmac_f32_16x16x64_bf16 v[92:95], a[88:91], v[44:51], v148
s_mov_b32 s99, 49152
buffer_load_dwordx4 a[192:195], v112, s[24:27], s99 offen offset:0 sc1
ds_read_u16 v70, v70 offset:18560
v_add_u32_sdwa v72, s42, v128 dst_sel:DWORD dst_unused:UNUSED_PAD src0_sel:DWORD src1_sel:WORD_0
v_smfmac_f32_16x16x64_bf16 v[96:99], a[92:95], v[44:51], v148 abid:1
ds_read_u16 v71, v71 offset:18560
v_add_u32_sdwa v73, s42, v128 dst_sel:DWORD dst_unused:UNUSED_PAD src0_sel:DWORD src1_sel:WORD_1
v_smfmac_f32_16x16x64_bf16 v[100:103], a[96:99], v[44:51], v149
ds_read_u16 v72, v72 offset:18560
v_add_u32_sdwa v74, s42, v129 dst_sel:DWORD dst_unused:UNUSED_PAD src0_sel:DWORD src1_sel:WORD_0
v_smfmac_f32_16x16x64_bf16 v[104:107], a[100:103], v[44:51], v149 abid:1
buffer_load_dwordx4 a[196:199], v112, s[24:27], s99 offen offset:1024 sc1
ds_read_u16 v73, v73 offset:18560
v_add_u32_sdwa v75, s42, v129 dst_sel:DWORD dst_unused:UNUSED_PAD src0_sel:DWORD src1_sel:WORD_1
v_smfmac_f32_16x16x64_bf16 v[108:111], a[104:107], v[44:51], v175
s_waitcnt lgkmcnt(8)
ds_read_u16 v74, v74 offset:18560
v_smfmac_f32_16x16x64_bf16 v[80:83], v[114:117], v[60:67], v180
ds_read_u16 v75, v75 offset:18560
v_smfmac_f32_16x16x64_bf16 v[84:87], v[114:117], v[60:67], v180 abid:1
buffer_load_dwordx4 a[200:203], v112, s[24:27], s99 offen offset:2048 sc1
v_smfmac_f32_16x16x64_bf16 v[88:91], v[114:117], v[60:67], v181
s_waitcnt lgkmcnt(8)
v_smfmac_f32_16x16x64_bf16 v[8:11], a[72:75], v[52:59], v146
ds_read_b128 v[114:117], v2 offset:192
v_add_u32_sdwa v60, s42, v126 dst_sel:DWORD dst_unused:UNUSED_PAD src0_sel:DWORD src1_sel:WORD_0
v_smfmac_f32_16x16x64_bf16 v[12:15], a[76:79], v[52:59], v146 abid:1
buffer_load_dwordx4 a[204:207], v112, s[24:27], s99 offen offset:3072 sc1
ds_read_b128 v[44:47], v0 offset:6144
v_add_u32_sdwa v61, s42, v126 dst_sel:DWORD dst_unused:UNUSED_PAD src0_sel:DWORD src1_sel:WORD_1
v_smfmac_f32_16x16x64_bf16 v[16:19], a[80:83], v[52:59], v147
ds_read_b128 v[48:51], v1 offset:6144
v_add_u32_sdwa v62, s42, v127 dst_sel:DWORD dst_unused:UNUSED_PAD src0_sel:DWORD src1_sel:WORD_0
v_smfmac_f32_16x16x64_bf16 v[20:23], a[84:87], v[52:59], v147 abid:1
ds_read_u16 v60, v60 offset:0
v_add_u32_sdwa v63, s42, v127 dst_sel:DWORD dst_unused:UNUSED_PAD src0_sel:DWORD src1_sel:WORD_1
v_smfmac_f32_16x16x64_bf16 v[24:27], a[88:91], v[52:59], v148
s_mov_b32 s99, 53248
buffer_load_dwordx4 a[208:211], v112, s[24:27], s99 offen offset:0 sc1
ds_read_u16 v61, v61 offset:0
v_add_u32_sdwa v64, s42, v128 dst_sel:DWORD dst_unused:UNUSED_PAD src0_sel:DWORD src1_sel:WORD_0
v_smfmac_f32_16x16x64_bf16 v[28:31], a[92:95], v[52:59], v148 abid:1
ds_read_u16 v62, v62 offset:0
v_add_u32_sdwa v65, s42, v128 dst_sel:DWORD dst_unused:UNUSED_PAD src0_sel:DWORD src1_sel:WORD_1
v_smfmac_f32_16x16x64_bf16 v[32:35], a[96:99], v[52:59], v149
ds_read_u16 v63, v63 offset:0
v_add_u32_sdwa v66, s42, v129 dst_sel:DWORD dst_unused:UNUSED_PAD src0_sel:DWORD src1_sel:WORD_0
v_smfmac_f32_16x16x64_bf16 v[36:39], a[100:103], v[52:59], v149 abid:1
buffer_load_dwordx4 a[212:215], v112, s[24:27], s99 offen offset:1024 sc1
ds_read_u16 v64, v64 offset:0
v_add_u32_sdwa v67, s42, v129 dst_sel:DWORD dst_unused:UNUSED_PAD src0_sel:DWORD src1_sel:WORD_1
v_smfmac_f32_16x16x64_bf16 v[40:43], a[104:107], v[52:59], v175
s_waitcnt lgkmcnt(7)
ds_read_u16 v65, v65 offset:0
v_smfmac_f32_16x16x64_bf16 v[20:23], v[114:117], v[68:75], v181 abid:1
ds_read_u16 v66, v66 offset:0
v_smfmac_f32_16x16x64_bf16 v[24:27], v[114:117], v[68:75], v182
s_mov_b32 s98, 6144
buffer_load_dwordx4 v[162:165], v113, s[24:27], s98 offen sc1
ds_read_u16 v67, v67 offset:0
v_smfmac_f32_16x16x64_bf16 v[28:31], v[114:117], v[68:75], v182 abid:1
s_waitcnt vmcnt(18) lgkmcnt(8)
v_smfmac_f32_16x16x64_bf16 v[76:79], a[108:111], v[44:51], v150
ds_read_b128 v[52:55], v0 offset:24704
v_add_u32_sdwa v68, s42, v130 dst_sel:DWORD dst_unused:UNUSED_PAD src0_sel:DWORD src1_sel:WORD_0
v_smfmac_f32_16x16x64_bf16 v[80:83], a[112:115], v[44:51], v150 abid:1
buffer_load_dwordx4 a[216:219], v112, s[24:27], s99 offen offset:2048 sc1
ds_read_b128 v[56:59], v1 offset:24704
v_add_u32_sdwa v69, s42, v130 dst_sel:DWORD dst_unused:UNUSED_PAD src0_sel:DWORD src1_sel:WORD_1
v_smfmac_f32_16x16x64_bf16 v[84:87], a[116:119], v[44:51], v151
ds_read_u16 v68, v68 offset:18560
v_add_u32_sdwa v70, s42, v131 dst_sel:DWORD dst_unused:UNUSED_PAD src0_sel:DWORD src1_sel:WORD_0
v_smfmac_f32_16x16x64_bf16 v[88:91], a[120:123], v[44:51], v151 abid:1
ds_read_u16 v69, v69 offset:18560
v_add_u32_sdwa v71, s42, v131 dst_sel:DWORD dst_unused:UNUSED_PAD src0_sel:DWORD src1_sel:WORD_1
v_smfmac_f32_16x16x64_bf16 v[92:95], a[124:127], v[44:51], v152
buffer_load_dwordx4 a[220:223], v112, s[24:27], s99 offen offset:3072 sc1
ds_read_u16 v70, v70 offset:18560
v_add_u32_sdwa v72, s42, v132 dst_sel:DWORD dst_unused:UNUSED_PAD src0_sel:DWORD src1_sel:WORD_0
v_smfmac_f32_16x16x64_bf16 v[96:99], a[128:131], v[44:51], v152 abid:1
ds_read_u16 v71, v71 offset:18560
v_add_u32_sdwa v73, s42, v132 dst_sel:DWORD dst_unused:UNUSED_PAD src0_sel:DWORD src1_sel:WORD_1
v_smfmac_f32_16x16x64_bf16 v[100:103], a[132:135], v[44:51], v153
ds_read_u16 v72, v72 offset:18560
v_add_u32_sdwa v74, s42, v133 dst_sel:DWORD dst_unused:UNUSED_PAD src0_sel:DWORD src1_sel:WORD_0
v_smfmac_f32_16x16x64_bf16 v[104:107], a[136:139], v[44:51], v153 abid:1
s_mov_b32 s99, 57344
buffer_load_dwordx4 a[224:227], v112, s[24:27], s99 offen offset:0 sc1
ds_read_u16 v73, v73 offset:18560
v_add_u32_sdwa v75, s42, v133 dst_sel:DWORD dst_unused:UNUSED_PAD src0_sel:DWORD src1_sel:WORD_1
v_smfmac_f32_16x16x64_bf16 v[108:111], a[140:143], v[44:51], v175 abid:1
s_waitcnt lgkmcnt(8)
ds_read_u16 v74, v74 offset:18560
v_smfmac_f32_16x16x64_bf16 v[88:91], v[114:117], v[60:67], v181 abid:1
buffer_load_dwordx4 a[228:231], v112, s[24:27], s99 offen offset:1024 sc1
ds_read_u16 v75, v75 offset:18560
v_smfmac_f32_16x16x64_bf16 v[92:95], v[114:117], v[60:67], v182
v_smfmac_f32_16x16x64_bf16 v[96:99], v[114:117], v[60:67], v182 abid:1
s_waitcnt lgkmcnt(8)
v_smfmac_f32_16x16x64_bf16 v[8:11], a[108:111], v[52:59], v150
buffer_load_dwordx4 a[232:235], v112, s[24:27], s99 offen offset:2048 sc1
ds_read_b128 v[114:117], v2 offset:256
v_add_u32_sdwa v60, s42, v130 dst_sel:DWORD dst_unused:UNUSED_PAD src0_sel:DWORD src1_sel:WORD_0
v_smfmac_f32_16x16x64_bf16 v[12:15], a[112:115], v[52:59], v150 abid:1
ds_read_b128 v[44:47], v0 offset:8192
v_add_u32_sdwa v61, s42, v130 dst_sel:DWORD dst_unused:UNUSED_PAD src0_sel:DWORD src1_sel:WORD_1
v_smfmac_f32_16x16x64_bf16 v[16:19], a[116:119], v[52:59], v151
ds_read_b128 v[48:51], v1 offset:8192
v_add_u32_sdwa v62, s42, v131 dst_sel:DWORD dst_unused:UNUSED_PAD src0_sel:DWORD src1_sel:WORD_0
v_smfmac_f32_16x16x64_bf16 v[20:23], a[120:123], v[52:59], v151 abid:1
buffer_load_dwordx4 a[236:239], v112, s[24:27], s99 offen offset:3072 sc1
ds_read_u16 v60, v60 offset:0
v_add_u32_sdwa v63, s42, v131 dst_sel:DWORD dst_unused:UNUSED_PAD src0_sel:DWORD src1_sel:WORD_1
v_smfmac_f32_16x16x64_bf16 v[24:27], a[124:127], v[52:59], v152
ds_read_u16 v61, v61 offset:0
v_add_u32_sdwa v64, s42, v132 dst_sel:DWORD dst_unused:UNUSED_PAD src0_sel:DWORD src1_sel:WORD_0
v_smfmac_f32_16x16x64_bf16 v[28:31], a[128:131], v[52:59], v152 abid:1
ds_read_u16 v62, v62 offset:0
v_add_u32_sdwa v65, s42, v132 dst_sel:DWORD dst_unused:UNUSED_PAD src0_sel:DWORD src1_sel:WORD_1
v_smfmac_f32_16x16x64_bf16 v[32:35], a[132:135], v[52:59], v153
s_mov_b32 s99, 61440
buffer_load_dwordx4 a[240:243], v112, s[24:27], s99 offen offset:0 sc1
ds_read_u16 v63, v63 offset:0
v_add_u32_sdwa v66, s42, v133 dst_sel:DWORD dst_unused:UNUSED_PAD src0_sel:DWORD src1_sel:WORD_0
v_smfmac_f32_16x16x64_bf16 v[36:39], a[136:139], v[52:59], v153 abid:1
ds_read_u16 v64, v64 offset:0
v_add_u32_sdwa v67, s42, v133 dst_sel:DWORD dst_unused:UNUSED_PAD src0_sel:DWORD src1_sel:WORD_1
v_smfmac_f32_16x16x64_bf16 v[40:43], a[140:143], v[52:59], v175 abid:1
s_waitcnt lgkmcnt(7)
ds_read_u16 v65, v65 offset:0
v_smfmac_f32_16x16x64_bf16 v[28:31], v[114:117], v[68:75], v183
buffer_load_dwordx4 a[244:247], v112, s[24:27], s99 offen offset:1024 sc1
ds_read_u16 v66, v66 offset:0
v_smfmac_f32_16x16x64_bf16 v[32:35], v[114:117], v[68:75], v183 abid:1
ds_read_u16 v67, v67 offset:0
v_smfmac_f32_16x16x64_bf16 v[36:39], v[114:117], v[68:75], v184
s_waitcnt lgkmcnt(8)
v_smfmac_f32_16x16x64_bf16 v[76:79], a[144:147], v[44:51], v154
buffer_load_dwordx4 a[248:251], v112, s[24:27], s99 offen offset:2048 sc1
ds_read_b128 v[52:55], v0 offset:26752
v_add_u32_sdwa v68, s42, v134 dst_sel:DWORD dst_unused:UNUSED_PAD src0_sel:DWORD src1_sel:WORD_0
v_smfmac_f32_16x16x64_bf16 v[80:83], a[148:151], v[44:51], v154 abid:1
s_waitcnt vmcnt(18)
ds_read_b128 v[56:59], v1 offset:26752
v_add_u32_sdwa v69, s42, v134 dst_sel:DWORD dst_unused:UNUSED_PAD src0_sel:DWORD src1_sel:WORD_1
v_smfmac_f32_16x16x64_bf16 v[84:87], a[152:155], v[44:51], v155
ds_read_u16 v68, v68 offset:18560
v_add_u32_sdwa v70, s42, v135 dst_sel:DWORD dst_unused:UNUSED_PAD src0_sel:DWORD src1_sel:WORD_0
v_smfmac_f32_16x16x64_bf16 v[88:91], a[156:159], v[44:51], v155 abid:1
s_mov_b32 s98, 7168
buffer_load_dwordx4 v[166:169], v113, s[24:27], s98 offen sc1
ds_read_u16 v69, v69 offset:18560
v_add_u32_sdwa v71, s42, v135 dst_sel:DWORD dst_unused:UNUSED_PAD src0_sel:DWORD src1_sel:WORD_1
v_smfmac_f32_16x16x64_bf16 v[92:95], a[160:163], v[44:51], v156
ds_read_u16 v70, v70 offset:18560
v_add_u32_sdwa v72, s42, v136 dst_sel:DWORD dst_unused:UNUSED_PAD src0_sel:DWORD src1_sel:WORD_0
v_smfmac_f32_16x16x64_bf16 v[96:99], a[164:167], v[44:51], v156 abid:1
ds_read_u16 v71, v71 offset:18560
v_add_u32_sdwa v73, s42, v136 dst_sel:DWORD dst_unused:UNUSED_PAD src0_sel:DWORD src1_sel:WORD_1
v_smfmac_f32_16x16x64_bf16 v[100:103], a[168:171], v[44:51], v157
s_mov_b32 s98, 8192
buffer_load_dwordx4 v[170:173], v113, s[24:27], s98 offen sc1
ds_read_u16 v72, v72 offset:18560
v_add_u32_sdwa v74, s42, v137 dst_sel:DWORD dst_unused:UNUSED_PAD src0_sel:DWORD src1_sel:WORD_0
v_smfmac_f32_16x16x64_bf16 v[104:107], a[172:175], v[44:51], v157 abid:1
ds_read_u16 v73, v73 offset:18560
v_add_u32_sdwa v75, s42, v137 dst_sel:DWORD dst_unused:UNUSED_PAD src0_sel:DWORD src1_sel:WORD_1
v_smfmac_f32_16x16x64_bf16 v[108:111], a[176:179], v[44:51], v176
s_waitcnt lgkmcnt(8)
ds_read_u16 v74, v74 offset:18560
v_smfmac_f32_16x16x64_bf16 v[96:99], v[114:117], v[60:67], v183
s_mov_b32 s99, 69632
buffer_load_dwordx4 v[214:217], v112, s[24:27], s99 offen offset:3072 sc1
ds_read_u16 v75, v75 offset:18560
v_smfmac_f32_16x16x64_bf16 v[100:103], v[114:117], v[60:67], v183 abid:1
v_smfmac_f32_16x16x64_bf16 v[104:107], v[114:117], v[60:67], v184
s_waitcnt lgkmcnt(8)
v_smfmac_f32_16x16x64_bf16 v[8:11], a[144:147], v[52:59], v154
s_mov_b32 s99, 81920
buffer_load_dwordx4 v[250:253], v112, s[24:27], s99 offen offset:0 sc1
ds_read_b128 v[114:117], v2 offset:320
v_add_u32_sdwa v60, s42, v134 dst_sel:DWORD dst_unused:UNUSED_PAD src0_sel:DWORD src1_sel:WORD_0
v_smfmac_f32_16x16x64_bf16 v[12:15], a[148:151], v[52:59], v154 abid:1
ds_read_b128 v[44:47], v0 offset:10240
v_add_u32_sdwa v61, s42, v134 dst_sel:DWORD dst_unused:UNUSED_PAD src0_sel:DWORD src1_sel:WORD_1
v_smfmac_f32_16x16x64_bf16 v[16:19], a[152:155], v[52:59], v155
ds_read_b128 v[48:51], v1 offset:10240
v_add_u32_sdwa v62, s42, v135 dst_sel:DWORD dst_unused:UNUSED_PAD src0_sel:DWORD src1_sel:WORD_0
v_smfmac_f32_16x16x64_bf16 v[20:23], a[156:159], v[52:59], v155 abid:1
s_mov_b32 s99, 61440
buffer_load_dwordx4 a[252:255], v112, s[24:27], s99 offen offset:3072 sc1
ds_read_u16 v60, v60 offset:0
v_add_u32_sdwa v63, s42, v135 dst_sel:DWORD dst_unused:UNUSED_PAD src0_sel:DWORD src1_sel:WORD_1
v_smfmac_f32_16x16x64_bf16 v[24:27], a[160:163], v[52:59], v156
ds_read_u16 v61, v61 offset:0
v_add_u32_sdwa v64, s42, v136 dst_sel:DWORD dst_unused:UNUSED_PAD src0_sel:DWORD src1_sel:WORD_0
v_smfmac_f32_16x16x64_bf16 v[28:31], a[164:167], v[52:59], v156 abid:1
ds_read_u16 v62, v62 offset:0
v_add_u32_sdwa v65, s42, v136 dst_sel:DWORD dst_unused:UNUSED_PAD src0_sel:DWORD src1_sel:WORD_1
v_smfmac_f32_16x16x64_bf16 v[32:35], a[168:171], v[52:59], v157
s_mov_b32 s99, 73728
buffer_load_dwordx4 v[218:221], v112, s[24:27], s99 offen offset:0 sc1
ds_read_u16 v63, v63 offset:0
v_add_u32_sdwa v66, s42, v137 dst_sel:DWORD dst_unused:UNUSED_PAD src0_sel:DWORD src1_sel:WORD_0
v_smfmac_f32_16x16x64_bf16 v[36:39], a[172:175], v[52:59], v157 abid:1
ds_read_u16 v64, v64 offset:0
v_add_u32_sdwa v67, s42, v137 dst_sel:DWORD dst_unused:UNUSED_PAD src0_sel:DWORD src1_sel:WORD_1
v_smfmac_f32_16x16x64_bf16 v[40:43], a[176:179], v[52:59], v176
s_waitcnt lgkmcnt(7)
ds_read_u16 v65, v65 offset:0
v_smfmac_f32_16x16x64_bf16 v[36:39], v[114:117], v[68:75], v184 abid:1
s_mov_b32 s99, 65536
buffer_load_dwordx4 v[186:189], v112, s[24:27], s99 offen offset:0 sc1
ds_read_u16 v66, v66 offset:0
v_smfmac_f32_16x16x64_bf16 v[40:43], v[114:117], v[68:75], v185
s_waitcnt lgkmcnt(7)
ds_read_u16 v67, v67 offset:0
v_smfmac_f32_16x16x64_bf16 v[76:79], a[180:183], v[44:51], v158
s_waitcnt vmcnt(18)
ds_read_b128 v[52:55], v0 offset:28800
v_smfmac_f32_16x16x64_bf16 v[80:83], a[184:187], v[44:51], v158 abid:1
s_mov_b32 s99, 73728
buffer_load_dwordx4 v[222:225], v112, s[24:27], s99 offen offset:1024 sc1
ds_read_b128 v[56:59], v1 offset:28800
v_smfmac_f32_16x16x64_bf16 v[84:87], a[188:191], v[44:51], v159
ds_read_b128 v[68:71], v0 offset:34944
v_smfmac_f32_16x16x64_bf16 v[88:91], a[192:195], v[44:51], v159 abid:1
ds_read_b128 v[72:75], v1 offset:34944
v_smfmac_f32_16x16x64_bf16 v[92:95], a[196:199], v[44:51], v160
s_mov_b32 s99, 65536
buffer_load_dwordx4 v[190:193], v112, s[24:27], s99 offen offset:1024 sc1
v_smfmac_f32_16x16x64_bf16 v[96:99], a[200:203], v[44:51], v160 abid:1
v_smfmac_f32_16x16x64_bf16 v[100:103], a[204:207], v[44:51], v161
v_smfmac_f32_16x16x64_bf16 v[104:107], a[208:211], v[44:51], v161 abid:1
s_waitcnt vmcnt(18)
s_mov_b32 s99, 73728
buffer_load_dwordx4 v[226:229], v112, s[24:27], s99 offen offset:2048 sc1
v_smfmac_f32_16x16x64_bf16 v[108:111], a[212:215], v[44:51], v176 abid:1
s_waitcnt lgkmcnt(4)
v_smfmac_f32_16x16x64_bf16 v[104:107], v[114:117], v[60:67], v184 abid:1
v_smfmac_f32_16x16x64_bf16 v[108:111], v[114:117], v[60:67], v185
s_waitcnt lgkmcnt(2)
s_mov_b32 s99, 65536
buffer_load_dwordx4 v[194:197], v112, s[24:27], s99 offen offset:2048 sc1
v_smfmac_f32_16x16x64_bf16 v[8:11], a[180:183], v[52:59], v158
ds_read_b128 v[44:47], v0 offset:12288
v_smfmac_f32_16x16x64_bf16 v[12:15], a[184:187], v[52:59], v158 abid:1
ds_read_b128 v[48:51], v1 offset:12288
v_smfmac_f32_16x16x64_bf16 v[16:19], a[188:191], v[52:59], v159
s_mov_b32 s99, 73728
buffer_load_dwordx4 v[230:233], v112, s[24:27], s99 offen offset:3072 sc1
ds_read_b128 v[60:63], v0 offset:32896
v_smfmac_f32_16x16x64_bf16 v[20:23], a[192:195], v[52:59], v159 abid:1
ds_read_b128 v[64:67], v1 offset:32896
v_smfmac_f32_16x16x64_bf16 v[24:27], a[196:199], v[52:59], v160
v_smfmac_f32_16x16x64_bf16 v[28:31], a[200:203], v[52:59], v160 abid:1
s_mov_b32 s99, 65536
buffer_load_dwordx4 v[198:201], v112, s[24:27], s99 offen offset:3072 sc1
v_smfmac_f32_16x16x64_bf16 v[32:35], a[204:207], v[52:59], v161
v_smfmac_f32_16x16x64_bf16 v[36:39], a[208:211], v[52:59], v161 abid:1
v_smfmac_f32_16x16x64_bf16 v[40:43], a[212:215], v[52:59], v176 abid:1
s_waitcnt vmcnt(18) lgkmcnt(2)
s_mov_b32 s99, 77824
buffer_load_dwordx4 v[234:237], v112, s[24:27], s99 offen offset:0 sc1
v_smfmac_f32_16x16x64_bf16 v[76:79], a[216:219], v[44:51], v162
ds_read_b128 v[52:55], v0 offset:30848
v_smfmac_f32_16x16x64_bf16 v[80:83], a[220:223], v[44:51], v162 abid:1
ds_read_b128 v[56:59], v1 offset:30848
v_smfmac_f32_16x16x64_bf16 v[84:87], a[224:227], v[44:51], v163
s_mov_b32 s99, 69632
buffer_load_dwordx4 v[202:205], v112, s[24:27], s99 offen offset:0 sc1
v_smfmac_f32_16x16x64_bf16 v[88:91], a[228:231], v[44:51], v163 abid:1
s_waitcnt vmcnt(18)
v_smfmac_f32_16x16x64_bf16 v[92:95], a[232:235], v[44:51], v164
v_smfmac_f32_16x16x64_bf16 v[96:99], a[236:239], v[44:51], v164 abid:1
s_waitcnt vmcnt(17)
s_mov_b32 s99, 77824
buffer_load_dwordx4 v[238:241], v112, s[24:27], s99 offen offset:1024 sc1
v_smfmac_f32_16x16x64_bf16 v[100:103], a[240:243], v[44:51], v165
s_waitcnt vmcnt(17)
v_smfmac_f32_16x16x64_bf16 v[104:107], a[244:247], v[44:51], v165 abid:1
s_waitcnt vmcnt(16)
v_smfmac_f32_16x16x64_bf16 v[108:111], a[248:251], v[44:51], v177
s_waitcnt lgkmcnt(0)
s_mov_b32 s99, 69632
buffer_load_dwordx4 v[206:209], v112, s[24:27], s99 offen offset:1024 sc1
v_smfmac_f32_16x16x64_bf16 v[8:11], a[216:219], v[52:59], v162
ds_read_b128 v[44:47], v0 offset:14336
v_smfmac_f32_16x16x64_bf16 v[12:15], a[220:223], v[52:59], v162 abid:1
ds_read_b128 v[48:51], v1 offset:14336
v_smfmac_f32_16x16x64_bf16 v[16:19], a[224:227], v[52:59], v163
s_mov_b32 s99, 77824
buffer_load_dwordx4 v[242:245], v112, s[24:27], s99 offen offset:2048 sc1
v_smfmac_f32_16x16x64_bf16 v[20:23], a[228:231], v[52:59], v163 abid:1
v_smfmac_f32_16x16x64_bf16 v[24:27], a[232:235], v[52:59], v164
v_smfmac_f32_16x16x64_bf16 v[28:31], a[236:239], v[52:59], v164 abid:1
s_mov_b32 s99, 69632
buffer_load_dwordx4 v[210:213], v112, s[24:27], s99 offen offset:2048 sc1
v_smfmac_f32_16x16x64_bf16 v[32:35], a[240:243], v[52:59], v165
v_smfmac_f32_16x16x64_bf16 v[36:39], a[244:247], v[52:59], v165 abid:1
v_smfmac_f32_16x16x64_bf16 v[40:43], a[248:251], v[52:59], v177
s_mov_b32 s99, 77824
buffer_load_dwordx4 v[246:249], v112, s[24:27], s99 offen offset:3072 sc1
s_bfe_u32 s47, s85, 0x40018
s_cbranch_scc0 L_ptail0
ds_read_b128 v[52:55], v0 offset:16384
ds_read_b128 v[56:59], v1 offset:16384
s_waitcnt vmcnt(17) lgkmcnt(2)
v_smfmac_f32_16x16x64_bf16 v[108:111], v[214:217], v[44:51], v177 abid:1
s_add_u32 m0, s44, 0
s_nop 0
buffer_load_dwordx4 v3, s[16:19], s45 offen offset:0 nt lds
s_waitcnt vmcnt(17) lgkmcnt(0)
v_smfmac_f32_16x16x64_bf16 v[108:111], v[250:253], v[52:59], v178
s_add_u32 m0, s44, 3840
s_nop 0
buffer_load_dwordx4 v3, s[16:19], s45 offen offset:256 nt lds
v_add_u32 v0, 37120, v0
v_add_u32 v1, 37120, v1
s_waitcnt vmcnt(17)
v_smfmac_f32_16x16x64_bf16 v[76:79], a[252:255], v[44:51], v166
s_add_u32 m0, s44, 7680
s_nop 0
buffer_load_dwordx4 v3, s[16:19], s45 offen offset:512 nt lds
s_waitcnt vmcnt(17)
v_smfmac_f32_16x16x64_bf16 v[76:79], v[218:221], v[52:59], v170
v_cvt_pk_bf16_f32 v108, v108, v109
v_cvt_pk_bf16_f32 v109, v110, v111
ds_bpermute_b32 v108, v6, v108
ds_bpermute_b32 v109, v6, v109
s_waitcnt vmcnt(16)
v_smfmac_f32_16x16x64_bf16 v[80:83], v[186:189], v[44:51], v166 abid:1
s_add_u32 m0, s44, 11520
s_nop 0
buffer_load_dwordx4 v3, s[16:19], s45 offen offset:768 nt lds
s_waitcnt vmcnt(16)
v_smfmac_f32_16x16x64_bf16 v[80:83], v[222:225], v[52:59], v170 abid:1
s_add_u32 m0, s44, s8
s_mov_b64 exec, s[10:11]
buffer_load_dwordx4 v3, s[16:19], s7 offen offset:896 nt lds
s_mov_b64 exec, -1
s_add_u32 s7, s7, 4718592
s_add_u32 s44, s44, 18560
s_add_u32 s45, s45, 4718592
v_cvt_pk_bf16_f32 v76, v76, v77
v_cvt_pk_bf16_f32 v77, v78, v79
s_waitcnt vmcnt(16)
v_smfmac_f32_16x16x64_bf16 v[84:87], v[190:193], v[44:51], v167
s_waitcnt vmcnt(15)
v_smfmac_f32_16x16x64_bf16 v[84:87], v[226:229], v[52:59], v171
s_add_u32 m0, s44, 0
s_nop 0
buffer_load_dwordx4 v3, s[16:19], s45 offen offset:0 nt lds
v_cvt_pk_bf16_f32 v78, v80, v81
v_cvt_pk_bf16_f32 v79, v82, v83
s_waitcnt lgkmcnt(0)
buffer_store_dwordx2 v[108:109], v5, s[20:23], s46 offen nt
s_waitcnt vmcnt(16)
v_smfmac_f32_16x16x64_bf16 v[88:91], v[194:197], v[44:51], v167 abid:1
s_add_u32 m0, s44, 3840
s_nop 0
buffer_load_dwordx4 v3, s[16:19], s45 offen offset:256 nt lds
s_waitcnt vmcnt(16)
v_smfmac_f32_16x16x64_bf16 v[88:91], v[230:233], v[52:59], v171 abid:1
s_add_u32 m0, s44, 7680
s_nop 0
buffer_load_dwordx4 v3, s[16:19], s45 offen offset:512 nt lds
v_cvt_pk_bf16_f32 v80, v84, v85
v_cvt_pk_bf16_f32 v81, v86, v87
s_waitcnt vmcnt(16)
v_smfmac_f32_16x16x64_bf16 v[92:95], v[198:201], v[44:51], v168
s_waitcnt vmcnt(15)
v_smfmac_f32_16x16x64_bf16 v[92:95], v[234:237], v[52:59], v172
s_add_u32 m0, s44, 11520
s_nop 0
buffer_load_dwordx4 v3, s[16:19], s45 offen offset:768 nt lds
v_cvt_pk_bf16_f32 v82, v88, v89
v_cvt_pk_bf16_f32 v83, v90, v91
v_cndmask_b32_dpp v114, v80, v76, vcc quad_perm:[1,0,3,2] row_mask:0xf bank_mask:0xf
v_cndmask_b32_dpp v115, v81, v77, vcc quad_perm:[1,0,3,2] row_mask:0xf bank_mask:0xf
v_cndmask_b32_dpp v116, v82, v78, vcc quad_perm:[1,0,3,2] row_mask:0xf bank_mask:0xf
v_cndmask_b32_dpp v117, v83, v79, vcc quad_perm:[1,0,3,2] row_mask:0xf bank_mask:0xf
buffer_store_dwordx4 v[114:117], v4, s[20:23], s46 offen offset:0 sc1
s_mov_b64 vcc, s[82:83]
s_waitcnt vmcnt(16)
v_smfmac_f32_16x16x64_bf16 v[96:99], v[202:205], v[44:51], v168 abid:1
s_add_u32 m0, s44, s8
s_mov_b64 exec, s[10:11]
buffer_load_dwordx4 v3, s[16:19], s7 offen offset:896 nt lds
s_mov_b64 exec, -1
s_add_u32 s7, s7, 4718592
s_add_u32 s44, s44, 18560
s_add_u32 s45, s45, 4718592
s_waitcnt vmcnt(16)
v_smfmac_f32_16x16x64_bf16 v[96:99], v[238:241], v[52:59], v172 abid:1
v_cvt_pk_bf16_f32 v84, v92, v93
v_cvt_pk_bf16_f32 v85, v94, v95
v_cndmask_b32_dpp v80, v76, v80, vcc quad_perm:[1,0,3,2] row_mask:0xf bank_mask:0xf
v_cndmask_b32_dpp v81, v77, v81, vcc quad_perm:[1,0,3,2] row_mask:0xf bank_mask:0xf
v_cndmask_b32_dpp v82, v78, v82, vcc quad_perm:[1,0,3,2] row_mask:0xf bank_mask:0xf
v_cndmask_b32_dpp v83, v79, v83, vcc quad_perm:[1,0,3,2] row_mask:0xf bank_mask:0xf
buffer_store_dwordx4 v[80:83], v4, s[20:23], s46 offen offset:1152 sc1
s_mov_b64 vcc, s[80:81]
s_waitcnt vmcnt(16)
v_smfmac_f32_16x16x64_bf16 v[100:103], v[206:209], v[44:51], v169
s_waitcnt vmcnt(15)
v_smfmac_f32_16x16x64_bf16 v[100:103], v[242:245], v[52:59], v173
v_cvt_pk_bf16_f32 v86, v96, v97
v_cvt_pk_bf16_f32 v87, v98, v99
v_add_u32_sdwa v76, s4, v118 dst_sel:DWORD dst_unused:UNUSED_PAD src0_sel:DWORD src1_sel:WORD_0
v_add_u32_sdwa v77, s4, v118 dst_sel:DWORD dst_unused:UNUSED_PAD src0_sel:DWORD src1_sel:WORD_1
v_add_u32_sdwa v78, s4, v119 dst_sel:DWORD dst_unused:UNUSED_PAD src0_sel:DWORD src1_sel:WORD_0
v_add_u32_sdwa v79, s4, v119 dst_sel:DWORD dst_unused:UNUSED_PAD src0_sel:DWORD src1_sel:WORD_1
s_waitcnt vmcnt(14)
v_smfmac_f32_16x16x64_bf16 v[104:107], v[210:213], v[44:51], v169 abid:1
s_waitcnt vmcnt(13)
v_smfmac_f32_16x16x64_bf16 v[104:107], v[246:249], v[52:59], v173 abid:1
v_cvt_pk_bf16_f32 v88, v100, v101
v_cvt_pk_bf16_f32 v89, v102, v103
v_add_u32_sdwa v80, s4, v120 dst_sel:DWORD dst_unused:UNUSED_PAD src0_sel:DWORD src1_sel:WORD_0
v_add_u32_sdwa v81, s4, v120 dst_sel:DWORD dst_unused:UNUSED_PAD src0_sel:DWORD src1_sel:WORD_1
v_add_u32_sdwa v82, s4, v121 dst_sel:DWORD dst_unused:UNUSED_PAD src0_sel:DWORD src1_sel:WORD_0
v_add_u32_sdwa v83, s4, v121 dst_sel:DWORD dst_unused:UNUSED_PAD src0_sel:DWORD src1_sel:WORD_1
s_nop 1
v_cvt_pk_bf16_f32 v90, v104, v105
v_cvt_pk_bf16_f32 v91, v106, v107
v_cndmask_b32_dpp v92, v88, v84, vcc quad_perm:[1,0,3,2] row_mask:0xf bank_mask:0xf
v_cndmask_b32_dpp v93, v89, v85, vcc quad_perm:[1,0,3,2] row_mask:0xf bank_mask:0xf
v_cndmask_b32_dpp v94, v90, v86, vcc quad_perm:[1,0,3,2] row_mask:0xf bank_mask:0xf
v_cndmask_b32_dpp v95, v91, v87, vcc quad_perm:[1,0,3,2] row_mask:0xf bank_mask:0xf
buffer_store_dwordx4 v[92:95], v4, s[20:23], s46 offen offset:128 sc1
s_mov_b64 vcc, s[82:83]
v_cndmask_b32_dpp v88, v84, v88, vcc quad_perm:[1,0,3,2] row_mask:0xf bank_mask:0xf
v_cndmask_b32_dpp v89, v85, v89, vcc quad_perm:[1,0,3,2] row_mask:0xf bank_mask:0xf
v_cndmask_b32_dpp v90, v86, v90, vcc quad_perm:[1,0,3,2] row_mask:0xf bank_mask:0xf
v_cndmask_b32_dpp v91, v87, v91, vcc quad_perm:[1,0,3,2] row_mask:0xf bank_mask:0xf
buffer_store_dwordx4 v[88:91], v4, s[20:23], s46 offen offset:1280 sc1
s_mov_b64 vcc, s[80:81]
s_branch L_ptail1
L_ptail0:
ds_read_b128 v[52:55], v0 offset:16384
ds_read_b128 v[56:59], v1 offset:16384
s_waitcnt vmcnt(17) lgkmcnt(2)
v_smfmac_f32_16x16x64_bf16 v[108:111], v[214:217], v[44:51], v177 abid:1
s_waitcnt vmcnt(16) lgkmcnt(0)
v_smfmac_f32_16x16x64_bf16 v[108:111], v[250:253], v[52:59], v178
v_add_u32 v0, 37120, v0
v_add_u32 v1, 37120, v1
s_waitcnt vmcnt(15)
v_smfmac_f32_16x16x64_bf16 v[76:79], a[252:255], v[44:51], v166
s_waitcnt vmcnt(14)
v_smfmac_f32_16x16x64_bf16 v[76:79], v[218:221], v[52:59], v170
s_nop 1
v_cvt_pk_bf16_f32 v108, v108, v109
v_cvt_pk_bf16_f32 v109, v110, v111
ds_bpermute_b32 v108, v6, v108
ds_bpermute_b32 v109, v6, v109
s_waitcnt vmcnt(13)
v_smfmac_f32_16x16x64_bf16 v[80:83], v[186:189], v[44:51], v166 abid:1
s_waitcnt vmcnt(12)
v_smfmac_f32_16x16x64_bf16 v[80:83], v[222:225], v[52:59], v170 abid:1
v_cvt_pk_bf16_f32 v76, v76, v77
v_cvt_pk_bf16_f32 v77, v78, v79
s_waitcnt vmcnt(11)
v_smfmac_f32_16x16x64_bf16 v[84:87], v[190:193], v[44:51], v167
s_waitcnt vmcnt(10)
v_smfmac_f32_16x16x64_bf16 v[84:87], v[226:229], v[52:59], v171
s_nop 1
v_cvt_pk_bf16_f32 v78, v80, v81
v_cvt_pk_bf16_f32 v79, v82, v83
s_waitcnt lgkmcnt(0)
buffer_store_dwordx2 v[108:109], v5, s[20:23], s46 offen nt
s_waitcnt vmcnt(10)
v_smfmac_f32_16x16x64_bf16 v[88:91], v[194:197], v[44:51], v167 abid:1
s_waitcnt vmcnt(9)
v_smfmac_f32_16x16x64_bf16 v[88:91], v[230:233], v[52:59], v171 abid:1
v_cvt_pk_bf16_f32 v80, v84, v85
v_cvt_pk_bf16_f32 v81, v86, v87
s_waitcnt vmcnt(8)
v_smfmac_f32_16x16x64_bf16 v[92:95], v[198:201], v[44:51], v168
s_waitcnt vmcnt(7)
v_smfmac_f32_16x16x64_bf16 v[92:95], v[234:237], v[52:59], v172
s_nop 1
v_cvt_pk_bf16_f32 v82, v88, v89
v_cvt_pk_bf16_f32 v83, v90, v91
v_cndmask_b32_dpp v114, v80, v76, vcc quad_perm:[1,0,3,2] row_mask:0xf bank_mask:0xf
v_cndmask_b32_dpp v115, v81, v77, vcc quad_perm:[1,0,3,2] row_mask:0xf bank_mask:0xf
v_cndmask_b32_dpp v116, v82, v78, vcc quad_perm:[1,0,3,2] row_mask:0xf bank_mask:0xf
v_cndmask_b32_dpp v117, v83, v79, vcc quad_perm:[1,0,3,2] row_mask:0xf bank_mask:0xf
buffer_store_dwordx4 v[114:117], v4, s[20:23], s46 offen offset:0 sc1
s_mov_b64 vcc, s[82:83]
s_waitcnt vmcnt(7)
v_smfmac_f32_16x16x64_bf16 v[96:99], v[202:205], v[44:51], v168 abid:1
s_waitcnt vmcnt(6)
v_smfmac_f32_16x16x64_bf16 v[96:99], v[238:241], v[52:59], v172 abid:1
v_cvt_pk_bf16_f32 v84, v92, v93
v_cvt_pk_bf16_f32 v85, v94, v95
v_cndmask_b32_dpp v80, v76, v80, vcc quad_perm:[1,0,3,2] row_mask:0xf bank_mask:0xf
v_cndmask_b32_dpp v81, v77, v81, vcc quad_perm:[1,0,3,2] row_mask:0xf bank_mask:0xf
v_cndmask_b32_dpp v82, v78, v82, vcc quad_perm:[1,0,3,2] row_mask:0xf bank_mask:0xf
v_cndmask_b32_dpp v83, v79, v83, vcc quad_perm:[1,0,3,2] row_mask:0xf bank_mask:0xf
buffer_store_dwordx4 v[80:83], v4, s[20:23], s46 offen offset:1152 sc1
s_mov_b64 vcc, s[80:81]
s_waitcnt vmcnt(6)
v_smfmac_f32_16x16x64_bf16 v[100:103], v[206:209], v[44:51], v169
s_waitcnt vmcnt(5)
v_smfmac_f32_16x16x64_bf16 v[100:103], v[242:245], v[52:59], v173
v_cvt_pk_bf16_f32 v86, v96, v97
v_cvt_pk_bf16_f32 v87, v98, v99
v_add_u32_sdwa v76, s4, v118 dst_sel:DWORD dst_unused:UNUSED_PAD src0_sel:DWORD src1_sel:WORD_0
v_add_u32_sdwa v77, s4, v118 dst_sel:DWORD dst_unused:UNUSED_PAD src0_sel:DWORD src1_sel:WORD_1
v_add_u32_sdwa v78, s4, v119 dst_sel:DWORD dst_unused:UNUSED_PAD src0_sel:DWORD src1_sel:WORD_0
v_add_u32_sdwa v79, s4, v119 dst_sel:DWORD dst_unused:UNUSED_PAD src0_sel:DWORD src1_sel:WORD_1
s_waitcnt vmcnt(4)
v_smfmac_f32_16x16x64_bf16 v[104:107], v[210:213], v[44:51], v169 abid:1
s_waitcnt vmcnt(3)
v_smfmac_f32_16x16x64_bf16 v[104:107], v[246:249], v[52:59], v173 abid:1
v_cvt_pk_bf16_f32 v88, v100, v101
v_cvt_pk_bf16_f32 v89, v102, v103
v_add_u32_sdwa v80, s4, v120 dst_sel:DWORD dst_unused:UNUSED_PAD src0_sel:DWORD src1_sel:WORD_0
v_add_u32_sdwa v81, s4, v120 dst_sel:DWORD dst_unused:UNUSED_PAD src0_sel:DWORD src1_sel:WORD_1
v_add_u32_sdwa v82, s4, v121 dst_sel:DWORD dst_unused:UNUSED_PAD src0_sel:DWORD src1_sel:WORD_0
v_add_u32_sdwa v83, s4, v121 dst_sel:DWORD dst_unused:UNUSED_PAD src0_sel:DWORD src1_sel:WORD_1
s_nop 1
v_cvt_pk_bf16_f32 v90, v104, v105
v_cvt_pk_bf16_f32 v91, v106, v107
v_cndmask_b32_dpp v92, v88, v84, vcc quad_perm:[1,0,3,2] row_mask:0xf bank_mask:0xf
v_cndmask_b32_dpp v93, v89, v85, vcc quad_perm:[1,0,3,2] row_mask:0xf bank_mask:0xf
v_cndmask_b32_dpp v94, v90, v86, vcc quad_perm:[1,0,3,2] row_mask:0xf bank_mask:0xf
v_cndmask_b32_dpp v95, v91, v87, vcc quad_perm:[1,0,3,2] row_mask:0xf bank_mask:0xf
buffer_store_dwordx4 v[92:95], v4, s[20:23], s46 offen offset:128 sc1
s_mov_b64 vcc, s[82:83]
v_cndmask_b32_dpp v88, v84, v88, vcc quad_perm:[1,0,3,2] row_mask:0xf bank_mask:0xf
v_cndmask_b32_dpp v89, v85, v89, vcc quad_perm:[1,0,3,2] row_mask:0xf bank_mask:0xf
v_cndmask_b32_dpp v90, v86, v90, vcc quad_perm:[1,0,3,2] row_mask:0xf bank_mask:0xf
v_cndmask_b32_dpp v91, v87, v91, vcc quad_perm:[1,0,3,2] row_mask:0xf bank_mask:0xf
buffer_store_dwordx4 v[88:91], v4, s[20:23], s46 offen offset:1280 sc1
s_mov_b64 vcc, s[80:81]
L_ptail1:
s_cmp_ge_u32 s44, 148480
s_cselect_b32 s44, s9, s44
s_add_u32 s46, s46, 4718592
s_waitcnt lgkmcnt(0)
s_barrier
s_cmp_lg_u32 s89, 0
s_cbranch_scc1 L_loopnk_p3
s_branch L_loopn_p3
.p2align 6
L_loop:
v_smfmac_f32_16x16x64_bf16 v[8:11], a[0:3], v[44:51], v138
ds_read_b128 v[32:35], v2 offset:1408
v_cvt_pk_bf16_f32 v106, v36, v37
v_smfmac_f32_16x16x64_bf16 v[8:11], a[36:39], v[52:59], v142
s_waitcnt lgkmcnt(9)
v_cvt_pk_bf16_f32 v107, v38, v39
v_smfmac_f32_16x16x64_bf16 v[12:15], a[4:7], v[44:51], v138 abid:1
ds_read_b128 v[36:39], v2 offset:1472
v_cvt_pk_bf16_f32 v112, v40, v41
v_smfmac_f32_16x16x64_bf16 v[12:15], a[40:43], v[52:59], v142 abid:1
s_waitcnt lgkmcnt(8)
ds_read_b128 v[60:63], v0 offset:4096
v_cvt_pk_bf16_f32 v113, v42, v43
v_smfmac_f32_16x16x64_bf16 v[16:19], a[8:11], v[44:51], v139
s_cmp_eq_u32 s4, 129920
ds_read_b128 v[40:43], v2 offset:1536
v_cndmask_b32_dpp v108, v96, v92, vcc quad_perm:[1,0,3,2] row_mask:0xf bank_mask:0xf
v_smfmac_f32_16x16x64_bf16 v[16:19], a[44:47], v[52:59], v143
s_waitcnt lgkmcnt(8)
ds_read_u16 v82, v82
v_cndmask_b32_dpp v109, v97, v93, vcc quad_perm:[1,0,3,2] row_mask:0xf bank_mask:0xf
v_smfmac_f32_16x16x64_bf16 v[20:23], a[12:15], v[44:51], v139 abid:1
s_cselect_b32 s43, -129920, s5
ds_read_u16 v84, v84
v_cndmask_b32_dpp v110, v98, v94, vcc quad_perm:[1,0,3,2] row_mask:0xf bank_mask:0xf
v_smfmac_f32_16x16x64_bf16 v[20:23], a[48:51], v[52:59], v143 abid:1
s_waitcnt lgkmcnt(8)
ds_read_b128 v[64:67], v1 offset:4096
v_cndmask_b32_dpp v111, v99, v95, vcc quad_perm:[1,0,3,2] row_mask:0xf bank_mask:0xf
v_smfmac_f32_16x16x64_bf16 v[24:27], a[16:19], v[44:51], v140
s_add_u32 s4, s4, s43
ds_read_b128 v[68:71], v0 offset:6144
v_add_u32_sdwa v87, s42, v123 dst_sel:DWORD dst_unused:UNUSED_PAD src0_sel:DWORD src1_sel:WORD_1
v_smfmac_f32_16x16x64_bf16 v[24:27], a[52:55], v[52:59], v144
buffer_store_dwordx4 v[108:111], v4, s[20:23], s46 offen offset:0 sc1
s_mov_b64 vcc, s[82:83]
s_waitcnt lgkmcnt(8)
ds_read_b128 v[72:75], v1 offset:6144
v_cndmask_b32_dpp v96, v92, v96, vcc quad_perm:[1,0,3,2] row_mask:0xf bank_mask:0xf
v_cndmask_b32_dpp v97, v93, v97, vcc quad_perm:[1,0,3,2] row_mask:0xf bank_mask:0xf
v_smfmac_f32_16x16x64_bf16 v[28:31], a[20:23], v[44:51], v140 abid:1
s_add_u32 s41, s41, 1
ds_read_u16 v83, v83
v_cndmask_b32_dpp v98, v94, v98, vcc quad_perm:[1,0,3,2] row_mask:0xf bank_mask:0xf
v_smfmac_f32_16x16x64_bf16 v[28:31], a[56:59], v[52:59], v144 abid:1
s_waitcnt lgkmcnt(9)
ds_read_b128 v[114:117], v2 offset:64
v_cndmask_b32_dpp v99, v95, v99, vcc quad_perm:[1,0,3,2] row_mask:0xf bank_mask:0xf
v_smfmac_f32_16x16x64_bf16 v[32:35], a[24:27], v[44:51], v141
ds_read_u16 v85, v85
v_add_u32_sdwa v88, s42, v124 dst_sel:DWORD dst_unused:UNUSED_PAD src0_sel:DWORD src1_sel:WORD_0
v_smfmac_f32_16x16x64_bf16 v[32:35], a[60:63], v[52:59], v145
s_waitcnt lgkmcnt(10)
ds_read_u16 v86, v86
v_add_u32_sdwa v89, s42, v124 dst_sel:DWORD dst_unused:UNUSED_PAD src0_sel:DWORD src1_sel:WORD_1
v_smfmac_f32_16x16x64_bf16 v[36:39], a[28:31], v[44:51], v141 abid:1
ds_read_u16 v87, v87
v_add_u32_sdwa v90, s42, v125 dst_sel:DWORD dst_unused:UNUSED_PAD src0_sel:DWORD src1_sel:WORD_0
v_smfmac_f32_16x16x64_bf16 v[36:39], a[64:67], v[52:59], v145 abid:1
s_waitcnt lgkmcnt(10)
ds_read_u16 v88, v88
v_add_u32_sdwa v91, s42, v125 dst_sel:DWORD dst_unused:UNUSED_PAD src0_sel:DWORD src1_sel:WORD_1
v_smfmac_f32_16x16x64_bf16 v[40:43], a[32:35], v[44:51], v174
buffer_store_dwordx4 v[96:99], v4, s[20:23], s46 offen offset:1152 sc1
s_mov_b64 vcc, s[80:81]
ds_read_u16 v89, v89
v_cndmask_b32_dpp v92, v104, v100, vcc quad_perm:[1,0,3,2] row_mask:0xf bank_mask:0xf
v_cndmask_b32_dpp v93, v105, v101, vcc quad_perm:[1,0,3,2] row_mask:0xf bank_mask:0xf
v_smfmac_f32_16x16x64_bf16 v[40:43], a[68:71], v[52:59], v174 abid:1
s_waitcnt lgkmcnt(9)
ds_read_u16 v90, v90
v_cndmask_b32_dpp v94, v106, v102, vcc quad_perm:[1,0,3,2] row_mask:0xf bank_mask:0xf
v_smfmac_f32_16x16x64_bf16 v[8:11], a[72:75], v[60:67], v146
s_waitcnt lgkmcnt(8)
ds_read_u16 v91, v91
v_cndmask_b32_dpp v95, v107, v103, vcc quad_perm:[1,0,3,2] row_mask:0xf bank_mask:0xf
v_smfmac_f32_16x16x64_bf16 v[8:11], a[108:111], v[68:75], v150
s_waitcnt lgkmcnt(7)
ds_bpermute_b32 v112, v6, v112
v_smfmac_f32_16x16x64_bf16 v[8:11], v[114:117], v[76:83], v179
ds_bpermute_b32 v113, v6, v113
v_smfmac_f32_16x16x64_bf16 v[12:15], v[114:117], v[76:83], v179 abid:1
ds_read_b128 v[114:117], v2 offset:128
v_add_u32_sdwa v76, s42, v126 dst_sel:DWORD dst_unused:UNUSED_PAD src0_sel:DWORD src1_sel:WORD_0
v_smfmac_f32_16x16x64_bf16 v[12:15], a[76:79], v[60:67], v146 abid:1
ds_read_u16 v76, v76
v_add_u32_sdwa v77, s42, v126 dst_sel:DWORD dst_unused:UNUSED_PAD src0_sel:DWORD src1_sel:WORD_1
v_smfmac_f32_16x16x64_bf16 v[12:15], a[112:115], v[68:75], v150 abid:1
buffer_store_dwordx4 v[92:95], v4, s[20:23], s46 offen offset:128 sc1
s_mov_b64 vcc, s[82:83]
ds_read_u16 v77, v77
v_cndmask_b32_dpp v104, v100, v104, vcc quad_perm:[1,0,3,2] row_mask:0xf bank_mask:0xf
v_add_u32_sdwa v78, s42, v127 dst_sel:DWORD dst_unused:UNUSED_PAD src0_sel:DWORD src1_sel:WORD_0
v_smfmac_f32_16x16x64_bf16 v[24:27], a[88:91], v[60:67], v148
ds_read_u16 v78, v78
v_cndmask_b32_dpp v105, v101, v105, vcc quad_perm:[1,0,3,2] row_mask:0xf bank_mask:0xf
v_smfmac_f32_16x16x64_bf16 v[24:27], a[124:127], v[68:75], v152
ds_read_b128 v[44:47], v0 offset:8192
v_cndmask_b32_dpp v106, v102, v106, vcc quad_perm:[1,0,3,2] row_mask:0xf bank_mask:0xf
v_smfmac_f32_16x16x64_bf16 v[28:31], a[92:95], v[60:67], v148 abid:1
ds_read_b128 v[48:51], v1 offset:8192
v_add_u32_sdwa v79, s42, v127 dst_sel:DWORD dst_unused:UNUSED_PAD src0_sel:DWORD src1_sel:WORD_1
v_smfmac_f32_16x16x64_bf16 v[28:31], a[128:131], v[68:75], v152 abid:1
ds_read_u16 v79, v79
v_cndmask_b32_dpp v107, v103, v107, vcc quad_perm:[1,0,3,2] row_mask:0xf bank_mask:0xf
v_smfmac_f32_16x16x64_bf16 v[32:35], a[96:99], v[60:67], v149
ds_read_b128 v[52:55], v0 offset:10240
v_add_u32_sdwa v80, s42, v128 dst_sel:DWORD dst_unused:UNUSED_PAD src0_sel:DWORD src1_sel:WORD_0
v_smfmac_f32_16x16x64_bf16 v[32:35], a[132:135], v[68:75], v153
ds_read_u16 v80, v80
v_add_u32_sdwa v81, s42, v128 dst_sel:DWORD dst_unused:UNUSED_PAD src0_sel:DWORD src1_sel:WORD_1
v_smfmac_f32_16x16x64_bf16 v[16:19], a[80:83], v[60:67], v147
buffer_store_dwordx4 v[104:107], v4, s[20:23], s46 offen offset:1280 sc1
s_mov_b64 vcc, s[80:81]
ds_read_b128 v[56:59], v1 offset:10240
v_add_u32_sdwa v82, s42, v129 dst_sel:DWORD dst_unused:UNUSED_PAD src0_sel:DWORD src1_sel:WORD_0
v_add_u32_sdwa v83, s42, v129 dst_sel:DWORD dst_unused:UNUSED_PAD src0_sel:DWORD src1_sel:WORD_1
v_smfmac_f32_16x16x64_bf16 v[16:19], a[116:119], v[68:75], v151
s_waitcnt lgkmcnt(9)
ds_read_b128 v[92:95], v0 offset:12288
v_add_u32_sdwa v100, s42, v130 dst_sel:DWORD dst_unused:UNUSED_PAD src0_sel:DWORD src1_sel:WORD_0
v_smfmac_f32_16x16x64_bf16 v[16:19], v[114:117], v[84:91], v180 abid:1
s_waitcnt vmcnt(4)
ds_read_u16 v81, v81
v_add_u32_sdwa v101, s42, v130 dst_sel:DWORD dst_unused:UNUSED_PAD src0_sel:DWORD src1_sel:WORD_1
v_smfmac_f32_16x16x64_bf16 v[20:23], v[114:117], v[84:91], v181
ds_read_b128 v[96:99], v1 offset:12288
v_add_u32_sdwa v102, s42, v131 dst_sel:DWORD dst_unused:UNUSED_PAD src0_sel:DWORD src1_sel:WORD_0
v_smfmac_f32_16x16x64_bf16 v[20:23], a[84:87], v[60:67], v147 abid:1
ds_read_u16 v100, v100
v_add_u32_sdwa v103, s42, v131 dst_sel:DWORD dst_unused:UNUSED_PAD src0_sel:DWORD src1_sel:WORD_1
v_smfmac_f32_16x16x64_bf16 v[20:23], a[120:123], v[68:75], v151 abid:1
ds_read_u16 v82, v82
v_add_u32_sdwa v104, s42, v132 dst_sel:DWORD dst_unused:UNUSED_PAD src0_sel:DWORD src1_sel:WORD_0
v_smfmac_f32_16x16x64_bf16 v[36:39], a[100:103], v[60:67], v149 abid:1
ds_read_u16 v101, v101
v_add_u32_sdwa v105, s42, v132 dst_sel:DWORD dst_unused:UNUSED_PAD src0_sel:DWORD src1_sel:WORD_1
v_smfmac_f32_16x16x64_bf16 v[36:39], a[136:139], v[68:75], v153 abid:1
buffer_store_dwordx2 v[112:113], v5, s[20:23], s46 offen nt
ds_read_u16 v83, v83
v_add_u32_sdwa v106, s42, v133 dst_sel:DWORD dst_unused:UNUSED_PAD src0_sel:DWORD src1_sel:WORD_0
v_smfmac_f32_16x16x64_bf16 v[40:43], a[104:107], v[60:67], v175
s_mov_b32 s22, 75497472
ds_read_b128 v[114:117], v2 offset:192
v_add_u32_sdwa v107, s42, v133 dst_sel:DWORD dst_unused:UNUSED_PAD src0_sel:DWORD src1_sel:WORD_1
v_smfmac_f32_16x16x64_bf16 v[40:43], a[140:143], v[68:75], v175 abid:1
s_waitcnt lgkmcnt(12)
ds_read_u16 v102, v102
v_add_u32_sdwa v84, s42, v134 dst_sel:DWORD dst_unused:UNUSED_PAD src0_sel:DWORD src1_sel:WORD_0
v_smfmac_f32_16x16x64_bf16 v[8:11], a[144:147], v[44:51], v154
s_waitcnt lgkmcnt(9)
ds_read_u16 v103, v103
v_add_u32_sdwa v85, s42, v134 dst_sel:DWORD dst_unused:UNUSED_PAD src0_sel:DWORD src1_sel:WORD_1
v_smfmac_f32_16x16x64_bf16 v[8:11], a[180:183], v[52:59], v158
s_waitcnt lgkmcnt(7)
ds_read_u16 v104, v104
v_add_u32_sdwa v86, s42, v135 dst_sel:DWORD dst_unused:UNUSED_PAD src0_sel:DWORD src1_sel:WORD_0
v_smfmac_f32_16x16x64_bf16 v[8:11], a[216:219], v[92:99], v162
s_mov_b32 s46, s48
ds_read_u16 v105, v105
v_add_u32_sdwa v87, s42, v135 dst_sel:DWORD dst_unused:UNUSED_PAD src0_sel:DWORD src1_sel:WORD_1
v_smfmac_f32_16x16x64_bf16 v[24:27], a[160:163], v[44:51], v156
s_add_u32 m0, s44, 0
ds_read_u16 v106, v106
v_add_u32_sdwa v88, s42, v136 dst_sel:DWORD dst_unused:UNUSED_PAD src0_sel:DWORD src1_sel:WORD_0
v_smfmac_f32_16x16x64_bf16 v[24:27], a[196:199], v[52:59], v160
buffer_load_dwordx4 v3, s[16:19], s45 offen offset:0 nt lds
v_add_u32_sdwa v89, s42, v136 dst_sel:DWORD dst_unused:UNUSED_PAD src0_sel:DWORD src1_sel:WORD_1
v_smfmac_f32_16x16x64_bf16 v[24:27], a[232:235], v[92:99], v164
s_waitcnt lgkmcnt(5)
ds_read_u16 v107, v107
v_add_u32_sdwa v90, s42, v137 dst_sel:DWORD dst_unused:UNUSED_PAD src0_sel:DWORD src1_sel:WORD_0
v_smfmac_f32_16x16x64_bf16 v[24:27], v[114:117], v[76:83], v182
s_mov_b32 s48, s49
ds_read_u16 v84, v84
v_add_u32_sdwa v91, s42, v137 dst_sel:DWORD dst_unused:UNUSED_PAD src0_sel:DWORD src1_sel:WORD_1
v_smfmac_f32_16x16x64_bf16 v[28:31], v[114:117], v[76:83], v182 abid:1
s_mov_b32 s49, s50
ds_read_b128 v[114:117], v2 offset:256
v_add_u32_sdwa v76, s4, v118 dst_sel:DWORD dst_unused:UNUSED_PAD src0_sel:DWORD src1_sel:WORD_0
v_smfmac_f32_16x16x64_bf16 v[28:31], a[164:167], v[44:51], v156 abid:1
s_add_u32 s50, s50, 4718592
ds_read_u16 v85, v85
v_add_u32_sdwa v77, s4, v118 dst_sel:DWORD dst_unused:UNUSED_PAD src0_sel:DWORD src1_sel:WORD_1
v_smfmac_f32_16x16x64_bf16 v[28:31], a[200:203], v[52:59], v160 abid:1
ds_read_u16 v86, v86
v_add_u32_sdwa v78, s4, v119 dst_sel:DWORD dst_unused:UNUSED_PAD src0_sel:DWORD src1_sel:WORD_0
v_smfmac_f32_16x16x64_bf16 v[28:31], a[236:239], v[92:99], v164 abid:1
ds_read_u16 v87, v87
v_add_u32_sdwa v79, s4, v119 dst_sel:DWORD dst_unused:UNUSED_PAD src0_sel:DWORD src1_sel:WORD_1
v_smfmac_f32_16x16x64_bf16 v[12:15], a[148:151], v[44:51], v154 abid:1
s_add_u32 m0, s44, 3840
ds_read_u16 v88, v88
v_add_u32_sdwa v80, s4, v120 dst_sel:DWORD dst_unused:UNUSED_PAD src0_sel:DWORD src1_sel:WORD_0
v_smfmac_f32_16x16x64_bf16 v[12:15], a[184:187], v[52:59], v158 abid:1
buffer_load_dwordx4 v3, s[16:19], s45 offen offset:256 nt lds
v_add_u32_sdwa v81, s4, v120 dst_sel:DWORD dst_unused:UNUSED_PAD src0_sel:DWORD src1_sel:WORD_1
v_smfmac_f32_16x16x64_bf16 v[12:15], a[220:223], v[92:99], v162 abid:1
ds_read_b128 v[60:63], v0 offset:14336
v_add_u32_sdwa v82, s4, v121 dst_sel:DWORD dst_unused:UNUSED_PAD src0_sel:DWORD src1_sel:WORD_0
v_smfmac_f32_16x16x64_bf16 v[32:35], a[168:171], v[44:51], v157
ds_read_u16 v89, v89
v_add_u32_sdwa v83, s4, v121 dst_sel:DWORD dst_unused:UNUSED_PAD src0_sel:DWORD src1_sel:WORD_1
v_smfmac_f32_16x16x64_bf16 v[32:35], a[204:207], v[52:59], v161
ds_read_b128 v[64:67], v1 offset:14336
v_smfmac_f32_16x16x64_bf16 v[32:35], a[240:243], v[92:99], v165
s_waitcnt lgkmcnt(7)
ds_read_b128 v[68:71], v0 offset:16384
v_smfmac_f32_16x16x64_bf16 v[32:35], v[114:117], v[100:107], v183 abid:1
ds_read_u16 v90, v90
v_smfmac_f32_16x16x64_bf16 v[36:39], v[114:117], v[100:107], v184
ds_read_b128 v[72:75], v1 offset:16384
v_add_u32 v0, s43, v0
v_smfmac_f32_16x16x64_bf16 v[36:39], a[172:175], v[44:51], v157 abid:1
s_add_u32 m0, s44, 7680
ds_read_u16 v91, v91
v_add_u32 v1, s43, v1
v_smfmac_f32_16x16x64_bf16 v[36:39], a[208:211], v[52:59], v161 abid:1
buffer_load_dwordx4 v3, s[16:19], s45 offen offset:512 nt lds
v_smfmac_f32_16x16x64_bf16 v[36:39], a[244:247], v[92:99], v165 abid:1
ds_read_b128 v[114:117], v2 offset:320
v_smfmac_f32_16x16x64_bf16 v[16:19], a[152:155], v[44:51], v155
s_add_u32 m0, s44, 11520
v_smfmac_f32_16x16x64_bf16 v[16:19], a[188:191], v[52:59], v159
buffer_load_dwordx4 v3, s[16:19], s45 offen offset:768 nt lds
v_smfmac_f32_16x16x64_bf16 v[16:19], a[224:227], v[92:99], v163
v_smfmac_f32_16x16x64_bf16 v[20:23], a[156:159], v[44:51], v155 abid:1
s_add_u32 m0, s44, s8
v_smfmac_f32_16x16x64_bf16 v[20:23], a[192:195], v[52:59], v159 abid:1
s_mov_b64 exec, s[10:11]
buffer_load_dwordx4 v3, s[16:19], s7 offen offset:896 nt lds
s_mov_b64 exec, -1
v_smfmac_f32_16x16x64_bf16 v[20:23], a[228:231], v[92:99], v163 abid:1
s_add_u32 s45, s45, 4718592
s_add_u32 s7, s7, 4718592
s_add_u32 s44, s44, s5
v_smfmac_f32_16x16x64_bf16 v[40:43], a[176:179], v[44:51], v176
s_cmp_ge_u32 s44, 148480
s_cselect_b32 s44, s9, s44
s_bitcmp1_b32 s92, s41
v_smfmac_f32_16x16x64_bf16 v[40:43], a[212:215], v[52:59], v176 abid:1
s_cbranch_scc1 L_loop_w
L_loop_wb:
v_smfmac_f32_16x16x64_bf16 v[40:43], a[248:251], v[92:99], v177
s_waitcnt lgkmcnt(0)
v_smfmac_f32_16x16x64_bf16 v[40:43], v[114:117], v[84:91], v185
s_waitcnt vmcnt(20)
s_barrier
v_smfmac_f32_16x16x64_bf16 v[8:11], a[252:255], v[60:67], v166
s_mov_b32 s42, s4
v_smfmac_f32_16x16x64_bf16 v[8:11], v[218:221], v[68:75], v170
ds_read_b128 v[44:47], v0 offset:0
v_add_u32_sdwa v84, s42, v122 dst_sel:DWORD dst_unused:UNUSED_PAD src0_sel:DWORD src1_sel:WORD_0
v_smfmac_f32_16x16x64_bf16 v[12:15], v[186:189], v[60:67], v166 abid:1
ds_read_b128 v[48:51], v1 offset:0
v_add_u32_sdwa v85, s42, v122 dst_sel:DWORD dst_unused:UNUSED_PAD src0_sel:DWORD src1_sel:WORD_1
v_smfmac_f32_16x16x64_bf16 v[12:15], v[222:225], v[68:75], v170 abid:1
ds_read_b128 v[52:55], v0 offset:2048
v_add_u32_sdwa v86, s42, v123 dst_sel:DWORD dst_unused:UNUSED_PAD src0_sel:DWORD src1_sel:WORD_0
v_smfmac_f32_16x16x64_bf16 v[16:19], v[190:193], v[60:67], v167
ds_read_b128 v[56:59], v1 offset:2048
v_cvt_pk_bf16_f32 v92, v8, v9
v_smfmac_f32_16x16x64_bf16 v[16:19], v[226:229], v[68:75], v171
ds_read_u16 v76, v76
v_cvt_pk_bf16_f32 v93, v10, v11
v_smfmac_f32_16x16x64_bf16 v[20:23], v[194:197], v[60:67], v167 abid:1
ds_read_b128 v[8:11], v2 offset:1024
v_cvt_pk_bf16_f32 v94, v12, v13
v_smfmac_f32_16x16x64_bf16 v[20:23], v[230:233], v[68:75], v171 abid:1
ds_read_u16 v77, v77
v_cvt_pk_bf16_f32 v95, v14, v15
v_smfmac_f32_16x16x64_bf16 v[24:27], v[198:201], v[60:67], v168
ds_read_b128 v[12:15], v2 offset:1088
v_cvt_pk_bf16_f32 v96, v16, v17
v_smfmac_f32_16x16x64_bf16 v[24:27], v[234:237], v[68:75], v172
ds_read_u16 v78, v78
v_cvt_pk_bf16_f32 v97, v18, v19
v_smfmac_f32_16x16x64_bf16 v[28:31], v[202:205], v[60:67], v168 abid:1
ds_read_b128 v[16:19], v2 offset:1152
v_cvt_pk_bf16_f32 v98, v20, v21
v_smfmac_f32_16x16x64_bf16 v[28:31], v[238:241], v[68:75], v172 abid:1
ds_read_u16 v79, v79
v_cvt_pk_bf16_f32 v99, v22, v23
v_smfmac_f32_16x16x64_bf16 v[32:35], v[206:209], v[60:67], v169
ds_read_b128 v[20:23], v2 offset:1216
v_cvt_pk_bf16_f32 v100, v24, v25
v_smfmac_f32_16x16x64_bf16 v[32:35], v[242:245], v[68:75], v173
ds_read_u16 v80, v80
v_cvt_pk_bf16_f32 v101, v26, v27
v_smfmac_f32_16x16x64_bf16 v[36:39], v[210:213], v[60:67], v169 abid:1
ds_read_b128 v[24:27], v2 offset:1280
v_cvt_pk_bf16_f32 v102, v28, v29
v_smfmac_f32_16x16x64_bf16 v[36:39], v[246:249], v[68:75], v173 abid:1
ds_read_u16 v81, v81
v_cvt_pk_bf16_f32 v103, v30, v31
v_smfmac_f32_16x16x64_bf16 v[40:43], v[214:217], v[60:67], v177 abid:1
s_bitcmp1_b32 s85, s41
ds_read_b128 v[28:31], v2 offset:1344
v_cvt_pk_bf16_f32 v104, v32, v33
v_smfmac_f32_16x16x64_bf16 v[40:43], v[250:253], v[68:75], v178
s_waitcnt lgkmcnt(10)
v_cvt_pk_bf16_f32 v105, v34, v35
s_cbranch_scc1 L_loop
s_cmp_lg_u32 s41, 6
s_cbranch_scc1 L_loopn
.p2align 3
L_loopc:
v_smfmac_f32_16x16x64_bf16 v[8:11], a[0:3], v[44:51], v138
s_cmp_lt_u32 s56, s65
s_cselect_b32 s34, s34, 0
s_cselect_b32 s64, s64, 0
ds_read_b128 v[32:35], v2 offset:1408
v_cvt_pk_bf16_f32 v106, v36, v37
v_mov_b32 v7, 1
v_smfmac_f32_16x16x64_bf16 v[8:11], a[36:39], v[52:59], v142
s_waitcnt lgkmcnt(9)
buffer_atomic_add v7, v6, s[32:35], 0 offen sc0 sc1
v_cvt_pk_bf16_f32 v107, v38, v39
v_smfmac_f32_16x16x64_bf16 v[12:15], a[4:7], v[44:51], v138 abid:1
ds_read_b128 v[36:39], v2 offset:1472
v_cvt_pk_bf16_f32 v112, v40, v41
v_smfmac_f32_16x16x64_bf16 v[12:15], a[40:43], v[52:59], v142 abid:1
s_waitcnt lgkmcnt(8)
ds_read_b128 v[60:63], v0 offset:4096
v_cvt_pk_bf16_f32 v113, v42, v43
v_smfmac_f32_16x16x64_bf16 v[16:19], a[8:11], v[44:51], v139
s_cmp_eq_u32 s4, 129920
ds_read_b128 v[40:43], v2 offset:1536
v_cndmask_b32_dpp v108, v96, v92, vcc quad_perm:[1,0,3,2] row_mask:0xf bank_mask:0xf
v_smfmac_f32_16x16x64_bf16 v[16:19], a[44:47], v[52:59], v143
s_waitcnt lgkmcnt(8)
ds_read_u16 v82, v82
v_cndmask_b32_dpp v109, v97, v93, vcc quad_perm:[1,0,3,2] row_mask:0xf bank_mask:0xf
v_smfmac_f32_16x16x64_bf16 v[20:23], a[12:15], v[44:51], v139 abid:1
s_cselect_b32 s43, -129920, s5
ds_read_u16 v84, v84
v_cndmask_b32_dpp v110, v98, v94, vcc quad_perm:[1,0,3,2] row_mask:0xf bank_mask:0xf
v_smfmac_f32_16x16x64_bf16 v[20:23], a[48:51], v[52:59], v143 abid:1
s_waitcnt lgkmcnt(8)
ds_read_b128 v[64:67], v1 offset:4096
v_cndmask_b32_dpp v111, v99, v95, vcc quad_perm:[1,0,3,2] row_mask:0xf bank_mask:0xf
v_smfmac_f32_16x16x64_bf16 v[24:27], a[16:19], v[44:51], v140
s_add_u32 s4, s4, s43
ds_read_b128 v[68:71], v0 offset:6144
v_add_u32_sdwa v87, s42, v123 dst_sel:DWORD dst_unused:UNUSED_PAD src0_sel:DWORD src1_sel:WORD_1
v_smfmac_f32_16x16x64_bf16 v[24:27], a[52:55], v[52:59], v144
buffer_store_dwordx4 v[108:111], v4, s[20:23], s46 offen offset:0 sc1
s_mov_b64 vcc, s[82:83]
s_waitcnt lgkmcnt(8)
ds_read_b128 v[72:75], v1 offset:6144
v_cndmask_b32_dpp v96, v92, v96, vcc quad_perm:[1,0,3,2] row_mask:0xf bank_mask:0xf
v_cndmask_b32_dpp v97, v93, v97, vcc quad_perm:[1,0,3,2] row_mask:0xf bank_mask:0xf
v_smfmac_f32_16x16x64_bf16 v[28:31], a[20:23], v[44:51], v140 abid:1
s_add_u32 s7, s45, s58
ds_read_u16 v83, v83
v_cndmask_b32_dpp v98, v94, v98, vcc quad_perm:[1,0,3,2] row_mask:0xf bank_mask:0xf
v_smfmac_f32_16x16x64_bf16 v[28:31], a[56:59], v[52:59], v144 abid:1
s_waitcnt lgkmcnt(9)
ds_read_b128 v[114:117], v2 offset:64
v_cndmask_b32_dpp v99, v95, v99, vcc quad_perm:[1,0,3,2] row_mask:0xf bank_mask:0xf
v_smfmac_f32_16x16x64_bf16 v[32:35], a[24:27], v[44:51], v141
ds_read_u16 v85, v85
v_add_u32_sdwa v88, s42, v124 dst_sel:DWORD dst_unused:UNUSED_PAD src0_sel:DWORD src1_sel:WORD_0
v_smfmac_f32_16x16x64_bf16 v[32:35], a[60:63], v[52:59], v145
s_waitcnt lgkmcnt(10)
ds_read_u16 v86, v86
v_add_u32_sdwa v89, s42, v124 dst_sel:DWORD dst_unused:UNUSED_PAD src0_sel:DWORD src1_sel:WORD_1
v_smfmac_f32_16x16x64_bf16 v[36:39], a[28:31], v[44:51], v141 abid:1
ds_read_u16 v87, v87
v_add_u32_sdwa v90, s42, v125 dst_sel:DWORD dst_unused:UNUSED_PAD src0_sel:DWORD src1_sel:WORD_0
v_smfmac_f32_16x16x64_bf16 v[36:39], a[64:67], v[52:59], v145 abid:1
s_waitcnt lgkmcnt(10)
ds_read_u16 v88, v88
v_add_u32_sdwa v91, s42, v125 dst_sel:DWORD dst_unused:UNUSED_PAD src0_sel:DWORD src1_sel:WORD_1
v_smfmac_f32_16x16x64_bf16 v[40:43], a[32:35], v[44:51], v174
buffer_store_dwordx4 v[96:99], v4, s[20:23], s46 offen offset:1152 sc1
s_mov_b64 vcc, s[80:81]
ds_read_u16 v89, v89
v_cndmask_b32_dpp v92, v104, v100, vcc quad_perm:[1,0,3,2] row_mask:0xf bank_mask:0xf
v_cndmask_b32_dpp v93, v105, v101, vcc quad_perm:[1,0,3,2] row_mask:0xf bank_mask:0xf
v_smfmac_f32_16x16x64_bf16 v[40:43], a[68:71], v[52:59], v174 abid:1
s_waitcnt lgkmcnt(9)
ds_read_u16 v90, v90
v_cndmask_b32_dpp v94, v106, v102, vcc quad_perm:[1,0,3,2] row_mask:0xf bank_mask:0xf
v_smfmac_f32_16x16x64_bf16 v[8:11], a[72:75], v[60:67], v146
s_waitcnt lgkmcnt(8)
ds_read_u16 v91, v91
v_cndmask_b32_dpp v95, v107, v103, vcc quad_perm:[1,0,3,2] row_mask:0xf bank_mask:0xf
v_smfmac_f32_16x16x64_bf16 v[8:11], a[108:111], v[68:75], v150
s_waitcnt lgkmcnt(7)
ds_bpermute_b32 v112, v6, v112
v_smfmac_f32_16x16x64_bf16 v[8:11], v[114:117], v[76:83], v179
ds_bpermute_b32 v113, v6, v113
v_smfmac_f32_16x16x64_bf16 v[12:15], v[114:117], v[76:83], v179 abid:1
ds_read_b128 v[114:117], v2 offset:128
v_add_u32_sdwa v76, s42, v126 dst_sel:DWORD dst_unused:UNUSED_PAD src0_sel:DWORD src1_sel:WORD_0
v_smfmac_f32_16x16x64_bf16 v[12:15], a[76:79], v[60:67], v146 abid:1
ds_read_u16 v76, v76
v_add_u32_sdwa v77, s42, v126 dst_sel:DWORD dst_unused:UNUSED_PAD src0_sel:DWORD src1_sel:WORD_1
v_smfmac_f32_16x16x64_bf16 v[12:15], a[112:115], v[68:75], v150 abid:1
buffer_store_dwordx4 v[92:95], v4, s[20:23], s46 offen offset:128 sc1
s_mov_b64 vcc, s[82:83]
ds_read_u16 v77, v77
v_cndmask_b32_dpp v104, v100, v104, vcc quad_perm:[1,0,3,2] row_mask:0xf bank_mask:0xf
v_add_u32_sdwa v78, s42, v127 dst_sel:DWORD dst_unused:UNUSED_PAD src0_sel:DWORD src1_sel:WORD_0
v_smfmac_f32_16x16x64_bf16 v[24:27], a[88:91], v[60:67], v148
ds_read_u16 v78, v78
v_cndmask_b32_dpp v105, v101, v105, vcc quad_perm:[1,0,3,2] row_mask:0xf bank_mask:0xf
v_smfmac_f32_16x16x64_bf16 v[24:27], a[124:127], v[68:75], v152
ds_read_b128 v[44:47], v0 offset:8192
v_cndmask_b32_dpp v106, v102, v106, vcc quad_perm:[1,0,3,2] row_mask:0xf bank_mask:0xf
v_smfmac_f32_16x16x64_bf16 v[28:31], a[92:95], v[60:67], v148 abid:1
ds_read_b128 v[48:51], v1 offset:8192
v_add_u32_sdwa v79, s42, v127 dst_sel:DWORD dst_unused:UNUSED_PAD src0_sel:DWORD src1_sel:WORD_1
v_smfmac_f32_16x16x64_bf16 v[28:31], a[128:131], v[68:75], v152 abid:1
ds_read_u16 v79, v79
v_cndmask_b32_dpp v107, v103, v107, vcc quad_perm:[1,0,3,2] row_mask:0xf bank_mask:0xf
v_smfmac_f32_16x16x64_bf16 v[32:35], a[96:99], v[60:67], v149
ds_read_b128 v[52:55], v0 offset:10240
v_add_u32_sdwa v80, s42, v128 dst_sel:DWORD dst_unused:UNUSED_PAD src0_sel:DWORD src1_sel:WORD_0
v_smfmac_f32_16x16x64_bf16 v[32:35], a[132:135], v[68:75], v153
ds_read_u16 v80, v80
v_add_u32_sdwa v81, s42, v128 dst_sel:DWORD dst_unused:UNUSED_PAD src0_sel:DWORD src1_sel:WORD_1
v_smfmac_f32_16x16x64_bf16 v[16:19], a[80:83], v[60:67], v147
buffer_store_dwordx4 v[104:107], v4, s[20:23], s46 offen offset:1280 sc1
s_mov_b64 vcc, s[80:81]
ds_read_b128 v[56:59], v1 offset:10240
v_add_u32_sdwa v82, s42, v129 dst_sel:DWORD dst_unused:UNUSED_PAD src0_sel:DWORD src1_sel:WORD_0
v_add_u32_sdwa v83, s42, v129 dst_sel:DWORD dst_unused:UNUSED_PAD src0_sel:DWORD src1_sel:WORD_1
v_smfmac_f32_16x16x64_bf16 v[16:19], a[116:119], v[68:75], v151
s_waitcnt lgkmcnt(9)
ds_read_b128 v[92:95], v0 offset:12288
v_add_u32_sdwa v100, s42, v130 dst_sel:DWORD dst_unused:UNUSED_PAD src0_sel:DWORD src1_sel:WORD_0
v_smfmac_f32_16x16x64_bf16 v[16:19], v[114:117], v[84:91], v180 abid:1
ds_read_u16 v81, v81
v_add_u32_sdwa v101, s42, v130 dst_sel:DWORD dst_unused:UNUSED_PAD src0_sel:DWORD src1_sel:WORD_1
v_smfmac_f32_16x16x64_bf16 v[20:23], v[114:117], v[84:91], v181
ds_read_b128 v[96:99], v1 offset:12288
v_add_u32_sdwa v102, s42, v131 dst_sel:DWORD dst_unused:UNUSED_PAD src0_sel:DWORD src1_sel:WORD_0
v_smfmac_f32_16x16x64_bf16 v[20:23], a[84:87], v[60:67], v147 abid:1
ds_read_u16 v100, v100
v_add_u32_sdwa v103, s42, v131 dst_sel:DWORD dst_unused:UNUSED_PAD src0_sel:DWORD src1_sel:WORD_1
v_smfmac_f32_16x16x64_bf16 v[20:23], a[120:123], v[68:75], v151 abid:1
ds_read_u16 v82, v82
v_add_u32_sdwa v104, s42, v132 dst_sel:DWORD dst_unused:UNUSED_PAD src0_sel:DWORD src1_sel:WORD_0
v_smfmac_f32_16x16x64_bf16 v[36:39], a[100:103], v[60:67], v149 abid:1
ds_read_u16 v101, v101
v_add_u32_sdwa v105, s42, v132 dst_sel:DWORD dst_unused:UNUSED_PAD src0_sel:DWORD src1_sel:WORD_1
v_smfmac_f32_16x16x64_bf16 v[36:39], a[136:139], v[68:75], v153 abid:1
buffer_store_dwordx2 v[112:113], v5, s[20:23], s46 offen nt
ds_read_u16 v83, v83
v_add_u32_sdwa v106, s42, v133 dst_sel:DWORD dst_unused:UNUSED_PAD src0_sel:DWORD src1_sel:WORD_0
v_smfmac_f32_16x16x64_bf16 v[40:43], a[104:107], v[60:67], v175
s_mov_b32 s46, s48
ds_read_b128 v[114:117], v2 offset:192
v_add_u32_sdwa v107, s42, v133 dst_sel:DWORD dst_unused:UNUSED_PAD src0_sel:DWORD src1_sel:WORD_1
v_smfmac_f32_16x16x64_bf16 v[40:43], a[140:143], v[68:75], v175 abid:1
s_waitcnt lgkmcnt(12)
ds_read_u16 v102, v102
v_add_u32_sdwa v84, s42, v134 dst_sel:DWORD dst_unused:UNUSED_PAD src0_sel:DWORD src1_sel:WORD_0
v_smfmac_f32_16x16x64_bf16 v[8:11], a[144:147], v[44:51], v154
s_waitcnt lgkmcnt(9)
ds_read_u16 v103, v103
v_add_u32_sdwa v85, s42, v134 dst_sel:DWORD dst_unused:UNUSED_PAD src0_sel:DWORD src1_sel:WORD_1
v_smfmac_f32_16x16x64_bf16 v[8:11], a[180:183], v[52:59], v158
s_waitcnt lgkmcnt(7)
ds_read_u16 v104, v104
v_add_u32_sdwa v86, s42, v135 dst_sel:DWORD dst_unused:UNUSED_PAD src0_sel:DWORD src1_sel:WORD_0
v_smfmac_f32_16x16x64_bf16 v[8:11], a[216:219], v[92:99], v162
s_mov_b32 s48, s49
ds_read_u16 v105, v105
v_add_u32_sdwa v87, s42, v135 dst_sel:DWORD dst_unused:UNUSED_PAD src0_sel:DWORD src1_sel:WORD_1
v_smfmac_f32_16x16x64_bf16 v[24:27], a[160:163], v[44:51], v156
s_add_u32 m0, s44, 0
ds_read_u16 v106, v106
v_add_u32_sdwa v88, s42, v136 dst_sel:DWORD dst_unused:UNUSED_PAD src0_sel:DWORD src1_sel:WORD_0
v_smfmac_f32_16x16x64_bf16 v[24:27], a[196:199], v[52:59], v160
buffer_load_dwordx4 v3, s[16:19], s45 offen offset:0 nt lds
v_add_u32_sdwa v89, s42, v136 dst_sel:DWORD dst_unused:UNUSED_PAD src0_sel:DWORD src1_sel:WORD_1
v_smfmac_f32_16x16x64_bf16 v[24:27], a[232:235], v[92:99], v164
s_waitcnt lgkmcnt(5)
ds_read_u16 v107, v107
v_add_u32_sdwa v90, s42, v137 dst_sel:DWORD dst_unused:UNUSED_PAD src0_sel:DWORD src1_sel:WORD_0
v_smfmac_f32_16x16x64_bf16 v[24:27], v[114:117], v[76:83], v182
s_mov_b32 s49, s50
ds_read_u16 v84, v84
v_add_u32_sdwa v91, s42, v137 dst_sel:DWORD dst_unused:UNUSED_PAD src0_sel:DWORD src1_sel:WORD_1
v_smfmac_f32_16x16x64_bf16 v[28:31], v[114:117], v[76:83], v182 abid:1
s_mov_b32 s50, s45
ds_read_b128 v[114:117], v2 offset:256
v_add_u32_sdwa v76, s4, v118 dst_sel:DWORD dst_unused:UNUSED_PAD src0_sel:DWORD src1_sel:WORD_0
v_smfmac_f32_16x16x64_bf16 v[28:31], a[164:167], v[44:51], v156 abid:1
ds_read_u16 v85, v85
v_add_u32_sdwa v77, s4, v118 dst_sel:DWORD dst_unused:UNUSED_PAD src0_sel:DWORD src1_sel:WORD_1
v_smfmac_f32_16x16x64_bf16 v[28:31], a[200:203], v[52:59], v160 abid:1
ds_read_u16 v86, v86
v_add_u32_sdwa v78, s4, v119 dst_sel:DWORD dst_unused:UNUSED_PAD src0_sel:DWORD src1_sel:WORD_0
v_smfmac_f32_16x16x64_bf16 v[28:31], a[236:239], v[92:99], v164 abid:1
ds_read_u16 v87, v87
v_add_u32_sdwa v79, s4, v119 dst_sel:DWORD dst_unused:UNUSED_PAD src0_sel:DWORD src1_sel:WORD_1
v_smfmac_f32_16x16x64_bf16 v[12:15], a[148:151], v[44:51], v154 abid:1
s_add_u32 m0, s44, 3840
ds_read_u16 v88, v88
v_add_u32_sdwa v80, s4, v120 dst_sel:DWORD dst_unused:UNUSED_PAD src0_sel:DWORD src1_sel:WORD_0
v_smfmac_f32_16x16x64_bf16 v[12:15], a[184:187], v[52:59], v158 abid:1
buffer_load_dwordx4 v3, s[16:19], s45 offen offset:256 nt lds
v_add_u32_sdwa v81, s4, v120 dst_sel:DWORD dst_unused:UNUSED_PAD src0_sel:DWORD src1_sel:WORD_1
v_smfmac_f32_16x16x64_bf16 v[12:15], a[220:223], v[92:99], v162 abid:1
ds_read_b128 v[60:63], v0 offset:14336
v_add_u32_sdwa v82, s4, v121 dst_sel:DWORD dst_unused:UNUSED_PAD src0_sel:DWORD src1_sel:WORD_0
v_smfmac_f32_16x16x64_bf16 v[32:35], a[168:171], v[44:51], v157
s_waitcnt vmcnt(7)
ds_read_u16 v89, v89
v_add_u32_sdwa v83, s4, v121 dst_sel:DWORD dst_unused:UNUSED_PAD src0_sel:DWORD src1_sel:WORD_1
v_smfmac_f32_16x16x64_bf16 v[32:35], a[204:207], v[52:59], v161
ds_read_b128 v[64:67], v1 offset:14336
v_smfmac_f32_16x16x64_bf16 v[32:35], a[240:243], v[92:99], v165
s_waitcnt lgkmcnt(7)
ds_read_b128 v[68:71], v0 offset:16384
v_smfmac_f32_16x16x64_bf16 v[32:35], v[114:117], v[100:107], v183 abid:1
ds_read_u16 v90, v90
v_smfmac_f32_16x16x64_bf16 v[36:39], v[114:117], v[100:107], v184
ds_read_b128 v[72:75], v1 offset:16384
v_add_u32 v0, s43, v0
v_smfmac_f32_16x16x64_bf16 v[36:39], a[172:175], v[44:51], v157 abid:1
s_add_u32 m0, s44, 7680
ds_read_u16 v91, v91
v_add_u32 v1, s43, v1
v_smfmac_f32_16x16x64_bf16 v[36:39], a[208:211], v[52:59], v161 abid:1
buffer_load_dwordx4 v3, s[16:19], s45 offen offset:512 nt lds
v_smfmac_f32_16x16x64_bf16 v[36:39], a[244:247], v[92:99], v165 abid:1
ds_read_b128 v[114:117], v2 offset:320
v_smfmac_f32_16x16x64_bf16 v[16:19], a[152:155], v[44:51], v155
s_add_u32 m0, s44, 11520
v_smfmac_f32_16x16x64_bf16 v[16:19], a[188:191], v[52:59], v159
buffer_load_dwordx4 v3, s[16:19], s45 offen offset:768 nt lds
v_smfmac_f32_16x16x64_bf16 v[16:19], a[224:227], v[92:99], v163
s_mov_b64 exec, s[62:63]
ds_write_b32 v0, v7 offset:18432
s_mov_b64 exec, -1
v_smfmac_f32_16x16x64_bf16 v[20:23], a[156:159], v[44:51], v155 abid:1
s_add_u32 m0, s44, s8
v_smfmac_f32_16x16x64_bf16 v[20:23], a[192:195], v[52:59], v159 abid:1
s_mov_b64 exec, s[10:11]
buffer_load_dwordx4 v3, s[16:19], s7 offen offset:896 nt lds
s_mov_b64 exec, -1
v_smfmac_f32_16x16x64_bf16 v[20:23], a[228:231], v[92:99], v163 abid:1
s_add_u32 s44, s44, s5
s_cmp_ge_u32 s44, 148480
s_cselect_b32 s44, s9, s44
v_smfmac_f32_16x16x64_bf16 v[40:43], a[176:179], v[44:51], v176
v_smfmac_f32_16x16x64_bf16 v[40:43], a[212:215], v[52:59], v176 abid:1
v_smfmac_f32_16x16x64_bf16 v[40:43], a[248:251], v[92:99], v177
s_waitcnt lgkmcnt(0)
v_smfmac_f32_16x16x64_bf16 v[40:43], v[114:117], v[84:91], v185
s_barrier
v_smfmac_f32_16x16x64_bf16 v[8:11], a[252:255], v[60:67], v166
s_mov_b32 s42, s4
ds_read_b32 v7, v0 offset:18432
v_smfmac_f32_16x16x64_bf16 v[8:11], v[218:221], v[68:75], v170
ds_read_b128 v[44:47], v0 offset:0
v_add_u32_sdwa v84, s42, v122 dst_sel:DWORD dst_unused:UNUSED_PAD src0_sel:DWORD src1_sel:WORD_0
v_smfmac_f32_16x16x64_bf16 v[12:15], v[186:189], v[60:67], v166 abid:1
ds_read_b128 v[48:51], v1 offset:0
v_add_u32_sdwa v85, s42, v122 dst_sel:DWORD dst_unused:UNUSED_PAD src0_sel:DWORD src1_sel:WORD_1
v_smfmac_f32_16x16x64_bf16 v[12:15], v[222:225], v[68:75], v170 abid:1
ds_read_b128 v[52:55], v0 offset:2048
v_add_u32_sdwa v86, s42, v123 dst_sel:DWORD dst_unused:UNUSED_PAD src0_sel:DWORD src1_sel:WORD_0
v_smfmac_f32_16x16x64_bf16 v[16:19], v[190:193], v[60:67], v167
ds_read_b128 v[56:59], v1 offset:2048
v_cvt_pk_bf16_f32 v92, v8, v9
v_smfmac_f32_16x16x64_bf16 v[16:19], v[226:229], v[68:75], v171
ds_read_u16 v76, v76
v_cvt_pk_bf16_f32 v93, v10, v11
v_smfmac_f32_16x16x64_bf16 v[20:23], v[194:197], v[60:67], v167 abid:1
ds_read_b128 v[8:11], v2 offset:1024
v_cvt_pk_bf16_f32 v94, v12, v13
v_smfmac_f32_16x16x64_bf16 v[20:23], v[230:233], v[68:75], v171 abid:1
ds_read_u16 v77, v77
v_cvt_pk_bf16_f32 v95, v14, v15
v_smfmac_f32_16x16x64_bf16 v[24:27], v[198:201], v[60:67], v168
ds_read_b128 v[12:15], v2 offset:1088
v_cvt_pk_bf16_f32 v96, v16, v17
v_smfmac_f32_16x16x64_bf16 v[24:27], v[234:237], v[68:75], v172
s_waitcnt lgkmcnt(8)
ds_read_u16 v78, v78
v_cvt_pk_bf16_f32 v97, v18, v19
v_readfirstlane_b32 s56, v7
v_smfmac_f32_16x16x64_bf16 v[28:31], v[202:205], v[60:67], v168 abid:1
s_lshr_b32 s60, s56, 4
ds_read_b128 v[16:19], v2 offset:1152
v_cvt_pk_bf16_f32 v98, v20, v21
v_smfmac_f32_16x16x64_bf16 v[28:31], v[238:241], v[68:75], v172 abid:1
s_mul_i32 s60, s60, 884736
ds_read_u16 v79, v79
v_cvt_pk_bf16_f32 v99, v22, v23
v_smfmac_f32_16x16x64_bf16 v[32:35], v[206:209], v[60:67], v169
s_mul_i32 s61, s56, 18432
ds_read_b128 v[20:23], v2 offset:1216
v_cvt_pk_bf16_f32 v100, v24, v25
v_smfmac_f32_16x16x64_bf16 v[32:35], v[242:245], v[68:75], v173
s_add_u32 s60, s60, s57
ds_read_u16 v80, v80
v_cvt_pk_bf16_f32 v101, v26, v27
v_smfmac_f32_16x16x64_bf16 v[36:39], v[210:213], v[60:67], v169 abid:1
s_add_u32 s45, s60, s61
ds_read_b128 v[24:27], v2 offset:1280
v_cvt_pk_bf16_f32 v102, v28, v29
v_smfmac_f32_16x16x64_bf16 v[36:39], v[246:249], v[68:75], v173 abid:1
ds_read_u16 v81, v81
v_cvt_pk_bf16_f32 v103, v30, v31
v_smfmac_f32_16x16x64_bf16 v[40:43], v[214:217], v[60:67], v177 abid:1
s_cmp_lt_u32 s56, s64
ds_read_b128 v[28:31], v2 offset:1344
v_cvt_pk_bf16_f32 v104, v32, v33
v_smfmac_f32_16x16x64_bf16 v[40:43], v[250:253], v[68:75], v178
s_waitcnt lgkmcnt(10)
v_cvt_pk_bf16_f32 v105, v34, v35
s_cbranch_scc1 L_loopc
s_mov_b32 s41, 0
s_mov_b32 s15, 3
s_mov_b32 s12, 7
s_mov_b32 s92, 4
s_mov_b32 s87, 4
s_mov_b32 s59, -1
.p2align 3
L_loopn:
v_smfmac_f32_16x16x64_bf16 v[8:11], a[0:3], v[44:51], v138
ds_read_b128 v[32:35], v2 offset:1408
v_cvt_pk_bf16_f32 v106, v36, v37
v_smfmac_f32_16x16x64_bf16 v[8:11], a[36:39], v[52:59], v142
s_waitcnt lgkmcnt(9)
v_cvt_pk_bf16_f32 v107, v38, v39
v_smfmac_f32_16x16x64_bf16 v[12:15], a[4:7], v[44:51], v138 abid:1
ds_read_b128 v[36:39], v2 offset:1472
v_cvt_pk_bf16_f32 v112, v40, v41
v_smfmac_f32_16x16x64_bf16 v[12:15], a[40:43], v[52:59], v142 abid:1
s_waitcnt lgkmcnt(8)
ds_read_b128 v[60:63], v0 offset:4096
v_cvt_pk_bf16_f32 v113, v42, v43
v_smfmac_f32_16x16x64_bf16 v[16:19], a[8:11], v[44:51], v139
s_cmp_eq_u32 s4, 129920
ds_read_b128 v[40:43], v2 offset:1536
v_cndmask_b32_dpp v108, v96, v92, vcc quad_perm:[1,0,3,2] row_mask:0xf bank_mask:0xf
v_smfmac_f32_16x16x64_bf16 v[16:19], a[44:47], v[52:59], v143
s_waitcnt lgkmcnt(8)
ds_read_u16 v82, v82
v_cndmask_b32_dpp v109, v97, v93, vcc quad_perm:[1,0,3,2] row_mask:0xf bank_mask:0xf
v_smfmac_f32_16x16x64_bf16 v[20:23], a[12:15], v[44:51], v139 abid:1
s_cselect_b32 s43, -129920, s5
ds_read_u16 v84, v84
v_cndmask_b32_dpp v110, v98, v94, vcc quad_perm:[1,0,3,2] row_mask:0xf bank_mask:0xf
v_smfmac_f32_16x16x64_bf16 v[20:23], a[48:51], v[52:59], v143 abid:1
s_waitcnt lgkmcnt(8)
ds_read_b128 v[64:67], v1 offset:4096
v_cndmask_b32_dpp v111, v99, v95, vcc quad_perm:[1,0,3,2] row_mask:0xf bank_mask:0xf
v_smfmac_f32_16x16x64_bf16 v[24:27], a[16:19], v[44:51], v140
s_add_u32 s4, s4, s43
ds_read_b128 v[68:71], v0 offset:6144
v_add_u32_sdwa v87, s42, v123 dst_sel:DWORD dst_unused:UNUSED_PAD src0_sel:DWORD src1_sel:WORD_1
v_smfmac_f32_16x16x64_bf16 v[24:27], a[52:55], v[52:59], v144
buffer_store_dwordx4 v[108:111], v4, s[20:23], s46 offen offset:0 sc1
s_mov_b64 vcc, s[82:83]
s_waitcnt lgkmcnt(8)
ds_read_b128 v[72:75], v1 offset:6144
v_cndmask_b32_dpp v96, v92, v96, vcc quad_perm:[1,0,3,2] row_mask:0xf bank_mask:0xf
v_cndmask_b32_dpp v97, v93, v97, vcc quad_perm:[1,0,3,2] row_mask:0xf bank_mask:0xf
v_smfmac_f32_16x16x64_bf16 v[28:31], a[20:23], v[44:51], v140 abid:1
s_add_u32 s41, s41, 1
ds_read_u16 v83, v83
v_cndmask_b32_dpp v98, v94, v98, vcc quad_perm:[1,0,3,2] row_mask:0xf bank_mask:0xf
v_smfmac_f32_16x16x64_bf16 v[28:31], a[56:59], v[52:59], v144 abid:1
s_waitcnt lgkmcnt(9)
ds_read_b128 v[114:117], v2 offset:64
v_cndmask_b32_dpp v99, v95, v99, vcc quad_perm:[1,0,3,2] row_mask:0xf bank_mask:0xf
v_smfmac_f32_16x16x64_bf16 v[32:35], a[24:27], v[44:51], v141
ds_read_u16 v85, v85
v_add_u32_sdwa v88, s42, v124 dst_sel:DWORD dst_unused:UNUSED_PAD src0_sel:DWORD src1_sel:WORD_0
v_smfmac_f32_16x16x64_bf16 v[32:35], a[60:63], v[52:59], v145
s_waitcnt lgkmcnt(10)
ds_read_u16 v86, v86
v_add_u32_sdwa v89, s42, v124 dst_sel:DWORD dst_unused:UNUSED_PAD src0_sel:DWORD src1_sel:WORD_1
v_smfmac_f32_16x16x64_bf16 v[36:39], a[28:31], v[44:51], v141 abid:1
ds_read_u16 v87, v87
v_add_u32_sdwa v90, s42, v125 dst_sel:DWORD dst_unused:UNUSED_PAD src0_sel:DWORD src1_sel:WORD_0
v_smfmac_f32_16x16x64_bf16 v[36:39], a[64:67], v[52:59], v145 abid:1
s_waitcnt lgkmcnt(10)
ds_read_u16 v88, v88
v_add_u32_sdwa v91, s42, v125 dst_sel:DWORD dst_unused:UNUSED_PAD src0_sel:DWORD src1_sel:WORD_1
v_smfmac_f32_16x16x64_bf16 v[40:43], a[32:35], v[44:51], v174
buffer_store_dwordx4 v[96:99], v4, s[20:23], s46 offen offset:1152 sc1
s_mov_b64 vcc, s[80:81]
ds_read_u16 v89, v89
v_cndmask_b32_dpp v92, v104, v100, vcc quad_perm:[1,0,3,2] row_mask:0xf bank_mask:0xf
v_cndmask_b32_dpp v93, v105, v101, vcc quad_perm:[1,0,3,2] row_mask:0xf bank_mask:0xf
v_smfmac_f32_16x16x64_bf16 v[40:43], a[68:71], v[52:59], v174 abid:1
s_waitcnt lgkmcnt(9)
ds_read_u16 v90, v90
v_cndmask_b32_dpp v94, v106, v102, vcc quad_perm:[1,0,3,2] row_mask:0xf bank_mask:0xf
v_smfmac_f32_16x16x64_bf16 v[8:11], a[72:75], v[60:67], v146
s_waitcnt lgkmcnt(8)
ds_read_u16 v91, v91
v_cndmask_b32_dpp v95, v107, v103, vcc quad_perm:[1,0,3,2] row_mask:0xf bank_mask:0xf
v_smfmac_f32_16x16x64_bf16 v[8:11], a[108:111], v[68:75], v150
s_waitcnt lgkmcnt(7)
ds_bpermute_b32 v112, v6, v112
v_smfmac_f32_16x16x64_bf16 v[8:11], v[114:117], v[76:83], v179
ds_bpermute_b32 v113, v6, v113
v_smfmac_f32_16x16x64_bf16 v[12:15], v[114:117], v[76:83], v179 abid:1
ds_read_b128 v[114:117], v2 offset:128
v_add_u32_sdwa v76, s42, v126 dst_sel:DWORD dst_unused:UNUSED_PAD src0_sel:DWORD src1_sel:WORD_0
v_smfmac_f32_16x16x64_bf16 v[12:15], a[76:79], v[60:67], v146 abid:1
ds_read_u16 v76, v76
v_add_u32_sdwa v77, s42, v126 dst_sel:DWORD dst_unused:UNUSED_PAD src0_sel:DWORD src1_sel:WORD_1
v_smfmac_f32_16x16x64_bf16 v[12:15], a[112:115], v[68:75], v150 abid:1
buffer_store_dwordx4 v[92:95], v4, s[20:23], s46 offen offset:128 sc1
s_mov_b64 vcc, s[82:83]
ds_read_u16 v77, v77
v_cndmask_b32_dpp v104, v100, v104, vcc quad_perm:[1,0,3,2] row_mask:0xf bank_mask:0xf
v_add_u32_sdwa v78, s42, v127 dst_sel:DWORD dst_unused:UNUSED_PAD src0_sel:DWORD src1_sel:WORD_0
v_smfmac_f32_16x16x64_bf16 v[24:27], a[88:91], v[60:67], v148
ds_read_u16 v78, v78
v_cndmask_b32_dpp v105, v101, v105, vcc quad_perm:[1,0,3,2] row_mask:0xf bank_mask:0xf
v_smfmac_f32_16x16x64_bf16 v[24:27], a[124:127], v[68:75], v152
ds_read_b128 v[44:47], v0 offset:8192
v_cndmask_b32_dpp v106, v102, v106, vcc quad_perm:[1,0,3,2] row_mask:0xf bank_mask:0xf
v_smfmac_f32_16x16x64_bf16 v[28:31], a[92:95], v[60:67], v148 abid:1
ds_read_b128 v[48:51], v1 offset:8192
v_add_u32_sdwa v79, s42, v127 dst_sel:DWORD dst_unused:UNUSED_PAD src0_sel:DWORD src1_sel:WORD_1
v_smfmac_f32_16x16x64_bf16 v[28:31], a[128:131], v[68:75], v152 abid:1
ds_read_u16 v79, v79
v_cndmask_b32_dpp v107, v103, v107, vcc quad_perm:[1,0,3,2] row_mask:0xf bank_mask:0xf
v_smfmac_f32_16x16x64_bf16 v[32:35], a[96:99], v[60:67], v149
ds_read_b128 v[52:55], v0 offset:10240
v_add_u32_sdwa v80, s42, v128 dst_sel:DWORD dst_unused:UNUSED_PAD src0_sel:DWORD src1_sel:WORD_0
v_smfmac_f32_16x16x64_bf16 v[32:35], a[132:135], v[68:75], v153
ds_read_u16 v80, v80
v_add_u32_sdwa v81, s42, v128 dst_sel:DWORD dst_unused:UNUSED_PAD src0_sel:DWORD src1_sel:WORD_1
v_smfmac_f32_16x16x64_bf16 v[16:19], a[80:83], v[60:67], v147
buffer_store_dwordx4 v[104:107], v4, s[20:23], s46 offen offset:1280 sc1
s_mov_b64 vcc, s[80:81]
ds_read_b128 v[56:59], v1 offset:10240
v_add_u32_sdwa v82, s42, v129 dst_sel:DWORD dst_unused:UNUSED_PAD src0_sel:DWORD src1_sel:WORD_0
v_add_u32_sdwa v83, s42, v129 dst_sel:DWORD dst_unused:UNUSED_PAD src0_sel:DWORD src1_sel:WORD_1
v_smfmac_f32_16x16x64_bf16 v[16:19], a[116:119], v[68:75], v151
s_waitcnt lgkmcnt(9)
ds_read_b128 v[92:95], v0 offset:12288
v_add_u32_sdwa v100, s42, v130 dst_sel:DWORD dst_unused:UNUSED_PAD src0_sel:DWORD src1_sel:WORD_0
v_smfmac_f32_16x16x64_bf16 v[16:19], v[114:117], v[84:91], v180 abid:1
ds_read_u16 v81, v81
v_add_u32_sdwa v101, s42, v130 dst_sel:DWORD dst_unused:UNUSED_PAD src0_sel:DWORD src1_sel:WORD_1
v_smfmac_f32_16x16x64_bf16 v[20:23], v[114:117], v[84:91], v181
ds_read_b128 v[96:99], v1 offset:12288
v_add_u32_sdwa v102, s42, v131 dst_sel:DWORD dst_unused:UNUSED_PAD src0_sel:DWORD src1_sel:WORD_0
v_smfmac_f32_16x16x64_bf16 v[20:23], a[84:87], v[60:67], v147 abid:1
ds_read_u16 v100, v100
v_add_u32_sdwa v103, s42, v131 dst_sel:DWORD dst_unused:UNUSED_PAD src0_sel:DWORD src1_sel:WORD_1
v_smfmac_f32_16x16x64_bf16 v[20:23], a[120:123], v[68:75], v151 abid:1
ds_read_u16 v82, v82
v_add_u32_sdwa v104, s42, v132 dst_sel:DWORD dst_unused:UNUSED_PAD src0_sel:DWORD src1_sel:WORD_0
v_smfmac_f32_16x16x64_bf16 v[36:39], a[100:103], v[60:67], v149 abid:1
ds_read_u16 v101, v101
v_add_u32_sdwa v105, s42, v132 dst_sel:DWORD dst_unused:UNUSED_PAD src0_sel:DWORD src1_sel:WORD_1
v_smfmac_f32_16x16x64_bf16 v[36:39], a[136:139], v[68:75], v153 abid:1
buffer_store_dwordx2 v[112:113], v5, s[20:23], s46 offen nt
ds_read_u16 v83, v83
v_add_u32_sdwa v106, s42, v133 dst_sel:DWORD dst_unused:UNUSED_PAD src0_sel:DWORD src1_sel:WORD_0
v_smfmac_f32_16x16x64_bf16 v[40:43], a[104:107], v[60:67], v175
s_mov_b32 s22, 75497472
ds_read_b128 v[114:117], v2 offset:192
v_add_u32_sdwa v107, s42, v133 dst_sel:DWORD dst_unused:UNUSED_PAD src0_sel:DWORD src1_sel:WORD_1
v_smfmac_f32_16x16x64_bf16 v[40:43], a[140:143], v[68:75], v175 abid:1
s_waitcnt lgkmcnt(12)
ds_read_u16 v102, v102
v_add_u32_sdwa v84, s42, v134 dst_sel:DWORD dst_unused:UNUSED_PAD src0_sel:DWORD src1_sel:WORD_0
v_smfmac_f32_16x16x64_bf16 v[8:11], a[144:147], v[44:51], v154
s_waitcnt lgkmcnt(9)
ds_read_u16 v103, v103
v_add_u32_sdwa v85, s42, v134 dst_sel:DWORD dst_unused:UNUSED_PAD src0_sel:DWORD src1_sel:WORD_1
v_smfmac_f32_16x16x64_bf16 v[8:11], a[180:183], v[52:59], v158
s_waitcnt lgkmcnt(7)
ds_read_u16 v104, v104
v_add_u32_sdwa v86, s42, v135 dst_sel:DWORD dst_unused:UNUSED_PAD src0_sel:DWORD src1_sel:WORD_0
v_smfmac_f32_16x16x64_bf16 v[8:11], a[216:219], v[92:99], v162
s_mov_b32 s46, s48
ds_read_u16 v105, v105
v_add_u32_sdwa v87, s42, v135 dst_sel:DWORD dst_unused:UNUSED_PAD src0_sel:DWORD src1_sel:WORD_1
v_smfmac_f32_16x16x64_bf16 v[24:27], a[160:163], v[44:51], v156
s_mov_b32 s48, s49
ds_read_u16 v106, v106
v_add_u32_sdwa v88, s42, v136 dst_sel:DWORD dst_unused:UNUSED_PAD src0_sel:DWORD src1_sel:WORD_0
v_smfmac_f32_16x16x64_bf16 v[24:27], a[196:199], v[52:59], v160
s_mov_b32 s49, s50
s_add_u32 s50, s50, 4718592
v_add_u32_sdwa v89, s42, v136 dst_sel:DWORD dst_unused:UNUSED_PAD src0_sel:DWORD src1_sel:WORD_1
v_smfmac_f32_16x16x64_bf16 v[24:27], a[232:235], v[92:99], v164
s_waitcnt lgkmcnt(5)
ds_read_u16 v107, v107
v_add_u32_sdwa v90, s42, v137 dst_sel:DWORD dst_unused:UNUSED_PAD src0_sel:DWORD src1_sel:WORD_0
v_smfmac_f32_16x16x64_bf16 v[24:27], v[114:117], v[76:83], v182
ds_read_u16 v84, v84
v_add_u32_sdwa v91, s42, v137 dst_sel:DWORD dst_unused:UNUSED_PAD src0_sel:DWORD src1_sel:WORD_1
v_smfmac_f32_16x16x64_bf16 v[28:31], v[114:117], v[76:83], v182 abid:1
ds_read_b128 v[114:117], v2 offset:256
v_add_u32_sdwa v76, s4, v118 dst_sel:DWORD dst_unused:UNUSED_PAD src0_sel:DWORD src1_sel:WORD_0
v_smfmac_f32_16x16x64_bf16 v[28:31], a[164:167], v[44:51], v156 abid:1
ds_read_u16 v85, v85
v_add_u32_sdwa v77, s4, v118 dst_sel:DWORD dst_unused:UNUSED_PAD src0_sel:DWORD src1_sel:WORD_1
v_smfmac_f32_16x16x64_bf16 v[28:31], a[200:203], v[52:59], v160 abid:1
ds_read_u16 v86, v86
v_add_u32_sdwa v78, s4, v119 dst_sel:DWORD dst_unused:UNUSED_PAD src0_sel:DWORD src1_sel:WORD_0
v_smfmac_f32_16x16x64_bf16 v[28:31], a[236:239], v[92:99], v164 abid:1
ds_read_u16 v87, v87
v_add_u32_sdwa v79, s4, v119 dst_sel:DWORD dst_unused:UNUSED_PAD src0_sel:DWORD src1_sel:WORD_1
v_smfmac_f32_16x16x64_bf16 v[12:15], a[148:151], v[44:51], v154 abid:1
ds_read_u16 v88, v88
v_add_u32_sdwa v80, s4, v120 dst_sel:DWORD dst_unused:UNUSED_PAD src0_sel:DWORD src1_sel:WORD_0
v_smfmac_f32_16x16x64_bf16 v[12:15], a[184:187], v[52:59], v158 abid:1
v_add_u32_sdwa v81, s4, v120 dst_sel:DWORD dst_unused:UNUSED_PAD src0_sel:DWORD src1_sel:WORD_1
v_smfmac_f32_16x16x64_bf16 v[12:15], a[220:223], v[92:99], v162 abid:1
ds_read_b128 v[60:63], v0 offset:14336
v_add_u32_sdwa v82, s4, v121 dst_sel:DWORD dst_unused:UNUSED_PAD src0_sel:DWORD src1_sel:WORD_0
v_smfmac_f32_16x16x64_bf16 v[32:35], a[168:171], v[44:51], v157
ds_read_u16 v89, v89
v_add_u32_sdwa v83, s4, v121 dst_sel:DWORD dst_unused:UNUSED_PAD src0_sel:DWORD src1_sel:WORD_1
v_smfmac_f32_16x16x64_bf16 v[32:35], a[204:207], v[52:59], v161
ds_read_b128 v[64:67], v1 offset:14336
v_smfmac_f32_16x16x64_bf16 v[32:35], a[240:243], v[92:99], v165
s_waitcnt lgkmcnt(7)
ds_read_b128 v[68:71], v0 offset:16384
v_smfmac_f32_16x16x64_bf16 v[32:35], v[114:117], v[100:107], v183 abid:1
ds_read_u16 v90, v90
v_smfmac_f32_16x16x64_bf16 v[36:39], v[114:117], v[100:107], v184
ds_read_b128 v[72:75], v1 offset:16384
v_add_u32 v0, s43, v0
v_smfmac_f32_16x16x64_bf16 v[36:39], a[172:175], v[44:51], v157 abid:1
ds_read_u16 v91, v91
v_add_u32 v1, s43, v1
v_smfmac_f32_16x16x64_bf16 v[36:39], a[208:211], v[52:59], v161 abid:1
v_smfmac_f32_16x16x64_bf16 v[36:39], a[244:247], v[92:99], v165 abid:1
ds_read_b128 v[114:117], v2 offset:320
v_smfmac_f32_16x16x64_bf16 v[16:19], a[152:155], v[44:51], v155
v_smfmac_f32_16x16x64_bf16 v[16:19], a[188:191], v[52:59], v159
v_smfmac_f32_16x16x64_bf16 v[16:19], a[224:227], v[92:99], v163
v_smfmac_f32_16x16x64_bf16 v[20:23], a[156:159], v[44:51], v155 abid:1
v_smfmac_f32_16x16x64_bf16 v[20:23], a[192:195], v[52:59], v159 abid:1
v_smfmac_f32_16x16x64_bf16 v[20:23], a[228:231], v[92:99], v163 abid:1
v_smfmac_f32_16x16x64_bf16 v[40:43], a[176:179], v[44:51], v176
s_bitcmp1_b32 s92, s41
v_smfmac_f32_16x16x64_bf16 v[40:43], a[212:215], v[52:59], v176 abid:1
s_cbranch_scc1 L_loopn_w
L_loopn_wb:
v_smfmac_f32_16x16x64_bf16 v[40:43], a[248:251], v[92:99], v177
s_waitcnt lgkmcnt(0)
v_smfmac_f32_16x16x64_bf16 v[40:43], v[114:117], v[84:91], v185
s_waitcnt vmcnt(20)
s_barrier
L_loopn_p3:
v_smfmac_f32_16x16x64_bf16 v[8:11], a[252:255], v[60:67], v166
s_mov_b32 s42, s4
v_smfmac_f32_16x16x64_bf16 v[8:11], v[218:221], v[68:75], v170
ds_read_b128 v[44:47], v0 offset:0
v_add_u32_sdwa v84, s42, v122 dst_sel:DWORD dst_unused:UNUSED_PAD src0_sel:DWORD src1_sel:WORD_0
v_smfmac_f32_16x16x64_bf16 v[12:15], v[186:189], v[60:67], v166 abid:1
ds_read_b128 v[48:51], v1 offset:0
v_add_u32_sdwa v85, s42, v122 dst_sel:DWORD dst_unused:UNUSED_PAD src0_sel:DWORD src1_sel:WORD_1
v_smfmac_f32_16x16x64_bf16 v[12:15], v[222:225], v[68:75], v170 abid:1
ds_read_b128 v[52:55], v0 offset:2048
v_add_u32_sdwa v86, s42, v123 dst_sel:DWORD dst_unused:UNUSED_PAD src0_sel:DWORD src1_sel:WORD_0
v_smfmac_f32_16x16x64_bf16 v[16:19], v[190:193], v[60:67], v167
ds_read_b128 v[56:59], v1 offset:2048
v_cvt_pk_bf16_f32 v92, v8, v9
v_smfmac_f32_16x16x64_bf16 v[16:19], v[226:229], v[68:75], v171
ds_read_u16 v76, v76
v_cvt_pk_bf16_f32 v93, v10, v11
v_smfmac_f32_16x16x64_bf16 v[20:23], v[194:197], v[60:67], v167 abid:1
ds_read_b128 v[8:11], v2 offset:1024
v_cvt_pk_bf16_f32 v94, v12, v13
v_smfmac_f32_16x16x64_bf16 v[20:23], v[230:233], v[68:75], v171 abid:1
ds_read_u16 v77, v77
v_cvt_pk_bf16_f32 v95, v14, v15
v_smfmac_f32_16x16x64_bf16 v[24:27], v[198:201], v[60:67], v168
ds_read_b128 v[12:15], v2 offset:1088
v_cvt_pk_bf16_f32 v96, v16, v17
v_smfmac_f32_16x16x64_bf16 v[24:27], v[234:237], v[68:75], v172
ds_read_u16 v78, v78
v_cvt_pk_bf16_f32 v97, v18, v19
v_smfmac_f32_16x16x64_bf16 v[28:31], v[202:205], v[60:67], v168 abid:1
ds_read_b128 v[16:19], v2 offset:1152
v_cvt_pk_bf16_f32 v98, v20, v21
v_smfmac_f32_16x16x64_bf16 v[28:31], v[238:241], v[68:75], v172 abid:1
ds_read_u16 v79, v79
v_cvt_pk_bf16_f32 v99, v22, v23
v_smfmac_f32_16x16x64_bf16 v[32:35], v[206:209], v[60:67], v169
ds_read_b128 v[20:23], v2 offset:1216
v_cvt_pk_bf16_f32 v100, v24, v25
v_smfmac_f32_16x16x64_bf16 v[32:35], v[242:245], v[68:75], v173
ds_read_u16 v80, v80
v_cvt_pk_bf16_f32 v101, v26, v27
v_smfmac_f32_16x16x64_bf16 v[36:39], v[210:213], v[60:67], v169 abid:1
ds_read_b128 v[24:27], v2 offset:1280
v_cvt_pk_bf16_f32 v102, v28, v29
v_smfmac_f32_16x16x64_bf16 v[36:39], v[246:249], v[68:75], v173 abid:1
ds_read_u16 v81, v81
v_cvt_pk_bf16_f32 v103, v30, v31
v_smfmac_f32_16x16x64_bf16 v[40:43], v[214:217], v[60:67], v177 abid:1
s_bitcmp1_b32 s12, s41
ds_read_b128 v[28:31], v2 offset:1344
v_cvt_pk_bf16_f32 v104, v32, v33
v_smfmac_f32_16x16x64_bf16 v[40:43], v[250:253], v[68:75], v178
s_waitcnt lgkmcnt(10)
v_cvt_pk_bf16_f32 v105, v34, v35
s_cbranch_scc1 L_loopn
s_cmp_eq_u32 s41, s59
s_cbranch_scc1 L_loopc
s_cmp_lt_u32 s41, s15
s_cbranch_scc1 L_loop
s_nop 0
v_cndmask_b32_dpp v108, v96, v92, vcc quad_perm:[1,0,3,2] row_mask:0xf bank_mask:0xf
v_cndmask_b32_dpp v109, v97, v93, vcc quad_perm:[1,0,3,2] row_mask:0xf bank_mask:0xf
v_cndmask_b32_dpp v110, v98, v94, vcc quad_perm:[1,0,3,2] row_mask:0xf bank_mask:0xf
v_cndmask_b32_dpp v111, v99, v95, vcc quad_perm:[1,0,3,2] row_mask:0xf bank_mask:0xf
buffer_store_dwordx4 v[108:111], v4, s[20:23], s46 offen offset:0 sc1
s_mov_b64 vcc, s[82:83]
v_cvt_pk_bf16_f32 v112, v40, v41
v_cvt_pk_bf16_f32 v113, v42, v43
ds_bpermute_b32 v112, v6, v112
ds_bpermute_b32 v113, v6, v113
v_cndmask_b32_dpp v96, v92, v96, vcc quad_perm:[1,0,3,2] row_mask:0xf bank_mask:0xf
v_cndmask_b32_dpp v97, v93, v97, vcc quad_perm:[1,0,3,2] row_mask:0xf bank_mask:0xf
v_cndmask_b32_dpp v98, v94, v98, vcc quad_perm:[1,0,3,2] row_mask:0xf bank_mask:0xf
v_cndmask_b32_dpp v99, v95, v99, vcc quad_perm:[1,0,3,2] row_mask:0xf bank_mask:0xf
buffer_store_dwordx4 v[96:99], v4, s[20:23], s46 offen offset:1152 sc1
s_mov_b64 vcc, s[80:81]
v_cvt_pk_bf16_f32 v106, v36, v37
v_cvt_pk_bf16_f32 v107, v38, v39
v_cndmask_b32_dpp v92, v104, v100, vcc quad_perm:[1,0,3,2] row_mask:0xf bank_mask:0xf
v_cndmask_b32_dpp v93, v105, v101, vcc quad_perm:[1,0,3,2] row_mask:0xf bank_mask:0xf
v_cndmask_b32_dpp v94, v106, v102, vcc quad_perm:[1,0,3,2] row_mask:0xf bank_mask:0xf
v_cndmask_b32_dpp v95, v107, v103, vcc quad_perm:[1,0,3,2] row_mask:0xf bank_mask:0xf
buffer_store_dwordx4 v[92:95], v4, s[20:23], s46 offen offset:128 sc1
s_mov_b64 vcc, s[82:83]
v_cndmask_b32_dpp v104, v100, v104, vcc quad_perm:[1,0,3,2] row_mask:0xf bank_mask:0xf
v_cndmask_b32_dpp v105, v101, v105, vcc quad_perm:[1,0,3,2] row_mask:0xf bank_mask:0xf
v_cndmask_b32_dpp v106, v102, v106, vcc quad_perm:[1,0,3,2] row_mask:0xf bank_mask:0xf
v_cndmask_b32_dpp v107, v103, v107, vcc quad_perm:[1,0,3,2] row_mask:0xf bank_mask:0xf
buffer_store_dwordx4 v[104:107], v4, s[20:23], s46 offen offset:1280 sc1
s_mov_b64 vcc, s[80:81]
s_waitcnt lgkmcnt(0)
buffer_store_dwordx2 v[112:113], v5, s[20:23], s46 offen nt
L_fin:
L_end_standalone__structured_sparse_n_m__ragged_kernel:
s_endpgm
L_more1:
v_and_b32 v73, v94, v16
v_lshrrev_b32 v72, 10, v16
v_cmp_eq_u32 s[64:65], v73, v95
v_and_or_b32 v32, v72, v96, v97
s_mov_b64 exec, s[64:65]
ds_add_rtn_u32 v48, v32, v88
s_mov_b64 exec, -1
v_and_b32 v73, v94, v17
v_lshrrev_b32 v72, 10, v17
v_cmp_eq_u32 s[66:67], v73, v95
v_and_or_b32 v33, v72, v96, v97
s_mov_b64 exec, s[66:67]
ds_add_rtn_u32 v49, v33, v88
s_mov_b64 exec, -1
v_and_b32 v73, v94, v18
v_lshrrev_b32 v72, 10, v18
v_cmp_eq_u32 s[68:69], v73, v95
v_and_or_b32 v34, v72, v96, v97
s_mov_b64 exec, s[68:69]
ds_add_rtn_u32 v50, v34, v88
s_mov_b64 exec, -1
v_and_b32 v73, v94, v19
v_lshrrev_b32 v72, 10, v19
v_cmp_eq_u32 s[70:71], v73, v95
v_and_or_b32 v35, v72, v96, v97
s_mov_b64 exec, s[70:71]
ds_add_rtn_u32 v51, v35, v88
s_mov_b64 exec, -1
v_and_b32 v73, v94, v20
v_lshrrev_b32 v72, 10, v20
v_cmp_eq_u32 s[72:73], v73, v95
v_and_or_b32 v36, v72, v96, v97
s_mov_b64 exec, s[72:73]
ds_add_rtn_u32 v52, v36, v88
s_mov_b64 exec, -1
v_and_b32 v73, v94, v21
v_lshrrev_b32 v72, 10, v21
v_cmp_eq_u32 s[74:75], v73, v95
v_and_or_b32 v37, v72, v96, v97
s_mov_b64 exec, s[74:75]
ds_add_rtn_u32 v53, v37, v88
s_mov_b64 exec, -1
v_and_b32 v73, v94, v22
v_lshrrev_b32 v72, 10, v22
v_cmp_eq_u32 s[76:77], v73, v95
v_and_or_b32 v38, v72, v96, v97
s_mov_b64 exec, s[76:77]
ds_add_rtn_u32 v54, v38, v88
s_mov_b64 exec, -1
s_branch L_more1b
L_greedy:
s_mov_b32 s47, 0
s_mov_b32 s89, 1
v_readlane_b32 s3, v72, 0
s_max_u32 s47, s47, 0
v_writelane_b32 v91, s47, 0
s_nop 1
s_add_u32 s47, s47, s3
s_cmp_gt_u32 s47, 32
s_cselect_b32 s90, 1, s90
v_readlane_b32 s3, v72, 1
s_max_u32 s47, s47, 0
v_writelane_b32 v91, s47, 1
s_nop 1
s_add_u32 s47, s47, s3
s_cmp_gt_u32 s47, 64
s_cselect_b32 s90, 1, s90
v_readlane_b32 s3, v72, 2
s_max_u32 s47, s47, 32
v_writelane_b32 v91, s47, 2
s_nop 1
s_add_u32 s47, s47, s3
s_cmp_gt_u32 s47, 64
s_cselect_b32 s90, 1, s90
v_readlane_b32 s3, v72, 3
s_max_u32 s47, s47, 32
v_writelane_b32 v91, s47, 3
s_nop 1
s_add_u32 s47, s47, s3
s_cmp_gt_u32 s47, 96
s_cselect_b32 s90, 1, s90
v_readlane_b32 s3, v72, 4
s_max_u32 s47, s47, 64
v_writelane_b32 v91, s47, 4
s_nop 1
s_add_u32 s47, s47, s3
s_cmp_gt_u32 s47, 96
s_cselect_b32 s90, 1, s90
v_readlane_b32 s3, v72, 5
s_max_u32 s47, s47, 64
v_writelane_b32 v91, s47, 5
s_nop 1
s_add_u32 s47, s47, s3
s_cmp_gt_u32 s47, 128
s_cselect_b32 s90, 1, s90
v_readlane_b32 s3, v72, 6
s_max_u32 s47, s47, 96
v_writelane_b32 v91, s47, 6
s_nop 1
s_add_u32 s47, s47, s3
s_cmp_gt_u32 s47, 128
s_cselect_b32 s90, 1, s90
v_readlane_b32 s3, v72, 7
s_max_u32 s47, s47, 96
v_writelane_b32 v91, s47, 7
s_nop 1
s_add_u32 s47, s47, s3
s_cmp_gt_u32 s47, 160
s_cselect_b32 s90, 1, s90
v_readlane_b32 s3, v72, 8
s_max_u32 s47, s47, 128
v_writelane_b32 v91, s47, 8
s_nop 1
s_add_u32 s47, s47, s3
s_cmp_gt_u32 s47, 160
s_cselect_b32 s90, 1, s90
s_cmp_lg_u32 s90, 0
s_cselect_b64 s[90:91], -1, 0
v_mov_b32 v73, 163072
s_mov_b64 exec, s[90:91]
ds_write_b32 v73, v88
s_mov_b64 exec, -1
s_branch L_greedyb
L_more2:
ds_bpermute_b32 v64, v32, v91
ds_bpermute_b32 v65, v33, v91
ds_bpermute_b32 v66, v34, v91
ds_bpermute_b32 v67, v35, v91
ds_bpermute_b32 v68, v36, v91
ds_bpermute_b32 v69, v37, v91
ds_bpermute_b32 v70, v38, v91
s_waitcnt lgkmcnt(0)
v_add_u32 v73, v48, v64
v_and_b32 v72, 0x87e, v16
v_lshl_add_u32 v73, v73, 1, s93
v_add_u32 v72, v90, v72
s_andn2_b64 exec, s[64:65], s[90:91]
ds_write_b16_d16_hi v73, v16 offset:64
ds_write_b16 v73, v72 offset:384
ds_write_b16 v73, v16 offset:704
s_mov_b64 exec, -1
v_add_u32 v73, v49, v65
v_and_b32 v72, 0x87e, v17
v_lshl_add_u32 v73, v73, 1, s93
v_add_u32 v72, v90, v72
s_andn2_b64 exec, s[66:67], s[90:91]
ds_write_b16_d16_hi v73, v17 offset:64
ds_write_b16 v73, v72 offset:384
ds_write_b16 v73, v17 offset:704
s_mov_b64 exec, -1
v_add_u32 v73, v50, v66
v_and_b32 v72, 0x87e, v18
v_lshl_add_u32 v73, v73, 1, s93
v_add_u32 v72, v90, v72
s_andn2_b64 exec, s[68:69], s[90:91]
ds_write_b16_d16_hi v73, v18 offset:64
ds_write_b16 v73, v72 offset:384
ds_write_b16 v73, v18 offset:704
s_mov_b64 exec, -1
v_add_u32 v73, v51, v67
v_and_b32 v72, 0x87e, v19
v_lshl_add_u32 v73, v73, 1, s93
v_add_u32 v72, v90, v72
s_andn2_b64 exec, s[70:71], s[90:91]
ds_write_b16_d16_hi v73, v19 offset:64
ds_write_b16 v73, v72 offset:384
ds_write_b16 v73, v19 offset:704
s_mov_b64 exec, -1
v_add_u32 v73, v52, v68
v_and_b32 v72, 0x87e, v20
v_lshl_add_u32 v73, v73, 1, s93
v_add_u32 v72, v90, v72
s_andn2_b64 exec, s[72:73], s[90:91]
ds_write_b16_d16_hi v73, v20 offset:64
ds_write_b16 v73, v72 offset:384
ds_write_b16 v73, v20 offset:704
s_mov_b64 exec, -1
v_add_u32 v73, v53, v69
v_and_b32 v72, 0x87e, v21
v_lshl_add_u32 v73, v73, 1, s93
v_add_u32 v72, v90, v72
s_andn2_b64 exec, s[74:75], s[90:91]
ds_write_b16_d16_hi v73, v21 offset:64
ds_write_b16 v73, v72 offset:384
ds_write_b16 v73, v21 offset:704
s_mov_b64 exec, -1
v_add_u32 v73, v54, v70
v_and_b32 v72, 0x87e, v22
v_lshl_add_u32 v73, v73, 1, s93
v_add_u32 v72, v90, v72
s_andn2_b64 exec, s[76:77], s[90:91]
ds_write_b16_d16_hi v73, v22 offset:64
ds_write_b16 v73, v72 offset:384
ds_write_b16 v73, v22 offset:704
s_mov_b64 exec, -1
s_branch L_more2b
L_cwait:
buffer_load_dword v8, off, s[36:39], 0 sc1
s_sub_u32 s3, s3, 1
s_cbranch_scc1 L_giveup
s_waitcnt vmcnt(0)
v_readfirstlane_b32 s47, v8
s_nop 3
s_cmp_lg_u32 s47, 1
s_cbranch_scc1 L_cwait
s_branch L_poll
L_giveup:
s_waitcnt vmcnt(0)
v_mov_b32 v8, 163072
v_mov_b32 v9, 1
ds_write_b32 v8, v9
s_branch L_polled
L_loop_w:
s_bitcmp1_b32 s87, s41
s_waitcnt vmcnt(15)
s_cbranch_scc0 L_loop_wb
s_waitcnt vmcnt(10)
s_branch L_loop_wb
L_loopn_w:
s_bitcmp1_b32 s87, s41
s_waitcnt vmcnt(15)
s_cbranch_scc0 L_loopn_wb
s_waitcnt vmcnt(10)
s_branch L_loopn_wb
L_linked:
.p2align 6
L_loopk:
v_smfmac_f32_16x16x64_bf16 v[8:11], a[0:3], v[44:51], v138
ds_read_b128 v[32:35], v2 offset:1408
v_cvt_pk_bf16_f32 v106, v36, v37
v_smfmac_f32_16x16x64_bf16 v[8:11], a[36:39], v[52:59], v142
s_waitcnt lgkmcnt(9)
v_cvt_pk_bf16_f32 v107, v38, v39
v_smfmac_f32_16x16x64_bf16 v[12:15], a[4:7], v[44:51], v138 abid:1
ds_read_b128 v[36:39], v2 offset:1472
v_cvt_pk_bf16_f32 v112, v40, v41
v_smfmac_f32_16x16x64_bf16 v[12:15], a[40:43], v[52:59], v142 abid:1
s_waitcnt lgkmcnt(8)
ds_read_b128 v[60:63], v0 offset:4096
v_cvt_pk_bf16_f32 v113, v42, v43
v_smfmac_f32_16x16x64_bf16 v[16:19], a[8:11], v[44:51], v139
s_cmp_eq_u32 s4, 129920
ds_read_b128 v[40:43], v2 offset:1536
v_cndmask_b32_dpp v108, v96, v92, vcc quad_perm:[1,0,3,2] row_mask:0xf bank_mask:0xf
v_smfmac_f32_16x16x64_bf16 v[16:19], a[44:47], v[52:59], v143
s_waitcnt lgkmcnt(8)
ds_read_u16 v82, v82
v_cndmask_b32_dpp v109, v97, v93, vcc quad_perm:[1,0,3,2] row_mask:0xf bank_mask:0xf
v_smfmac_f32_16x16x64_bf16 v[20:23], a[12:15], v[44:51], v139 abid:1
s_cselect_b32 s43, -129920, s5
ds_read_u16 v84, v84
v_cndmask_b32_dpp v110, v98, v94, vcc quad_perm:[1,0,3,2] row_mask:0xf bank_mask:0xf
v_smfmac_f32_16x16x64_bf16 v[20:23], a[48:51], v[52:59], v143 abid:1
s_waitcnt lgkmcnt(8)
ds_read_b128 v[64:67], v1 offset:4096
v_cndmask_b32_dpp v111, v99, v95, vcc quad_perm:[1,0,3,2] row_mask:0xf bank_mask:0xf
v_smfmac_f32_16x16x64_bf16 v[24:27], a[16:19], v[44:51], v140
s_add_u32 s4, s4, s43
ds_read_b128 v[68:71], v0 offset:6144
v_add_u32_sdwa v87, s42, v123 dst_sel:DWORD dst_unused:UNUSED_PAD src0_sel:DWORD src1_sel:WORD_1
v_smfmac_f32_16x16x64_bf16 v[24:27], a[52:55], v[52:59], v144
buffer_store_dwordx4 v[108:111], v4, s[20:23], s46 offen offset:0 sc1
s_mov_b64 vcc, s[82:83]
s_waitcnt lgkmcnt(8)
ds_read_b128 v[72:75], v1 offset:6144
v_cndmask_b32_dpp v96, v92, v96, vcc quad_perm:[1,0,3,2] row_mask:0xf bank_mask:0xf
v_cndmask_b32_dpp v97, v93, v97, vcc quad_perm:[1,0,3,2] row_mask:0xf bank_mask:0xf
v_smfmac_f32_16x16x64_bf16 v[28:31], a[20:23], v[44:51], v140 abid:1
s_add_u32 s41, s41, 1
ds_read_u16 v83, v83
v_cndmask_b32_dpp v98, v94, v98, vcc quad_perm:[1,0,3,2] row_mask:0xf bank_mask:0xf
v_smfmac_f32_16x16x64_bf16 v[28:31], a[56:59], v[52:59], v144 abid:1
s_waitcnt lgkmcnt(9)
ds_read_b128 v[114:117], v2 offset:64
v_cndmask_b32_dpp v99, v95, v99, vcc quad_perm:[1,0,3,2] row_mask:0xf bank_mask:0xf
v_smfmac_f32_16x16x64_bf16 v[32:35], a[24:27], v[44:51], v141
ds_read_u16 v85, v85
v_add_u32_sdwa v88, s42, v124 dst_sel:DWORD dst_unused:UNUSED_PAD src0_sel:DWORD src1_sel:WORD_0
v_smfmac_f32_16x16x64_bf16 v[32:35], a[60:63], v[52:59], v145
s_waitcnt lgkmcnt(10)
ds_read_u16 v86, v86
v_add_u32_sdwa v89, s42, v124 dst_sel:DWORD dst_unused:UNUSED_PAD src0_sel:DWORD src1_sel:WORD_1
v_smfmac_f32_16x16x64_bf16 v[36:39], a[28:31], v[44:51], v141 abid:1
ds_read_u16 v87, v87
v_add_u32_sdwa v90, s42, v125 dst_sel:DWORD dst_unused:UNUSED_PAD src0_sel:DWORD src1_sel:WORD_0
v_smfmac_f32_16x16x64_bf16 v[36:39], a[64:67], v[52:59], v145 abid:1
s_waitcnt lgkmcnt(10)
ds_read_u16 v88, v88
v_add_u32_sdwa v91, s42, v125 dst_sel:DWORD dst_unused:UNUSED_PAD src0_sel:DWORD src1_sel:WORD_1
v_smfmac_f32_16x16x64_bf16 v[40:43], a[32:35], v[44:51], v174
buffer_store_dwordx4 v[96:99], v4, s[20:23], s46 offen offset:1152 sc1
s_mov_b64 vcc, s[80:81]
ds_read_u16 v89, v89
v_cndmask_b32_dpp v92, v104, v100, vcc quad_perm:[1,0,3,2] row_mask:0xf bank_mask:0xf
v_cndmask_b32_dpp v93, v105, v101, vcc quad_perm:[1,0,3,2] row_mask:0xf bank_mask:0xf
v_smfmac_f32_16x16x64_bf16 v[40:43], a[68:71], v[52:59], v174 abid:1
s_waitcnt lgkmcnt(9)
ds_read_u16 v90, v90
v_cndmask_b32_dpp v94, v106, v102, vcc quad_perm:[1,0,3,2] row_mask:0xf bank_mask:0xf
v_smfmac_f32_16x16x64_bf16 v[8:11], a[72:75], v[60:67], v146
s_waitcnt lgkmcnt(8)
ds_read_u16 v91, v91
v_cndmask_b32_dpp v95, v107, v103, vcc quad_perm:[1,0,3,2] row_mask:0xf bank_mask:0xf
v_smfmac_f32_16x16x64_bf16 v[8:11], a[108:111], v[68:75], v150
s_waitcnt lgkmcnt(7)
ds_bpermute_b32 v112, v6, v112
v_smfmac_f32_16x16x64_bf16 v[8:11], v[114:117], v[76:83], v179
ds_bpermute_b32 v113, v6, v113
v_smfmac_f32_16x16x64_bf16 v[12:15], v[114:117], v[76:83], v179 abid:1
ds_read_b128 v[114:117], v2 offset:128
v_add_u32_sdwa v76, s42, v126 dst_sel:DWORD dst_unused:UNUSED_PAD src0_sel:DWORD src1_sel:WORD_0
v_smfmac_f32_16x16x64_bf16 v[12:15], a[76:79], v[60:67], v146 abid:1
ds_read_u16 v76, v76
v_add_u32_sdwa v77, s42, v126 dst_sel:DWORD dst_unused:UNUSED_PAD src0_sel:DWORD src1_sel:WORD_1
v_smfmac_f32_16x16x64_bf16 v[12:15], a[112:115], v[68:75], v150 abid:1
buffer_store_dwordx4 v[92:95], v4, s[20:23], s46 offen offset:128 sc1
s_mov_b64 vcc, s[82:83]
ds_read_u16 v77, v77
v_cndmask_b32_dpp v104, v100, v104, vcc quad_perm:[1,0,3,2] row_mask:0xf bank_mask:0xf
v_cndmask_b32_dpp v105, v101, v105, vcc quad_perm:[1,0,3,2] row_mask:0xf bank_mask:0xf
v_smfmac_f32_16x16x64_bf16 v[24:27], a[88:91], v[60:67], v148
ds_read_b128 v[44:47], v0 offset:8192
v_add_u32_sdwa v78, s42, v127 dst_sel:DWORD dst_unused:UNUSED_PAD src0_sel:DWORD src1_sel:WORD_0
v_smfmac_f32_16x16x64_bf16 v[24:27], a[124:127], v[68:75], v152
ds_read_u16 v78, v78
v_cndmask_b32_dpp v106, v102, v106, vcc quad_perm:[1,0,3,2] row_mask:0xf bank_mask:0xf
v_smfmac_f32_16x16x64_bf16 v[28:31], a[92:95], v[60:67], v148 abid:1
ds_read_b128 v[48:51], v1 offset:8192
v_cndmask_b32_dpp v107, v103, v107, vcc quad_perm:[1,0,3,2] row_mask:0xf bank_mask:0xf
v_smfmac_f32_16x16x64_bf16 v[28:31], a[128:131], v[68:75], v152 abid:1
ds_read_b128 v[52:55], v0 offset:10240
v_add_u32_sdwa v79, s42, v127 dst_sel:DWORD dst_unused:UNUSED_PAD src0_sel:DWORD src1_sel:WORD_1
v_smfmac_f32_16x16x64_bf16 v[32:35], a[96:99], v[60:67], v149
ds_read_u16 v79, v79
v_add_u32_sdwa v80, s42, v128 dst_sel:DWORD dst_unused:UNUSED_PAD src0_sel:DWORD src1_sel:WORD_0
v_smfmac_f32_16x16x64_bf16 v[32:35], a[132:135], v[68:75], v153
ds_read_u16 v80, v80
v_add_u32_sdwa v81, s42, v128 dst_sel:DWORD dst_unused:UNUSED_PAD src0_sel:DWORD src1_sel:WORD_1
v_smfmac_f32_16x16x64_bf16 v[16:19], a[80:83], v[60:67], v147
buffer_store_dwordx4 v[104:107], v4, s[20:23], s46 offen offset:1280 sc1
s_mov_b64 vcc, s[80:81]
ds_read_b128 v[56:59], v1 offset:10240
v_add_u32_sdwa v82, s42, v129 dst_sel:DWORD dst_unused:UNUSED_PAD src0_sel:DWORD src1_sel:WORD_0
v_add_u32_sdwa v83, s42, v129 dst_sel:DWORD dst_unused:UNUSED_PAD src0_sel:DWORD src1_sel:WORD_1
v_smfmac_f32_16x16x64_bf16 v[16:19], a[116:119], v[68:75], v151
s_waitcnt lgkmcnt(9)
ds_read_b128 v[92:95], v0 offset:12288
v_add_u32_sdwa v100, s42, v130 dst_sel:DWORD dst_unused:UNUSED_PAD src0_sel:DWORD src1_sel:WORD_0
v_smfmac_f32_16x16x64_bf16 v[16:19], v[114:117], v[84:91], v180 abid:1
s_waitcnt vmcnt(4)
ds_read_u16 v81, v81
v_add_u32_sdwa v101, s42, v130 dst_sel:DWORD dst_unused:UNUSED_PAD src0_sel:DWORD src1_sel:WORD_1
v_smfmac_f32_16x16x64_bf16 v[12:15], v[114:117], v[84:91], v180
ds_read_b128 v[96:99], v1 offset:12288
v_add_u32_sdwa v102, s42, v131 dst_sel:DWORD dst_unused:UNUSED_PAD src0_sel:DWORD src1_sel:WORD_0
v_smfmac_f32_16x16x64_bf16 v[20:23], v[114:117], v[84:91], v181
ds_read_u16 v82, v82
v_add_u32_sdwa v103, s42, v131 dst_sel:DWORD dst_unused:UNUSED_PAD src0_sel:DWORD src1_sel:WORD_1
v_smfmac_f32_16x16x64_bf16 v[20:23], a[84:87], v[60:67], v147 abid:1
ds_read_u16 v100, v100
v_add_u32_sdwa v104, s42, v132 dst_sel:DWORD dst_unused:UNUSED_PAD src0_sel:DWORD src1_sel:WORD_0
v_smfmac_f32_16x16x64_bf16 v[20:23], a[120:123], v[68:75], v151 abid:1
ds_read_u16 v83, v83
v_add_u32_sdwa v105, s42, v132 dst_sel:DWORD dst_unused:UNUSED_PAD src0_sel:DWORD src1_sel:WORD_1
v_smfmac_f32_16x16x64_bf16 v[36:39], a[100:103], v[60:67], v149 abid:1
buffer_store_dwordx2 v[112:113], v5, s[20:23], s46 offen nt
ds_read_b128 v[114:117], v2 offset:192
v_add_u32_sdwa v106, s42, v133 dst_sel:DWORD dst_unused:UNUSED_PAD src0_sel:DWORD src1_sel:WORD_0
v_smfmac_f32_16x16x64_bf16 v[36:39], a[136:139], v[68:75], v153 abid:1
s_mov_b32 s22, 75497472
ds_read_u16 v101, v101
v_add_u32_sdwa v107, s42, v133 dst_sel:DWORD dst_unused:UNUSED_PAD src0_sel:DWORD src1_sel:WORD_1
v_smfmac_f32_16x16x64_bf16 v[40:43], a[104:107], v[60:67], v175
s_mov_b32 s46, s48
ds_read_u16 v102, v102
v_add_u32_sdwa v84, s42, v134 dst_sel:DWORD dst_unused:UNUSED_PAD src0_sel:DWORD src1_sel:WORD_0
v_smfmac_f32_16x16x64_bf16 v[40:43], a[140:143], v[68:75], v175 abid:1
s_waitcnt lgkmcnt(13)
ds_read_u16 v103, v103
v_add_u32_sdwa v85, s42, v134 dst_sel:DWORD dst_unused:UNUSED_PAD src0_sel:DWORD src1_sel:WORD_1
v_smfmac_f32_16x16x64_bf16 v[8:11], a[144:147], v[44:51], v154
s_waitcnt lgkmcnt(10)
ds_read_u16 v104, v104
v_add_u32_sdwa v86, s42, v135 dst_sel:DWORD dst_unused:UNUSED_PAD src0_sel:DWORD src1_sel:WORD_0
v_smfmac_f32_16x16x64_bf16 v[8:11], a[180:183], v[52:59], v158
s_waitcnt lgkmcnt(8)
ds_read_u16 v105, v105
v_add_u32_sdwa v87, s42, v135 dst_sel:DWORD dst_unused:UNUSED_PAD src0_sel:DWORD src1_sel:WORD_1
v_smfmac_f32_16x16x64_bf16 v[8:11], a[216:219], v[92:99], v162
s_add_u32 m0, s44, 0
ds_read_u16 v106, v106
v_add_u32_sdwa v88, s42, v136 dst_sel:DWORD dst_unused:UNUSED_PAD src0_sel:DWORD src1_sel:WORD_0
v_smfmac_f32_16x16x64_bf16 v[24:27], a[160:163], v[44:51], v156
buffer_load_dwordx4 v3, s[16:19], s45 offen offset:0 nt lds
v_add_u32_sdwa v89, s42, v136 dst_sel:DWORD dst_unused:UNUSED_PAD src0_sel:DWORD src1_sel:WORD_1
v_smfmac_f32_16x16x64_bf16 v[24:27], a[196:199], v[52:59], v160
s_mov_b32 s48, s49
ds_read_u16 v107, v107
v_add_u32_sdwa v90, s42, v137 dst_sel:DWORD dst_unused:UNUSED_PAD src0_sel:DWORD src1_sel:WORD_0
v_smfmac_f32_16x16x64_bf16 v[24:27], a[232:235], v[92:99], v164
s_waitcnt lgkmcnt(7)
ds_read_u16 v84, v84
v_add_u32_sdwa v91, s42, v137 dst_sel:DWORD dst_unused:UNUSED_PAD src0_sel:DWORD src1_sel:WORD_1
v_smfmac_f32_16x16x64_bf16 v[24:27], v[114:117], v[76:83], v182
s_mov_b32 s49, s50
ds_read_u16 v85, v85
v_smfmac_f32_16x16x64_bf16 v[20:23], v[114:117], v[76:83], v181 abid:1
s_add_u32 s50, s50, 4718592
ds_read_u16 v86, v86
v_smfmac_f32_16x16x64_bf16 v[28:31], v[114:117], v[76:83], v182 abid:1
ds_read_b128 v[114:117], v2 offset:256
v_add_u32_sdwa v76, s4, v118 dst_sel:DWORD dst_unused:UNUSED_PAD src0_sel:DWORD src1_sel:WORD_0
v_smfmac_f32_16x16x64_bf16 v[28:31], a[164:167], v[44:51], v156 abid:1
ds_read_u16 v87, v87
v_add_u32_sdwa v77, s4, v118 dst_sel:DWORD dst_unused:UNUSED_PAD src0_sel:DWORD src1_sel:WORD_1
v_smfmac_f32_16x16x64_bf16 v[28:31], a[200:203], v[52:59], v160 abid:1
ds_read_u16 v88, v88
v_add_u32_sdwa v78, s4, v119 dst_sel:DWORD dst_unused:UNUSED_PAD src0_sel:DWORD src1_sel:WORD_0
v_smfmac_f32_16x16x64_bf16 v[28:31], a[236:239], v[92:99], v164 abid:1
ds_read_b128 v[60:63], v0 offset:14336
v_add_u32_sdwa v79, s4, v119 dst_sel:DWORD dst_unused:UNUSED_PAD src0_sel:DWORD src1_sel:WORD_1
v_smfmac_f32_16x16x64_bf16 v[12:15], a[148:151], v[44:51], v154 abid:1
ds_read_u16 v89, v89
v_add_u32_sdwa v80, s4, v120 dst_sel:DWORD dst_unused:UNUSED_PAD src0_sel:DWORD src1_sel:WORD_0
v_smfmac_f32_16x16x64_bf16 v[12:15], a[184:187], v[52:59], v158 abid:1
s_add_u32 m0, s44, 3840
ds_read_b128 v[64:67], v1 offset:14336
v_add_u32_sdwa v81, s4, v120 dst_sel:DWORD dst_unused:UNUSED_PAD src0_sel:DWORD src1_sel:WORD_1
v_smfmac_f32_16x16x64_bf16 v[12:15], a[220:223], v[92:99], v162 abid:1
buffer_load_dwordx4 v3, s[16:19], s45 offen offset:256 nt lds
v_add_u32_sdwa v82, s4, v121 dst_sel:DWORD dst_unused:UNUSED_PAD src0_sel:DWORD src1_sel:WORD_0
v_smfmac_f32_16x16x64_bf16 v[32:35], a[168:171], v[44:51], v157
ds_read_b128 v[68:71], v0 offset:16384
v_add_u32_sdwa v83, s4, v121 dst_sel:DWORD dst_unused:UNUSED_PAD src0_sel:DWORD src1_sel:WORD_1
v_smfmac_f32_16x16x64_bf16 v[32:35], a[204:207], v[52:59], v161
ds_read_u16 v90, v90
v_smfmac_f32_16x16x64_bf16 v[32:35], a[240:243], v[92:99], v165
s_waitcnt lgkmcnt(7)
ds_read_b128 v[72:75], v1 offset:16384
v_add_u32 v0, s43, v0
v_smfmac_f32_16x16x64_bf16 v[32:35], v[114:117], v[100:107], v183 abid:1
ds_read_u16 v91, v91
v_add_u32 v1, s43, v1
v_smfmac_f32_16x16x64_bf16 v[28:31], v[114:117], v[100:107], v183
v_smfmac_f32_16x16x64_bf16 v[36:39], v[114:117], v[100:107], v184
ds_read_b128 v[114:117], v2 offset:320
v_smfmac_f32_16x16x64_bf16 v[36:39], a[172:175], v[44:51], v157 abid:1
s_add_u32 m0, s44, 7680
v_smfmac_f32_16x16x64_bf16 v[36:39], a[208:211], v[52:59], v161 abid:1
buffer_load_dwordx4 v3, s[16:19], s45 offen offset:512 nt lds
v_smfmac_f32_16x16x64_bf16 v[36:39], a[244:247], v[92:99], v165 abid:1
v_smfmac_f32_16x16x64_bf16 v[16:19], a[152:155], v[44:51], v155
s_add_u32 m0, s44, 11520
v_smfmac_f32_16x16x64_bf16 v[16:19], a[188:191], v[52:59], v159
buffer_load_dwordx4 v3, s[16:19], s45 offen offset:768 nt lds
v_smfmac_f32_16x16x64_bf16 v[16:19], a[224:227], v[92:99], v163
v_smfmac_f32_16x16x64_bf16 v[20:23], a[156:159], v[44:51], v155 abid:1
s_add_u32 m0, s44, s8
v_smfmac_f32_16x16x64_bf16 v[20:23], a[192:195], v[52:59], v159 abid:1
s_mov_b64 exec, s[10:11]
buffer_load_dwordx4 v3, s[16:19], s7 offen offset:896 nt lds
s_mov_b64 exec, -1
v_smfmac_f32_16x16x64_bf16 v[20:23], a[228:231], v[92:99], v163 abid:1
s_add_u32 s45, s45, 4718592
s_add_u32 s7, s7, 4718592
s_add_u32 s44, s44, s5
v_smfmac_f32_16x16x64_bf16 v[40:43], a[176:179], v[44:51], v176
s_cmp_ge_u32 s44, 148480
s_cselect_b32 s44, s9, s44
s_bitcmp1_b32 s92, s41
v_smfmac_f32_16x16x64_bf16 v[40:43], a[212:215], v[52:59], v176 abid:1
s_cbranch_scc1 L_loopk_w
L_loopk_wb:
v_smfmac_f32_16x16x64_bf16 v[40:43], a[248:251], v[92:99], v177
s_waitcnt lgkmcnt(0)
v_smfmac_f32_16x16x64_bf16 v[40:43], v[114:117], v[84:91], v185
v_smfmac_f32_16x16x64_bf16 v[36:39], v[114:117], v[84:91], v184 abid:1
s_waitcnt vmcnt(20)
s_barrier
v_smfmac_f32_16x16x64_bf16 v[8:11], a[252:255], v[60:67], v166
s_mov_b32 s42, s4
v_smfmac_f32_16x16x64_bf16 v[8:11], v[218:221], v[68:75], v170
ds_read_b128 v[44:47], v0 offset:0
v_add_u32_sdwa v84, s42, v122 dst_sel:DWORD dst_unused:UNUSED_PAD src0_sel:DWORD src1_sel:WORD_0
v_smfmac_f32_16x16x64_bf16 v[12:15], v[186:189], v[60:67], v166 abid:1
ds_read_b128 v[48:51], v1 offset:0
v_add_u32_sdwa v85, s42, v122 dst_sel:DWORD dst_unused:UNUSED_PAD src0_sel:DWORD src1_sel:WORD_1
v_smfmac_f32_16x16x64_bf16 v[12:15], v[222:225], v[68:75], v170 abid:1
ds_read_b128 v[52:55], v0 offset:2048
v_add_u32_sdwa v86, s42, v123 dst_sel:DWORD dst_unused:UNUSED_PAD src0_sel:DWORD src1_sel:WORD_0
v_smfmac_f32_16x16x64_bf16 v[16:19], v[190:193], v[60:67], v167
ds_read_b128 v[56:59], v1 offset:2048
v_cvt_pk_bf16_f32 v92, v8, v9
v_smfmac_f32_16x16x64_bf16 v[16:19], v[226:229], v[68:75], v171
ds_read_u16 v76, v76
v_cvt_pk_bf16_f32 v93, v10, v11
v_smfmac_f32_16x16x64_bf16 v[20:23], v[194:197], v[60:67], v167 abid:1
ds_read_b128 v[8:11], v2 offset:1024
v_cvt_pk_bf16_f32 v94, v12, v13
v_smfmac_f32_16x16x64_bf16 v[20:23], v[230:233], v[68:75], v171 abid:1
ds_read_u16 v77, v77
v_cvt_pk_bf16_f32 v95, v14, v15
v_smfmac_f32_16x16x64_bf16 v[24:27], v[198:201], v[60:67], v168
ds_read_b128 v[12:15], v2 offset:1088
v_cvt_pk_bf16_f32 v96, v16, v17
v_smfmac_f32_16x16x64_bf16 v[24:27], v[234:237], v[68:75], v172
ds_read_u16 v78, v78
v_cvt_pk_bf16_f32 v97, v18, v19
v_smfmac_f32_16x16x64_bf16 v[28:31], v[202:205], v[60:67], v168 abid:1
ds_read_b128 v[16:19], v2 offset:1152
v_cvt_pk_bf16_f32 v98, v20, v21
v_smfmac_f32_16x16x64_bf16 v[28:31], v[238:241], v[68:75], v172 abid:1
ds_read_u16 v79, v79
v_cvt_pk_bf16_f32 v99, v22, v23
v_smfmac_f32_16x16x64_bf16 v[32:35], v[206:209], v[60:67], v169
ds_read_b128 v[20:23], v2 offset:1216
v_cvt_pk_bf16_f32 v100, v24, v25
v_smfmac_f32_16x16x64_bf16 v[32:35], v[242:245], v[68:75], v173
ds_read_u16 v80, v80
v_cvt_pk_bf16_f32 v101, v26, v27
v_smfmac_f32_16x16x64_bf16 v[36:39], v[210:213], v[60:67], v169 abid:1
ds_read_b128 v[24:27], v2 offset:1280
v_cvt_pk_bf16_f32 v102, v28, v29
v_smfmac_f32_16x16x64_bf16 v[36:39], v[246:249], v[68:75], v173 abid:1
ds_read_u16 v81, v81
v_cvt_pk_bf16_f32 v103, v30, v31
v_smfmac_f32_16x16x64_bf16 v[40:43], v[214:217], v[60:67], v177 abid:1
s_bitcmp1_b32 s85, s41
ds_read_b128 v[28:31], v2 offset:1344
v_cvt_pk_bf16_f32 v104, v32, v33
v_smfmac_f32_16x16x64_bf16 v[40:43], v[250:253], v[68:75], v178
s_waitcnt lgkmcnt(10)
v_cvt_pk_bf16_f32 v105, v34, v35
s_cbranch_scc1 L_loopk
s_cmp_lg_u32 s41, 6
s_cbranch_scc1 L_loopnk
.p2align 3
L_loopck:
v_smfmac_f32_16x16x64_bf16 v[8:11], a[0:3], v[44:51], v138
s_cmp_lt_u32 s56, s65
s_cselect_b32 s34, s34, 0
s_cselect_b32 s64, s64, 0
ds_read_b128 v[32:35], v2 offset:1408
v_cvt_pk_bf16_f32 v106, v36, v37
v_mov_b32 v7, 1
v_smfmac_f32_16x16x64_bf16 v[8:11], a[36:39], v[52:59], v142
s_waitcnt lgkmcnt(9)
buffer_atomic_add v7, v6, s[32:35], 0 offen sc0 sc1
v_cvt_pk_bf16_f32 v107, v38, v39
v_smfmac_f32_16x16x64_bf16 v[12:15], a[4:7], v[44:51], v138 abid:1
ds_read_b128 v[36:39], v2 offset:1472
v_cvt_pk_bf16_f32 v112, v40, v41
v_smfmac_f32_16x16x64_bf16 v[12:15], a[40:43], v[52:59], v142 abid:1
s_waitcnt lgkmcnt(8)
ds_read_b128 v[60:63], v0 offset:4096
v_cvt_pk_bf16_f32 v113, v42, v43
v_smfmac_f32_16x16x64_bf16 v[16:19], a[8:11], v[44:51], v139
s_cmp_eq_u32 s4, 129920
ds_read_b128 v[40:43], v2 offset:1536
v_cndmask_b32_dpp v108, v96, v92, vcc quad_perm:[1,0,3,2] row_mask:0xf bank_mask:0xf
v_smfmac_f32_16x16x64_bf16 v[16:19], a[44:47], v[52:59], v143
s_waitcnt lgkmcnt(8)
ds_read_u16 v82, v82
v_cndmask_b32_dpp v109, v97, v93, vcc quad_perm:[1,0,3,2] row_mask:0xf bank_mask:0xf
v_smfmac_f32_16x16x64_bf16 v[20:23], a[12:15], v[44:51], v139 abid:1
s_cselect_b32 s43, -129920, s5
ds_read_u16 v84, v84
v_cndmask_b32_dpp v110, v98, v94, vcc quad_perm:[1,0,3,2] row_mask:0xf bank_mask:0xf
v_smfmac_f32_16x16x64_bf16 v[20:23], a[48:51], v[52:59], v143 abid:1
s_waitcnt lgkmcnt(8)
ds_read_b128 v[64:67], v1 offset:4096
v_cndmask_b32_dpp v111, v99, v95, vcc quad_perm:[1,0,3,2] row_mask:0xf bank_mask:0xf
v_smfmac_f32_16x16x64_bf16 v[24:27], a[16:19], v[44:51], v140
s_add_u32 s4, s4, s43
ds_read_b128 v[68:71], v0 offset:6144
v_add_u32_sdwa v87, s42, v123 dst_sel:DWORD dst_unused:UNUSED_PAD src0_sel:DWORD src1_sel:WORD_1
v_smfmac_f32_16x16x64_bf16 v[24:27], a[52:55], v[52:59], v144
buffer_store_dwordx4 v[108:111], v4, s[20:23], s46 offen offset:0 sc1
s_mov_b64 vcc, s[82:83]
s_waitcnt lgkmcnt(8)
ds_read_b128 v[72:75], v1 offset:6144
v_cndmask_b32_dpp v96, v92, v96, vcc quad_perm:[1,0,3,2] row_mask:0xf bank_mask:0xf
v_cndmask_b32_dpp v97, v93, v97, vcc quad_perm:[1,0,3,2] row_mask:0xf bank_mask:0xf
v_smfmac_f32_16x16x64_bf16 v[28:31], a[20:23], v[44:51], v140 abid:1
s_add_u32 s7, s45, s58
ds_read_u16 v83, v83
v_cndmask_b32_dpp v98, v94, v98, vcc quad_perm:[1,0,3,2] row_mask:0xf bank_mask:0xf
v_smfmac_f32_16x16x64_bf16 v[28:31], a[56:59], v[52:59], v144 abid:1
s_waitcnt lgkmcnt(9)
ds_read_b128 v[114:117], v2 offset:64
v_cndmask_b32_dpp v99, v95, v99, vcc quad_perm:[1,0,3,2] row_mask:0xf bank_mask:0xf
v_smfmac_f32_16x16x64_bf16 v[32:35], a[24:27], v[44:51], v141
ds_read_u16 v85, v85
v_add_u32_sdwa v88, s42, v124 dst_sel:DWORD dst_unused:UNUSED_PAD src0_sel:DWORD src1_sel:WORD_0
v_smfmac_f32_16x16x64_bf16 v[32:35], a[60:63], v[52:59], v145
s_waitcnt lgkmcnt(10)
ds_read_u16 v86, v86
v_add_u32_sdwa v89, s42, v124 dst_sel:DWORD dst_unused:UNUSED_PAD src0_sel:DWORD src1_sel:WORD_1
v_smfmac_f32_16x16x64_bf16 v[36:39], a[28:31], v[44:51], v141 abid:1
ds_read_u16 v87, v87
v_add_u32_sdwa v90, s42, v125 dst_sel:DWORD dst_unused:UNUSED_PAD src0_sel:DWORD src1_sel:WORD_0
v_smfmac_f32_16x16x64_bf16 v[36:39], a[64:67], v[52:59], v145 abid:1
s_waitcnt lgkmcnt(10)
ds_read_u16 v88, v88
v_add_u32_sdwa v91, s42, v125 dst_sel:DWORD dst_unused:UNUSED_PAD src0_sel:DWORD src1_sel:WORD_1
v_smfmac_f32_16x16x64_bf16 v[40:43], a[32:35], v[44:51], v174
buffer_store_dwordx4 v[96:99], v4, s[20:23], s46 offen offset:1152 sc1
s_mov_b64 vcc, s[80:81]
ds_read_u16 v89, v89
v_cndmask_b32_dpp v92, v104, v100, vcc quad_perm:[1,0,3,2] row_mask:0xf bank_mask:0xf
v_cndmask_b32_dpp v93, v105, v101, vcc quad_perm:[1,0,3,2] row_mask:0xf bank_mask:0xf
v_smfmac_f32_16x16x64_bf16 v[40:43], a[68:71], v[52:59], v174 abid:1
s_waitcnt lgkmcnt(9)
ds_read_u16 v90, v90
v_cndmask_b32_dpp v94, v106, v102, vcc quad_perm:[1,0,3,2] row_mask:0xf bank_mask:0xf
v_smfmac_f32_16x16x64_bf16 v[8:11], a[72:75], v[60:67], v146
s_waitcnt lgkmcnt(8)
ds_read_u16 v91, v91
v_cndmask_b32_dpp v95, v107, v103, vcc quad_perm:[1,0,3,2] row_mask:0xf bank_mask:0xf
v_smfmac_f32_16x16x64_bf16 v[8:11], a[108:111], v[68:75], v150
s_waitcnt lgkmcnt(7)
ds_bpermute_b32 v112, v6, v112
v_smfmac_f32_16x16x64_bf16 v[8:11], v[114:117], v[76:83], v179
ds_bpermute_b32 v113, v6, v113
v_smfmac_f32_16x16x64_bf16 v[12:15], v[114:117], v[76:83], v179 abid:1
ds_read_b128 v[114:117], v2 offset:128
v_add_u32_sdwa v76, s42, v126 dst_sel:DWORD dst_unused:UNUSED_PAD src0_sel:DWORD src1_sel:WORD_0
v_smfmac_f32_16x16x64_bf16 v[12:15], a[76:79], v[60:67], v146 abid:1
ds_read_u16 v76, v76
v_add_u32_sdwa v77, s42, v126 dst_sel:DWORD dst_unused:UNUSED_PAD src0_sel:DWORD src1_sel:WORD_1
v_smfmac_f32_16x16x64_bf16 v[12:15], a[112:115], v[68:75], v150 abid:1
buffer_store_dwordx4 v[92:95], v4, s[20:23], s46 offen offset:128 sc1
s_mov_b64 vcc, s[82:83]
ds_read_u16 v77, v77
v_cndmask_b32_dpp v104, v100, v104, vcc quad_perm:[1,0,3,2] row_mask:0xf bank_mask:0xf
v_cndmask_b32_dpp v105, v101, v105, vcc quad_perm:[1,0,3,2] row_mask:0xf bank_mask:0xf
v_smfmac_f32_16x16x64_bf16 v[24:27], a[88:91], v[60:67], v148
ds_read_b128 v[44:47], v0 offset:8192
v_add_u32_sdwa v78, s42, v127 dst_sel:DWORD dst_unused:UNUSED_PAD src0_sel:DWORD src1_sel:WORD_0
v_smfmac_f32_16x16x64_bf16 v[24:27], a[124:127], v[68:75], v152
ds_read_u16 v78, v78
v_cndmask_b32_dpp v106, v102, v106, vcc quad_perm:[1,0,3,2] row_mask:0xf bank_mask:0xf
v_smfmac_f32_16x16x64_bf16 v[28:31], a[92:95], v[60:67], v148 abid:1
ds_read_b128 v[48:51], v1 offset:8192
v_cndmask_b32_dpp v107, v103, v107, vcc quad_perm:[1,0,3,2] row_mask:0xf bank_mask:0xf
v_smfmac_f32_16x16x64_bf16 v[28:31], a[128:131], v[68:75], v152 abid:1
ds_read_b128 v[52:55], v0 offset:10240
v_add_u32_sdwa v79, s42, v127 dst_sel:DWORD dst_unused:UNUSED_PAD src0_sel:DWORD src1_sel:WORD_1
v_smfmac_f32_16x16x64_bf16 v[32:35], a[96:99], v[60:67], v149
ds_read_u16 v79, v79
v_add_u32_sdwa v80, s42, v128 dst_sel:DWORD dst_unused:UNUSED_PAD src0_sel:DWORD src1_sel:WORD_0
v_smfmac_f32_16x16x64_bf16 v[32:35], a[132:135], v[68:75], v153
ds_read_u16 v80, v80
v_add_u32_sdwa v81, s42, v128 dst_sel:DWORD dst_unused:UNUSED_PAD src0_sel:DWORD src1_sel:WORD_1
v_smfmac_f32_16x16x64_bf16 v[16:19], a[80:83], v[60:67], v147
buffer_store_dwordx4 v[104:107], v4, s[20:23], s46 offen offset:1280 sc1
s_mov_b64 vcc, s[80:81]
ds_read_b128 v[56:59], v1 offset:10240
v_add_u32_sdwa v82, s42, v129 dst_sel:DWORD dst_unused:UNUSED_PAD src0_sel:DWORD src1_sel:WORD_0
v_add_u32_sdwa v83, s42, v129 dst_sel:DWORD dst_unused:UNUSED_PAD src0_sel:DWORD src1_sel:WORD_1
v_smfmac_f32_16x16x64_bf16 v[16:19], a[116:119], v[68:75], v151
s_waitcnt lgkmcnt(9)
ds_read_b128 v[92:95], v0 offset:12288
v_add_u32_sdwa v100, s42, v130 dst_sel:DWORD dst_unused:UNUSED_PAD src0_sel:DWORD src1_sel:WORD_0
v_smfmac_f32_16x16x64_bf16 v[16:19], v[114:117], v[84:91], v180 abid:1
ds_read_u16 v81, v81
v_add_u32_sdwa v101, s42, v130 dst_sel:DWORD dst_unused:UNUSED_PAD src0_sel:DWORD src1_sel:WORD_1
v_smfmac_f32_16x16x64_bf16 v[12:15], v[114:117], v[84:91], v180
ds_read_b128 v[96:99], v1 offset:12288
v_add_u32_sdwa v102, s42, v131 dst_sel:DWORD dst_unused:UNUSED_PAD src0_sel:DWORD src1_sel:WORD_0
v_smfmac_f32_16x16x64_bf16 v[20:23], v[114:117], v[84:91], v181
ds_read_u16 v82, v82
v_add_u32_sdwa v103, s42, v131 dst_sel:DWORD dst_unused:UNUSED_PAD src0_sel:DWORD src1_sel:WORD_1
v_smfmac_f32_16x16x64_bf16 v[20:23], a[84:87], v[60:67], v147 abid:1
ds_read_u16 v100, v100
v_add_u32_sdwa v104, s42, v132 dst_sel:DWORD dst_unused:UNUSED_PAD src0_sel:DWORD src1_sel:WORD_0
v_smfmac_f32_16x16x64_bf16 v[20:23], a[120:123], v[68:75], v151 abid:1
ds_read_u16 v83, v83
v_add_u32_sdwa v105, s42, v132 dst_sel:DWORD dst_unused:UNUSED_PAD src0_sel:DWORD src1_sel:WORD_1
v_smfmac_f32_16x16x64_bf16 v[36:39], a[100:103], v[60:67], v149 abid:1
buffer_store_dwordx2 v[112:113], v5, s[20:23], s46 offen nt
ds_read_b128 v[114:117], v2 offset:192
v_add_u32_sdwa v106, s42, v133 dst_sel:DWORD dst_unused:UNUSED_PAD src0_sel:DWORD src1_sel:WORD_0
v_smfmac_f32_16x16x64_bf16 v[36:39], a[136:139], v[68:75], v153 abid:1
s_mov_b32 s46, s48
ds_read_u16 v101, v101
v_add_u32_sdwa v107, s42, v133 dst_sel:DWORD dst_unused:UNUSED_PAD src0_sel:DWORD src1_sel:WORD_1
v_smfmac_f32_16x16x64_bf16 v[40:43], a[104:107], v[60:67], v175
s_mov_b32 s48, s49
ds_read_u16 v102, v102
v_add_u32_sdwa v84, s42, v134 dst_sel:DWORD dst_unused:UNUSED_PAD src0_sel:DWORD src1_sel:WORD_0
v_smfmac_f32_16x16x64_bf16 v[40:43], a[140:143], v[68:75], v175 abid:1
s_waitcnt lgkmcnt(13)
ds_read_u16 v103, v103
v_add_u32_sdwa v85, s42, v134 dst_sel:DWORD dst_unused:UNUSED_PAD src0_sel:DWORD src1_sel:WORD_1
v_smfmac_f32_16x16x64_bf16 v[8:11], a[144:147], v[44:51], v154
s_waitcnt lgkmcnt(10)
ds_read_u16 v104, v104
v_add_u32_sdwa v86, s42, v135 dst_sel:DWORD dst_unused:UNUSED_PAD src0_sel:DWORD src1_sel:WORD_0
v_smfmac_f32_16x16x64_bf16 v[8:11], a[180:183], v[52:59], v158
s_waitcnt lgkmcnt(8)
ds_read_u16 v105, v105
v_add_u32_sdwa v87, s42, v135 dst_sel:DWORD dst_unused:UNUSED_PAD src0_sel:DWORD src1_sel:WORD_1
v_smfmac_f32_16x16x64_bf16 v[8:11], a[216:219], v[92:99], v162
s_add_u32 m0, s44, 0
ds_read_u16 v106, v106
v_add_u32_sdwa v88, s42, v136 dst_sel:DWORD dst_unused:UNUSED_PAD src0_sel:DWORD src1_sel:WORD_0
v_smfmac_f32_16x16x64_bf16 v[24:27], a[160:163], v[44:51], v156
buffer_load_dwordx4 v3, s[16:19], s45 offen offset:0 nt lds
v_add_u32_sdwa v89, s42, v136 dst_sel:DWORD dst_unused:UNUSED_PAD src0_sel:DWORD src1_sel:WORD_1
v_smfmac_f32_16x16x64_bf16 v[24:27], a[196:199], v[52:59], v160
s_mov_b32 s49, s50
ds_read_u16 v107, v107
v_add_u32_sdwa v90, s42, v137 dst_sel:DWORD dst_unused:UNUSED_PAD src0_sel:DWORD src1_sel:WORD_0
v_smfmac_f32_16x16x64_bf16 v[24:27], a[232:235], v[92:99], v164
s_waitcnt lgkmcnt(7)
ds_read_u16 v84, v84
v_add_u32_sdwa v91, s42, v137 dst_sel:DWORD dst_unused:UNUSED_PAD src0_sel:DWORD src1_sel:WORD_1
v_smfmac_f32_16x16x64_bf16 v[24:27], v[114:117], v[76:83], v182
s_mov_b32 s50, s45
ds_read_u16 v85, v85
v_smfmac_f32_16x16x64_bf16 v[20:23], v[114:117], v[76:83], v181 abid:1
ds_read_u16 v86, v86
v_smfmac_f32_16x16x64_bf16 v[28:31], v[114:117], v[76:83], v182 abid:1
ds_read_b128 v[114:117], v2 offset:256
v_add_u32_sdwa v76, s4, v118 dst_sel:DWORD dst_unused:UNUSED_PAD src0_sel:DWORD src1_sel:WORD_0
v_smfmac_f32_16x16x64_bf16 v[28:31], a[164:167], v[44:51], v156 abid:1
ds_read_u16 v87, v87
v_add_u32_sdwa v77, s4, v118 dst_sel:DWORD dst_unused:UNUSED_PAD src0_sel:DWORD src1_sel:WORD_1
v_smfmac_f32_16x16x64_bf16 v[28:31], a[200:203], v[52:59], v160 abid:1
ds_read_u16 v88, v88
v_add_u32_sdwa v78, s4, v119 dst_sel:DWORD dst_unused:UNUSED_PAD src0_sel:DWORD src1_sel:WORD_0
v_smfmac_f32_16x16x64_bf16 v[28:31], a[236:239], v[92:99], v164 abid:1
ds_read_b128 v[60:63], v0 offset:14336
v_add_u32_sdwa v79, s4, v119 dst_sel:DWORD dst_unused:UNUSED_PAD src0_sel:DWORD src1_sel:WORD_1
v_smfmac_f32_16x16x64_bf16 v[12:15], a[148:151], v[44:51], v154 abid:1
ds_read_u16 v89, v89
v_add_u32_sdwa v80, s4, v120 dst_sel:DWORD dst_unused:UNUSED_PAD src0_sel:DWORD src1_sel:WORD_0
v_smfmac_f32_16x16x64_bf16 v[12:15], a[184:187], v[52:59], v158 abid:1
s_add_u32 m0, s44, 3840
s_waitcnt vmcnt(6)
ds_read_b128 v[64:67], v1 offset:14336
v_add_u32_sdwa v81, s4, v120 dst_sel:DWORD dst_unused:UNUSED_PAD src0_sel:DWORD src1_sel:WORD_1
v_smfmac_f32_16x16x64_bf16 v[12:15], a[220:223], v[92:99], v162 abid:1
buffer_load_dwordx4 v3, s[16:19], s45 offen offset:256 nt lds
v_add_u32_sdwa v82, s4, v121 dst_sel:DWORD dst_unused:UNUSED_PAD src0_sel:DWORD src1_sel:WORD_0
v_smfmac_f32_16x16x64_bf16 v[32:35], a[168:171], v[44:51], v157
ds_read_b128 v[68:71], v0 offset:16384
v_add_u32_sdwa v83, s4, v121 dst_sel:DWORD dst_unused:UNUSED_PAD src0_sel:DWORD src1_sel:WORD_1
v_smfmac_f32_16x16x64_bf16 v[32:35], a[204:207], v[52:59], v161
ds_read_u16 v90, v90
v_smfmac_f32_16x16x64_bf16 v[32:35], a[240:243], v[92:99], v165
s_waitcnt lgkmcnt(7)
ds_read_b128 v[72:75], v1 offset:16384
v_add_u32 v0, s43, v0
v_smfmac_f32_16x16x64_bf16 v[32:35], v[114:117], v[100:107], v183 abid:1
ds_read_u16 v91, v91
v_add_u32 v1, s43, v1
v_smfmac_f32_16x16x64_bf16 v[28:31], v[114:117], v[100:107], v183
v_smfmac_f32_16x16x64_bf16 v[36:39], v[114:117], v[100:107], v184
ds_read_b128 v[114:117], v2 offset:320
v_smfmac_f32_16x16x64_bf16 v[36:39], a[172:175], v[44:51], v157 abid:1
s_add_u32 m0, s44, 7680
v_smfmac_f32_16x16x64_bf16 v[36:39], a[208:211], v[52:59], v161 abid:1
buffer_load_dwordx4 v3, s[16:19], s45 offen offset:512 nt lds
v_smfmac_f32_16x16x64_bf16 v[36:39], a[244:247], v[92:99], v165 abid:1
v_smfmac_f32_16x16x64_bf16 v[16:19], a[152:155], v[44:51], v155
s_add_u32 m0, s44, 11520
v_smfmac_f32_16x16x64_bf16 v[16:19], a[188:191], v[52:59], v159
buffer_load_dwordx4 v3, s[16:19], s45 offen offset:768 nt lds
v_smfmac_f32_16x16x64_bf16 v[16:19], a[224:227], v[92:99], v163
s_mov_b64 exec, s[62:63]
ds_write_b32 v0, v7 offset:18432
s_mov_b64 exec, -1
v_smfmac_f32_16x16x64_bf16 v[20:23], a[156:159], v[44:51], v155 abid:1
s_add_u32 m0, s44, s8
v_smfmac_f32_16x16x64_bf16 v[20:23], a[192:195], v[52:59], v159 abid:1
s_mov_b64 exec, s[10:11]
buffer_load_dwordx4 v3, s[16:19], s7 offen offset:896 nt lds
s_mov_b64 exec, -1
v_smfmac_f32_16x16x64_bf16 v[20:23], a[228:231], v[92:99], v163 abid:1
s_add_u32 s44, s44, s5
s_cmp_ge_u32 s44, 148480
s_cselect_b32 s44, s9, s44
v_smfmac_f32_16x16x64_bf16 v[40:43], a[176:179], v[44:51], v176
v_smfmac_f32_16x16x64_bf16 v[40:43], a[212:215], v[52:59], v176 abid:1
v_smfmac_f32_16x16x64_bf16 v[40:43], a[248:251], v[92:99], v177
s_waitcnt lgkmcnt(0)
v_smfmac_f32_16x16x64_bf16 v[40:43], v[114:117], v[84:91], v185
v_smfmac_f32_16x16x64_bf16 v[36:39], v[114:117], v[84:91], v184 abid:1
s_barrier
v_smfmac_f32_16x16x64_bf16 v[8:11], a[252:255], v[60:67], v166
s_mov_b32 s42, s4
ds_read_b32 v7, v0 offset:18432
v_smfmac_f32_16x16x64_bf16 v[8:11], v[218:221], v[68:75], v170
ds_read_b128 v[44:47], v0 offset:0
v_add_u32_sdwa v84, s42, v122 dst_sel:DWORD dst_unused:UNUSED_PAD src0_sel:DWORD src1_sel:WORD_0
v_smfmac_f32_16x16x64_bf16 v[12:15], v[186:189], v[60:67], v166 abid:1
ds_read_b128 v[48:51], v1 offset:0
v_add_u32_sdwa v85, s42, v122 dst_sel:DWORD dst_unused:UNUSED_PAD src0_sel:DWORD src1_sel:WORD_1
v_smfmac_f32_16x16x64_bf16 v[12:15], v[222:225], v[68:75], v170 abid:1
ds_read_b128 v[52:55], v0 offset:2048
v_add_u32_sdwa v86, s42, v123 dst_sel:DWORD dst_unused:UNUSED_PAD src0_sel:DWORD src1_sel:WORD_0
v_smfmac_f32_16x16x64_bf16 v[16:19], v[190:193], v[60:67], v167
ds_read_b128 v[56:59], v1 offset:2048
v_cvt_pk_bf16_f32 v92, v8, v9
v_smfmac_f32_16x16x64_bf16 v[16:19], v[226:229], v[68:75], v171
ds_read_u16 v76, v76
v_cvt_pk_bf16_f32 v93, v10, v11
v_smfmac_f32_16x16x64_bf16 v[20:23], v[194:197], v[60:67], v167 abid:1
ds_read_b128 v[8:11], v2 offset:1024
v_cvt_pk_bf16_f32 v94, v12, v13
v_smfmac_f32_16x16x64_bf16 v[20:23], v[230:233], v[68:75], v171 abid:1
ds_read_u16 v77, v77
v_cvt_pk_bf16_f32 v95, v14, v15
v_smfmac_f32_16x16x64_bf16 v[24:27], v[198:201], v[60:67], v168
ds_read_b128 v[12:15], v2 offset:1088
v_cvt_pk_bf16_f32 v96, v16, v17
v_smfmac_f32_16x16x64_bf16 v[24:27], v[234:237], v[68:75], v172
s_waitcnt lgkmcnt(8)
ds_read_u16 v78, v78
v_cvt_pk_bf16_f32 v97, v18, v19
v_readfirstlane_b32 s56, v7
v_smfmac_f32_16x16x64_bf16 v[28:31], v[202:205], v[60:67], v168 abid:1
s_lshr_b32 s60, s56, 4
ds_read_b128 v[16:19], v2 offset:1152
v_cvt_pk_bf16_f32 v98, v20, v21
v_smfmac_f32_16x16x64_bf16 v[28:31], v[238:241], v[68:75], v172 abid:1
s_mul_i32 s60, s60, 884736
ds_read_u16 v79, v79
v_cvt_pk_bf16_f32 v99, v22, v23
v_smfmac_f32_16x16x64_bf16 v[32:35], v[206:209], v[60:67], v169
s_mul_i32 s61, s56, 18432
ds_read_b128 v[20:23], v2 offset:1216
v_cvt_pk_bf16_f32 v100, v24, v25
v_smfmac_f32_16x16x64_bf16 v[32:35], v[242:245], v[68:75], v173
s_add_u32 s60, s60, s57
ds_read_u16 v80, v80
v_cvt_pk_bf16_f32 v101, v26, v27
v_smfmac_f32_16x16x64_bf16 v[36:39], v[210:213], v[60:67], v169 abid:1
s_add_u32 s45, s60, s61
ds_read_b128 v[24:27], v2 offset:1280
v_cvt_pk_bf16_f32 v102, v28, v29
v_smfmac_f32_16x16x64_bf16 v[36:39], v[246:249], v[68:75], v173 abid:1
ds_read_u16 v81, v81
v_cvt_pk_bf16_f32 v103, v30, v31
v_smfmac_f32_16x16x64_bf16 v[40:43], v[214:217], v[60:67], v177 abid:1
s_cmp_lt_u32 s56, s64
ds_read_b128 v[28:31], v2 offset:1344
v_cvt_pk_bf16_f32 v104, v32, v33
v_smfmac_f32_16x16x64_bf16 v[40:43], v[250:253], v[68:75], v178
s_waitcnt lgkmcnt(10)
v_cvt_pk_bf16_f32 v105, v34, v35
s_cbranch_scc1 L_loopck
s_mov_b32 s41, 0
s_mov_b32 s15, 3
s_mov_b32 s12, 7
s_mov_b32 s92, 4
s_mov_b32 s87, 4
s_mov_b32 s59, -1
.p2align 3
L_loopnk:
v_smfmac_f32_16x16x64_bf16 v[8:11], a[0:3], v[44:51], v138
ds_read_b128 v[32:35], v2 offset:1408
v_cvt_pk_bf16_f32 v106, v36, v37
v_smfmac_f32_16x16x64_bf16 v[8:11], a[36:39], v[52:59], v142
s_waitcnt lgkmcnt(9)
v_cvt_pk_bf16_f32 v107, v38, v39
v_smfmac_f32_16x16x64_bf16 v[12:15], a[4:7], v[44:51], v138 abid:1
ds_read_b128 v[36:39], v2 offset:1472
v_cvt_pk_bf16_f32 v112, v40, v41
v_smfmac_f32_16x16x64_bf16 v[12:15], a[40:43], v[52:59], v142 abid:1
s_waitcnt lgkmcnt(8)
ds_read_b128 v[60:63], v0 offset:4096
v_cvt_pk_bf16_f32 v113, v42, v43
v_smfmac_f32_16x16x64_bf16 v[16:19], a[8:11], v[44:51], v139
s_cmp_eq_u32 s4, 129920
ds_read_b128 v[40:43], v2 offset:1536
v_cndmask_b32_dpp v108, v96, v92, vcc quad_perm:[1,0,3,2] row_mask:0xf bank_mask:0xf
v_smfmac_f32_16x16x64_bf16 v[16:19], a[44:47], v[52:59], v143
s_waitcnt lgkmcnt(8)
ds_read_u16 v82, v82
v_cndmask_b32_dpp v109, v97, v93, vcc quad_perm:[1,0,3,2] row_mask:0xf bank_mask:0xf
v_smfmac_f32_16x16x64_bf16 v[20:23], a[12:15], v[44:51], v139 abid:1
s_cselect_b32 s43, -129920, s5
ds_read_u16 v84, v84
v_cndmask_b32_dpp v110, v98, v94, vcc quad_perm:[1,0,3,2] row_mask:0xf bank_mask:0xf
v_smfmac_f32_16x16x64_bf16 v[20:23], a[48:51], v[52:59], v143 abid:1
s_waitcnt lgkmcnt(8)
ds_read_b128 v[64:67], v1 offset:4096
v_cndmask_b32_dpp v111, v99, v95, vcc quad_perm:[1,0,3,2] row_mask:0xf bank_mask:0xf
v_smfmac_f32_16x16x64_bf16 v[24:27], a[16:19], v[44:51], v140
s_add_u32 s4, s4, s43
ds_read_b128 v[68:71], v0 offset:6144
v_add_u32_sdwa v87, s42, v123 dst_sel:DWORD dst_unused:UNUSED_PAD src0_sel:DWORD src1_sel:WORD_1
v_smfmac_f32_16x16x64_bf16 v[24:27], a[52:55], v[52:59], v144
buffer_store_dwordx4 v[108:111], v4, s[20:23], s46 offen offset:0 sc1
s_mov_b64 vcc, s[82:83]
s_waitcnt lgkmcnt(8)
ds_read_b128 v[72:75], v1 offset:6144
v_cndmask_b32_dpp v96, v92, v96, vcc quad_perm:[1,0,3,2] row_mask:0xf bank_mask:0xf
v_cndmask_b32_dpp v97, v93, v97, vcc quad_perm:[1,0,3,2] row_mask:0xf bank_mask:0xf
v_smfmac_f32_16x16x64_bf16 v[28:31], a[20:23], v[44:51], v140 abid:1
s_add_u32 s41, s41, 1
ds_read_u16 v83, v83
v_cndmask_b32_dpp v98, v94, v98, vcc quad_perm:[1,0,3,2] row_mask:0xf bank_mask:0xf
v_smfmac_f32_16x16x64_bf16 v[28:31], a[56:59], v[52:59], v144 abid:1
s_waitcnt lgkmcnt(9)
ds_read_b128 v[114:117], v2 offset:64
v_cndmask_b32_dpp v99, v95, v99, vcc quad_perm:[1,0,3,2] row_mask:0xf bank_mask:0xf
v_smfmac_f32_16x16x64_bf16 v[32:35], a[24:27], v[44:51], v141
ds_read_u16 v85, v85
v_add_u32_sdwa v88, s42, v124 dst_sel:DWORD dst_unused:UNUSED_PAD src0_sel:DWORD src1_sel:WORD_0
v_smfmac_f32_16x16x64_bf16 v[32:35], a[60:63], v[52:59], v145
s_waitcnt lgkmcnt(10)
ds_read_u16 v86, v86
v_add_u32_sdwa v89, s42, v124 dst_sel:DWORD dst_unused:UNUSED_PAD src0_sel:DWORD src1_sel:WORD_1
v_smfmac_f32_16x16x64_bf16 v[36:39], a[28:31], v[44:51], v141 abid:1
ds_read_u16 v87, v87
v_add_u32_sdwa v90, s42, v125 dst_sel:DWORD dst_unused:UNUSED_PAD src0_sel:DWORD src1_sel:WORD_0
v_smfmac_f32_16x16x64_bf16 v[36:39], a[64:67], v[52:59], v145 abid:1
s_waitcnt lgkmcnt(10)
ds_read_u16 v88, v88
v_add_u32_sdwa v91, s42, v125 dst_sel:DWORD dst_unused:UNUSED_PAD src0_sel:DWORD src1_sel:WORD_1
v_smfmac_f32_16x16x64_bf16 v[40:43], a[32:35], v[44:51], v174
buffer_store_dwordx4 v[96:99], v4, s[20:23], s46 offen offset:1152 sc1
s_mov_b64 vcc, s[80:81]
ds_read_u16 v89, v89
v_cndmask_b32_dpp v92, v104, v100, vcc quad_perm:[1,0,3,2] row_mask:0xf bank_mask:0xf
v_cndmask_b32_dpp v93, v105, v101, vcc quad_perm:[1,0,3,2] row_mask:0xf bank_mask:0xf
v_smfmac_f32_16x16x64_bf16 v[40:43], a[68:71], v[52:59], v174 abid:1
s_waitcnt lgkmcnt(9)
ds_read_u16 v90, v90
v_cndmask_b32_dpp v94, v106, v102, vcc quad_perm:[1,0,3,2] row_mask:0xf bank_mask:0xf
v_smfmac_f32_16x16x64_bf16 v[8:11], a[72:75], v[60:67], v146
s_waitcnt lgkmcnt(8)
ds_read_u16 v91, v91
v_cndmask_b32_dpp v95, v107, v103, vcc quad_perm:[1,0,3,2] row_mask:0xf bank_mask:0xf
v_smfmac_f32_16x16x64_bf16 v[8:11], a[108:111], v[68:75], v150
s_waitcnt lgkmcnt(7)
ds_bpermute_b32 v112, v6, v112
v_smfmac_f32_16x16x64_bf16 v[8:11], v[114:117], v[76:83], v179
ds_bpermute_b32 v113, v6, v113
v_smfmac_f32_16x16x64_bf16 v[12:15], v[114:117], v[76:83], v179 abid:1
ds_read_b128 v[114:117], v2 offset:128
v_add_u32_sdwa v76, s42, v126 dst_sel:DWORD dst_unused:UNUSED_PAD src0_sel:DWORD src1_sel:WORD_0
v_smfmac_f32_16x16x64_bf16 v[12:15], a[76:79], v[60:67], v146 abid:1
ds_read_u16 v76, v76
v_add_u32_sdwa v77, s42, v126 dst_sel:DWORD dst_unused:UNUSED_PAD src0_sel:DWORD src1_sel:WORD_1
v_smfmac_f32_16x16x64_bf16 v[12:15], a[112:115], v[68:75], v150 abid:1
buffer_store_dwordx4 v[92:95], v4, s[20:23], s46 offen offset:128 sc1
s_mov_b64 vcc, s[82:83]
ds_read_u16 v77, v77
v_cndmask_b32_dpp v104, v100, v104, vcc quad_perm:[1,0,3,2] row_mask:0xf bank_mask:0xf
v_cndmask_b32_dpp v105, v101, v105, vcc quad_perm:[1,0,3,2] row_mask:0xf bank_mask:0xf
v_smfmac_f32_16x16x64_bf16 v[24:27], a[88:91], v[60:67], v148
ds_read_b128 v[44:47], v0 offset:8192
v_add_u32_sdwa v78, s42, v127 dst_sel:DWORD dst_unused:UNUSED_PAD src0_sel:DWORD src1_sel:WORD_0
v_smfmac_f32_16x16x64_bf16 v[24:27], a[124:127], v[68:75], v152
ds_read_u16 v78, v78
v_cndmask_b32_dpp v106, v102, v106, vcc quad_perm:[1,0,3,2] row_mask:0xf bank_mask:0xf
v_smfmac_f32_16x16x64_bf16 v[28:31], a[92:95], v[60:67], v148 abid:1
ds_read_b128 v[48:51], v1 offset:8192
v_cndmask_b32_dpp v107, v103, v107, vcc quad_perm:[1,0,3,2] row_mask:0xf bank_mask:0xf
v_smfmac_f32_16x16x64_bf16 v[28:31], a[128:131], v[68:75], v152 abid:1
ds_read_b128 v[52:55], v0 offset:10240
v_add_u32_sdwa v79, s42, v127 dst_sel:DWORD dst_unused:UNUSED_PAD src0_sel:DWORD src1_sel:WORD_1
v_smfmac_f32_16x16x64_bf16 v[32:35], a[96:99], v[60:67], v149
ds_read_u16 v79, v79
v_add_u32_sdwa v80, s42, v128 dst_sel:DWORD dst_unused:UNUSED_PAD src0_sel:DWORD src1_sel:WORD_0
v_smfmac_f32_16x16x64_bf16 v[32:35], a[132:135], v[68:75], v153
ds_read_u16 v80, v80
v_add_u32_sdwa v81, s42, v128 dst_sel:DWORD dst_unused:UNUSED_PAD src0_sel:DWORD src1_sel:WORD_1
v_smfmac_f32_16x16x64_bf16 v[16:19], a[80:83], v[60:67], v147
buffer_store_dwordx4 v[104:107], v4, s[20:23], s46 offen offset:1280 sc1
s_mov_b64 vcc, s[80:81]
ds_read_b128 v[56:59], v1 offset:10240
v_add_u32_sdwa v82, s42, v129 dst_sel:DWORD dst_unused:UNUSED_PAD src0_sel:DWORD src1_sel:WORD_0
v_add_u32_sdwa v83, s42, v129 dst_sel:DWORD dst_unused:UNUSED_PAD src0_sel:DWORD src1_sel:WORD_1
v_smfmac_f32_16x16x64_bf16 v[16:19], a[116:119], v[68:75], v151
s_waitcnt lgkmcnt(9)
ds_read_b128 v[92:95], v0 offset:12288
v_add_u32_sdwa v100, s42, v130 dst_sel:DWORD dst_unused:UNUSED_PAD src0_sel:DWORD src1_sel:WORD_0
v_smfmac_f32_16x16x64_bf16 v[16:19], v[114:117], v[84:91], v180 abid:1
ds_read_u16 v81, v81
v_add_u32_sdwa v101, s42, v130 dst_sel:DWORD dst_unused:UNUSED_PAD src0_sel:DWORD src1_sel:WORD_1
v_smfmac_f32_16x16x64_bf16 v[12:15], v[114:117], v[84:91], v180
ds_read_b128 v[96:99], v1 offset:12288
v_add_u32_sdwa v102, s42, v131 dst_sel:DWORD dst_unused:UNUSED_PAD src0_sel:DWORD src1_sel:WORD_0
v_smfmac_f32_16x16x64_bf16 v[20:23], v[114:117], v[84:91], v181
ds_read_u16 v82, v82
v_add_u32_sdwa v103, s42, v131 dst_sel:DWORD dst_unused:UNUSED_PAD src0_sel:DWORD src1_sel:WORD_1
v_smfmac_f32_16x16x64_bf16 v[20:23], a[84:87], v[60:67], v147 abid:1
ds_read_u16 v100, v100
v_add_u32_sdwa v104, s42, v132 dst_sel:DWORD dst_unused:UNUSED_PAD src0_sel:DWORD src1_sel:WORD_0
v_smfmac_f32_16x16x64_bf16 v[20:23], a[120:123], v[68:75], v151 abid:1
ds_read_u16 v83, v83
v_add_u32_sdwa v105, s42, v132 dst_sel:DWORD dst_unused:UNUSED_PAD src0_sel:DWORD src1_sel:WORD_1
v_smfmac_f32_16x16x64_bf16 v[36:39], a[100:103], v[60:67], v149 abid:1
buffer_store_dwordx2 v[112:113], v5, s[20:23], s46 offen nt
ds_read_b128 v[114:117], v2 offset:192
v_add_u32_sdwa v106, s42, v133 dst_sel:DWORD dst_unused:UNUSED_PAD src0_sel:DWORD src1_sel:WORD_0
v_smfmac_f32_16x16x64_bf16 v[36:39], a[136:139], v[68:75], v153 abid:1
s_mov_b32 s22, 75497472
ds_read_u16 v101, v101
v_add_u32_sdwa v107, s42, v133 dst_sel:DWORD dst_unused:UNUSED_PAD src0_sel:DWORD src1_sel:WORD_1
v_smfmac_f32_16x16x64_bf16 v[40:43], a[104:107], v[60:67], v175
s_mov_b32 s46, s48
ds_read_u16 v102, v102
v_add_u32_sdwa v84, s42, v134 dst_sel:DWORD dst_unused:UNUSED_PAD src0_sel:DWORD src1_sel:WORD_0
v_smfmac_f32_16x16x64_bf16 v[40:43], a[140:143], v[68:75], v175 abid:1
s_waitcnt lgkmcnt(13)
ds_read_u16 v103, v103
v_add_u32_sdwa v85, s42, v134 dst_sel:DWORD dst_unused:UNUSED_PAD src0_sel:DWORD src1_sel:WORD_1
v_smfmac_f32_16x16x64_bf16 v[8:11], a[144:147], v[44:51], v154
s_waitcnt lgkmcnt(10)
ds_read_u16 v104, v104
v_add_u32_sdwa v86, s42, v135 dst_sel:DWORD dst_unused:UNUSED_PAD src0_sel:DWORD src1_sel:WORD_0
v_smfmac_f32_16x16x64_bf16 v[8:11], a[180:183], v[52:59], v158
s_waitcnt lgkmcnt(8)
ds_read_u16 v105, v105
v_add_u32_sdwa v87, s42, v135 dst_sel:DWORD dst_unused:UNUSED_PAD src0_sel:DWORD src1_sel:WORD_1
v_smfmac_f32_16x16x64_bf16 v[8:11], a[216:219], v[92:99], v162
s_mov_b32 s48, s49
ds_read_u16 v106, v106
v_add_u32_sdwa v88, s42, v136 dst_sel:DWORD dst_unused:UNUSED_PAD src0_sel:DWORD src1_sel:WORD_0
v_smfmac_f32_16x16x64_bf16 v[24:27], a[160:163], v[44:51], v156
s_mov_b32 s49, s50
s_add_u32 s50, s50, 4718592
v_add_u32_sdwa v89, s42, v136 dst_sel:DWORD dst_unused:UNUSED_PAD src0_sel:DWORD src1_sel:WORD_1
v_smfmac_f32_16x16x64_bf16 v[24:27], a[196:199], v[52:59], v160
ds_read_u16 v107, v107
v_add_u32_sdwa v90, s42, v137 dst_sel:DWORD dst_unused:UNUSED_PAD src0_sel:DWORD src1_sel:WORD_0
v_smfmac_f32_16x16x64_bf16 v[24:27], a[232:235], v[92:99], v164
s_waitcnt lgkmcnt(7)
ds_read_u16 v84, v84
v_add_u32_sdwa v91, s42, v137 dst_sel:DWORD dst_unused:UNUSED_PAD src0_sel:DWORD src1_sel:WORD_1
v_smfmac_f32_16x16x64_bf16 v[24:27], v[114:117], v[76:83], v182
ds_read_u16 v85, v85
v_smfmac_f32_16x16x64_bf16 v[20:23], v[114:117], v[76:83], v181 abid:1
ds_read_u16 v86, v86
v_smfmac_f32_16x16x64_bf16 v[28:31], v[114:117], v[76:83], v182 abid:1
ds_read_b128 v[114:117], v2 offset:256
v_add_u32_sdwa v76, s4, v118 dst_sel:DWORD dst_unused:UNUSED_PAD src0_sel:DWORD src1_sel:WORD_0
v_smfmac_f32_16x16x64_bf16 v[28:31], a[164:167], v[44:51], v156 abid:1
ds_read_u16 v87, v87
v_add_u32_sdwa v77, s4, v118 dst_sel:DWORD dst_unused:UNUSED_PAD src0_sel:DWORD src1_sel:WORD_1
v_smfmac_f32_16x16x64_bf16 v[28:31], a[200:203], v[52:59], v160 abid:1
ds_read_u16 v88, v88
v_add_u32_sdwa v78, s4, v119 dst_sel:DWORD dst_unused:UNUSED_PAD src0_sel:DWORD src1_sel:WORD_0
v_smfmac_f32_16x16x64_bf16 v[28:31], a[236:239], v[92:99], v164 abid:1
ds_read_b128 v[60:63], v0 offset:14336
v_add_u32_sdwa v79, s4, v119 dst_sel:DWORD dst_unused:UNUSED_PAD src0_sel:DWORD src1_sel:WORD_1
v_smfmac_f32_16x16x64_bf16 v[12:15], a[148:151], v[44:51], v154 abid:1
ds_read_u16 v89, v89
v_add_u32_sdwa v80, s4, v120 dst_sel:DWORD dst_unused:UNUSED_PAD src0_sel:DWORD src1_sel:WORD_0
v_smfmac_f32_16x16x64_bf16 v[12:15], a[184:187], v[52:59], v158 abid:1
ds_read_b128 v[64:67], v1 offset:14336
v_add_u32_sdwa v81, s4, v120 dst_sel:DWORD dst_unused:UNUSED_PAD src0_sel:DWORD src1_sel:WORD_1
v_smfmac_f32_16x16x64_bf16 v[12:15], a[220:223], v[92:99], v162 abid:1
v_add_u32_sdwa v82, s4, v121 dst_sel:DWORD dst_unused:UNUSED_PAD src0_sel:DWORD src1_sel:WORD_0
v_smfmac_f32_16x16x64_bf16 v[32:35], a[168:171], v[44:51], v157
ds_read_b128 v[68:71], v0 offset:16384
v_add_u32_sdwa v83, s4, v121 dst_sel:DWORD dst_unused:UNUSED_PAD src0_sel:DWORD src1_sel:WORD_1
v_smfmac_f32_16x16x64_bf16 v[32:35], a[204:207], v[52:59], v161
ds_read_u16 v90, v90
v_smfmac_f32_16x16x64_bf16 v[32:35], a[240:243], v[92:99], v165
s_waitcnt lgkmcnt(7)
ds_read_b128 v[72:75], v1 offset:16384
v_add_u32 v0, s43, v0
v_smfmac_f32_16x16x64_bf16 v[32:35], v[114:117], v[100:107], v183 abid:1
ds_read_u16 v91, v91
v_add_u32 v1, s43, v1
v_smfmac_f32_16x16x64_bf16 v[28:31], v[114:117], v[100:107], v183
v_smfmac_f32_16x16x64_bf16 v[36:39], v[114:117], v[100:107], v184
ds_read_b128 v[114:117], v2 offset:320
v_smfmac_f32_16x16x64_bf16 v[36:39], a[172:175], v[44:51], v157 abid:1
v_smfmac_f32_16x16x64_bf16 v[36:39], a[208:211], v[52:59], v161 abid:1
v_smfmac_f32_16x16x64_bf16 v[36:39], a[244:247], v[92:99], v165 abid:1
v_smfmac_f32_16x16x64_bf16 v[16:19], a[152:155], v[44:51], v155
v_smfmac_f32_16x16x64_bf16 v[16:19], a[188:191], v[52:59], v159
v_smfmac_f32_16x16x64_bf16 v[16:19], a[224:227], v[92:99], v163
v_smfmac_f32_16x16x64_bf16 v[20:23], a[156:159], v[44:51], v155 abid:1
v_smfmac_f32_16x16x64_bf16 v[20:23], a[192:195], v[52:59], v159 abid:1
v_smfmac_f32_16x16x64_bf16 v[20:23], a[228:231], v[92:99], v163 abid:1
v_smfmac_f32_16x16x64_bf16 v[40:43], a[176:179], v[44:51], v176
s_bitcmp1_b32 s92, s41
v_smfmac_f32_16x16x64_bf16 v[40:43], a[212:215], v[52:59], v176 abid:1
s_cbranch_scc1 L_loopnk_w
L_loopnk_wb:
v_smfmac_f32_16x16x64_bf16 v[40:43], a[248:251], v[92:99], v177
s_waitcnt lgkmcnt(0)
v_smfmac_f32_16x16x64_bf16 v[40:43], v[114:117], v[84:91], v185
v_smfmac_f32_16x16x64_bf16 v[36:39], v[114:117], v[84:91], v184 abid:1
s_waitcnt vmcnt(20)
s_barrier
L_loopnk_p3:
v_smfmac_f32_16x16x64_bf16 v[8:11], a[252:255], v[60:67], v166
s_mov_b32 s42, s4
v_smfmac_f32_16x16x64_bf16 v[8:11], v[218:221], v[68:75], v170
ds_read_b128 v[44:47], v0 offset:0
v_add_u32_sdwa v84, s42, v122 dst_sel:DWORD dst_unused:UNUSED_PAD src0_sel:DWORD src1_sel:WORD_0
v_smfmac_f32_16x16x64_bf16 v[12:15], v[186:189], v[60:67], v166 abid:1
ds_read_b128 v[48:51], v1 offset:0
v_add_u32_sdwa v85, s42, v122 dst_sel:DWORD dst_unused:UNUSED_PAD src0_sel:DWORD src1_sel:WORD_1
v_smfmac_f32_16x16x64_bf16 v[12:15], v[222:225], v[68:75], v170 abid:1
ds_read_b128 v[52:55], v0 offset:2048
v_add_u32_sdwa v86, s42, v123 dst_sel:DWORD dst_unused:UNUSED_PAD src0_sel:DWORD src1_sel:WORD_0
v_smfmac_f32_16x16x64_bf16 v[16:19], v[190:193], v[60:67], v167
ds_read_b128 v[56:59], v1 offset:2048
v_cvt_pk_bf16_f32 v92, v8, v9
v_smfmac_f32_16x16x64_bf16 v[16:19], v[226:229], v[68:75], v171
ds_read_u16 v76, v76
v_cvt_pk_bf16_f32 v93, v10, v11
v_smfmac_f32_16x16x64_bf16 v[20:23], v[194:197], v[60:67], v167 abid:1
ds_read_b128 v[8:11], v2 offset:1024
v_cvt_pk_bf16_f32 v94, v12, v13
v_smfmac_f32_16x16x64_bf16 v[20:23], v[230:233], v[68:75], v171 abid:1
ds_read_u16 v77, v77
v_cvt_pk_bf16_f32 v95, v14, v15
v_smfmac_f32_16x16x64_bf16 v[24:27], v[198:201], v[60:67], v168
ds_read_b128 v[12:15], v2 offset:1088
v_cvt_pk_bf16_f32 v96, v16, v17
v_smfmac_f32_16x16x64_bf16 v[24:27], v[234:237], v[68:75], v172
ds_read_u16 v78, v78
v_cvt_pk_bf16_f32 v97, v18, v19
v_smfmac_f32_16x16x64_bf16 v[28:31], v[202:205], v[60:67], v168 abid:1
ds_read_b128 v[16:19], v2 offset:1152
v_cvt_pk_bf16_f32 v98, v20, v21
v_smfmac_f32_16x16x64_bf16 v[28:31], v[238:241], v[68:75], v172 abid:1
ds_read_u16 v79, v79
v_cvt_pk_bf16_f32 v99, v22, v23
v_smfmac_f32_16x16x64_bf16 v[32:35], v[206:209], v[60:67], v169
ds_read_b128 v[20:23], v2 offset:1216
v_cvt_pk_bf16_f32 v100, v24, v25
v_smfmac_f32_16x16x64_bf16 v[32:35], v[242:245], v[68:75], v173
ds_read_u16 v80, v80
v_cvt_pk_bf16_f32 v101, v26, v27
v_smfmac_f32_16x16x64_bf16 v[36:39], v[210:213], v[60:67], v169 abid:1
ds_read_b128 v[24:27], v2 offset:1280
v_cvt_pk_bf16_f32 v102, v28, v29
v_smfmac_f32_16x16x64_bf16 v[36:39], v[246:249], v[68:75], v173 abid:1
ds_read_u16 v81, v81
v_cvt_pk_bf16_f32 v103, v30, v31
v_smfmac_f32_16x16x64_bf16 v[40:43], v[214:217], v[60:67], v177 abid:1
s_bitcmp1_b32 s12, s41
ds_read_b128 v[28:31], v2 offset:1344
v_cvt_pk_bf16_f32 v104, v32, v33
v_smfmac_f32_16x16x64_bf16 v[40:43], v[250:253], v[68:75], v178
s_waitcnt lgkmcnt(10)
v_cvt_pk_bf16_f32 v105, v34, v35
s_cbranch_scc1 L_loopnk
s_cmp_eq_u32 s41, s59
s_cbranch_scc1 L_loopck
s_cmp_lt_u32 s41, s15
s_cbranch_scc1 L_loopk
s_nop 0
v_cndmask_b32_dpp v108, v96, v92, vcc quad_perm:[1,0,3,2] row_mask:0xf bank_mask:0xf
v_cndmask_b32_dpp v109, v97, v93, vcc quad_perm:[1,0,3,2] row_mask:0xf bank_mask:0xf
v_cndmask_b32_dpp v110, v98, v94, vcc quad_perm:[1,0,3,2] row_mask:0xf bank_mask:0xf
v_cndmask_b32_dpp v111, v99, v95, vcc quad_perm:[1,0,3,2] row_mask:0xf bank_mask:0xf
buffer_store_dwordx4 v[108:111], v4, s[20:23], s46 offen offset:0 sc1
s_mov_b64 vcc, s[82:83]
v_cvt_pk_bf16_f32 v112, v40, v41
v_cvt_pk_bf16_f32 v113, v42, v43
ds_bpermute_b32 v112, v6, v112
ds_bpermute_b32 v113, v6, v113
v_cndmask_b32_dpp v96, v92, v96, vcc quad_perm:[1,0,3,2] row_mask:0xf bank_mask:0xf
v_cndmask_b32_dpp v97, v93, v97, vcc quad_perm:[1,0,3,2] row_mask:0xf bank_mask:0xf
v_cndmask_b32_dpp v98, v94, v98, vcc quad_perm:[1,0,3,2] row_mask:0xf bank_mask:0xf
v_cndmask_b32_dpp v99, v95, v99, vcc quad_perm:[1,0,3,2] row_mask:0xf bank_mask:0xf
buffer_store_dwordx4 v[96:99], v4, s[20:23], s46 offen offset:1152 sc1
s_mov_b64 vcc, s[80:81]
v_cvt_pk_bf16_f32 v106, v36, v37
v_cvt_pk_bf16_f32 v107, v38, v39
v_cndmask_b32_dpp v92, v104, v100, vcc quad_perm:[1,0,3,2] row_mask:0xf bank_mask:0xf
v_cndmask_b32_dpp v93, v105, v101, vcc quad_perm:[1,0,3,2] row_mask:0xf bank_mask:0xf
v_cndmask_b32_dpp v94, v106, v102, vcc quad_perm:[1,0,3,2] row_mask:0xf bank_mask:0xf
v_cndmask_b32_dpp v95, v107, v103, vcc quad_perm:[1,0,3,2] row_mask:0xf bank_mask:0xf
buffer_store_dwordx4 v[92:95], v4, s[20:23], s46 offen offset:128 sc1
s_mov_b64 vcc, s[82:83]
v_cndmask_b32_dpp v104, v100, v104, vcc quad_perm:[1,0,3,2] row_mask:0xf bank_mask:0xf
v_cndmask_b32_dpp v105, v101, v105, vcc quad_perm:[1,0,3,2] row_mask:0xf bank_mask:0xf
v_cndmask_b32_dpp v106, v102, v106, vcc quad_perm:[1,0,3,2] row_mask:0xf bank_mask:0xf
v_cndmask_b32_dpp v107, v103, v107, vcc quad_perm:[1,0,3,2] row_mask:0xf bank_mask:0xf
buffer_store_dwordx4 v[104:107], v4, s[20:23], s46 offen offset:1280 sc1
s_mov_b64 vcc, s[80:81]
s_waitcnt lgkmcnt(0)
buffer_store_dwordx2 v[112:113], v5, s[20:23], s46 offen nt
s_branch L_fin
L_loopk_w:
s_bitcmp1_b32 s87, s41
s_waitcnt vmcnt(15)
s_cbranch_scc0 L_loopk_wb
s_waitcnt vmcnt(10)
s_branch L_loopk_wb
L_loopnk_w:
s_bitcmp1_b32 s87, s41
s_waitcnt vmcnt(15)
s_cbranch_scc0 L_loopnk_wb
s_waitcnt vmcnt(10)
s_branch L_loopnk_wb
L_slow:
s_waitcnt vmcnt(0) lgkmcnt(0)
s_mov_b32 s87, 0
L_sm:
s_lshl_b32 s86, s2, 1
s_add_u32 s86, s86, s87
s_add_u32 s86, s86, 2
s_mul_i32 s86, s86, 393216
s_mov_b32 s84, 0
L_st:
s_and_b32 s48, s84, 3
s_lshr_b32 s49, s84, 2
s_sub_u32 s50, s84, 36
s_lshl_b32 s51, s40, 4
s_lshl_b32 s52, s50, 1
s_lshl_b32 s53, s48, 8
s_cmp_lt_u32 s84, 36
s_cselect_b32 s52, s49, s52
s_cselect_b32 s53, s53, 1024
s_cselect_b32 s54, 8, 73728
s_cselect_b32 s55, 32, 8
s_cselect_b32 s56, 16, 32
s_cselect_b32 s57, 128, 64
s_mul_i32 s52, s52, 73728
s_mul_i32 s58, s40, 18432
v_and_b32 v58, 1, v7
v_bfe_u32 v59, v7, 1, 1
v_bfe_u32 v60, v7, 2, 2
v_bfe_u32 v62, v7, 4, 1
v_lshrrev_b32 v63, 5, v7
v_lshl_add_u32 v50, v58, 2, s52
v_mad_u32_u24 v50, v59, s54, v50
v_mad_u32_u24 v50, v60, s55, v50
v_mad_u32_u24 v50, v62, s56, v50
v_mad_u32_u24 v50, v63, s57, v50
v_add_u32 v50, s53, v50
v_add_u32 v50, s58, v50
v_add_u32 v62, 4608, v50
v_add_u32 v63, 9216, v50
v_add_u32 v64, 13824, v50
buffer_load_dword v8, v50, s[28:31], 0 offen offset:0
buffer_load_dword v9, v50, s[28:31], 0 offen offset:1152
buffer_load_dword v10, v50, s[28:31], 0 offen offset:2304
buffer_load_dword v11, v50, s[28:31], 0 offen offset:3456
buffer_load_dword v12, v62, s[28:31], 0 offen offset:0
buffer_load_dword v13, v62, s[28:31], 0 offen offset:1152
buffer_load_dword v14, v62, s[28:31], 0 offen offset:2304
buffer_load_dword v15, v62, s[28:31], 0 offen offset:3456
buffer_load_dword v16, v63, s[28:31], 0 offen offset:0
buffer_load_dword v17, v63, s[28:31], 0 offen offset:1152
buffer_load_dword v18, v63, s[28:31], 0 offen offset:2304
buffer_load_dword v19, v63, s[28:31], 0 offen offset:3456
buffer_load_dword v20, v64, s[28:31], 0 offen offset:0
buffer_load_dword v21, v64, s[28:31], 0 offen offset:1152
buffer_load_dword v22, v64, s[28:31], 0 offen offset:2304
buffer_load_dword v23, v64, s[28:31], 0 offen offset:3456
s_mul_i32 s52, s48, 9
s_add_u32 s52, s52, s49
s_mul_i32 s53, s52, 9
s_mul_i32 s54, s50, 18
s_add_u32 s54, s54, 8
s_lshl_b32 s55, s52, 2
s_add_u32 s55, s55, s40
s_lshl_b32 s56, s50, 2
s_add_u32 s56, s56, s40
s_cmp_eq_u32 s84, 40
s_cselect_b32 s57, 0x100000, 9
s_cmp_lt_u32 s84, 36
s_cselect_b32 s53, s53, s54
s_cselect_b32 s54, 2, 81
s_cselect_b32 s57, 1, s57
s_cselect_b32 s55, s55, s56
s_mov_b32 s56, 331776
s_cselect_b32 s56, s56, 368640
s_mov_b32 s58, 373760
s_cselect_b32 s58, s58, 382976
s_cselect_b32 s59, 16, 4
s_cselect_b32 s60, 4, 64
s_cselect_b32 s61, 12, 11
s_cselect_b32 s62, 1, 0x8001
v_lshrrev_b32 v61, 4, v7
v_lshlrev_b32 v62, 1, v58
v_lshl_add_u32 v60, v60, 2, v62
v_add_u32 v62, v60, v59
v_mul_u32_u24 v51, s54, v61
v_add_lshl_u32 v51, v51, s53, 6
v_add3_u32 v51, v51, v62, s51
v_lshl_add_u32 v51, v51, 4, s86
s_lshl_b32 s57, s57, 10
v_add_u32 v66, s57, v51
s_lshl_b32 s52, s55, 8
s_add_u32 s52, s52, s56
s_add_u32 s52, s52, s86
v_mul_u32_u24 v52, s59, v62
v_mad_u32_u24 v52, v61, s60, v52
v_lshl_add_u32 v54, v7, 2, s52
v_mov_b32 v55, 0x05040100
v_mov_b32 v62, 0x03020706
v_cmp_eq_u32 vcc, 1, v59
v_mov_b32 v68, 0xf0a0500
v_mov_b32 v69, 0x8f8a8580
v_mov_b32 v70, 0x1f1a1510
v_mov_b32 v71, 0x9f9a9590
v_mov_b32 v72, 0x2f2a2520
v_mov_b32 v73, 0xafaaa5a0
v_mov_b32 v74, 0x3f3a3530
v_mov_b32 v75, 0xbfbab5b0
v_cndmask_b32 v55, v55, v62, vcc
s_mov_b32 s64, 0x5040500
s_mov_b32 s65, 0x5040501
s_mov_b32 s66, 0x5040502
s_mov_b32 s67, 0x5040503
s_mov_b32 s68, 0x7060700
s_mov_b32 s69, 0x7060701
s_mov_b32 s70, 0x7060702
s_mov_b32 s71, 0x7060703
s_mov_b32 s72, 0x05060102
s_cmp_lg_u32 s87, 0
s_waitcnt vmcnt(12)
v_perm_b32 v24, v8, v68, s64
v_perm_b32 v25, v9, v68, s65
v_perm_b32 v26, v10, v68, s66
v_perm_b32 v27, v11, v68, s67
v_max3_f32 v28, |v24|, |v25|, |v26|
v_med3_f32 v29, |v24|, |v25|, |v26|
v_min3_f32 v30, |v24|, |v25|, |v26|
v_med3_f32 v32, v28, v29, |v27|
v_med3_f32 v33, v29, v30, |v27|
v_max_f32 v31, v28, |v27|
v_cmp_eq_u32_sdwa vcc, v33, v32 src0_sel:WORD_1 src1_sel:WORD_1
s_cbranch_scc0 L_rb0g
v_min_f32 v30, v30, |v27|
v_cndmask_b32 v31, 0, v33, vcc
v_cmp_eq_u32_sdwa vcc, v30, v32 src0_sel:WORD_1 src1_sel:WORD_1
s_nop 1
v_cndmask_b32 v32, 0, v30, vcc
L_rb0g:
v_perm_b32 v36, v31, v32, s72
v_bfi_b32 v44, 3, v32, v31
v_perm_b32 v24, v8, v69, s68
v_perm_b32 v25, v9, v69, s69
v_perm_b32 v26, v10, v69, s70
v_perm_b32 v27, v11, v69, s71
v_max3_f32 v28, |v24|, |v25|, |v26|
v_med3_f32 v29, |v24|, |v25|, |v26|
v_min3_f32 v30, |v24|, |v25|, |v26|
v_med3_f32 v32, v28, v29, |v27|
v_med3_f32 v33, v29, v30, |v27|
v_max_f32 v31, v28, |v27|
v_cmp_eq_u32_sdwa vcc, v33, v32 src0_sel:WORD_1 src1_sel:WORD_1
s_cbranch_scc0 L_rb1g
v_min_f32 v30, v30, |v27|
v_cndmask_b32 v31, 0, v33, vcc
v_cmp_eq_u32_sdwa vcc, v30, v32 src0_sel:WORD_1 src1_sel:WORD_1
s_nop 1
v_cndmask_b32 v32, 0, v30, vcc
L_rb1g:
v_perm_b32 v40, v31, v32, s72
v_bfi_b32 v46, 3, v32, v31
s_waitcnt vmcnt(8)
v_perm_b32 v24, v12, v70, s64
v_perm_b32 v25, v13, v70, s65
v_perm_b32 v26, v14, v70, s66
v_perm_b32 v27, v15, v70, s67
v_max3_f32 v28, |v24|, |v25|, |v26|
v_med3_f32 v29, |v24|, |v25|, |v26|
v_min3_f32 v30, |v24|, |v25|, |v26|
v_med3_f32 v32, v28, v29, |v27|
v_med3_f32 v33, v29, v30, |v27|
v_max_f32 v31, v28, |v27|
v_cmp_eq_u32_sdwa vcc, v33, v32 src0_sel:WORD_1 src1_sel:WORD_1
s_cbranch_scc0 L_rb2g
v_min_f32 v30, v30, |v27|
v_cndmask_b32 v31, 0, v33, vcc
v_cmp_eq_u32_sdwa vcc, v30, v32 src0_sel:WORD_1 src1_sel:WORD_1
s_nop 1
v_cndmask_b32 v32, 0, v30, vcc
L_rb2g:
v_perm_b32 v37, v31, v32, s72
v_bfi_b32 v31, 3, v32, v31
v_lshlrev_b32 v31, 4, v31
v_bfi_b32 v44, 15, v44, v31
v_perm_b32 v24, v12, v71, s68
v_perm_b32 v25, v13, v71, s69
v_perm_b32 v26, v14, v71, s70
v_perm_b32 v27, v15, v71, s71
v_max3_f32 v28, |v24|, |v25|, |v26|
v_med3_f32 v29, |v24|, |v25|, |v26|
v_min3_f32 v30, |v24|, |v25|, |v26|
v_med3_f32 v32, v28, v29, |v27|
v_med3_f32 v33, v29, v30, |v27|
v_max_f32 v31, v28, |v27|
v_cmp_eq_u32_sdwa vcc, v33, v32 src0_sel:WORD_1 src1_sel:WORD_1
s_cbranch_scc0 L_rb3g
v_min_f32 v30, v30, |v27|
v_cndmask_b32 v31, 0, v33, vcc
v_cmp_eq_u32_sdwa vcc, v30, v32 src0_sel:WORD_1 src1_sel:WORD_1
s_nop 1
v_cndmask_b32 v32, 0, v30, vcc
L_rb3g:
v_perm_b32 v41, v31, v32, s72
v_bfi_b32 v31, 3, v32, v31
v_lshlrev_b32 v31, 4, v31
v_bfi_b32 v46, 15, v46, v31
s_waitcnt vmcnt(4)
v_perm_b32 v24, v16, v72, s64
v_perm_b32 v25, v17, v72, s65
v_perm_b32 v26, v18, v72, s66
v_perm_b32 v27, v19, v72, s67
v_max3_f32 v28, |v24|, |v25|, |v26|
v_med3_f32 v29, |v24|, |v25|, |v26|
v_min3_f32 v30, |v24|, |v25|, |v26|
v_med3_f32 v32, v28, v29, |v27|
v_med3_f32 v33, v29, v30, |v27|
v_max_f32 v31, v28, |v27|
v_cmp_eq_u32_sdwa vcc, v33, v32 src0_sel:WORD_1 src1_sel:WORD_1
s_cbranch_scc0 L_rb4g
v_min_f32 v30, v30, |v27|
v_cndmask_b32 v31, 0, v33, vcc
v_cmp_eq_u32_sdwa vcc, v30, v32 src0_sel:WORD_1 src1_sel:WORD_1
s_nop 1
v_cndmask_b32 v32, 0, v30, vcc
L_rb4g:
v_perm_b32 v38, v31, v32, s72
v_bfi_b32 v45, 3, v32, v31
v_perm_b32 v24, v16, v73, s68
v_perm_b32 v25, v17, v73, s69
v_perm_b32 v26, v18, v73, s70
v_perm_b32 v27, v19, v73, s71
v_max3_f32 v28, |v24|, |v25|, |v26|
v_med3_f32 v29, |v24|, |v25|, |v26|
v_min3_f32 v30, |v24|, |v25|, |v26|
v_med3_f32 v32, v28, v29, |v27|
v_med3_f32 v33, v29, v30, |v27|
v_max_f32 v31, v28, |v27|
v_cmp_eq_u32_sdwa vcc, v33, v32 src0_sel:WORD_1 src1_sel:WORD_1
s_cbranch_scc0 L_rb5g
v_min_f32 v30, v30, |v27|
v_cndmask_b32 v31, 0, v33, vcc
v_cmp_eq_u32_sdwa vcc, v30, v32 src0_sel:WORD_1 src1_sel:WORD_1
s_nop 1
v_cndmask_b32 v32, 0, v30, vcc
L_rb5g:
v_perm_b32 v42, v31, v32, s72
v_bfi_b32 v47, 3, v32, v31
s_waitcnt vmcnt(0)
v_perm_b32 v24, v20, v74, s64
v_perm_b32 v25, v21, v74, s65
v_perm_b32 v26, v22, v74, s66
v_perm_b32 v27, v23, v74, s67
v_max3_f32 v28, |v24|, |v25|, |v26|
v_med3_f32 v29, |v24|, |v25|, |v26|
v_min3_f32 v30, |v24|, |v25|, |v26|
v_med3_f32 v32, v28, v29, |v27|
v_med3_f32 v33, v29, v30, |v27|
v_max_f32 v31, v28, |v27|
v_cmp_eq_u32_sdwa vcc, v33, v32 src0_sel:WORD_1 src1_sel:WORD_1
s_cbranch_scc0 L_rb6g
v_min_f32 v30, v30, |v27|
v_cndmask_b32 v31, 0, v33, vcc
v_cmp_eq_u32_sdwa vcc, v30, v32 src0_sel:WORD_1 src1_sel:WORD_1
s_nop 1
v_cndmask_b32 v32, 0, v30, vcc
L_rb6g:
v_perm_b32 v39, v31, v32, s72
v_bfi_b32 v31, 3, v32, v31
v_lshlrev_b32 v31, 4, v31
v_bfi_b32 v45, 15, v45, v31
v_perm_b32 v24, v20, v75, s68
v_perm_b32 v25, v21, v75, s69
v_perm_b32 v26, v22, v75, s70
v_perm_b32 v27, v23, v75, s71
v_max3_f32 v28, |v24|, |v25|, |v26|
v_med3_f32 v29, |v24|, |v25|, |v26|
v_min3_f32 v30, |v24|, |v25|, |v26|
v_med3_f32 v32, v28, v29, |v27|
v_med3_f32 v33, v29, v30, |v27|
v_max_f32 v31, v28, |v27|
v_cmp_eq_u32_sdwa vcc, v33, v32 src0_sel:WORD_1 src1_sel:WORD_1
s_cbranch_scc0 L_rb7g
v_min_f32 v30, v30, |v27|
v_cndmask_b32 v31, 0, v33, vcc
v_cmp_eq_u32_sdwa vcc, v30, v32 src0_sel:WORD_1 src1_sel:WORD_1
s_nop 1
v_cndmask_b32 v32, 0, v30, vcc
L_rb7g:
v_perm_b32 v43, v31, v32, s72
v_bfi_b32 v31, 3, v32, v31
v_lshlrev_b32 v31, 4, v31
v_bfi_b32 v47, 15, v47, v31
s_mov_b32 vcc_lo, 0x33333333
s_mov_b32 vcc_hi, 0x33333333
v_cndmask_b32_dpp v24, v40, v36, vcc quad_perm:[2,3,0,1] row_mask:0xf bank_mask:0xf
v_cndmask_b32_dpp v25, v41, v37, vcc quad_perm:[2,3,0,1] row_mask:0xf bank_mask:0xf
v_cndmask_b32_dpp v26, v42, v38, vcc quad_perm:[2,3,0,1] row_mask:0xf bank_mask:0xf
v_cndmask_b32_dpp v27, v43, v39, vcc quad_perm:[2,3,0,1] row_mask:0xf bank_mask:0xf
s_not_b64 vcc, vcc
buffer_store_dwordx4 v[24:27], v51, s[24:27], 0 offen sc1
v_cndmask_b32_dpp v40, v36, v40, vcc quad_perm:[2,3,0,1] row_mask:0xf bank_mask:0xf
v_cndmask_b32_dpp v41, v37, v41, vcc quad_perm:[2,3,0,1] row_mask:0xf bank_mask:0xf
v_cndmask_b32_dpp v42, v38, v42, vcc quad_perm:[2,3,0,1] row_mask:0xf bank_mask:0xf
v_cndmask_b32_dpp v43, v39, v43, vcc quad_perm:[2,3,0,1] row_mask:0xf bank_mask:0xf
s_mov_b32 s52, 0x0c0c0400
s_mov_b32 s53, 0x04000c0c
buffer_store_dwordx4 v[40:43], v66, s[24:27], 0 offen sc1
v_perm_b32 v48, v45, v44, s52
v_perm_b32 v49, v47, v46, s53
v_or_b32 v48, v48, v49
s_nop 1
v_mov_b32_dpp v49, v48 quad_perm:[2,3,0,1] row_mask:0xf bank_mask:0xf
v_perm_b32 v48, v49, v48, v55
ds_permute_b32 v48, v52, v48
s_waitcnt lgkmcnt(0)
buffer_store_dword v48, v54, s[24:27], 0 offen sc1
s_waitcnt vmcnt(0)
s_add_u32 s84, s84, 1
s_cmp_lt_u32 s84, 41
s_cbranch_scc1 L_st
s_add_u32 s87, s87, 1
s_cmp_lt_u32 s87, 2
s_cbranch_scc1 L_sm
v_lshrrev_b32 v72, 3, v7
v_and_b32 v73, 7, v7
v_xor_b32 v73, v73, v72
v_mul_u32_u24 v72, 1152, v72
s_and_b32 s47, s40, 1
s_mul_i32 s47, s47, 9216
s_lshr_b32 s3, s40, 1
s_lshl_b32 s3, s3, 7
s_add_u32 s47, s47, s3
v_lshl_add_u32 v72, v73, 4, v72
v_add_u32 v3, s47, v72
s_lshl_b32 s44, s40, 10
s_mul_i32 s45, s2, 18432
s_mov_b32 s46, s45
s_lshr_b32 s47, s40, 1
s_lshl_b32 s3, s47, 11
s_sub_u32 s8, 15488, s3
s_lshl_b32 s3, s47, 7
s_add_u32 s7, s45, 128
s_sub_u32 s7, s7, s3
s_sub_u32 s10, s47, 1
s_sub_u32 s11, 0, s47
s_mov_b32 s9, s44
s_mov_b32 s13, 4718592
s_mov_b32 s15, 16
s_mov_b32 s14, s13
s_mov_b32 s22, 75497472
s_mov_b32 s18, 75497472
s_mov_b32 s41, 0
s_bitcmp1_b32 s2, 0
s_cselect_b32 s15, 16, 22
L_stile:
s_barrier
s_add_u32 m0, s44, 0
s_nop 0
buffer_load_dwordx4 v3, s[16:19], s45 offen offset:0 nt lds
s_add_u32 m0, s44, 3840
s_nop 0
buffer_load_dwordx4 v3, s[16:19], s45 offen offset:256 nt lds
s_add_u32 m0, s44, 7680
s_nop 0
buffer_load_dwordx4 v3, s[16:19], s45 offen offset:512 nt lds
s_add_u32 m0, s44, 11520
s_nop 0
buffer_load_dwordx4 v3, s[16:19], s45 offen offset:768 nt lds
s_add_u32 m0, s44, s8
s_mov_b64 exec, s[10:11]
buffer_load_dwordx4 v3, s[16:19], s7 offen offset:896 nt lds
s_mov_b64 exec, -1
ds_read_b128 v[8:11], v2 offset:1024
ds_read_b128 v[12:15], v2 offset:1088
ds_read_b128 v[16:19], v2 offset:1152
ds_read_b128 v[20:23], v2 offset:1216
ds_read_b128 v[24:27], v2 offset:1280
ds_read_b128 v[28:31], v2 offset:1344
ds_read_b128 v[32:35], v2 offset:1408
ds_read_b128 v[36:39], v2 offset:1472
ds_read_b128 v[40:43], v2 offset:1536
s_mov_b32 s87, 0
L_spass:
s_lshl_b32 s86, s2, 1
s_add_u32 s86, s86, s87
s_add_u32 s86, s86, 2
s_mul_i32 s86, s86, 393216
s_mul_i32 s47, s40, 82944
s_add_u32 s47, s47, s86
v_lshl_add_u32 v104, v7, 4, s47
s_mul_i32 s47, s40, 9216
s_add_u32 s47, s47, s86
s_add_u32 s47, s47, 331776
v_lshl_add_u32 v105, v7, 4, s47
s_lshl_b32 s47, s40, 6
s_add_u32 s47, s47, s86
s_add_u32 s47, s47, 368640
v_and_b32 v106, 15, v7
v_lshl_add_u32 v106, v106, 2, s47
v_lshrrev_b32 v107, 4, v7
v_lshl_add_u32 v106, v107, 8, v106
buffer_load_dword v174, v106, s[24:27], 0 offen offset:0 sc1
buffer_load_dword v175, v106, s[24:27], 0 offen offset:1024 sc1
buffer_load_dword v176, v106, s[24:27], 0 offen offset:2048 sc1
buffer_load_dword v177, v106, s[24:27], 0 offen offset:3072 sc1
s_mov_b32 s99, 4096
buffer_load_dword v178, v106, s[24:27], s99 offen offset:0 sc1
s_mov_b32 s98, 0
buffer_load_dwordx4 v[138:141], v105, s[24:27], s98 offen sc1
s_mov_b32 s99, 0
buffer_load_dwordx4 a[0:3], v104, s[24:27], s99 offen offset:0 sc1
buffer_load_dwordx4 a[4:7], v104, s[24:27], s99 offen offset:1024 sc1
buffer_load_dwordx4 a[8:11], v104, s[24:27], s99 offen offset:2048 sc1
buffer_load_dwordx4 a[12:15], v104, s[24:27], s99 offen offset:3072 sc1
s_mov_b32 s99, 4096
buffer_load_dwordx4 a[16:19], v104, s[24:27], s99 offen offset:0 sc1
buffer_load_dwordx4 a[20:23], v104, s[24:27], s99 offen offset:1024 sc1
buffer_load_dwordx4 a[24:27], v104, s[24:27], s99 offen offset:2048 sc1
buffer_load_dwordx4 a[28:31], v104, s[24:27], s99 offen offset:3072 sc1
s_mov_b32 s99, 8192
buffer_load_dwordx4 a[32:35], v104, s[24:27], s99 offen offset:0 sc1
s_mov_b32 s98, 1024
buffer_load_dwordx4 v[142:145], v105, s[24:27], s98 offen sc1
buffer_load_dwordx4 a[36:39], v104, s[24:27], s99 offen offset:1024 sc1
buffer_load_dwordx4 a[40:43], v104, s[24:27], s99 offen offset:2048 sc1
buffer_load_dwordx4 a[44:47], v104, s[24:27], s99 offen offset:3072 sc1
s_mov_b32 s99, 12288
buffer_load_dwordx4 a[48:51], v104, s[24:27], s99 offen offset:0 sc1
buffer_load_dwordx4 a[52:55], v104, s[24:27], s99 offen offset:1024 sc1
buffer_load_dwordx4 a[56:59], v104, s[24:27], s99 offen offset:2048 sc1
buffer_load_dwordx4 a[60:63], v104, s[24:27], s99 offen offset:3072 sc1
s_mov_b32 s99, 16384
buffer_load_dwordx4 a[64:67], v104, s[24:27], s99 offen offset:0 sc1
buffer_load_dwordx4 a[68:71], v104, s[24:27], s99 offen offset:1024 sc1
s_mov_b32 s98, 2048
buffer_load_dwordx4 v[146:149], v105, s[24:27], s98 offen sc1
buffer_load_dwordx4 a[72:75], v104, s[24:27], s99 offen offset:2048 sc1
buffer_load_dwordx4 a[76:79], v104, s[24:27], s99 offen offset:3072 sc1
s_mov_b32 s99, 20480
buffer_load_dwordx4 a[80:83], v104, s[24:27], s99 offen offset:0 sc1
buffer_load_dwordx4 a[84:87], v104, s[24:27], s99 offen offset:1024 sc1
buffer_load_dwordx4 a[88:91], v104, s[24:27], s99 offen offset:2048 sc1
buffer_load_dwordx4 a[92:95], v104, s[24:27], s99 offen offset:3072 sc1
s_mov_b32 s99, 24576
buffer_load_dwordx4 a[96:99], v104, s[24:27], s99 offen offset:0 sc1
buffer_load_dwordx4 a[100:103], v104, s[24:27], s99 offen offset:1024 sc1
buffer_load_dwordx4 a[104:107], v104, s[24:27], s99 offen offset:2048 sc1
s_mov_b32 s98, 3072
buffer_load_dwordx4 v[150:153], v105, s[24:27], s98 offen sc1
buffer_load_dwordx4 a[108:111], v104, s[24:27], s99 offen offset:3072 sc1
s_mov_b32 s99, 28672
buffer_load_dwordx4 a[112:115], v104, s[24:27], s99 offen offset:0 sc1
buffer_load_dwordx4 a[116:119], v104, s[24:27], s99 offen offset:1024 sc1
buffer_load_dwordx4 a[120:123], v104, s[24:27], s99 offen offset:2048 sc1
buffer_load_dwordx4 a[124:127], v104, s[24:27], s99 offen offset:3072 sc1
s_mov_b32 s99, 32768
buffer_load_dwordx4 a[128:131], v104, s[24:27], s99 offen offset:0 sc1
buffer_load_dwordx4 a[132:135], v104, s[24:27], s99 offen offset:1024 sc1
buffer_load_dwordx4 a[136:139], v104, s[24:27], s99 offen offset:2048 sc1
buffer_load_dwordx4 a[140:143], v104, s[24:27], s99 offen offset:3072 sc1
s_mov_b32 s98, 4096
buffer_load_dwordx4 v[154:157], v105, s[24:27], s98 offen sc1
s_mov_b32 s99, 36864
buffer_load_dwordx4 a[144:147], v104, s[24:27], s99 offen offset:0 sc1
buffer_load_dwordx4 a[148:151], v104, s[24:27], s99 offen offset:1024 sc1
buffer_load_dwordx4 a[152:155], v104, s[24:27], s99 offen offset:2048 sc1
buffer_load_dwordx4 a[156:159], v104, s[24:27], s99 offen offset:3072 sc1
s_mov_b32 s99, 40960
buffer_load_dwordx4 a[160:163], v104, s[24:27], s99 offen offset:0 sc1
buffer_load_dwordx4 a[164:167], v104, s[24:27], s99 offen offset:1024 sc1
buffer_load_dwordx4 a[168:171], v104, s[24:27], s99 offen offset:2048 sc1
buffer_load_dwordx4 a[172:175], v104, s[24:27], s99 offen offset:3072 sc1
s_mov_b32 s99, 45056
buffer_load_dwordx4 a[176:179], v104, s[24:27], s99 offen offset:0 sc1
s_mov_b32 s98, 5120
buffer_load_dwordx4 v[158:161], v105, s[24:27], s98 offen sc1
buffer_load_dwordx4 a[180:183], v104, s[24:27], s99 offen offset:1024 sc1
buffer_load_dwordx4 a[184:187], v104, s[24:27], s99 offen offset:2048 sc1
buffer_load_dwordx4 a[188:191], v104, s[24:27], s99 offen offset:3072 sc1
s_mov_b32 s99, 49152
buffer_load_dwordx4 a[192:195], v104, s[24:27], s99 offen offset:0 sc1
buffer_load_dwordx4 a[196:199], v104, s[24:27], s99 offen offset:1024 sc1
buffer_load_dwordx4 a[200:203], v104, s[24:27], s99 offen offset:2048 sc1
buffer_load_dwordx4 a[204:207], v104, s[24:27], s99 offen offset:3072 sc1
s_mov_b32 s99, 53248
buffer_load_dwordx4 a[208:211], v104, s[24:27], s99 offen offset:0 sc1
buffer_load_dwordx4 a[212:215], v104, s[24:27], s99 offen offset:1024 sc1
s_mov_b32 s98, 6144
buffer_load_dwordx4 v[162:165], v105, s[24:27], s98 offen sc1
buffer_load_dwordx4 a[216:219], v104, s[24:27], s99 offen offset:2048 sc1
buffer_load_dwordx4 a[220:223], v104, s[24:27], s99 offen offset:3072 sc1
s_mov_b32 s99, 57344
buffer_load_dwordx4 a[224:227], v104, s[24:27], s99 offen offset:0 sc1
buffer_load_dwordx4 a[228:231], v104, s[24:27], s99 offen offset:1024 sc1
buffer_load_dwordx4 a[232:235], v104, s[24:27], s99 offen offset:2048 sc1
buffer_load_dwordx4 a[236:239], v104, s[24:27], s99 offen offset:3072 sc1
s_mov_b32 s99, 61440
buffer_load_dwordx4 a[240:243], v104, s[24:27], s99 offen offset:0 sc1
buffer_load_dwordx4 a[244:247], v104, s[24:27], s99 offen offset:1024 sc1
buffer_load_dwordx4 a[248:251], v104, s[24:27], s99 offen offset:2048 sc1
s_mov_b32 s98, 7168
buffer_load_dwordx4 v[166:169], v105, s[24:27], s98 offen sc1
buffer_load_dwordx4 a[252:255], v104, s[24:27], s99 offen offset:3072 sc1
s_mov_b32 s99, 65536
buffer_load_dwordx4 v[186:189], v104, s[24:27], s99 offen offset:0 sc1
buffer_load_dwordx4 v[190:193], v104, s[24:27], s99 offen offset:1024 sc1
buffer_load_dwordx4 v[194:197], v104, s[24:27], s99 offen offset:2048 sc1
buffer_load_dwordx4 v[198:201], v104, s[24:27], s99 offen offset:3072 sc1
s_mov_b32 s99, 69632
buffer_load_dwordx4 v[202:205], v104, s[24:27], s99 offen offset:0 sc1
buffer_load_dwordx4 v[206:209], v104, s[24:27], s99 offen offset:1024 sc1
buffer_load_dwordx4 v[210:213], v104, s[24:27], s99 offen offset:2048 sc1
buffer_load_dwordx4 v[214:217], v104, s[24:27], s99 offen offset:3072 sc1
s_mov_b32 s98, 8192
buffer_load_dwordx4 v[170:173], v105, s[24:27], s98 offen sc1
s_mov_b32 s99, 73728
buffer_load_dwordx4 v[218:221], v104, s[24:27], s99 offen offset:0 sc1
buffer_load_dwordx4 v[222:225], v104, s[24:27], s99 offen offset:1024 sc1
buffer_load_dwordx4 v[226:229], v104, s[24:27], s99 offen offset:2048 sc1
buffer_load_dwordx4 v[230:233], v104, s[24:27], s99 offen offset:3072 sc1
s_mov_b32 s99, 77824
buffer_load_dwordx4 v[234:237], v104, s[24:27], s99 offen offset:0 sc1
buffer_load_dwordx4 v[238:241], v104, s[24:27], s99 offen offset:1024 sc1
buffer_load_dwordx4 v[242:245], v104, s[24:27], s99 offen offset:2048 sc1
buffer_load_dwordx4 v[246:249], v104, s[24:27], s99 offen offset:3072 sc1
s_mov_b32 s99, 81920
buffer_load_dwordx4 v[250:253], v104, s[24:27], s99 offen offset:0 sc1
s_waitcnt vmcnt(0)
s_barrier
ds_read_b128 v[44:47], v0 offset:0
ds_read_b128 v[48:51], v1 offset:0
s_waitcnt lgkmcnt(0)
v_smfmac_f32_16x16x64_bf16 v[8:11], a[0:3], v[44:51], v138
v_smfmac_f32_16x16x64_bf16 v[12:15], a[4:7], v[44:51], v138 abid:1
v_smfmac_f32_16x16x64_bf16 v[16:19], a[8:11], v[44:51], v139
v_smfmac_f32_16x16x64_bf16 v[20:23], a[12:15], v[44:51], v139 abid:1
v_smfmac_f32_16x16x64_bf16 v[24:27], a[16:19], v[44:51], v140
v_smfmac_f32_16x16x64_bf16 v[28:31], a[20:23], v[44:51], v140 abid:1
v_smfmac_f32_16x16x64_bf16 v[32:35], a[24:27], v[44:51], v141
v_smfmac_f32_16x16x64_bf16 v[36:39], a[28:31], v[44:51], v141 abid:1
v_smfmac_f32_16x16x64_bf16 v[40:43], a[32:35], v[44:51], v174
s_nop 7
ds_read_b128 v[44:47], v0 offset:2048
ds_read_b128 v[48:51], v1 offset:2048
s_waitcnt lgkmcnt(0)
v_smfmac_f32_16x16x64_bf16 v[8:11], a[36:39], v[44:51], v142
v_smfmac_f32_16x16x64_bf16 v[12:15], a[40:43], v[44:51], v142 abid:1
v_smfmac_f32_16x16x64_bf16 v[16:19], a[44:47], v[44:51], v143
v_smfmac_f32_16x16x64_bf16 v[20:23], a[48:51], v[44:51], v143 abid:1
v_smfmac_f32_16x16x64_bf16 v[24:27], a[52:55], v[44:51], v144
v_smfmac_f32_16x16x64_bf16 v[28:31], a[56:59], v[44:51], v144 abid:1
v_smfmac_f32_16x16x64_bf16 v[32:35], a[60:63], v[44:51], v145
v_smfmac_f32_16x16x64_bf16 v[36:39], a[64:67], v[44:51], v145 abid:1
v_smfmac_f32_16x16x64_bf16 v[40:43], a[68:71], v[44:51], v174 abid:1
s_nop 7
ds_read_b128 v[44:47], v0 offset:4096
ds_read_b128 v[48:51], v1 offset:4096
s_waitcnt lgkmcnt(0)
v_smfmac_f32_16x16x64_bf16 v[8:11], a[72:75], v[44:51], v146
v_smfmac_f32_16x16x64_bf16 v[12:15], a[76:79], v[44:51], v146 abid:1
v_smfmac_f32_16x16x64_bf16 v[16:19], a[80:83], v[44:51], v147
v_smfmac_f32_16x16x64_bf16 v[20:23], a[84:87], v[44:51], v147 abid:1
v_smfmac_f32_16x16x64_bf16 v[24:27], a[88:91], v[44:51], v148
v_smfmac_f32_16x16x64_bf16 v[28:31], a[92:95], v[44:51], v148 abid:1
v_smfmac_f32_16x16x64_bf16 v[32:35], a[96:99], v[44:51], v149
v_smfmac_f32_16x16x64_bf16 v[36:39], a[100:103], v[44:51], v149 abid:1
v_smfmac_f32_16x16x64_bf16 v[40:43], a[104:107], v[44:51], v175
s_nop 7
ds_read_b128 v[44:47], v0 offset:6144
ds_read_b128 v[48:51], v1 offset:6144
s_waitcnt lgkmcnt(0)
v_smfmac_f32_16x16x64_bf16 v[8:11], a[108:111], v[44:51], v150
v_smfmac_f32_16x16x64_bf16 v[12:15], a[112:115], v[44:51], v150 abid:1
v_smfmac_f32_16x16x64_bf16 v[16:19], a[116:119], v[44:51], v151
v_smfmac_f32_16x16x64_bf16 v[20:23], a[120:123], v[44:51], v151 abid:1
v_smfmac_f32_16x16x64_bf16 v[24:27], a[124:127], v[44:51], v152
v_smfmac_f32_16x16x64_bf16 v[28:31], a[128:131], v[44:51], v152 abid:1
v_smfmac_f32_16x16x64_bf16 v[32:35], a[132:135], v[44:51], v153
v_smfmac_f32_16x16x64_bf16 v[36:39], a[136:139], v[44:51], v153 abid:1
v_smfmac_f32_16x16x64_bf16 v[40:43], a[140:143], v[44:51], v175 abid:1
s_nop 7
ds_read_b128 v[44:47], v0 offset:8192
ds_read_b128 v[48:51], v1 offset:8192
s_waitcnt lgkmcnt(0)
v_smfmac_f32_16x16x64_bf16 v[8:11], a[144:147], v[44:51], v154
v_smfmac_f32_16x16x64_bf16 v[12:15], a[148:151], v[44:51], v154 abid:1
v_smfmac_f32_16x16x64_bf16 v[16:19], a[152:155], v[44:51], v155
v_smfmac_f32_16x16x64_bf16 v[20:23], a[156:159], v[44:51], v155 abid:1
v_smfmac_f32_16x16x64_bf16 v[24:27], a[160:163], v[44:51], v156
v_smfmac_f32_16x16x64_bf16 v[28:31], a[164:167], v[44:51], v156 abid:1
v_smfmac_f32_16x16x64_bf16 v[32:35], a[168:171], v[44:51], v157
v_smfmac_f32_16x16x64_bf16 v[36:39], a[172:175], v[44:51], v157 abid:1
v_smfmac_f32_16x16x64_bf16 v[40:43], a[176:179], v[44:51], v176
s_nop 7
ds_read_b128 v[44:47], v0 offset:10240
ds_read_b128 v[48:51], v1 offset:10240
s_waitcnt lgkmcnt(0)
v_smfmac_f32_16x16x64_bf16 v[8:11], a[180:183], v[44:51], v158
v_smfmac_f32_16x16x64_bf16 v[12:15], a[184:187], v[44:51], v158 abid:1
v_smfmac_f32_16x16x64_bf16 v[16:19], a[188:191], v[44:51], v159
v_smfmac_f32_16x16x64_bf16 v[20:23], a[192:195], v[44:51], v159 abid:1
v_smfmac_f32_16x16x64_bf16 v[24:27], a[196:199], v[44:51], v160
v_smfmac_f32_16x16x64_bf16 v[28:31], a[200:203], v[44:51], v160 abid:1
v_smfmac_f32_16x16x64_bf16 v[32:35], a[204:207], v[44:51], v161
v_smfmac_f32_16x16x64_bf16 v[36:39], a[208:211], v[44:51], v161 abid:1
v_smfmac_f32_16x16x64_bf16 v[40:43], a[212:215], v[44:51], v176 abid:1
s_nop 7
ds_read_b128 v[44:47], v0 offset:12288
ds_read_b128 v[48:51], v1 offset:12288
s_waitcnt lgkmcnt(0)
v_smfmac_f32_16x16x64_bf16 v[8:11], a[216:219], v[44:51], v162
v_smfmac_f32_16x16x64_bf16 v[12:15], a[220:223], v[44:51], v162 abid:1
v_smfmac_f32_16x16x64_bf16 v[16:19], a[224:227], v[44:51], v163
v_smfmac_f32_16x16x64_bf16 v[20:23], a[228:231], v[44:51], v163 abid:1
v_smfmac_f32_16x16x64_bf16 v[24:27], a[232:235], v[44:51], v164
v_smfmac_f32_16x16x64_bf16 v[28:31], a[236:239], v[44:51], v164 abid:1
v_smfmac_f32_16x16x64_bf16 v[32:35], a[240:243], v[44:51], v165
v_smfmac_f32_16x16x64_bf16 v[36:39], a[244:247], v[44:51], v165 abid:1
v_smfmac_f32_16x16x64_bf16 v[40:43], a[248:251], v[44:51], v177
s_nop 7
ds_read_b128 v[44:47], v0 offset:14336
ds_read_b128 v[48:51], v1 offset:14336
s_waitcnt lgkmcnt(0)
v_smfmac_f32_16x16x64_bf16 v[8:11], a[252:255], v[44:51], v166
v_smfmac_f32_16x16x64_bf16 v[12:15], v[186:189], v[44:51], v166 abid:1
v_smfmac_f32_16x16x64_bf16 v[16:19], v[190:193], v[44:51], v167
v_smfmac_f32_16x16x64_bf16 v[20:23], v[194:197], v[44:51], v167 abid:1
v_smfmac_f32_16x16x64_bf16 v[24:27], v[198:201], v[44:51], v168
v_smfmac_f32_16x16x64_bf16 v[28:31], v[202:205], v[44:51], v168 abid:1
v_smfmac_f32_16x16x64_bf16 v[32:35], v[206:209], v[44:51], v169
v_smfmac_f32_16x16x64_bf16 v[36:39], v[210:213], v[44:51], v169 abid:1
v_smfmac_f32_16x16x64_bf16 v[40:43], v[214:217], v[44:51], v177 abid:1
s_nop 7
ds_read_b128 v[44:47], v0 offset:16384
ds_read_b128 v[48:51], v1 offset:16384
s_waitcnt lgkmcnt(0)
v_smfmac_f32_16x16x64_bf16 v[8:11], v[218:221], v[44:51], v170
v_smfmac_f32_16x16x64_bf16 v[12:15], v[222:225], v[44:51], v170 abid:1
v_smfmac_f32_16x16x64_bf16 v[16:19], v[226:229], v[44:51], v171
v_smfmac_f32_16x16x64_bf16 v[20:23], v[230:233], v[44:51], v171 abid:1
v_smfmac_f32_16x16x64_bf16 v[24:27], v[234:237], v[44:51], v172
v_smfmac_f32_16x16x64_bf16 v[28:31], v[238:241], v[44:51], v172 abid:1
v_smfmac_f32_16x16x64_bf16 v[32:35], v[242:245], v[44:51], v173
v_smfmac_f32_16x16x64_bf16 v[36:39], v[246:249], v[44:51], v173 abid:1
v_smfmac_f32_16x16x64_bf16 v[40:43], v[250:253], v[44:51], v178
s_nop 7
s_add_u32 s87, s87, 1
s_cmp_lt_u32 s87, 2
s_cbranch_scc1 L_spass
v_cvt_pk_bf16_f32 v92, v8, v9
v_cvt_pk_bf16_f32 v93, v10, v11
v_cvt_pk_bf16_f32 v94, v12, v13
v_cvt_pk_bf16_f32 v95, v14, v15
v_cvt_pk_bf16_f32 v96, v16, v17
v_cvt_pk_bf16_f32 v97, v18, v19
v_cvt_pk_bf16_f32 v98, v20, v21
v_cvt_pk_bf16_f32 v99, v22, v23
v_cvt_pk_bf16_f32 v100, v24, v25
v_cvt_pk_bf16_f32 v101, v26, v27
v_cvt_pk_bf16_f32 v102, v28, v29
v_cvt_pk_bf16_f32 v103, v30, v31
v_cvt_pk_bf16_f32 v104, v32, v33
v_cvt_pk_bf16_f32 v105, v34, v35
s_mov_b64 vcc, s[80:81]
s_nop 0
v_cndmask_b32_dpp v108, v96, v92, vcc quad_perm:[1,0,3,2] row_mask:0xf bank_mask:0xf
v_cndmask_b32_dpp v109, v97, v93, vcc quad_perm:[1,0,3,2] row_mask:0xf bank_mask:0xf
v_cndmask_b32_dpp v110, v98, v94, vcc quad_perm:[1,0,3,2] row_mask:0xf bank_mask:0xf
v_cndmask_b32_dpp v111, v99, v95, vcc quad_perm:[1,0,3,2] row_mask:0xf bank_mask:0xf
buffer_store_dwordx4 v[108:111], v4, s[20:23], s46 offen offset:0 sc1
s_mov_b64 vcc, s[82:83]
v_cvt_pk_bf16_f32 v112, v40, v41
v_cvt_pk_bf16_f32 v113, v42, v43
ds_bpermute_b32 v112, v6, v112
ds_bpermute_b32 v113, v6, v113
v_cndmask_b32_dpp v96, v92, v96, vcc quad_perm:[1,0,3,2] row_mask:0xf bank_mask:0xf
v_cndmask_b32_dpp v97, v93, v97, vcc quad_perm:[1,0,3,2] row_mask:0xf bank_mask:0xf
v_cndmask_b32_dpp v98, v94, v98, vcc quad_perm:[1,0,3,2] row_mask:0xf bank_mask:0xf
v_cndmask_b32_dpp v99, v95, v99, vcc quad_perm:[1,0,3,2] row_mask:0xf bank_mask:0xf
buffer_store_dwordx4 v[96:99], v4, s[20:23], s46 offen offset:1152 sc1
s_mov_b64 vcc, s[80:81]
v_cvt_pk_bf16_f32 v106, v36, v37
v_cvt_pk_bf16_f32 v107, v38, v39
v_cndmask_b32_dpp v92, v104, v100, vcc quad_perm:[1,0,3,2] row_mask:0xf bank_mask:0xf
v_cndmask_b32_dpp v93, v105, v101, vcc quad_perm:[1,0,3,2] row_mask:0xf bank_mask:0xf
v_cndmask_b32_dpp v94, v106, v102, vcc quad_perm:[1,0,3,2] row_mask:0xf bank_mask:0xf
v_cndmask_b32_dpp v95, v107, v103, vcc quad_perm:[1,0,3,2] row_mask:0xf bank_mask:0xf
buffer_store_dwordx4 v[92:95], v4, s[20:23], s46 offen offset:128 sc1
s_mov_b64 vcc, s[82:83]
v_cndmask_b32_dpp v104, v100, v104, vcc quad_perm:[1,0,3,2] row_mask:0xf bank_mask:0xf
v_cndmask_b32_dpp v105, v101, v105, vcc quad_perm:[1,0,3,2] row_mask:0xf bank_mask:0xf
v_cndmask_b32_dpp v106, v102, v106, vcc quad_perm:[1,0,3,2] row_mask:0xf bank_mask:0xf
v_cndmask_b32_dpp v107, v103, v107, vcc quad_perm:[1,0,3,2] row_mask:0xf bank_mask:0xf
buffer_store_dwordx4 v[104:107], v4, s[20:23], s46 offen offset:1280 sc1
s_mov_b64 vcc, s[80:81]
s_waitcnt lgkmcnt(0)
buffer_store_dwordx2 v[112:113], v5, s[20:23], s46 offen nt
s_cmp_eq_u32 s41, 15
s_cselect_b32 s13, -23574528, s13
s_add_u32 s45, s45, s13
s_add_u32 s7, s7, s13
s_add_u32 s46, s46, s13
s_mov_b32 s13, 4718592
s_add_u32 s41, s41, 1
s_cmp_lt_u32 s41, s15
s_cbranch_scc1 L_stile
s_branch L_fin
.section .rodata,"a"
.p2align 6
.amdhsa_kernel standalone__structured_sparse_n_m__ragged_kernel
  .amdhsa_next_free_vgpr 512
  .amdhsa_next_free_sgpr 102
  .amdhsa_accum_offset 256
  .amdhsa_group_segment_fixed_size 0
  .amdhsa_float_denorm_mode_32 3
  .amdhsa_kernarg_size 48
  .amdhsa_user_sgpr_count 2
  .amdhsa_user_sgpr_kernarg_segment_ptr 1
  .amdhsa_system_sgpr_workgroup_id_x 1
.end_amdhsa_kernel
```

```asm
; @launch grid=(256,1,1) block=(256,1,1) lds=163840
.amdgcn_target "amdgcn-amd-amdhsa--gfx950"
.text
.globl standalone__structured_sparse_n_m__ragged_kernel
.p2align 8
.type standalone__structured_sparse_n_m__ragged_kernel,@function
standalone__structured_sparse_n_m__ragged_kernel:
s_load_dwordx8 s[4:11], s[0:1], 0
s_load_dwordx4 s[12:15], s[0:1], 32
s_cmp_ge_u32 s2, 256
s_cbranch_scc1 L_end_standalone__structured_sparse_n_m__ragged_kernel
v_lshrrev_b32 v1, 6, v0
v_and_b32 v7, 63, v0
s_lshr_b32 s49, s2, 6
s_and_b32 s47, s2, 9
s_lshl1_add_u32 s49, s49, s47
s_bfe_u32 s48, s2, 0x20004
s_lshl2_add_u32 s84, s49, s48
s_and_b32 s47, s2, 6
s_cselect_b32 s84, 63, s84
s_cmp_lt_u32 s84, 41
s_cbranch_scc0 L_cw
s_cmp_ge_u32 s84, 36
s_cbranch_scc1 L_pb
s_mul_i32 s52, s49, 288
s_add_u32 s52, s52, s48
s_lshl_b32 s52, s52, 8
v_lshl_add_u32 v50, v7, 2, s52
L_pbb:
v_mul_u32_u24 v62, 18432, v1
v_add_u32 v50, v62, v50
s_mov_b32 s30, 663552
s_mov_b32 s31, 0x20000
s_waitcnt lgkmcnt(0)
s_mov_b32 s28, s6
s_and_b32 s29, s7, 0xffff
buffer_load_dword v8, v50, s[28:31], 0 offen offset:0 nt
buffer_load_dword v9, v50, s[28:31], 0 offen offset:1152 nt
buffer_load_dword v10, v50, s[28:31], 0 offen offset:2304 nt
buffer_load_dword v11, v50, s[28:31], 0 offen offset:3456 nt
v_add_u32 v50, 4608, v50
buffer_load_dword v12, v50, s[28:31], 0 offen offset:0 nt
buffer_load_dword v13, v50, s[28:31], 0 offen offset:1152 nt
buffer_load_dword v14, v50, s[28:31], 0 offen offset:2304 nt
buffer_load_dword v15, v50, s[28:31], 0 offen offset:3456 nt
v_add_u32 v50, 4608, v50
buffer_load_dword v16, v50, s[28:31], 0 offen offset:0 nt
buffer_load_dword v17, v50, s[28:31], 0 offen offset:1152 nt
buffer_load_dword v18, v50, s[28:31], 0 offen offset:2304 nt
buffer_load_dword v19, v50, s[28:31], 0 offen offset:3456 nt
v_add_u32 v50, 4608, v50
buffer_load_dword v20, v50, s[28:31], 0 offen offset:0 nt
buffer_load_dword v21, v50, s[28:31], 0 offen offset:1152 nt
buffer_load_dword v22, v50, s[28:31], 0 offen offset:2304 nt
buffer_load_dword v23, v50, s[28:31], 0 offen offset:3456 nt
s_branch L_pc
L_pb:
s_mul_i32 s52, s84, 147456
s_sub_u32 s52, s52, 5307392
v_and_b32 v62, 2, v7
v_mul_u32_u24 v50, 36864, v62
v_and_b32 v62, 1, v7
v_lshl_add_u32 v50, v62, 2, v50
v_and_b32 v62, 4, v7
v_lshl_add_u32 v50, v62, 3, v50
v_and_b32 v62, 32, v7
v_lshl_add_u32 v50, v62, 1, v50
v_and_b32 v62, 24, v7
v_add3_u32 v50, v50, v62, s52
s_branch L_pbb
L_cw:
v_lshlrev_b32 v3, 7, v0
s_getpc_b64 s[96:97]
v_min_u32 v2, L_slow-standalone__structured_sparse_n_m__ragged_kernel, v3
global_load_dword v120, v2, s[96:97]
s_branch L_cons
L_pc:
v_readfirstlane_b32 s40, v1
s_mov_b32 s86, 0
s_mov_b32 s18, 75497472
s_mov_b32 s19, 0x20000
s_mov_b32 s16, s4
s_and_b32 s17, s5, 0xffff
s_mov_b32 s26, 301989888
s_mov_b32 s27, 0x20000
s_mov_b32 s24, s14
s_and_b32 s25, s15, 0xffff
s_mov_b32 s34, 1152
s_mov_b32 s35, 0x20000
s_mov_b32 s32, s8
s_and_b32 s33, s9, 0xffff
s_mov_b32 s22, 0
s_mov_b32 s23, 0x20000
s_mov_b32 s20, s10
s_and_b32 s21, s11, 0xffff
s_mov_b32 s38, 256
s_mov_b32 s39, 0x20000
s_mov_b32 s36, s12
s_and_b32 s37, s13, 0xffff
s_sub_u32 s50, s84, 36
s_lshl_b32 s51, s40, 4
v_and_b32 v58, 1, v7
v_bfe_u32 v59, v7, 1, 1
v_bfe_u32 v60, v7, 3, 2
s_mul_i32 s52, s48, 9
s_add_u32 s52, s52, s49
s_mul_i32 s53, s52, 9
s_mul_i32 s54, s50, 18
s_add_u32 s54, s54, 8
s_lshl_b32 s55, s52, 2
s_add_u32 s55, s55, s40
s_lshl_b32 s56, s50, 2
s_add_u32 s56, s56, s40
s_cmp_eq_u32 s84, 40
s_cselect_b32 s57, 0x100000, 9
s_cmp_lt_u32 s84, 36
s_cselect_b32 s53, s53, s54
s_cselect_b32 s54, 2, 81
s_cselect_b32 s57, 1, s57
s_cselect_b32 s55, s55, s56
s_mov_b32 s56, 331776
s_cselect_b32 s56, s56, 368640
s_mov_b32 s58, 373760
s_cselect_b32 s58, s58, 382976
s_cselect_b32 s59, 16, 4
s_cselect_b32 s60, 4, 64
s_cselect_b32 s61, 12, 11
s_cselect_b32 s62, 1, 0x8001
v_bfe_u32 v61, v7, 2, 1
v_lshrrev_b32 v62, 5, v7
v_lshl_add_u32 v61, v62, 1, v61
v_lshlrev_b32 v62, 1, v58
v_lshl_add_u32 v60, v60, 2, v62
v_add_u32 v62, v60, v59
v_mul_u32_u24 v51, s54, v61
v_add_lshl_u32 v51, v51, s53, 6
v_add3_u32 v51, v51, v62, s51
v_lshl_add_u32 v51, v51, 4, s86
s_lshl_b32 s57, s57, 10
v_add_u32 v66, s57, v51
s_lshl_b32 s52, s55, 8
s_add_u32 s52, s52, s56
s_add_u32 s52, s52, s86
v_mul_u32_u24 v52, s59, v62
v_mad_u32_u24 v52, v61, s60, v52
v_lshl_add_u32 v54, v7, 2, s52
s_lshr_b32 s52, s55, 2
s_lshl_b32 s52, s52, 8
s_add_u32 s58, s58, s52
s_lshl2_add_u32 s58, s51, s58
s_lshl_b32 s52, s51, 1
s_add_u32 s52, s52, s62
v_lshl_add_u32 v62, v61, 1, v59
v_lshlrev_b32 v62, s61, v62
v_lshl_add_u32 v53, v60, 7, v62
v_add_u32 v53, s52, v53
v_and_b32 v62, 12, v7
v_and_b32 v63, 15, v7
v_mad_u32_u24 v62, v62, 3, v63
v_lshl_add_u32 v62, v62, 2, s51
v_mov_b32 v67, 0
ds_write_b32 v62, v67
s_lshl2_add_u32 s52, s84, s40
s_lshl_b32 s52, s52, 7
s_add_u32 s52, s52, 393152
v_lshl_add_u32 v65, v7, 2, s58
v_lshl_add_u32 v62, v7, 2, s52
v_cmp_gt_u32 vcc, 16, v7
s_lshl_b32 s52, s51, 2
v_lshl_add_u32 v57, v7, 2, s52
v_cndmask_b32 v65, v62, v65, vcc
s_mov_b32 s75, 0
s_mov_b32 s73, 0x05060100
s_mov_b32 s74, 0xffff
v_mov_b32 v55, 0x05040100
v_mov_b32 v62, 0x03020706
v_cmp_eq_u32 vcc, 1, v59
v_mov_b32 v68, 0xf0a0500
v_mov_b32 v69, 0x8f8a8580
v_mov_b32 v70, 0x1f1a1510
v_mov_b32 v71, 0x9f9a9590
v_mov_b32 v72, 0x2f2a2520
v_mov_b32 v73, 0xafaaa5a0
v_mov_b32 v74, 0x3f3a3530
v_mov_b32 v75, 0xbfbab5b0
v_cndmask_b32 v55, v55, v62, vcc
v_mov_b64 v[76:77], 0
v_mov_b64 v[78:79], 0
v_mov_b64 v[80:81], 0
v_mov_b32 v82, 0
s_mov_b32 s64, 0x5040500
s_mov_b32 s65, 0x5040501
s_mov_b32 s66, 0x5040502
s_mov_b32 s67, 0x5040503
s_mov_b32 s68, 0x7060700
s_mov_b32 s69, 0x7060701
s_mov_b32 s70, 0x7060702
s_mov_b32 s71, 0x7060703
s_mov_b32 s72, 0x05060102
s_waitcnt vmcnt(12)
v_perm_b32 v24, v8, v68, s64
v_perm_b32 v25, v9, v68, s65
v_perm_b32 v26, v10, v68, s66
v_perm_b32 v27, v11, v68, s67
v_max3_f32 v28, |v24|, |v25|, |v26|
v_med3_f32 v29, |v24|, |v25|, |v26|
v_min3_f32 v30, |v24|, |v25|, |v26|
v_med3_f32 v32, v28, v29, |v27|
v_med3_f32 v33, v29, v30, |v27|
v_max_f32 v31, v28, |v27|
v_perm_b32 v36, v31, v32, s72
v_bfi_b32 v44, 3, v32, v31
v_cmpx_eq_u32_sdwa vcc, v33, v32 src0_sel:WORD_1 src1_sel:WORD_1
v_mov_b32 v76, v33
v_min_f32 v77, v30, |v27|
s_mov_b64 exec, -1
v_perm_b32 v24, v8, v69, s68
v_perm_b32 v25, v9, v69, s69
v_perm_b32 v26, v10, v69, s70
v_perm_b32 v27, v11, v69, s71
v_max3_f32 v28, |v24|, |v25|, |v26|
v_med3_f32 v29, |v24|, |v25|, |v26|
v_min3_f32 v30, |v24|, |v25|, |v26|
v_med3_f32 v32, v28, v29, |v27|
v_med3_f32 v33, v29, v30, |v27|
v_max_f32 v31, v28, |v27|
v_perm_b32 v40, v31, v32, s72
v_bfi_b32 v46, 3, v32, v31
v_cmpx_eq_u32_sdwa vcc, v33, v32 src0_sel:WORD_1 src1_sel:WORD_1
v_mov_b64 v[78:79], v[76:77]
v_mov_b32 v76, v33
v_min_f32 v77, v30, |v27|
s_mov_b64 exec, -1
s_waitcnt vmcnt(8)
v_perm_b32 v24, v12, v70, s64
v_perm_b32 v25, v13, v70, s65
v_perm_b32 v26, v14, v70, s66
v_perm_b32 v27, v15, v70, s67
v_max3_f32 v28, |v24|, |v25|, |v26|
v_med3_f32 v29, |v24|, |v25|, |v26|
v_min3_f32 v30, |v24|, |v25|, |v26|
v_med3_f32 v32, v28, v29, |v27|
v_med3_f32 v33, v29, v30, |v27|
v_max_f32 v31, v28, |v27|
v_perm_b32 v37, v31, v32, s72
v_bfi_b32 v31, 3, v32, v31
v_lshlrev_b32 v31, 4, v31
v_bfi_b32 v44, 15, v44, v31
v_cmpx_eq_u32_sdwa vcc, v33, v32 src0_sel:WORD_1 src1_sel:WORD_1
v_mov_b64 v[80:81], v[78:79]
v_mov_b64 v[78:79], v[76:77]
v_mov_b32 v76, v33
v_min_f32 v77, v30, |v27|
s_mov_b64 exec, -1
v_perm_b32 v24, v12, v71, s68
v_perm_b32 v25, v13, v71, s69
v_perm_b32 v26, v14, v71, s70
v_perm_b32 v27, v15, v71, s71
v_max3_f32 v28, |v24|, |v25|, |v26|
v_med3_f32 v29, |v24|, |v25|, |v26|
v_min3_f32 v30, |v24|, |v25|, |v26|
v_med3_f32 v32, v28, v29, |v27|
v_med3_f32 v33, v29, v30, |v27|
v_max_f32 v31, v28, |v27|
v_perm_b32 v41, v31, v32, s72
v_bfi_b32 v31, 3, v32, v31
v_lshlrev_b32 v31, 4, v31
v_bfi_b32 v46, 15, v46, v31
v_cmpx_eq_u32_sdwa vcc, v33, v32 src0_sel:WORD_1 src1_sel:WORD_1
v_or_b32 v82, v82, v80
v_mov_b64 v[80:81], v[78:79]
v_mov_b64 v[78:79], v[76:77]
v_mov_b32 v76, v33
v_min_f32 v77, v30, |v27|
s_mov_b64 exec, -1
s_waitcnt vmcnt(4)
v_perm_b32 v24, v16, v72, s64
v_perm_b32 v25, v17, v72, s65
v_perm_b32 v26, v18, v72, s66
v_perm_b32 v27, v19, v72, s67
v_max3_f32 v28, |v24|, |v25|, |v26|
v_med3_f32 v29, |v24|, |v25|, |v26|
v_min3_f32 v30, |v24|, |v25|, |v26|
v_med3_f32 v32, v28, v29, |v27|
v_med3_f32 v33, v29, v30, |v27|
v_max_f32 v31, v28, |v27|
v_perm_b32 v38, v31, v32, s72
v_bfi_b32 v45, 3, v32, v31
v_cmpx_eq_u32_sdwa vcc, v33, v32 src0_sel:WORD_1 src1_sel:WORD_1
v_or_b32 v82, v82, v80
v_mov_b64 v[80:81], v[78:79]
v_mov_b64 v[78:79], v[76:77]
v_mov_b32 v76, v33
v_min_f32 v77, v30, |v27|
s_mov_b64 exec, -1
v_perm_b32 v24, v16, v73, s68
v_perm_b32 v25, v17, v73, s69
v_perm_b32 v26, v18, v73, s70
v_perm_b32 v27, v19, v73, s71
v_max3_f32 v28, |v24|, |v25|, |v26|
v_med3_f32 v29, |v24|, |v25|, |v26|
v_min3_f32 v30, |v24|, |v25|, |v26|
v_med3_f32 v32, v28, v29, |v27|
v_med3_f32 v33, v29, v30, |v27|
v_max_f32 v31, v28, |v27|
v_perm_b32 v42, v31, v32, s72
v_bfi_b32 v47, 3, v32, v31
v_cmpx_eq_u32_sdwa vcc, v33, v32 src0_sel:WORD_1 src1_sel:WORD_1
v_or_b32 v82, v82, v80
v_mov_b64 v[80:81], v[78:79]
v_mov_b64 v[78:79], v[76:77]
v_mov_b32 v76, v33
v_min_f32 v77, v30, |v27|
s_mov_b64 exec, -1
s_waitcnt vmcnt(0)
v_perm_b32 v24, v20, v74, s64
v_perm_b32 v25, v21, v74, s65
v_perm_b32 v26, v22, v74, s66
v_perm_b32 v27, v23, v74, s67
v_max3_f32 v28, |v24|, |v25|, |v26|
v_med3_f32 v29, |v24|, |v25|, |v26|
v_min3_f32 v30, |v24|, |v25|, |v26|
v_med3_f32 v32, v28, v29, |v27|
v_med3_f32 v33, v29, v30, |v27|
v_max_f32 v31, v28, |v27|
v_perm_b32 v39, v31, v32, s72
v_bfi_b32 v31, 3, v32, v31
v_lshlrev_b32 v31, 4, v31
v_bfi_b32 v45, 15, v45, v31
v_cmpx_eq_u32_sdwa vcc, v33, v32 src0_sel:WORD_1 src1_sel:WORD_1
v_or_b32 v82, v82, v80
v_mov_b64 v[80:81], v[78:79]
v_mov_b64 v[78:79], v[76:77]
v_mov_b32 v76, v33
v_min_f32 v77, v30, |v27|
s_mov_b64 exec, -1
v_perm_b32 v24, v20, v75, s68
v_perm_b32 v25, v21, v75, s69
v_perm_b32 v26, v22, v75, s70
v_perm_b32 v27, v23, v75, s71
v_max3_f32 v28, |v24|, |v25|, |v26|
v_med3_f32 v29, |v24|, |v25|, |v26|
v_min3_f32 v30, |v24|, |v25|, |v26|
v_med3_f32 v32, v28, v29, |v27|
v_med3_f32 v33, v29, v30, |v27|
v_max_f32 v31, v28, |v27|
v_perm_b32 v43, v31, v32, s72
v_bfi_b32 v31, 3, v32, v31
v_lshlrev_b32 v31, 4, v31
v_bfi_b32 v47, 15, v47, v31
v_cmpx_eq_u32_sdwa vcc, v33, v32 src0_sel:WORD_1 src1_sel:WORD_1
v_or_b32 v82, v82, v80
v_mov_b64 v[80:81], v[78:79]
v_mov_b64 v[78:79], v[76:77]
v_mov_b32 v76, v33
v_min_f32 v77, v30, |v27|
s_mov_b64 exec, -1
s_mov_b32 vcc_lo, 0x33333333
s_mov_b32 vcc_hi, 0x33333333
v_cndmask_b32_dpp v24, v40, v36, vcc quad_perm:[2,3,0,1] row_mask:0xf bank_mask:0xf
v_cndmask_b32_dpp v25, v41, v37, vcc quad_perm:[2,3,0,1] row_mask:0xf bank_mask:0xf
v_cndmask_b32_dpp v26, v42, v38, vcc quad_perm:[2,3,0,1] row_mask:0xf bank_mask:0xf
v_cndmask_b32_dpp v27, v43, v39, vcc quad_perm:[2,3,0,1] row_mask:0xf bank_mask:0xf
s_not_b64 vcc, vcc
buffer_store_dwordx4 v[24:27], v51, s[24:27], 0 offen sc1
v_cndmask_b32_dpp v40, v36, v40, vcc quad_perm:[2,3,0,1] row_mask:0xf bank_mask:0xf
v_cndmask_b32_dpp v41, v37, v41, vcc quad_perm:[2,3,0,1] row_mask:0xf bank_mask:0xf
v_cndmask_b32_dpp v42, v38, v42, vcc quad_perm:[2,3,0,1] row_mask:0xf bank_mask:0xf
v_cndmask_b32_dpp v43, v39, v43, vcc quad_perm:[2,3,0,1] row_mask:0xf bank_mask:0xf
s_mov_b32 s52, 0x0c0c0400
s_mov_b32 s53, 0x04000c0c
buffer_store_dwordx4 v[40:43], v66, s[24:27], 0 offen sc1
v_perm_b32 v48, v45, v44, s52
v_perm_b32 v49, v47, v46, s53
v_or_b32 v48, v48, v49
s_nop 1
v_mov_b32_dpp v49, v48 quad_perm:[2,3,0,1] row_mask:0xf bank_mask:0xf
v_perm_b32 v48, v49, v48, v55
ds_permute_b32 v48, v52, v48
v_cmp_lt_u32 s[54:55], s74, v82
L_emit:
v_cmp_lt_u32 vcc, s74, v76
v_cmp_eq_u32_sdwa s[48:49], v77, v76 src0_sel:WORD_1 src1_sel:WORD_1
v_perm_b32 v63, v76, v53, s73
v_bfe_u32 v62, v76, 2, 4
v_and_b32 v64, 0x80, v76
v_lshl_add_u32 v63, v62, 1, v63
v_mbcnt_lo_u32_b32 v62, vcc_lo, 0
v_mbcnt_hi_u32_b32 v62, vcc_hi, v62
v_add_u32 v63, v64, v63
v_add_u32 v62, s75, v62
s_bcnt1_i32_b64 s52, vcc
s_add_u32 s75, s75, s52
v_cmp_gt_u32 s[52:53], 15, v62
v_and_b32 v64, 12, v62
v_mad_u32_u24 v62, v64, 3, v62
v_lshl_add_u32 v62, v62, 2, s51
s_and_b64 s[48:49], s[48:49], vcc
s_and_b64 exec, s[52:53], vcc
ds_write_b32 v62, v63
s_mov_b64 exec, s[48:49]
v_mov_b32 v76, v77
v_mov_b32 v77, 0
s_not_b64 exec, exec
v_mov_b64 v[76:77], v[78:79]
v_mov_b64 v[78:79], v[80:81]
v_mov_b64 v[80:81], 0
s_mov_b64 exec, -1
v_or3_b32 v62, v76, v78, v80
v_cmp_lt_u32 vcc, s74, v62
s_cmp_lg_u64 s[54:55], 0
s_cselect_b32 s52, 99, s75
s_cmp_gt_u32 s52, 15
s_cselect_b32 s52, -1, 0
v_mov_b32 v63, s51
s_cbranch_vccnz L_emit
v_mov_b32 v62, s52
ds_write_b32 v63, v62 offset:204
v_lshlrev_b32 v11, 4, v63
s_waitcnt lgkmcnt(0)
s_barrier
s_mov_b64 exec, 0xffff
ds_read_b32 v67, v57
s_mov_b64 exec, -1
buffer_store_dword v48, v54, s[24:27], 0 offen sc1
s_mov_b32 exec_hi, 0xffff
s_waitcnt lgkmcnt(0)
buffer_store_dword v67, v65, s[24:27], 0 offen sc1
s_mov_b64 exec, 1
buffer_load_dword v8, v11, s[36:39], 0 offen sc1
s_mov_b64 exec, -1
s_lshl_b32 s52, s84, 7
s_add_u32 s52, s52, 458752
v_lshl_add_u32 v9, v7, 2, s52
v_mov_b32 v10, 1
s_waitcnt vmcnt(0)
s_mov_b32 s85, 0x230003c
s_barrier
s_cmp_lg_u32 s40, 0
s_cbranch_scc1 L_cons2
v_readfirstlane_b32 s47, v8
s_mov_b64 exec, 0xffff
s_cmp_lg_u32 s47, 1
s_cbranch_scc1 L_pwait
L_pset:
buffer_store_dword v10, v9, s[24:27], 0 offen sc1
L_notlast:
s_mov_b64 exec, -1
L_cons2:
v_lshrrev_b32 v72, 3, v7
v_and_b32 v73, 7, v7
v_xor_b32 v73, v73, v72
v_mul_u32_u24 v72, 1152, v72
s_and_b32 s47, s40, 1
s_mul_i32 s47, s47, 9216
s_lshr_b32 s3, s40, 1
s_lshl_b32 s3, s3, 7
s_add_u32 s47, s47, s3
v_lshl_add_u32 v72, v73, 4, v72
v_add_u32 v3, s47, v72
s_lshl_b32 s44, s40, 10
s_mul_i32 s45, s2, 18432
s_mov_b32 s46, s45
s_branch L_cons3
L_pwait:
s_mov_b32 s3, 20015
L_pwait1:
buffer_load_dword v8, off, s[36:39], 0 sc1
s_waitcnt vmcnt(0)
v_readfirstlane_b32 s47, v8
s_nop 3
s_cmp_eq_u32 s47, 1
s_cbranch_scc1 L_pset
s_sub_u32 s3, s3, 1
s_cbranch_scc0 L_pwait1
s_branch L_notlast
L_cons:
v_readfirstlane_b32 s40, v1
s_mov_b32 s86, 0
s_mov_b32 s85, 0x700030
s_mov_b32 s47, 0x700030
s_bitcmp1_b32 s2, 3
s_cselect_b32 s85, s85, 0x230003c
s_cselect_b32 s47, s47, 0x230003c
s_bitcmp1_b32 s2, 6
s_cselect_b32 s85, s47, s85
v_lshrrev_b32 v72, 3, v7
v_and_b32 v73, 7, v7
v_xor_b32 v73, v73, v72
v_mul_u32_u24 v72, 1152, v72
s_and_b32 s47, s40, 1
s_mul_i32 s47, s47, 9216
s_lshr_b32 s3, s40, 1
s_lshl_b32 s3, s3, 7
s_add_u32 s47, s47, s3
v_lshl_add_u32 v72, v73, 4, v72
v_add_u32 v3, s47, v72
s_lshl_b32 s44, s40, 10
s_mul_i32 s45, s2, 18432
s_mov_b32 s46, s45
s_waitcnt lgkmcnt(0)
s_mov_b32 s30, 663552
s_mov_b32 s31, 0x20000
s_mov_b32 s28, s6
s_and_b32 s29, s7, 0xffff
s_mov_b32 s18, 75497472
s_mov_b32 s19, 0x20000
s_mov_b32 s16, s4
s_and_b32 s17, s5, 0xffff
s_mov_b32 s26, 301989888
s_mov_b32 s27, 0x20000
s_mov_b32 s24, s14
s_and_b32 s25, s15, 0xffff
s_mov_b32 s34, 1152
s_mov_b32 s35, 0x20000
s_mov_b32 s32, s8
s_and_b32 s33, s9, 0xffff
s_mov_b32 s22, 0
s_mov_b32 s23, 0x20000
s_mov_b32 s20, s10
s_and_b32 s21, s11, 0xffff
s_mov_b32 s38, 256
s_mov_b32 s39, 0x20000
s_mov_b32 s36, s12
s_and_b32 s37, s13, 0xffff
s_cmp_lg_u32 s2, 200
s_cbranch_scc1 L_cons3
v_lshlrev_b32 v8, 4, v0
v_mov_b64 v[12:13], 0
v_mov_b64 v[14:15], 0
buffer_store_dwordx4 v[12:15], v8, s[36:39], 0 offen sc1
v_add_u32 v8, 458752, v8
v_add_u32 v9, 4096, v8
buffer_store_dwordx4 v[12:15], v8, s[24:27], 0 offen sc1
buffer_store_dwordx4 v[12:15], v9, s[24:27], 0 offen sc1
v_mov_b32 v10, 1
v_lshlrev_b32 v11, 2, v0
s_waitcnt vmcnt(0)
s_barrier
s_mov_b32 exec_hi, 0
buffer_store_dword v10, v11, s[36:39], 0 offen sc1
s_mov_b64 exec, -1
L_cons3:
s_lshr_b32 s47, s40, 1
s_lshl_b32 s3, s47, 11
s_sub_u32 s8, 15488, s3
s_lshl_b32 s3, s47, 7
s_add_u32 s7, s45, 128
s_sub_u32 s7, s7, s3
s_sub_u32 s10, s47, 1
s_sub_u32 s11, 0, s47
s_mov_b32 s9, s44
s_mov_b32 s13, 4718592
s_mov_b32 s15, 16
s_mov_b32 s14, s13
v_and_b32 v80, 3, v7
v_bfe_u32 v81, v7, 2, 2
v_bfe_u32 v82, v7, 4, 1
v_lshlrev_b32 v81, 3, v81
v_lshl_add_u32 v81, v80, 5, v81
v_lshl_add_u32 v81, v82, 7, v81
s_lshl_b32 s47, s40, 8
v_add_u32 v81, s47, v81
s_lshl_b32 s47, s40, 5
s_add_u32 s47, s47, 1024
v_lshl_add_u32 v80, v80, 3, s47
v_cmp_gt_u32 vcc, 32, v7
s_nop 1
v_cndmask_b32 v80, v80, v81, vcc
buffer_load_dwordx2 v[110:111], v80, s[32:35], 0 offen
s_cmp_lt_u32 s84, 41
s_cbranch_scc1 L_pfd
s_waitcnt vmcnt(0)
L_pfd:
s_bfe_u32 s88, s85, 0x40014
s_mov_b32 s3, 55680
s_cmp_ge_u32 s88, 6
s_cselect_b32 s3, s3, 0
s_cmp_ge_u32 s84, 41
s_cselect_b32 s3, s3, 0
L_pf:
s_add_u32 m0, s44, 0
s_nop 0
buffer_load_dwordx4 v3, s[16:19], s45 offen offset:0 nt lds
s_add_u32 m0, s44, 3840
s_nop 0
buffer_load_dwordx4 v3, s[16:19], s45 offen offset:256 nt lds
s_add_u32 m0, s44, 7680
s_nop 0
buffer_load_dwordx4 v3, s[16:19], s45 offen offset:512 nt lds
s_add_u32 m0, s44, 11520
s_nop 0
buffer_load_dwordx4 v3, s[16:19], s45 offen offset:768 nt lds
s_add_u32 m0, s44, s8
s_mov_b64 exec, s[10:11]
buffer_load_dwordx4 v3, s[16:19], s7 offen offset:896 nt lds
s_mov_b64 exec, -1
s_cmp_lg_u32 s44, 37120
s_cbranch_scc1 L_pf_f
s_mov_b64 exec, 1
buffer_load_dword v124, off, s[36:39], 0 sc1
s_mov_b64 exec, -1
L_pf_f:
s_cmp_ge_u32 s44, s3
s_cbranch_scc1 L_pf_n
s_waitcnt vmcnt(1)
L_pf_n:
s_add_u32 s7, s7, s13
s_add_u32 s44, s44, 18560
s_add_u32 s45, s45, s13
s_mov_b32 s13, 4718592
s_sub_u32 s88, s88, 1
s_cmp_lg_u32 s88, 0
s_cbranch_scc1 L_pf
L_pf_e:
L_rest:
s_mov_b32 s92, 0x80
s_mov_b32 s47, 0x80
s_bitcmp1_b32 s2, 3
s_cselect_b32 s92, s92, 0x88
s_cselect_b32 s47, s47, 0x88
s_bitcmp1_b32 s2, 6
s_cselect_b32 s92, s47, s92
s_mov_b32 s3, 0x88
s_cmp_lt_u32 s84, 41
s_cselect_b32 s92, s3, s92
s_mov_b32 s87, 0x80
s_mov_b32 s3, 0x80
s_cmp_lt_u32 s84, 41
s_cselect_b32 s87, s3, s87
v_and_b32 v72, 15, v7
v_lshrrev_b32 v73, 4, v7
v_and_b32 v74, 7, v7
v_xor_b32 v74, v74, v73
v_lshlrev_b32 v74, 4, v74
v_lshl_add_u32 v0, v72, 7, v74
v_xor_b32 v1, 64, v0
s_mul_i32 s93, s40, 3584
s_add_u32 s93, s93, 148480
v_lshl_add_u32 v2, v73, 4, s93
v_and_b32 v74, 14, v7
v_mul_u32_u24 v4, 1152, v74
v_and_b32 v74, 1, v7
v_lshl_add_u32 v4, v74, 4, v4
v_lshl_add_u32 v4, v73, 5, v4
s_lshl_b32 s47, s40, 8
v_add_u32 v4, s47, v4
s_lshl_b32 s47, s40, 5
s_add_u32 s47, s47, 1024
v_lshrrev_b32 v72, 2, v7
v_and_b32 v73, 3, v7
v_lshl_add_u32 v6, v73, 4, v72
v_lshlrev_b32 v6, 2, v6
v_mul_u32_u24 v5, 1152, v72
v_lshl_add_u32 v5, v73, 3, v5
v_add_u32 v5, s47, v5
s_mov_b32 s80, 0x55555555
s_mov_b32 s81, 0x55555555
s_mov_b32 s82, 0xaaaaaaaa
s_mov_b32 s83, 0xaaaaaaaa
v_lshl_add_u32 v109, v7, 4, s93
v_lshl_add_u32 v89, v7, 2, s93
v_mov_b32 v76, 0
v_mov_b32 v77, 0
v_mov_b32 v78, 0
v_mov_b32 v79, 0
v_mov_b32 v90, 0xdddddddd
ds_write_b128 v109, v[76:79]
ds_write_b32 v89, v90 offset:1792
ds_write_b32 v89, v90 offset:2048
ds_write_b32 v89, v90 offset:2304
ds_write_b32 v89, v90 offset:2560
ds_write_b32 v89, v90 offset:2816
ds_write_b32 v89, v90 offset:3072
ds_write_b32 v89, v90 offset:3328
s_lshl_b32 s47, s40, 2
s_add_u32 s47, s47, 163072
v_mov_b32 v88, s47
ds_write_b32 v88, v76
s_mul_i32 s47, s40, 2304
s_add_u32 s47, s47, 373760
v_and_b32 v73, 60, v7
v_mad_u32_u24 v73, v73, 3, v7
v_lshl_add_u32 v72, v73, 4, s47
s_mov_b32 s47, 380672
v_lshl_add_u32 v73, v73, 4, s47
v_lshrrev_b32 v74, 2, v7
v_cmp_gt_u32 vcc, 36, v7
v_lshlrev_b32 v90, 11, v74
v_subrev_u32 v74, 9, v74
v_lshlrev_b32 v74, 12, v74
v_cndmask_b32 v72, v73, v72, vcc
v_cndmask_b32 v90, v74, v90, vcc
s_lshl_b32 s47, s40, 12
s_add_u32 s47, s47, 0x8001
v_mov_b32 v88, 1
v_mov_b32 v94, 0xf001
v_mov_b32 v95, s47
v_cndmask_b32 v94, v94, v88, vcc
v_cndmask_b32 v95, v95, v88, vcc
v_cndmask_b32 v96, 0, 28, vcc
v_cndmask_b32 v97, 32, 0, vcc
v_add_u32 v97, s93, v97
v_cmp_gt_u32 vcc, 56, v7
v_mov_b32 v73, 0x40000000
s_lshr_b32 s47, s2, 3
s_lshl_b32 s47, s47, 2
s_add_u32 s47, s47, s40
s_mul_i32 s47, s47, 2944
v_cndmask_b32 v72, v73, v72, vcc
v_lshl_add_u32 v93, v7, 4, s47
s_mul_i32 s47, s40, 82944
s_add_u32 s47, s47, s86
v_lshl_add_u32 v112, v7, 4, s47
s_mul_i32 s47, s40, 9216
s_add_u32 s47, s47, s86
s_add_u32 s47, s47, 331776
v_lshl_add_u32 v113, v7, 4, s47
s_lshl_b32 s47, s40, 6
s_add_u32 s47, s47, s86
s_add_u32 s47, s47, 368640
v_and_b32 v106, 15, v7
v_lshl_add_u32 v106, v106, 2, s47
v_lshrrev_b32 v107, 4, v7
v_lshl_add_u32 v106, v107, 8, v106
v_and_b32 v74, 15, v7
v_and_b32 v73, 7, v7
v_lshlrev_b32 v100, 1, v73
v_lshlrev_b32 v100, v100, v88
v_lshlrev_b32 v73, 4, v73
v_lshl_add_u32 v92, v74, 7, v73
v_lshl_or_b32 v92, v92, 16, v92
v_lshrrev_b32 v98, 5, v7
v_bfe_u32 v99, v7, 3, 2
v_lshl_add_u32 v99, v99, 6, s93
v_lshl_add_u32 v101, v7, 1, s93
v_lshrrev_b32 v102, 4, v7
v_lshl_add_u32 v102, v102, 3, s93
v_lshrrev_b32 v103, 1, v7
v_lshlrev_b32 v103, 5, v103
s_mov_b32 s89, 0
s_cmp_lg_u32 s40, 0
s_cbranch_scc1 L_ready
s_mov_b32 s3, 20015
s_mov_b32 s47, 458752
v_lshl_add_u32 v9, v7, 7, s47
s_bfe_u32 s47, s85, 0x40014
s_cmp_ge_u32 s47, 6
s_waitcnt vmcnt(15)
s_cbranch_scc1 L_deep
s_waitcnt vmcnt(0)
L_deep:
v_readfirstlane_b32 s47, v124
s_mov_b32 exec_hi, 511
s_cmp_lg_u32 s47, 1
s_cbranch_scc1 L_cwait
L_poll:
buffer_load_dword v8, v9, s[24:27], 0 offen sc1
s_sub_u32 s3, s3, 1
s_cbranch_scc1 L_giveup
s_waitcnt vmcnt(0)
v_cmp_ne_u32 vcc, 1, v8
s_nop 4
s_cbranch_vccnz L_poll
L_polled:
s_mov_b64 exec, -1
L_ready:
s_waitcnt lgkmcnt(0)
s_barrier
buffer_load_dwordx4 v[8:11], v72, s[24:27], 0 offen offset:0 sc1
buffer_load_dwordx4 v[12:15], v72, s[24:27], 0 offen offset:64 sc1
buffer_load_dwordx4 v[16:19], v72, s[24:27], 0 offen offset:128 sc1
buffer_load_dwordx4 v[20:23], v72, s[24:27], 0 offen offset:192 sc1
buffer_load_dwordx4 v[76:79], v93, s[24:27], 0 offen offset:0 sc1
buffer_load_dwordx4 v[80:83], v93, s[24:27], 0 offen offset:1024 sc1
buffer_load_dwordx4 v[84:87], v93, s[24:27], 0 offen offset:2048 sc1
buffer_load_dword v174, v106, s[24:27], 0 offen offset:0 sc1
buffer_load_dword v175, v106, s[24:27], 0 offen offset:1024 sc1
buffer_load_dword v176, v106, s[24:27], 0 offen offset:2048 sc1
buffer_load_dword v177, v106, s[24:27], 0 offen offset:3072 sc1
s_mov_b32 s99, 4096
buffer_load_dword v178, v106, s[24:27], s99 offen offset:0 sc1
s_mov_b32 s98, 0
buffer_load_dwordx4 v[138:141], v113, s[24:27], s98 offen sc1
s_mov_b32 s99, 0
buffer_load_dwordx4 a[0:3], v112, s[24:27], s99 offen offset:0 sc1
buffer_load_dwordx4 a[4:7], v112, s[24:27], s99 offen offset:1024 sc1
buffer_load_dwordx4 a[8:11], v112, s[24:27], s99 offen offset:2048 sc1
s_waitcnt vmcnt(12)
v_cmp_ne_u32 s[90:91], 0, v23
v_cmp_ne_u32 s[78:79], 0, v16
v_and_b32 v73, v94, v8
v_lshrrev_b32 v72, 10, v8
v_cmp_eq_u32 s[48:49], v73, v95
v_and_or_b32 v24, v72, v96, v97
s_mov_b64 exec, s[48:49]
ds_add_rtn_u32 v40, v24, v88
s_mov_b64 exec, -1
buffer_load_dwordx4 a[12:15], v112, s[24:27], s99 offen offset:3072 sc1
v_and_b32 v73, v94, v9
v_lshrrev_b32 v72, 10, v9
v_cmp_eq_u32 s[50:51], v73, v95
v_and_or_b32 v25, v72, v96, v97
s_mov_b64 exec, s[50:51]
ds_add_rtn_u32 v41, v25, v88
s_mov_b64 exec, -1
v_and_b32 v73, v94, v10
v_lshrrev_b32 v72, 10, v10
v_cmp_eq_u32 s[52:53], v73, v95
v_and_or_b32 v26, v72, v96, v97
s_mov_b64 exec, s[52:53]
ds_add_rtn_u32 v42, v26, v88
s_mov_b64 exec, -1
s_mov_b32 s99, 4096
buffer_load_dwordx4 a[16:19], v112, s[24:27], s99 offen offset:0 sc1
v_and_b32 v73, v94, v11
v_lshrrev_b32 v72, 10, v11
v_cmp_eq_u32 s[54:55], v73, v95
v_and_or_b32 v27, v72, v96, v97
s_mov_b64 exec, s[54:55]
ds_add_rtn_u32 v43, v27, v88
s_mov_b64 exec, -1
buffer_load_dwordx4 a[20:23], v112, s[24:27], s99 offen offset:1024 sc1
v_and_b32 v73, v94, v12
v_lshrrev_b32 v72, 10, v12
v_cmp_eq_u32 s[56:57], v73, v95
v_and_or_b32 v28, v72, v96, v97
s_mov_b64 exec, s[56:57]
ds_add_rtn_u32 v44, v28, v88
s_mov_b64 exec, -1
buffer_load_dwordx4 a[24:27], v112, s[24:27], s99 offen offset:2048 sc1
v_and_b32 v73, v94, v13
v_lshrrev_b32 v72, 10, v13
v_cmp_eq_u32 s[58:59], v73, v95
v_and_or_b32 v29, v72, v96, v97
s_mov_b64 exec, s[58:59]
ds_add_rtn_u32 v45, v29, v88
s_mov_b64 exec, -1
v_and_b32 v73, v94, v14
v_lshrrev_b32 v72, 10, v14
v_cmp_eq_u32 s[60:61], v73, v95
v_and_or_b32 v30, v72, v96, v97
s_mov_b64 exec, s[60:61]
ds_add_rtn_u32 v46, v30, v88
s_mov_b64 exec, -1
buffer_load_dwordx4 a[28:31], v112, s[24:27], s99 offen offset:3072 sc1
v_and_b32 v73, v94, v15
v_lshrrev_b32 v72, 10, v15
v_cmp_eq_u32 s[62:63], v73, v95
v_and_or_b32 v31, v72, v96, v97
s_mov_b64 exec, s[62:63]
ds_add_rtn_u32 v47, v31, v88
s_mov_b64 exec, -1
s_mov_b32 s99, 8192
buffer_load_dwordx4 a[32:35], v112, s[24:27], s99 offen offset:0 sc1
s_cmp_lg_u64 s[78:79], 0
s_cbranch_scc1 L_more1
L_more1b:
ds_read_b32 v72, v89
v_mov_b32 v73, 0
s_mov_b32 s98, 1024
buffer_load_dwordx4 v[142:145], v113, s[24:27], s98 offen sc1
buffer_load_dwordx4 a[36:39], v112, s[24:27], s99 offen offset:1024 sc1
buffer_load_dwordx4 a[40:43], v112, s[24:27], s99 offen offset:2048 sc1
s_waitcnt lgkmcnt(0)
s_mov_b64 vcc, s[80:81]
v_cndmask_b32_dpp v73, v72, v73, vcc quad_perm:[0,0,2,2] row_mask:0xf bank_mask:0xf
v_add_u32 v91, v103, v73
v_add_u32 v73, v72, v73
v_cmp_lt_u32 vcc, 32, v73
s_or_b32 s90, s90, s91
s_and_b32 s47, vcc_lo, 0x1ff
s_or_b32 s47, s47, s90
s_cbranch_scc1 L_greedy
L_greedyb:
buffer_load_dwordx4 a[44:47], v112, s[24:27], s99 offen offset:3072 sc1
ds_bpermute_b32 v56, v24, v91
ds_bpermute_b32 v57, v25, v91
ds_bpermute_b32 v58, v26, v91
ds_bpermute_b32 v59, v27, v91
ds_bpermute_b32 v60, v28, v91
ds_bpermute_b32 v61, v29, v91
ds_bpermute_b32 v62, v30, v91
ds_bpermute_b32 v63, v31, v91
s_mov_b32 s99, 12288
buffer_load_dwordx4 a[48:51], v112, s[24:27], s99 offen offset:0 sc1
buffer_load_dwordx4 a[52:55], v112, s[24:27], s99 offen offset:1024 sc1
buffer_load_dwordx4 a[56:59], v112, s[24:27], s99 offen offset:2048 sc1
s_waitcnt lgkmcnt(7)
v_add_u32 v73, v40, v56
v_and_b32 v72, 0x87e, v8
v_lshl_add_u32 v73, v73, 1, s93
v_add_u32 v72, v90, v72
s_andn2_b64 exec, s[48:49], s[90:91]
ds_write_b16_d16_hi v73, v8 offset:64
ds_write_b16 v73, v72 offset:384
ds_write_b16 v73, v8 offset:704
s_mov_b64 exec, -1
buffer_load_dwordx4 a[60:63], v112, s[24:27], s99 offen offset:3072 sc1
s_waitcnt lgkmcnt(9)
v_add_u32 v73, v41, v57
v_and_b32 v72, 0x87e, v9
v_lshl_add_u32 v73, v73, 1, s93
v_add_u32 v72, v90, v72
s_andn2_b64 exec, s[50:51], s[90:91]
ds_write_b16_d16_hi v73, v9 offset:64
ds_write_b16 v73, v72 offset:384
ds_write_b16 v73, v9 offset:704
s_mov_b64 exec, -1
s_mov_b32 s99, 16384
buffer_load_dwordx4 a[64:67], v112, s[24:27], s99 offen offset:0 sc1
s_waitcnt lgkmcnt(11)
v_add_u32 v73, v42, v58
v_and_b32 v72, 0x87e, v10
v_lshl_add_u32 v73, v73, 1, s93
v_add_u32 v72, v90, v72
s_andn2_b64 exec, s[52:53], s[90:91]
ds_write_b16_d16_hi v73, v10 offset:64
ds_write_b16 v73, v72 offset:384
ds_write_b16 v73, v10 offset:704
s_mov_b64 exec, -1
buffer_load_dwordx4 a[68:71], v112, s[24:27], s99 offen offset:1024 sc1
s_waitcnt lgkmcnt(13)
v_add_u32 v73, v43, v59
v_and_b32 v72, 0x87e, v11
v_lshl_add_u32 v73, v73, 1, s93
v_add_u32 v72, v90, v72
s_andn2_b64 exec, s[54:55], s[90:91]
ds_write_b16_d16_hi v73, v11 offset:64
ds_write_b16 v73, v72 offset:384
ds_write_b16 v73, v11 offset:704
s_mov_b64 exec, -1
s_mov_b32 s98, 2048
buffer_load_dwordx4 v[146:149], v113, s[24:27], s98 offen sc1
s_waitcnt lgkmcnt(15)
v_add_u32 v73, v44, v60
v_and_b32 v72, 0x87e, v12
v_lshl_add_u32 v73, v73, 1, s93
v_add_u32 v72, v90, v72
s_andn2_b64 exec, s[56:57], s[90:91]
ds_write_b16_d16_hi v73, v12 offset:64
ds_write_b16 v73, v72 offset:384
ds_write_b16 v73, v12 offset:704
s_mov_b64 exec, -1
buffer_load_dwordx4 a[72:75], v112, s[24:27], s99 offen offset:2048 sc1
s_waitcnt lgkmcnt(15)
v_add_u32 v73, v45, v61
v_and_b32 v72, 0x87e, v13
v_lshl_add_u32 v73, v73, 1, s93
v_add_u32 v72, v90, v72
s_andn2_b64 exec, s[58:59], s[90:91]
ds_write_b16_d16_hi v73, v13 offset:64
ds_write_b16 v73, v72 offset:384
ds_write_b16 v73, v13 offset:704
s_mov_b64 exec, -1
buffer_load_dwordx4 a[76:79], v112, s[24:27], s99 offen offset:3072 sc1
s_waitcnt lgkmcnt(15)
v_add_u32 v73, v46, v62
v_and_b32 v72, 0x87e, v14
v_lshl_add_u32 v73, v73, 1, s93
v_add_u32 v72, v90, v72
s_andn2_b64 exec, s[60:61], s[90:91]
ds_write_b16_d16_hi v73, v14 offset:64
ds_write_b16 v73, v72 offset:384
ds_write_b16 v73, v14 offset:704
s_mov_b64 exec, -1
s_mov_b32 s99, 20480
buffer_load_dwordx4 a[80:83], v112, s[24:27], s99 offen offset:0 sc1
s_waitcnt lgkmcnt(15)
v_add_u32 v73, v47, v63
v_and_b32 v72, 0x87e, v15
v_lshl_add_u32 v73, v73, 1, s93
v_add_u32 v72, v90, v72
s_andn2_b64 exec, s[62:63], s[90:91]
ds_write_b16_d16_hi v73, v15 offset:64
ds_write_b16 v73, v72 offset:384
ds_write_b16 v73, v15 offset:704
s_mov_b64 exec, -1
buffer_load_dwordx4 a[84:87], v112, s[24:27], s99 offen offset:1024 sc1
buffer_load_dwordx4 a[88:91], v112, s[24:27], s99 offen offset:2048 sc1
s_cmp_lg_u64 s[78:79], 0
s_cbranch_scc1 L_more2
L_more2b:
ds_read_u16 v8, v101 offset:704
ds_read_u16 v9, v101 offset:832
ds_read_u16 v10, v101 offset:960
ds_read2_b64 v[118:121], v102 offset0:48 offset1:52
ds_read2_b64 v[122:125], v102 offset0:56 offset1:60
ds_read2_b64 v[126:129], v102 offset0:64 offset1:68
ds_read2_b64 v[130:133], v102 offset0:72 offset1:76
ds_read2_b64 v[134:137], v102 offset0:80 offset1:84
buffer_load_dwordx4 a[92:95], v112, s[24:27], s99 offen offset:3072 sc1
s_mov_b32 s99, 24576
buffer_load_dwordx4 a[96:99], v112, s[24:27], s99 offen offset:0 sc1
buffer_load_dwordx4 a[100:103], v112, s[24:27], s99 offen offset:1024 sc1
s_waitcnt lgkmcnt(5)
v_lshrrev_b32 v72, 12, v8
v_cmp_ne_u32 vcc, 0, v8
v_min_u32 v72, 8, v72
v_add3_u32 v72, v72, v98, 0
v_lshlrev_b32 v73, 4, v72
v_lshrrev_b32 v72, 1, v72
buffer_load_dwordx4 a[104:107], v112, s[24:27], s99 offen offset:2048 sc1
v_lshlrev_b32 v73, v73, v100
v_lshl_add_u32 v72, v72, 8, v99
v_bfe_u32 v74, v8, 7, 4
v_lshl_add_u32 v72, v74, 2, v72
s_mov_b64 exec, vcc
ds_xor_b32 v72, v73 offset:1792
s_mov_b64 exec, -1
v_lshrrev_b32 v72, 12, v9
v_cmp_ne_u32 vcc, 0, v9
v_min_u32 v72, 8, v72
v_add3_u32 v72, v72, v98, 2
v_lshlrev_b32 v73, 4, v72
v_lshrrev_b32 v72, 1, v72
s_mov_b32 s98, 3072
buffer_load_dwordx4 v[150:153], v113, s[24:27], s98 offen sc1
v_lshlrev_b32 v73, v73, v100
v_lshl_add_u32 v72, v72, 8, v99
v_bfe_u32 v74, v9, 7, 4
v_lshl_add_u32 v72, v74, 2, v72
s_mov_b64 exec, vcc
ds_xor_b32 v72, v73 offset:1792
s_mov_b64 exec, -1
buffer_load_dwordx4 a[108:111], v112, s[24:27], s99 offen offset:3072 sc1
v_lshrrev_b32 v72, 12, v10
v_cmp_ne_u32 vcc, 0, v10
v_min_u32 v72, 8, v72
v_add3_u32 v72, v72, v98, 4
v_lshlrev_b32 v73, 4, v72
v_lshrrev_b32 v72, 1, v72
v_lshlrev_b32 v73, v73, v100
v_lshl_add_u32 v72, v72, 8, v99
v_bfe_u32 v74, v10, 7, 4
v_lshl_add_u32 v72, v74, 2, v72
s_mov_b64 exec, vcc
s_mov_b32 exec_hi, 0
ds_xor_b32 v72, v73 offset:1792
s_mov_b64 exec, -1
s_mov_b32 s99, 28672
buffer_load_dwordx4 a[112:115], v112, s[24:27], s99 offen offset:0 sc1
ds_read_b32 v179, v89 offset:1792
ds_read_b32 v180, v89 offset:2048
ds_read_b32 v181, v89 offset:2304
ds_read_b32 v182, v89 offset:2560
ds_read_b32 v183, v89 offset:2816
ds_read_b32 v184, v89 offset:3072
ds_read_b32 v185, v89 offset:3328
buffer_load_dwordx4 a[116:119], v112, s[24:27], s99 offen offset:1024 sc1
s_waitcnt lgkmcnt(10)
v_xor_b32 v118, v92, v118
v_xor_b32 v119, v92, v119
v_xor_b32 v120, v92, v120
v_xor_b32 v121, v92, v121
buffer_load_dwordx4 a[120:123], v112, s[24:27], s99 offen offset:2048 sc1
v_xor_b32 v122, v92, v122
v_xor_b32 v123, v92, v123
v_xor_b32 v124, v92, v124
v_xor_b32 v125, v92, v125
v_xor_b32 v126, v92, v126
v_xor_b32 v127, v92, v127
v_xor_b32 v128, v92, v128
v_xor_b32 v129, v92, v129
buffer_load_dwordx4 a[124:127], v112, s[24:27], s99 offen offset:3072 sc1
v_xor_b32 v130, v92, v130
v_xor_b32 v131, v92, v131
v_xor_b32 v132, v92, v132
v_xor_b32 v133, v92, v133
v_xor_b32 v134, v92, v134
v_xor_b32 v135, v92, v135
v_xor_b32 v136, v92, v136
v_xor_b32 v137, v92, v137
v_lshlrev_b32 v114, 16, v110
v_and_b32 v115, 0xffff0000, v110
v_lshlrev_b32 v116, 16, v111
v_and_b32 v117, 0xffff0000, v111
s_mov_b32 exec_hi, 15
ds_write_b128 v109, v[114:117] offset:1024
s_mov_b64 exec, -1
s_mov_b32 s99, 32768
buffer_load_dwordx4 a[128:131], v112, s[24:27], s99 offen offset:0 sc1
s_mov_b32 s41, 2
s_mov_b32 s42, 0
s_mov_b32 s4, 37120
s_mov_b32 s22, 75497472
s_mov_b32 s5, 18560
s_mov_b32 s6, 4718592
s_mov_b64 vcc, s[80:81]
s_andn2_b32 s12, 63, s85
s_mov_b32 s59, 6
s_mov_b32 s56, 0
s_mov_b32 s64, 384
s_bitcmp1_b32 s2, 0
s_cselect_b32 s65, 288, -1
s_add_u32 s48, s46, 9437184
s_add_u32 s49, s48, 4718592
s_add_u32 s50, s49, 4718592
s_sub_u32 s58, s7, s45
s_bfe_u32 s47, s2, 0x20004
s_mul_i32 s57, s47, 294912
s_add_u32 s57, s57, 47185920
s_lshl_b32 s47, s47, 7
s_add_u32 s47, s47, 393216
s_add_u32 s32, s24, s47
s_addc_u32 s33, s25, 0
s_cmp_eq_u32 s40, 0
s_cselect_b32 s34, 4, 0
s_cselect_b64 s[62:63], 1, 0
s_waitcnt lgkmcnt(0)
v_mov_b32 v114, 163072
s_barrier
ds_read_b32 v114, v114
ds_read_b128 v[44:47], v0 offset:0
ds_read_b128 v[48:51], v1 offset:0
s_waitcnt vmcnt(18)
ds_read_b128 v[76:79], v2 offset:1024
ds_read_b128 v[80:83], v2 offset:1088
ds_read_b128 v[84:87], v2 offset:1152
ds_read_b128 v[88:91], v2 offset:1216
ds_read_b128 v[92:95], v2 offset:1280
ds_read_b128 v[96:99], v2 offset:1344
ds_read_b128 v[100:103], v2 offset:1408
ds_read_b128 v[104:107], v2 offset:1472
ds_read_b128 v[108:111], v2 offset:1536
buffer_load_dwordx4 a[132:135], v112, s[24:27], s99 offen offset:1024 sc1
ds_read_b128 v[8:11], v2 offset:1024
ds_read_b128 v[12:15], v2 offset:1088
ds_read_b128 v[16:19], v2 offset:1152
ds_read_b128 v[20:23], v2 offset:1216
ds_read_b128 v[24:27], v2 offset:1280
ds_read_b128 v[28:31], v2 offset:1344
ds_read_b128 v[32:35], v2 offset:1408
ds_read_b128 v[36:39], v2 offset:1472
ds_read_b128 v[40:43], v2 offset:1536
buffer_load_dwordx4 a[136:139], v112, s[24:27], s99 offen offset:2048 sc1
s_waitcnt lgkmcnt(15)
v_readfirstlane_b32 s47, v114
v_add_u32_sdwa v60, s42, v118 dst_sel:DWORD dst_unused:UNUSED_PAD src0_sel:DWORD src1_sel:WORD_0
s_cmp_lg_u32 s47, 0
s_cbranch_scc1 L_slow
v_smfmac_f32_16x16x64_bf16 v[76:79], a[0:3], v[44:51], v138
ds_read_b128 v[52:55], v0 offset:18560
ds_read_b128 v[56:59], v1 offset:18560
v_add_u32_sdwa v68, s42, v118 dst_sel:DWORD dst_unused:UNUSED_PAD src0_sel:DWORD src1_sel:WORD_0
v_smfmac_f32_16x16x64_bf16 v[80:83], a[4:7], v[44:51], v138 abid:1
ds_read_u16 v68, v68 offset:18560
v_add_u32_sdwa v69, s42, v118 dst_sel:DWORD dst_unused:UNUSED_PAD src0_sel:DWORD src1_sel:WORD_1
v_smfmac_f32_16x16x64_bf16 v[84:87], a[8:11], v[44:51], v139
s_waitcnt lgkmcnt(15)
buffer_load_dwordx4 a[140:143], v112, s[24:27], s99 offen offset:3072 sc1
ds_read_u16 v69, v69 offset:18560
v_add_u32_sdwa v70, s42, v119 dst_sel:DWORD dst_unused:UNUSED_PAD src0_sel:DWORD src1_sel:WORD_0
v_smfmac_f32_16x16x64_bf16 v[88:91], a[12:15], v[44:51], v139 abid:1
ds_read_u16 v70, v70 offset:18560
v_add_u32_sdwa v71, s42, v119 dst_sel:DWORD dst_unused:UNUSED_PAD src0_sel:DWORD src1_sel:WORD_1
v_smfmac_f32_16x16x64_bf16 v[92:95], a[16:19], v[44:51], v140
ds_read_u16 v71, v71 offset:18560
v_add_u32_sdwa v72, s42, v120 dst_sel:DWORD dst_unused:UNUSED_PAD src0_sel:DWORD src1_sel:WORD_0
v_smfmac_f32_16x16x64_bf16 v[96:99], a[20:23], v[44:51], v140 abid:1
s_waitcnt lgkmcnt(15)
s_mov_b32 s98, 4096
buffer_load_dwordx4 v[154:157], v113, s[24:27], s98 offen sc1
ds_read_u16 v72, v72 offset:18560
v_add_u32_sdwa v73, s42, v120 dst_sel:DWORD dst_unused:UNUSED_PAD src0_sel:DWORD src1_sel:WORD_1
v_smfmac_f32_16x16x64_bf16 v[100:103], a[24:27], v[44:51], v141
ds_read_u16 v73, v73 offset:18560
v_add_u32_sdwa v74, s42, v121 dst_sel:DWORD dst_unused:UNUSED_PAD src0_sel:DWORD src1_sel:WORD_0
v_smfmac_f32_16x16x64_bf16 v[104:107], a[28:31], v[44:51], v141 abid:1
ds_read_u16 v74, v74 offset:18560
v_add_u32_sdwa v75, s42, v121 dst_sel:DWORD dst_unused:UNUSED_PAD src0_sel:DWORD src1_sel:WORD_1
v_smfmac_f32_16x16x64_bf16 v[108:111], a[32:35], v[44:51], v174
s_waitcnt lgkmcnt(7)
s_mov_b32 s99, 36864
buffer_load_dwordx4 a[144:147], v112, s[24:27], s99 offen offset:0 sc1
ds_read_u16 v75, v75 offset:18560
v_smfmac_f32_16x16x64_bf16 v[8:11], a[0:3], v[52:59], v138
ds_read_b128 v[114:117], v2 offset:64
v_add_u32_sdwa v60, s42, v118 dst_sel:DWORD dst_unused:UNUSED_PAD src0_sel:DWORD src1_sel:WORD_0
v_smfmac_f32_16x16x64_bf16 v[12:15], a[4:7], v[52:59], v138 abid:1
ds_read_b128 v[44:47], v0 offset:2048
v_add_u32_sdwa v61, s42, v118 dst_sel:DWORD dst_unused:UNUSED_PAD src0_sel:DWORD src1_sel:WORD_1
v_smfmac_f32_16x16x64_bf16 v[16:19], a[8:11], v[52:59], v139
buffer_load_dwordx4 a[148:151], v112, s[24:27], s99 offen offset:1024 sc1
ds_read_b128 v[48:51], v1 offset:2048
v_add_u32_sdwa v62, s42, v119 dst_sel:DWORD dst_unused:UNUSED_PAD src0_sel:DWORD src1_sel:WORD_0
v_smfmac_f32_16x16x64_bf16 v[20:23], a[12:15], v[52:59], v139 abid:1
ds_read_u16 v60, v60 offset:0
v_add_u32_sdwa v63, s42, v119 dst_sel:DWORD dst_unused:UNUSED_PAD src0_sel:DWORD src1_sel:WORD_1
v_smfmac_f32_16x16x64_bf16 v[24:27], a[16:19], v[52:59], v140
ds_read_u16 v61, v61 offset:0
v_add_u32_sdwa v64, s42, v120 dst_sel:DWORD dst_unused:UNUSED_PAD src0_sel:DWORD src1_sel:WORD_0
v_smfmac_f32_16x16x64_bf16 v[28:31], a[20:23], v[52:59], v140 abid:1
buffer_load_dwordx4 a[152:155], v112, s[24:27], s99 offen offset:2048 sc1
ds_read_u16 v62, v62 offset:0
v_add_u32_sdwa v65, s42, v120 dst_sel:DWORD dst_unused:UNUSED_PAD src0_sel:DWORD src1_sel:WORD_1
v_smfmac_f32_16x16x64_bf16 v[32:35], a[24:27], v[52:59], v141
ds_read_u16 v63, v63 offset:0
v_add_u32_sdwa v66, s42, v121 dst_sel:DWORD dst_unused:UNUSED_PAD src0_sel:DWORD src1_sel:WORD_0
v_smfmac_f32_16x16x64_bf16 v[36:39], a[28:31], v[52:59], v141 abid:1
ds_read_u16 v64, v64 offset:0
v_add_u32_sdwa v67, s42, v121 dst_sel:DWORD dst_unused:UNUSED_PAD src0_sel:DWORD src1_sel:WORD_1
v_smfmac_f32_16x16x64_bf16 v[40:43], a[32:35], v[52:59], v174
s_waitcnt lgkmcnt(7)
buffer_load_dwordx4 a[156:159], v112, s[24:27], s99 offen offset:3072 sc1
ds_read_u16 v65, v65 offset:0
v_smfmac_f32_16x16x64_bf16 v[8:11], v[114:117], v[68:75], v179
ds_read_u16 v66, v66 offset:0
v_smfmac_f32_16x16x64_bf16 v[12:15], v[114:117], v[68:75], v179 abid:1
s_waitcnt lgkmcnt(7)
ds_read_u16 v67, v67 offset:0
v_smfmac_f32_16x16x64_bf16 v[76:79], a[36:39], v[44:51], v142
s_mov_b32 s99, 40960
buffer_load_dwordx4 a[160:163], v112, s[24:27], s99 offen offset:0 sc1
ds_read_b128 v[52:55], v0 offset:20608
v_add_u32_sdwa v68, s42, v122 dst_sel:DWORD dst_unused:UNUSED_PAD src0_sel:DWORD src1_sel:WORD_0
v_smfmac_f32_16x16x64_bf16 v[80:83], a[40:43], v[44:51], v142 abid:1
ds_read_b128 v[56:59], v1 offset:20608
v_add_u32_sdwa v69, s42, v122 dst_sel:DWORD dst_unused:UNUSED_PAD src0_sel:DWORD src1_sel:WORD_1
v_smfmac_f32_16x16x64_bf16 v[84:87], a[44:47], v[44:51], v143
ds_read_u16 v68, v68 offset:18560
v_add_u32_sdwa v70, s42, v123 dst_sel:DWORD dst_unused:UNUSED_PAD src0_sel:DWORD src1_sel:WORD_0
v_smfmac_f32_16x16x64_bf16 v[88:91], a[48:51], v[44:51], v143 abid:1
buffer_load_dwordx4 a[164:167], v112, s[24:27], s99 offen offset:1024 sc1
ds_read_u16 v69, v69 offset:18560
v_add_u32_sdwa v71, s42, v123 dst_sel:DWORD dst_unused:UNUSED_PAD src0_sel:DWORD src1_sel:WORD_1
v_smfmac_f32_16x16x64_bf16 v[92:95], a[52:55], v[44:51], v144
ds_read_u16 v70, v70 offset:18560
v_add_u32_sdwa v72, s42, v124 dst_sel:DWORD dst_unused:UNUSED_PAD src0_sel:DWORD src1_sel:WORD_0
v_smfmac_f32_16x16x64_bf16 v[96:99], a[56:59], v[44:51], v144 abid:1
ds_read_u16 v71, v71 offset:18560
v_add_u32_sdwa v73, s42, v124 dst_sel:DWORD dst_unused:UNUSED_PAD src0_sel:DWORD src1_sel:WORD_1
v_smfmac_f32_16x16x64_bf16 v[100:103], a[60:63], v[44:51], v145
buffer_load_dwordx4 a[168:171], v112, s[24:27], s99 offen offset:2048 sc1
ds_read_u16 v72, v72 offset:18560
v_add_u32_sdwa v74, s42, v125 dst_sel:DWORD dst_unused:UNUSED_PAD src0_sel:DWORD src1_sel:WORD_0
v_smfmac_f32_16x16x64_bf16 v[104:107], a[64:67], v[44:51], v145 abid:1
s_waitcnt vmcnt(18)
ds_read_u16 v73, v73 offset:18560
v_add_u32_sdwa v75, s42, v125 dst_sel:DWORD dst_unused:UNUSED_PAD src0_sel:DWORD src1_sel:WORD_1
v_smfmac_f32_16x16x64_bf16 v[108:111], a[68:71], v[44:51], v174 abid:1
s_waitcnt lgkmcnt(8)
ds_read_u16 v74, v74 offset:18560
v_smfmac_f32_16x16x64_bf16 v[76:79], v[114:117], v[60:67], v179
buffer_load_dwordx4 a[172:175], v112, s[24:27], s99 offen offset:3072 sc1
ds_read_u16 v75, v75 offset:18560
v_smfmac_f32_16x16x64_bf16 v[80:83], v[114:117], v[60:67], v179 abid:1
s_waitcnt lgkmcnt(8)
v_smfmac_f32_16x16x64_bf16 v[8:11], a[36:39], v[52:59], v142
ds_read_b128 v[114:117], v2 offset:128
v_add_u32_sdwa v60, s42, v122 dst_sel:DWORD dst_unused:UNUSED_PAD src0_sel:DWORD src1_sel:WORD_0
v_smfmac_f32_16x16x64_bf16 v[12:15], a[40:43], v[52:59], v142 abid:1
s_mov_b32 s99, 45056
buffer_load_dwordx4 a[176:179], v112, s[24:27], s99 offen offset:0 sc1
ds_read_b128 v[44:47], v0 offset:4096
v_add_u32_sdwa v61, s42, v122 dst_sel:DWORD dst_unused:UNUSED_PAD src0_sel:DWORD src1_sel:WORD_1
v_smfmac_f32_16x16x64_bf16 v[16:19], a[44:47], v[52:59], v143
ds_read_b128 v[48:51], v1 offset:4096
v_add_u32_sdwa v62, s42, v123 dst_sel:DWORD dst_unused:UNUSED_PAD src0_sel:DWORD src1_sel:WORD_0
v_smfmac_f32_16x16x64_bf16 v[20:23], a[48:51], v[52:59], v143 abid:1
ds_read_u16 v60, v60 offset:0
v_add_u32_sdwa v63, s42, v123 dst_sel:DWORD dst_unused:UNUSED_PAD src0_sel:DWORD src1_sel:WORD_1
v_smfmac_f32_16x16x64_bf16 v[24:27], a[52:55], v[52:59], v144
s_mov_b32 s98, 5120
buffer_load_dwordx4 v[158:161], v113, s[24:27], s98 offen sc1
ds_read_u16 v61, v61 offset:0
v_add_u32_sdwa v64, s42, v124 dst_sel:DWORD dst_unused:UNUSED_PAD src0_sel:DWORD src1_sel:WORD_0
v_smfmac_f32_16x16x64_bf16 v[28:31], a[56:59], v[52:59], v144 abid:1
ds_read_u16 v62, v62 offset:0
v_add_u32_sdwa v65, s42, v124 dst_sel:DWORD dst_unused:UNUSED_PAD src0_sel:DWORD src1_sel:WORD_1
v_smfmac_f32_16x16x64_bf16 v[32:35], a[60:63], v[52:59], v145
ds_read_u16 v63, v63 offset:0
v_add_u32_sdwa v66, s42, v125 dst_sel:DWORD dst_unused:UNUSED_PAD src0_sel:DWORD src1_sel:WORD_0
v_smfmac_f32_16x16x64_bf16 v[36:39], a[64:67], v[52:59], v145 abid:1
buffer_load_dwordx4 a[180:183], v112, s[24:27], s99 offen offset:1024 sc1
ds_read_u16 v64, v64 offset:0
v_add_u32_sdwa v67, s42, v125 dst_sel:DWORD dst_unused:UNUSED_PAD src0_sel:DWORD src1_sel:WORD_1
v_smfmac_f32_16x16x64_bf16 v[40:43], a[68:71], v[52:59], v174 abid:1
s_waitcnt lgkmcnt(7)
ds_read_u16 v65, v65 offset:0
v_smfmac_f32_16x16x64_bf16 v[12:15], v[114:117], v[68:75], v180
ds_read_u16 v66, v66 offset:0
v_smfmac_f32_16x16x64_bf16 v[16:19], v[114:117], v[68:75], v180 abid:1
buffer_load_dwordx4 a[184:187], v112, s[24:27], s99 offen offset:2048 sc1
ds_read_u16 v67, v67 offset:0
v_smfmac_f32_16x16x64_bf16 v[20:23], v[114:117], v[68:75], v181
s_waitcnt lgkmcnt(8)
v_smfmac_f32_16x16x64_bf16 v[76:79], a[72:75], v[44:51], v146
ds_read_b128 v[52:55], v0 offset:22656
v_add_u32_sdwa v68, s42, v126 dst_sel:DWORD dst_unused:UNUSED_PAD src0_sel:DWORD src1_sel:WORD_0
v_smfmac_f32_16x16x64_bf16 v[80:83], a[76:79], v[44:51], v146 abid:1
buffer_load_dwordx4 a[188:191], v112, s[24:27], s99 offen offset:3072 sc1
ds_read_b128 v[56:59], v1 offset:22656
v_add_u32_sdwa v69, s42, v126 dst_sel:DWORD dst_unused:UNUSED_PAD src0_sel:DWORD src1_sel:WORD_1
v_smfmac_f32_16x16x64_bf16 v[84:87], a[80:83], v[44:51], v147
ds_read_u16 v68, v68 offset:18560
v_add_u32_sdwa v70, s42, v127 dst_sel:DWORD dst_unused:UNUSED_PAD src0_sel:DWORD src1_sel:WORD_0
v_smfmac_f32_16x16x64_bf16 v[88:91], a[84:87], v[44:51], v147 abid:1
ds_read_u16 v69, v69 offset:18560
v_add_u32_sdwa v71, s42, v127 dst_sel:DWORD dst_unused:UNUSED_PAD src0_sel:DWORD src1_sel:WORD_1
v_smfmac_f32_16x16x64_bf16 v[92:95], a[88:91], v[44:51], v148
s_mov_b32 s99, 49152
buffer_load_dwordx4 a[192:195], v112, s[24:27], s99 offen offset:0 sc1
ds_read_u16 v70, v70 offset:18560
v_add_u32_sdwa v72, s42, v128 dst_sel:DWORD dst_unused:UNUSED_PAD src0_sel:DWORD src1_sel:WORD_0
v_smfmac_f32_16x16x64_bf16 v[96:99], a[92:95], v[44:51], v148 abid:1
ds_read_u16 v71, v71 offset:18560
v_add_u32_sdwa v73, s42, v128 dst_sel:DWORD dst_unused:UNUSED_PAD src0_sel:DWORD src1_sel:WORD_1
v_smfmac_f32_16x16x64_bf16 v[100:103], a[96:99], v[44:51], v149
ds_read_u16 v72, v72 offset:18560
v_add_u32_sdwa v74, s42, v129 dst_sel:DWORD dst_unused:UNUSED_PAD src0_sel:DWORD src1_sel:WORD_0
v_smfmac_f32_16x16x64_bf16 v[104:107], a[100:103], v[44:51], v149 abid:1
buffer_load_dwordx4 a[196:199], v112, s[24:27], s99 offen offset:1024 sc1
ds_read_u16 v73, v73 offset:18560
v_add_u32_sdwa v75, s42, v129 dst_sel:DWORD dst_unused:UNUSED_PAD src0_sel:DWORD src1_sel:WORD_1
v_smfmac_f32_16x16x64_bf16 v[108:111], a[104:107], v[44:51], v175
s_waitcnt lgkmcnt(8)
ds_read_u16 v74, v74 offset:18560
v_smfmac_f32_16x16x64_bf16 v[80:83], v[114:117], v[60:67], v180
ds_read_u16 v75, v75 offset:18560
v_smfmac_f32_16x16x64_bf16 v[84:87], v[114:117], v[60:67], v180 abid:1
buffer_load_dwordx4 a[200:203], v112, s[24:27], s99 offen offset:2048 sc1
v_smfmac_f32_16x16x64_bf16 v[88:91], v[114:117], v[60:67], v181
s_waitcnt lgkmcnt(8)
v_smfmac_f32_16x16x64_bf16 v[8:11], a[72:75], v[52:59], v146
ds_read_b128 v[114:117], v2 offset:192
v_add_u32_sdwa v60, s42, v126 dst_sel:DWORD dst_unused:UNUSED_PAD src0_sel:DWORD src1_sel:WORD_0
v_smfmac_f32_16x16x64_bf16 v[12:15], a[76:79], v[52:59], v146 abid:1
buffer_load_dwordx4 a[204:207], v112, s[24:27], s99 offen offset:3072 sc1
ds_read_b128 v[44:47], v0 offset:6144
v_add_u32_sdwa v61, s42, v126 dst_sel:DWORD dst_unused:UNUSED_PAD src0_sel:DWORD src1_sel:WORD_1
v_smfmac_f32_16x16x64_bf16 v[16:19], a[80:83], v[52:59], v147
ds_read_b128 v[48:51], v1 offset:6144
v_add_u32_sdwa v62, s42, v127 dst_sel:DWORD dst_unused:UNUSED_PAD src0_sel:DWORD src1_sel:WORD_0
v_smfmac_f32_16x16x64_bf16 v[20:23], a[84:87], v[52:59], v147 abid:1
ds_read_u16 v60, v60 offset:0
v_add_u32_sdwa v63, s42, v127 dst_sel:DWORD dst_unused:UNUSED_PAD src0_sel:DWORD src1_sel:WORD_1
v_smfmac_f32_16x16x64_bf16 v[24:27], a[88:91], v[52:59], v148
s_mov_b32 s99, 53248
buffer_load_dwordx4 a[208:211], v112, s[24:27], s99 offen offset:0 sc1
ds_read_u16 v61, v61 offset:0
v_add_u32_sdwa v64, s42, v128 dst_sel:DWORD dst_unused:UNUSED_PAD src0_sel:DWORD src1_sel:WORD_0
v_smfmac_f32_16x16x64_bf16 v[28:31], a[92:95], v[52:59], v148 abid:1
ds_read_u16 v62, v62 offset:0
v_add_u32_sdwa v65, s42, v128 dst_sel:DWORD dst_unused:UNUSED_PAD src0_sel:DWORD src1_sel:WORD_1
v_smfmac_f32_16x16x64_bf16 v[32:35], a[96:99], v[52:59], v149
ds_read_u16 v63, v63 offset:0
v_add_u32_sdwa v66, s42, v129 dst_sel:DWORD dst_unused:UNUSED_PAD src0_sel:DWORD src1_sel:WORD_0
v_smfmac_f32_16x16x64_bf16 v[36:39], a[100:103], v[52:59], v149 abid:1
buffer_load_dwordx4 a[212:215], v112, s[24:27], s99 offen offset:1024 sc1
ds_read_u16 v64, v64 offset:0
v_add_u32_sdwa v67, s42, v129 dst_sel:DWORD dst_unused:UNUSED_PAD src0_sel:DWORD src1_sel:WORD_1
v_smfmac_f32_16x16x64_bf16 v[40:43], a[104:107], v[52:59], v175
s_waitcnt lgkmcnt(7)
ds_read_u16 v65, v65 offset:0
v_smfmac_f32_16x16x64_bf16 v[20:23], v[114:117], v[68:75], v181 abid:1
ds_read_u16 v66, v66 offset:0
v_smfmac_f32_16x16x64_bf16 v[24:27], v[114:117], v[68:75], v182
s_mov_b32 s98, 6144
buffer_load_dwordx4 v[162:165], v113, s[24:27], s98 offen sc1
ds_read_u16 v67, v67 offset:0
v_smfmac_f32_16x16x64_bf16 v[28:31], v[114:117], v[68:75], v182 abid:1
s_waitcnt vmcnt(18) lgkmcnt(8)
v_smfmac_f32_16x16x64_bf16 v[76:79], a[108:111], v[44:51], v150
ds_read_b128 v[52:55], v0 offset:24704
v_add_u32_sdwa v68, s42, v130 dst_sel:DWORD dst_unused:UNUSED_PAD src0_sel:DWORD src1_sel:WORD_0
v_smfmac_f32_16x16x64_bf16 v[80:83], a[112:115], v[44:51], v150 abid:1
buffer_load_dwordx4 a[216:219], v112, s[24:27], s99 offen offset:2048 sc1
ds_read_b128 v[56:59], v1 offset:24704
v_add_u32_sdwa v69, s42, v130 dst_sel:DWORD dst_unused:UNUSED_PAD src0_sel:DWORD src1_sel:WORD_1
v_smfmac_f32_16x16x64_bf16 v[84:87], a[116:119], v[44:51], v151
ds_read_u16 v68, v68 offset:18560
v_add_u32_sdwa v70, s42, v131 dst_sel:DWORD dst_unused:UNUSED_PAD src0_sel:DWORD src1_sel:WORD_0
v_smfmac_f32_16x16x64_bf16 v[88:91], a[120:123], v[44:51], v151 abid:1
ds_read_u16 v69, v69 offset:18560
v_add_u32_sdwa v71, s42, v131 dst_sel:DWORD dst_unused:UNUSED_PAD src0_sel:DWORD src1_sel:WORD_1
v_smfmac_f32_16x16x64_bf16 v[92:95], a[124:127], v[44:51], v152
buffer_load_dwordx4 a[220:223], v112, s[24:27], s99 offen offset:3072 sc1
ds_read_u16 v70, v70 offset:18560
v_add_u32_sdwa v72, s42, v132 dst_sel:DWORD dst_unused:UNUSED_PAD src0_sel:DWORD src1_sel:WORD_0
v_smfmac_f32_16x16x64_bf16 v[96:99], a[128:131], v[44:51], v152 abid:1
ds_read_u16 v71, v71 offset:18560
v_add_u32_sdwa v73, s42, v132 dst_sel:DWORD dst_unused:UNUSED_PAD src0_sel:DWORD src1_sel:WORD_1
v_smfmac_f32_16x16x64_bf16 v[100:103], a[132:135], v[44:51], v153
ds_read_u16 v72, v72 offset:18560
v_add_u32_sdwa v74, s42, v133 dst_sel:DWORD dst_unused:UNUSED_PAD src0_sel:DWORD src1_sel:WORD_0
v_smfmac_f32_16x16x64_bf16 v[104:107], a[136:139], v[44:51], v153 abid:1
s_mov_b32 s99, 57344
buffer_load_dwordx4 a[224:227], v112, s[24:27], s99 offen offset:0 sc1
ds_read_u16 v73, v73 offset:18560
v_add_u32_sdwa v75, s42, v133 dst_sel:DWORD dst_unused:UNUSED_PAD src0_sel:DWORD src1_sel:WORD_1
v_smfmac_f32_16x16x64_bf16 v[108:111], a[140:143], v[44:51], v175 abid:1
s_waitcnt lgkmcnt(8)
ds_read_u16 v74, v74 offset:18560
v_smfmac_f32_16x16x64_bf16 v[88:91], v[114:117], v[60:67], v181 abid:1
buffer_load_dwordx4 a[228:231], v112, s[24:27], s99 offen offset:1024 sc1
ds_read_u16 v75, v75 offset:18560
v_smfmac_f32_16x16x64_bf16 v[92:95], v[114:117], v[60:67], v182
v_smfmac_f32_16x16x64_bf16 v[96:99], v[114:117], v[60:67], v182 abid:1
s_waitcnt lgkmcnt(8)
v_smfmac_f32_16x16x64_bf16 v[8:11], a[108:111], v[52:59], v150
buffer_load_dwordx4 a[232:235], v112, s[24:27], s99 offen offset:2048 sc1
ds_read_b128 v[114:117], v2 offset:256
v_add_u32_sdwa v60, s42, v130 dst_sel:DWORD dst_unused:UNUSED_PAD src0_sel:DWORD src1_sel:WORD_0
v_smfmac_f32_16x16x64_bf16 v[12:15], a[112:115], v[52:59], v150 abid:1
ds_read_b128 v[44:47], v0 offset:8192
v_add_u32_sdwa v61, s42, v130 dst_sel:DWORD dst_unused:UNUSED_PAD src0_sel:DWORD src1_sel:WORD_1
v_smfmac_f32_16x16x64_bf16 v[16:19], a[116:119], v[52:59], v151
ds_read_b128 v[48:51], v1 offset:8192
v_add_u32_sdwa v62, s42, v131 dst_sel:DWORD dst_unused:UNUSED_PAD src0_sel:DWORD src1_sel:WORD_0
v_smfmac_f32_16x16x64_bf16 v[20:23], a[120:123], v[52:59], v151 abid:1
buffer_load_dwordx4 a[236:239], v112, s[24:27], s99 offen offset:3072 sc1
ds_read_u16 v60, v60 offset:0
v_add_u32_sdwa v63, s42, v131 dst_sel:DWORD dst_unused:UNUSED_PAD src0_sel:DWORD src1_sel:WORD_1
v_smfmac_f32_16x16x64_bf16 v[24:27], a[124:127], v[52:59], v152
ds_read_u16 v61, v61 offset:0
v_add_u32_sdwa v64, s42, v132 dst_sel:DWORD dst_unused:UNUSED_PAD src0_sel:DWORD src1_sel:WORD_0
v_smfmac_f32_16x16x64_bf16 v[28:31], a[128:131], v[52:59], v152 abid:1
ds_read_u16 v62, v62 offset:0
v_add_u32_sdwa v65, s42, v132 dst_sel:DWORD dst_unused:UNUSED_PAD src0_sel:DWORD src1_sel:WORD_1
v_smfmac_f32_16x16x64_bf16 v[32:35], a[132:135], v[52:59], v153
s_mov_b32 s99, 61440
buffer_load_dwordx4 a[240:243], v112, s[24:27], s99 offen offset:0 sc1
ds_read_u16 v63, v63 offset:0
v_add_u32_sdwa v66, s42, v133 dst_sel:DWORD dst_unused:UNUSED_PAD src0_sel:DWORD src1_sel:WORD_0
v_smfmac_f32_16x16x64_bf16 v[36:39], a[136:139], v[52:59], v153 abid:1
ds_read_u16 v64, v64 offset:0
v_add_u32_sdwa v67, s42, v133 dst_sel:DWORD dst_unused:UNUSED_PAD src0_sel:DWORD src1_sel:WORD_1
v_smfmac_f32_16x16x64_bf16 v[40:43], a[140:143], v[52:59], v175 abid:1
s_waitcnt lgkmcnt(7)
ds_read_u16 v65, v65 offset:0
v_smfmac_f32_16x16x64_bf16 v[28:31], v[114:117], v[68:75], v183
buffer_load_dwordx4 a[244:247], v112, s[24:27], s99 offen offset:1024 sc1
ds_read_u16 v66, v66 offset:0
v_smfmac_f32_16x16x64_bf16 v[32:35], v[114:117], v[68:75], v183 abid:1
ds_read_u16 v67, v67 offset:0
v_smfmac_f32_16x16x64_bf16 v[36:39], v[114:117], v[68:75], v184
s_waitcnt lgkmcnt(8)
v_smfmac_f32_16x16x64_bf16 v[76:79], a[144:147], v[44:51], v154
buffer_load_dwordx4 a[248:251], v112, s[24:27], s99 offen offset:2048 sc1
ds_read_b128 v[52:55], v0 offset:26752
v_add_u32_sdwa v68, s42, v134 dst_sel:DWORD dst_unused:UNUSED_PAD src0_sel:DWORD src1_sel:WORD_0
v_smfmac_f32_16x16x64_bf16 v[80:83], a[148:151], v[44:51], v154 abid:1
s_waitcnt vmcnt(18)
ds_read_b128 v[56:59], v1 offset:26752
v_add_u32_sdwa v69, s42, v134 dst_sel:DWORD dst_unused:UNUSED_PAD src0_sel:DWORD src1_sel:WORD_1
v_smfmac_f32_16x16x64_bf16 v[84:87], a[152:155], v[44:51], v155
ds_read_u16 v68, v68 offset:18560
v_add_u32_sdwa v70, s42, v135 dst_sel:DWORD dst_unused:UNUSED_PAD src0_sel:DWORD src1_sel:WORD_0
v_smfmac_f32_16x16x64_bf16 v[88:91], a[156:159], v[44:51], v155 abid:1
s_mov_b32 s98, 7168
buffer_load_dwordx4 v[166:169], v113, s[24:27], s98 offen sc1
ds_read_u16 v69, v69 offset:18560
v_add_u32_sdwa v71, s42, v135 dst_sel:DWORD dst_unused:UNUSED_PAD src0_sel:DWORD src1_sel:WORD_1
v_smfmac_f32_16x16x64_bf16 v[92:95], a[160:163], v[44:51], v156
ds_read_u16 v70, v70 offset:18560
v_add_u32_sdwa v72, s42, v136 dst_sel:DWORD dst_unused:UNUSED_PAD src0_sel:DWORD src1_sel:WORD_0
v_smfmac_f32_16x16x64_bf16 v[96:99], a[164:167], v[44:51], v156 abid:1
ds_read_u16 v71, v71 offset:18560
v_add_u32_sdwa v73, s42, v136 dst_sel:DWORD dst_unused:UNUSED_PAD src0_sel:DWORD src1_sel:WORD_1
v_smfmac_f32_16x16x64_bf16 v[100:103], a[168:171], v[44:51], v157
s_mov_b32 s98, 8192
buffer_load_dwordx4 v[170:173], v113, s[24:27], s98 offen sc1
ds_read_u16 v72, v72 offset:18560
v_add_u32_sdwa v74, s42, v137 dst_sel:DWORD dst_unused:UNUSED_PAD src0_sel:DWORD src1_sel:WORD_0
v_smfmac_f32_16x16x64_bf16 v[104:107], a[172:175], v[44:51], v157 abid:1
ds_read_u16 v73, v73 offset:18560
v_add_u32_sdwa v75, s42, v137 dst_sel:DWORD dst_unused:UNUSED_PAD src0_sel:DWORD src1_sel:WORD_1
v_smfmac_f32_16x16x64_bf16 v[108:111], a[176:179], v[44:51], v176
s_waitcnt lgkmcnt(8)
ds_read_u16 v74, v74 offset:18560
v_smfmac_f32_16x16x64_bf16 v[96:99], v[114:117], v[60:67], v183
s_mov_b32 s99, 69632
buffer_load_dwordx4 v[214:217], v112, s[24:27], s99 offen offset:3072 sc1
ds_read_u16 v75, v75 offset:18560
v_smfmac_f32_16x16x64_bf16 v[100:103], v[114:117], v[60:67], v183 abid:1
v_smfmac_f32_16x16x64_bf16 v[104:107], v[114:117], v[60:67], v184
s_waitcnt lgkmcnt(8)
v_smfmac_f32_16x16x64_bf16 v[8:11], a[144:147], v[52:59], v154
s_mov_b32 s99, 81920
buffer_load_dwordx4 v[250:253], v112, s[24:27], s99 offen offset:0 sc1
ds_read_b128 v[114:117], v2 offset:320
v_add_u32_sdwa v60, s42, v134 dst_sel:DWORD dst_unused:UNUSED_PAD src0_sel:DWORD src1_sel:WORD_0
v_smfmac_f32_16x16x64_bf16 v[12:15], a[148:151], v[52:59], v154 abid:1
ds_read_b128 v[44:47], v0 offset:10240
v_add_u32_sdwa v61, s42, v134 dst_sel:DWORD dst_unused:UNUSED_PAD src0_sel:DWORD src1_sel:WORD_1
v_smfmac_f32_16x16x64_bf16 v[16:19], a[152:155], v[52:59], v155
ds_read_b128 v[48:51], v1 offset:10240
v_add_u32_sdwa v62, s42, v135 dst_sel:DWORD dst_unused:UNUSED_PAD src0_sel:DWORD src1_sel:WORD_0
v_smfmac_f32_16x16x64_bf16 v[20:23], a[156:159], v[52:59], v155 abid:1
s_mov_b32 s99, 61440
buffer_load_dwordx4 a[252:255], v112, s[24:27], s99 offen offset:3072 sc1
ds_read_u16 v60, v60 offset:0
v_add_u32_sdwa v63, s42, v135 dst_sel:DWORD dst_unused:UNUSED_PAD src0_sel:DWORD src1_sel:WORD_1
v_smfmac_f32_16x16x64_bf16 v[24:27], a[160:163], v[52:59], v156
ds_read_u16 v61, v61 offset:0
v_add_u32_sdwa v64, s42, v136 dst_sel:DWORD dst_unused:UNUSED_PAD src0_sel:DWORD src1_sel:WORD_0
v_smfmac_f32_16x16x64_bf16 v[28:31], a[164:167], v[52:59], v156 abid:1
ds_read_u16 v62, v62 offset:0
v_add_u32_sdwa v65, s42, v136 dst_sel:DWORD dst_unused:UNUSED_PAD src0_sel:DWORD src1_sel:WORD_1
v_smfmac_f32_16x16x64_bf16 v[32:35], a[168:171], v[52:59], v157
s_mov_b32 s99, 73728
buffer_load_dwordx4 v[218:221], v112, s[24:27], s99 offen offset:0 sc1
ds_read_u16 v63, v63 offset:0
v_add_u32_sdwa v66, s42, v137 dst_sel:DWORD dst_unused:UNUSED_PAD src0_sel:DWORD src1_sel:WORD_0
v_smfmac_f32_16x16x64_bf16 v[36:39], a[172:175], v[52:59], v157 abid:1
ds_read_u16 v64, v64 offset:0
v_add_u32_sdwa v67, s42, v137 dst_sel:DWORD dst_unused:UNUSED_PAD src0_sel:DWORD src1_sel:WORD_1
v_smfmac_f32_16x16x64_bf16 v[40:43], a[176:179], v[52:59], v176
s_waitcnt lgkmcnt(7)
ds_read_u16 v65, v65 offset:0
v_smfmac_f32_16x16x64_bf16 v[36:39], v[114:117], v[68:75], v184 abid:1
s_mov_b32 s99, 65536
buffer_load_dwordx4 v[186:189], v112, s[24:27], s99 offen offset:0 sc1
ds_read_u16 v66, v66 offset:0
v_smfmac_f32_16x16x64_bf16 v[40:43], v[114:117], v[68:75], v185
s_waitcnt lgkmcnt(7)
ds_read_u16 v67, v67 offset:0
v_smfmac_f32_16x16x64_bf16 v[76:79], a[180:183], v[44:51], v158
s_waitcnt vmcnt(18)
ds_read_b128 v[52:55], v0 offset:28800
v_smfmac_f32_16x16x64_bf16 v[80:83], a[184:187], v[44:51], v158 abid:1
s_mov_b32 s99, 73728
buffer_load_dwordx4 v[222:225], v112, s[24:27], s99 offen offset:1024 sc1
ds_read_b128 v[56:59], v1 offset:28800
v_smfmac_f32_16x16x64_bf16 v[84:87], a[188:191], v[44:51], v159
ds_read_b128 v[68:71], v0 offset:34944
v_smfmac_f32_16x16x64_bf16 v[88:91], a[192:195], v[44:51], v159 abid:1
ds_read_b128 v[72:75], v1 offset:34944
v_smfmac_f32_16x16x64_bf16 v[92:95], a[196:199], v[44:51], v160
s_mov_b32 s99, 65536
buffer_load_dwordx4 v[190:193], v112, s[24:27], s99 offen offset:1024 sc1
v_smfmac_f32_16x16x64_bf16 v[96:99], a[200:203], v[44:51], v160 abid:1
v_smfmac_f32_16x16x64_bf16 v[100:103], a[204:207], v[44:51], v161
v_smfmac_f32_16x16x64_bf16 v[104:107], a[208:211], v[44:51], v161 abid:1
s_waitcnt vmcnt(18)
s_mov_b32 s99, 73728
buffer_load_dwordx4 v[226:229], v112, s[24:27], s99 offen offset:2048 sc1
v_smfmac_f32_16x16x64_bf16 v[108:111], a[212:215], v[44:51], v176 abid:1
s_waitcnt lgkmcnt(4)
v_smfmac_f32_16x16x64_bf16 v[104:107], v[114:117], v[60:67], v184 abid:1
v_smfmac_f32_16x16x64_bf16 v[108:111], v[114:117], v[60:67], v185
s_waitcnt lgkmcnt(2)
s_mov_b32 s99, 65536
buffer_load_dwordx4 v[194:197], v112, s[24:27], s99 offen offset:2048 sc1
v_smfmac_f32_16x16x64_bf16 v[8:11], a[180:183], v[52:59], v158
ds_read_b128 v[44:47], v0 offset:12288
v_smfmac_f32_16x16x64_bf16 v[12:15], a[184:187], v[52:59], v158 abid:1
ds_read_b128 v[48:51], v1 offset:12288
v_smfmac_f32_16x16x64_bf16 v[16:19], a[188:191], v[52:59], v159
s_mov_b32 s99, 73728
buffer_load_dwordx4 v[230:233], v112, s[24:27], s99 offen offset:3072 sc1
ds_read_b128 v[60:63], v0 offset:32896
v_smfmac_f32_16x16x64_bf16 v[20:23], a[192:195], v[52:59], v159 abid:1
ds_read_b128 v[64:67], v1 offset:32896
v_smfmac_f32_16x16x64_bf16 v[24:27], a[196:199], v[52:59], v160
v_smfmac_f32_16x16x64_bf16 v[28:31], a[200:203], v[52:59], v160 abid:1
s_mov_b32 s99, 65536
buffer_load_dwordx4 v[198:201], v112, s[24:27], s99 offen offset:3072 sc1
v_smfmac_f32_16x16x64_bf16 v[32:35], a[204:207], v[52:59], v161
v_smfmac_f32_16x16x64_bf16 v[36:39], a[208:211], v[52:59], v161 abid:1
v_smfmac_f32_16x16x64_bf16 v[40:43], a[212:215], v[52:59], v176 abid:1
s_waitcnt vmcnt(18) lgkmcnt(2)
s_mov_b32 s99, 77824
buffer_load_dwordx4 v[234:237], v112, s[24:27], s99 offen offset:0 sc1
v_smfmac_f32_16x16x64_bf16 v[76:79], a[216:219], v[44:51], v162
ds_read_b128 v[52:55], v0 offset:30848
v_smfmac_f32_16x16x64_bf16 v[80:83], a[220:223], v[44:51], v162 abid:1
ds_read_b128 v[56:59], v1 offset:30848
v_smfmac_f32_16x16x64_bf16 v[84:87], a[224:227], v[44:51], v163
s_mov_b32 s99, 69632
buffer_load_dwordx4 v[202:205], v112, s[24:27], s99 offen offset:0 sc1
v_smfmac_f32_16x16x64_bf16 v[88:91], a[228:231], v[44:51], v163 abid:1
s_waitcnt vmcnt(18)
v_smfmac_f32_16x16x64_bf16 v[92:95], a[232:235], v[44:51], v164
v_smfmac_f32_16x16x64_bf16 v[96:99], a[236:239], v[44:51], v164 abid:1
s_waitcnt vmcnt(17)
s_mov_b32 s99, 77824
buffer_load_dwordx4 v[238:241], v112, s[24:27], s99 offen offset:1024 sc1
v_smfmac_f32_16x16x64_bf16 v[100:103], a[240:243], v[44:51], v165
s_waitcnt vmcnt(17)
v_smfmac_f32_16x16x64_bf16 v[104:107], a[244:247], v[44:51], v165 abid:1
s_waitcnt vmcnt(16)
v_smfmac_f32_16x16x64_bf16 v[108:111], a[248:251], v[44:51], v177
s_waitcnt lgkmcnt(0)
s_mov_b32 s99, 69632
buffer_load_dwordx4 v[206:209], v112, s[24:27], s99 offen offset:1024 sc1
v_smfmac_f32_16x16x64_bf16 v[8:11], a[216:219], v[52:59], v162
ds_read_b128 v[44:47], v0 offset:14336
v_smfmac_f32_16x16x64_bf16 v[12:15], a[220:223], v[52:59], v162 abid:1
ds_read_b128 v[48:51], v1 offset:14336
v_smfmac_f32_16x16x64_bf16 v[16:19], a[224:227], v[52:59], v163
s_mov_b32 s99, 77824
buffer_load_dwordx4 v[242:245], v112, s[24:27], s99 offen offset:2048 sc1
v_smfmac_f32_16x16x64_bf16 v[20:23], a[228:231], v[52:59], v163 abid:1
v_smfmac_f32_16x16x64_bf16 v[24:27], a[232:235], v[52:59], v164
v_smfmac_f32_16x16x64_bf16 v[28:31], a[236:239], v[52:59], v164 abid:1
s_mov_b32 s99, 69632
buffer_load_dwordx4 v[210:213], v112, s[24:27], s99 offen offset:2048 sc1
v_smfmac_f32_16x16x64_bf16 v[32:35], a[240:243], v[52:59], v165
v_smfmac_f32_16x16x64_bf16 v[36:39], a[244:247], v[52:59], v165 abid:1
v_smfmac_f32_16x16x64_bf16 v[40:43], a[248:251], v[52:59], v177
s_mov_b32 s99, 77824
buffer_load_dwordx4 v[246:249], v112, s[24:27], s99 offen offset:3072 sc1
s_bfe_u32 s47, s85, 0x40018
s_cbranch_scc0 L_ptail0
ds_read_b128 v[52:55], v0 offset:16384
ds_read_b128 v[56:59], v1 offset:16384
s_waitcnt vmcnt(17) lgkmcnt(2)
v_smfmac_f32_16x16x64_bf16 v[108:111], v[214:217], v[44:51], v177 abid:1
s_add_u32 m0, s44, 0
s_nop 0
buffer_load_dwordx4 v3, s[16:19], s45 offen offset:0 nt lds
s_waitcnt vmcnt(17) lgkmcnt(0)
v_smfmac_f32_16x16x64_bf16 v[108:111], v[250:253], v[52:59], v178
s_add_u32 m0, s44, 3840
s_nop 0
buffer_load_dwordx4 v3, s[16:19], s45 offen offset:256 nt lds
v_add_u32 v0, 37120, v0
v_add_u32 v1, 37120, v1
s_waitcnt vmcnt(17)
v_smfmac_f32_16x16x64_bf16 v[76:79], a[252:255], v[44:51], v166
s_add_u32 m0, s44, 7680
s_nop 0
buffer_load_dwordx4 v3, s[16:19], s45 offen offset:512 nt lds
s_waitcnt vmcnt(17)
v_smfmac_f32_16x16x64_bf16 v[76:79], v[218:221], v[52:59], v170
v_cvt_pk_bf16_f32 v108, v108, v109
v_cvt_pk_bf16_f32 v109, v110, v111
ds_bpermute_b32 v108, v6, v108
ds_bpermute_b32 v109, v6, v109
s_waitcnt vmcnt(16)
v_smfmac_f32_16x16x64_bf16 v[80:83], v[186:189], v[44:51], v166 abid:1
s_add_u32 m0, s44, 11520
s_nop 0
buffer_load_dwordx4 v3, s[16:19], s45 offen offset:768 nt lds
s_waitcnt vmcnt(16)
v_smfmac_f32_16x16x64_bf16 v[80:83], v[222:225], v[52:59], v170 abid:1
s_add_u32 m0, s44, s8
s_mov_b64 exec, s[10:11]
buffer_load_dwordx4 v3, s[16:19], s7 offen offset:896 nt lds
s_mov_b64 exec, -1
s_add_u32 s7, s7, 4718592
s_add_u32 s44, s44, 18560
s_add_u32 s45, s45, 4718592
v_cvt_pk_bf16_f32 v76, v76, v77
v_cvt_pk_bf16_f32 v77, v78, v79
s_waitcnt vmcnt(16)
v_smfmac_f32_16x16x64_bf16 v[84:87], v[190:193], v[44:51], v167
s_waitcnt vmcnt(15)
v_smfmac_f32_16x16x64_bf16 v[84:87], v[226:229], v[52:59], v171
s_add_u32 m0, s44, 0
s_nop 0
buffer_load_dwordx4 v3, s[16:19], s45 offen offset:0 nt lds
v_cvt_pk_bf16_f32 v78, v80, v81
v_cvt_pk_bf16_f32 v79, v82, v83
s_waitcnt lgkmcnt(0)
buffer_store_dwordx2 v[108:109], v5, s[20:23], s46 offen nt
s_waitcnt vmcnt(16)
v_smfmac_f32_16x16x64_bf16 v[88:91], v[194:197], v[44:51], v167 abid:1
s_add_u32 m0, s44, 3840
s_nop 0
buffer_load_dwordx4 v3, s[16:19], s45 offen offset:256 nt lds
s_waitcnt vmcnt(16)
v_smfmac_f32_16x16x64_bf16 v[88:91], v[230:233], v[52:59], v171 abid:1
s_add_u32 m0, s44, 7680
s_nop 0
buffer_load_dwordx4 v3, s[16:19], s45 offen offset:512 nt lds
v_cvt_pk_bf16_f32 v80, v84, v85
v_cvt_pk_bf16_f32 v81, v86, v87
s_waitcnt vmcnt(16)
v_smfmac_f32_16x16x64_bf16 v[92:95], v[198:201], v[44:51], v168
s_waitcnt vmcnt(15)
v_smfmac_f32_16x16x64_bf16 v[92:95], v[234:237], v[52:59], v172
s_add_u32 m0, s44, 11520
s_nop 0
buffer_load_dwordx4 v3, s[16:19], s45 offen offset:768 nt lds
v_cvt_pk_bf16_f32 v82, v88, v89
v_cvt_pk_bf16_f32 v83, v90, v91
v_cndmask_b32_dpp v114, v80, v76, vcc quad_perm:[1,0,3,2] row_mask:0xf bank_mask:0xf
v_cndmask_b32_dpp v115, v81, v77, vcc quad_perm:[1,0,3,2] row_mask:0xf bank_mask:0xf
v_cndmask_b32_dpp v116, v82, v78, vcc quad_perm:[1,0,3,2] row_mask:0xf bank_mask:0xf
v_cndmask_b32_dpp v117, v83, v79, vcc quad_perm:[1,0,3,2] row_mask:0xf bank_mask:0xf
buffer_store_dwordx4 v[114:117], v4, s[20:23], s46 offen offset:0 sc1
s_mov_b64 vcc, s[82:83]
s_waitcnt vmcnt(16)
v_smfmac_f32_16x16x64_bf16 v[96:99], v[202:205], v[44:51], v168 abid:1
s_add_u32 m0, s44, s8
s_mov_b64 exec, s[10:11]
buffer_load_dwordx4 v3, s[16:19], s7 offen offset:896 nt lds
s_mov_b64 exec, -1
s_add_u32 s7, s7, 4718592
s_add_u32 s44, s44, 18560
s_add_u32 s45, s45, 4718592
s_waitcnt vmcnt(16)
v_smfmac_f32_16x16x64_bf16 v[96:99], v[238:241], v[52:59], v172 abid:1
v_cvt_pk_bf16_f32 v84, v92, v93
v_cvt_pk_bf16_f32 v85, v94, v95
v_cndmask_b32_dpp v80, v76, v80, vcc quad_perm:[1,0,3,2] row_mask:0xf bank_mask:0xf
v_cndmask_b32_dpp v81, v77, v81, vcc quad_perm:[1,0,3,2] row_mask:0xf bank_mask:0xf
v_cndmask_b32_dpp v82, v78, v82, vcc quad_perm:[1,0,3,2] row_mask:0xf bank_mask:0xf
v_cndmask_b32_dpp v83, v79, v83, vcc quad_perm:[1,0,3,2] row_mask:0xf bank_mask:0xf
buffer_store_dwordx4 v[80:83], v4, s[20:23], s46 offen offset:1152 sc1
s_mov_b64 vcc, s[80:81]
s_waitcnt vmcnt(16)
v_smfmac_f32_16x16x64_bf16 v[100:103], v[206:209], v[44:51], v169
s_waitcnt vmcnt(15)
v_smfmac_f32_16x16x64_bf16 v[100:103], v[242:245], v[52:59], v173
v_cvt_pk_bf16_f32 v86, v96, v97
v_cvt_pk_bf16_f32 v87, v98, v99
v_add_u32_sdwa v76, s4, v118 dst_sel:DWORD dst_unused:UNUSED_PAD src0_sel:DWORD src1_sel:WORD_0
v_add_u32_sdwa v77, s4, v118 dst_sel:DWORD dst_unused:UNUSED_PAD src0_sel:DWORD src1_sel:WORD_1
v_add_u32_sdwa v78, s4, v119 dst_sel:DWORD dst_unused:UNUSED_PAD src0_sel:DWORD src1_sel:WORD_0
v_add_u32_sdwa v79, s4, v119 dst_sel:DWORD dst_unused:UNUSED_PAD src0_sel:DWORD src1_sel:WORD_1
s_waitcnt vmcnt(14)
v_smfmac_f32_16x16x64_bf16 v[104:107], v[210:213], v[44:51], v169 abid:1
s_waitcnt vmcnt(13)
v_smfmac_f32_16x16x64_bf16 v[104:107], v[246:249], v[52:59], v173 abid:1
v_cvt_pk_bf16_f32 v88, v100, v101
v_cvt_pk_bf16_f32 v89, v102, v103
v_add_u32_sdwa v80, s4, v120 dst_sel:DWORD dst_unused:UNUSED_PAD src0_sel:DWORD src1_sel:WORD_0
v_add_u32_sdwa v81, s4, v120 dst_sel:DWORD dst_unused:UNUSED_PAD src0_sel:DWORD src1_sel:WORD_1
v_add_u32_sdwa v82, s4, v121 dst_sel:DWORD dst_unused:UNUSED_PAD src0_sel:DWORD src1_sel:WORD_0
v_add_u32_sdwa v83, s4, v121 dst_sel:DWORD dst_unused:UNUSED_PAD src0_sel:DWORD src1_sel:WORD_1
s_nop 1
v_cvt_pk_bf16_f32 v90, v104, v105
v_cvt_pk_bf16_f32 v91, v106, v107
v_cndmask_b32_dpp v92, v88, v84, vcc quad_perm:[1,0,3,2] row_mask:0xf bank_mask:0xf
v_cndmask_b32_dpp v93, v89, v85, vcc quad_perm:[1,0,3,2] row_mask:0xf bank_mask:0xf
v_cndmask_b32_dpp v94, v90, v86, vcc quad_perm:[1,0,3,2] row_mask:0xf bank_mask:0xf
v_cndmask_b32_dpp v95, v91, v87, vcc quad_perm:[1,0,3,2] row_mask:0xf bank_mask:0xf
buffer_store_dwordx4 v[92:95], v4, s[20:23], s46 offen offset:128 sc1
s_mov_b64 vcc, s[82:83]
v_cndmask_b32_dpp v88, v84, v88, vcc quad_perm:[1,0,3,2] row_mask:0xf bank_mask:0xf
v_cndmask_b32_dpp v89, v85, v89, vcc quad_perm:[1,0,3,2] row_mask:0xf bank_mask:0xf
v_cndmask_b32_dpp v90, v86, v90, vcc quad_perm:[1,0,3,2] row_mask:0xf bank_mask:0xf
v_cndmask_b32_dpp v91, v87, v91, vcc quad_perm:[1,0,3,2] row_mask:0xf bank_mask:0xf
buffer_store_dwordx4 v[88:91], v4, s[20:23], s46 offen offset:1280 sc1
s_mov_b64 vcc, s[80:81]
s_branch L_ptail1
L_ptail0:
ds_read_b128 v[52:55], v0 offset:16384
ds_read_b128 v[56:59], v1 offset:16384
s_waitcnt vmcnt(17) lgkmcnt(2)
v_smfmac_f32_16x16x64_bf16 v[108:111], v[214:217], v[44:51], v177 abid:1
s_waitcnt vmcnt(16) lgkmcnt(0)
v_smfmac_f32_16x16x64_bf16 v[108:111], v[250:253], v[52:59], v178
v_add_u32 v0, 37120, v0
v_add_u32 v1, 37120, v1
s_waitcnt vmcnt(15)
v_smfmac_f32_16x16x64_bf16 v[76:79], a[252:255], v[44:51], v166
s_waitcnt vmcnt(14)
v_smfmac_f32_16x16x64_bf16 v[76:79], v[218:221], v[52:59], v170
s_nop 1
v_cvt_pk_bf16_f32 v108, v108, v109
v_cvt_pk_bf16_f32 v109, v110, v111
ds_bpermute_b32 v108, v6, v108
ds_bpermute_b32 v109, v6, v109
s_waitcnt vmcnt(13)
v_smfmac_f32_16x16x64_bf16 v[80:83], v[186:189], v[44:51], v166 abid:1
s_waitcnt vmcnt(12)
v_smfmac_f32_16x16x64_bf16 v[80:83], v[222:225], v[52:59], v170 abid:1
v_cvt_pk_bf16_f32 v76, v76, v77
v_cvt_pk_bf16_f32 v77, v78, v79
s_waitcnt vmcnt(11)
v_smfmac_f32_16x16x64_bf16 v[84:87], v[190:193], v[44:51], v167
s_waitcnt vmcnt(10)
v_smfmac_f32_16x16x64_bf16 v[84:87], v[226:229], v[52:59], v171
s_nop 1
v_cvt_pk_bf16_f32 v78, v80, v81
v_cvt_pk_bf16_f32 v79, v82, v83
s_waitcnt lgkmcnt(0)
buffer_store_dwordx2 v[108:109], v5, s[20:23], s46 offen nt
s_waitcnt vmcnt(10)
v_smfmac_f32_16x16x64_bf16 v[88:91], v[194:197], v[44:51], v167 abid:1
s_waitcnt vmcnt(9)
v_smfmac_f32_16x16x64_bf16 v[88:91], v[230:233], v[52:59], v171 abid:1
v_cvt_pk_bf16_f32 v80, v84, v85
v_cvt_pk_bf16_f32 v81, v86, v87
s_waitcnt vmcnt(8)
v_smfmac_f32_16x16x64_bf16 v[92:95], v[198:201], v[44:51], v168
s_waitcnt vmcnt(7)
v_smfmac_f32_16x16x64_bf16 v[92:95], v[234:237], v[52:59], v172
s_nop 1
v_cvt_pk_bf16_f32 v82, v88, v89
v_cvt_pk_bf16_f32 v83, v90, v91
v_cndmask_b32_dpp v114, v80, v76, vcc quad_perm:[1,0,3,2] row_mask:0xf bank_mask:0xf
v_cndmask_b32_dpp v115, v81, v77, vcc quad_perm:[1,0,3,2] row_mask:0xf bank_mask:0xf
v_cndmask_b32_dpp v116, v82, v78, vcc quad_perm:[1,0,3,2] row_mask:0xf bank_mask:0xf
v_cndmask_b32_dpp v117, v83, v79, vcc quad_perm:[1,0,3,2] row_mask:0xf bank_mask:0xf
buffer_store_dwordx4 v[114:117], v4, s[20:23], s46 offen offset:0 sc1
s_mov_b64 vcc, s[82:83]
s_waitcnt vmcnt(7)
v_smfmac_f32_16x16x64_bf16 v[96:99], v[202:205], v[44:51], v168 abid:1
s_waitcnt vmcnt(6)
v_smfmac_f32_16x16x64_bf16 v[96:99], v[238:241], v[52:59], v172 abid:1
v_cvt_pk_bf16_f32 v84, v92, v93
v_cvt_pk_bf16_f32 v85, v94, v95
v_cndmask_b32_dpp v80, v76, v80, vcc quad_perm:[1,0,3,2] row_mask:0xf bank_mask:0xf
v_cndmask_b32_dpp v81, v77, v81, vcc quad_perm:[1,0,3,2] row_mask:0xf bank_mask:0xf
v_cndmask_b32_dpp v82, v78, v82, vcc quad_perm:[1,0,3,2] row_mask:0xf bank_mask:0xf
v_cndmask_b32_dpp v83, v79, v83, vcc quad_perm:[1,0,3,2] row_mask:0xf bank_mask:0xf
buffer_store_dwordx4 v[80:83], v4, s[20:23], s46 offen offset:1152 sc1
s_mov_b64 vcc, s[80:81]
s_waitcnt vmcnt(6)
v_smfmac_f32_16x16x64_bf16 v[100:103], v[206:209], v[44:51], v169
s_waitcnt vmcnt(5)
v_smfmac_f32_16x16x64_bf16 v[100:103], v[242:245], v[52:59], v173
v_cvt_pk_bf16_f32 v86, v96, v97
v_cvt_pk_bf16_f32 v87, v98, v99
v_add_u32_sdwa v76, s4, v118 dst_sel:DWORD dst_unused:UNUSED_PAD src0_sel:DWORD src1_sel:WORD_0
v_add_u32_sdwa v77, s4, v118 dst_sel:DWORD dst_unused:UNUSED_PAD src0_sel:DWORD src1_sel:WORD_1
v_add_u32_sdwa v78, s4, v119 dst_sel:DWORD dst_unused:UNUSED_PAD src0_sel:DWORD src1_sel:WORD_0
v_add_u32_sdwa v79, s4, v119 dst_sel:DWORD dst_unused:UNUSED_PAD src0_sel:DWORD src1_sel:WORD_1
s_waitcnt vmcnt(4)
v_smfmac_f32_16x16x64_bf16 v[104:107], v[210:213], v[44:51], v169 abid:1
s_waitcnt vmcnt(3)
v_smfmac_f32_16x16x64_bf16 v[104:107], v[246:249], v[52:59], v173 abid:1
v_cvt_pk_bf16_f32 v88, v100, v101
v_cvt_pk_bf16_f32 v89, v102, v103
v_add_u32_sdwa v80, s4, v120 dst_sel:DWORD dst_unused:UNUSED_PAD src0_sel:DWORD src1_sel:WORD_0
v_add_u32_sdwa v81, s4, v120 dst_sel:DWORD dst_unused:UNUSED_PAD src0_sel:DWORD src1_sel:WORD_1
v_add_u32_sdwa v82, s4, v121 dst_sel:DWORD dst_unused:UNUSED_PAD src0_sel:DWORD src1_sel:WORD_0
v_add_u32_sdwa v83, s4, v121 dst_sel:DWORD dst_unused:UNUSED_PAD src0_sel:DWORD src1_sel:WORD_1
s_nop 1
v_cvt_pk_bf16_f32 v90, v104, v105
v_cvt_pk_bf16_f32 v91, v106, v107
v_cndmask_b32_dpp v92, v88, v84, vcc quad_perm:[1,0,3,2] row_mask:0xf bank_mask:0xf
v_cndmask_b32_dpp v93, v89, v85, vcc quad_perm:[1,0,3,2] row_mask:0xf bank_mask:0xf
v_cndmask_b32_dpp v94, v90, v86, vcc quad_perm:[1,0,3,2] row_mask:0xf bank_mask:0xf
v_cndmask_b32_dpp v95, v91, v87, vcc quad_perm:[1,0,3,2] row_mask:0xf bank_mask:0xf
buffer_store_dwordx4 v[92:95], v4, s[20:23], s46 offen offset:128 sc1
s_mov_b64 vcc, s[82:83]
v_cndmask_b32_dpp v88, v84, v88, vcc quad_perm:[1,0,3,2] row_mask:0xf bank_mask:0xf
v_cndmask_b32_dpp v89, v85, v89, vcc quad_perm:[1,0,3,2] row_mask:0xf bank_mask:0xf
v_cndmask_b32_dpp v90, v86, v90, vcc quad_perm:[1,0,3,2] row_mask:0xf bank_mask:0xf
v_cndmask_b32_dpp v91, v87, v91, vcc quad_perm:[1,0,3,2] row_mask:0xf bank_mask:0xf
buffer_store_dwordx4 v[88:91], v4, s[20:23], s46 offen offset:1280 sc1
s_mov_b64 vcc, s[80:81]
L_ptail1:
s_cmp_ge_u32 s44, 148480
s_cselect_b32 s44, s9, s44
s_add_u32 s46, s46, 4718592
s_waitcnt lgkmcnt(0)
s_barrier
s_cmp_lg_u32 s89, 0
s_cbranch_scc1 L_loopnk_p3
s_branch L_loopn_p3
.p2align 6
L_loop:
v_smfmac_f32_16x16x64_bf16 v[8:11], a[0:3], v[44:51], v138
ds_read_b128 v[32:35], v2 offset:1408
v_cvt_pk_bf16_f32 v106, v36, v37
v_smfmac_f32_16x16x64_bf16 v[8:11], a[36:39], v[52:59], v142
s_waitcnt lgkmcnt(9)
v_cvt_pk_bf16_f32 v107, v38, v39
v_smfmac_f32_16x16x64_bf16 v[12:15], a[4:7], v[44:51], v138 abid:1
ds_read_b128 v[36:39], v2 offset:1472
v_cvt_pk_bf16_f32 v112, v40, v41
v_smfmac_f32_16x16x64_bf16 v[12:15], a[40:43], v[52:59], v142 abid:1
s_waitcnt lgkmcnt(8)
ds_read_b128 v[60:63], v0 offset:4096
v_cvt_pk_bf16_f32 v113, v42, v43
v_smfmac_f32_16x16x64_bf16 v[16:19], a[8:11], v[44:51], v139
s_cmp_eq_u32 s4, 129920
ds_read_b128 v[40:43], v2 offset:1536
v_cndmask_b32_dpp v108, v96, v92, vcc quad_perm:[1,0,3,2] row_mask:0xf bank_mask:0xf
v_smfmac_f32_16x16x64_bf16 v[16:19], a[44:47], v[52:59], v143
s_waitcnt lgkmcnt(8)
ds_read_u16 v82, v82
v_cndmask_b32_dpp v109, v97, v93, vcc quad_perm:[1,0,3,2] row_mask:0xf bank_mask:0xf
v_smfmac_f32_16x16x64_bf16 v[20:23], a[12:15], v[44:51], v139 abid:1
s_cselect_b32 s43, -129920, s5
ds_read_u16 v84, v84
v_cndmask_b32_dpp v110, v98, v94, vcc quad_perm:[1,0,3,2] row_mask:0xf bank_mask:0xf
v_smfmac_f32_16x16x64_bf16 v[20:23], a[48:51], v[52:59], v143 abid:1
s_waitcnt lgkmcnt(8)
ds_read_b128 v[64:67], v1 offset:4096
v_cndmask_b32_dpp v111, v99, v95, vcc quad_perm:[1,0,3,2] row_mask:0xf bank_mask:0xf
v_smfmac_f32_16x16x64_bf16 v[24:27], a[16:19], v[44:51], v140
s_add_u32 s4, s4, s43
ds_read_b128 v[68:71], v0 offset:6144
v_add_u32_sdwa v87, s42, v123 dst_sel:DWORD dst_unused:UNUSED_PAD src0_sel:DWORD src1_sel:WORD_1
v_smfmac_f32_16x16x64_bf16 v[24:27], a[52:55], v[52:59], v144
buffer_store_dwordx4 v[108:111], v4, s[20:23], s46 offen offset:0 sc1
s_mov_b64 vcc, s[82:83]
s_waitcnt lgkmcnt(8)
ds_read_b128 v[72:75], v1 offset:6144
v_cndmask_b32_dpp v96, v92, v96, vcc quad_perm:[1,0,3,2] row_mask:0xf bank_mask:0xf
v_cndmask_b32_dpp v97, v93, v97, vcc quad_perm:[1,0,3,2] row_mask:0xf bank_mask:0xf
v_smfmac_f32_16x16x64_bf16 v[28:31], a[20:23], v[44:51], v140 abid:1
s_add_u32 s41, s41, 1
ds_read_u16 v83, v83
v_cndmask_b32_dpp v98, v94, v98, vcc quad_perm:[1,0,3,2] row_mask:0xf bank_mask:0xf
v_smfmac_f32_16x16x64_bf16 v[28:31], a[56:59], v[52:59], v144 abid:1
s_waitcnt lgkmcnt(9)
ds_read_b128 v[114:117], v2 offset:64
v_cndmask_b32_dpp v99, v95, v99, vcc quad_perm:[1,0,3,2] row_mask:0xf bank_mask:0xf
v_smfmac_f32_16x16x64_bf16 v[32:35], a[24:27], v[44:51], v141
ds_read_u16 v85, v85
v_add_u32_sdwa v88, s42, v124 dst_sel:DWORD dst_unused:UNUSED_PAD src0_sel:DWORD src1_sel:WORD_0
v_smfmac_f32_16x16x64_bf16 v[32:35], a[60:63], v[52:59], v145
s_waitcnt lgkmcnt(10)
ds_read_u16 v86, v86
v_add_u32_sdwa v89, s42, v124 dst_sel:DWORD dst_unused:UNUSED_PAD src0_sel:DWORD src1_sel:WORD_1
v_smfmac_f32_16x16x64_bf16 v[36:39], a[28:31], v[44:51], v141 abid:1
ds_read_u16 v87, v87
v_add_u32_sdwa v90, s42, v125 dst_sel:DWORD dst_unused:UNUSED_PAD src0_sel:DWORD src1_sel:WORD_0
v_smfmac_f32_16x16x64_bf16 v[36:39], a[64:67], v[52:59], v145 abid:1
s_waitcnt lgkmcnt(10)
ds_read_u16 v88, v88
v_add_u32_sdwa v91, s42, v125 dst_sel:DWORD dst_unused:UNUSED_PAD src0_sel:DWORD src1_sel:WORD_1
v_smfmac_f32_16x16x64_bf16 v[40:43], a[32:35], v[44:51], v174
buffer_store_dwordx4 v[96:99], v4, s[20:23], s46 offen offset:1152 sc1
s_mov_b64 vcc, s[80:81]
ds_read_u16 v89, v89
v_cndmask_b32_dpp v92, v104, v100, vcc quad_perm:[1,0,3,2] row_mask:0xf bank_mask:0xf
v_cndmask_b32_dpp v93, v105, v101, vcc quad_perm:[1,0,3,2] row_mask:0xf bank_mask:0xf
v_smfmac_f32_16x16x64_bf16 v[40:43], a[68:71], v[52:59], v174 abid:1
s_waitcnt lgkmcnt(9)
ds_read_u16 v90, v90
v_cndmask_b32_dpp v94, v106, v102, vcc quad_perm:[1,0,3,2] row_mask:0xf bank_mask:0xf
v_smfmac_f32_16x16x64_bf16 v[8:11], a[72:75], v[60:67], v146
s_waitcnt lgkmcnt(8)
ds_read_u16 v91, v91
v_cndmask_b32_dpp v95, v107, v103, vcc quad_perm:[1,0,3,2] row_mask:0xf bank_mask:0xf
v_smfmac_f32_16x16x64_bf16 v[8:11], a[108:111], v[68:75], v150
s_waitcnt lgkmcnt(7)
ds_bpermute_b32 v112, v6, v112
v_smfmac_f32_16x16x64_bf16 v[8:11], v[114:117], v[76:83], v179
ds_bpermute_b32 v113, v6, v113
v_smfmac_f32_16x16x64_bf16 v[12:15], v[114:117], v[76:83], v179 abid:1
ds_read_b128 v[114:117], v2 offset:128
v_add_u32_sdwa v76, s42, v126 dst_sel:DWORD dst_unused:UNUSED_PAD src0_sel:DWORD src1_sel:WORD_0
v_smfmac_f32_16x16x64_bf16 v[12:15], a[76:79], v[60:67], v146 abid:1
ds_read_u16 v76, v76
v_add_u32_sdwa v77, s42, v126 dst_sel:DWORD dst_unused:UNUSED_PAD src0_sel:DWORD src1_sel:WORD_1
v_smfmac_f32_16x16x64_bf16 v[12:15], a[112:115], v[68:75], v150 abid:1
buffer_store_dwordx4 v[92:95], v4, s[20:23], s46 offen offset:128 sc1
s_mov_b64 vcc, s[82:83]
ds_read_u16 v77, v77
v_cndmask_b32_dpp v104, v100, v104, vcc quad_perm:[1,0,3,2] row_mask:0xf bank_mask:0xf
v_add_u32_sdwa v78, s42, v127 dst_sel:DWORD dst_unused:UNUSED_PAD src0_sel:DWORD src1_sel:WORD_0
v_smfmac_f32_16x16x64_bf16 v[24:27], a[88:91], v[60:67], v148
ds_read_u16 v78, v78
v_cndmask_b32_dpp v105, v101, v105, vcc quad_perm:[1,0,3,2] row_mask:0xf bank_mask:0xf
v_smfmac_f32_16x16x64_bf16 v[24:27], a[124:127], v[68:75], v152
ds_read_b128 v[44:47], v0 offset:8192
v_cndmask_b32_dpp v106, v102, v106, vcc quad_perm:[1,0,3,2] row_mask:0xf bank_mask:0xf
v_smfmac_f32_16x16x64_bf16 v[28:31], a[92:95], v[60:67], v148 abid:1
ds_read_b128 v[48:51], v1 offset:8192
v_add_u32_sdwa v79, s42, v127 dst_sel:DWORD dst_unused:UNUSED_PAD src0_sel:DWORD src1_sel:WORD_1
v_smfmac_f32_16x16x64_bf16 v[28:31], a[128:131], v[68:75], v152 abid:1
ds_read_u16 v79, v79
v_cndmask_b32_dpp v107, v103, v107, vcc quad_perm:[1,0,3,2] row_mask:0xf bank_mask:0xf
v_smfmac_f32_16x16x64_bf16 v[32:35], a[96:99], v[60:67], v149
ds_read_b128 v[52:55], v0 offset:10240
v_add_u32_sdwa v80, s42, v128 dst_sel:DWORD dst_unused:UNUSED_PAD src0_sel:DWORD src1_sel:WORD_0
v_smfmac_f32_16x16x64_bf16 v[32:35], a[132:135], v[68:75], v153
ds_read_u16 v80, v80
v_add_u32_sdwa v81, s42, v128 dst_sel:DWORD dst_unused:UNUSED_PAD src0_sel:DWORD src1_sel:WORD_1
v_smfmac_f32_16x16x64_bf16 v[16:19], a[80:83], v[60:67], v147
buffer_store_dwordx4 v[104:107], v4, s[20:23], s46 offen offset:1280 sc1
s_mov_b64 vcc, s[80:81]
ds_read_b128 v[56:59], v1 offset:10240
v_add_u32_sdwa v82, s42, v129 dst_sel:DWORD dst_unused:UNUSED_PAD src0_sel:DWORD src1_sel:WORD_0
v_add_u32_sdwa v83, s42, v129 dst_sel:DWORD dst_unused:UNUSED_PAD src0_sel:DWORD src1_sel:WORD_1
v_smfmac_f32_16x16x64_bf16 v[16:19], a[116:119], v[68:75], v151
s_waitcnt lgkmcnt(9)
ds_read_b128 v[92:95], v0 offset:12288
v_add_u32_sdwa v100, s42, v130 dst_sel:DWORD dst_unused:UNUSED_PAD src0_sel:DWORD src1_sel:WORD_0
v_smfmac_f32_16x16x64_bf16 v[16:19], v[114:117], v[84:91], v180 abid:1
s_waitcnt vmcnt(4)
ds_read_u16 v81, v81
v_add_u32_sdwa v101, s42, v130 dst_sel:DWORD dst_unused:UNUSED_PAD src0_sel:DWORD src1_sel:WORD_1
v_smfmac_f32_16x16x64_bf16 v[20:23], v[114:117], v[84:91], v181
ds_read_b128 v[96:99], v1 offset:12288
v_add_u32_sdwa v102, s42, v131 dst_sel:DWORD dst_unused:UNUSED_PAD src0_sel:DWORD src1_sel:WORD_0
v_smfmac_f32_16x16x64_bf16 v[20:23], a[84:87], v[60:67], v147 abid:1
ds_read_u16 v100, v100
v_add_u32_sdwa v103, s42, v131 dst_sel:DWORD dst_unused:UNUSED_PAD src0_sel:DWORD src1_sel:WORD_1
v_smfmac_f32_16x16x64_bf16 v[20:23], a[120:123], v[68:75], v151 abid:1
ds_read_u16 v82, v82
v_add_u32_sdwa v104, s42, v132 dst_sel:DWORD dst_unused:UNUSED_PAD src0_sel:DWORD src1_sel:WORD_0
v_smfmac_f32_16x16x64_bf16 v[36:39], a[100:103], v[60:67], v149 abid:1
ds_read_u16 v101, v101
v_add_u32_sdwa v105, s42, v132 dst_sel:DWORD dst_unused:UNUSED_PAD src0_sel:DWORD src1_sel:WORD_1
v_smfmac_f32_16x16x64_bf16 v[36:39], a[136:139], v[68:75], v153 abid:1
buffer_store_dwordx2 v[112:113], v5, s[20:23], s46 offen nt
ds_read_u16 v83, v83
v_add_u32_sdwa v106, s42, v133 dst_sel:DWORD dst_unused:UNUSED_PAD src0_sel:DWORD src1_sel:WORD_0
v_smfmac_f32_16x16x64_bf16 v[40:43], a[104:107], v[60:67], v175
s_mov_b32 s22, 75497472
ds_read_b128 v[114:117], v2 offset:192
v_add_u32_sdwa v107, s42, v133 dst_sel:DWORD dst_unused:UNUSED_PAD src0_sel:DWORD src1_sel:WORD_1
v_smfmac_f32_16x16x64_bf16 v[40:43], a[140:143], v[68:75], v175 abid:1
s_waitcnt lgkmcnt(12)
ds_read_u16 v102, v102
v_add_u32_sdwa v84, s42, v134 dst_sel:DWORD dst_unused:UNUSED_PAD src0_sel:DWORD src1_sel:WORD_0
v_smfmac_f32_16x16x64_bf16 v[8:11], a[144:147], v[44:51], v154
s_waitcnt lgkmcnt(9)
ds_read_u16 v103, v103
v_add_u32_sdwa v85, s42, v134 dst_sel:DWORD dst_unused:UNUSED_PAD src0_sel:DWORD src1_sel:WORD_1
v_smfmac_f32_16x16x64_bf16 v[8:11], a[180:183], v[52:59], v158
s_waitcnt lgkmcnt(7)
ds_read_u16 v104, v104
v_add_u32_sdwa v86, s42, v135 dst_sel:DWORD dst_unused:UNUSED_PAD src0_sel:DWORD src1_sel:WORD_0
v_smfmac_f32_16x16x64_bf16 v[8:11], a[216:219], v[92:99], v162
s_mov_b32 s46, s48
ds_read_u16 v105, v105
v_add_u32_sdwa v87, s42, v135 dst_sel:DWORD dst_unused:UNUSED_PAD src0_sel:DWORD src1_sel:WORD_1
v_smfmac_f32_16x16x64_bf16 v[24:27], a[160:163], v[44:51], v156
s_add_u32 m0, s44, 0
ds_read_u16 v106, v106
v_add_u32_sdwa v88, s42, v136 dst_sel:DWORD dst_unused:UNUSED_PAD src0_sel:DWORD src1_sel:WORD_0
v_smfmac_f32_16x16x64_bf16 v[24:27], a[196:199], v[52:59], v160
buffer_load_dwordx4 v3, s[16:19], s45 offen offset:0 nt lds
v_add_u32_sdwa v89, s42, v136 dst_sel:DWORD dst_unused:UNUSED_PAD src0_sel:DWORD src1_sel:WORD_1
v_smfmac_f32_16x16x64_bf16 v[24:27], a[232:235], v[92:99], v164
s_waitcnt lgkmcnt(5)
ds_read_u16 v107, v107
v_add_u32_sdwa v90, s42, v137 dst_sel:DWORD dst_unused:UNUSED_PAD src0_sel:DWORD src1_sel:WORD_0
v_smfmac_f32_16x16x64_bf16 v[24:27], v[114:117], v[76:83], v182
s_mov_b32 s48, s49
ds_read_u16 v84, v84
v_add_u32_sdwa v91, s42, v137 dst_sel:DWORD dst_unused:UNUSED_PAD src0_sel:DWORD src1_sel:WORD_1
v_smfmac_f32_16x16x64_bf16 v[28:31], v[114:117], v[76:83], v182 abid:1
s_mov_b32 s49, s50
ds_read_b128 v[114:117], v2 offset:256
v_add_u32_sdwa v76, s4, v118 dst_sel:DWORD dst_unused:UNUSED_PAD src0_sel:DWORD src1_sel:WORD_0
v_smfmac_f32_16x16x64_bf16 v[28:31], a[164:167], v[44:51], v156 abid:1
s_add_u32 s50, s50, 4718592
ds_read_u16 v85, v85
v_add_u32_sdwa v77, s4, v118 dst_sel:DWORD dst_unused:UNUSED_PAD src0_sel:DWORD src1_sel:WORD_1
v_smfmac_f32_16x16x64_bf16 v[28:31], a[200:203], v[52:59], v160 abid:1
ds_read_u16 v86, v86
v_add_u32_sdwa v78, s4, v119 dst_sel:DWORD dst_unused:UNUSED_PAD src0_sel:DWORD src1_sel:WORD_0
v_smfmac_f32_16x16x64_bf16 v[28:31], a[236:239], v[92:99], v164 abid:1
ds_read_u16 v87, v87
v_add_u32_sdwa v79, s4, v119 dst_sel:DWORD dst_unused:UNUSED_PAD src0_sel:DWORD src1_sel:WORD_1
v_smfmac_f32_16x16x64_bf16 v[12:15], a[148:151], v[44:51], v154 abid:1
s_add_u32 m0, s44, 3840
ds_read_u16 v88, v88
v_add_u32_sdwa v80, s4, v120 dst_sel:DWORD dst_unused:UNUSED_PAD src0_sel:DWORD src1_sel:WORD_0
v_smfmac_f32_16x16x64_bf16 v[12:15], a[184:187], v[52:59], v158 abid:1
buffer_load_dwordx4 v3, s[16:19], s45 offen offset:256 nt lds
v_add_u32_sdwa v81, s4, v120 dst_sel:DWORD dst_unused:UNUSED_PAD src0_sel:DWORD src1_sel:WORD_1
v_smfmac_f32_16x16x64_bf16 v[12:15], a[220:223], v[92:99], v162 abid:1
ds_read_b128 v[60:63], v0 offset:14336
v_add_u32_sdwa v82, s4, v121 dst_sel:DWORD dst_unused:UNUSED_PAD src0_sel:DWORD src1_sel:WORD_0
v_smfmac_f32_16x16x64_bf16 v[32:35], a[168:171], v[44:51], v157
ds_read_u16 v89, v89
v_add_u32_sdwa v83, s4, v121 dst_sel:DWORD dst_unused:UNUSED_PAD src0_sel:DWORD src1_sel:WORD_1
v_smfmac_f32_16x16x64_bf16 v[32:35], a[204:207], v[52:59], v161
ds_read_b128 v[64:67], v1 offset:14336
v_smfmac_f32_16x16x64_bf16 v[32:35], a[240:243], v[92:99], v165
s_waitcnt lgkmcnt(7)
ds_read_b128 v[68:71], v0 offset:16384
v_smfmac_f32_16x16x64_bf16 v[32:35], v[114:117], v[100:107], v183 abid:1
ds_read_u16 v90, v90
v_smfmac_f32_16x16x64_bf16 v[36:39], v[114:117], v[100:107], v184
ds_read_b128 v[72:75], v1 offset:16384
v_add_u32 v0, s43, v0
v_smfmac_f32_16x16x64_bf16 v[36:39], a[172:175], v[44:51], v157 abid:1
s_add_u32 m0, s44, 7680
ds_read_u16 v91, v91
v_add_u32 v1, s43, v1
v_smfmac_f32_16x16x64_bf16 v[36:39], a[208:211], v[52:59], v161 abid:1
buffer_load_dwordx4 v3, s[16:19], s45 offen offset:512 nt lds
v_smfmac_f32_16x16x64_bf16 v[36:39], a[244:247], v[92:99], v165 abid:1
ds_read_b128 v[114:117], v2 offset:320
v_smfmac_f32_16x16x64_bf16 v[16:19], a[152:155], v[44:51], v155
s_add_u32 m0, s44, 11520
v_smfmac_f32_16x16x64_bf16 v[16:19], a[188:191], v[52:59], v159
buffer_load_dwordx4 v3, s[16:19], s45 offen offset:768 nt lds
v_smfmac_f32_16x16x64_bf16 v[16:19], a[224:227], v[92:99], v163
v_smfmac_f32_16x16x64_bf16 v[20:23], a[156:159], v[44:51], v155 abid:1
s_add_u32 m0, s44, s8
v_smfmac_f32_16x16x64_bf16 v[20:23], a[192:195], v[52:59], v159 abid:1
s_mov_b64 exec, s[10:11]
buffer_load_dwordx4 v3, s[16:19], s7 offen offset:896 nt lds
s_mov_b64 exec, -1
v_smfmac_f32_16x16x64_bf16 v[20:23], a[228:231], v[92:99], v163 abid:1
s_add_u32 s45, s45, 4718592
s_add_u32 s7, s7, 4718592
s_add_u32 s44, s44, s5
v_smfmac_f32_16x16x64_bf16 v[40:43], a[176:179], v[44:51], v176
s_cmp_ge_u32 s44, 148480
s_cselect_b32 s44, s9, s44
s_bitcmp1_b32 s92, s41
v_smfmac_f32_16x16x64_bf16 v[40:43], a[212:215], v[52:59], v176 abid:1
s_cbranch_scc1 L_loop_w
L_loop_wb:
v_smfmac_f32_16x16x64_bf16 v[40:43], a[248:251], v[92:99], v177
s_waitcnt lgkmcnt(0)
v_smfmac_f32_16x16x64_bf16 v[40:43], v[114:117], v[84:91], v185
s_waitcnt vmcnt(20)
s_barrier
v_smfmac_f32_16x16x64_bf16 v[8:11], a[252:255], v[60:67], v166
s_mov_b32 s42, s4
v_smfmac_f32_16x16x64_bf16 v[8:11], v[218:221], v[68:75], v170
ds_read_b128 v[44:47], v0 offset:0
v_add_u32_sdwa v84, s42, v122 dst_sel:DWORD dst_unused:UNUSED_PAD src0_sel:DWORD src1_sel:WORD_0
v_smfmac_f32_16x16x64_bf16 v[12:15], v[186:189], v[60:67], v166 abid:1
ds_read_b128 v[48:51], v1 offset:0
v_add_u32_sdwa v85, s42, v122 dst_sel:DWORD dst_unused:UNUSED_PAD src0_sel:DWORD src1_sel:WORD_1
v_smfmac_f32_16x16x64_bf16 v[12:15], v[222:225], v[68:75], v170 abid:1
ds_read_b128 v[52:55], v0 offset:2048
v_add_u32_sdwa v86, s42, v123 dst_sel:DWORD dst_unused:UNUSED_PAD src0_sel:DWORD src1_sel:WORD_0
v_smfmac_f32_16x16x64_bf16 v[16:19], v[190:193], v[60:67], v167
ds_read_b128 v[56:59], v1 offset:2048
v_cvt_pk_bf16_f32 v92, v8, v9
v_smfmac_f32_16x16x64_bf16 v[16:19], v[226:229], v[68:75], v171
ds_read_u16 v76, v76
v_cvt_pk_bf16_f32 v93, v10, v11
v_smfmac_f32_16x16x64_bf16 v[20:23], v[194:197], v[60:67], v167 abid:1
ds_read_b128 v[8:11], v2 offset:1024
v_cvt_pk_bf16_f32 v94, v12, v13
v_smfmac_f32_16x16x64_bf16 v[20:23], v[230:233], v[68:75], v171 abid:1
ds_read_u16 v77, v77
v_cvt_pk_bf16_f32 v95, v14, v15
v_smfmac_f32_16x16x64_bf16 v[24:27], v[198:201], v[60:67], v168
ds_read_b128 v[12:15], v2 offset:1088
v_cvt_pk_bf16_f32 v96, v16, v17
v_smfmac_f32_16x16x64_bf16 v[24:27], v[234:237], v[68:75], v172
ds_read_u16 v78, v78
v_cvt_pk_bf16_f32 v97, v18, v19
v_smfmac_f32_16x16x64_bf16 v[28:31], v[202:205], v[60:67], v168 abid:1
ds_read_b128 v[16:19], v2 offset:1152
v_cvt_pk_bf16_f32 v98, v20, v21
v_smfmac_f32_16x16x64_bf16 v[28:31], v[238:241], v[68:75], v172 abid:1
ds_read_u16 v79, v79
v_cvt_pk_bf16_f32 v99, v22, v23
v_smfmac_f32_16x16x64_bf16 v[32:35], v[206:209], v[60:67], v169
ds_read_b128 v[20:23], v2 offset:1216
v_cvt_pk_bf16_f32 v100, v24, v25
v_smfmac_f32_16x16x64_bf16 v[32:35], v[242:245], v[68:75], v173
ds_read_u16 v80, v80
v_cvt_pk_bf16_f32 v101, v26, v27
v_smfmac_f32_16x16x64_bf16 v[36:39], v[210:213], v[60:67], v169 abid:1
ds_read_b128 v[24:27], v2 offset:1280
v_cvt_pk_bf16_f32 v102, v28, v29
v_smfmac_f32_16x16x64_bf16 v[36:39], v[246:249], v[68:75], v173 abid:1
ds_read_u16 v81, v81
v_cvt_pk_bf16_f32 v103, v30, v31
v_smfmac_f32_16x16x64_bf16 v[40:43], v[214:217], v[60:67], v177 abid:1
s_bitcmp1_b32 s85, s41
ds_read_b128 v[28:31], v2 offset:1344
v_cvt_pk_bf16_f32 v104, v32, v33
v_smfmac_f32_16x16x64_bf16 v[40:43], v[250:253], v[68:75], v178
s_waitcnt lgkmcnt(10)
v_cvt_pk_bf16_f32 v105, v34, v35
s_cbranch_scc1 L_loop
s_cmp_lg_u32 s41, 6
s_cbranch_scc1 L_loopn
.p2align 3
L_loopc:
v_smfmac_f32_16x16x64_bf16 v[8:11], a[0:3], v[44:51], v138
s_cmp_lt_u32 s56, s65
s_cselect_b32 s34, s34, 0
s_cselect_b32 s64, s64, 0
ds_read_b128 v[32:35], v2 offset:1408
v_cvt_pk_bf16_f32 v106, v36, v37
v_mov_b32 v7, 1
v_smfmac_f32_16x16x64_bf16 v[8:11], a[36:39], v[52:59], v142
s_waitcnt lgkmcnt(9)
buffer_atomic_add v7, v6, s[32:35], 0 offen sc0 sc1
v_cvt_pk_bf16_f32 v107, v38, v39
v_smfmac_f32_16x16x64_bf16 v[12:15], a[4:7], v[44:51], v138 abid:1
ds_read_b128 v[36:39], v2 offset:1472
v_cvt_pk_bf16_f32 v112, v40, v41
v_smfmac_f32_16x16x64_bf16 v[12:15], a[40:43], v[52:59], v142 abid:1
s_waitcnt lgkmcnt(8)
ds_read_b128 v[60:63], v0 offset:4096
v_cvt_pk_bf16_f32 v113, v42, v43
v_smfmac_f32_16x16x64_bf16 v[16:19], a[8:11], v[44:51], v139
s_cmp_eq_u32 s4, 129920
ds_read_b128 v[40:43], v2 offset:1536
v_cndmask_b32_dpp v108, v96, v92, vcc quad_perm:[1,0,3,2] row_mask:0xf bank_mask:0xf
v_smfmac_f32_16x16x64_bf16 v[16:19], a[44:47], v[52:59], v143
s_waitcnt lgkmcnt(8)
ds_read_u16 v82, v82
v_cndmask_b32_dpp v109, v97, v93, vcc quad_perm:[1,0,3,2] row_mask:0xf bank_mask:0xf
v_smfmac_f32_16x16x64_bf16 v[20:23], a[12:15], v[44:51], v139 abid:1
s_cselect_b32 s43, -129920, s5
ds_read_u16 v84, v84
v_cndmask_b32_dpp v110, v98, v94, vcc quad_perm:[1,0,3,2] row_mask:0xf bank_mask:0xf
v_smfmac_f32_16x16x64_bf16 v[20:23], a[48:51], v[52:59], v143 abid:1
s_waitcnt lgkmcnt(8)
ds_read_b128 v[64:67], v1 offset:4096
v_cndmask_b32_dpp v111, v99, v95, vcc quad_perm:[1,0,3,2] row_mask:0xf bank_mask:0xf
v_smfmac_f32_16x16x64_bf16 v[24:27], a[16:19], v[44:51], v140
s_add_u32 s4, s4, s43
ds_read_b128 v[68:71], v0 offset:6144
v_add_u32_sdwa v87, s42, v123 dst_sel:DWORD dst_unused:UNUSED_PAD src0_sel:DWORD src1_sel:WORD_1
v_smfmac_f32_16x16x64_bf16 v[24:27], a[52:55], v[52:59], v144
buffer_store_dwordx4 v[108:111], v4, s[20:23], s46 offen offset:0 sc1
s_mov_b64 vcc, s[82:83]
s_waitcnt lgkmcnt(8)
ds_read_b128 v[72:75], v1 offset:6144
v_cndmask_b32_dpp v96, v92, v96, vcc quad_perm:[1,0,3,2] row_mask:0xf bank_mask:0xf
v_cndmask_b32_dpp v97, v93, v97, vcc quad_perm:[1,0,3,2] row_mask:0xf bank_mask:0xf
v_smfmac_f32_16x16x64_bf16 v[28:31], a[20:23], v[44:51], v140 abid:1
s_add_u32 s7, s45, s58
ds_read_u16 v83, v83
v_cndmask_b32_dpp v98, v94, v98, vcc quad_perm:[1,0,3,2] row_mask:0xf bank_mask:0xf
v_smfmac_f32_16x16x64_bf16 v[28:31], a[56:59], v[52:59], v144 abid:1
s_waitcnt lgkmcnt(9)
ds_read_b128 v[114:117], v2 offset:64
v_cndmask_b32_dpp v99, v95, v99, vcc quad_perm:[1,0,3,2] row_mask:0xf bank_mask:0xf
v_smfmac_f32_16x16x64_bf16 v[32:35], a[24:27], v[44:51], v141
ds_read_u16 v85, v85
v_add_u32_sdwa v88, s42, v124 dst_sel:DWORD dst_unused:UNUSED_PAD src0_sel:DWORD src1_sel:WORD_0
v_smfmac_f32_16x16x64_bf16 v[32:35], a[60:63], v[52:59], v145
s_waitcnt lgkmcnt(10)
ds_read_u16 v86, v86
v_add_u32_sdwa v89, s42, v124 dst_sel:DWORD dst_unused:UNUSED_PAD src0_sel:DWORD src1_sel:WORD_1
v_smfmac_f32_16x16x64_bf16 v[36:39], a[28:31], v[44:51], v141 abid:1
ds_read_u16 v87, v87
v_add_u32_sdwa v90, s42, v125 dst_sel:DWORD dst_unused:UNUSED_PAD src0_sel:DWORD src1_sel:WORD_0
v_smfmac_f32_16x16x64_bf16 v[36:39], a[64:67], v[52:59], v145 abid:1
s_waitcnt lgkmcnt(10)
ds_read_u16 v88, v88
v_add_u32_sdwa v91, s42, v125 dst_sel:DWORD dst_unused:UNUSED_PAD src0_sel:DWORD src1_sel:WORD_1
v_smfmac_f32_16x16x64_bf16 v[40:43], a[32:35], v[44:51], v174
buffer_store_dwordx4 v[96:99], v4, s[20:23], s46 offen offset:1152 sc1
s_mov_b64 vcc, s[80:81]
ds_read_u16 v89, v89
v_cndmask_b32_dpp v92, v104, v100, vcc quad_perm:[1,0,3,2] row_mask:0xf bank_mask:0xf
v_cndmask_b32_dpp v93, v105, v101, vcc quad_perm:[1,0,3,2] row_mask:0xf bank_mask:0xf
v_smfmac_f32_16x16x64_bf16 v[40:43], a[68:71], v[52:59], v174 abid:1
s_waitcnt lgkmcnt(9)
ds_read_u16 v90, v90
v_cndmask_b32_dpp v94, v106, v102, vcc quad_perm:[1,0,3,2] row_mask:0xf bank_mask:0xf
v_smfmac_f32_16x16x64_bf16 v[8:11], a[72:75], v[60:67], v146
s_waitcnt lgkmcnt(8)
ds_read_u16 v91, v91
v_cndmask_b32_dpp v95, v107, v103, vcc quad_perm:[1,0,3,2] row_mask:0xf bank_mask:0xf
v_smfmac_f32_16x16x64_bf16 v[8:11], a[108:111], v[68:75], v150
s_waitcnt lgkmcnt(7)
ds_bpermute_b32 v112, v6, v112
v_smfmac_f32_16x16x64_bf16 v[8:11], v[114:117], v[76:83], v179
ds_bpermute_b32 v113, v6, v113
v_smfmac_f32_16x16x64_bf16 v[12:15], v[114:117], v[76:83], v179 abid:1
ds_read_b128 v[114:117], v2 offset:128
v_add_u32_sdwa v76, s42, v126 dst_sel:DWORD dst_unused:UNUSED_PAD src0_sel:DWORD src1_sel:WORD_0
v_smfmac_f32_16x16x64_bf16 v[12:15], a[76:79], v[60:67], v146 abid:1
ds_read_u16 v76, v76
v_add_u32_sdwa v77, s42, v126 dst_sel:DWORD dst_unused:UNUSED_PAD src0_sel:DWORD src1_sel:WORD_1
v_smfmac_f32_16x16x64_bf16 v[12:15], a[112:115], v[68:75], v150 abid:1
buffer_store_dwordx4 v[92:95], v4, s[20:23], s46 offen offset:128 sc1
s_mov_b64 vcc, s[82:83]
ds_read_u16 v77, v77
v_cndmask_b32_dpp v104, v100, v104, vcc quad_perm:[1,0,3,2] row_mask:0xf bank_mask:0xf
v_add_u32_sdwa v78, s42, v127 dst_sel:DWORD dst_unused:UNUSED_PAD src0_sel:DWORD src1_sel:WORD_0
v_smfmac_f32_16x16x64_bf16 v[24:27], a[88:91], v[60:67], v148
ds_read_u16 v78, v78
v_cndmask_b32_dpp v105, v101, v105, vcc quad_perm:[1,0,3,2] row_mask:0xf bank_mask:0xf
v_smfmac_f32_16x16x64_bf16 v[24:27], a[124:127], v[68:75], v152
ds_read_b128 v[44:47], v0 offset:8192
v_cndmask_b32_dpp v106, v102, v106, vcc quad_perm:[1,0,3,2] row_mask:0xf bank_mask:0xf
v_smfmac_f32_16x16x64_bf16 v[28:31], a[92:95], v[60:67], v148 abid:1
ds_read_b128 v[48:51], v1 offset:8192
v_add_u32_sdwa v79, s42, v127 dst_sel:DWORD dst_unused:UNUSED_PAD src0_sel:DWORD src1_sel:WORD_1
v_smfmac_f32_16x16x64_bf16 v[28:31], a[128:131], v[68:75], v152 abid:1
ds_read_u16 v79, v79
v_cndmask_b32_dpp v107, v103, v107, vcc quad_perm:[1,0,3,2] row_mask:0xf bank_mask:0xf
v_smfmac_f32_16x16x64_bf16 v[32:35], a[96:99], v[60:67], v149
ds_read_b128 v[52:55], v0 offset:10240
v_add_u32_sdwa v80, s42, v128 dst_sel:DWORD dst_unused:UNUSED_PAD src0_sel:DWORD src1_sel:WORD_0
v_smfmac_f32_16x16x64_bf16 v[32:35], a[132:135], v[68:75], v153
ds_read_u16 v80, v80
v_add_u32_sdwa v81, s42, v128 dst_sel:DWORD dst_unused:UNUSED_PAD src0_sel:DWORD src1_sel:WORD_1
v_smfmac_f32_16x16x64_bf16 v[16:19], a[80:83], v[60:67], v147
buffer_store_dwordx4 v[104:107], v4, s[20:23], s46 offen offset:1280 sc1
s_mov_b64 vcc, s[80:81]
ds_read_b128 v[56:59], v1 offset:10240
v_add_u32_sdwa v82, s42, v129 dst_sel:DWORD dst_unused:UNUSED_PAD src0_sel:DWORD src1_sel:WORD_0
v_add_u32_sdwa v83, s42, v129 dst_sel:DWORD dst_unused:UNUSED_PAD src0_sel:DWORD src1_sel:WORD_1
v_smfmac_f32_16x16x64_bf16 v[16:19], a[116:119], v[68:75], v151
s_waitcnt lgkmcnt(9)
ds_read_b128 v[92:95], v0 offset:12288
v_add_u32_sdwa v100, s42, v130 dst_sel:DWORD dst_unused:UNUSED_PAD src0_sel:DWORD src1_sel:WORD_0
v_smfmac_f32_16x16x64_bf16 v[16:19], v[114:117], v[84:91], v180 abid:1
ds_read_u16 v81, v81
v_add_u32_sdwa v101, s42, v130 dst_sel:DWORD dst_unused:UNUSED_PAD src0_sel:DWORD src1_sel:WORD_1
v_smfmac_f32_16x16x64_bf16 v[20:23], v[114:117], v[84:91], v181
ds_read_b128 v[96:99], v1 offset:12288
v_add_u32_sdwa v102, s42, v131 dst_sel:DWORD dst_unused:UNUSED_PAD src0_sel:DWORD src1_sel:WORD_0
v_smfmac_f32_16x16x64_bf16 v[20:23], a[84:87], v[60:67], v147 abid:1
ds_read_u16 v100, v100
v_add_u32_sdwa v103, s42, v131 dst_sel:DWORD dst_unused:UNUSED_PAD src0_sel:DWORD src1_sel:WORD_1
v_smfmac_f32_16x16x64_bf16 v[20:23], a[120:123], v[68:75], v151 abid:1
ds_read_u16 v82, v82
v_add_u32_sdwa v104, s42, v132 dst_sel:DWORD dst_unused:UNUSED_PAD src0_sel:DWORD src1_sel:WORD_0
v_smfmac_f32_16x16x64_bf16 v[36:39], a[100:103], v[60:67], v149 abid:1
ds_read_u16 v101, v101
v_add_u32_sdwa v105, s42, v132 dst_sel:DWORD dst_unused:UNUSED_PAD src0_sel:DWORD src1_sel:WORD_1
v_smfmac_f32_16x16x64_bf16 v[36:39], a[136:139], v[68:75], v153 abid:1
buffer_store_dwordx2 v[112:113], v5, s[20:23], s46 offen nt
ds_read_u16 v83, v83
v_add_u32_sdwa v106, s42, v133 dst_sel:DWORD dst_unused:UNUSED_PAD src0_sel:DWORD src1_sel:WORD_0
v_smfmac_f32_16x16x64_bf16 v[40:43], a[104:107], v[60:67], v175
s_mov_b32 s46, s48
ds_read_b128 v[114:117], v2 offset:192
v_add_u32_sdwa v107, s42, v133 dst_sel:DWORD dst_unused:UNUSED_PAD src0_sel:DWORD src1_sel:WORD_1
v_smfmac_f32_16x16x64_bf16 v[40:43], a[140:143], v[68:75], v175 abid:1
s_waitcnt lgkmcnt(12)
ds_read_u16 v102, v102
v_add_u32_sdwa v84, s42, v134 dst_sel:DWORD dst_unused:UNUSED_PAD src0_sel:DWORD src1_sel:WORD_0
v_smfmac_f32_16x16x64_bf16 v[8:11], a[144:147], v[44:51], v154
s_waitcnt lgkmcnt(9)
ds_read_u16 v103, v103
v_add_u32_sdwa v85, s42, v134 dst_sel:DWORD dst_unused:UNUSED_PAD src0_sel:DWORD src1_sel:WORD_1
v_smfmac_f32_16x16x64_bf16 v[8:11], a[180:183], v[52:59], v158
s_waitcnt lgkmcnt(7)
ds_read_u16 v104, v104
v_add_u32_sdwa v86, s42, v135 dst_sel:DWORD dst_unused:UNUSED_PAD src0_sel:DWORD src1_sel:WORD_0
v_smfmac_f32_16x16x64_bf16 v[8:11], a[216:219], v[92:99], v162
s_mov_b32 s48, s49
ds_read_u16 v105, v105
v_add_u32_sdwa v87, s42, v135 dst_sel:DWORD dst_unused:UNUSED_PAD src0_sel:DWORD src1_sel:WORD_1
v_smfmac_f32_16x16x64_bf16 v[24:27], a[160:163], v[44:51], v156
s_add_u32 m0, s44, 0
ds_read_u16 v106, v106
v_add_u32_sdwa v88, s42, v136 dst_sel:DWORD dst_unused:UNUSED_PAD src0_sel:DWORD src1_sel:WORD_0
v_smfmac_f32_16x16x64_bf16 v[24:27], a[196:199], v[52:59], v160
buffer_load_dwordx4 v3, s[16:19], s45 offen offset:0 nt lds
v_add_u32_sdwa v89, s42, v136 dst_sel:DWORD dst_unused:UNUSED_PAD src0_sel:DWORD src1_sel:WORD_1
v_smfmac_f32_16x16x64_bf16 v[24:27], a[232:235], v[92:99], v164
s_waitcnt lgkmcnt(5)
ds_read_u16 v107, v107
v_add_u32_sdwa v90, s42, v137 dst_sel:DWORD dst_unused:UNUSED_PAD src0_sel:DWORD src1_sel:WORD_0
v_smfmac_f32_16x16x64_bf16 v[24:27], v[114:117], v[76:83], v182
s_mov_b32 s49, s50
ds_read_u16 v84, v84
v_add_u32_sdwa v91, s42, v137 dst_sel:DWORD dst_unused:UNUSED_PAD src0_sel:DWORD src1_sel:WORD_1
v_smfmac_f32_16x16x64_bf16 v[28:31], v[114:117], v[76:83], v182 abid:1
s_mov_b32 s50, s45
ds_read_b128 v[114:117], v2 offset:256
v_add_u32_sdwa v76, s4, v118 dst_sel:DWORD dst_unused:UNUSED_PAD src0_sel:DWORD src1_sel:WORD_0
v_smfmac_f32_16x16x64_bf16 v[28:31], a[164:167], v[44:51], v156 abid:1
ds_read_u16 v85, v85
v_add_u32_sdwa v77, s4, v118 dst_sel:DWORD dst_unused:UNUSED_PAD src0_sel:DWORD src1_sel:WORD_1
v_smfmac_f32_16x16x64_bf16 v[28:31], a[200:203], v[52:59], v160 abid:1
ds_read_u16 v86, v86
v_add_u32_sdwa v78, s4, v119 dst_sel:DWORD dst_unused:UNUSED_PAD src0_sel:DWORD src1_sel:WORD_0
v_smfmac_f32_16x16x64_bf16 v[28:31], a[236:239], v[92:99], v164 abid:1
ds_read_u16 v87, v87
v_add_u32_sdwa v79, s4, v119 dst_sel:DWORD dst_unused:UNUSED_PAD src0_sel:DWORD src1_sel:WORD_1
v_smfmac_f32_16x16x64_bf16 v[12:15], a[148:151], v[44:51], v154 abid:1
s_add_u32 m0, s44, 3840
ds_read_u16 v88, v88
v_add_u32_sdwa v80, s4, v120 dst_sel:DWORD dst_unused:UNUSED_PAD src0_sel:DWORD src1_sel:WORD_0
v_smfmac_f32_16x16x64_bf16 v[12:15], a[184:187], v[52:59], v158 abid:1
buffer_load_dwordx4 v3, s[16:19], s45 offen offset:256 nt lds
v_add_u32_sdwa v81, s4, v120 dst_sel:DWORD dst_unused:UNUSED_PAD src0_sel:DWORD src1_sel:WORD_1
v_smfmac_f32_16x16x64_bf16 v[12:15], a[220:223], v[92:99], v162 abid:1
ds_read_b128 v[60:63], v0 offset:14336
v_add_u32_sdwa v82, s4, v121 dst_sel:DWORD dst_unused:UNUSED_PAD src0_sel:DWORD src1_sel:WORD_0
v_smfmac_f32_16x16x64_bf16 v[32:35], a[168:171], v[44:51], v157
s_waitcnt vmcnt(7)
ds_read_u16 v89, v89
v_add_u32_sdwa v83, s4, v121 dst_sel:DWORD dst_unused:UNUSED_PAD src0_sel:DWORD src1_sel:WORD_1
v_smfmac_f32_16x16x64_bf16 v[32:35], a[204:207], v[52:59], v161
ds_read_b128 v[64:67], v1 offset:14336
v_smfmac_f32_16x16x64_bf16 v[32:35], a[240:243], v[92:99], v165
s_waitcnt lgkmcnt(7)
ds_read_b128 v[68:71], v0 offset:16384
v_smfmac_f32_16x16x64_bf16 v[32:35], v[114:117], v[100:107], v183 abid:1
ds_read_u16 v90, v90
v_smfmac_f32_16x16x64_bf16 v[36:39], v[114:117], v[100:107], v184
ds_read_b128 v[72:75], v1 offset:16384
v_add_u32 v0, s43, v0
v_smfmac_f32_16x16x64_bf16 v[36:39], a[172:175], v[44:51], v157 abid:1
s_add_u32 m0, s44, 7680
ds_read_u16 v91, v91
v_add_u32 v1, s43, v1
v_smfmac_f32_16x16x64_bf16 v[36:39], a[208:211], v[52:59], v161 abid:1
buffer_load_dwordx4 v3, s[16:19], s45 offen offset:512 nt lds
v_smfmac_f32_16x16x64_bf16 v[36:39], a[244:247], v[92:99], v165 abid:1
ds_read_b128 v[114:117], v2 offset:320
v_smfmac_f32_16x16x64_bf16 v[16:19], a[152:155], v[44:51], v155
s_add_u32 m0, s44, 11520
v_smfmac_f32_16x16x64_bf16 v[16:19], a[188:191], v[52:59], v159
buffer_load_dwordx4 v3, s[16:19], s45 offen offset:768 nt lds
v_smfmac_f32_16x16x64_bf16 v[16:19], a[224:227], v[92:99], v163
s_mov_b64 exec, s[62:63]
ds_write_b32 v0, v7 offset:18432
s_mov_b64 exec, -1
v_smfmac_f32_16x16x64_bf16 v[20:23], a[156:159], v[44:51], v155 abid:1
s_add_u32 m0, s44, s8
v_smfmac_f32_16x16x64_bf16 v[20:23], a[192:195], v[52:59], v159 abid:1
s_mov_b64 exec, s[10:11]
buffer_load_dwordx4 v3, s[16:19], s7 offen offset:896 nt lds
s_mov_b64 exec, -1
v_smfmac_f32_16x16x64_bf16 v[20:23], a[228:231], v[92:99], v163 abid:1
s_add_u32 s44, s44, s5
s_cmp_ge_u32 s44, 148480
s_cselect_b32 s44, s9, s44
v_smfmac_f32_16x16x64_bf16 v[40:43], a[176:179], v[44:51], v176
v_smfmac_f32_16x16x64_bf16 v[40:43], a[212:215], v[52:59], v176 abid:1
v_smfmac_f32_16x16x64_bf16 v[40:43], a[248:251], v[92:99], v177
s_waitcnt lgkmcnt(0)
v_smfmac_f32_16x16x64_bf16 v[40:43], v[114:117], v[84:91], v185
s_barrier
v_smfmac_f32_16x16x64_bf16 v[8:11], a[252:255], v[60:67], v166
s_mov_b32 s42, s4
ds_read_b32 v7, v0 offset:18432
v_smfmac_f32_16x16x64_bf16 v[8:11], v[218:221], v[68:75], v170
ds_read_b128 v[44:47], v0 offset:0
v_add_u32_sdwa v84, s42, v122 dst_sel:DWORD dst_unused:UNUSED_PAD src0_sel:DWORD src1_sel:WORD_0
v_smfmac_f32_16x16x64_bf16 v[12:15], v[186:189], v[60:67], v166 abid:1
ds_read_b128 v[48:51], v1 offset:0
v_add_u32_sdwa v85, s42, v122 dst_sel:DWORD dst_unused:UNUSED_PAD src0_sel:DWORD src1_sel:WORD_1
v_smfmac_f32_16x16x64_bf16 v[12:15], v[222:225], v[68:75], v170 abid:1
ds_read_b128 v[52:55], v0 offset:2048
v_add_u32_sdwa v86, s42, v123 dst_sel:DWORD dst_unused:UNUSED_PAD src0_sel:DWORD src1_sel:WORD_0
v_smfmac_f32_16x16x64_bf16 v[16:19], v[190:193], v[60:67], v167
ds_read_b128 v[56:59], v1 offset:2048
v_cvt_pk_bf16_f32 v92, v8, v9
v_smfmac_f32_16x16x64_bf16 v[16:19], v[226:229], v[68:75], v171
ds_read_u16 v76, v76
v_cvt_pk_bf16_f32 v93, v10, v11
v_smfmac_f32_16x16x64_bf16 v[20:23], v[194:197], v[60:67], v167 abid:1
ds_read_b128 v[8:11], v2 offset:1024
v_cvt_pk_bf16_f32 v94, v12, v13
v_smfmac_f32_16x16x64_bf16 v[20:23], v[230:233], v[68:75], v171 abid:1
ds_read_u16 v77, v77
v_cvt_pk_bf16_f32 v95, v14, v15
v_smfmac_f32_16x16x64_bf16 v[24:27], v[198:201], v[60:67], v168
ds_read_b128 v[12:15], v2 offset:1088
v_cvt_pk_bf16_f32 v96, v16, v17
v_smfmac_f32_16x16x64_bf16 v[24:27], v[234:237], v[68:75], v172
s_waitcnt lgkmcnt(8)
ds_read_u16 v78, v78
v_cvt_pk_bf16_f32 v97, v18, v19
v_readfirstlane_b32 s56, v7
v_smfmac_f32_16x16x64_bf16 v[28:31], v[202:205], v[60:67], v168 abid:1
s_lshr_b32 s60, s56, 4
ds_read_b128 v[16:19], v2 offset:1152
v_cvt_pk_bf16_f32 v98, v20, v21
v_smfmac_f32_16x16x64_bf16 v[28:31], v[238:241], v[68:75], v172 abid:1
s_mul_i32 s60, s60, 884736
ds_read_u16 v79, v79
v_cvt_pk_bf16_f32 v99, v22, v23
v_smfmac_f32_16x16x64_bf16 v[32:35], v[206:209], v[60:67], v169
s_mul_i32 s61, s56, 18432
ds_read_b128 v[20:23], v2 offset:1216
v_cvt_pk_bf16_f32 v100, v24, v25
v_smfmac_f32_16x16x64_bf16 v[32:35], v[242:245], v[68:75], v173
s_add_u32 s60, s60, s57
ds_read_u16 v80, v80
v_cvt_pk_bf16_f32 v101, v26, v27
v_smfmac_f32_16x16x64_bf16 v[36:39], v[210:213], v[60:67], v169 abid:1
s_add_u32 s45, s60, s61
ds_read_b128 v[24:27], v2 offset:1280
v_cvt_pk_bf16_f32 v102, v28, v29
v_smfmac_f32_16x16x64_bf16 v[36:39], v[246:249], v[68:75], v173 abid:1
ds_read_u16 v81, v81
v_cvt_pk_bf16_f32 v103, v30, v31
v_smfmac_f32_16x16x64_bf16 v[40:43], v[214:217], v[60:67], v177 abid:1
s_cmp_lt_u32 s56, s64
ds_read_b128 v[28:31], v2 offset:1344
v_cvt_pk_bf16_f32 v104, v32, v33
v_smfmac_f32_16x16x64_bf16 v[40:43], v[250:253], v[68:75], v178
s_waitcnt lgkmcnt(10)
v_cvt_pk_bf16_f32 v105, v34, v35
s_cbranch_scc1 L_loopc
s_mov_b32 s41, 0
s_mov_b32 s15, 3
s_mov_b32 s12, 7
s_mov_b32 s92, 4
s_mov_b32 s87, 4
s_mov_b32 s59, -1
.p2align 3
L_loopn:
v_smfmac_f32_16x16x64_bf16 v[8:11], a[0:3], v[44:51], v138
ds_read_b128 v[32:35], v2 offset:1408
v_cvt_pk_bf16_f32 v106, v36, v37
v_smfmac_f32_16x16x64_bf16 v[8:11], a[36:39], v[52:59], v142
s_waitcnt lgkmcnt(9)
v_cvt_pk_bf16_f32 v107, v38, v39
v_smfmac_f32_16x16x64_bf16 v[12:15], a[4:7], v[44:51], v138 abid:1
ds_read_b128 v[36:39], v2 offset:1472
v_cvt_pk_bf16_f32 v112, v40, v41
v_smfmac_f32_16x16x64_bf16 v[12:15], a[40:43], v[52:59], v142 abid:1
s_waitcnt lgkmcnt(8)
ds_read_b128 v[60:63], v0 offset:4096
v_cvt_pk_bf16_f32 v113, v42, v43
v_smfmac_f32_16x16x64_bf16 v[16:19], a[8:11], v[44:51], v139
s_cmp_eq_u32 s4, 129920
ds_read_b128 v[40:43], v2 offset:1536
v_cndmask_b32_dpp v108, v96, v92, vcc quad_perm:[1,0,3,2] row_mask:0xf bank_mask:0xf
v_smfmac_f32_16x16x64_bf16 v[16:19], a[44:47], v[52:59], v143
s_waitcnt lgkmcnt(8)
ds_read_u16 v82, v82
v_cndmask_b32_dpp v109, v97, v93, vcc quad_perm:[1,0,3,2] row_mask:0xf bank_mask:0xf
v_smfmac_f32_16x16x64_bf16 v[20:23], a[12:15], v[44:51], v139 abid:1
s_cselect_b32 s43, -129920, s5
ds_read_u16 v84, v84
v_cndmask_b32_dpp v110, v98, v94, vcc quad_perm:[1,0,3,2] row_mask:0xf bank_mask:0xf
v_smfmac_f32_16x16x64_bf16 v[20:23], a[48:51], v[52:59], v143 abid:1
s_waitcnt lgkmcnt(8)
ds_read_b128 v[64:67], v1 offset:4096
v_cndmask_b32_dpp v111, v99, v95, vcc quad_perm:[1,0,3,2] row_mask:0xf bank_mask:0xf
v_smfmac_f32_16x16x64_bf16 v[24:27], a[16:19], v[44:51], v140
s_add_u32 s4, s4, s43
ds_read_b128 v[68:71], v0 offset:6144
v_add_u32_sdwa v87, s42, v123 dst_sel:DWORD dst_unused:UNUSED_PAD src0_sel:DWORD src1_sel:WORD_1
v_smfmac_f32_16x16x64_bf16 v[24:27], a[52:55], v[52:59], v144
buffer_store_dwordx4 v[108:111], v4, s[20:23], s46 offen offset:0 sc1
s_mov_b64 vcc, s[82:83]
s_waitcnt lgkmcnt(8)
ds_read_b128 v[72:75], v1 offset:6144
v_cndmask_b32_dpp v96, v92, v96, vcc quad_perm:[1,0,3,2] row_mask:0xf bank_mask:0xf
v_cndmask_b32_dpp v97, v93, v97, vcc quad_perm:[1,0,3,2] row_mask:0xf bank_mask:0xf
v_smfmac_f32_16x16x64_bf16 v[28:31], a[20:23], v[44:51], v140 abid:1
s_add_u32 s41, s41, 1
ds_read_u16 v83, v83
v_cndmask_b32_dpp v98, v94, v98, vcc quad_perm:[1,0,3,2] row_mask:0xf bank_mask:0xf
v_smfmac_f32_16x16x64_bf16 v[28:31], a[56:59], v[52:59], v144 abid:1
s_waitcnt lgkmcnt(9)
ds_read_b128 v[114:117], v2 offset:64
v_cndmask_b32_dpp v99, v95, v99, vcc quad_perm:[1,0,3,2] row_mask:0xf bank_mask:0xf
v_smfmac_f32_16x16x64_bf16 v[32:35], a[24:27], v[44:51], v141
ds_read_u16 v85, v85
v_add_u32_sdwa v88, s42, v124 dst_sel:DWORD dst_unused:UNUSED_PAD src0_sel:DWORD src1_sel:WORD_0
v_smfmac_f32_16x16x64_bf16 v[32:35], a[60:63], v[52:59], v145
s_waitcnt lgkmcnt(10)
ds_read_u16 v86, v86
v_add_u32_sdwa v89, s42, v124 dst_sel:DWORD dst_unused:UNUSED_PAD src0_sel:DWORD src1_sel:WORD_1
v_smfmac_f32_16x16x64_bf16 v[36:39], a[28:31], v[44:51], v141 abid:1
ds_read_u16 v87, v87
v_add_u32_sdwa v90, s42, v125 dst_sel:DWORD dst_unused:UNUSED_PAD src0_sel:DWORD src1_sel:WORD_0
v_smfmac_f32_16x16x64_bf16 v[36:39], a[64:67], v[52:59], v145 abid:1
s_waitcnt lgkmcnt(10)
ds_read_u16 v88, v88
v_add_u32_sdwa v91, s42, v125 dst_sel:DWORD dst_unused:UNUSED_PAD src0_sel:DWORD src1_sel:WORD_1
v_smfmac_f32_16x16x64_bf16 v[40:43], a[32:35], v[44:51], v174
buffer_store_dwordx4 v[96:99], v4, s[20:23], s46 offen offset:1152 sc1
s_mov_b64 vcc, s[80:81]
ds_read_u16 v89, v89
v_cndmask_b32_dpp v92, v104, v100, vcc quad_perm:[1,0,3,2] row_mask:0xf bank_mask:0xf
v_cndmask_b32_dpp v93, v105, v101, vcc quad_perm:[1,0,3,2] row_mask:0xf bank_mask:0xf
v_smfmac_f32_16x16x64_bf16 v[40:43], a[68:71], v[52:59], v174 abid:1
s_waitcnt lgkmcnt(9)
ds_read_u16 v90, v90
v_cndmask_b32_dpp v94, v106, v102, vcc quad_perm:[1,0,3,2] row_mask:0xf bank_mask:0xf
v_smfmac_f32_16x16x64_bf16 v[8:11], a[72:75], v[60:67], v146
s_waitcnt lgkmcnt(8)
ds_read_u16 v91, v91
v_cndmask_b32_dpp v95, v107, v103, vcc quad_perm:[1,0,3,2] row_mask:0xf bank_mask:0xf
v_smfmac_f32_16x16x64_bf16 v[8:11], a[108:111], v[68:75], v150
s_waitcnt lgkmcnt(7)
ds_bpermute_b32 v112, v6, v112
v_smfmac_f32_16x16x64_bf16 v[8:11], v[114:117], v[76:83], v179
ds_bpermute_b32 v113, v6, v113
v_smfmac_f32_16x16x64_bf16 v[12:15], v[114:117], v[76:83], v179 abid:1
ds_read_b128 v[114:117], v2 offset:128
v_add_u32_sdwa v76, s42, v126 dst_sel:DWORD dst_unused:UNUSED_PAD src0_sel:DWORD src1_sel:WORD_0
v_smfmac_f32_16x16x64_bf16 v[12:15], a[76:79], v[60:67], v146 abid:1
ds_read_u16 v76, v76
v_add_u32_sdwa v77, s42, v126 dst_sel:DWORD dst_unused:UNUSED_PAD src0_sel:DWORD src1_sel:WORD_1
v_smfmac_f32_16x16x64_bf16 v[12:15], a[112:115], v[68:75], v150 abid:1
buffer_store_dwordx4 v[92:95], v4, s[20:23], s46 offen offset:128 sc1
s_mov_b64 vcc, s[82:83]
ds_read_u16 v77, v77
v_cndmask_b32_dpp v104, v100, v104, vcc quad_perm:[1,0,3,2] row_mask:0xf bank_mask:0xf
v_add_u32_sdwa v78, s42, v127 dst_sel:DWORD dst_unused:UNUSED_PAD src0_sel:DWORD src1_sel:WORD_0
v_smfmac_f32_16x16x64_bf16 v[24:27], a[88:91], v[60:67], v148
ds_read_u16 v78, v78
v_cndmask_b32_dpp v105, v101, v105, vcc quad_perm:[1,0,3,2] row_mask:0xf bank_mask:0xf
v_smfmac_f32_16x16x64_bf16 v[24:27], a[124:127], v[68:75], v152
ds_read_b128 v[44:47], v0 offset:8192
v_cndmask_b32_dpp v106, v102, v106, vcc quad_perm:[1,0,3,2] row_mask:0xf bank_mask:0xf
v_smfmac_f32_16x16x64_bf16 v[28:31], a[92:95], v[60:67], v148 abid:1
ds_read_b128 v[48:51], v1 offset:8192
v_add_u32_sdwa v79, s42, v127 dst_sel:DWORD dst_unused:UNUSED_PAD src0_sel:DWORD src1_sel:WORD_1
v_smfmac_f32_16x16x64_bf16 v[28:31], a[128:131], v[68:75], v152 abid:1
ds_read_u16 v79, v79
v_cndmask_b32_dpp v107, v103, v107, vcc quad_perm:[1,0,3,2] row_mask:0xf bank_mask:0xf
v_smfmac_f32_16x16x64_bf16 v[32:35], a[96:99], v[60:67], v149
ds_read_b128 v[52:55], v0 offset:10240
v_add_u32_sdwa v80, s42, v128 dst_sel:DWORD dst_unused:UNUSED_PAD src0_sel:DWORD src1_sel:WORD_0
v_smfmac_f32_16x16x64_bf16 v[32:35], a[132:135], v[68:75], v153
ds_read_u16 v80, v80
v_add_u32_sdwa v81, s42, v128 dst_sel:DWORD dst_unused:UNUSED_PAD src0_sel:DWORD src1_sel:WORD_1
v_smfmac_f32_16x16x64_bf16 v[16:19], a[80:83], v[60:67], v147
buffer_store_dwordx4 v[104:107], v4, s[20:23], s46 offen offset:1280 sc1
s_mov_b64 vcc, s[80:81]
ds_read_b128 v[56:59], v1 offset:10240
v_add_u32_sdwa v82, s42, v129 dst_sel:DWORD dst_unused:UNUSED_PAD src0_sel:DWORD src1_sel:WORD_0
v_add_u32_sdwa v83, s42, v129 dst_sel:DWORD dst_unused:UNUSED_PAD src0_sel:DWORD src1_sel:WORD_1
v_smfmac_f32_16x16x64_bf16 v[16:19], a[116:119], v[68:75], v151
s_waitcnt lgkmcnt(9)
ds_read_b128 v[92:95], v0 offset:12288
v_add_u32_sdwa v100, s42, v130 dst_sel:DWORD dst_unused:UNUSED_PAD src0_sel:DWORD src1_sel:WORD_0
v_smfmac_f32_16x16x64_bf16 v[16:19], v[114:117], v[84:91], v180 abid:1
ds_read_u16 v81, v81
v_add_u32_sdwa v101, s42, v130 dst_sel:DWORD dst_unused:UNUSED_PAD src0_sel:DWORD src1_sel:WORD_1
v_smfmac_f32_16x16x64_bf16 v[20:23], v[114:117], v[84:91], v181
ds_read_b128 v[96:99], v1 offset:12288
v_add_u32_sdwa v102, s42, v131 dst_sel:DWORD dst_unused:UNUSED_PAD src0_sel:DWORD src1_sel:WORD_0
v_smfmac_f32_16x16x64_bf16 v[20:23], a[84:87], v[60:67], v147 abid:1
ds_read_u16 v100, v100
v_add_u32_sdwa v103, s42, v131 dst_sel:DWORD dst_unused:UNUSED_PAD src0_sel:DWORD src1_sel:WORD_1
v_smfmac_f32_16x16x64_bf16 v[20:23], a[120:123], v[68:75], v151 abid:1
ds_read_u16 v82, v82
v_add_u32_sdwa v104, s42, v132 dst_sel:DWORD dst_unused:UNUSED_PAD src0_sel:DWORD src1_sel:WORD_0
v_smfmac_f32_16x16x64_bf16 v[36:39], a[100:103], v[60:67], v149 abid:1
ds_read_u16 v101, v101
v_add_u32_sdwa v105, s42, v132 dst_sel:DWORD dst_unused:UNUSED_PAD src0_sel:DWORD src1_sel:WORD_1
v_smfmac_f32_16x16x64_bf16 v[36:39], a[136:139], v[68:75], v153 abid:1
buffer_store_dwordx2 v[112:113], v5, s[20:23], s46 offen nt
ds_read_u16 v83, v83
v_add_u32_sdwa v106, s42, v133 dst_sel:DWORD dst_unused:UNUSED_PAD src0_sel:DWORD src1_sel:WORD_0
v_smfmac_f32_16x16x64_bf16 v[40:43], a[104:107], v[60:67], v175
s_mov_b32 s22, 75497472
ds_read_b128 v[114:117], v2 offset:192
v_add_u32_sdwa v107, s42, v133 dst_sel:DWORD dst_unused:UNUSED_PAD src0_sel:DWORD src1_sel:WORD_1
v_smfmac_f32_16x16x64_bf16 v[40:43], a[140:143], v[68:75], v175 abid:1
s_waitcnt lgkmcnt(12)
ds_read_u16 v102, v102
v_add_u32_sdwa v84, s42, v134 dst_sel:DWORD dst_unused:UNUSED_PAD src0_sel:DWORD src1_sel:WORD_0
v_smfmac_f32_16x16x64_bf16 v[8:11], a[144:147], v[44:51], v154
s_waitcnt lgkmcnt(9)
ds_read_u16 v103, v103
v_add_u32_sdwa v85, s42, v134 dst_sel:DWORD dst_unused:UNUSED_PAD src0_sel:DWORD src1_sel:WORD_1
v_smfmac_f32_16x16x64_bf16 v[8:11], a[180:183], v[52:59], v158
s_waitcnt lgkmcnt(7)
ds_read_u16 v104, v104
v_add_u32_sdwa v86, s42, v135 dst_sel:DWORD dst_unused:UNUSED_PAD src0_sel:DWORD src1_sel:WORD_0
v_smfmac_f32_16x16x64_bf16 v[8:11], a[216:219], v[92:99], v162
s_mov_b32 s46, s48
ds_read_u16 v105, v105
v_add_u32_sdwa v87, s42, v135 dst_sel:DWORD dst_unused:UNUSED_PAD src0_sel:DWORD src1_sel:WORD_1
v_smfmac_f32_16x16x64_bf16 v[24:27], a[160:163], v[44:51], v156
s_mov_b32 s48, s49
ds_read_u16 v106, v106
v_add_u32_sdwa v88, s42, v136 dst_sel:DWORD dst_unused:UNUSED_PAD src0_sel:DWORD src1_sel:WORD_0
v_smfmac_f32_16x16x64_bf16 v[24:27], a[196:199], v[52:59], v160
s_mov_b32 s49, s50
s_add_u32 s50, s50, 4718592
v_add_u32_sdwa v89, s42, v136 dst_sel:DWORD dst_unused:UNUSED_PAD src0_sel:DWORD src1_sel:WORD_1
v_smfmac_f32_16x16x64_bf16 v[24:27], a[232:235], v[92:99], v164
s_waitcnt lgkmcnt(5)
ds_read_u16 v107, v107
v_add_u32_sdwa v90, s42, v137 dst_sel:DWORD dst_unused:UNUSED_PAD src0_sel:DWORD src1_sel:WORD_0
v_smfmac_f32_16x16x64_bf16 v[24:27], v[114:117], v[76:83], v182
ds_read_u16 v84, v84
v_add_u32_sdwa v91, s42, v137 dst_sel:DWORD dst_unused:UNUSED_PAD src0_sel:DWORD src1_sel:WORD_1
v_smfmac_f32_16x16x64_bf16 v[28:31], v[114:117], v[76:83], v182 abid:1
ds_read_b128 v[114:117], v2 offset:256
v_add_u32_sdwa v76, s4, v118 dst_sel:DWORD dst_unused:UNUSED_PAD src0_sel:DWORD src1_sel:WORD_0
v_smfmac_f32_16x16x64_bf16 v[28:31], a[164:167], v[44:51], v156 abid:1
ds_read_u16 v85, v85
v_add_u32_sdwa v77, s4, v118 dst_sel:DWORD dst_unused:UNUSED_PAD src0_sel:DWORD src1_sel:WORD_1
v_smfmac_f32_16x16x64_bf16 v[28:31], a[200:203], v[52:59], v160 abid:1
ds_read_u16 v86, v86
v_add_u32_sdwa v78, s4, v119 dst_sel:DWORD dst_unused:UNUSED_PAD src0_sel:DWORD src1_sel:WORD_0
v_smfmac_f32_16x16x64_bf16 v[28:31], a[236:239], v[92:99], v164 abid:1
ds_read_u16 v87, v87
v_add_u32_sdwa v79, s4, v119 dst_sel:DWORD dst_unused:UNUSED_PAD src0_sel:DWORD src1_sel:WORD_1
v_smfmac_f32_16x16x64_bf16 v[12:15], a[148:151], v[44:51], v154 abid:1
ds_read_u16 v88, v88
v_add_u32_sdwa v80, s4, v120 dst_sel:DWORD dst_unused:UNUSED_PAD src0_sel:DWORD src1_sel:WORD_0
v_smfmac_f32_16x16x64_bf16 v[12:15], a[184:187], v[52:59], v158 abid:1
v_add_u32_sdwa v81, s4, v120 dst_sel:DWORD dst_unused:UNUSED_PAD src0_sel:DWORD src1_sel:WORD_1
v_smfmac_f32_16x16x64_bf16 v[12:15], a[220:223], v[92:99], v162 abid:1
ds_read_b128 v[60:63], v0 offset:14336
v_add_u32_sdwa v82, s4, v121 dst_sel:DWORD dst_unused:UNUSED_PAD src0_sel:DWORD src1_sel:WORD_0
v_smfmac_f32_16x16x64_bf16 v[32:35], a[168:171], v[44:51], v157
ds_read_u16 v89, v89
v_add_u32_sdwa v83, s4, v121 dst_sel:DWORD dst_unused:UNUSED_PAD src0_sel:DWORD src1_sel:WORD_1
v_smfmac_f32_16x16x64_bf16 v[32:35], a[204:207], v[52:59], v161
ds_read_b128 v[64:67], v1 offset:14336
v_smfmac_f32_16x16x64_bf16 v[32:35], a[240:243], v[92:99], v165
s_waitcnt lgkmcnt(7)
ds_read_b128 v[68:71], v0 offset:16384
v_smfmac_f32_16x16x64_bf16 v[32:35], v[114:117], v[100:107], v183 abid:1
ds_read_u16 v90, v90
v_smfmac_f32_16x16x64_bf16 v[36:39], v[114:117], v[100:107], v184
ds_read_b128 v[72:75], v1 offset:16384
v_add_u32 v0, s43, v0
v_smfmac_f32_16x16x64_bf16 v[36:39], a[172:175], v[44:51], v157 abid:1
ds_read_u16 v91, v91
v_add_u32 v1, s43, v1
v_smfmac_f32_16x16x64_bf16 v[36:39], a[208:211], v[52:59], v161 abid:1
v_smfmac_f32_16x16x64_bf16 v[36:39], a[244:247], v[92:99], v165 abid:1
ds_read_b128 v[114:117], v2 offset:320
v_smfmac_f32_16x16x64_bf16 v[16:19], a[152:155], v[44:51], v155
v_smfmac_f32_16x16x64_bf16 v[16:19], a[188:191], v[52:59], v159
v_smfmac_f32_16x16x64_bf16 v[16:19], a[224:227], v[92:99], v163
v_smfmac_f32_16x16x64_bf16 v[20:23], a[156:159], v[44:51], v155 abid:1
v_smfmac_f32_16x16x64_bf16 v[20:23], a[192:195], v[52:59], v159 abid:1
v_smfmac_f32_16x16x64_bf16 v[20:23], a[228:231], v[92:99], v163 abid:1
v_smfmac_f32_16x16x64_bf16 v[40:43], a[176:179], v[44:51], v176
s_bitcmp1_b32 s92, s41
v_smfmac_f32_16x16x64_bf16 v[40:43], a[212:215], v[52:59], v176 abid:1
s_cbranch_scc1 L_loopn_w
L_loopn_wb:
v_smfmac_f32_16x16x64_bf16 v[40:43], a[248:251], v[92:99], v177
s_waitcnt lgkmcnt(0)
v_smfmac_f32_16x16x64_bf16 v[40:43], v[114:117], v[84:91], v185
s_waitcnt vmcnt(20)
s_barrier
L_loopn_p3:
v_smfmac_f32_16x16x64_bf16 v[8:11], a[252:255], v[60:67], v166
s_mov_b32 s42, s4
v_smfmac_f32_16x16x64_bf16 v[8:11], v[218:221], v[68:75], v170
ds_read_b128 v[44:47], v0 offset:0
v_add_u32_sdwa v84, s42, v122 dst_sel:DWORD dst_unused:UNUSED_PAD src0_sel:DWORD src1_sel:WORD_0
v_smfmac_f32_16x16x64_bf16 v[12:15], v[186:189], v[60:67], v166 abid:1
ds_read_b128 v[48:51], v1 offset:0
v_add_u32_sdwa v85, s42, v122 dst_sel:DWORD dst_unused:UNUSED_PAD src0_sel:DWORD src1_sel:WORD_1
v_smfmac_f32_16x16x64_bf16 v[12:15], v[222:225], v[68:75], v170 abid:1
ds_read_b128 v[52:55], v0 offset:2048
v_add_u32_sdwa v86, s42, v123 dst_sel:DWORD dst_unused:UNUSED_PAD src0_sel:DWORD src1_sel:WORD_0
v_smfmac_f32_16x16x64_bf16 v[16:19], v[190:193], v[60:67], v167
ds_read_b128 v[56:59], v1 offset:2048
v_cvt_pk_bf16_f32 v92, v8, v9
v_smfmac_f32_16x16x64_bf16 v[16:19], v[226:229], v[68:75], v171
ds_read_u16 v76, v76
v_cvt_pk_bf16_f32 v93, v10, v11
v_smfmac_f32_16x16x64_bf16 v[20:23], v[194:197], v[60:67], v167 abid:1
ds_read_b128 v[8:11], v2 offset:1024
v_cvt_pk_bf16_f32 v94, v12, v13
v_smfmac_f32_16x16x64_bf16 v[20:23], v[230:233], v[68:75], v171 abid:1
ds_read_u16 v77, v77
v_cvt_pk_bf16_f32 v95, v14, v15
v_smfmac_f32_16x16x64_bf16 v[24:27], v[198:201], v[60:67], v168
ds_read_b128 v[12:15], v2 offset:1088
v_cvt_pk_bf16_f32 v96, v16, v17
v_smfmac_f32_16x16x64_bf16 v[24:27], v[234:237], v[68:75], v172
ds_read_u16 v78, v78
v_cvt_pk_bf16_f32 v97, v18, v19
v_smfmac_f32_16x16x64_bf16 v[28:31], v[202:205], v[60:67], v168 abid:1
ds_read_b128 v[16:19], v2 offset:1152
v_cvt_pk_bf16_f32 v98, v20, v21
v_smfmac_f32_16x16x64_bf16 v[28:31], v[238:241], v[68:75], v172 abid:1
ds_read_u16 v79, v79
v_cvt_pk_bf16_f32 v99, v22, v23
v_smfmac_f32_16x16x64_bf16 v[32:35], v[206:209], v[60:67], v169
ds_read_b128 v[20:23], v2 offset:1216
v_cvt_pk_bf16_f32 v100, v24, v25
v_smfmac_f32_16x16x64_bf16 v[32:35], v[242:245], v[68:75], v173
ds_read_u16 v80, v80
v_cvt_pk_bf16_f32 v101, v26, v27
v_smfmac_f32_16x16x64_bf16 v[36:39], v[210:213], v[60:67], v169 abid:1
ds_read_b128 v[24:27], v2 offset:1280
v_cvt_pk_bf16_f32 v102, v28, v29
v_smfmac_f32_16x16x64_bf16 v[36:39], v[246:249], v[68:75], v173 abid:1
ds_read_u16 v81, v81
v_cvt_pk_bf16_f32 v103, v30, v31
v_smfmac_f32_16x16x64_bf16 v[40:43], v[214:217], v[60:67], v177 abid:1
s_bitcmp1_b32 s12, s41
ds_read_b128 v[28:31], v2 offset:1344
v_cvt_pk_bf16_f32 v104, v32, v33
v_smfmac_f32_16x16x64_bf16 v[40:43], v[250:253], v[68:75], v178
s_waitcnt lgkmcnt(10)
v_cvt_pk_bf16_f32 v105, v34, v35
s_cbranch_scc1 L_loopn
s_cmp_eq_u32 s41, s59
s_cbranch_scc1 L_loopc
s_cmp_lt_u32 s41, s15
s_cbranch_scc1 L_loop
s_nop 0
v_cndmask_b32_dpp v108, v96, v92, vcc quad_perm:[1,0,3,2] row_mask:0xf bank_mask:0xf
v_cndmask_b32_dpp v109, v97, v93, vcc quad_perm:[1,0,3,2] row_mask:0xf bank_mask:0xf
v_cndmask_b32_dpp v110, v98, v94, vcc quad_perm:[1,0,3,2] row_mask:0xf bank_mask:0xf
v_cndmask_b32_dpp v111, v99, v95, vcc quad_perm:[1,0,3,2] row_mask:0xf bank_mask:0xf
buffer_store_dwordx4 v[108:111], v4, s[20:23], s46 offen offset:0 sc1
s_mov_b64 vcc, s[82:83]
v_cvt_pk_bf16_f32 v112, v40, v41
v_cvt_pk_bf16_f32 v113, v42, v43
ds_bpermute_b32 v112, v6, v112
ds_bpermute_b32 v113, v6, v113
v_cndmask_b32_dpp v96, v92, v96, vcc quad_perm:[1,0,3,2] row_mask:0xf bank_mask:0xf
v_cndmask_b32_dpp v97, v93, v97, vcc quad_perm:[1,0,3,2] row_mask:0xf bank_mask:0xf
v_cndmask_b32_dpp v98, v94, v98, vcc quad_perm:[1,0,3,2] row_mask:0xf bank_mask:0xf
v_cndmask_b32_dpp v99, v95, v99, vcc quad_perm:[1,0,3,2] row_mask:0xf bank_mask:0xf
buffer_store_dwordx4 v[96:99], v4, s[20:23], s46 offen offset:1152 sc1
s_mov_b64 vcc, s[80:81]
v_cvt_pk_bf16_f32 v106, v36, v37
v_cvt_pk_bf16_f32 v107, v38, v39
v_cndmask_b32_dpp v92, v104, v100, vcc quad_perm:[1,0,3,2] row_mask:0xf bank_mask:0xf
v_cndmask_b32_dpp v93, v105, v101, vcc quad_perm:[1,0,3,2] row_mask:0xf bank_mask:0xf
v_cndmask_b32_dpp v94, v106, v102, vcc quad_perm:[1,0,3,2] row_mask:0xf bank_mask:0xf
v_cndmask_b32_dpp v95, v107, v103, vcc quad_perm:[1,0,3,2] row_mask:0xf bank_mask:0xf
buffer_store_dwordx4 v[92:95], v4, s[20:23], s46 offen offset:128 sc1
s_mov_b64 vcc, s[82:83]
v_cndmask_b32_dpp v104, v100, v104, vcc quad_perm:[1,0,3,2] row_mask:0xf bank_mask:0xf
v_cndmask_b32_dpp v105, v101, v105, vcc quad_perm:[1,0,3,2] row_mask:0xf bank_mask:0xf
v_cndmask_b32_dpp v106, v102, v106, vcc quad_perm:[1,0,3,2] row_mask:0xf bank_mask:0xf
v_cndmask_b32_dpp v107, v103, v107, vcc quad_perm:[1,0,3,2] row_mask:0xf bank_mask:0xf
buffer_store_dwordx4 v[104:107], v4, s[20:23], s46 offen offset:1280 sc1
s_mov_b64 vcc, s[80:81]
s_waitcnt lgkmcnt(0)
buffer_store_dwordx2 v[112:113], v5, s[20:23], s46 offen nt
L_fin:
L_end_standalone__structured_sparse_n_m__ragged_kernel:
s_endpgm
L_more1:
v_and_b32 v73, v94, v16
v_lshrrev_b32 v72, 10, v16
v_cmp_eq_u32 s[64:65], v73, v95
v_and_or_b32 v32, v72, v96, v97
s_mov_b64 exec, s[64:65]
ds_add_rtn_u32 v48, v32, v88
s_mov_b64 exec, -1
v_and_b32 v73, v94, v17
v_lshrrev_b32 v72, 10, v17
v_cmp_eq_u32 s[66:67], v73, v95
v_and_or_b32 v33, v72, v96, v97
s_mov_b64 exec, s[66:67]
ds_add_rtn_u32 v49, v33, v88
s_mov_b64 exec, -1
v_and_b32 v73, v94, v18
v_lshrrev_b32 v72, 10, v18
v_cmp_eq_u32 s[68:69], v73, v95
v_and_or_b32 v34, v72, v96, v97
s_mov_b64 exec, s[68:69]
ds_add_rtn_u32 v50, v34, v88
s_mov_b64 exec, -1
v_and_b32 v73, v94, v19
v_lshrrev_b32 v72, 10, v19
v_cmp_eq_u32 s[70:71], v73, v95
v_and_or_b32 v35, v72, v96, v97
s_mov_b64 exec, s[70:71]
ds_add_rtn_u32 v51, v35, v88
s_mov_b64 exec, -1
v_and_b32 v73, v94, v20
v_lshrrev_b32 v72, 10, v20
v_cmp_eq_u32 s[72:73], v73, v95
v_and_or_b32 v36, v72, v96, v97
s_mov_b64 exec, s[72:73]
ds_add_rtn_u32 v52, v36, v88
s_mov_b64 exec, -1
v_and_b32 v73, v94, v21
v_lshrrev_b32 v72, 10, v21
v_cmp_eq_u32 s[74:75], v73, v95
v_and_or_b32 v37, v72, v96, v97
s_mov_b64 exec, s[74:75]
ds_add_rtn_u32 v53, v37, v88
s_mov_b64 exec, -1
v_and_b32 v73, v94, v22
v_lshrrev_b32 v72, 10, v22
v_cmp_eq_u32 s[76:77], v73, v95
v_and_or_b32 v38, v72, v96, v97
s_mov_b64 exec, s[76:77]
ds_add_rtn_u32 v54, v38, v88
s_mov_b64 exec, -1
s_branch L_more1b
L_greedy:
s_mov_b32 s47, 0
s_mov_b32 s89, 1
v_readlane_b32 s3, v72, 0
s_max_u32 s47, s47, 0
v_writelane_b32 v91, s47, 0
s_nop 1
s_add_u32 s47, s47, s3
s_cmp_gt_u32 s47, 32
s_cselect_b32 s90, 1, s90
v_readlane_b32 s3, v72, 1
s_max_u32 s47, s47, 0
v_writelane_b32 v91, s47, 1
s_nop 1
s_add_u32 s47, s47, s3
s_cmp_gt_u32 s47, 64
s_cselect_b32 s90, 1, s90
v_readlane_b32 s3, v72, 2
s_max_u32 s47, s47, 32
v_writelane_b32 v91, s47, 2
s_nop 1
s_add_u32 s47, s47, s3
s_cmp_gt_u32 s47, 64
s_cselect_b32 s90, 1, s90
v_readlane_b32 s3, v72, 3
s_max_u32 s47, s47, 32
v_writelane_b32 v91, s47, 3
s_nop 1
s_add_u32 s47, s47, s3
s_cmp_gt_u32 s47, 96
s_cselect_b32 s90, 1, s90
v_readlane_b32 s3, v72, 4
s_max_u32 s47, s47, 64
v_writelane_b32 v91, s47, 4
s_nop 1
s_add_u32 s47, s47, s3
s_cmp_gt_u32 s47, 96
s_cselect_b32 s90, 1, s90
v_readlane_b32 s3, v72, 5
s_max_u32 s47, s47, 64
v_writelane_b32 v91, s47, 5
s_nop 1
s_add_u32 s47, s47, s3
s_cmp_gt_u32 s47, 128
s_cselect_b32 s90, 1, s90
v_readlane_b32 s3, v72, 6
s_max_u32 s47, s47, 96
v_writelane_b32 v91, s47, 6
s_nop 1
s_add_u32 s47, s47, s3
s_cmp_gt_u32 s47, 128
s_cselect_b32 s90, 1, s90
v_readlane_b32 s3, v72, 7
s_max_u32 s47, s47, 96
v_writelane_b32 v91, s47, 7
s_nop 1
s_add_u32 s47, s47, s3
s_cmp_gt_u32 s47, 160
s_cselect_b32 s90, 1, s90
v_readlane_b32 s3, v72, 8
s_max_u32 s47, s47, 128
v_writelane_b32 v91, s47, 8
s_nop 1
s_add_u32 s47, s47, s3
s_cmp_gt_u32 s47, 160
s_cselect_b32 s90, 1, s90
s_cmp_lg_u32 s90, 0
s_cselect_b64 s[90:91], -1, 0
v_mov_b32 v73, 163072
s_mov_b64 exec, s[90:91]
ds_write_b32 v73, v88
s_mov_b64 exec, -1
s_branch L_greedyb
L_more2:
ds_bpermute_b32 v64, v32, v91
ds_bpermute_b32 v65, v33, v91
ds_bpermute_b32 v66, v34, v91
ds_bpermute_b32 v67, v35, v91
ds_bpermute_b32 v68, v36, v91
ds_bpermute_b32 v69, v37, v91
ds_bpermute_b32 v70, v38, v91
s_waitcnt lgkmcnt(0)
v_add_u32 v73, v48, v64
v_and_b32 v72, 0x87e, v16
v_lshl_add_u32 v73, v73, 1, s93
v_add_u32 v72, v90, v72
s_andn2_b64 exec, s[64:65], s[90:91]
ds_write_b16_d16_hi v73, v16 offset:64
ds_write_b16 v73, v72 offset:384
ds_write_b16 v73, v16 offset:704
s_mov_b64 exec, -1
v_add_u32 v73, v49, v65
v_and_b32 v72, 0x87e, v17
v_lshl_add_u32 v73, v73, 1, s93
v_add_u32 v72, v90, v72
s_andn2_b64 exec, s[66:67], s[90:91]
ds_write_b16_d16_hi v73, v17 offset:64
ds_write_b16 v73, v72 offset:384
ds_write_b16 v73, v17 offset:704
s_mov_b64 exec, -1
v_add_u32 v73, v50, v66
v_and_b32 v72, 0x87e, v18
v_lshl_add_u32 v73, v73, 1, s93
v_add_u32 v72, v90, v72
s_andn2_b64 exec, s[68:69], s[90:91]
ds_write_b16_d16_hi v73, v18 offset:64
ds_write_b16 v73, v72 offset:384
ds_write_b16 v73, v18 offset:704
s_mov_b64 exec, -1
v_add_u32 v73, v51, v67
v_and_b32 v72, 0x87e, v19
v_lshl_add_u32 v73, v73, 1, s93
v_add_u32 v72, v90, v72
s_andn2_b64 exec, s[70:71], s[90:91]
ds_write_b16_d16_hi v73, v19 offset:64
ds_write_b16 v73, v72 offset:384
ds_write_b16 v73, v19 offset:704
s_mov_b64 exec, -1
v_add_u32 v73, v52, v68
v_and_b32 v72, 0x87e, v20
v_lshl_add_u32 v73, v73, 1, s93
v_add_u32 v72, v90, v72
s_andn2_b64 exec, s[72:73], s[90:91]
ds_write_b16_d16_hi v73, v20 offset:64
ds_write_b16 v73, v72 offset:384
ds_write_b16 v73, v20 offset:704
s_mov_b64 exec, -1
v_add_u32 v73, v53, v69
v_and_b32 v72, 0x87e, v21
v_lshl_add_u32 v73, v73, 1, s93
v_add_u32 v72, v90, v72
s_andn2_b64 exec, s[74:75], s[90:91]
ds_write_b16_d16_hi v73, v21 offset:64
ds_write_b16 v73, v72 offset:384
ds_write_b16 v73, v21 offset:704
s_mov_b64 exec, -1
v_add_u32 v73, v54, v70
v_and_b32 v72, 0x87e, v22
v_lshl_add_u32 v73, v73, 1, s93
v_add_u32 v72, v90, v72
s_andn2_b64 exec, s[76:77], s[90:91]
ds_write_b16_d16_hi v73, v22 offset:64
ds_write_b16 v73, v72 offset:384
ds_write_b16 v73, v22 offset:704
s_mov_b64 exec, -1
s_branch L_more2b
L_cwait:
buffer_load_dword v8, off, s[36:39], 0 sc1
s_sub_u32 s3, s3, 1
s_cbranch_scc1 L_giveup
s_waitcnt vmcnt(0)
v_readfirstlane_b32 s47, v8
s_nop 3
s_cmp_lg_u32 s47, 1
s_cbranch_scc1 L_cwait
s_branch L_poll
L_giveup:
s_waitcnt vmcnt(0)
v_mov_b32 v8, 163072
v_mov_b32 v9, 1
ds_write_b32 v8, v9
s_branch L_polled
L_loop_w:
s_bitcmp1_b32 s87, s41
s_waitcnt vmcnt(15)
s_cbranch_scc0 L_loop_wb
s_waitcnt vmcnt(10)
s_branch L_loop_wb
L_loopn_w:
s_bitcmp1_b32 s87, s41
s_waitcnt vmcnt(15)
s_cbranch_scc0 L_loopn_wb
s_waitcnt vmcnt(10)
s_branch L_loopn_wb
L_linked:
.p2align 6
L_loopk:
v_smfmac_f32_16x16x64_bf16 v[8:11], a[0:3], v[44:51], v138
ds_read_b128 v[32:35], v2 offset:1408
v_cvt_pk_bf16_f32 v106, v36, v37
v_smfmac_f32_16x16x64_bf16 v[8:11], a[36:39], v[52:59], v142
s_waitcnt lgkmcnt(9)
v_cvt_pk_bf16_f32 v107, v38, v39
v_smfmac_f32_16x16x64_bf16 v[12:15], a[4:7], v[44:51], v138 abid:1
ds_read_b128 v[36:39], v2 offset:1472
v_cvt_pk_bf16_f32 v112, v40, v41
v_smfmac_f32_16x16x64_bf16 v[12:15], a[40:43], v[52:59], v142 abid:1
s_waitcnt lgkmcnt(8)
ds_read_b128 v[60:63], v0 offset:4096
v_cvt_pk_bf16_f32 v113, v42, v43
v_smfmac_f32_16x16x64_bf16 v[16:19], a[8:11], v[44:51], v139
s_cmp_eq_u32 s4, 129920
ds_read_b128 v[40:43], v2 offset:1536
v_cndmask_b32_dpp v108, v96, v92, vcc quad_perm:[1,0,3,2] row_mask:0xf bank_mask:0xf
v_smfmac_f32_16x16x64_bf16 v[16:19], a[44:47], v[52:59], v143
s_waitcnt lgkmcnt(8)
ds_read_u16 v82, v82
v_cndmask_b32_dpp v109, v97, v93, vcc quad_perm:[1,0,3,2] row_mask:0xf bank_mask:0xf
v_smfmac_f32_16x16x64_bf16 v[20:23], a[12:15], v[44:51], v139 abid:1
s_cselect_b32 s43, -129920, s5
ds_read_u16 v84, v84
v_cndmask_b32_dpp v110, v98, v94, vcc quad_perm:[1,0,3,2] row_mask:0xf bank_mask:0xf
v_smfmac_f32_16x16x64_bf16 v[20:23], a[48:51], v[52:59], v143 abid:1
s_waitcnt lgkmcnt(8)
ds_read_b128 v[64:67], v1 offset:4096
v_cndmask_b32_dpp v111, v99, v95, vcc quad_perm:[1,0,3,2] row_mask:0xf bank_mask:0xf
v_smfmac_f32_16x16x64_bf16 v[24:27], a[16:19], v[44:51], v140
s_add_u32 s4, s4, s43
ds_read_b128 v[68:71], v0 offset:6144
v_add_u32_sdwa v87, s42, v123 dst_sel:DWORD dst_unused:UNUSED_PAD src0_sel:DWORD src1_sel:WORD_1
v_smfmac_f32_16x16x64_bf16 v[24:27], a[52:55], v[52:59], v144
buffer_store_dwordx4 v[108:111], v4, s[20:23], s46 offen offset:0 sc1
s_mov_b64 vcc, s[82:83]
s_waitcnt lgkmcnt(8)
ds_read_b128 v[72:75], v1 offset:6144
v_cndmask_b32_dpp v96, v92, v96, vcc quad_perm:[1,0,3,2] row_mask:0xf bank_mask:0xf
v_cndmask_b32_dpp v97, v93, v97, vcc quad_perm:[1,0,3,2] row_mask:0xf bank_mask:0xf
v_smfmac_f32_16x16x64_bf16 v[28:31], a[20:23], v[44:51], v140 abid:1
s_add_u32 s41, s41, 1
ds_read_u16 v83, v83
v_cndmask_b32_dpp v98, v94, v98, vcc quad_perm:[1,0,3,2] row_mask:0xf bank_mask:0xf
v_smfmac_f32_16x16x64_bf16 v[28:31], a[56:59], v[52:59], v144 abid:1
s_waitcnt lgkmcnt(9)
ds_read_b128 v[114:117], v2 offset:64
v_cndmask_b32_dpp v99, v95, v99, vcc quad_perm:[1,0,3,2] row_mask:0xf bank_mask:0xf
v_smfmac_f32_16x16x64_bf16 v[32:35], a[24:27], v[44:51], v141
ds_read_u16 v85, v85
v_add_u32_sdwa v88, s42, v124 dst_sel:DWORD dst_unused:UNUSED_PAD src0_sel:DWORD src1_sel:WORD_0
v_smfmac_f32_16x16x64_bf16 v[32:35], a[60:63], v[52:59], v145
s_waitcnt lgkmcnt(10)
ds_read_u16 v86, v86
v_add_u32_sdwa v89, s42, v124 dst_sel:DWORD dst_unused:UNUSED_PAD src0_sel:DWORD src1_sel:WORD_1
v_smfmac_f32_16x16x64_bf16 v[36:39], a[28:31], v[44:51], v141 abid:1
ds_read_u16 v87, v87
v_add_u32_sdwa v90, s42, v125 dst_sel:DWORD dst_unused:UNUSED_PAD src0_sel:DWORD src1_sel:WORD_0
v_smfmac_f32_16x16x64_bf16 v[36:39], a[64:67], v[52:59], v145 abid:1
s_waitcnt lgkmcnt(10)
ds_read_u16 v88, v88
v_add_u32_sdwa v91, s42, v125 dst_sel:DWORD dst_unused:UNUSED_PAD src0_sel:DWORD src1_sel:WORD_1
v_smfmac_f32_16x16x64_bf16 v[40:43], a[32:35], v[44:51], v174
buffer_store_dwordx4 v[96:99], v4, s[20:23], s46 offen offset:1152 sc1
s_mov_b64 vcc, s[80:81]
ds_read_u16 v89, v89
v_cndmask_b32_dpp v92, v104, v100, vcc quad_perm:[1,0,3,2] row_mask:0xf bank_mask:0xf
v_cndmask_b32_dpp v93, v105, v101, vcc quad_perm:[1,0,3,2] row_mask:0xf bank_mask:0xf
v_smfmac_f32_16x16x64_bf16 v[40:43], a[68:71], v[52:59], v174 abid:1
s_waitcnt lgkmcnt(9)
ds_read_u16 v90, v90
v_cndmask_b32_dpp v94, v106, v102, vcc quad_perm:[1,0,3,2] row_mask:0xf bank_mask:0xf
v_smfmac_f32_16x16x64_bf16 v[8:11], a[72:75], v[60:67], v146
s_waitcnt lgkmcnt(8)
ds_read_u16 v91, v91
v_cndmask_b32_dpp v95, v107, v103, vcc quad_perm:[1,0,3,2] row_mask:0xf bank_mask:0xf
v_smfmac_f32_16x16x64_bf16 v[8:11], a[108:111], v[68:75], v150
s_waitcnt lgkmcnt(7)
ds_bpermute_b32 v112, v6, v112
v_smfmac_f32_16x16x64_bf16 v[8:11], v[114:117], v[76:83], v179
ds_bpermute_b32 v113, v6, v113
v_smfmac_f32_16x16x64_bf16 v[12:15], v[114:117], v[76:83], v179 abid:1
ds_read_b128 v[114:117], v2 offset:128
v_add_u32_sdwa v76, s42, v126 dst_sel:DWORD dst_unused:UNUSED_PAD src0_sel:DWORD src1_sel:WORD_0
v_smfmac_f32_16x16x64_bf16 v[12:15], a[76:79], v[60:67], v146 abid:1
ds_read_u16 v76, v76
v_add_u32_sdwa v77, s42, v126 dst_sel:DWORD dst_unused:UNUSED_PAD src0_sel:DWORD src1_sel:WORD_1
v_smfmac_f32_16x16x64_bf16 v[12:15], a[112:115], v[68:75], v150 abid:1
buffer_store_dwordx4 v[92:95], v4, s[20:23], s46 offen offset:128 sc1
s_mov_b64 vcc, s[82:83]
ds_read_u16 v77, v77
v_cndmask_b32_dpp v104, v100, v104, vcc quad_perm:[1,0,3,2] row_mask:0xf bank_mask:0xf
v_cndmask_b32_dpp v105, v101, v105, vcc quad_perm:[1,0,3,2] row_mask:0xf bank_mask:0xf
v_smfmac_f32_16x16x64_bf16 v[24:27], a[88:91], v[60:67], v148
ds_read_b128 v[44:47], v0 offset:8192
v_add_u32_sdwa v78, s42, v127 dst_sel:DWORD dst_unused:UNUSED_PAD src0_sel:DWORD src1_sel:WORD_0
v_smfmac_f32_16x16x64_bf16 v[24:27], a[124:127], v[68:75], v152
ds_read_u16 v78, v78
v_cndmask_b32_dpp v106, v102, v106, vcc quad_perm:[1,0,3,2] row_mask:0xf bank_mask:0xf
v_smfmac_f32_16x16x64_bf16 v[28:31], a[92:95], v[60:67], v148 abid:1
ds_read_b128 v[48:51], v1 offset:8192
v_cndmask_b32_dpp v107, v103, v107, vcc quad_perm:[1,0,3,2] row_mask:0xf bank_mask:0xf
v_smfmac_f32_16x16x64_bf16 v[28:31], a[128:131], v[68:75], v152 abid:1
ds_read_b128 v[52:55], v0 offset:10240
v_add_u32_sdwa v79, s42, v127 dst_sel:DWORD dst_unused:UNUSED_PAD src0_sel:DWORD src1_sel:WORD_1
v_smfmac_f32_16x16x64_bf16 v[32:35], a[96:99], v[60:67], v149
ds_read_u16 v79, v79
v_add_u32_sdwa v80, s42, v128 dst_sel:DWORD dst_unused:UNUSED_PAD src0_sel:DWORD src1_sel:WORD_0
v_smfmac_f32_16x16x64_bf16 v[32:35], a[132:135], v[68:75], v153
ds_read_u16 v80, v80
v_add_u32_sdwa v81, s42, v128 dst_sel:DWORD dst_unused:UNUSED_PAD src0_sel:DWORD src1_sel:WORD_1
v_smfmac_f32_16x16x64_bf16 v[16:19], a[80:83], v[60:67], v147
buffer_store_dwordx4 v[104:107], v4, s[20:23], s46 offen offset:1280 sc1
s_mov_b64 vcc, s[80:81]
ds_read_b128 v[56:59], v1 offset:10240
v_add_u32_sdwa v82, s42, v129 dst_sel:DWORD dst_unused:UNUSED_PAD src0_sel:DWORD src1_sel:WORD_0
v_add_u32_sdwa v83, s42, v129 dst_sel:DWORD dst_unused:UNUSED_PAD src0_sel:DWORD src1_sel:WORD_1
v_smfmac_f32_16x16x64_bf16 v[16:19], a[116:119], v[68:75], v151
s_waitcnt lgkmcnt(9)
ds_read_b128 v[92:95], v0 offset:12288
v_add_u32_sdwa v100, s42, v130 dst_sel:DWORD dst_unused:UNUSED_PAD src0_sel:DWORD src1_sel:WORD_0
v_smfmac_f32_16x16x64_bf16 v[16:19], v[114:117], v[84:91], v180 abid:1
s_waitcnt vmcnt(4)
ds_read_u16 v81, v81
v_add_u32_sdwa v101, s42, v130 dst_sel:DWORD dst_unused:UNUSED_PAD src0_sel:DWORD src1_sel:WORD_1
v_smfmac_f32_16x16x64_bf16 v[12:15], v[114:117], v[84:91], v180
ds_read_b128 v[96:99], v1 offset:12288
v_add_u32_sdwa v102, s42, v131 dst_sel:DWORD dst_unused:UNUSED_PAD src0_sel:DWORD src1_sel:WORD_0
v_smfmac_f32_16x16x64_bf16 v[20:23], v[114:117], v[84:91], v181
ds_read_u16 v82, v82
v_add_u32_sdwa v103, s42, v131 dst_sel:DWORD dst_unused:UNUSED_PAD src0_sel:DWORD src1_sel:WORD_1
v_smfmac_f32_16x16x64_bf16 v[20:23], a[84:87], v[60:67], v147 abid:1
ds_read_u16 v100, v100
v_add_u32_sdwa v104, s42, v132 dst_sel:DWORD dst_unused:UNUSED_PAD src0_sel:DWORD src1_sel:WORD_0
v_smfmac_f32_16x16x64_bf16 v[20:23], a[120:123], v[68:75], v151 abid:1
ds_read_u16 v83, v83
v_add_u32_sdwa v105, s42, v132 dst_sel:DWORD dst_unused:UNUSED_PAD src0_sel:DWORD src1_sel:WORD_1
v_smfmac_f32_16x16x64_bf16 v[36:39], a[100:103], v[60:67], v149 abid:1
buffer_store_dwordx2 v[112:113], v5, s[20:23], s46 offen nt
ds_read_b128 v[114:117], v2 offset:192
v_add_u32_sdwa v106, s42, v133 dst_sel:DWORD dst_unused:UNUSED_PAD src0_sel:DWORD src1_sel:WORD_0
v_smfmac_f32_16x16x64_bf16 v[36:39], a[136:139], v[68:75], v153 abid:1
s_mov_b32 s22, 75497472
ds_read_u16 v101, v101
v_add_u32_sdwa v107, s42, v133 dst_sel:DWORD dst_unused:UNUSED_PAD src0_sel:DWORD src1_sel:WORD_1
v_smfmac_f32_16x16x64_bf16 v[40:43], a[104:107], v[60:67], v175
s_mov_b32 s46, s48
ds_read_u16 v102, v102
v_add_u32_sdwa v84, s42, v134 dst_sel:DWORD dst_unused:UNUSED_PAD src0_sel:DWORD src1_sel:WORD_0
v_smfmac_f32_16x16x64_bf16 v[40:43], a[140:143], v[68:75], v175 abid:1
s_waitcnt lgkmcnt(13)
ds_read_u16 v103, v103
v_add_u32_sdwa v85, s42, v134 dst_sel:DWORD dst_unused:UNUSED_PAD src0_sel:DWORD src1_sel:WORD_1
v_smfmac_f32_16x16x64_bf16 v[8:11], a[144:147], v[44:51], v154
s_waitcnt lgkmcnt(10)
ds_read_u16 v104, v104
v_add_u32_sdwa v86, s42, v135 dst_sel:DWORD dst_unused:UNUSED_PAD src0_sel:DWORD src1_sel:WORD_0
v_smfmac_f32_16x16x64_bf16 v[8:11], a[180:183], v[52:59], v158
s_waitcnt lgkmcnt(8)
ds_read_u16 v105, v105
v_add_u32_sdwa v87, s42, v135 dst_sel:DWORD dst_unused:UNUSED_PAD src0_sel:DWORD src1_sel:WORD_1
v_smfmac_f32_16x16x64_bf16 v[8:11], a[216:219], v[92:99], v162
s_add_u32 m0, s44, 0
ds_read_u16 v106, v106
v_add_u32_sdwa v88, s42, v136 dst_sel:DWORD dst_unused:UNUSED_PAD src0_sel:DWORD src1_sel:WORD_0
v_smfmac_f32_16x16x64_bf16 v[24:27], a[160:163], v[44:51], v156
buffer_load_dwordx4 v3, s[16:19], s45 offen offset:0 nt lds
v_add_u32_sdwa v89, s42, v136 dst_sel:DWORD dst_unused:UNUSED_PAD src0_sel:DWORD src1_sel:WORD_1
v_smfmac_f32_16x16x64_bf16 v[24:27], a[196:199], v[52:59], v160
s_mov_b32 s48, s49
ds_read_u16 v107, v107
v_add_u32_sdwa v90, s42, v137 dst_sel:DWORD dst_unused:UNUSED_PAD src0_sel:DWORD src1_sel:WORD_0
v_smfmac_f32_16x16x64_bf16 v[24:27], a[232:235], v[92:99], v164
s_waitcnt lgkmcnt(7)
ds_read_u16 v84, v84
v_add_u32_sdwa v91, s42, v137 dst_sel:DWORD dst_unused:UNUSED_PAD src0_sel:DWORD src1_sel:WORD_1
v_smfmac_f32_16x16x64_bf16 v[24:27], v[114:117], v[76:83], v182
s_mov_b32 s49, s50
ds_read_u16 v85, v85
v_smfmac_f32_16x16x64_bf16 v[20:23], v[114:117], v[76:83], v181 abid:1
s_add_u32 s50, s50, 4718592
ds_read_u16 v86, v86
v_smfmac_f32_16x16x64_bf16 v[28:31], v[114:117], v[76:83], v182 abid:1
ds_read_b128 v[114:117], v2 offset:256
v_add_u32_sdwa v76, s4, v118 dst_sel:DWORD dst_unused:UNUSED_PAD src0_sel:DWORD src1_sel:WORD_0
v_smfmac_f32_16x16x64_bf16 v[28:31], a[164:167], v[44:51], v156 abid:1
ds_read_u16 v87, v87
v_add_u32_sdwa v77, s4, v118 dst_sel:DWORD dst_unused:UNUSED_PAD src0_sel:DWORD src1_sel:WORD_1
v_smfmac_f32_16x16x64_bf16 v[28:31], a[200:203], v[52:59], v160 abid:1
ds_read_u16 v88, v88
v_add_u32_sdwa v78, s4, v119 dst_sel:DWORD dst_unused:UNUSED_PAD src0_sel:DWORD src1_sel:WORD_0
v_smfmac_f32_16x16x64_bf16 v[28:31], a[236:239], v[92:99], v164 abid:1
ds_read_b128 v[60:63], v0 offset:14336
v_add_u32_sdwa v79, s4, v119 dst_sel:DWORD dst_unused:UNUSED_PAD src0_sel:DWORD src1_sel:WORD_1
v_smfmac_f32_16x16x64_bf16 v[12:15], a[148:151], v[44:51], v154 abid:1
ds_read_u16 v89, v89
v_add_u32_sdwa v80, s4, v120 dst_sel:DWORD dst_unused:UNUSED_PAD src0_sel:DWORD src1_sel:WORD_0
v_smfmac_f32_16x16x64_bf16 v[12:15], a[184:187], v[52:59], v158 abid:1
s_add_u32 m0, s44, 3840
ds_read_b128 v[64:67], v1 offset:14336
v_add_u32_sdwa v81, s4, v120 dst_sel:DWORD dst_unused:UNUSED_PAD src0_sel:DWORD src1_sel:WORD_1
v_smfmac_f32_16x16x64_bf16 v[12:15], a[220:223], v[92:99], v162 abid:1
buffer_load_dwordx4 v3, s[16:19], s45 offen offset:256 nt lds
v_add_u32_sdwa v82, s4, v121 dst_sel:DWORD dst_unused:UNUSED_PAD src0_sel:DWORD src1_sel:WORD_0
v_smfmac_f32_16x16x64_bf16 v[32:35], a[168:171], v[44:51], v157
ds_read_b128 v[68:71], v0 offset:16384
v_add_u32_sdwa v83, s4, v121 dst_sel:DWORD dst_unused:UNUSED_PAD src0_sel:DWORD src1_sel:WORD_1
v_smfmac_f32_16x16x64_bf16 v[32:35], a[204:207], v[52:59], v161
ds_read_u16 v90, v90
v_smfmac_f32_16x16x64_bf16 v[32:35], a[240:243], v[92:99], v165
s_waitcnt lgkmcnt(7)
ds_read_b128 v[72:75], v1 offset:16384
v_add_u32 v0, s43, v0
v_smfmac_f32_16x16x64_bf16 v[32:35], v[114:117], v[100:107], v183 abid:1
ds_read_u16 v91, v91
v_add_u32 v1, s43, v1
v_smfmac_f32_16x16x64_bf16 v[28:31], v[114:117], v[100:107], v183
v_smfmac_f32_16x16x64_bf16 v[36:39], v[114:117], v[100:107], v184
ds_read_b128 v[114:117], v2 offset:320
v_smfmac_f32_16x16x64_bf16 v[36:39], a[172:175], v[44:51], v157 abid:1
s_add_u32 m0, s44, 7680
v_smfmac_f32_16x16x64_bf16 v[36:39], a[208:211], v[52:59], v161 abid:1
buffer_load_dwordx4 v3, s[16:19], s45 offen offset:512 nt lds
v_smfmac_f32_16x16x64_bf16 v[36:39], a[244:247], v[92:99], v165 abid:1
v_smfmac_f32_16x16x64_bf16 v[16:19], a[152:155], v[44:51], v155
s_add_u32 m0, s44, 11520
v_smfmac_f32_16x16x64_bf16 v[16:19], a[188:191], v[52:59], v159
buffer_load_dwordx4 v3, s[16:19], s45 offen offset:768 nt lds
v_smfmac_f32_16x16x64_bf16 v[16:19], a[224:227], v[92:99], v163
v_smfmac_f32_16x16x64_bf16 v[20:23], a[156:159], v[44:51], v155 abid:1
s_add_u32 m0, s44, s8
v_smfmac_f32_16x16x64_bf16 v[20:23], a[192:195], v[52:59], v159 abid:1
s_mov_b64 exec, s[10:11]
buffer_load_dwordx4 v3, s[16:19], s7 offen offset:896 nt lds
s_mov_b64 exec, -1
v_smfmac_f32_16x16x64_bf16 v[20:23], a[228:231], v[92:99], v163 abid:1
s_add_u32 s45, s45, 4718592
s_add_u32 s7, s7, 4718592
s_add_u32 s44, s44, s5
v_smfmac_f32_16x16x64_bf16 v[40:43], a[176:179], v[44:51], v176
s_cmp_ge_u32 s44, 148480
s_cselect_b32 s44, s9, s44
s_bitcmp1_b32 s92, s41
v_smfmac_f32_16x16x64_bf16 v[40:43], a[212:215], v[52:59], v176 abid:1
s_cbranch_scc1 L_loopk_w
L_loopk_wb:
v_smfmac_f32_16x16x64_bf16 v[40:43], a[248:251], v[92:99], v177
s_waitcnt lgkmcnt(0)
v_smfmac_f32_16x16x64_bf16 v[40:43], v[114:117], v[84:91], v185
v_smfmac_f32_16x16x64_bf16 v[36:39], v[114:117], v[84:91], v184 abid:1
s_waitcnt vmcnt(20)
s_barrier
v_smfmac_f32_16x16x64_bf16 v[8:11], a[252:255], v[60:67], v166
s_mov_b32 s42, s4
v_smfmac_f32_16x16x64_bf16 v[8:11], v[218:221], v[68:75], v170
ds_read_b128 v[44:47], v0 offset:0
v_add_u32_sdwa v84, s42, v122 dst_sel:DWORD dst_unused:UNUSED_PAD src0_sel:DWORD src1_sel:WORD_0
v_smfmac_f32_16x16x64_bf16 v[12:15], v[186:189], v[60:67], v166 abid:1
ds_read_b128 v[48:51], v1 offset:0
v_add_u32_sdwa v85, s42, v122 dst_sel:DWORD dst_unused:UNUSED_PAD src0_sel:DWORD src1_sel:WORD_1
v_smfmac_f32_16x16x64_bf16 v[12:15], v[222:225], v[68:75], v170 abid:1
ds_read_b128 v[52:55], v0 offset:2048
v_add_u32_sdwa v86, s42, v123 dst_sel:DWORD dst_unused:UNUSED_PAD src0_sel:DWORD src1_sel:WORD_0
v_smfmac_f32_16x16x64_bf16 v[16:19], v[190:193], v[60:67], v167
ds_read_b128 v[56:59], v1 offset:2048
v_cvt_pk_bf16_f32 v92, v8, v9
v_smfmac_f32_16x16x64_bf16 v[16:19], v[226:229], v[68:75], v171
ds_read_u16 v76, v76
v_cvt_pk_bf16_f32 v93, v10, v11
v_smfmac_f32_16x16x64_bf16 v[20:23], v[194:197], v[60:67], v167 abid:1
ds_read_b128 v[8:11], v2 offset:1024
v_cvt_pk_bf16_f32 v94, v12, v13
v_smfmac_f32_16x16x64_bf16 v[20:23], v[230:233], v[68:75], v171 abid:1
ds_read_u16 v77, v77
v_cvt_pk_bf16_f32 v95, v14, v15
v_smfmac_f32_16x16x64_bf16 v[24:27], v[198:201], v[60:67], v168
ds_read_b128 v[12:15], v2 offset:1088
v_cvt_pk_bf16_f32 v96, v16, v17
v_smfmac_f32_16x16x64_bf16 v[24:27], v[234:237], v[68:75], v172
ds_read_u16 v78, v78
v_cvt_pk_bf16_f32 v97, v18, v19
v_smfmac_f32_16x16x64_bf16 v[28:31], v[202:205], v[60:67], v168 abid:1
ds_read_b128 v[16:19], v2 offset:1152
v_cvt_pk_bf16_f32 v98, v20, v21
v_smfmac_f32_16x16x64_bf16 v[28:31], v[238:241], v[68:75], v172 abid:1
ds_read_u16 v79, v79
v_cvt_pk_bf16_f32 v99, v22, v23
v_smfmac_f32_16x16x64_bf16 v[32:35], v[206:209], v[60:67], v169
ds_read_b128 v[20:23], v2 offset:1216
v_cvt_pk_bf16_f32 v100, v24, v25
v_smfmac_f32_16x16x64_bf16 v[32:35], v[242:245], v[68:75], v173
ds_read_u16 v80, v80
v_cvt_pk_bf16_f32 v101, v26, v27
v_smfmac_f32_16x16x64_bf16 v[36:39], v[210:213], v[60:67], v169 abid:1
ds_read_b128 v[24:27], v2 offset:1280
v_cvt_pk_bf16_f32 v102, v28, v29
v_smfmac_f32_16x16x64_bf16 v[36:39], v[246:249], v[68:75], v173 abid:1
ds_read_u16 v81, v81
v_cvt_pk_bf16_f32 v103, v30, v31
v_smfmac_f32_16x16x64_bf16 v[40:43], v[214:217], v[60:67], v177 abid:1
s_bitcmp1_b32 s85, s41
ds_read_b128 v[28:31], v2 offset:1344
v_cvt_pk_bf16_f32 v104, v32, v33
v_smfmac_f32_16x16x64_bf16 v[40:43], v[250:253], v[68:75], v178
s_waitcnt lgkmcnt(10)
v_cvt_pk_bf16_f32 v105, v34, v35
s_cbranch_scc1 L_loopk
s_cmp_lg_u32 s41, 6
s_cbranch_scc1 L_loopnk
.p2align 3
L_loopck:
v_smfmac_f32_16x16x64_bf16 v[8:11], a[0:3], v[44:51], v138
s_cmp_lt_u32 s56, s65
s_cselect_b32 s34, s34, 0
s_cselect_b32 s64, s64, 0
ds_read_b128 v[32:35], v2 offset:1408
v_cvt_pk_bf16_f32 v106, v36, v37
v_mov_b32 v7, 1
v_smfmac_f32_16x16x64_bf16 v[8:11], a[36:39], v[52:59], v142
s_waitcnt lgkmcnt(9)
buffer_atomic_add v7, v6, s[32:35], 0 offen sc0 sc1
v_cvt_pk_bf16_f32 v107, v38, v39
v_smfmac_f32_16x16x64_bf16 v[12:15], a[4:7], v[44:51], v138 abid:1
ds_read_b128 v[36:39], v2 offset:1472
v_cvt_pk_bf16_f32 v112, v40, v41
v_smfmac_f32_16x16x64_bf16 v[12:15], a[40:43], v[52:59], v142 abid:1
s_waitcnt lgkmcnt(8)
ds_read_b128 v[60:63], v0 offset:4096
v_cvt_pk_bf16_f32 v113, v42, v43
v_smfmac_f32_16x16x64_bf16 v[16:19], a[8:11], v[44:51], v139
s_cmp_eq_u32 s4, 129920
ds_read_b128 v[40:43], v2 offset:1536
v_cndmask_b32_dpp v108, v96, v92, vcc quad_perm:[1,0,3,2] row_mask:0xf bank_mask:0xf
v_smfmac_f32_16x16x64_bf16 v[16:19], a[44:47], v[52:59], v143
s_waitcnt lgkmcnt(8)
ds_read_u16 v82, v82
v_cndmask_b32_dpp v109, v97, v93, vcc quad_perm:[1,0,3,2] row_mask:0xf bank_mask:0xf
v_smfmac_f32_16x16x64_bf16 v[20:23], a[12:15], v[44:51], v139 abid:1
s_cselect_b32 s43, -129920, s5
ds_read_u16 v84, v84
v_cndmask_b32_dpp v110, v98, v94, vcc quad_perm:[1,0,3,2] row_mask:0xf bank_mask:0xf
v_smfmac_f32_16x16x64_bf16 v[20:23], a[48:51], v[52:59], v143 abid:1
s_waitcnt lgkmcnt(8)
ds_read_b128 v[64:67], v1 offset:4096
v_cndmask_b32_dpp v111, v99, v95, vcc quad_perm:[1,0,3,2] row_mask:0xf bank_mask:0xf
v_smfmac_f32_16x16x64_bf16 v[24:27], a[16:19], v[44:51], v140
s_add_u32 s4, s4, s43
ds_read_b128 v[68:71], v0 offset:6144
v_add_u32_sdwa v87, s42, v123 dst_sel:DWORD dst_unused:UNUSED_PAD src0_sel:DWORD src1_sel:WORD_1
v_smfmac_f32_16x16x64_bf16 v[24:27], a[52:55], v[52:59], v144
buffer_store_dwordx4 v[108:111], v4, s[20:23], s46 offen offset:0 sc1
s_mov_b64 vcc, s[82:83]
s_waitcnt lgkmcnt(8)
ds_read_b128 v[72:75], v1 offset:6144
v_cndmask_b32_dpp v96, v92, v96, vcc quad_perm:[1,0,3,2] row_mask:0xf bank_mask:0xf
v_cndmask_b32_dpp v97, v93, v97, vcc quad_perm:[1,0,3,2] row_mask:0xf bank_mask:0xf
v_smfmac_f32_16x16x64_bf16 v[28:31], a[20:23], v[44:51], v140 abid:1
s_add_u32 s7, s45, s58
ds_read_u16 v83, v83
v_cndmask_b32_dpp v98, v94, v98, vcc quad_perm:[1,0,3,2] row_mask:0xf bank_mask:0xf
v_smfmac_f32_16x16x64_bf16 v[28:31], a[56:59], v[52:59], v144 abid:1
s_waitcnt lgkmcnt(9)
ds_read_b128 v[114:117], v2 offset:64
v_cndmask_b32_dpp v99, v95, v99, vcc quad_perm:[1,0,3,2] row_mask:0xf bank_mask:0xf
v_smfmac_f32_16x16x64_bf16 v[32:35], a[24:27], v[44:51], v141
ds_read_u16 v85, v85
v_add_u32_sdwa v88, s42, v124 dst_sel:DWORD dst_unused:UNUSED_PAD src0_sel:DWORD src1_sel:WORD_0
v_smfmac_f32_16x16x64_bf16 v[32:35], a[60:63], v[52:59], v145
s_waitcnt lgkmcnt(10)
ds_read_u16 v86, v86
v_add_u32_sdwa v89, s42, v124 dst_sel:DWORD dst_unused:UNUSED_PAD src0_sel:DWORD src1_sel:WORD_1
v_smfmac_f32_16x16x64_bf16 v[36:39], a[28:31], v[44:51], v141 abid:1
ds_read_u16 v87, v87
v_add_u32_sdwa v90, s42, v125 dst_sel:DWORD dst_unused:UNUSED_PAD src0_sel:DWORD src1_sel:WORD_0
v_smfmac_f32_16x16x64_bf16 v[36:39], a[64:67], v[52:59], v145 abid:1
s_waitcnt lgkmcnt(10)
ds_read_u16 v88, v88
v_add_u32_sdwa v91, s42, v125 dst_sel:DWORD dst_unused:UNUSED_PAD src0_sel:DWORD src1_sel:WORD_1
v_smfmac_f32_16x16x64_bf16 v[40:43], a[32:35], v[44:51], v174
buffer_store_dwordx4 v[96:99], v4, s[20:23], s46 offen offset:1152 sc1
s_mov_b64 vcc, s[80:81]
ds_read_u16 v89, v89
v_cndmask_b32_dpp v92, v104, v100, vcc quad_perm:[1,0,3,2] row_mask:0xf bank_mask:0xf
v_cndmask_b32_dpp v93, v105, v101, vcc quad_perm:[1,0,3,2] row_mask:0xf bank_mask:0xf
v_smfmac_f32_16x16x64_bf16 v[40:43], a[68:71], v[52:59], v174 abid:1
s_waitcnt lgkmcnt(9)
ds_read_u16 v90, v90
v_cndmask_b32_dpp v94, v106, v102, vcc quad_perm:[1,0,3,2] row_mask:0xf bank_mask:0xf
v_smfmac_f32_16x16x64_bf16 v[8:11], a[72:75], v[60:67], v146
s_waitcnt lgkmcnt(8)
ds_read_u16 v91, v91
v_cndmask_b32_dpp v95, v107, v103, vcc quad_perm:[1,0,3,2] row_mask:0xf bank_mask:0xf
v_smfmac_f32_16x16x64_bf16 v[8:11], a[108:111], v[68:75], v150
s_waitcnt lgkmcnt(7)
ds_bpermute_b32 v112, v6, v112
v_smfmac_f32_16x16x64_bf16 v[8:11], v[114:117], v[76:83], v179
ds_bpermute_b32 v113, v6, v113
v_smfmac_f32_16x16x64_bf16 v[12:15], v[114:117], v[76:83], v179 abid:1
ds_read_b128 v[114:117], v2 offset:128
v_add_u32_sdwa v76, s42, v126 dst_sel:DWORD dst_unused:UNUSED_PAD src0_sel:DWORD src1_sel:WORD_0
v_smfmac_f32_16x16x64_bf16 v[12:15], a[76:79], v[60:67], v146 abid:1
ds_read_u16 v76, v76
v_add_u32_sdwa v77, s42, v126 dst_sel:DWORD dst_unused:UNUSED_PAD src0_sel:DWORD src1_sel:WORD_1
v_smfmac_f32_16x16x64_bf16 v[12:15], a[112:115], v[68:75], v150 abid:1
buffer_store_dwordx4 v[92:95], v4, s[20:23], s46 offen offset:128 sc1
s_mov_b64 vcc, s[82:83]
ds_read_u16 v77, v77
v_cndmask_b32_dpp v104, v100, v104, vcc quad_perm:[1,0,3,2] row_mask:0xf bank_mask:0xf
v_cndmask_b32_dpp v105, v101, v105, vcc quad_perm:[1,0,3,2] row_mask:0xf bank_mask:0xf
v_smfmac_f32_16x16x64_bf16 v[24:27], a[88:91], v[60:67], v148
ds_read_b128 v[44:47], v0 offset:8192
v_add_u32_sdwa v78, s42, v127 dst_sel:DWORD dst_unused:UNUSED_PAD src0_sel:DWORD src1_sel:WORD_0
v_smfmac_f32_16x16x64_bf16 v[24:27], a[124:127], v[68:75], v152
ds_read_u16 v78, v78
v_cndmask_b32_dpp v106, v102, v106, vcc quad_perm:[1,0,3,2] row_mask:0xf bank_mask:0xf
v_smfmac_f32_16x16x64_bf16 v[28:31], a[92:95], v[60:67], v148 abid:1
ds_read_b128 v[48:51], v1 offset:8192
v_cndmask_b32_dpp v107, v103, v107, vcc quad_perm:[1,0,3,2] row_mask:0xf bank_mask:0xf
v_smfmac_f32_16x16x64_bf16 v[28:31], a[128:131], v[68:75], v152 abid:1
ds_read_b128 v[52:55], v0 offset:10240
v_add_u32_sdwa v79, s42, v127 dst_sel:DWORD dst_unused:UNUSED_PAD src0_sel:DWORD src1_sel:WORD_1
v_smfmac_f32_16x16x64_bf16 v[32:35], a[96:99], v[60:67], v149
ds_read_u16 v79, v79
v_add_u32_sdwa v80, s42, v128 dst_sel:DWORD dst_unused:UNUSED_PAD src0_sel:DWORD src1_sel:WORD_0
v_smfmac_f32_16x16x64_bf16 v[32:35], a[132:135], v[68:75], v153
ds_read_u16 v80, v80
v_add_u32_sdwa v81, s42, v128 dst_sel:DWORD dst_unused:UNUSED_PAD src0_sel:DWORD src1_sel:WORD_1
v_smfmac_f32_16x16x64_bf16 v[16:19], a[80:83], v[60:67], v147
buffer_store_dwordx4 v[104:107], v4, s[20:23], s46 offen offset:1280 sc1
s_mov_b64 vcc, s[80:81]
ds_read_b128 v[56:59], v1 offset:10240
v_add_u32_sdwa v82, s42, v129 dst_sel:DWORD dst_unused:UNUSED_PAD src0_sel:DWORD src1_sel:WORD_0
v_add_u32_sdwa v83, s42, v129 dst_sel:DWORD dst_unused:UNUSED_PAD src0_sel:DWORD src1_sel:WORD_1
v_smfmac_f32_16x16x64_bf16 v[16:19], a[116:119], v[68:75], v151
s_waitcnt lgkmcnt(9)
ds_read_b128 v[92:95], v0 offset:12288
v_add_u32_sdwa v100, s42, v130 dst_sel:DWORD dst_unused:UNUSED_PAD src0_sel:DWORD src1_sel:WORD_0
v_smfmac_f32_16x16x64_bf16 v[16:19], v[114:117], v[84:91], v180 abid:1
ds_read_u16 v81, v81
v_add_u32_sdwa v101, s42, v130 dst_sel:DWORD dst_unused:UNUSED_PAD src0_sel:DWORD src1_sel:WORD_1
v_smfmac_f32_16x16x64_bf16 v[12:15], v[114:117], v[84:91], v180
ds_read_b128 v[96:99], v1 offset:12288
v_add_u32_sdwa v102, s42, v131 dst_sel:DWORD dst_unused:UNUSED_PAD src0_sel:DWORD src1_sel:WORD_0
v_smfmac_f32_16x16x64_bf16 v[20:23], v[114:117], v[84:91], v181
ds_read_u16 v82, v82
v_add_u32_sdwa v103, s42, v131 dst_sel:DWORD dst_unused:UNUSED_PAD src0_sel:DWORD src1_sel:WORD_1
v_smfmac_f32_16x16x64_bf16 v[20:23], a[84:87], v[60:67], v147 abid:1
ds_read_u16 v100, v100
v_add_u32_sdwa v104, s42, v132 dst_sel:DWORD dst_unused:UNUSED_PAD src0_sel:DWORD src1_sel:WORD_0
v_smfmac_f32_16x16x64_bf16 v[20:23], a[120:123], v[68:75], v151 abid:1
ds_read_u16 v83, v83
v_add_u32_sdwa v105, s42, v132 dst_sel:DWORD dst_unused:UNUSED_PAD src0_sel:DWORD src1_sel:WORD_1
v_smfmac_f32_16x16x64_bf16 v[36:39], a[100:103], v[60:67], v149 abid:1
buffer_store_dwordx2 v[112:113], v5, s[20:23], s46 offen nt
ds_read_b128 v[114:117], v2 offset:192
v_add_u32_sdwa v106, s42, v133 dst_sel:DWORD dst_unused:UNUSED_PAD src0_sel:DWORD src1_sel:WORD_0
v_smfmac_f32_16x16x64_bf16 v[36:39], a[136:139], v[68:75], v153 abid:1
s_mov_b32 s46, s48
ds_read_u16 v101, v101
v_add_u32_sdwa v107, s42, v133 dst_sel:DWORD dst_unused:UNUSED_PAD src0_sel:DWORD src1_sel:WORD_1
v_smfmac_f32_16x16x64_bf16 v[40:43], a[104:107], v[60:67], v175
s_mov_b32 s48, s49
ds_read_u16 v102, v102
v_add_u32_sdwa v84, s42, v134 dst_sel:DWORD dst_unused:UNUSED_PAD src0_sel:DWORD src1_sel:WORD_0
v_smfmac_f32_16x16x64_bf16 v[40:43], a[140:143], v[68:75], v175 abid:1
s_waitcnt lgkmcnt(13)
ds_read_u16 v103, v103
v_add_u32_sdwa v85, s42, v134 dst_sel:DWORD dst_unused:UNUSED_PAD src0_sel:DWORD src1_sel:WORD_1
v_smfmac_f32_16x16x64_bf16 v[8:11], a[144:147], v[44:51], v154
s_waitcnt lgkmcnt(10)
ds_read_u16 v104, v104
v_add_u32_sdwa v86, s42, v135 dst_sel:DWORD dst_unused:UNUSED_PAD src0_sel:DWORD src1_sel:WORD_0
v_smfmac_f32_16x16x64_bf16 v[8:11], a[180:183], v[52:59], v158
s_waitcnt lgkmcnt(8)
ds_read_u16 v105, v105
v_add_u32_sdwa v87, s42, v135 dst_sel:DWORD dst_unused:UNUSED_PAD src0_sel:DWORD src1_sel:WORD_1
v_smfmac_f32_16x16x64_bf16 v[8:11], a[216:219], v[92:99], v162
s_add_u32 m0, s44, 0
ds_read_u16 v106, v106
v_add_u32_sdwa v88, s42, v136 dst_sel:DWORD dst_unused:UNUSED_PAD src0_sel:DWORD src1_sel:WORD_0
v_smfmac_f32_16x16x64_bf16 v[24:27], a[160:163], v[44:51], v156
buffer_load_dwordx4 v3, s[16:19], s45 offen offset:0 nt lds
v_add_u32_sdwa v89, s42, v136 dst_sel:DWORD dst_unused:UNUSED_PAD src0_sel:DWORD src1_sel:WORD_1
v_smfmac_f32_16x16x64_bf16 v[24:27], a[196:199], v[52:59], v160
s_mov_b32 s49, s50
ds_read_u16 v107, v107
v_add_u32_sdwa v90, s42, v137 dst_sel:DWORD dst_unused:UNUSED_PAD src0_sel:DWORD src1_sel:WORD_0
v_smfmac_f32_16x16x64_bf16 v[24:27], a[232:235], v[92:99], v164
s_waitcnt lgkmcnt(7)
ds_read_u16 v84, v84
v_add_u32_sdwa v91, s42, v137 dst_sel:DWORD dst_unused:UNUSED_PAD src0_sel:DWORD src1_sel:WORD_1
v_smfmac_f32_16x16x64_bf16 v[24:27], v[114:117], v[76:83], v182
s_mov_b32 s50, s45
ds_read_u16 v85, v85
v_smfmac_f32_16x16x64_bf16 v[20:23], v[114:117], v[76:83], v181 abid:1
ds_read_u16 v86, v86
v_smfmac_f32_16x16x64_bf16 v[28:31], v[114:117], v[76:83], v182 abid:1
ds_read_b128 v[114:117], v2 offset:256
v_add_u32_sdwa v76, s4, v118 dst_sel:DWORD dst_unused:UNUSED_PAD src0_sel:DWORD src1_sel:WORD_0
v_smfmac_f32_16x16x64_bf16 v[28:31], a[164:167], v[44:51], v156 abid:1
ds_read_u16 v87, v87
v_add_u32_sdwa v77, s4, v118 dst_sel:DWORD dst_unused:UNUSED_PAD src0_sel:DWORD src1_sel:WORD_1
v_smfmac_f32_16x16x64_bf16 v[28:31], a[200:203], v[52:59], v160 abid:1
ds_read_u16 v88, v88
v_add_u32_sdwa v78, s4, v119 dst_sel:DWORD dst_unused:UNUSED_PAD src0_sel:DWORD src1_sel:WORD_0
v_smfmac_f32_16x16x64_bf16 v[28:31], a[236:239], v[92:99], v164 abid:1
ds_read_b128 v[60:63], v0 offset:14336
v_add_u32_sdwa v79, s4, v119 dst_sel:DWORD dst_unused:UNUSED_PAD src0_sel:DWORD src1_sel:WORD_1
v_smfmac_f32_16x16x64_bf16 v[12:15], a[148:151], v[44:51], v154 abid:1
ds_read_u16 v89, v89
v_add_u32_sdwa v80, s4, v120 dst_sel:DWORD dst_unused:UNUSED_PAD src0_sel:DWORD src1_sel:WORD_0
v_smfmac_f32_16x16x64_bf16 v[12:15], a[184:187], v[52:59], v158 abid:1
s_add_u32 m0, s44, 3840
s_waitcnt vmcnt(6)
ds_read_b128 v[64:67], v1 offset:14336
v_add_u32_sdwa v81, s4, v120 dst_sel:DWORD dst_unused:UNUSED_PAD src0_sel:DWORD src1_sel:WORD_1
v_smfmac_f32_16x16x64_bf16 v[12:15], a[220:223], v[92:99], v162 abid:1
buffer_load_dwordx4 v3, s[16:19], s45 offen offset:256 nt lds
v_add_u32_sdwa v82, s4, v121 dst_sel:DWORD dst_unused:UNUSED_PAD src0_sel:DWORD src1_sel:WORD_0
v_smfmac_f32_16x16x64_bf16 v[32:35], a[168:171], v[44:51], v157
ds_read_b128 v[68:71], v0 offset:16384
v_add_u32_sdwa v83, s4, v121 dst_sel:DWORD dst_unused:UNUSED_PAD src0_sel:DWORD src1_sel:WORD_1
v_smfmac_f32_16x16x64_bf16 v[32:35], a[204:207], v[52:59], v161
ds_read_u16 v90, v90
v_smfmac_f32_16x16x64_bf16 v[32:35], a[240:243], v[92:99], v165
s_waitcnt lgkmcnt(7)
ds_read_b128 v[72:75], v1 offset:16384
v_add_u32 v0, s43, v0
v_smfmac_f32_16x16x64_bf16 v[32:35], v[114:117], v[100:107], v183 abid:1
ds_read_u16 v91, v91
v_add_u32 v1, s43, v1
v_smfmac_f32_16x16x64_bf16 v[28:31], v[114:117], v[100:107], v183
v_smfmac_f32_16x16x64_bf16 v[36:39], v[114:117], v[100:107], v184
ds_read_b128 v[114:117], v2 offset:320
v_smfmac_f32_16x16x64_bf16 v[36:39], a[172:175], v[44:51], v157 abid:1
s_add_u32 m0, s44, 7680
v_smfmac_f32_16x16x64_bf16 v[36:39], a[208:211], v[52:59], v161 abid:1
buffer_load_dwordx4 v3, s[16:19], s45 offen offset:512 nt lds
v_smfmac_f32_16x16x64_bf16 v[36:39], a[244:247], v[92:99], v165 abid:1
v_smfmac_f32_16x16x64_bf16 v[16:19], a[152:155], v[44:51], v155
s_add_u32 m0, s44, 11520
v_smfmac_f32_16x16x64_bf16 v[16:19], a[188:191], v[52:59], v159
buffer_load_dwordx4 v3, s[16:19], s45 offen offset:768 nt lds
v_smfmac_f32_16x16x64_bf16 v[16:19], a[224:227], v[92:99], v163
s_mov_b64 exec, s[62:63]
ds_write_b32 v0, v7 offset:18432
s_mov_b64 exec, -1
v_smfmac_f32_16x16x64_bf16 v[20:23], a[156:159], v[44:51], v155 abid:1
s_add_u32 m0, s44, s8
v_smfmac_f32_16x16x64_bf16 v[20:23], a[192:195], v[52:59], v159 abid:1
s_mov_b64 exec, s[10:11]
buffer_load_dwordx4 v3, s[16:19], s7 offen offset:896 nt lds
s_mov_b64 exec, -1
v_smfmac_f32_16x16x64_bf16 v[20:23], a[228:231], v[92:99], v163 abid:1
s_add_u32 s44, s44, s5
s_cmp_ge_u32 s44, 148480
s_cselect_b32 s44, s9, s44
v_smfmac_f32_16x16x64_bf16 v[40:43], a[176:179], v[44:51], v176
v_smfmac_f32_16x16x64_bf16 v[40:43], a[212:215], v[52:59], v176 abid:1
v_smfmac_f32_16x16x64_bf16 v[40:43], a[248:251], v[92:99], v177
s_waitcnt lgkmcnt(0)
v_smfmac_f32_16x16x64_bf16 v[40:43], v[114:117], v[84:91], v185
v_smfmac_f32_16x16x64_bf16 v[36:39], v[114:117], v[84:91], v184 abid:1
s_barrier
v_smfmac_f32_16x16x64_bf16 v[8:11], a[252:255], v[60:67], v166
s_mov_b32 s42, s4
ds_read_b32 v7, v0 offset:18432
v_smfmac_f32_16x16x64_bf16 v[8:11], v[218:221], v[68:75], v170
ds_read_b128 v[44:47], v0 offset:0
v_add_u32_sdwa v84, s42, v122 dst_sel:DWORD dst_unused:UNUSED_PAD src0_sel:DWORD src1_sel:WORD_0
v_smfmac_f32_16x16x64_bf16 v[12:15], v[186:189], v[60:67], v166 abid:1
ds_read_b128 v[48:51], v1 offset:0
v_add_u32_sdwa v85, s42, v122 dst_sel:DWORD dst_unused:UNUSED_PAD src0_sel:DWORD src1_sel:WORD_1
v_smfmac_f32_16x16x64_bf16 v[12:15], v[222:225], v[68:75], v170 abid:1
ds_read_b128 v[52:55], v0 offset:2048
v_add_u32_sdwa v86, s42, v123 dst_sel:DWORD dst_unused:UNUSED_PAD src0_sel:DWORD src1_sel:WORD_0
v_smfmac_f32_16x16x64_bf16 v[16:19], v[190:193], v[60:67], v167
ds_read_b128 v[56:59], v1 offset:2048
v_cvt_pk_bf16_f32 v92, v8, v9
v_smfmac_f32_16x16x64_bf16 v[16:19], v[226:229], v[68:75], v171
ds_read_u16 v76, v76
v_cvt_pk_bf16_f32 v93, v10, v11
v_smfmac_f32_16x16x64_bf16 v[20:23], v[194:197], v[60:67], v167 abid:1
ds_read_b128 v[8:11], v2 offset:1024
v_cvt_pk_bf16_f32 v94, v12, v13
v_smfmac_f32_16x16x64_bf16 v[20:23], v[230:233], v[68:75], v171 abid:1
ds_read_u16 v77, v77
v_cvt_pk_bf16_f32 v95, v14, v15
v_smfmac_f32_16x16x64_bf16 v[24:27], v[198:201], v[60:67], v168
ds_read_b128 v[12:15], v2 offset:1088
v_cvt_pk_bf16_f32 v96, v16, v17
v_smfmac_f32_16x16x64_bf16 v[24:27], v[234:237], v[68:75], v172
s_waitcnt lgkmcnt(8)
ds_read_u16 v78, v78
v_cvt_pk_bf16_f32 v97, v18, v19
v_readfirstlane_b32 s56, v7
v_smfmac_f32_16x16x64_bf16 v[28:31], v[202:205], v[60:67], v168 abid:1
s_lshr_b32 s60, s56, 4
ds_read_b128 v[16:19], v2 offset:1152
v_cvt_pk_bf16_f32 v98, v20, v21
v_smfmac_f32_16x16x64_bf16 v[28:31], v[238:241], v[68:75], v172 abid:1
s_mul_i32 s60, s60, 884736
ds_read_u16 v79, v79
v_cvt_pk_bf16_f32 v99, v22, v23
v_smfmac_f32_16x16x64_bf16 v[32:35], v[206:209], v[60:67], v169
s_mul_i32 s61, s56, 18432
ds_read_b128 v[20:23], v2 offset:1216
v_cvt_pk_bf16_f32 v100, v24, v25
v_smfmac_f32_16x16x64_bf16 v[32:35], v[242:245], v[68:75], v173
s_add_u32 s60, s60, s57
ds_read_u16 v80, v80
v_cvt_pk_bf16_f32 v101, v26, v27
v_smfmac_f32_16x16x64_bf16 v[36:39], v[210:213], v[60:67], v169 abid:1
s_add_u32 s45, s60, s61
ds_read_b128 v[24:27], v2 offset:1280
v_cvt_pk_bf16_f32 v102, v28, v29
v_smfmac_f32_16x16x64_bf16 v[36:39], v[246:249], v[68:75], v173 abid:1
ds_read_u16 v81, v81
v_cvt_pk_bf16_f32 v103, v30, v31
v_smfmac_f32_16x16x64_bf16 v[40:43], v[214:217], v[60:67], v177 abid:1
s_cmp_lt_u32 s56, s64
ds_read_b128 v[28:31], v2 offset:1344
v_cvt_pk_bf16_f32 v104, v32, v33
v_smfmac_f32_16x16x64_bf16 v[40:43], v[250:253], v[68:75], v178
s_waitcnt lgkmcnt(10)
v_cvt_pk_bf16_f32 v105, v34, v35
s_cbranch_scc1 L_loopck
s_mov_b32 s41, 0
s_mov_b32 s15, 3
s_mov_b32 s12, 7
s_mov_b32 s92, 4
s_mov_b32 s87, 4
s_mov_b32 s59, -1
.p2align 3
L_loopnk:
v_smfmac_f32_16x16x64_bf16 v[8:11], a[0:3], v[44:51], v138
ds_read_b128 v[32:35], v2 offset:1408
v_cvt_pk_bf16_f32 v106, v36, v37
v_smfmac_f32_16x16x64_bf16 v[8:11], a[36:39], v[52:59], v142
s_waitcnt lgkmcnt(9)
v_cvt_pk_bf16_f32 v107, v38, v39
v_smfmac_f32_16x16x64_bf16 v[12:15], a[4:7], v[44:51], v138 abid:1
ds_read_b128 v[36:39], v2 offset:1472
v_cvt_pk_bf16_f32 v112, v40, v41
v_smfmac_f32_16x16x64_bf16 v[12:15], a[40:43], v[52:59], v142 abid:1
s_waitcnt lgkmcnt(8)
ds_read_b128 v[60:63], v0 offset:4096
v_cvt_pk_bf16_f32 v113, v42, v43
v_smfmac_f32_16x16x64_bf16 v[16:19], a[8:11], v[44:51], v139
s_cmp_eq_u32 s4, 129920
ds_read_b128 v[40:43], v2 offset:1536
v_cndmask_b32_dpp v108, v96, v92, vcc quad_perm:[1,0,3,2] row_mask:0xf bank_mask:0xf
v_smfmac_f32_16x16x64_bf16 v[16:19], a[44:47], v[52:59], v143
s_waitcnt lgkmcnt(8)
ds_read_u16 v82, v82
v_cndmask_b32_dpp v109, v97, v93, vcc quad_perm:[1,0,3,2] row_mask:0xf bank_mask:0xf
v_smfmac_f32_16x16x64_bf16 v[20:23], a[12:15], v[44:51], v139 abid:1
s_cselect_b32 s43, -129920, s5
ds_read_u16 v84, v84
v_cndmask_b32_dpp v110, v98, v94, vcc quad_perm:[1,0,3,2] row_mask:0xf bank_mask:0xf
v_smfmac_f32_16x16x64_bf16 v[20:23], a[48:51], v[52:59], v143 abid:1
s_waitcnt lgkmcnt(8)
ds_read_b128 v[64:67], v1 offset:4096
v_cndmask_b32_dpp v111, v99, v95, vcc quad_perm:[1,0,3,2] row_mask:0xf bank_mask:0xf
v_smfmac_f32_16x16x64_bf16 v[24:27], a[16:19], v[44:51], v140
s_add_u32 s4, s4, s43
ds_read_b128 v[68:71], v0 offset:6144
v_add_u32_sdwa v87, s42, v123 dst_sel:DWORD dst_unused:UNUSED_PAD src0_sel:DWORD src1_sel:WORD_1
v_smfmac_f32_16x16x64_bf16 v[24:27], a[52:55], v[52:59], v144
buffer_store_dwordx4 v[108:111], v4, s[20:23], s46 offen offset:0 sc1
s_mov_b64 vcc, s[82:83]
s_waitcnt lgkmcnt(8)
ds_read_b128 v[72:75], v1 offset:6144
v_cndmask_b32_dpp v96, v92, v96, vcc quad_perm:[1,0,3,2] row_mask:0xf bank_mask:0xf
v_cndmask_b32_dpp v97, v93, v97, vcc quad_perm:[1,0,3,2] row_mask:0xf bank_mask:0xf
v_smfmac_f32_16x16x64_bf16 v[28:31], a[20:23], v[44:51], v140 abid:1
s_add_u32 s41, s41, 1
ds_read_u16 v83, v83
v_cndmask_b32_dpp v98, v94, v98, vcc quad_perm:[1,0,3,2] row_mask:0xf bank_mask:0xf
v_smfmac_f32_16x16x64_bf16 v[28:31], a[56:59], v[52:59], v144 abid:1
s_waitcnt lgkmcnt(9)
ds_read_b128 v[114:117], v2 offset:64
v_cndmask_b32_dpp v99, v95, v99, vcc quad_perm:[1,0,3,2] row_mask:0xf bank_mask:0xf
v_smfmac_f32_16x16x64_bf16 v[32:35], a[24:27], v[44:51], v141
ds_read_u16 v85, v85
v_add_u32_sdwa v88, s42, v124 dst_sel:DWORD dst_unused:UNUSED_PAD src0_sel:DWORD src1_sel:WORD_0
v_smfmac_f32_16x16x64_bf16 v[32:35], a[60:63], v[52:59], v145
s_waitcnt lgkmcnt(10)
ds_read_u16 v86, v86
v_add_u32_sdwa v89, s42, v124 dst_sel:DWORD dst_unused:UNUSED_PAD src0_sel:DWORD src1_sel:WORD_1
v_smfmac_f32_16x16x64_bf16 v[36:39], a[28:31], v[44:51], v141 abid:1
ds_read_u16 v87, v87
v_add_u32_sdwa v90, s42, v125 dst_sel:DWORD dst_unused:UNUSED_PAD src0_sel:DWORD src1_sel:WORD_0
v_smfmac_f32_16x16x64_bf16 v[36:39], a[64:67], v[52:59], v145 abid:1
s_waitcnt lgkmcnt(10)
ds_read_u16 v88, v88
v_add_u32_sdwa v91, s42, v125 dst_sel:DWORD dst_unused:UNUSED_PAD src0_sel:DWORD src1_sel:WORD_1
v_smfmac_f32_16x16x64_bf16 v[40:43], a[32:35], v[44:51], v174
buffer_store_dwordx4 v[96:99], v4, s[20:23], s46 offen offset:1152 sc1
s_mov_b64 vcc, s[80:81]
ds_read_u16 v89, v89
v_cndmask_b32_dpp v92, v104, v100, vcc quad_perm:[1,0,3,2] row_mask:0xf bank_mask:0xf
v_cndmask_b32_dpp v93, v105, v101, vcc quad_perm:[1,0,3,2] row_mask:0xf bank_mask:0xf
v_smfmac_f32_16x16x64_bf16 v[40:43], a[68:71], v[52:59], v174 abid:1
s_waitcnt lgkmcnt(9)
ds_read_u16 v90, v90
v_cndmask_b32_dpp v94, v106, v102, vcc quad_perm:[1,0,3,2] row_mask:0xf bank_mask:0xf
v_smfmac_f32_16x16x64_bf16 v[8:11], a[72:75], v[60:67], v146
s_waitcnt lgkmcnt(8)
ds_read_u16 v91, v91
v_cndmask_b32_dpp v95, v107, v103, vcc quad_perm:[1,0,3,2] row_mask:0xf bank_mask:0xf
v_smfmac_f32_16x16x64_bf16 v[8:11], a[108:111], v[68:75], v150
s_waitcnt lgkmcnt(7)
ds_bpermute_b32 v112, v6, v112
v_smfmac_f32_16x16x64_bf16 v[8:11], v[114:117], v[76:83], v179
ds_bpermute_b32 v113, v6, v113
v_smfmac_f32_16x16x64_bf16 v[12:15], v[114:117], v[76:83], v179 abid:1
ds_read_b128 v[114:117], v2 offset:128
v_add_u32_sdwa v76, s42, v126 dst_sel:DWORD dst_unused:UNUSED_PAD src0_sel:DWORD src1_sel:WORD_0
v_smfmac_f32_16x16x64_bf16 v[12:15], a[76:79], v[60:67], v146 abid:1
ds_read_u16 v76, v76
v_add_u32_sdwa v77, s42, v126 dst_sel:DWORD dst_unused:UNUSED_PAD src0_sel:DWORD src1_sel:WORD_1
v_smfmac_f32_16x16x64_bf16 v[12:15], a[112:115], v[68:75], v150 abid:1
buffer_store_dwordx4 v[92:95], v4, s[20:23], s46 offen offset:128 sc1
s_mov_b64 vcc, s[82:83]
ds_read_u16 v77, v77
v_cndmask_b32_dpp v104, v100, v104, vcc quad_perm:[1,0,3,2] row_mask:0xf bank_mask:0xf
v_cndmask_b32_dpp v105, v101, v105, vcc quad_perm:[1,0,3,2] row_mask:0xf bank_mask:0xf
v_smfmac_f32_16x16x64_bf16 v[24:27], a[88:91], v[60:67], v148
ds_read_b128 v[44:47], v0 offset:8192
v_add_u32_sdwa v78, s42, v127 dst_sel:DWORD dst_unused:UNUSED_PAD src0_sel:DWORD src1_sel:WORD_0
v_smfmac_f32_16x16x64_bf16 v[24:27], a[124:127], v[68:75], v152
ds_read_u16 v78, v78
v_cndmask_b32_dpp v106, v102, v106, vcc quad_perm:[1,0,3,2] row_mask:0xf bank_mask:0xf
v_smfmac_f32_16x16x64_bf16 v[28:31], a[92:95], v[60:67], v148 abid:1
ds_read_b128 v[48:51], v1 offset:8192
v_cndmask_b32_dpp v107, v103, v107, vcc quad_perm:[1,0,3,2] row_mask:0xf bank_mask:0xf
v_smfmac_f32_16x16x64_bf16 v[28:31], a[128:131], v[68:75], v152 abid:1
ds_read_b128 v[52:55], v0 offset:10240
v_add_u32_sdwa v79, s42, v127 dst_sel:DWORD dst_unused:UNUSED_PAD src0_sel:DWORD src1_sel:WORD_1
v_smfmac_f32_16x16x64_bf16 v[32:35], a[96:99], v[60:67], v149
ds_read_u16 v79, v79
v_add_u32_sdwa v80, s42, v128 dst_sel:DWORD dst_unused:UNUSED_PAD src0_sel:DWORD src1_sel:WORD_0
v_smfmac_f32_16x16x64_bf16 v[32:35], a[132:135], v[68:75], v153
ds_read_u16 v80, v80
v_add_u32_sdwa v81, s42, v128 dst_sel:DWORD dst_unused:UNUSED_PAD src0_sel:DWORD src1_sel:WORD_1
v_smfmac_f32_16x16x64_bf16 v[16:19], a[80:83], v[60:67], v147
buffer_store_dwordx4 v[104:107], v4, s[20:23], s46 offen offset:1280 sc1
s_mov_b64 vcc, s[80:81]
ds_read_b128 v[56:59], v1 offset:10240
v_add_u32_sdwa v82, s42, v129 dst_sel:DWORD dst_unused:UNUSED_PAD src0_sel:DWORD src1_sel:WORD_0
v_add_u32_sdwa v83, s42, v129 dst_sel:DWORD dst_unused:UNUSED_PAD src0_sel:DWORD src1_sel:WORD_1
v_smfmac_f32_16x16x64_bf16 v[16:19], a[116:119], v[68:75], v151
s_waitcnt lgkmcnt(9)
ds_read_b128 v[92:95], v0 offset:12288
v_add_u32_sdwa v100, s42, v130 dst_sel:DWORD dst_unused:UNUSED_PAD src0_sel:DWORD src1_sel:WORD_0
v_smfmac_f32_16x16x64_bf16 v[16:19], v[114:117], v[84:91], v180 abid:1
ds_read_u16 v81, v81
v_add_u32_sdwa v101, s42, v130 dst_sel:DWORD dst_unused:UNUSED_PAD src0_sel:DWORD src1_sel:WORD_1
v_smfmac_f32_16x16x64_bf16 v[12:15], v[114:117], v[84:91], v180
ds_read_b128 v[96:99], v1 offset:12288
v_add_u32_sdwa v102, s42, v131 dst_sel:DWORD dst_unused:UNUSED_PAD src0_sel:DWORD src1_sel:WORD_0
v_smfmac_f32_16x16x64_bf16 v[20:23], v[114:117], v[84:91], v181
ds_read_u16 v82, v82
v_add_u32_sdwa v103, s42, v131 dst_sel:DWORD dst_unused:UNUSED_PAD src0_sel:DWORD src1_sel:WORD_1
v_smfmac_f32_16x16x64_bf16 v[20:23], a[84:87], v[60:67], v147 abid:1
ds_read_u16 v100, v100
v_add_u32_sdwa v104, s42, v132 dst_sel:DWORD dst_unused:UNUSED_PAD src0_sel:DWORD src1_sel:WORD_0
v_smfmac_f32_16x16x64_bf16 v[20:23], a[120:123], v[68:75], v151 abid:1
ds_read_u16 v83, v83
v_add_u32_sdwa v105, s42, v132 dst_sel:DWORD dst_unused:UNUSED_PAD src0_sel:DWORD src1_sel:WORD_1
v_smfmac_f32_16x16x64_bf16 v[36:39], a[100:103], v[60:67], v149 abid:1
buffer_store_dwordx2 v[112:113], v5, s[20:23], s46 offen nt
ds_read_b128 v[114:117], v2 offset:192
v_add_u32_sdwa v106, s42, v133 dst_sel:DWORD dst_unused:UNUSED_PAD src0_sel:DWORD src1_sel:WORD_0
v_smfmac_f32_16x16x64_bf16 v[36:39], a[136:139], v[68:75], v153 abid:1
s_mov_b32 s22, 75497472
ds_read_u16 v101, v101
v_add_u32_sdwa v107, s42, v133 dst_sel:DWORD dst_unused:UNUSED_PAD src0_sel:DWORD src1_sel:WORD_1
v_smfmac_f32_16x16x64_bf16 v[40:43], a[104:107], v[60:67], v175
s_mov_b32 s46, s48
ds_read_u16 v102, v102
v_add_u32_sdwa v84, s42, v134 dst_sel:DWORD dst_unused:UNUSED_PAD src0_sel:DWORD src1_sel:WORD_0
v_smfmac_f32_16x16x64_bf16 v[40:43], a[140:143], v[68:75], v175 abid:1
s_waitcnt lgkmcnt(13)
ds_read_u16 v103, v103
v_add_u32_sdwa v85, s42, v134 dst_sel:DWORD dst_unused:UNUSED_PAD src0_sel:DWORD src1_sel:WORD_1
v_smfmac_f32_16x16x64_bf16 v[8:11], a[144:147], v[44:51], v154
s_waitcnt lgkmcnt(10)
ds_read_u16 v104, v104
v_add_u32_sdwa v86, s42, v135 dst_sel:DWORD dst_unused:UNUSED_PAD src0_sel:DWORD src1_sel:WORD_0
v_smfmac_f32_16x16x64_bf16 v[8:11], a[180:183], v[52:59], v158
s_waitcnt lgkmcnt(8)
ds_read_u16 v105, v105
v_add_u32_sdwa v87, s42, v135 dst_sel:DWORD dst_unused:UNUSED_PAD src0_sel:DWORD src1_sel:WORD_1
v_smfmac_f32_16x16x64_bf16 v[8:11], a[216:219], v[92:99], v162
s_mov_b32 s48, s49
ds_read_u16 v106, v106
v_add_u32_sdwa v88, s42, v136 dst_sel:DWORD dst_unused:UNUSED_PAD src0_sel:DWORD src1_sel:WORD_0
v_smfmac_f32_16x16x64_bf16 v[24:27], a[160:163], v[44:51], v156
s_mov_b32 s49, s50
s_add_u32 s50, s50, 4718592
v_add_u32_sdwa v89, s42, v136 dst_sel:DWORD dst_unused:UNUSED_PAD src0_sel:DWORD src1_sel:WORD_1
v_smfmac_f32_16x16x64_bf16 v[24:27], a[196:199], v[52:59], v160
ds_read_u16 v107, v107
v_add_u32_sdwa v90, s42, v137 dst_sel:DWORD dst_unused:UNUSED_PAD src0_sel:DWORD src1_sel:WORD_0
v_smfmac_f32_16x16x64_bf16 v[24:27], a[232:235], v[92:99], v164
s_waitcnt lgkmcnt(7)
ds_read_u16 v84, v84
v_add_u32_sdwa v91, s42, v137 dst_sel:DWORD dst_unused:UNUSED_PAD src0_sel:DWORD src1_sel:WORD_1
v_smfmac_f32_16x16x64_bf16 v[24:27], v[114:117], v[76:83], v182
ds_read_u16 v85, v85
v_smfmac_f32_16x16x64_bf16 v[20:23], v[114:117], v[76:83], v181 abid:1
ds_read_u16 v86, v86
v_smfmac_f32_16x16x64_bf16 v[28:31], v[114:117], v[76:83], v182 abid:1
ds_read_b128 v[114:117], v2 offset:256
v_add_u32_sdwa v76, s4, v118 dst_sel:DWORD dst_unused:UNUSED_PAD src0_sel:DWORD src1_sel:WORD_0
v_smfmac_f32_16x16x64_bf16 v[28:31], a[164:167], v[44:51], v156 abid:1
ds_read_u16 v87, v87
v_add_u32_sdwa v77, s4, v118 dst_sel:DWORD dst_unused:UNUSED_PAD src0_sel:DWORD src1_sel:WORD_1
v_smfmac_f32_16x16x64_bf16 v[28:31], a[200:203], v[52:59], v160 abid:1
ds_read_u16 v88, v88
v_add_u32_sdwa v78, s4, v119 dst_sel:DWORD dst_unused:UNUSED_PAD src0_sel:DWORD src1_sel:WORD_0
v_smfmac_f32_16x16x64_bf16 v[28:31], a[236:239], v[92:99], v164 abid:1
ds_read_b128 v[60:63], v0 offset:14336
v_add_u32_sdwa v79, s4, v119 dst_sel:DWORD dst_unused:UNUSED_PAD src0_sel:DWORD src1_sel:WORD_1
v_smfmac_f32_16x16x64_bf16 v[12:15], a[148:151], v[44:51], v154 abid:1
ds_read_u16 v89, v89
v_add_u32_sdwa v80, s4, v120 dst_sel:DWORD dst_unused:UNUSED_PAD src0_sel:DWORD src1_sel:WORD_0
v_smfmac_f32_16x16x64_bf16 v[12:15], a[184:187], v[52:59], v158 abid:1
ds_read_b128 v[64:67], v1 offset:14336
v_add_u32_sdwa v81, s4, v120 dst_sel:DWORD dst_unused:UNUSED_PAD src0_sel:DWORD src1_sel:WORD_1
v_smfmac_f32_16x16x64_bf16 v[12:15], a[220:223], v[92:99], v162 abid:1
v_add_u32_sdwa v82, s4, v121 dst_sel:DWORD dst_unused:UNUSED_PAD src0_sel:DWORD src1_sel:WORD_0
v_smfmac_f32_16x16x64_bf16 v[32:35], a[168:171], v[44:51], v157
ds_read_b128 v[68:71], v0 offset:16384
v_add_u32_sdwa v83, s4, v121 dst_sel:DWORD dst_unused:UNUSED_PAD src0_sel:DWORD src1_sel:WORD_1
v_smfmac_f32_16x16x64_bf16 v[32:35], a[204:207], v[52:59], v161
ds_read_u16 v90, v90
v_smfmac_f32_16x16x64_bf16 v[32:35], a[240:243], v[92:99], v165
s_waitcnt lgkmcnt(7)
ds_read_b128 v[72:75], v1 offset:16384
v_add_u32 v0, s43, v0
v_smfmac_f32_16x16x64_bf16 v[32:35], v[114:117], v[100:107], v183 abid:1
ds_read_u16 v91, v91
v_add_u32 v1, s43, v1
v_smfmac_f32_16x16x64_bf16 v[28:31], v[114:117], v[100:107], v183
v_smfmac_f32_16x16x64_bf16 v[36:39], v[114:117], v[100:107], v184
ds_read_b128 v[114:117], v2 offset:320
v_smfmac_f32_16x16x64_bf16 v[36:39], a[172:175], v[44:51], v157 abid:1
v_smfmac_f32_16x16x64_bf16 v[36:39], a[208:211], v[52:59], v161 abid:1
v_smfmac_f32_16x16x64_bf16 v[36:39], a[244:247], v[92:99], v165 abid:1
v_smfmac_f32_16x16x64_bf16 v[16:19], a[152:155], v[44:51], v155
v_smfmac_f32_16x16x64_bf16 v[16:19], a[188:191], v[52:59], v159
v_smfmac_f32_16x16x64_bf16 v[16:19], a[224:227], v[92:99], v163
v_smfmac_f32_16x16x64_bf16 v[20:23], a[156:159], v[44:51], v155 abid:1
v_smfmac_f32_16x16x64_bf16 v[20:23], a[192:195], v[52:59], v159 abid:1
v_smfmac_f32_16x16x64_bf16 v[20:23], a[228:231], v[92:99], v163 abid:1
v_smfmac_f32_16x16x64_bf16 v[40:43], a[176:179], v[44:51], v176
s_bitcmp1_b32 s92, s41
v_smfmac_f32_16x16x64_bf16 v[40:43], a[212:215], v[52:59], v176 abid:1
s_cbranch_scc1 L_loopnk_w
L_loopnk_wb:
v_smfmac_f32_16x16x64_bf16 v[40:43], a[248:251], v[92:99], v177
s_waitcnt lgkmcnt(0)
v_smfmac_f32_16x16x64_bf16 v[40:43], v[114:117], v[84:91], v185
v_smfmac_f32_16x16x64_bf16 v[36:39], v[114:117], v[84:91], v184 abid:1
s_waitcnt vmcnt(20)
s_barrier
L_loopnk_p3:
v_smfmac_f32_16x16x64_bf16 v[8:11], a[252:255], v[60:67], v166
s_mov_b32 s42, s4
v_smfmac_f32_16x16x64_bf16 v[8:11], v[218:221], v[68:75], v170
ds_read_b128 v[44:47], v0 offset:0
v_add_u32_sdwa v84, s42, v122 dst_sel:DWORD dst_unused:UNUSED_PAD src0_sel:DWORD src1_sel:WORD_0
v_smfmac_f32_16x16x64_bf16 v[12:15], v[186:189], v[60:67], v166 abid:1
ds_read_b128 v[48:51], v1 offset:0
v_add_u32_sdwa v85, s42, v122 dst_sel:DWORD dst_unused:UNUSED_PAD src0_sel:DWORD src1_sel:WORD_1
v_smfmac_f32_16x16x64_bf16 v[12:15], v[222:225], v[68:75], v170 abid:1
ds_read_b128 v[52:55], v0 offset:2048
v_add_u32_sdwa v86, s42, v123 dst_sel:DWORD dst_unused:UNUSED_PAD src0_sel:DWORD src1_sel:WORD_0
v_smfmac_f32_16x16x64_bf16 v[16:19], v[190:193], v[60:67], v167
ds_read_b128 v[56:59], v1 offset:2048
v_cvt_pk_bf16_f32 v92, v8, v9
v_smfmac_f32_16x16x64_bf16 v[16:19], v[226:229], v[68:75], v171
ds_read_u16 v76, v76
v_cvt_pk_bf16_f32 v93, v10, v11
v_smfmac_f32_16x16x64_bf16 v[20:23], v[194:197], v[60:67], v167 abid:1
ds_read_b128 v[8:11], v2 offset:1024
v_cvt_pk_bf16_f32 v94, v12, v13
v_smfmac_f32_16x16x64_bf16 v[20:23], v[230:233], v[68:75], v171 abid:1
ds_read_u16 v77, v77
v_cvt_pk_bf16_f32 v95, v14, v15
v_smfmac_f32_16x16x64_bf16 v[24:27], v[198:201], v[60:67], v168
ds_read_b128 v[12:15], v2 offset:1088
v_cvt_pk_bf16_f32 v96, v16, v17
v_smfmac_f32_16x16x64_bf16 v[24:27], v[234:237], v[68:75], v172
ds_read_u16 v78, v78
v_cvt_pk_bf16_f32 v97, v18, v19
v_smfmac_f32_16x16x64_bf16 v[28:31], v[202:205], v[60:67], v168 abid:1
ds_read_b128 v[16:19], v2 offset:1152
v_cvt_pk_bf16_f32 v98, v20, v21
v_smfmac_f32_16x16x64_bf16 v[28:31], v[238:241], v[68:75], v172 abid:1
ds_read_u16 v79, v79
v_cvt_pk_bf16_f32 v99, v22, v23
v_smfmac_f32_16x16x64_bf16 v[32:35], v[206:209], v[60:67], v169
ds_read_b128 v[20:23], v2 offset:1216
v_cvt_pk_bf16_f32 v100, v24, v25
v_smfmac_f32_16x16x64_bf16 v[32:35], v[242:245], v[68:75], v173
ds_read_u16 v80, v80
v_cvt_pk_bf16_f32 v101, v26, v27
v_smfmac_f32_16x16x64_bf16 v[36:39], v[210:213], v[60:67], v169 abid:1
ds_read_b128 v[24:27], v2 offset:1280
v_cvt_pk_bf16_f32 v102, v28, v29
v_smfmac_f32_16x16x64_bf16 v[36:39], v[246:249], v[68:75], v173 abid:1
ds_read_u16 v81, v81
v_cvt_pk_bf16_f32 v103, v30, v31
v_smfmac_f32_16x16x64_bf16 v[40:43], v[214:217], v[60:67], v177 abid:1
s_bitcmp1_b32 s12, s41
ds_read_b128 v[28:31], v2 offset:1344
v_cvt_pk_bf16_f32 v104, v32, v33
v_smfmac_f32_16x16x64_bf16 v[40:43], v[250:253], v[68:75], v178
s_waitcnt lgkmcnt(10)
v_cvt_pk_bf16_f32 v105, v34, v35
s_cbranch_scc1 L_loopnk
s_cmp_eq_u32 s41, s59
s_cbranch_scc1 L_loopck
s_cmp_lt_u32 s41, s15
s_cbranch_scc1 L_loopk
s_nop 0
v_cndmask_b32_dpp v108, v96, v92, vcc quad_perm:[1,0,3,2] row_mask:0xf bank_mask:0xf
v_cndmask_b32_dpp v109, v97, v93, vcc quad_perm:[1,0,3,2] row_mask:0xf bank_mask:0xf
v_cndmask_b32_dpp v110, v98, v94, vcc quad_perm:[1,0,3,2] row_mask:0xf bank_mask:0xf
v_cndmask_b32_dpp v111, v99, v95, vcc quad_perm:[1,0,3,2] row_mask:0xf bank_mask:0xf
buffer_store_dwordx4 v[108:111], v4, s[20:23], s46 offen offset:0 sc1
s_mov_b64 vcc, s[82:83]
v_cvt_pk_bf16_f32 v112, v40, v41
v_cvt_pk_bf16_f32 v113, v42, v43
ds_bpermute_b32 v112, v6, v112
ds_bpermute_b32 v113, v6, v113
v_cndmask_b32_dpp v96, v92, v96, vcc quad_perm:[1,0,3,2] row_mask:0xf bank_mask:0xf
v_cndmask_b32_dpp v97, v93, v97, vcc quad_perm:[1,0,3,2] row_mask:0xf bank_mask:0xf
v_cndmask_b32_dpp v98, v94, v98, vcc quad_perm:[1,0,3,2] row_mask:0xf bank_mask:0xf
v_cndmask_b32_dpp v99, v95, v99, vcc quad_perm:[1,0,3,2] row_mask:0xf bank_mask:0xf
buffer_store_dwordx4 v[96:99], v4, s[20:23], s46 offen offset:1152 sc1
s_mov_b64 vcc, s[80:81]
v_cvt_pk_bf16_f32 v106, v36, v37
v_cvt_pk_bf16_f32 v107, v38, v39
v_cndmask_b32_dpp v92, v104, v100, vcc quad_perm:[1,0,3,2] row_mask:0xf bank_mask:0xf
v_cndmask_b32_dpp v93, v105, v101, vcc quad_perm:[1,0,3,2] row_mask:0xf bank_mask:0xf
v_cndmask_b32_dpp v94, v106, v102, vcc quad_perm:[1,0,3,2] row_mask:0xf bank_mask:0xf
v_cndmask_b32_dpp v95, v107, v103, vcc quad_perm:[1,0,3,2] row_mask:0xf bank_mask:0xf
buffer_store_dwordx4 v[92:95], v4, s[20:23], s46 offen offset:128 sc1
s_mov_b64 vcc, s[82:83]
v_cndmask_b32_dpp v104, v100, v104, vcc quad_perm:[1,0,3,2] row_mask:0xf bank_mask:0xf
v_cndmask_b32_dpp v105, v101, v105, vcc quad_perm:[1,0,3,2] row_mask:0xf bank_mask:0xf
v_cndmask_b32_dpp v106, v102, v106, vcc quad_perm:[1,0,3,2] row_mask:0xf bank_mask:0xf
v_cndmask_b32_dpp v107, v103, v107, vcc quad_perm:[1,0,3,2] row_mask:0xf bank_mask:0xf
buffer_store_dwordx4 v[104:107], v4, s[20:23], s46 offen offset:1280 sc1
s_mov_b64 vcc, s[80:81]
s_waitcnt lgkmcnt(0)
buffer_store_dwordx2 v[112:113], v5, s[20:23], s46 offen nt
s_branch L_fin
L_loopk_w:
s_bitcmp1_b32 s87, s41
s_waitcnt vmcnt(15)
s_cbranch_scc0 L_loopk_wb
s_waitcnt vmcnt(10)
s_branch L_loopk_wb
L_loopnk_w:
s_bitcmp1_b32 s87, s41
s_waitcnt vmcnt(15)
s_cbranch_scc0 L_loopnk_wb
s_waitcnt vmcnt(10)
s_branch L_loopnk_wb
L_slow:
s_waitcnt vmcnt(0) lgkmcnt(0)
s_mov_b32 s87, 0
L_sm:
s_lshl_b32 s86, s2, 1
s_add_u32 s86, s86, s87
s_add_u32 s86, s86, 2
s_mul_i32 s86, s86, 393216
s_mov_b32 s84, 0
L_st:
s_and_b32 s48, s84, 3
s_lshr_b32 s49, s84, 2
s_cmp_ge_u32 s84, 36
s_cbranch_scc1 L_pbg
s_mul_i32 s52, s49, 288
s_add_u32 s52, s52, s48
s_lshl_b32 s52, s52, 8
v_lshl_add_u32 v50, v7, 2, s52
L_pbbg:
s_mul_i32 s52, s40, 18432
v_mov_b32 v62, s52
v_add_u32 v50, v62, v50
buffer_load_dword v8, v50, s[28:31], 0 offen offset:0
buffer_load_dword v9, v50, s[28:31], 0 offen offset:1152
buffer_load_dword v10, v50, s[28:31], 0 offen offset:2304
buffer_load_dword v11, v50, s[28:31], 0 offen offset:3456
v_add_u32 v50, 4608, v50
buffer_load_dword v12, v50, s[28:31], 0 offen offset:0
buffer_load_dword v13, v50, s[28:31], 0 offen offset:1152
buffer_load_dword v14, v50, s[28:31], 0 offen offset:2304
buffer_load_dword v15, v50, s[28:31], 0 offen offset:3456
v_add_u32 v50, 4608, v50
buffer_load_dword v16, v50, s[28:31], 0 offen offset:0
buffer_load_dword v17, v50, s[28:31], 0 offen offset:1152
buffer_load_dword v18, v50, s[28:31], 0 offen offset:2304
buffer_load_dword v19, v50, s[28:31], 0 offen offset:3456
v_add_u32 v50, 4608, v50
buffer_load_dword v20, v50, s[28:31], 0 offen offset:0
buffer_load_dword v21, v50, s[28:31], 0 offen offset:1152
buffer_load_dword v22, v50, s[28:31], 0 offen offset:2304
buffer_load_dword v23, v50, s[28:31], 0 offen offset:3456
s_branch L_pcg
L_pbg:
s_mul_i32 s52, s84, 147456
s_sub_u32 s52, s52, 5307392
v_and_b32 v62, 2, v7
v_mul_u32_u24 v50, 36864, v62
v_and_b32 v62, 1, v7
v_lshl_add_u32 v50, v62, 2, v50
v_and_b32 v62, 4, v7
v_lshl_add_u32 v50, v62, 3, v50
v_and_b32 v62, 32, v7
v_lshl_add_u32 v50, v62, 1, v50
v_and_b32 v62, 24, v7
v_add3_u32 v50, v50, v62, s52
s_branch L_pbbg
L_pcg:
s_sub_u32 s50, s84, 36
s_lshl_b32 s51, s40, 4
v_and_b32 v58, 1, v7
v_bfe_u32 v59, v7, 1, 1
v_bfe_u32 v60, v7, 3, 2
s_mul_i32 s52, s48, 9
s_add_u32 s52, s52, s49
s_mul_i32 s53, s52, 9
s_mul_i32 s54, s50, 18
s_add_u32 s54, s54, 8
s_lshl_b32 s55, s52, 2
s_add_u32 s55, s55, s40
s_lshl_b32 s56, s50, 2
s_add_u32 s56, s56, s40
s_cmp_eq_u32 s84, 40
s_cselect_b32 s57, 0x100000, 9
s_cmp_lt_u32 s84, 36
s_cselect_b32 s53, s53, s54
s_cselect_b32 s54, 2, 81
s_cselect_b32 s57, 1, s57
s_cselect_b32 s55, s55, s56
s_mov_b32 s56, 331776
s_cselect_b32 s56, s56, 368640
s_mov_b32 s58, 373760
s_cselect_b32 s58, s58, 382976
s_cselect_b32 s59, 16, 4
s_cselect_b32 s60, 4, 64
s_cselect_b32 s61, 12, 11
s_cselect_b32 s62, 1, 0x8001
v_bfe_u32 v61, v7, 2, 1
v_lshrrev_b32 v62, 5, v7
v_lshl_add_u32 v61, v62, 1, v61
v_lshlrev_b32 v62, 1, v58
v_lshl_add_u32 v60, v60, 2, v62
v_add_u32 v62, v60, v59
v_mul_u32_u24 v51, s54, v61
v_add_lshl_u32 v51, v51, s53, 6
v_add3_u32 v51, v51, v62, s51
v_lshl_add_u32 v51, v51, 4, s86
s_lshl_b32 s57, s57, 10
v_add_u32 v66, s57, v51
s_lshl_b32 s52, s55, 8
s_add_u32 s52, s52, s56
s_add_u32 s52, s52, s86
v_mul_u32_u24 v52, s59, v62
v_mad_u32_u24 v52, v61, s60, v52
v_lshl_add_u32 v54, v7, 2, s52
v_mov_b32 v55, 0x05040100
v_mov_b32 v62, 0x03020706
v_cmp_eq_u32 vcc, 1, v59
v_mov_b32 v68, 0xf0a0500
v_mov_b32 v69, 0x8f8a8580
v_mov_b32 v70, 0x1f1a1510
v_mov_b32 v71, 0x9f9a9590
v_mov_b32 v72, 0x2f2a2520
v_mov_b32 v73, 0xafaaa5a0
v_mov_b32 v74, 0x3f3a3530
v_mov_b32 v75, 0xbfbab5b0
v_cndmask_b32 v55, v55, v62, vcc
s_mov_b32 s64, 0x5040500
s_mov_b32 s65, 0x5040501
s_mov_b32 s66, 0x5040502
s_mov_b32 s67, 0x5040503
s_mov_b32 s68, 0x7060700
s_mov_b32 s69, 0x7060701
s_mov_b32 s70, 0x7060702
s_mov_b32 s71, 0x7060703
s_mov_b32 s72, 0x05060102
s_cmp_lg_u32 s87, 0
s_waitcnt vmcnt(12)
v_perm_b32 v24, v8, v68, s64
v_perm_b32 v25, v9, v68, s65
v_perm_b32 v26, v10, v68, s66
v_perm_b32 v27, v11, v68, s67
v_max3_f32 v28, |v24|, |v25|, |v26|
v_med3_f32 v29, |v24|, |v25|, |v26|
v_min3_f32 v30, |v24|, |v25|, |v26|
v_med3_f32 v32, v28, v29, |v27|
v_med3_f32 v33, v29, v30, |v27|
v_max_f32 v31, v28, |v27|
v_cmp_eq_u32_sdwa vcc, v33, v32 src0_sel:WORD_1 src1_sel:WORD_1
s_cbranch_scc0 L_rb0g
v_min_f32 v30, v30, |v27|
v_cndmask_b32 v31, 0, v33, vcc
v_cmp_eq_u32_sdwa vcc, v30, v32 src0_sel:WORD_1 src1_sel:WORD_1
s_nop 1
v_cndmask_b32 v32, 0, v30, vcc
L_rb0g:
v_perm_b32 v36, v31, v32, s72
v_bfi_b32 v44, 3, v32, v31
v_perm_b32 v24, v8, v69, s68
v_perm_b32 v25, v9, v69, s69
v_perm_b32 v26, v10, v69, s70
v_perm_b32 v27, v11, v69, s71
v_max3_f32 v28, |v24|, |v25|, |v26|
v_med3_f32 v29, |v24|, |v25|, |v26|
v_min3_f32 v30, |v24|, |v25|, |v26|
v_med3_f32 v32, v28, v29, |v27|
v_med3_f32 v33, v29, v30, |v27|
v_max_f32 v31, v28, |v27|
v_cmp_eq_u32_sdwa vcc, v33, v32 src0_sel:WORD_1 src1_sel:WORD_1
s_cbranch_scc0 L_rb1g
v_min_f32 v30, v30, |v27|
v_cndmask_b32 v31, 0, v33, vcc
v_cmp_eq_u32_sdwa vcc, v30, v32 src0_sel:WORD_1 src1_sel:WORD_1
s_nop 1
v_cndmask_b32 v32, 0, v30, vcc
L_rb1g:
v_perm_b32 v40, v31, v32, s72
v_bfi_b32 v46, 3, v32, v31
s_waitcnt vmcnt(8)
v_perm_b32 v24, v12, v70, s64
v_perm_b32 v25, v13, v70, s65
v_perm_b32 v26, v14, v70, s66
v_perm_b32 v27, v15, v70, s67
v_max3_f32 v28, |v24|, |v25|, |v26|
v_med3_f32 v29, |v24|, |v25|, |v26|
v_min3_f32 v30, |v24|, |v25|, |v26|
v_med3_f32 v32, v28, v29, |v27|
v_med3_f32 v33, v29, v30, |v27|
v_max_f32 v31, v28, |v27|
v_cmp_eq_u32_sdwa vcc, v33, v32 src0_sel:WORD_1 src1_sel:WORD_1
s_cbranch_scc0 L_rb2g
v_min_f32 v30, v30, |v27|
v_cndmask_b32 v31, 0, v33, vcc
v_cmp_eq_u32_sdwa vcc, v30, v32 src0_sel:WORD_1 src1_sel:WORD_1
s_nop 1
v_cndmask_b32 v32, 0, v30, vcc
L_rb2g:
v_perm_b32 v37, v31, v32, s72
v_bfi_b32 v31, 3, v32, v31
v_lshlrev_b32 v31, 4, v31
v_bfi_b32 v44, 15, v44, v31
v_perm_b32 v24, v12, v71, s68
v_perm_b32 v25, v13, v71, s69
v_perm_b32 v26, v14, v71, s70
v_perm_b32 v27, v15, v71, s71
v_max3_f32 v28, |v24|, |v25|, |v26|
v_med3_f32 v29, |v24|, |v25|, |v26|
v_min3_f32 v30, |v24|, |v25|, |v26|
v_med3_f32 v32, v28, v29, |v27|
v_med3_f32 v33, v29, v30, |v27|
v_max_f32 v31, v28, |v27|
v_cmp_eq_u32_sdwa vcc, v33, v32 src0_sel:WORD_1 src1_sel:WORD_1
s_cbranch_scc0 L_rb3g
v_min_f32 v30, v30, |v27|
v_cndmask_b32 v31, 0, v33, vcc
v_cmp_eq_u32_sdwa vcc, v30, v32 src0_sel:WORD_1 src1_sel:WORD_1
s_nop 1
v_cndmask_b32 v32, 0, v30, vcc
L_rb3g:
v_perm_b32 v41, v31, v32, s72
v_bfi_b32 v31, 3, v32, v31
v_lshlrev_b32 v31, 4, v31
v_bfi_b32 v46, 15, v46, v31
s_waitcnt vmcnt(4)
v_perm_b32 v24, v16, v72, s64
v_perm_b32 v25, v17, v72, s65
v_perm_b32 v26, v18, v72, s66
v_perm_b32 v27, v19, v72, s67
v_max3_f32 v28, |v24|, |v25|, |v26|
v_med3_f32 v29, |v24|, |v25|, |v26|
v_min3_f32 v30, |v24|, |v25|, |v26|
v_med3_f32 v32, v28, v29, |v27|
v_med3_f32 v33, v29, v30, |v27|
v_max_f32 v31, v28, |v27|
v_cmp_eq_u32_sdwa vcc, v33, v32 src0_sel:WORD_1 src1_sel:WORD_1
s_cbranch_scc0 L_rb4g
v_min_f32 v30, v30, |v27|
v_cndmask_b32 v31, 0, v33, vcc
v_cmp_eq_u32_sdwa vcc, v30, v32 src0_sel:WORD_1 src1_sel:WORD_1
s_nop 1
v_cndmask_b32 v32, 0, v30, vcc
L_rb4g:
v_perm_b32 v38, v31, v32, s72
v_bfi_b32 v45, 3, v32, v31
v_perm_b32 v24, v16, v73, s68
v_perm_b32 v25, v17, v73, s69
v_perm_b32 v26, v18, v73, s70
v_perm_b32 v27, v19, v73, s71
v_max3_f32 v28, |v24|, |v25|, |v26|
v_med3_f32 v29, |v24|, |v25|, |v26|
v_min3_f32 v30, |v24|, |v25|, |v26|
v_med3_f32 v32, v28, v29, |v27|
v_med3_f32 v33, v29, v30, |v27|
v_max_f32 v31, v28, |v27|
v_cmp_eq_u32_sdwa vcc, v33, v32 src0_sel:WORD_1 src1_sel:WORD_1
s_cbranch_scc0 L_rb5g
v_min_f32 v30, v30, |v27|
v_cndmask_b32 v31, 0, v33, vcc
v_cmp_eq_u32_sdwa vcc, v30, v32 src0_sel:WORD_1 src1_sel:WORD_1
s_nop 1
v_cndmask_b32 v32, 0, v30, vcc
L_rb5g:
v_perm_b32 v42, v31, v32, s72
v_bfi_b32 v47, 3, v32, v31
s_waitcnt vmcnt(0)
v_perm_b32 v24, v20, v74, s64
v_perm_b32 v25, v21, v74, s65
v_perm_b32 v26, v22, v74, s66
v_perm_b32 v27, v23, v74, s67
v_max3_f32 v28, |v24|, |v25|, |v26|
v_med3_f32 v29, |v24|, |v25|, |v26|
v_min3_f32 v30, |v24|, |v25|, |v26|
v_med3_f32 v32, v28, v29, |v27|
v_med3_f32 v33, v29, v30, |v27|
v_max_f32 v31, v28, |v27|
v_cmp_eq_u32_sdwa vcc, v33, v32 src0_sel:WORD_1 src1_sel:WORD_1
s_cbranch_scc0 L_rb6g
v_min_f32 v30, v30, |v27|
v_cndmask_b32 v31, 0, v33, vcc
v_cmp_eq_u32_sdwa vcc, v30, v32 src0_sel:WORD_1 src1_sel:WORD_1
s_nop 1
v_cndmask_b32 v32, 0, v30, vcc
L_rb6g:
v_perm_b32 v39, v31, v32, s72
v_bfi_b32 v31, 3, v32, v31
v_lshlrev_b32 v31, 4, v31
v_bfi_b32 v45, 15, v45, v31
v_perm_b32 v24, v20, v75, s68
v_perm_b32 v25, v21, v75, s69
v_perm_b32 v26, v22, v75, s70
v_perm_b32 v27, v23, v75, s71
v_max3_f32 v28, |v24|, |v25|, |v26|
v_med3_f32 v29, |v24|, |v25|, |v26|
v_min3_f32 v30, |v24|, |v25|, |v26|
v_med3_f32 v32, v28, v29, |v27|
v_med3_f32 v33, v29, v30, |v27|
v_max_f32 v31, v28, |v27|
v_cmp_eq_u32_sdwa vcc, v33, v32 src0_sel:WORD_1 src1_sel:WORD_1
s_cbranch_scc0 L_rb7g
v_min_f32 v30, v30, |v27|
v_cndmask_b32 v31, 0, v33, vcc
v_cmp_eq_u32_sdwa vcc, v30, v32 src0_sel:WORD_1 src1_sel:WORD_1
s_nop 1
v_cndmask_b32 v32, 0, v30, vcc
L_rb7g:
v_perm_b32 v43, v31, v32, s72
v_bfi_b32 v31, 3, v32, v31
v_lshlrev_b32 v31, 4, v31
v_bfi_b32 v47, 15, v47, v31
s_mov_b32 vcc_lo, 0x33333333
s_mov_b32 vcc_hi, 0x33333333
v_cndmask_b32_dpp v24, v40, v36, vcc quad_perm:[2,3,0,1] row_mask:0xf bank_mask:0xf
v_cndmask_b32_dpp v25, v41, v37, vcc quad_perm:[2,3,0,1] row_mask:0xf bank_mask:0xf
v_cndmask_b32_dpp v26, v42, v38, vcc quad_perm:[2,3,0,1] row_mask:0xf bank_mask:0xf
v_cndmask_b32_dpp v27, v43, v39, vcc quad_perm:[2,3,0,1] row_mask:0xf bank_mask:0xf
s_not_b64 vcc, vcc
buffer_store_dwordx4 v[24:27], v51, s[24:27], 0 offen sc1
v_cndmask_b32_dpp v40, v36, v40, vcc quad_perm:[2,3,0,1] row_mask:0xf bank_mask:0xf
v_cndmask_b32_dpp v41, v37, v41, vcc quad_perm:[2,3,0,1] row_mask:0xf bank_mask:0xf
v_cndmask_b32_dpp v42, v38, v42, vcc quad_perm:[2,3,0,1] row_mask:0xf bank_mask:0xf
v_cndmask_b32_dpp v43, v39, v43, vcc quad_perm:[2,3,0,1] row_mask:0xf bank_mask:0xf
s_mov_b32 s52, 0x0c0c0400
s_mov_b32 s53, 0x04000c0c
buffer_store_dwordx4 v[40:43], v66, s[24:27], 0 offen sc1
v_perm_b32 v48, v45, v44, s52
v_perm_b32 v49, v47, v46, s53
v_or_b32 v48, v48, v49
s_nop 1
v_mov_b32_dpp v49, v48 quad_perm:[2,3,0,1] row_mask:0xf bank_mask:0xf
v_perm_b32 v48, v49, v48, v55
ds_permute_b32 v48, v52, v48
s_waitcnt lgkmcnt(0)
buffer_store_dword v48, v54, s[24:27], 0 offen sc1
s_waitcnt vmcnt(0)
s_add_u32 s84, s84, 1
s_cmp_lt_u32 s84, 41
s_cbranch_scc1 L_st
s_add_u32 s87, s87, 1
s_cmp_lt_u32 s87, 2
s_cbranch_scc1 L_sm
v_lshrrev_b32 v72, 3, v7
v_and_b32 v73, 7, v7
v_xor_b32 v73, v73, v72
v_mul_u32_u24 v72, 1152, v72
s_and_b32 s47, s40, 1
s_mul_i32 s47, s47, 9216
s_lshr_b32 s3, s40, 1
s_lshl_b32 s3, s3, 7
s_add_u32 s47, s47, s3
v_lshl_add_u32 v72, v73, 4, v72
v_add_u32 v3, s47, v72
s_lshl_b32 s44, s40, 10
s_mul_i32 s45, s2, 18432
s_mov_b32 s46, s45
s_lshr_b32 s47, s40, 1
s_lshl_b32 s3, s47, 11
s_sub_u32 s8, 15488, s3
s_lshl_b32 s3, s47, 7
s_add_u32 s7, s45, 128
s_sub_u32 s7, s7, s3
s_sub_u32 s10, s47, 1
s_sub_u32 s11, 0, s47
s_mov_b32 s9, s44
s_mov_b32 s13, 4718592
s_mov_b32 s15, 16
s_mov_b32 s14, s13
s_mov_b32 s22, 75497472
s_mov_b32 s18, 75497472
s_mov_b32 s41, 0
s_bitcmp1_b32 s2, 0
s_cselect_b32 s15, 16, 22
L_stile:
s_barrier
s_add_u32 m0, s44, 0
s_nop 0
buffer_load_dwordx4 v3, s[16:19], s45 offen offset:0 nt lds
s_add_u32 m0, s44, 3840
s_nop 0
buffer_load_dwordx4 v3, s[16:19], s45 offen offset:256 nt lds
s_add_u32 m0, s44, 7680
s_nop 0
buffer_load_dwordx4 v3, s[16:19], s45 offen offset:512 nt lds
s_add_u32 m0, s44, 11520
s_nop 0
buffer_load_dwordx4 v3, s[16:19], s45 offen offset:768 nt lds
s_add_u32 m0, s44, s8
s_mov_b64 exec, s[10:11]
buffer_load_dwordx4 v3, s[16:19], s7 offen offset:896 nt lds
s_mov_b64 exec, -1
ds_read_b128 v[8:11], v2 offset:1024
ds_read_b128 v[12:15], v2 offset:1088
ds_read_b128 v[16:19], v2 offset:1152
ds_read_b128 v[20:23], v2 offset:1216
ds_read_b128 v[24:27], v2 offset:1280
ds_read_b128 v[28:31], v2 offset:1344
ds_read_b128 v[32:35], v2 offset:1408
ds_read_b128 v[36:39], v2 offset:1472
ds_read_b128 v[40:43], v2 offset:1536
s_mov_b32 s87, 0
L_spass:
s_lshl_b32 s86, s2, 1
s_add_u32 s86, s86, s87
s_add_u32 s86, s86, 2
s_mul_i32 s86, s86, 393216
s_mul_i32 s47, s40, 82944
s_add_u32 s47, s47, s86
v_lshl_add_u32 v104, v7, 4, s47
s_mul_i32 s47, s40, 9216
s_add_u32 s47, s47, s86
s_add_u32 s47, s47, 331776
v_lshl_add_u32 v105, v7, 4, s47
s_lshl_b32 s47, s40, 6
s_add_u32 s47, s47, s86
s_add_u32 s47, s47, 368640
v_and_b32 v106, 15, v7
v_lshl_add_u32 v106, v106, 2, s47
v_lshrrev_b32 v107, 4, v7
v_lshl_add_u32 v106, v107, 8, v106
buffer_load_dword v174, v106, s[24:27], 0 offen offset:0 sc1
buffer_load_dword v175, v106, s[24:27], 0 offen offset:1024 sc1
buffer_load_dword v176, v106, s[24:27], 0 offen offset:2048 sc1
buffer_load_dword v177, v106, s[24:27], 0 offen offset:3072 sc1
s_mov_b32 s99, 4096
buffer_load_dword v178, v106, s[24:27], s99 offen offset:0 sc1
s_mov_b32 s98, 0
buffer_load_dwordx4 v[138:141], v105, s[24:27], s98 offen sc1
s_mov_b32 s99, 0
buffer_load_dwordx4 a[0:3], v104, s[24:27], s99 offen offset:0 sc1
buffer_load_dwordx4 a[4:7], v104, s[24:27], s99 offen offset:1024 sc1
buffer_load_dwordx4 a[8:11], v104, s[24:27], s99 offen offset:2048 sc1
buffer_load_dwordx4 a[12:15], v104, s[24:27], s99 offen offset:3072 sc1
s_mov_b32 s99, 4096
buffer_load_dwordx4 a[16:19], v104, s[24:27], s99 offen offset:0 sc1
buffer_load_dwordx4 a[20:23], v104, s[24:27], s99 offen offset:1024 sc1
buffer_load_dwordx4 a[24:27], v104, s[24:27], s99 offen offset:2048 sc1
buffer_load_dwordx4 a[28:31], v104, s[24:27], s99 offen offset:3072 sc1
s_mov_b32 s99, 8192
buffer_load_dwordx4 a[32:35], v104, s[24:27], s99 offen offset:0 sc1
s_mov_b32 s98, 1024
buffer_load_dwordx4 v[142:145], v105, s[24:27], s98 offen sc1
buffer_load_dwordx4 a[36:39], v104, s[24:27], s99 offen offset:1024 sc1
buffer_load_dwordx4 a[40:43], v104, s[24:27], s99 offen offset:2048 sc1
buffer_load_dwordx4 a[44:47], v104, s[24:27], s99 offen offset:3072 sc1
s_mov_b32 s99, 12288
buffer_load_dwordx4 a[48:51], v104, s[24:27], s99 offen offset:0 sc1
buffer_load_dwordx4 a[52:55], v104, s[24:27], s99 offen offset:1024 sc1
buffer_load_dwordx4 a[56:59], v104, s[24:27], s99 offen offset:2048 sc1
buffer_load_dwordx4 a[60:63], v104, s[24:27], s99 offen offset:3072 sc1
s_mov_b32 s99, 16384
buffer_load_dwordx4 a[64:67], v104, s[24:27], s99 offen offset:0 sc1
buffer_load_dwordx4 a[68:71], v104, s[24:27], s99 offen offset:1024 sc1
s_mov_b32 s98, 2048
buffer_load_dwordx4 v[146:149], v105, s[24:27], s98 offen sc1
buffer_load_dwordx4 a[72:75], v104, s[24:27], s99 offen offset:2048 sc1
buffer_load_dwordx4 a[76:79], v104, s[24:27], s99 offen offset:3072 sc1
s_mov_b32 s99, 20480
buffer_load_dwordx4 a[80:83], v104, s[24:27], s99 offen offset:0 sc1
buffer_load_dwordx4 a[84:87], v104, s[24:27], s99 offen offset:1024 sc1
buffer_load_dwordx4 a[88:91], v104, s[24:27], s99 offen offset:2048 sc1
buffer_load_dwordx4 a[92:95], v104, s[24:27], s99 offen offset:3072 sc1
s_mov_b32 s99, 24576
buffer_load_dwordx4 a[96:99], v104, s[24:27], s99 offen offset:0 sc1
buffer_load_dwordx4 a[100:103], v104, s[24:27], s99 offen offset:1024 sc1
buffer_load_dwordx4 a[104:107], v104, s[24:27], s99 offen offset:2048 sc1
s_mov_b32 s98, 3072
buffer_load_dwordx4 v[150:153], v105, s[24:27], s98 offen sc1
buffer_load_dwordx4 a[108:111], v104, s[24:27], s99 offen offset:3072 sc1
s_mov_b32 s99, 28672
buffer_load_dwordx4 a[112:115], v104, s[24:27], s99 offen offset:0 sc1
buffer_load_dwordx4 a[116:119], v104, s[24:27], s99 offen offset:1024 sc1
buffer_load_dwordx4 a[120:123], v104, s[24:27], s99 offen offset:2048 sc1
buffer_load_dwordx4 a[124:127], v104, s[24:27], s99 offen offset:3072 sc1
s_mov_b32 s99, 32768
buffer_load_dwordx4 a[128:131], v104, s[24:27], s99 offen offset:0 sc1
buffer_load_dwordx4 a[132:135], v104, s[24:27], s99 offen offset:1024 sc1
buffer_load_dwordx4 a[136:139], v104, s[24:27], s99 offen offset:2048 sc1
buffer_load_dwordx4 a[140:143], v104, s[24:27], s99 offen offset:3072 sc1
s_mov_b32 s98, 4096
buffer_load_dwordx4 v[154:157], v105, s[24:27], s98 offen sc1
s_mov_b32 s99, 36864
buffer_load_dwordx4 a[144:147], v104, s[24:27], s99 offen offset:0 sc1
buffer_load_dwordx4 a[148:151], v104, s[24:27], s99 offen offset:1024 sc1
buffer_load_dwordx4 a[152:155], v104, s[24:27], s99 offen offset:2048 sc1
buffer_load_dwordx4 a[156:159], v104, s[24:27], s99 offen offset:3072 sc1
s_mov_b32 s99, 40960
buffer_load_dwordx4 a[160:163], v104, s[24:27], s99 offen offset:0 sc1
buffer_load_dwordx4 a[164:167], v104, s[24:27], s99 offen offset:1024 sc1
buffer_load_dwordx4 a[168:171], v104, s[24:27], s99 offen offset:2048 sc1
buffer_load_dwordx4 a[172:175], v104, s[24:27], s99 offen offset:3072 sc1
s_mov_b32 s99, 45056
buffer_load_dwordx4 a[176:179], v104, s[24:27], s99 offen offset:0 sc1
s_mov_b32 s98, 5120
buffer_load_dwordx4 v[158:161], v105, s[24:27], s98 offen sc1
buffer_load_dwordx4 a[180:183], v104, s[24:27], s99 offen offset:1024 sc1
buffer_load_dwordx4 a[184:187], v104, s[24:27], s99 offen offset:2048 sc1
buffer_load_dwordx4 a[188:191], v104, s[24:27], s99 offen offset:3072 sc1
s_mov_b32 s99, 49152
buffer_load_dwordx4 a[192:195], v104, s[24:27], s99 offen offset:0 sc1
buffer_load_dwordx4 a[196:199], v104, s[24:27], s99 offen offset:1024 sc1
buffer_load_dwordx4 a[200:203], v104, s[24:27], s99 offen offset:2048 sc1
buffer_load_dwordx4 a[204:207], v104, s[24:27], s99 offen offset:3072 sc1
s_mov_b32 s99, 53248
buffer_load_dwordx4 a[208:211], v104, s[24:27], s99 offen offset:0 sc1
buffer_load_dwordx4 a[212:215], v104, s[24:27], s99 offen offset:1024 sc1
s_mov_b32 s98, 6144
buffer_load_dwordx4 v[162:165], v105, s[24:27], s98 offen sc1
buffer_load_dwordx4 a[216:219], v104, s[24:27], s99 offen offset:2048 sc1
buffer_load_dwordx4 a[220:223], v104, s[24:27], s99 offen offset:3072 sc1
s_mov_b32 s99, 57344
buffer_load_dwordx4 a[224:227], v104, s[24:27], s99 offen offset:0 sc1
buffer_load_dwordx4 a[228:231], v104, s[24:27], s99 offen offset:1024 sc1
buffer_load_dwordx4 a[232:235], v104, s[24:27], s99 offen offset:2048 sc1
buffer_load_dwordx4 a[236:239], v104, s[24:27], s99 offen offset:3072 sc1
s_mov_b32 s99, 61440
buffer_load_dwordx4 a[240:243], v104, s[24:27], s99 offen offset:0 sc1
buffer_load_dwordx4 a[244:247], v104, s[24:27], s99 offen offset:1024 sc1
buffer_load_dwordx4 a[248:251], v104, s[24:27], s99 offen offset:2048 sc1
s_mov_b32 s98, 7168
buffer_load_dwordx4 v[166:169], v105, s[24:27], s98 offen sc1
buffer_load_dwordx4 a[252:255], v104, s[24:27], s99 offen offset:3072 sc1
s_mov_b32 s99, 65536
buffer_load_dwordx4 v[186:189], v104, s[24:27], s99 offen offset:0 sc1
buffer_load_dwordx4 v[190:193], v104, s[24:27], s99 offen offset:1024 sc1
buffer_load_dwordx4 v[194:197], v104, s[24:27], s99 offen offset:2048 sc1
buffer_load_dwordx4 v[198:201], v104, s[24:27], s99 offen offset:3072 sc1
s_mov_b32 s99, 69632
buffer_load_dwordx4 v[202:205], v104, s[24:27], s99 offen offset:0 sc1
buffer_load_dwordx4 v[206:209], v104, s[24:27], s99 offen offset:1024 sc1
buffer_load_dwordx4 v[210:213], v104, s[24:27], s99 offen offset:2048 sc1
buffer_load_dwordx4 v[214:217], v104, s[24:27], s99 offen offset:3072 sc1
s_mov_b32 s98, 8192
buffer_load_dwordx4 v[170:173], v105, s[24:27], s98 offen sc1
s_mov_b32 s99, 73728
buffer_load_dwordx4 v[218:221], v104, s[24:27], s99 offen offset:0 sc1
buffer_load_dwordx4 v[222:225], v104, s[24:27], s99 offen offset:1024 sc1
buffer_load_dwordx4 v[226:229], v104, s[24:27], s99 offen offset:2048 sc1
buffer_load_dwordx4 v[230:233], v104, s[24:27], s99 offen offset:3072 sc1
s_mov_b32 s99, 77824
buffer_load_dwordx4 v[234:237], v104, s[24:27], s99 offen offset:0 sc1
buffer_load_dwordx4 v[238:241], v104, s[24:27], s99 offen offset:1024 sc1
buffer_load_dwordx4 v[242:245], v104, s[24:27], s99 offen offset:2048 sc1
buffer_load_dwordx4 v[246:249], v104, s[24:27], s99 offen offset:3072 sc1
s_mov_b32 s99, 81920
buffer_load_dwordx4 v[250:253], v104, s[24:27], s99 offen offset:0 sc1
s_waitcnt vmcnt(0)
s_barrier
ds_read_b128 v[44:47], v0 offset:0
ds_read_b128 v[48:51], v1 offset:0
s_waitcnt lgkmcnt(0)
v_smfmac_f32_16x16x64_bf16 v[8:11], a[0:3], v[44:51], v138
v_smfmac_f32_16x16x64_bf16 v[12:15], a[4:7], v[44:51], v138 abid:1
v_smfmac_f32_16x16x64_bf16 v[16:19], a[8:11], v[44:51], v139
v_smfmac_f32_16x16x64_bf16 v[20:23], a[12:15], v[44:51], v139 abid:1
v_smfmac_f32_16x16x64_bf16 v[24:27], a[16:19], v[44:51], v140
v_smfmac_f32_16x16x64_bf16 v[28:31], a[20:23], v[44:51], v140 abid:1
v_smfmac_f32_16x16x64_bf16 v[32:35], a[24:27], v[44:51], v141
v_smfmac_f32_16x16x64_bf16 v[36:39], a[28:31], v[44:51], v141 abid:1
v_smfmac_f32_16x16x64_bf16 v[40:43], a[32:35], v[44:51], v174
s_nop 7
ds_read_b128 v[44:47], v0 offset:2048
ds_read_b128 v[48:51], v1 offset:2048
s_waitcnt lgkmcnt(0)
v_smfmac_f32_16x16x64_bf16 v[8:11], a[36:39], v[44:51], v142
v_smfmac_f32_16x16x64_bf16 v[12:15], a[40:43], v[44:51], v142 abid:1
v_smfmac_f32_16x16x64_bf16 v[16:19], a[44:47], v[44:51], v143
v_smfmac_f32_16x16x64_bf16 v[20:23], a[48:51], v[44:51], v143 abid:1
v_smfmac_f32_16x16x64_bf16 v[24:27], a[52:55], v[44:51], v144
v_smfmac_f32_16x16x64_bf16 v[28:31], a[56:59], v[44:51], v144 abid:1
v_smfmac_f32_16x16x64_bf16 v[32:35], a[60:63], v[44:51], v145
v_smfmac_f32_16x16x64_bf16 v[36:39], a[64:67], v[44:51], v145 abid:1
v_smfmac_f32_16x16x64_bf16 v[40:43], a[68:71], v[44:51], v174 abid:1
s_nop 7
ds_read_b128 v[44:47], v0 offset:4096
ds_read_b128 v[48:51], v1 offset:4096
s_waitcnt lgkmcnt(0)
v_smfmac_f32_16x16x64_bf16 v[8:11], a[72:75], v[44:51], v146
v_smfmac_f32_16x16x64_bf16 v[12:15], a[76:79], v[44:51], v146 abid:1
v_smfmac_f32_16x16x64_bf16 v[16:19], a[80:83], v[44:51], v147
v_smfmac_f32_16x16x64_bf16 v[20:23], a[84:87], v[44:51], v147 abid:1
v_smfmac_f32_16x16x64_bf16 v[24:27], a[88:91], v[44:51], v148
v_smfmac_f32_16x16x64_bf16 v[28:31], a[92:95], v[44:51], v148 abid:1
v_smfmac_f32_16x16x64_bf16 v[32:35], a[96:99], v[44:51], v149
v_smfmac_f32_16x16x64_bf16 v[36:39], a[100:103], v[44:51], v149 abid:1
v_smfmac_f32_16x16x64_bf16 v[40:43], a[104:107], v[44:51], v175
s_nop 7
ds_read_b128 v[44:47], v0 offset:6144
ds_read_b128 v[48:51], v1 offset:6144
s_waitcnt lgkmcnt(0)
v_smfmac_f32_16x16x64_bf16 v[8:11], a[108:111], v[44:51], v150
v_smfmac_f32_16x16x64_bf16 v[12:15], a[112:115], v[44:51], v150 abid:1
v_smfmac_f32_16x16x64_bf16 v[16:19], a[116:119], v[44:51], v151
v_smfmac_f32_16x16x64_bf16 v[20:23], a[120:123], v[44:51], v151 abid:1
v_smfmac_f32_16x16x64_bf16 v[24:27], a[124:127], v[44:51], v152
v_smfmac_f32_16x16x64_bf16 v[28:31], a[128:131], v[44:51], v152 abid:1
v_smfmac_f32_16x16x64_bf16 v[32:35], a[132:135], v[44:51], v153
v_smfmac_f32_16x16x64_bf16 v[36:39], a[136:139], v[44:51], v153 abid:1
v_smfmac_f32_16x16x64_bf16 v[40:43], a[140:143], v[44:51], v175 abid:1
s_nop 7
ds_read_b128 v[44:47], v0 offset:8192
ds_read_b128 v[48:51], v1 offset:8192
s_waitcnt lgkmcnt(0)
v_smfmac_f32_16x16x64_bf16 v[8:11], a[144:147], v[44:51], v154
v_smfmac_f32_16x16x64_bf16 v[12:15], a[148:151], v[44:51], v154 abid:1
v_smfmac_f32_16x16x64_bf16 v[16:19], a[152:155], v[44:51], v155
v_smfmac_f32_16x16x64_bf16 v[20:23], a[156:159], v[44:51], v155 abid:1
v_smfmac_f32_16x16x64_bf16 v[24:27], a[160:163], v[44:51], v156
v_smfmac_f32_16x16x64_bf16 v[28:31], a[164:167], v[44:51], v156 abid:1
v_smfmac_f32_16x16x64_bf16 v[32:35], a[168:171], v[44:51], v157
v_smfmac_f32_16x16x64_bf16 v[36:39], a[172:175], v[44:51], v157 abid:1
v_smfmac_f32_16x16x64_bf16 v[40:43], a[176:179], v[44:51], v176
s_nop 7
ds_read_b128 v[44:47], v0 offset:10240
ds_read_b128 v[48:51], v1 offset:10240
s_waitcnt lgkmcnt(0)
v_smfmac_f32_16x16x64_bf16 v[8:11], a[180:183], v[44:51], v158
v_smfmac_f32_16x16x64_bf16 v[12:15], a[184:187], v[44:51], v158 abid:1
v_smfmac_f32_16x16x64_bf16 v[16:19], a[188:191], v[44:51], v159
v_smfmac_f32_16x16x64_bf16 v[20:23], a[192:195], v[44:51], v159 abid:1
v_smfmac_f32_16x16x64_bf16 v[24:27], a[196:199], v[44:51], v160
v_smfmac_f32_16x16x64_bf16 v[28:31], a[200:203], v[44:51], v160 abid:1
v_smfmac_f32_16x16x64_bf16 v[32:35], a[204:207], v[44:51], v161
v_smfmac_f32_16x16x64_bf16 v[36:39], a[208:211], v[44:51], v161 abid:1
v_smfmac_f32_16x16x64_bf16 v[40:43], a[212:215], v[44:51], v176 abid:1
s_nop 7
ds_read_b128 v[44:47], v0 offset:12288
ds_read_b128 v[48:51], v1 offset:12288
s_waitcnt lgkmcnt(0)
v_smfmac_f32_16x16x64_bf16 v[8:11], a[216:219], v[44:51], v162
v_smfmac_f32_16x16x64_bf16 v[12:15], a[220:223], v[44:51], v162 abid:1
v_smfmac_f32_16x16x64_bf16 v[16:19], a[224:227], v[44:51], v163
v_smfmac_f32_16x16x64_bf16 v[20:23], a[228:231], v[44:51], v163 abid:1
v_smfmac_f32_16x16x64_bf16 v[24:27], a[232:235], v[44:51], v164
v_smfmac_f32_16x16x64_bf16 v[28:31], a[236:239], v[44:51], v164 abid:1
v_smfmac_f32_16x16x64_bf16 v[32:35], a[240:243], v[44:51], v165
v_smfmac_f32_16x16x64_bf16 v[36:39], a[244:247], v[44:51], v165 abid:1
v_smfmac_f32_16x16x64_bf16 v[40:43], a[248:251], v[44:51], v177
s_nop 7
ds_read_b128 v[44:47], v0 offset:14336
ds_read_b128 v[48:51], v1 offset:14336
s_waitcnt lgkmcnt(0)
v_smfmac_f32_16x16x64_bf16 v[8:11], a[252:255], v[44:51], v166
v_smfmac_f32_16x16x64_bf16 v[12:15], v[186:189], v[44:51], v166 abid:1
v_smfmac_f32_16x16x64_bf16 v[16:19], v[190:193], v[44:51], v167
v_smfmac_f32_16x16x64_bf16 v[20:23], v[194:197], v[44:51], v167 abid:1
v_smfmac_f32_16x16x64_bf16 v[24:27], v[198:201], v[44:51], v168
v_smfmac_f32_16x16x64_bf16 v[28:31], v[202:205], v[44:51], v168 abid:1
v_smfmac_f32_16x16x64_bf16 v[32:35], v[206:209], v[44:51], v169
v_smfmac_f32_16x16x64_bf16 v[36:39], v[210:213], v[44:51], v169 abid:1
v_smfmac_f32_16x16x64_bf16 v[40:43], v[214:217], v[44:51], v177 abid:1
s_nop 7
ds_read_b128 v[44:47], v0 offset:16384
ds_read_b128 v[48:51], v1 offset:16384
s_waitcnt lgkmcnt(0)
v_smfmac_f32_16x16x64_bf16 v[8:11], v[218:221], v[44:51], v170
v_smfmac_f32_16x16x64_bf16 v[12:15], v[222:225], v[44:51], v170 abid:1
v_smfmac_f32_16x16x64_bf16 v[16:19], v[226:229], v[44:51], v171
v_smfmac_f32_16x16x64_bf16 v[20:23], v[230:233], v[44:51], v171 abid:1
v_smfmac_f32_16x16x64_bf16 v[24:27], v[234:237], v[44:51], v172
v_smfmac_f32_16x16x64_bf16 v[28:31], v[238:241], v[44:51], v172 abid:1
v_smfmac_f32_16x16x64_bf16 v[32:35], v[242:245], v[44:51], v173
v_smfmac_f32_16x16x64_bf16 v[36:39], v[246:249], v[44:51], v173 abid:1
v_smfmac_f32_16x16x64_bf16 v[40:43], v[250:253], v[44:51], v178
s_nop 7
s_add_u32 s87, s87, 1
s_cmp_lt_u32 s87, 2
s_cbranch_scc1 L_spass
v_cvt_pk_bf16_f32 v92, v8, v9
v_cvt_pk_bf16_f32 v93, v10, v11
v_cvt_pk_bf16_f32 v94, v12, v13
v_cvt_pk_bf16_f32 v95, v14, v15
v_cvt_pk_bf16_f32 v96, v16, v17
v_cvt_pk_bf16_f32 v97, v18, v19
v_cvt_pk_bf16_f32 v98, v20, v21
v_cvt_pk_bf16_f32 v99, v22, v23
v_cvt_pk_bf16_f32 v100, v24, v25
v_cvt_pk_bf16_f32 v101, v26, v27
v_cvt_pk_bf16_f32 v102, v28, v29
v_cvt_pk_bf16_f32 v103, v30, v31
v_cvt_pk_bf16_f32 v104, v32, v33
v_cvt_pk_bf16_f32 v105, v34, v35
s_mov_b64 vcc, s[80:81]
s_nop 0
v_cndmask_b32_dpp v108, v96, v92, vcc quad_perm:[1,0,3,2] row_mask:0xf bank_mask:0xf
v_cndmask_b32_dpp v109, v97, v93, vcc quad_perm:[1,0,3,2] row_mask:0xf bank_mask:0xf
v_cndmask_b32_dpp v110, v98, v94, vcc quad_perm:[1,0,3,2] row_mask:0xf bank_mask:0xf
v_cndmask_b32_dpp v111, v99, v95, vcc quad_perm:[1,0,3,2] row_mask:0xf bank_mask:0xf
buffer_store_dwordx4 v[108:111], v4, s[20:23], s46 offen offset:0 sc1
s_mov_b64 vcc, s[82:83]
v_cvt_pk_bf16_f32 v112, v40, v41
v_cvt_pk_bf16_f32 v113, v42, v43
ds_bpermute_b32 v112, v6, v112
ds_bpermute_b32 v113, v6, v113
v_cndmask_b32_dpp v96, v92, v96, vcc quad_perm:[1,0,3,2] row_mask:0xf bank_mask:0xf
v_cndmask_b32_dpp v97, v93, v97, vcc quad_perm:[1,0,3,2] row_mask:0xf bank_mask:0xf
v_cndmask_b32_dpp v98, v94, v98, vcc quad_perm:[1,0,3,2] row_mask:0xf bank_mask:0xf
v_cndmask_b32_dpp v99, v95, v99, vcc quad_perm:[1,0,3,2] row_mask:0xf bank_mask:0xf
buffer_store_dwordx4 v[96:99], v4, s[20:23], s46 offen offset:1152 sc1
s_mov_b64 vcc, s[80:81]
v_cvt_pk_bf16_f32 v106, v36, v37
v_cvt_pk_bf16_f32 v107, v38, v39
v_cndmask_b32_dpp v92, v104, v100, vcc quad_perm:[1,0,3,2] row_mask:0xf bank_mask:0xf
v_cndmask_b32_dpp v93, v105, v101, vcc quad_perm:[1,0,3,2] row_mask:0xf bank_mask:0xf
v_cndmask_b32_dpp v94, v106, v102, vcc quad_perm:[1,0,3,2] row_mask:0xf bank_mask:0xf
v_cndmask_b32_dpp v95, v107, v103, vcc quad_perm:[1,0,3,2] row_mask:0xf bank_mask:0xf
buffer_store_dwordx4 v[92:95], v4, s[20:23], s46 offen offset:128 sc1
s_mov_b64 vcc, s[82:83]
v_cndmask_b32_dpp v104, v100, v104, vcc quad_perm:[1,0,3,2] row_mask:0xf bank_mask:0xf
v_cndmask_b32_dpp v105, v101, v105, vcc quad_perm:[1,0,3,2] row_mask:0xf bank_mask:0xf
v_cndmask_b32_dpp v106, v102, v106, vcc quad_perm:[1,0,3,2] row_mask:0xf bank_mask:0xf
v_cndmask_b32_dpp v107, v103, v107, vcc quad_perm:[1,0,3,2] row_mask:0xf bank_mask:0xf
buffer_store_dwordx4 v[104:107], v4, s[20:23], s46 offen offset:1280 sc1
s_mov_b64 vcc, s[80:81]
s_waitcnt lgkmcnt(0)
buffer_store_dwordx2 v[112:113], v5, s[20:23], s46 offen nt
s_cmp_eq_u32 s41, 15
s_cselect_b32 s13, -23574528, s13
s_add_u32 s45, s45, s13
s_add_u32 s7, s7, s13
s_add_u32 s46, s46, s13
s_mov_b32 s13, 4718592
s_add_u32 s41, s41, 1
s_cmp_lt_u32 s41, s15
s_cbranch_scc1 L_stile
s_branch L_fin
.section .rodata,"a"
.p2align 6
.amdhsa_kernel standalone__structured_sparse_n_m__ragged_kernel
  .amdhsa_next_free_vgpr 512
  .amdhsa_next_free_sgpr 102
  .amdhsa_accum_offset 256
  .amdhsa_group_segment_fixed_size 0
  .amdhsa_float_denorm_mode_32 3
  .amdhsa_kernarg_size 48
  .amdhsa_user_sgpr_count 2
  .amdhsa_user_sgpr_kernarg_segment_ptr 1
  .amdhsa_system_sgpr_workgroup_id_x 1
.end_amdhsa_kernel
```

```asm
; @launch grid=(256,1,1) block=(256,1,1) lds=163840
.amdgcn_target "amdgcn-amd-amdhsa--gfx950"
.text
.globl standalone__structured_sparse_n_m__ragged_kernel
.p2align 8
.type standalone__structured_sparse_n_m__ragged_kernel,@function
standalone__structured_sparse_n_m__ragged_kernel:
s_load_dwordx8 s[4:11], s[0:1], 0
s_load_dwordx4 s[12:15], s[0:1], 32
s_cmp_ge_u32 s2, 256
s_cbranch_scc1 L_end_standalone__structured_sparse_n_m__ragged_kernel
v_lshrrev_b32 v1, 6, v0
v_and_b32 v7, 63, v0
s_lshr_b32 s49, s2, 6
s_and_b32 s47, s2, 9
s_lshl1_add_u32 s49, s49, s47
s_bfe_u32 s48, s2, 0x20004
s_lshl2_add_u32 s84, s49, s48
s_and_b32 s47, s2, 6
s_cselect_b32 s84, 63, s84
s_cmp_lt_u32 s84, 41
s_cbranch_scc0 L_cw
s_cmp_ge_u32 s84, 36
s_cbranch_scc1 L_pb
s_mul_i32 s52, s49, 288
s_add_u32 s52, s52, s48
s_lshl_b32 s52, s52, 8
v_lshl_add_u32 v50, v7, 2, s52
L_pbb:
v_mul_u32_u24 v62, 18432, v1
v_add_u32 v50, v62, v50
s_mov_b32 s30, 663552
s_mov_b32 s31, 0x20000
s_waitcnt lgkmcnt(0)
s_mov_b32 s28, s6
s_and_b32 s29, s7, 0xffff
buffer_load_dword v8, v50, s[28:31], 0 offen offset:0 nt
buffer_load_dword v9, v50, s[28:31], 0 offen offset:1152 nt
buffer_load_dword v10, v50, s[28:31], 0 offen offset:2304 nt
buffer_load_dword v11, v50, s[28:31], 0 offen offset:3456 nt
v_add_u32 v50, 4608, v50
buffer_load_dword v12, v50, s[28:31], 0 offen offset:0 nt
buffer_load_dword v13, v50, s[28:31], 0 offen offset:1152 nt
buffer_load_dword v14, v50, s[28:31], 0 offen offset:2304 nt
buffer_load_dword v15, v50, s[28:31], 0 offen offset:3456 nt
v_add_u32 v50, 4608, v50
buffer_load_dword v16, v50, s[28:31], 0 offen offset:0 nt
buffer_load_dword v17, v50, s[28:31], 0 offen offset:1152 nt
buffer_load_dword v18, v50, s[28:31], 0 offen offset:2304 nt
buffer_load_dword v19, v50, s[28:31], 0 offen offset:3456 nt
v_add_u32 v50, 4608, v50
buffer_load_dword v20, v50, s[28:31], 0 offen offset:0 nt
buffer_load_dword v21, v50, s[28:31], 0 offen offset:1152 nt
buffer_load_dword v22, v50, s[28:31], 0 offen offset:2304 nt
buffer_load_dword v23, v50, s[28:31], 0 offen offset:3456 nt
s_branch L_pc
L_pb:
s_mul_i32 s52, s84, 147456
s_sub_u32 s52, s52, 5307392
v_and_b32 v62, 2, v7
v_mul_u32_u24 v50, 36864, v62
v_and_b32 v62, 1, v7
v_lshl_add_u32 v50, v62, 2, v50
v_and_b32 v62, 4, v7
v_lshl_add_u32 v50, v62, 3, v50
v_and_b32 v62, 32, v7
v_lshl_add_u32 v50, v62, 1, v50
v_and_b32 v62, 24, v7
v_add3_u32 v50, v50, v62, s52
s_branch L_pbb
L_cw:
v_lshlrev_b32 v3, 7, v0
s_getpc_b64 s[96:97]
v_min_u32 v2, L_slow-standalone__structured_sparse_n_m__ragged_kernel, v3
global_load_dword v120, v2, s[96:97]
s_branch L_cons
L_pc:
v_readfirstlane_b32 s40, v1
s_mov_b32 s86, 0
s_mov_b32 s18, 75497472
s_mov_b32 s19, 0x20000
s_mov_b32 s16, s4
s_and_b32 s17, s5, 0xffff
s_mov_b32 s26, 301989888
s_mov_b32 s27, 0x20000
s_mov_b32 s24, s14
s_and_b32 s25, s15, 0xffff
s_mov_b32 s34, 1152
s_mov_b32 s35, 0x20000
s_mov_b32 s32, s8
s_and_b32 s33, s9, 0xffff
s_mov_b32 s22, 0
s_mov_b32 s23, 0x20000
s_mov_b32 s20, s10
s_and_b32 s21, s11, 0xffff
s_mov_b32 s38, 256
s_mov_b32 s39, 0x20000
s_mov_b32 s36, s12
s_and_b32 s37, s13, 0xffff
s_sub_u32 s50, s84, 36
s_lshl_b32 s51, s40, 4
v_and_b32 v58, 1, v7
v_bfe_u32 v59, v7, 1, 1
v_bfe_u32 v60, v7, 3, 2
s_mul_i32 s52, s48, 9
s_add_u32 s52, s52, s49
s_mul_i32 s53, s52, 9
s_mul_i32 s54, s50, 18
s_add_u32 s54, s54, 8
s_lshl_b32 s55, s52, 2
s_add_u32 s55, s55, s40
s_lshl_b32 s56, s50, 2
s_add_u32 s56, s56, s40
s_cmp_eq_u32 s84, 40
s_cselect_b32 s57, 0x100000, 9
s_cmp_lt_u32 s84, 36
s_cselect_b32 s53, s53, s54
s_cselect_b32 s54, 2, 81
s_cselect_b32 s57, 1, s57
s_cselect_b32 s55, s55, s56
s_mov_b32 s56, 331776
s_cselect_b32 s56, s56, 368640
s_mov_b32 s58, 373760
s_cselect_b32 s58, s58, 382976
s_cselect_b32 s59, 16, 4
s_cselect_b32 s60, 4, 64
s_cselect_b32 s61, 12, 11
s_cselect_b32 s62, 1, 0x8001
v_bfe_u32 v61, v7, 2, 1
v_lshrrev_b32 v62, 5, v7
v_lshl_add_u32 v61, v62, 1, v61
v_lshlrev_b32 v62, 1, v58
v_lshl_add_u32 v60, v60, 2, v62
v_add_u32 v62, v60, v59
v_mul_u32_u24 v51, s54, v61
v_add_lshl_u32 v51, v51, s53, 6
v_add3_u32 v51, v51, v62, s51
v_lshl_add_u32 v51, v51, 4, s86
s_lshl_b32 s57, s57, 10
v_add_u32 v66, s57, v51
s_lshl_b32 s52, s55, 8
s_add_u32 s52, s52, s56
s_add_u32 s52, s52, s86
v_mul_u32_u24 v52, s59, v62
v_mad_u32_u24 v52, v61, s60, v52
v_lshl_add_u32 v54, v7, 2, s52
s_lshr_b32 s52, s55, 2
s_lshl_b32 s52, s52, 8
s_add_u32 s58, s58, s52
s_lshl2_add_u32 s58, s51, s58
s_lshl_b32 s52, s51, 1
s_add_u32 s52, s52, s62
v_lshl_add_u32 v62, v61, 1, v59
v_lshlrev_b32 v62, s61, v62
v_lshl_add_u32 v53, v60, 7, v62
v_add_u32 v53, s52, v53
v_and_b32 v62, 12, v7
v_and_b32 v63, 15, v7
v_mad_u32_u24 v62, v62, 3, v63
v_lshl_add_u32 v62, v62, 2, s51
v_mov_b32 v67, 0
ds_write_b32 v62, v67
s_lshl2_add_u32 s52, s84, s40
s_lshl_b32 s52, s52, 7
s_add_u32 s52, s52, 393152
v_lshl_add_u32 v65, v7, 2, s58
v_lshl_add_u32 v62, v7, 2, s52
v_cmp_gt_u32 vcc, 16, v7
s_lshl_b32 s52, s51, 2
v_lshl_add_u32 v57, v7, 2, s52
v_cndmask_b32 v65, v62, v65, vcc
s_mov_b32 s75, 0
s_mov_b32 s73, 0x05060100
s_mov_b32 s74, 0xffff
v_mov_b32 v55, 0x05040100
v_mov_b32 v62, 0x03020706
v_cmp_eq_u32 vcc, 1, v59
v_mov_b32 v68, 0xf0a0500
v_mov_b32 v69, 0x8f8a8580
v_mov_b32 v70, 0x1f1a1510
v_mov_b32 v71, 0x9f9a9590
v_mov_b32 v72, 0x2f2a2520
v_mov_b32 v73, 0xafaaa5a0
v_mov_b32 v74, 0x3f3a3530
v_mov_b32 v75, 0xbfbab5b0
v_cndmask_b32 v55, v55, v62, vcc
v_mov_b64 v[76:77], 0
v_mov_b64 v[78:79], 0
v_mov_b64 v[80:81], 0
v_mov_b32 v82, 0
s_mov_b32 s64, 0x5040500
s_mov_b32 s65, 0x5040501
s_mov_b32 s66, 0x5040502
s_mov_b32 s67, 0x5040503
s_mov_b32 s68, 0x7060700
s_mov_b32 s69, 0x7060701
s_mov_b32 s70, 0x7060702
s_mov_b32 s71, 0x7060703
s_mov_b32 s72, 0x05060102
s_waitcnt vmcnt(12)
v_perm_b32 v24, v8, v68, s64
v_perm_b32 v25, v9, v68, s65
v_perm_b32 v26, v10, v68, s66
v_perm_b32 v27, v11, v68, s67
v_max3_f32 v28, |v24|, |v25|, |v26|
v_med3_f32 v29, |v24|, |v25|, |v26|
v_min3_f32 v30, |v24|, |v25|, |v26|
v_med3_f32 v32, v28, v29, |v27|
v_med3_f32 v33, v29, v30, |v27|
v_max_f32 v31, v28, |v27|
v_perm_b32 v36, v31, v32, s72
v_bfi_b32 v44, 3, v32, v31
v_cmpx_eq_u32_sdwa vcc, v33, v32 src0_sel:WORD_1 src1_sel:WORD_1
v_mov_b32 v76, v33
v_min_f32 v77, v30, |v27|
s_mov_b64 exec, -1
v_perm_b32 v24, v8, v69, s68
v_perm_b32 v25, v9, v69, s69
v_perm_b32 v26, v10, v69, s70
v_perm_b32 v27, v11, v69, s71
v_max3_f32 v28, |v24|, |v25|, |v26|
v_med3_f32 v29, |v24|, |v25|, |v26|
v_min3_f32 v30, |v24|, |v25|, |v26|
v_med3_f32 v32, v28, v29, |v27|
v_med3_f32 v33, v29, v30, |v27|
v_max_f32 v31, v28, |v27|
v_perm_b32 v40, v31, v32, s72
v_bfi_b32 v46, 3, v32, v31
v_cmpx_eq_u32_sdwa vcc, v33, v32 src0_sel:WORD_1 src1_sel:WORD_1
v_mov_b64 v[78:79], v[76:77]
v_mov_b32 v76, v33
v_min_f32 v77, v30, |v27|
s_mov_b64 exec, -1
s_waitcnt vmcnt(8)
v_perm_b32 v24, v12, v70, s64
v_perm_b32 v25, v13, v70, s65
v_perm_b32 v26, v14, v70, s66
v_perm_b32 v27, v15, v70, s67
v_max3_f32 v28, |v24|, |v25|, |v26|
v_med3_f32 v29, |v24|, |v25|, |v26|
v_min3_f32 v30, |v24|, |v25|, |v26|
v_med3_f32 v32, v28, v29, |v27|
v_med3_f32 v33, v29, v30, |v27|
v_max_f32 v31, v28, |v27|
v_perm_b32 v37, v31, v32, s72
v_bfi_b32 v31, 3, v32, v31
v_lshlrev_b32 v31, 4, v31
v_bfi_b32 v44, 15, v44, v31
v_cmpx_eq_u32_sdwa vcc, v33, v32 src0_sel:WORD_1 src1_sel:WORD_1
v_mov_b64 v[80:81], v[78:79]
v_mov_b64 v[78:79], v[76:77]
v_mov_b32 v76, v33
v_min_f32 v77, v30, |v27|
s_mov_b64 exec, -1
v_perm_b32 v24, v12, v71, s68
v_perm_b32 v25, v13, v71, s69
v_perm_b32 v26, v14, v71, s70
v_perm_b32 v27, v15, v71, s71
v_max3_f32 v28, |v24|, |v25|, |v26|
v_med3_f32 v29, |v24|, |v25|, |v26|
v_min3_f32 v30, |v24|, |v25|, |v26|
v_med3_f32 v32, v28, v29, |v27|
v_med3_f32 v33, v29, v30, |v27|
v_max_f32 v31, v28, |v27|
v_perm_b32 v41, v31, v32, s72
v_bfi_b32 v31, 3, v32, v31
v_lshlrev_b32 v31, 4, v31
v_bfi_b32 v46, 15, v46, v31
v_cmpx_eq_u32_sdwa vcc, v33, v32 src0_sel:WORD_1 src1_sel:WORD_1
v_or_b32 v82, v82, v80
v_mov_b64 v[80:81], v[78:79]
v_mov_b64 v[78:79], v[76:77]
v_mov_b32 v76, v33
v_min_f32 v77, v30, |v27|
s_mov_b64 exec, -1
s_waitcnt vmcnt(4)
v_perm_b32 v24, v16, v72, s64
v_perm_b32 v25, v17, v72, s65
v_perm_b32 v26, v18, v72, s66
v_perm_b32 v27, v19, v72, s67
v_max3_f32 v28, |v24|, |v25|, |v26|
v_med3_f32 v29, |v24|, |v25|, |v26|
v_min3_f32 v30, |v24|, |v25|, |v26|
v_med3_f32 v32, v28, v29, |v27|
v_med3_f32 v33, v29, v30, |v27|
v_max_f32 v31, v28, |v27|
v_perm_b32 v38, v31, v32, s72
v_bfi_b32 v45, 3, v32, v31
v_cmpx_eq_u32_sdwa vcc, v33, v32 src0_sel:WORD_1 src1_sel:WORD_1
v_or_b32 v82, v82, v80
v_mov_b64 v[80:81], v[78:79]
v_mov_b64 v[78:79], v[76:77]
v_mov_b32 v76, v33
v_min_f32 v77, v30, |v27|
s_mov_b64 exec, -1
v_perm_b32 v24, v16, v73, s68
v_perm_b32 v25, v17, v73, s69
v_perm_b32 v26, v18, v73, s70
v_perm_b32 v27, v19, v73, s71
v_max3_f32 v28, |v24|, |v25|, |v26|
v_med3_f32 v29, |v24|, |v25|, |v26|
v_min3_f32 v30, |v24|, |v25|, |v26|
v_med3_f32 v32, v28, v29, |v27|
v_med3_f32 v33, v29, v30, |v27|
v_max_f32 v31, v28, |v27|
v_perm_b32 v42, v31, v32, s72
v_bfi_b32 v47, 3, v32, v31
v_cmpx_eq_u32_sdwa vcc, v33, v32 src0_sel:WORD_1 src1_sel:WORD_1
v_or_b32 v82, v82, v80
v_mov_b64 v[80:81], v[78:79]
v_mov_b64 v[78:79], v[76:77]
v_mov_b32 v76, v33
v_min_f32 v77, v30, |v27|
s_mov_b64 exec, -1
s_waitcnt vmcnt(0)
v_perm_b32 v24, v20, v74, s64
v_perm_b32 v25, v21, v74, s65
v_perm_b32 v26, v22, v74, s66
v_perm_b32 v27, v23, v74, s67
v_max3_f32 v28, |v24|, |v25|, |v26|
v_med3_f32 v29, |v24|, |v25|, |v26|
v_min3_f32 v30, |v24|, |v25|, |v26|
v_med3_f32 v32, v28, v29, |v27|
v_med3_f32 v33, v29, v30, |v27|
v_max_f32 v31, v28, |v27|
v_perm_b32 v39, v31, v32, s72
v_bfi_b32 v31, 3, v32, v31
v_lshlrev_b32 v31, 4, v31
v_bfi_b32 v45, 15, v45, v31
v_cmpx_eq_u32_sdwa vcc, v33, v32 src0_sel:WORD_1 src1_sel:WORD_1
v_or_b32 v82, v82, v80
v_mov_b64 v[80:81], v[78:79]
v_mov_b64 v[78:79], v[76:77]
v_mov_b32 v76, v33
v_min_f32 v77, v30, |v27|
s_mov_b64 exec, -1
v_perm_b32 v24, v20, v75, s68
v_perm_b32 v25, v21, v75, s69
v_perm_b32 v26, v22, v75, s70
v_perm_b32 v27, v23, v75, s71
v_max3_f32 v28, |v24|, |v25|, |v26|
v_med3_f32 v29, |v24|, |v25|, |v26|
v_min3_f32 v30, |v24|, |v25|, |v26|
v_med3_f32 v32, v28, v29, |v27|
v_med3_f32 v33, v29, v30, |v27|
v_max_f32 v31, v28, |v27|
v_perm_b32 v43, v31, v32, s72
v_bfi_b32 v31, 3, v32, v31
v_lshlrev_b32 v31, 4, v31
v_bfi_b32 v47, 15, v47, v31
v_cmpx_eq_u32_sdwa vcc, v33, v32 src0_sel:WORD_1 src1_sel:WORD_1
v_or_b32 v82, v82, v80
v_mov_b64 v[80:81], v[78:79]
v_mov_b64 v[78:79], v[76:77]
v_mov_b32 v76, v33
v_min_f32 v77, v30, |v27|
s_mov_b64 exec, -1
s_mov_b32 vcc_lo, 0x33333333
s_mov_b32 vcc_hi, 0x33333333
v_cndmask_b32_dpp v24, v40, v36, vcc quad_perm:[2,3,0,1] row_mask:0xf bank_mask:0xf
v_cndmask_b32_dpp v25, v41, v37, vcc quad_perm:[2,3,0,1] row_mask:0xf bank_mask:0xf
v_cndmask_b32_dpp v26, v42, v38, vcc quad_perm:[2,3,0,1] row_mask:0xf bank_mask:0xf
v_cndmask_b32_dpp v27, v43, v39, vcc quad_perm:[2,3,0,1] row_mask:0xf bank_mask:0xf
s_not_b64 vcc, vcc
buffer_store_dwordx4 v[24:27], v51, s[24:27], 0 offen sc1
v_cndmask_b32_dpp v40, v36, v40, vcc quad_perm:[2,3,0,1] row_mask:0xf bank_mask:0xf
v_cndmask_b32_dpp v41, v37, v41, vcc quad_perm:[2,3,0,1] row_mask:0xf bank_mask:0xf
v_cndmask_b32_dpp v42, v38, v42, vcc quad_perm:[2,3,0,1] row_mask:0xf bank_mask:0xf
v_cndmask_b32_dpp v43, v39, v43, vcc quad_perm:[2,3,0,1] row_mask:0xf bank_mask:0xf
s_mov_b32 s52, 0x0c0c0400
s_mov_b32 s53, 0x04000c0c
buffer_store_dwordx4 v[40:43], v66, s[24:27], 0 offen sc1
v_perm_b32 v48, v45, v44, s52
v_perm_b32 v49, v47, v46, s53
v_or_b32 v48, v48, v49
s_nop 1
v_mov_b32_dpp v49, v48 quad_perm:[2,3,0,1] row_mask:0xf bank_mask:0xf
v_perm_b32 v48, v49, v48, v55
ds_permute_b32 v48, v52, v48
v_cmp_lt_u32 s[54:55], s74, v82
L_emit:
v_cmp_lt_u32 vcc, s74, v76
v_cmp_eq_u32_sdwa s[48:49], v77, v76 src0_sel:WORD_1 src1_sel:WORD_1
v_perm_b32 v63, v76, v53, s73
v_bfe_u32 v62, v76, 2, 4
v_and_b32 v64, 0x80, v76
v_lshl_add_u32 v63, v62, 1, v63
v_mbcnt_lo_u32_b32 v62, vcc_lo, 0
v_mbcnt_hi_u32_b32 v62, vcc_hi, v62
v_add_u32 v63, v64, v63
v_add_u32 v62, s75, v62
s_bcnt1_i32_b64 s52, vcc
s_add_u32 s75, s75, s52
v_cmp_gt_u32 s[52:53], 15, v62
v_and_b32 v64, 12, v62
v_mad_u32_u24 v62, v64, 3, v62
v_lshl_add_u32 v62, v62, 2, s51
s_and_b64 s[48:49], s[48:49], vcc
s_and_b64 exec, s[52:53], vcc
ds_write_b32 v62, v63
s_mov_b64 exec, s[48:49]
v_mov_b32 v76, v77
v_mov_b32 v77, 0
s_not_b64 exec, exec
v_mov_b64 v[76:77], v[78:79]
v_mov_b64 v[78:79], v[80:81]
v_mov_b64 v[80:81], 0
s_mov_b64 exec, -1
v_or3_b32 v62, v76, v78, v80
v_cmp_lt_u32 vcc, s74, v62
s_cmp_lg_u64 s[54:55], 0
s_cselect_b32 s52, 99, s75
s_cmp_gt_u32 s52, 15
s_cselect_b32 s52, -1, 0
v_mov_b32 v63, s51
s_cbranch_vccnz L_emit
v_mov_b32 v62, s52
ds_write_b32 v63, v62 offset:204
v_lshlrev_b32 v11, 4, v63
s_waitcnt lgkmcnt(0)
s_barrier
s_mov_b64 exec, 0xffff
ds_read_b32 v67, v57
s_mov_b64 exec, -1
buffer_store_dword v48, v54, s[24:27], 0 offen sc1
s_mov_b32 exec_hi, 0xffff
s_waitcnt lgkmcnt(0)
buffer_store_dword v67, v65, s[24:27], 0 offen sc1
s_mov_b64 exec, 1
buffer_load_dword v8, v11, s[36:39], 0 offen sc1
s_mov_b64 exec, -1
s_lshl_b32 s52, s84, 7
s_add_u32 s52, s52, 458752
v_lshl_add_u32 v9, v7, 2, s52
v_mov_b32 v10, 1
s_waitcnt vmcnt(0)
s_mov_b32 s85, 0x230003c
s_barrier
s_cmp_lg_u32 s40, 0
s_cbranch_scc1 L_cons2
v_readfirstlane_b32 s47, v8
s_mov_b64 exec, 0xffff
s_cmp_lg_u32 s47, 1
s_cbranch_scc1 L_pwait
L_pset:
buffer_store_dword v10, v9, s[24:27], 0 offen sc1
L_notlast:
s_mov_b64 exec, -1
L_cons2:
v_lshrrev_b32 v72, 3, v7
v_and_b32 v73, 7, v7
v_xor_b32 v73, v73, v72
v_mul_u32_u24 v72, 1152, v72
s_and_b32 s47, s40, 1
s_mul_i32 s47, s47, 9216
s_lshr_b32 s3, s40, 1
s_lshl_b32 s3, s3, 7
s_add_u32 s47, s47, s3
v_lshl_add_u32 v72, v73, 4, v72
v_add_u32 v3, s47, v72
s_lshl_b32 s44, s40, 10
s_mul_i32 s45, s2, 18432
s_mov_b32 s46, s45
s_branch L_cons3
L_pwait:
s_mov_b32 s3, 20015
L_pwait1:
buffer_load_dword v8, off, s[36:39], 0 sc1
s_waitcnt vmcnt(0)
v_readfirstlane_b32 s47, v8
s_nop 3
s_cmp_eq_u32 s47, 1
s_cbranch_scc1 L_pset
s_sub_u32 s3, s3, 1
s_cbranch_scc0 L_pwait1
s_branch L_notlast
L_cons:
v_readfirstlane_b32 s40, v1
s_mov_b32 s86, 0
s_mov_b32 s85, 0x700030
s_mov_b32 s47, 0x700030
s_bitcmp1_b32 s2, 3
s_cselect_b32 s85, s85, 0x230003c
s_cselect_b32 s47, s47, 0x230003c
s_bitcmp1_b32 s2, 6
s_cselect_b32 s85, s47, s85
v_lshrrev_b32 v72, 3, v7
v_and_b32 v73, 7, v7
v_xor_b32 v73, v73, v72
v_mul_u32_u24 v72, 1152, v72
s_and_b32 s47, s40, 1
s_mul_i32 s47, s47, 9216
s_lshr_b32 s3, s40, 1
s_lshl_b32 s3, s3, 7
s_add_u32 s47, s47, s3
v_lshl_add_u32 v72, v73, 4, v72
v_add_u32 v3, s47, v72
s_lshl_b32 s44, s40, 10
s_mul_i32 s45, s2, 18432
s_mov_b32 s46, s45
s_waitcnt lgkmcnt(0)
s_mov_b32 s30, 663552
s_mov_b32 s31, 0x20000
s_mov_b32 s28, s6
s_and_b32 s29, s7, 0xffff
s_mov_b32 s18, 75497472
s_mov_b32 s19, 0x20000
s_mov_b32 s16, s4
s_and_b32 s17, s5, 0xffff
s_mov_b32 s26, 301989888
s_mov_b32 s27, 0x20000
s_mov_b32 s24, s14
s_and_b32 s25, s15, 0xffff
s_mov_b32 s34, 1152
s_mov_b32 s35, 0x20000
s_mov_b32 s32, s8
s_and_b32 s33, s9, 0xffff
s_mov_b32 s22, 0
s_mov_b32 s23, 0x20000
s_mov_b32 s20, s10
s_and_b32 s21, s11, 0xffff
s_mov_b32 s38, 256
s_mov_b32 s39, 0x20000
s_mov_b32 s36, s12
s_and_b32 s37, s13, 0xffff
s_cmp_lg_u32 s2, 200
s_cbranch_scc1 L_cons3
v_lshlrev_b32 v8, 4, v0
v_mov_b64 v[12:13], 0
v_mov_b64 v[14:15], 0
buffer_store_dwordx4 v[12:15], v8, s[36:39], 0 offen sc1
v_add_u32 v8, 458752, v8
v_add_u32 v9, 4096, v8
buffer_store_dwordx4 v[12:15], v8, s[24:27], 0 offen sc1
buffer_store_dwordx4 v[12:15], v9, s[24:27], 0 offen sc1
v_mov_b32 v10, 1
v_lshlrev_b32 v11, 2, v0
s_waitcnt vmcnt(0)
s_barrier
s_mov_b32 exec_hi, 0
buffer_store_dword v10, v11, s[36:39], 0 offen sc1
s_mov_b64 exec, -1
L_cons3:
s_lshr_b32 s47, s40, 1
s_lshl_b32 s3, s47, 11
s_sub_u32 s8, 15488, s3
s_lshl_b32 s3, s47, 7
s_add_u32 s7, s45, 128
s_sub_u32 s7, s7, s3
s_sub_u32 s10, s47, 1
s_sub_u32 s11, 0, s47
s_mov_b32 s9, s44
s_mov_b32 s13, 4718592
s_mov_b32 s15, 16
s_mov_b32 s14, s13
v_and_b32 v80, 3, v7
v_bfe_u32 v81, v7, 2, 2
v_bfe_u32 v82, v7, 4, 1
v_lshlrev_b32 v81, 3, v81
v_lshl_add_u32 v81, v80, 5, v81
v_lshl_add_u32 v81, v82, 7, v81
s_lshl_b32 s47, s40, 8
v_add_u32 v81, s47, v81
s_lshl_b32 s47, s40, 5
s_add_u32 s47, s47, 1024
v_lshl_add_u32 v80, v80, 3, s47
v_cmp_gt_u32 vcc, 32, v7
s_nop 1
v_cndmask_b32 v80, v80, v81, vcc
buffer_load_dwordx2 v[110:111], v80, s[32:35], 0 offen
s_cmp_lt_u32 s84, 41
s_cbranch_scc1 L_pfd
s_waitcnt vmcnt(0)
L_pfd:
s_bfe_u32 s88, s85, 0x40014
s_mov_b32 s3, 55680
s_cmp_ge_u32 s88, 6
s_cselect_b32 s3, s3, 0
s_cmp_ge_u32 s84, 41
s_cselect_b32 s3, s3, 0
L_pf:
s_add_u32 m0, s44, 0
s_nop 0
buffer_load_dwordx4 v3, s[16:19], s45 offen offset:0 nt lds
s_add_u32 m0, s44, 3840
s_nop 0
buffer_load_dwordx4 v3, s[16:19], s45 offen offset:256 nt lds
s_add_u32 m0, s44, 7680
s_nop 0
buffer_load_dwordx4 v3, s[16:19], s45 offen offset:512 nt lds
s_add_u32 m0, s44, 11520
s_nop 0
buffer_load_dwordx4 v3, s[16:19], s45 offen offset:768 nt lds
s_add_u32 m0, s44, s8
s_mov_b64 exec, s[10:11]
buffer_load_dwordx4 v3, s[16:19], s7 offen offset:896 nt lds
s_mov_b64 exec, -1
s_cmp_lg_u32 s44, 37120
s_cbranch_scc1 L_pf_f
s_mov_b64 exec, 1
buffer_load_dword v124, off, s[36:39], 0 sc1
s_mov_b64 exec, -1
L_pf_f:
s_cmp_ge_u32 s44, s3
s_cbranch_scc1 L_pf_n
s_waitcnt vmcnt(1)
L_pf_n:
s_add_u32 s7, s7, s13
s_add_u32 s44, s44, 18560
s_add_u32 s45, s45, s13
s_mov_b32 s13, 4718592
s_sub_u32 s88, s88, 1
s_cmp_lg_u32 s88, 0
s_cbranch_scc1 L_pf
L_pf_e:
L_rest:
s_mov_b32 s92, 0x80
s_mov_b32 s47, 0x80
s_bitcmp1_b32 s2, 3
s_cselect_b32 s92, s92, 0x88
s_cselect_b32 s47, s47, 0x88
s_bitcmp1_b32 s2, 6
s_cselect_b32 s92, s47, s92
s_mov_b32 s3, 0x88
s_cmp_lt_u32 s84, 41
s_cselect_b32 s92, s3, s92
s_mov_b32 s87, 0x80
s_mov_b32 s3, 0x80
s_cmp_lt_u32 s84, 41
s_cselect_b32 s87, s3, s87
v_and_b32 v72, 15, v7
v_lshrrev_b32 v73, 4, v7
v_and_b32 v74, 7, v7
v_xor_b32 v74, v74, v73
v_lshlrev_b32 v74, 4, v74
v_lshl_add_u32 v0, v72, 7, v74
v_xor_b32 v1, 64, v0
s_mul_i32 s93, s40, 3584
s_add_u32 s93, s93, 148480
v_lshl_add_u32 v2, v73, 4, s93
v_and_b32 v74, 14, v7
v_mul_u32_u24 v4, 1152, v74
v_and_b32 v74, 1, v7
v_lshl_add_u32 v4, v74, 4, v4
v_lshl_add_u32 v4, v73, 5, v4
s_lshl_b32 s47, s40, 8
v_add_u32 v4, s47, v4
s_lshl_b32 s47, s40, 5
s_add_u32 s47, s47, 1024
v_lshrrev_b32 v72, 2, v7
v_and_b32 v73, 3, v7
v_lshl_add_u32 v6, v73, 4, v72
v_lshlrev_b32 v6, 2, v6
v_mul_u32_u24 v5, 1152, v72
v_lshl_add_u32 v5, v73, 3, v5
v_add_u32 v5, s47, v5
s_mov_b32 s80, 0x55555555
s_mov_b32 s81, 0x55555555
s_mov_b32 s82, 0xaaaaaaaa
s_mov_b32 s83, 0xaaaaaaaa
v_lshl_add_u32 v109, v7, 4, s93
v_lshl_add_u32 v89, v7, 2, s93
v_mov_b32 v76, 0
v_mov_b32 v77, 0
v_mov_b32 v78, 0
v_mov_b32 v79, 0
v_mov_b32 v90, 0xdddddddd
ds_write_b128 v109, v[76:79]
ds_write_b32 v89, v90 offset:1792
ds_write_b32 v89, v90 offset:2048
ds_write_b32 v89, v90 offset:2304
ds_write_b32 v89, v90 offset:2560
ds_write_b32 v89, v90 offset:2816
ds_write_b32 v89, v90 offset:3072
ds_write_b32 v89, v90 offset:3328
s_lshl_b32 s47, s40, 2
s_add_u32 s47, s47, 163072
v_mov_b32 v88, s47
ds_write_b32 v88, v76
s_mul_i32 s47, s40, 2304
s_add_u32 s47, s47, 373760
v_and_b32 v73, 60, v7
v_mad_u32_u24 v73, v73, 3, v7
v_lshl_add_u32 v72, v73, 4, s47
s_mov_b32 s47, 380672
v_lshl_add_u32 v73, v73, 4, s47
v_lshrrev_b32 v74, 2, v7
v_cmp_gt_u32 vcc, 36, v7
v_lshlrev_b32 v90, 11, v74
v_subrev_u32 v74, 9, v74
v_lshlrev_b32 v74, 12, v74
v_cndmask_b32 v72, v73, v72, vcc
v_cndmask_b32 v90, v74, v90, vcc
s_lshl_b32 s47, s40, 12
s_add_u32 s47, s47, 0x8001
v_mov_b32 v88, 1
v_mov_b32 v94, 0xf001
v_mov_b32 v95, s47
v_cndmask_b32 v94, v94, v88, vcc
v_cndmask_b32 v95, v95, v88, vcc
v_cndmask_b32 v96, 0, 28, vcc
v_cndmask_b32 v97, 32, 0, vcc
v_add_u32 v97, s93, v97
v_cmp_gt_u32 vcc, 56, v7
v_mov_b32 v73, 0x40000000
s_lshr_b32 s47, s2, 3
s_lshl_b32 s47, s47, 2
s_add_u32 s47, s47, s40
s_mul_i32 s47, s47, 2944
v_cndmask_b32 v72, v73, v72, vcc
v_lshl_add_u32 v93, v7, 4, s47
s_mul_i32 s47, s40, 82944
s_add_u32 s47, s47, s86
v_lshl_add_u32 v112, v7, 4, s47
s_mul_i32 s47, s40, 9216
s_add_u32 s47, s47, s86
s_add_u32 s47, s47, 331776
v_lshl_add_u32 v113, v7, 4, s47
s_lshl_b32 s47, s40, 6
s_add_u32 s47, s47, s86
s_add_u32 s47, s47, 368640
v_and_b32 v106, 15, v7
v_lshl_add_u32 v106, v106, 2, s47
v_lshrrev_b32 v107, 4, v7
v_lshl_add_u32 v106, v107, 8, v106
v_and_b32 v74, 15, v7
v_and_b32 v73, 7, v7
v_lshlrev_b32 v100, 1, v73
v_lshlrev_b32 v100, v100, v88
v_lshlrev_b32 v73, 4, v73
v_lshl_add_u32 v92, v74, 7, v73
v_lshl_or_b32 v92, v92, 16, v92
v_lshrrev_b32 v98, 5, v7
v_bfe_u32 v99, v7, 3, 2
v_lshl_add_u32 v99, v99, 6, s93
v_lshl_add_u32 v101, v7, 1, s93
v_lshrrev_b32 v102, 4, v7
v_lshl_add_u32 v102, v102, 3, s93
v_lshrrev_b32 v103, 1, v7
v_lshlrev_b32 v103, 5, v103
s_mov_b32 s89, 0
s_cmp_lg_u32 s40, 0
s_cbranch_scc1 L_ready
s_mov_b32 s3, 20015
s_mov_b32 s47, 458752
v_lshl_add_u32 v9, v7, 7, s47
s_bfe_u32 s47, s85, 0x40014
s_cmp_ge_u32 s47, 6
s_waitcnt vmcnt(15)
s_cbranch_scc1 L_deep
s_waitcnt vmcnt(0)
L_deep:
v_readfirstlane_b32 s47, v124
s_mov_b32 exec_hi, 511
s_cmp_lg_u32 s47, 1
s_cbranch_scc1 L_cwait
L_poll:
buffer_load_dword v8, v9, s[24:27], 0 offen sc1
s_sub_u32 s3, s3, 1
s_cbranch_scc1 L_giveup
s_waitcnt vmcnt(0)
v_cmp_ne_u32 vcc, 1, v8
s_nop 4
s_cbranch_vccnz L_poll
L_polled:
s_mov_b64 exec, -1
L_ready:
s_waitcnt lgkmcnt(0)
s_barrier
buffer_load_dwordx4 v[8:11], v72, s[24:27], 0 offen offset:0 sc1
buffer_load_dwordx4 v[12:15], v72, s[24:27], 0 offen offset:64 sc1
buffer_load_dwordx4 v[16:19], v72, s[24:27], 0 offen offset:128 sc1
buffer_load_dwordx4 v[20:23], v72, s[24:27], 0 offen offset:192 sc1
buffer_load_dwordx4 v[76:79], v93, s[24:27], 0 offen offset:0 sc1
buffer_load_dwordx4 v[80:83], v93, s[24:27], 0 offen offset:1024 sc1
buffer_load_dwordx4 v[84:87], v93, s[24:27], 0 offen offset:2048 sc1
buffer_load_dword v174, v106, s[24:27], 0 offen offset:0 sc1
buffer_load_dword v175, v106, s[24:27], 0 offen offset:1024 sc1
buffer_load_dword v176, v106, s[24:27], 0 offen offset:2048 sc1
buffer_load_dword v177, v106, s[24:27], 0 offen offset:3072 sc1
s_mov_b32 s99, 4096
buffer_load_dword v178, v106, s[24:27], s99 offen offset:0 sc1
s_mov_b32 s98, 0
buffer_load_dwordx4 v[138:141], v113, s[24:27], s98 offen sc1
s_mov_b32 s99, 0
buffer_load_dwordx4 a[0:3], v112, s[24:27], s99 offen offset:0 sc1
buffer_load_dwordx4 a[4:7], v112, s[24:27], s99 offen offset:1024 sc1
buffer_load_dwordx4 a[8:11], v112, s[24:27], s99 offen offset:2048 sc1
s_waitcnt vmcnt(12)
v_cmp_ne_u32 s[90:91], 0, v23
v_cmp_ne_u32 s[78:79], 0, v16
v_and_b32 v73, v94, v8
v_lshrrev_b32 v72, 10, v8
v_cmp_eq_u32 s[48:49], v73, v95
v_and_or_b32 v24, v72, v96, v97
s_mov_b64 exec, s[48:49]
ds_add_rtn_u32 v40, v24, v88
s_mov_b64 exec, -1
buffer_load_dwordx4 a[12:15], v112, s[24:27], s99 offen offset:3072 sc1
v_and_b32 v73, v94, v9
v_lshrrev_b32 v72, 10, v9
v_cmp_eq_u32 s[50:51], v73, v95
v_and_or_b32 v25, v72, v96, v97
s_mov_b64 exec, s[50:51]
ds_add_rtn_u32 v41, v25, v88
s_mov_b64 exec, -1
v_and_b32 v73, v94, v10
v_lshrrev_b32 v72, 10, v10
v_cmp_eq_u32 s[52:53], v73, v95
v_and_or_b32 v26, v72, v96, v97
s_mov_b64 exec, s[52:53]
ds_add_rtn_u32 v42, v26, v88
s_mov_b64 exec, -1
s_mov_b32 s99, 4096
buffer_load_dwordx4 a[16:19], v112, s[24:27], s99 offen offset:0 sc1
v_and_b32 v73, v94, v11
v_lshrrev_b32 v72, 10, v11
v_cmp_eq_u32 s[54:55], v73, v95
v_and_or_b32 v27, v72, v96, v97
s_mov_b64 exec, s[54:55]
ds_add_rtn_u32 v43, v27, v88
s_mov_b64 exec, -1
buffer_load_dwordx4 a[20:23], v112, s[24:27], s99 offen offset:1024 sc1
v_and_b32 v73, v94, v12
v_lshrrev_b32 v72, 10, v12
v_cmp_eq_u32 s[56:57], v73, v95
v_and_or_b32 v28, v72, v96, v97
s_mov_b64 exec, s[56:57]
ds_add_rtn_u32 v44, v28, v88
s_mov_b64 exec, -1
buffer_load_dwordx4 a[24:27], v112, s[24:27], s99 offen offset:2048 sc1
v_and_b32 v73, v94, v13
v_lshrrev_b32 v72, 10, v13
v_cmp_eq_u32 s[58:59], v73, v95
v_and_or_b32 v29, v72, v96, v97
s_mov_b64 exec, s[58:59]
ds_add_rtn_u32 v45, v29, v88
s_mov_b64 exec, -1
v_and_b32 v73, v94, v14
v_lshrrev_b32 v72, 10, v14
v_cmp_eq_u32 s[60:61], v73, v95
v_and_or_b32 v30, v72, v96, v97
s_mov_b64 exec, s[60:61]
ds_add_rtn_u32 v46, v30, v88
s_mov_b64 exec, -1
buffer_load_dwordx4 a[28:31], v112, s[24:27], s99 offen offset:3072 sc1
v_and_b32 v73, v94, v15
v_lshrrev_b32 v72, 10, v15
v_cmp_eq_u32 s[62:63], v73, v95
v_and_or_b32 v31, v72, v96, v97
s_mov_b64 exec, s[62:63]
ds_add_rtn_u32 v47, v31, v88
s_mov_b64 exec, -1
s_mov_b32 s99, 8192
buffer_load_dwordx4 a[32:35], v112, s[24:27], s99 offen offset:0 sc1
s_cmp_lg_u64 s[78:79], 0
s_cbranch_scc1 L_more1
L_more1b:
ds_read_b32 v72, v89
v_mov_b32 v73, 0
s_mov_b32 s98, 1024
buffer_load_dwordx4 v[142:145], v113, s[24:27], s98 offen sc1
buffer_load_dwordx4 a[36:39], v112, s[24:27], s99 offen offset:1024 sc1
buffer_load_dwordx4 a[40:43], v112, s[24:27], s99 offen offset:2048 sc1
s_waitcnt lgkmcnt(0)
s_mov_b64 vcc, s[80:81]
v_cndmask_b32_dpp v73, v72, v73, vcc quad_perm:[0,0,2,2] row_mask:0xf bank_mask:0xf
v_add_u32 v91, v103, v73
v_add_u32 v73, v72, v73
v_cmp_lt_u32 vcc, 32, v73
s_or_b32 s90, s90, s91
s_and_b32 s47, vcc_lo, 0x1ff
s_or_b32 s47, s47, s90
s_cbranch_scc1 L_greedy
L_greedyb:
buffer_load_dwordx4 a[44:47], v112, s[24:27], s99 offen offset:3072 sc1
ds_bpermute_b32 v56, v24, v91
ds_bpermute_b32 v57, v25, v91
ds_bpermute_b32 v58, v26, v91
ds_bpermute_b32 v59, v27, v91
ds_bpermute_b32 v60, v28, v91
ds_bpermute_b32 v61, v29, v91
ds_bpermute_b32 v62, v30, v91
ds_bpermute_b32 v63, v31, v91
s_mov_b32 s99, 12288
buffer_load_dwordx4 a[48:51], v112, s[24:27], s99 offen offset:0 sc1
buffer_load_dwordx4 a[52:55], v112, s[24:27], s99 offen offset:1024 sc1
buffer_load_dwordx4 a[56:59], v112, s[24:27], s99 offen offset:2048 sc1
s_waitcnt lgkmcnt(7)
v_add_u32 v73, v40, v56
v_and_b32 v72, 0x87e, v8
v_lshl_add_u32 v73, v73, 1, s93
v_add_u32 v72, v90, v72
s_andn2_b64 exec, s[48:49], s[90:91]
ds_write_b16_d16_hi v73, v8 offset:64
ds_write_b16 v73, v72 offset:384
ds_write_b16 v73, v8 offset:704
s_mov_b64 exec, -1
buffer_load_dwordx4 a[60:63], v112, s[24:27], s99 offen offset:3072 sc1
s_waitcnt lgkmcnt(9)
v_add_u32 v73, v41, v57
v_and_b32 v72, 0x87e, v9
v_lshl_add_u32 v73, v73, 1, s93
v_add_u32 v72, v90, v72
s_andn2_b64 exec, s[50:51], s[90:91]
ds_write_b16_d16_hi v73, v9 offset:64
ds_write_b16 v73, v72 offset:384
ds_write_b16 v73, v9 offset:704
s_mov_b64 exec, -1
s_mov_b32 s99, 16384
buffer_load_dwordx4 a[64:67], v112, s[24:27], s99 offen offset:0 sc1
s_waitcnt lgkmcnt(11)
v_add_u32 v73, v42, v58
v_and_b32 v72, 0x87e, v10
v_lshl_add_u32 v73, v73, 1, s93
v_add_u32 v72, v90, v72
s_andn2_b64 exec, s[52:53], s[90:91]
ds_write_b16_d16_hi v73, v10 offset:64
ds_write_b16 v73, v72 offset:384
ds_write_b16 v73, v10 offset:704
s_mov_b64 exec, -1
buffer_load_dwordx4 a[68:71], v112, s[24:27], s99 offen offset:1024 sc1
s_waitcnt lgkmcnt(13)
v_add_u32 v73, v43, v59
v_and_b32 v72, 0x87e, v11
v_lshl_add_u32 v73, v73, 1, s93
v_add_u32 v72, v90, v72
s_andn2_b64 exec, s[54:55], s[90:91]
ds_write_b16_d16_hi v73, v11 offset:64
ds_write_b16 v73, v72 offset:384
ds_write_b16 v73, v11 offset:704
s_mov_b64 exec, -1
s_mov_b32 s98, 2048
buffer_load_dwordx4 v[146:149], v113, s[24:27], s98 offen sc1
s_waitcnt lgkmcnt(15)
v_add_u32 v73, v44, v60
v_and_b32 v72, 0x87e, v12
v_lshl_add_u32 v73, v73, 1, s93
v_add_u32 v72, v90, v72
s_andn2_b64 exec, s[56:57], s[90:91]
ds_write_b16_d16_hi v73, v12 offset:64
ds_write_b16 v73, v72 offset:384
ds_write_b16 v73, v12 offset:704
s_mov_b64 exec, -1
buffer_load_dwordx4 a[72:75], v112, s[24:27], s99 offen offset:2048 sc1
s_waitcnt lgkmcnt(15)
v_add_u32 v73, v45, v61
v_and_b32 v72, 0x87e, v13
v_lshl_add_u32 v73, v73, 1, s93
v_add_u32 v72, v90, v72
s_andn2_b64 exec, s[58:59], s[90:91]
ds_write_b16_d16_hi v73, v13 offset:64
ds_write_b16 v73, v72 offset:384
ds_write_b16 v73, v13 offset:704
s_mov_b64 exec, -1
buffer_load_dwordx4 a[76:79], v112, s[24:27], s99 offen offset:3072 sc1
s_waitcnt lgkmcnt(15)
v_add_u32 v73, v46, v62
v_and_b32 v72, 0x87e, v14
v_lshl_add_u32 v73, v73, 1, s93
v_add_u32 v72, v90, v72
s_andn2_b64 exec, s[60:61], s[90:91]
ds_write_b16_d16_hi v73, v14 offset:64
ds_write_b16 v73, v72 offset:384
ds_write_b16 v73, v14 offset:704
s_mov_b64 exec, -1
s_mov_b32 s99, 20480
buffer_load_dwordx4 a[80:83], v112, s[24:27], s99 offen offset:0 sc1
s_waitcnt lgkmcnt(15)
v_add_u32 v73, v47, v63
v_and_b32 v72, 0x87e, v15
v_lshl_add_u32 v73, v73, 1, s93
v_add_u32 v72, v90, v72
s_andn2_b64 exec, s[62:63], s[90:91]
ds_write_b16_d16_hi v73, v15 offset:64
ds_write_b16 v73, v72 offset:384
ds_write_b16 v73, v15 offset:704
s_mov_b64 exec, -1
buffer_load_dwordx4 a[84:87], v112, s[24:27], s99 offen offset:1024 sc1
buffer_load_dwordx4 a[88:91], v112, s[24:27], s99 offen offset:2048 sc1
s_cmp_lg_u64 s[78:79], 0
s_cbranch_scc1 L_more2
L_more2b:
ds_read_u16 v8, v101 offset:704
ds_read_u16 v9, v101 offset:832
ds_read_u16 v10, v101 offset:960
ds_read2_b64 v[118:121], v102 offset0:48 offset1:52
ds_read2_b64 v[122:125], v102 offset0:56 offset1:60
ds_read2_b64 v[126:129], v102 offset0:64 offset1:68
ds_read2_b64 v[130:133], v102 offset0:72 offset1:76
ds_read2_b64 v[134:137], v102 offset0:80 offset1:84
buffer_load_dwordx4 a[92:95], v112, s[24:27], s99 offen offset:3072 sc1
s_mov_b32 s99, 24576
buffer_load_dwordx4 a[96:99], v112, s[24:27], s99 offen offset:0 sc1
buffer_load_dwordx4 a[100:103], v112, s[24:27], s99 offen offset:1024 sc1
s_waitcnt lgkmcnt(5)
v_lshrrev_b32 v72, 12, v8
v_cmp_ne_u32 vcc, 0, v8
v_min_u32 v72, 8, v72
v_add3_u32 v72, v72, v98, 0
v_lshlrev_b32 v73, 4, v72
v_lshrrev_b32 v72, 1, v72
buffer_load_dwordx4 a[104:107], v112, s[24:27], s99 offen offset:2048 sc1
v_lshlrev_b32 v73, v73, v100
v_lshl_add_u32 v72, v72, 8, v99
v_bfe_u32 v74, v8, 7, 4
v_lshl_add_u32 v72, v74, 2, v72
s_mov_b64 exec, vcc
ds_xor_b32 v72, v73 offset:1792
s_mov_b64 exec, -1
v_lshrrev_b32 v72, 12, v9
v_cmp_ne_u32 vcc, 0, v9
v_min_u32 v72, 8, v72
v_add3_u32 v72, v72, v98, 2
v_lshlrev_b32 v73, 4, v72
v_lshrrev_b32 v72, 1, v72
s_mov_b32 s98, 3072
buffer_load_dwordx4 v[150:153], v113, s[24:27], s98 offen sc1
v_lshlrev_b32 v73, v73, v100
v_lshl_add_u32 v72, v72, 8, v99
v_bfe_u32 v74, v9, 7, 4
v_lshl_add_u32 v72, v74, 2, v72
s_mov_b64 exec, vcc
ds_xor_b32 v72, v73 offset:1792
s_mov_b64 exec, -1
buffer_load_dwordx4 a[108:111], v112, s[24:27], s99 offen offset:3072 sc1
v_lshrrev_b32 v72, 12, v10
v_cmp_ne_u32 vcc, 0, v10
v_min_u32 v72, 8, v72
v_add3_u32 v72, v72, v98, 4
v_lshlrev_b32 v73, 4, v72
v_lshrrev_b32 v72, 1, v72
v_lshlrev_b32 v73, v73, v100
v_lshl_add_u32 v72, v72, 8, v99
v_bfe_u32 v74, v10, 7, 4
v_lshl_add_u32 v72, v74, 2, v72
s_mov_b64 exec, vcc
s_mov_b32 exec_hi, 0
ds_xor_b32 v72, v73 offset:1792
s_mov_b64 exec, -1
s_mov_b32 s99, 28672
buffer_load_dwordx4 a[112:115], v112, s[24:27], s99 offen offset:0 sc1
ds_read_b32 v179, v89 offset:1792
ds_read_b32 v180, v89 offset:2048
ds_read_b32 v181, v89 offset:2304
ds_read_b32 v182, v89 offset:2560
ds_read_b32 v183, v89 offset:2816
ds_read_b32 v184, v89 offset:3072
ds_read_b32 v185, v89 offset:3328
buffer_load_dwordx4 a[116:119], v112, s[24:27], s99 offen offset:1024 sc1
s_waitcnt lgkmcnt(10)
v_xor_b32 v118, v92, v118
v_xor_b32 v119, v92, v119
v_xor_b32 v120, v92, v120
v_xor_b32 v121, v92, v121
buffer_load_dwordx4 a[120:123], v112, s[24:27], s99 offen offset:2048 sc1
v_xor_b32 v122, v92, v122
v_xor_b32 v123, v92, v123
v_xor_b32 v124, v92, v124
v_xor_b32 v125, v92, v125
v_xor_b32 v126, v92, v126
v_xor_b32 v127, v92, v127
v_xor_b32 v128, v92, v128
v_xor_b32 v129, v92, v129
buffer_load_dwordx4 a[124:127], v112, s[24:27], s99 offen offset:3072 sc1
v_xor_b32 v130, v92, v130
v_xor_b32 v131, v92, v131
v_xor_b32 v132, v92, v132
v_xor_b32 v133, v92, v133
v_xor_b32 v134, v92, v134
v_xor_b32 v135, v92, v135
v_xor_b32 v136, v92, v136
v_xor_b32 v137, v92, v137
v_lshlrev_b32 v114, 16, v110
v_and_b32 v115, 0xffff0000, v110
v_lshlrev_b32 v116, 16, v111
v_and_b32 v117, 0xffff0000, v111
s_mov_b32 exec_hi, 15
ds_write_b128 v109, v[114:117] offset:1024
s_mov_b64 exec, -1
s_mov_b32 s99, 32768
buffer_load_dwordx4 a[128:131], v112, s[24:27], s99 offen offset:0 sc1
s_mov_b32 s41, 2
s_mov_b32 s42, 0
s_mov_b32 s4, 37120
s_mov_b32 s22, 75497472
s_mov_b32 s5, 18560
s_mov_b32 s6, 4718592
s_mov_b64 vcc, s[80:81]
s_andn2_b32 s12, 63, s85
s_mov_b32 s59, 6
s_mov_b32 s56, 0
s_mov_b32 s64, 384
s_bitcmp1_b32 s2, 0
s_cselect_b32 s65, 288, -1
s_add_u32 s48, s46, 9437184
s_add_u32 s49, s48, 4718592
s_add_u32 s50, s49, 4718592
s_sub_u32 s58, s7, s45
s_bfe_u32 s47, s2, 0x20004
s_mul_i32 s57, s47, 294912
s_add_u32 s57, s57, 47185920
s_lshl_b32 s47, s47, 7
s_add_u32 s47, s47, 393216
s_add_u32 s32, s24, s47
s_addc_u32 s33, s25, 0
s_cmp_eq_u32 s40, 0
s_cselect_b32 s34, 4, 0
s_cselect_b64 s[62:63], 1, 0
s_waitcnt lgkmcnt(0)
v_mov_b32 v114, 163072
s_barrier
ds_read_b32 v114, v114
ds_read_b128 v[44:47], v0 offset:0
ds_read_b128 v[48:51], v1 offset:0
s_waitcnt vmcnt(18)
ds_read_b128 v[76:79], v2 offset:1024
ds_read_b128 v[80:83], v2 offset:1088
ds_read_b128 v[84:87], v2 offset:1152
ds_read_b128 v[88:91], v2 offset:1216
ds_read_b128 v[92:95], v2 offset:1280
ds_read_b128 v[96:99], v2 offset:1344
ds_read_b128 v[100:103], v2 offset:1408
ds_read_b128 v[104:107], v2 offset:1472
ds_read_b128 v[108:111], v2 offset:1536
buffer_load_dwordx4 a[132:135], v112, s[24:27], s99 offen offset:1024 sc1
ds_read_b128 v[8:11], v2 offset:1024
ds_read_b128 v[12:15], v2 offset:1088
ds_read_b128 v[16:19], v2 offset:1152
ds_read_b128 v[20:23], v2 offset:1216
ds_read_b128 v[24:27], v2 offset:1280
ds_read_b128 v[28:31], v2 offset:1344
ds_read_b128 v[32:35], v2 offset:1408
ds_read_b128 v[36:39], v2 offset:1472
ds_read_b128 v[40:43], v2 offset:1536
buffer_load_dwordx4 a[136:139], v112, s[24:27], s99 offen offset:2048 sc1
s_waitcnt lgkmcnt(15)
v_readfirstlane_b32 s47, v114
v_add_u32_sdwa v60, s42, v118 dst_sel:DWORD dst_unused:UNUSED_PAD src0_sel:DWORD src1_sel:WORD_0
s_cmp_lg_u32 s47, 0
s_cbranch_scc1 L_slow
v_smfmac_f32_16x16x64_bf16 v[76:79], a[0:3], v[44:51], v138
ds_read_b128 v[52:55], v0 offset:18560
ds_read_b128 v[56:59], v1 offset:18560
v_add_u32_sdwa v68, s42, v118 dst_sel:DWORD dst_unused:UNUSED_PAD src0_sel:DWORD src1_sel:WORD_0
v_smfmac_f32_16x16x64_bf16 v[80:83], a[4:7], v[44:51], v138 abid:1
ds_read_u16 v68, v68 offset:18560
v_add_u32_sdwa v69, s42, v118 dst_sel:DWORD dst_unused:UNUSED_PAD src0_sel:DWORD src1_sel:WORD_1
v_smfmac_f32_16x16x64_bf16 v[84:87], a[8:11], v[44:51], v139
s_waitcnt lgkmcnt(15)
buffer_load_dwordx4 a[140:143], v112, s[24:27], s99 offen offset:3072 sc1
ds_read_u16 v69, v69 offset:18560
v_add_u32_sdwa v70, s42, v119 dst_sel:DWORD dst_unused:UNUSED_PAD src0_sel:DWORD src1_sel:WORD_0
v_smfmac_f32_16x16x64_bf16 v[88:91], a[12:15], v[44:51], v139 abid:1
ds_read_u16 v70, v70 offset:18560
v_add_u32_sdwa v71, s42, v119 dst_sel:DWORD dst_unused:UNUSED_PAD src0_sel:DWORD src1_sel:WORD_1
v_smfmac_f32_16x16x64_bf16 v[92:95], a[16:19], v[44:51], v140
ds_read_u16 v71, v71 offset:18560
v_add_u32_sdwa v72, s42, v120 dst_sel:DWORD dst_unused:UNUSED_PAD src0_sel:DWORD src1_sel:WORD_0
v_smfmac_f32_16x16x64_bf16 v[96:99], a[20:23], v[44:51], v140 abid:1
s_waitcnt lgkmcnt(15)
s_mov_b32 s98, 4096
buffer_load_dwordx4 v[154:157], v113, s[24:27], s98 offen sc1
ds_read_u16 v72, v72 offset:18560
v_add_u32_sdwa v73, s42, v120 dst_sel:DWORD dst_unused:UNUSED_PAD src0_sel:DWORD src1_sel:WORD_1
v_smfmac_f32_16x16x64_bf16 v[100:103], a[24:27], v[44:51], v141
ds_read_u16 v73, v73 offset:18560
v_add_u32_sdwa v74, s42, v121 dst_sel:DWORD dst_unused:UNUSED_PAD src0_sel:DWORD src1_sel:WORD_0
v_smfmac_f32_16x16x64_bf16 v[104:107], a[28:31], v[44:51], v141 abid:1
ds_read_u16 v74, v74 offset:18560
v_add_u32_sdwa v75, s42, v121 dst_sel:DWORD dst_unused:UNUSED_PAD src0_sel:DWORD src1_sel:WORD_1
v_smfmac_f32_16x16x64_bf16 v[108:111], a[32:35], v[44:51], v174
s_waitcnt lgkmcnt(7)
s_mov_b32 s99, 36864
buffer_load_dwordx4 a[144:147], v112, s[24:27], s99 offen offset:0 sc1
ds_read_u16 v75, v75 offset:18560
v_smfmac_f32_16x16x64_bf16 v[8:11], a[0:3], v[52:59], v138
ds_read_b128 v[114:117], v2 offset:64
v_add_u32_sdwa v60, s42, v118 dst_sel:DWORD dst_unused:UNUSED_PAD src0_sel:DWORD src1_sel:WORD_0
v_smfmac_f32_16x16x64_bf16 v[12:15], a[4:7], v[52:59], v138 abid:1
ds_read_b128 v[44:47], v0 offset:2048
v_add_u32_sdwa v61, s42, v118 dst_sel:DWORD dst_unused:UNUSED_PAD src0_sel:DWORD src1_sel:WORD_1
v_smfmac_f32_16x16x64_bf16 v[16:19], a[8:11], v[52:59], v139
buffer_load_dwordx4 a[148:151], v112, s[24:27], s99 offen offset:1024 sc1
ds_read_b128 v[48:51], v1 offset:2048
v_add_u32_sdwa v62, s42, v119 dst_sel:DWORD dst_unused:UNUSED_PAD src0_sel:DWORD src1_sel:WORD_0
v_smfmac_f32_16x16x64_bf16 v[20:23], a[12:15], v[52:59], v139 abid:1
ds_read_u16 v60, v60 offset:0
v_add_u32_sdwa v63, s42, v119 dst_sel:DWORD dst_unused:UNUSED_PAD src0_sel:DWORD src1_sel:WORD_1
v_smfmac_f32_16x16x64_bf16 v[24:27], a[16:19], v[52:59], v140
ds_read_u16 v61, v61 offset:0
v_add_u32_sdwa v64, s42, v120 dst_sel:DWORD dst_unused:UNUSED_PAD src0_sel:DWORD src1_sel:WORD_0
v_smfmac_f32_16x16x64_bf16 v[28:31], a[20:23], v[52:59], v140 abid:1
buffer_load_dwordx4 a[152:155], v112, s[24:27], s99 offen offset:2048 sc1
ds_read_u16 v62, v62 offset:0
v_add_u32_sdwa v65, s42, v120 dst_sel:DWORD dst_unused:UNUSED_PAD src0_sel:DWORD src1_sel:WORD_1
v_smfmac_f32_16x16x64_bf16 v[32:35], a[24:27], v[52:59], v141
ds_read_u16 v63, v63 offset:0
v_add_u32_sdwa v66, s42, v121 dst_sel:DWORD dst_unused:UNUSED_PAD src0_sel:DWORD src1_sel:WORD_0
v_smfmac_f32_16x16x64_bf16 v[36:39], a[28:31], v[52:59], v141 abid:1
ds_read_u16 v64, v64 offset:0
v_add_u32_sdwa v67, s42, v121 dst_sel:DWORD dst_unused:UNUSED_PAD src0_sel:DWORD src1_sel:WORD_1
v_smfmac_f32_16x16x64_bf16 v[40:43], a[32:35], v[52:59], v174
s_waitcnt lgkmcnt(7)
buffer_load_dwordx4 a[156:159], v112, s[24:27], s99 offen offset:3072 sc1
ds_read_u16 v65, v65 offset:0
v_smfmac_f32_16x16x64_bf16 v[8:11], v[114:117], v[68:75], v179
ds_read_u16 v66, v66 offset:0
v_smfmac_f32_16x16x64_bf16 v[12:15], v[114:117], v[68:75], v179 abid:1
s_waitcnt lgkmcnt(7)
ds_read_u16 v67, v67 offset:0
v_smfmac_f32_16x16x64_bf16 v[76:79], a[36:39], v[44:51], v142
s_mov_b32 s99, 40960
buffer_load_dwordx4 a[160:163], v112, s[24:27], s99 offen offset:0 sc1
ds_read_b128 v[52:55], v0 offset:20608
v_add_u32_sdwa v68, s42, v122 dst_sel:DWORD dst_unused:UNUSED_PAD src0_sel:DWORD src1_sel:WORD_0
v_smfmac_f32_16x16x64_bf16 v[80:83], a[40:43], v[44:51], v142 abid:1
ds_read_b128 v[56:59], v1 offset:20608
v_add_u32_sdwa v69, s42, v122 dst_sel:DWORD dst_unused:UNUSED_PAD src0_sel:DWORD src1_sel:WORD_1
v_smfmac_f32_16x16x64_bf16 v[84:87], a[44:47], v[44:51], v143
ds_read_u16 v68, v68 offset:18560
v_add_u32_sdwa v70, s42, v123 dst_sel:DWORD dst_unused:UNUSED_PAD src0_sel:DWORD src1_sel:WORD_0
v_smfmac_f32_16x16x64_bf16 v[88:91], a[48:51], v[44:51], v143 abid:1
buffer_load_dwordx4 a[164:167], v112, s[24:27], s99 offen offset:1024 sc1
ds_read_u16 v69, v69 offset:18560
v_add_u32_sdwa v71, s42, v123 dst_sel:DWORD dst_unused:UNUSED_PAD src0_sel:DWORD src1_sel:WORD_1
v_smfmac_f32_16x16x64_bf16 v[92:95], a[52:55], v[44:51], v144
ds_read_u16 v70, v70 offset:18560
v_add_u32_sdwa v72, s42, v124 dst_sel:DWORD dst_unused:UNUSED_PAD src0_sel:DWORD src1_sel:WORD_0
v_smfmac_f32_16x16x64_bf16 v[96:99], a[56:59], v[44:51], v144 abid:1
ds_read_u16 v71, v71 offset:18560
v_add_u32_sdwa v73, s42, v124 dst_sel:DWORD dst_unused:UNUSED_PAD src0_sel:DWORD src1_sel:WORD_1
v_smfmac_f32_16x16x64_bf16 v[100:103], a[60:63], v[44:51], v145
buffer_load_dwordx4 a[168:171], v112, s[24:27], s99 offen offset:2048 sc1
ds_read_u16 v72, v72 offset:18560
v_add_u32_sdwa v74, s42, v125 dst_sel:DWORD dst_unused:UNUSED_PAD src0_sel:DWORD src1_sel:WORD_0
v_smfmac_f32_16x16x64_bf16 v[104:107], a[64:67], v[44:51], v145 abid:1
s_waitcnt vmcnt(18)
ds_read_u16 v73, v73 offset:18560
v_add_u32_sdwa v75, s42, v125 dst_sel:DWORD dst_unused:UNUSED_PAD src0_sel:DWORD src1_sel:WORD_1
v_smfmac_f32_16x16x64_bf16 v[108:111], a[68:71], v[44:51], v174 abid:1
s_waitcnt lgkmcnt(8)
ds_read_u16 v74, v74 offset:18560
v_smfmac_f32_16x16x64_bf16 v[76:79], v[114:117], v[60:67], v179
buffer_load_dwordx4 a[172:175], v112, s[24:27], s99 offen offset:3072 sc1
ds_read_u16 v75, v75 offset:18560
v_smfmac_f32_16x16x64_bf16 v[80:83], v[114:117], v[60:67], v179 abid:1
s_waitcnt lgkmcnt(8)
v_smfmac_f32_16x16x64_bf16 v[8:11], a[36:39], v[52:59], v142
ds_read_b128 v[114:117], v2 offset:128
v_add_u32_sdwa v60, s42, v122 dst_sel:DWORD dst_unused:UNUSED_PAD src0_sel:DWORD src1_sel:WORD_0
v_smfmac_f32_16x16x64_bf16 v[12:15], a[40:43], v[52:59], v142 abid:1
s_mov_b32 s99, 45056
buffer_load_dwordx4 a[176:179], v112, s[24:27], s99 offen offset:0 sc1
ds_read_b128 v[44:47], v0 offset:4096
v_add_u32_sdwa v61, s42, v122 dst_sel:DWORD dst_unused:UNUSED_PAD src0_sel:DWORD src1_sel:WORD_1
v_smfmac_f32_16x16x64_bf16 v[16:19], a[44:47], v[52:59], v143
ds_read_b128 v[48:51], v1 offset:4096
v_add_u32_sdwa v62, s42, v123 dst_sel:DWORD dst_unused:UNUSED_PAD src0_sel:DWORD src1_sel:WORD_0
v_smfmac_f32_16x16x64_bf16 v[20:23], a[48:51], v[52:59], v143 abid:1
ds_read_u16 v60, v60 offset:0
v_add_u32_sdwa v63, s42, v123 dst_sel:DWORD dst_unused:UNUSED_PAD src0_sel:DWORD src1_sel:WORD_1
v_smfmac_f32_16x16x64_bf16 v[24:27], a[52:55], v[52:59], v144
s_mov_b32 s98, 5120
buffer_load_dwordx4 v[158:161], v113, s[24:27], s98 offen sc1
ds_read_u16 v61, v61 offset:0
v_add_u32_sdwa v64, s42, v124 dst_sel:DWORD dst_unused:UNUSED_PAD src0_sel:DWORD src1_sel:WORD_0
v_smfmac_f32_16x16x64_bf16 v[28:31], a[56:59], v[52:59], v144 abid:1
ds_read_u16 v62, v62 offset:0
v_add_u32_sdwa v65, s42, v124 dst_sel:DWORD dst_unused:UNUSED_PAD src0_sel:DWORD src1_sel:WORD_1
v_smfmac_f32_16x16x64_bf16 v[32:35], a[60:63], v[52:59], v145
ds_read_u16 v63, v63 offset:0
v_add_u32_sdwa v66, s42, v125 dst_sel:DWORD dst_unused:UNUSED_PAD src0_sel:DWORD src1_sel:WORD_0
v_smfmac_f32_16x16x64_bf16 v[36:39], a[64:67], v[52:59], v145 abid:1
buffer_load_dwordx4 a[180:183], v112, s[24:27], s99 offen offset:1024 sc1
ds_read_u16 v64, v64 offset:0
v_add_u32_sdwa v67, s42, v125 dst_sel:DWORD dst_unused:UNUSED_PAD src0_sel:DWORD src1_sel:WORD_1
v_smfmac_f32_16x16x64_bf16 v[40:43], a[68:71], v[52:59], v174 abid:1
s_waitcnt lgkmcnt(7)
ds_read_u16 v65, v65 offset:0
v_smfmac_f32_16x16x64_bf16 v[12:15], v[114:117], v[68:75], v180
ds_read_u16 v66, v66 offset:0
v_smfmac_f32_16x16x64_bf16 v[16:19], v[114:117], v[68:75], v180 abid:1
buffer_load_dwordx4 a[184:187], v112, s[24:27], s99 offen offset:2048 sc1
ds_read_u16 v67, v67 offset:0
v_smfmac_f32_16x16x64_bf16 v[20:23], v[114:117], v[68:75], v181
s_waitcnt lgkmcnt(8)
v_smfmac_f32_16x16x64_bf16 v[76:79], a[72:75], v[44:51], v146
ds_read_b128 v[52:55], v0 offset:22656
v_add_u32_sdwa v68, s42, v126 dst_sel:DWORD dst_unused:UNUSED_PAD src0_sel:DWORD src1_sel:WORD_0
v_smfmac_f32_16x16x64_bf16 v[80:83], a[76:79], v[44:51], v146 abid:1
buffer_load_dwordx4 a[188:191], v112, s[24:27], s99 offen offset:3072 sc1
ds_read_b128 v[56:59], v1 offset:22656
v_add_u32_sdwa v69, s42, v126 dst_sel:DWORD dst_unused:UNUSED_PAD src0_sel:DWORD src1_sel:WORD_1
v_smfmac_f32_16x16x64_bf16 v[84:87], a[80:83], v[44:51], v147
ds_read_u16 v68, v68 offset:18560
v_add_u32_sdwa v70, s42, v127 dst_sel:DWORD dst_unused:UNUSED_PAD src0_sel:DWORD src1_sel:WORD_0
v_smfmac_f32_16x16x64_bf16 v[88:91], a[84:87], v[44:51], v147 abid:1
ds_read_u16 v69, v69 offset:18560
v_add_u32_sdwa v71, s42, v127 dst_sel:DWORD dst_unused:UNUSED_PAD src0_sel:DWORD src1_sel:WORD_1
v_smfmac_f32_16x16x64_bf16 v[92:95], a[88:91], v[44:51], v148
s_mov_b32 s99, 49152
buffer_load_dwordx4 a[192:195], v112, s[24:27], s99 offen offset:0 sc1
ds_read_u16 v70, v70 offset:18560
v_add_u32_sdwa v72, s42, v128 dst_sel:DWORD dst_unused:UNUSED_PAD src0_sel:DWORD src1_sel:WORD_0
v_smfmac_f32_16x16x64_bf16 v[96:99], a[92:95], v[44:51], v148 abid:1
ds_read_u16 v71, v71 offset:18560
v_add_u32_sdwa v73, s42, v128 dst_sel:DWORD dst_unused:UNUSED_PAD src0_sel:DWORD src1_sel:WORD_1
v_smfmac_f32_16x16x64_bf16 v[100:103], a[96:99], v[44:51], v149
ds_read_u16 v72, v72 offset:18560
v_add_u32_sdwa v74, s42, v129 dst_sel:DWORD dst_unused:UNUSED_PAD src0_sel:DWORD src1_sel:WORD_0
v_smfmac_f32_16x16x64_bf16 v[104:107], a[100:103], v[44:51], v149 abid:1
buffer_load_dwordx4 a[196:199], v112, s[24:27], s99 offen offset:1024 sc1
ds_read_u16 v73, v73 offset:18560
v_add_u32_sdwa v75, s42, v129 dst_sel:DWORD dst_unused:UNUSED_PAD src0_sel:DWORD src1_sel:WORD_1
v_smfmac_f32_16x16x64_bf16 v[108:111], a[104:107], v[44:51], v175
s_waitcnt lgkmcnt(8)
ds_read_u16 v74, v74 offset:18560
v_smfmac_f32_16x16x64_bf16 v[80:83], v[114:117], v[60:67], v180
ds_read_u16 v75, v75 offset:18560
v_smfmac_f32_16x16x64_bf16 v[84:87], v[114:117], v[60:67], v180 abid:1
buffer_load_dwordx4 a[200:203], v112, s[24:27], s99 offen offset:2048 sc1
v_smfmac_f32_16x16x64_bf16 v[88:91], v[114:117], v[60:67], v181
s_waitcnt lgkmcnt(8)
v_smfmac_f32_16x16x64_bf16 v[8:11], a[72:75], v[52:59], v146
ds_read_b128 v[114:117], v2 offset:192
v_add_u32_sdwa v60, s42, v126 dst_sel:DWORD dst_unused:UNUSED_PAD src0_sel:DWORD src1_sel:WORD_0
v_smfmac_f32_16x16x64_bf16 v[12:15], a[76:79], v[52:59], v146 abid:1
buffer_load_dwordx4 a[204:207], v112, s[24:27], s99 offen offset:3072 sc1
ds_read_b128 v[44:47], v0 offset:6144
v_add_u32_sdwa v61, s42, v126 dst_sel:DWORD dst_unused:UNUSED_PAD src0_sel:DWORD src1_sel:WORD_1
v_smfmac_f32_16x16x64_bf16 v[16:19], a[80:83], v[52:59], v147
ds_read_b128 v[48:51], v1 offset:6144
v_add_u32_sdwa v62, s42, v127 dst_sel:DWORD dst_unused:UNUSED_PAD src0_sel:DWORD src1_sel:WORD_0
v_smfmac_f32_16x16x64_bf16 v[20:23], a[84:87], v[52:59], v147 abid:1
ds_read_u16 v60, v60 offset:0
v_add_u32_sdwa v63, s42, v127 dst_sel:DWORD dst_unused:UNUSED_PAD src0_sel:DWORD src1_sel:WORD_1
v_smfmac_f32_16x16x64_bf16 v[24:27], a[88:91], v[52:59], v148
s_mov_b32 s99, 53248
buffer_load_dwordx4 a[208:211], v112, s[24:27], s99 offen offset:0 sc1
ds_read_u16 v61, v61 offset:0
v_add_u32_sdwa v64, s42, v128 dst_sel:DWORD dst_unused:UNUSED_PAD src0_sel:DWORD src1_sel:WORD_0
v_smfmac_f32_16x16x64_bf16 v[28:31], a[92:95], v[52:59], v148 abid:1
ds_read_u16 v62, v62 offset:0
v_add_u32_sdwa v65, s42, v128 dst_sel:DWORD dst_unused:UNUSED_PAD src0_sel:DWORD src1_sel:WORD_1
v_smfmac_f32_16x16x64_bf16 v[32:35], a[96:99], v[52:59], v149
ds_read_u16 v63, v63 offset:0
v_add_u32_sdwa v66, s42, v129 dst_sel:DWORD dst_unused:UNUSED_PAD src0_sel:DWORD src1_sel:WORD_0
v_smfmac_f32_16x16x64_bf16 v[36:39], a[100:103], v[52:59], v149 abid:1
buffer_load_dwordx4 a[212:215], v112, s[24:27], s99 offen offset:1024 sc1
ds_read_u16 v64, v64 offset:0
v_add_u32_sdwa v67, s42, v129 dst_sel:DWORD dst_unused:UNUSED_PAD src0_sel:DWORD src1_sel:WORD_1
v_smfmac_f32_16x16x64_bf16 v[40:43], a[104:107], v[52:59], v175
s_waitcnt lgkmcnt(7)
ds_read_u16 v65, v65 offset:0
v_smfmac_f32_16x16x64_bf16 v[20:23], v[114:117], v[68:75], v181 abid:1
ds_read_u16 v66, v66 offset:0
v_smfmac_f32_16x16x64_bf16 v[24:27], v[114:117], v[68:75], v182
s_mov_b32 s98, 6144
buffer_load_dwordx4 v[162:165], v113, s[24:27], s98 offen sc1
ds_read_u16 v67, v67 offset:0
v_smfmac_f32_16x16x64_bf16 v[28:31], v[114:117], v[68:75], v182 abid:1
s_waitcnt vmcnt(18) lgkmcnt(8)
v_smfmac_f32_16x16x64_bf16 v[76:79], a[108:111], v[44:51], v150
ds_read_b128 v[52:55], v0 offset:24704
v_add_u32_sdwa v68, s42, v130 dst_sel:DWORD dst_unused:UNUSED_PAD src0_sel:DWORD src1_sel:WORD_0
v_smfmac_f32_16x16x64_bf16 v[80:83], a[112:115], v[44:51], v150 abid:1
buffer_load_dwordx4 a[216:219], v112, s[24:27], s99 offen offset:2048 sc1
ds_read_b128 v[56:59], v1 offset:24704
v_add_u32_sdwa v69, s42, v130 dst_sel:DWORD dst_unused:UNUSED_PAD src0_sel:DWORD src1_sel:WORD_1
v_smfmac_f32_16x16x64_bf16 v[84:87], a[116:119], v[44:51], v151
ds_read_u16 v68, v68 offset:18560
v_add_u32_sdwa v70, s42, v131 dst_sel:DWORD dst_unused:UNUSED_PAD src0_sel:DWORD src1_sel:WORD_0
v_smfmac_f32_16x16x64_bf16 v[88:91], a[120:123], v[44:51], v151 abid:1
ds_read_u16 v69, v69 offset:18560
v_add_u32_sdwa v71, s42, v131 dst_sel:DWORD dst_unused:UNUSED_PAD src0_sel:DWORD src1_sel:WORD_1
v_smfmac_f32_16x16x64_bf16 v[92:95], a[124:127], v[44:51], v152
buffer_load_dwordx4 a[220:223], v112, s[24:27], s99 offen offset:3072 sc1
ds_read_u16 v70, v70 offset:18560
v_add_u32_sdwa v72, s42, v132 dst_sel:DWORD dst_unused:UNUSED_PAD src0_sel:DWORD src1_sel:WORD_0
v_smfmac_f32_16x16x64_bf16 v[96:99], a[128:131], v[44:51], v152 abid:1
ds_read_u16 v71, v71 offset:18560
v_add_u32_sdwa v73, s42, v132 dst_sel:DWORD dst_unused:UNUSED_PAD src0_sel:DWORD src1_sel:WORD_1
v_smfmac_f32_16x16x64_bf16 v[100:103], a[132:135], v[44:51], v153
ds_read_u16 v72, v72 offset:18560
v_add_u32_sdwa v74, s42, v133 dst_sel:DWORD dst_unused:UNUSED_PAD src0_sel:DWORD src1_sel:WORD_0
v_smfmac_f32_16x16x64_bf16 v[104:107], a[136:139], v[44:51], v153 abid:1
s_mov_b32 s99, 57344
buffer_load_dwordx4 a[224:227], v112, s[24:27], s99 offen offset:0 sc1
ds_read_u16 v73, v73 offset:18560
v_add_u32_sdwa v75, s42, v133 dst_sel:DWORD dst_unused:UNUSED_PAD src0_sel:DWORD src1_sel:WORD_1
v_smfmac_f32_16x16x64_bf16 v[108:111], a[140:143], v[44:51], v175 abid:1
s_waitcnt lgkmcnt(8)
ds_read_u16 v74, v74 offset:18560
v_smfmac_f32_16x16x64_bf16 v[88:91], v[114:117], v[60:67], v181 abid:1
buffer_load_dwordx4 a[228:231], v112, s[24:27], s99 offen offset:1024 sc1
ds_read_u16 v75, v75 offset:18560
v_smfmac_f32_16x16x64_bf16 v[92:95], v[114:117], v[60:67], v182
v_smfmac_f32_16x16x64_bf16 v[96:99], v[114:117], v[60:67], v182 abid:1
s_waitcnt lgkmcnt(8)
v_smfmac_f32_16x16x64_bf16 v[8:11], a[108:111], v[52:59], v150
buffer_load_dwordx4 a[232:235], v112, s[24:27], s99 offen offset:2048 sc1
ds_read_b128 v[114:117], v2 offset:256
v_add_u32_sdwa v60, s42, v130 dst_sel:DWORD dst_unused:UNUSED_PAD src0_sel:DWORD src1_sel:WORD_0
v_smfmac_f32_16x16x64_bf16 v[12:15], a[112:115], v[52:59], v150 abid:1
ds_read_b128 v[44:47], v0 offset:8192
v_add_u32_sdwa v61, s42, v130 dst_sel:DWORD dst_unused:UNUSED_PAD src0_sel:DWORD src1_sel:WORD_1
v_smfmac_f32_16x16x64_bf16 v[16:19], a[116:119], v[52:59], v151
ds_read_b128 v[48:51], v1 offset:8192
v_add_u32_sdwa v62, s42, v131 dst_sel:DWORD dst_unused:UNUSED_PAD src0_sel:DWORD src1_sel:WORD_0
v_smfmac_f32_16x16x64_bf16 v[20:23], a[120:123], v[52:59], v151 abid:1
buffer_load_dwordx4 a[236:239], v112, s[24:27], s99 offen offset:3072 sc1
ds_read_u16 v60, v60 offset:0
v_add_u32_sdwa v63, s42, v131 dst_sel:DWORD dst_unused:UNUSED_PAD src0_sel:DWORD src1_sel:WORD_1
v_smfmac_f32_16x16x64_bf16 v[24:27], a[124:127], v[52:59], v152
ds_read_u16 v61, v61 offset:0
v_add_u32_sdwa v64, s42, v132 dst_sel:DWORD dst_unused:UNUSED_PAD src0_sel:DWORD src1_sel:WORD_0
v_smfmac_f32_16x16x64_bf16 v[28:31], a[128:131], v[52:59], v152 abid:1
ds_read_u16 v62, v62 offset:0
v_add_u32_sdwa v65, s42, v132 dst_sel:DWORD dst_unused:UNUSED_PAD src0_sel:DWORD src1_sel:WORD_1
v_smfmac_f32_16x16x64_bf16 v[32:35], a[132:135], v[52:59], v153
s_mov_b32 s99, 61440
buffer_load_dwordx4 a[240:243], v112, s[24:27], s99 offen offset:0 sc1
ds_read_u16 v63, v63 offset:0
v_add_u32_sdwa v66, s42, v133 dst_sel:DWORD dst_unused:UNUSED_PAD src0_sel:DWORD src1_sel:WORD_0
v_smfmac_f32_16x16x64_bf16 v[36:39], a[136:139], v[52:59], v153 abid:1
ds_read_u16 v64, v64 offset:0
v_add_u32_sdwa v67, s42, v133 dst_sel:DWORD dst_unused:UNUSED_PAD src0_sel:DWORD src1_sel:WORD_1
v_smfmac_f32_16x16x64_bf16 v[40:43], a[140:143], v[52:59], v175 abid:1
s_waitcnt lgkmcnt(7)
ds_read_u16 v65, v65 offset:0
v_smfmac_f32_16x16x64_bf16 v[28:31], v[114:117], v[68:75], v183
buffer_load_dwordx4 a[244:247], v112, s[24:27], s99 offen offset:1024 sc1
ds_read_u16 v66, v66 offset:0
v_smfmac_f32_16x16x64_bf16 v[32:35], v[114:117], v[68:75], v183 abid:1
ds_read_u16 v67, v67 offset:0
v_smfmac_f32_16x16x64_bf16 v[36:39], v[114:117], v[68:75], v184
s_waitcnt lgkmcnt(8)
v_smfmac_f32_16x16x64_bf16 v[76:79], a[144:147], v[44:51], v154
buffer_load_dwordx4 a[248:251], v112, s[24:27], s99 offen offset:2048 sc1
ds_read_b128 v[52:55], v0 offset:26752
v_add_u32_sdwa v68, s42, v134 dst_sel:DWORD dst_unused:UNUSED_PAD src0_sel:DWORD src1_sel:WORD_0
v_smfmac_f32_16x16x64_bf16 v[80:83], a[148:151], v[44:51], v154 abid:1
s_waitcnt vmcnt(18)
ds_read_b128 v[56:59], v1 offset:26752
v_add_u32_sdwa v69, s42, v134 dst_sel:DWORD dst_unused:UNUSED_PAD src0_sel:DWORD src1_sel:WORD_1
v_smfmac_f32_16x16x64_bf16 v[84:87], a[152:155], v[44:51], v155
ds_read_u16 v68, v68 offset:18560
v_add_u32_sdwa v70, s42, v135 dst_sel:DWORD dst_unused:UNUSED_PAD src0_sel:DWORD src1_sel:WORD_0
v_smfmac_f32_16x16x64_bf16 v[88:91], a[156:159], v[44:51], v155 abid:1
s_mov_b32 s98, 7168
buffer_load_dwordx4 v[166:169], v113, s[24:27], s98 offen sc1
ds_read_u16 v69, v69 offset:18560
v_add_u32_sdwa v71, s42, v135 dst_sel:DWORD dst_unused:UNUSED_PAD src0_sel:DWORD src1_sel:WORD_1
v_smfmac_f32_16x16x64_bf16 v[92:95], a[160:163], v[44:51], v156
ds_read_u16 v70, v70 offset:18560
v_add_u32_sdwa v72, s42, v136 dst_sel:DWORD dst_unused:UNUSED_PAD src0_sel:DWORD src1_sel:WORD_0
v_smfmac_f32_16x16x64_bf16 v[96:99], a[164:167], v[44:51], v156 abid:1
ds_read_u16 v71, v71 offset:18560
v_add_u32_sdwa v73, s42, v136 dst_sel:DWORD dst_unused:UNUSED_PAD src0_sel:DWORD src1_sel:WORD_1
v_smfmac_f32_16x16x64_bf16 v[100:103], a[168:171], v[44:51], v157
s_mov_b32 s98, 8192
buffer_load_dwordx4 v[170:173], v113, s[24:27], s98 offen sc1
ds_read_u16 v72, v72 offset:18560
v_add_u32_sdwa v74, s42, v137 dst_sel:DWORD dst_unused:UNUSED_PAD src0_sel:DWORD src1_sel:WORD_0
v_smfmac_f32_16x16x64_bf16 v[104:107], a[172:175], v[44:51], v157 abid:1
ds_read_u16 v73, v73 offset:18560
v_add_u32_sdwa v75, s42, v137 dst_sel:DWORD dst_unused:UNUSED_PAD src0_sel:DWORD src1_sel:WORD_1
v_smfmac_f32_16x16x64_bf16 v[108:111], a[176:179], v[44:51], v176
s_waitcnt lgkmcnt(8)
ds_read_u16 v74, v74 offset:18560
v_smfmac_f32_16x16x64_bf16 v[96:99], v[114:117], v[60:67], v183
s_mov_b32 s99, 69632
buffer_load_dwordx4 v[214:217], v112, s[24:27], s99 offen offset:3072 sc1
ds_read_u16 v75, v75 offset:18560
v_smfmac_f32_16x16x64_bf16 v[100:103], v[114:117], v[60:67], v183 abid:1
v_smfmac_f32_16x16x64_bf16 v[104:107], v[114:117], v[60:67], v184
s_waitcnt lgkmcnt(8)
v_smfmac_f32_16x16x64_bf16 v[8:11], a[144:147], v[52:59], v154
s_mov_b32 s99, 81920
buffer_load_dwordx4 v[250:253], v112, s[24:27], s99 offen offset:0 sc1
ds_read_b128 v[114:117], v2 offset:320
v_add_u32_sdwa v60, s42, v134 dst_sel:DWORD dst_unused:UNUSED_PAD src0_sel:DWORD src1_sel:WORD_0
v_smfmac_f32_16x16x64_bf16 v[12:15], a[148:151], v[52:59], v154 abid:1
ds_read_b128 v[44:47], v0 offset:10240
v_add_u32_sdwa v61, s42, v134 dst_sel:DWORD dst_unused:UNUSED_PAD src0_sel:DWORD src1_sel:WORD_1
v_smfmac_f32_16x16x64_bf16 v[16:19], a[152:155], v[52:59], v155
ds_read_b128 v[48:51], v1 offset:10240
v_add_u32_sdwa v62, s42, v135 dst_sel:DWORD dst_unused:UNUSED_PAD src0_sel:DWORD src1_sel:WORD_0
v_smfmac_f32_16x16x64_bf16 v[20:23], a[156:159], v[52:59], v155 abid:1
s_mov_b32 s99, 61440
buffer_load_dwordx4 a[252:255], v112, s[24:27], s99 offen offset:3072 sc1
ds_read_u16 v60, v60 offset:0
v_add_u32_sdwa v63, s42, v135 dst_sel:DWORD dst_unused:UNUSED_PAD src0_sel:DWORD src1_sel:WORD_1
v_smfmac_f32_16x16x64_bf16 v[24:27], a[160:163], v[52:59], v156
ds_read_u16 v61, v61 offset:0
v_add_u32_sdwa v64, s42, v136 dst_sel:DWORD dst_unused:UNUSED_PAD src0_sel:DWORD src1_sel:WORD_0
v_smfmac_f32_16x16x64_bf16 v[28:31], a[164:167], v[52:59], v156 abid:1
ds_read_u16 v62, v62 offset:0
v_add_u32_sdwa v65, s42, v136 dst_sel:DWORD dst_unused:UNUSED_PAD src0_sel:DWORD src1_sel:WORD_1
v_smfmac_f32_16x16x64_bf16 v[32:35], a[168:171], v[52:59], v157
s_mov_b32 s99, 73728
buffer_load_dwordx4 v[218:221], v112, s[24:27], s99 offen offset:0 sc1
ds_read_u16 v63, v63 offset:0
v_add_u32_sdwa v66, s42, v137 dst_sel:DWORD dst_unused:UNUSED_PAD src0_sel:DWORD src1_sel:WORD_0
v_smfmac_f32_16x16x64_bf16 v[36:39], a[172:175], v[52:59], v157 abid:1
ds_read_u16 v64, v64 offset:0
v_add_u32_sdwa v67, s42, v137 dst_sel:DWORD dst_unused:UNUSED_PAD src0_sel:DWORD src1_sel:WORD_1
v_smfmac_f32_16x16x64_bf16 v[40:43], a[176:179], v[52:59], v176
s_waitcnt lgkmcnt(7)
ds_read_u16 v65, v65 offset:0
v_smfmac_f32_16x16x64_bf16 v[36:39], v[114:117], v[68:75], v184 abid:1
s_mov_b32 s99, 65536
buffer_load_dwordx4 v[186:189], v112, s[24:27], s99 offen offset:0 sc1
ds_read_u16 v66, v66 offset:0
v_smfmac_f32_16x16x64_bf16 v[40:43], v[114:117], v[68:75], v185
s_waitcnt lgkmcnt(7)
ds_read_u16 v67, v67 offset:0
v_smfmac_f32_16x16x64_bf16 v[76:79], a[180:183], v[44:51], v158
s_waitcnt vmcnt(18)
ds_read_b128 v[52:55], v0 offset:28800
v_smfmac_f32_16x16x64_bf16 v[80:83], a[184:187], v[44:51], v158 abid:1
s_mov_b32 s99, 73728
buffer_load_dwordx4 v[222:225], v112, s[24:27], s99 offen offset:1024 sc1
ds_read_b128 v[56:59], v1 offset:28800
v_smfmac_f32_16x16x64_bf16 v[84:87], a[188:191], v[44:51], v159
ds_read_b128 v[68:71], v0 offset:34944
v_smfmac_f32_16x16x64_bf16 v[88:91], a[192:195], v[44:51], v159 abid:1
ds_read_b128 v[72:75], v1 offset:34944
v_smfmac_f32_16x16x64_bf16 v[92:95], a[196:199], v[44:51], v160
s_mov_b32 s99, 65536
buffer_load_dwordx4 v[190:193], v112, s[24:27], s99 offen offset:1024 sc1
v_smfmac_f32_16x16x64_bf16 v[96:99], a[200:203], v[44:51], v160 abid:1
v_smfmac_f32_16x16x64_bf16 v[100:103], a[204:207], v[44:51], v161
v_smfmac_f32_16x16x64_bf16 v[104:107], a[208:211], v[44:51], v161 abid:1
s_waitcnt vmcnt(18)
s_mov_b32 s99, 73728
buffer_load_dwordx4 v[226:229], v112, s[24:27], s99 offen offset:2048 sc1
v_smfmac_f32_16x16x64_bf16 v[108:111], a[212:215], v[44:51], v176 abid:1
s_waitcnt lgkmcnt(4)
v_smfmac_f32_16x16x64_bf16 v[104:107], v[114:117], v[60:67], v184 abid:1
v_smfmac_f32_16x16x64_bf16 v[108:111], v[114:117], v[60:67], v185
s_waitcnt lgkmcnt(2)
s_mov_b32 s99, 65536
buffer_load_dwordx4 v[194:197], v112, s[24:27], s99 offen offset:2048 sc1
v_smfmac_f32_16x16x64_bf16 v[8:11], a[180:183], v[52:59], v158
ds_read_b128 v[44:47], v0 offset:12288
v_smfmac_f32_16x16x64_bf16 v[12:15], a[184:187], v[52:59], v158 abid:1
ds_read_b128 v[48:51], v1 offset:12288
v_smfmac_f32_16x16x64_bf16 v[16:19], a[188:191], v[52:59], v159
s_mov_b32 s99, 73728
buffer_load_dwordx4 v[230:233], v112, s[24:27], s99 offen offset:3072 sc1
ds_read_b128 v[60:63], v0 offset:32896
v_smfmac_f32_16x16x64_bf16 v[20:23], a[192:195], v[52:59], v159 abid:1
ds_read_b128 v[64:67], v1 offset:32896
v_smfmac_f32_16x16x64_bf16 v[24:27], a[196:199], v[52:59], v160
v_smfmac_f32_16x16x64_bf16 v[28:31], a[200:203], v[52:59], v160 abid:1
s_mov_b32 s99, 65536
buffer_load_dwordx4 v[198:201], v112, s[24:27], s99 offen offset:3072 sc1
v_smfmac_f32_16x16x64_bf16 v[32:35], a[204:207], v[52:59], v161
v_smfmac_f32_16x16x64_bf16 v[36:39], a[208:211], v[52:59], v161 abid:1
v_smfmac_f32_16x16x64_bf16 v[40:43], a[212:215], v[52:59], v176 abid:1
s_waitcnt vmcnt(18) lgkmcnt(2)
s_mov_b32 s99, 77824
buffer_load_dwordx4 v[234:237], v112, s[24:27], s99 offen offset:0 sc1
v_smfmac_f32_16x16x64_bf16 v[76:79], a[216:219], v[44:51], v162
ds_read_b128 v[52:55], v0 offset:30848
v_smfmac_f32_16x16x64_bf16 v[80:83], a[220:223], v[44:51], v162 abid:1
ds_read_b128 v[56:59], v1 offset:30848
v_smfmac_f32_16x16x64_bf16 v[84:87], a[224:227], v[44:51], v163
s_mov_b32 s99, 69632
buffer_load_dwordx4 v[202:205], v112, s[24:27], s99 offen offset:0 sc1
v_smfmac_f32_16x16x64_bf16 v[88:91], a[228:231], v[44:51], v163 abid:1
s_waitcnt vmcnt(18)
v_smfmac_f32_16x16x64_bf16 v[92:95], a[232:235], v[44:51], v164
v_smfmac_f32_16x16x64_bf16 v[96:99], a[236:239], v[44:51], v164 abid:1
s_waitcnt vmcnt(17)
s_mov_b32 s99, 77824
buffer_load_dwordx4 v[238:241], v112, s[24:27], s99 offen offset:1024 sc1
v_smfmac_f32_16x16x64_bf16 v[100:103], a[240:243], v[44:51], v165
s_waitcnt vmcnt(17)
v_smfmac_f32_16x16x64_bf16 v[104:107], a[244:247], v[44:51], v165 abid:1
s_waitcnt vmcnt(16)
v_smfmac_f32_16x16x64_bf16 v[108:111], a[248:251], v[44:51], v177
s_waitcnt lgkmcnt(0)
s_mov_b32 s99, 69632
buffer_load_dwordx4 v[206:209], v112, s[24:27], s99 offen offset:1024 sc1
v_smfmac_f32_16x16x64_bf16 v[8:11], a[216:219], v[52:59], v162
ds_read_b128 v[44:47], v0 offset:14336
v_smfmac_f32_16x16x64_bf16 v[12:15], a[220:223], v[52:59], v162 abid:1
ds_read_b128 v[48:51], v1 offset:14336
v_smfmac_f32_16x16x64_bf16 v[16:19], a[224:227], v[52:59], v163
s_mov_b32 s99, 77824
buffer_load_dwordx4 v[242:245], v112, s[24:27], s99 offen offset:2048 sc1
v_smfmac_f32_16x16x64_bf16 v[20:23], a[228:231], v[52:59], v163 abid:1
v_smfmac_f32_16x16x64_bf16 v[24:27], a[232:235], v[52:59], v164
v_smfmac_f32_16x16x64_bf16 v[28:31], a[236:239], v[52:59], v164 abid:1
s_mov_b32 s99, 69632
buffer_load_dwordx4 v[210:213], v112, s[24:27], s99 offen offset:2048 sc1
v_smfmac_f32_16x16x64_bf16 v[32:35], a[240:243], v[52:59], v165
v_smfmac_f32_16x16x64_bf16 v[36:39], a[244:247], v[52:59], v165 abid:1
v_smfmac_f32_16x16x64_bf16 v[40:43], a[248:251], v[52:59], v177
s_mov_b32 s99, 77824
buffer_load_dwordx4 v[246:249], v112, s[24:27], s99 offen offset:3072 sc1
s_bfe_u32 s47, s85, 0x40018
s_cbranch_scc0 L_ptail0
ds_read_b128 v[52:55], v0 offset:16384
ds_read_b128 v[56:59], v1 offset:16384
s_waitcnt vmcnt(17) lgkmcnt(2)
v_smfmac_f32_16x16x64_bf16 v[108:111], v[214:217], v[44:51], v177 abid:1
s_add_u32 m0, s44, 0
s_nop 0
buffer_load_dwordx4 v3, s[16:19], s45 offen offset:0 nt lds
s_waitcnt vmcnt(17) lgkmcnt(0)
v_smfmac_f32_16x16x64_bf16 v[108:111], v[250:253], v[52:59], v178
s_add_u32 m0, s44, 3840
s_nop 0
buffer_load_dwordx4 v3, s[16:19], s45 offen offset:256 nt lds
v_add_u32 v0, 37120, v0
v_add_u32 v1, 37120, v1
s_waitcnt vmcnt(17)
v_smfmac_f32_16x16x64_bf16 v[76:79], a[252:255], v[44:51], v166
s_add_u32 m0, s44, 7680
s_nop 0
buffer_load_dwordx4 v3, s[16:19], s45 offen offset:512 nt lds
s_waitcnt vmcnt(17)
v_smfmac_f32_16x16x64_bf16 v[76:79], v[218:221], v[52:59], v170
v_cvt_pk_bf16_f32 v108, v108, v109
v_cvt_pk_bf16_f32 v109, v110, v111
ds_bpermute_b32 v108, v6, v108
ds_bpermute_b32 v109, v6, v109
s_waitcnt vmcnt(16)
v_smfmac_f32_16x16x64_bf16 v[80:83], v[186:189], v[44:51], v166 abid:1
s_add_u32 m0, s44, 11520
s_nop 0
buffer_load_dwordx4 v3, s[16:19], s45 offen offset:768 nt lds
s_waitcnt vmcnt(16)
v_smfmac_f32_16x16x64_bf16 v[80:83], v[222:225], v[52:59], v170 abid:1
s_add_u32 m0, s44, s8
s_mov_b64 exec, s[10:11]
buffer_load_dwordx4 v3, s[16:19], s7 offen offset:896 nt lds
s_mov_b64 exec, -1
s_add_u32 s7, s7, 4718592
s_add_u32 s44, s44, 18560
s_add_u32 s45, s45, 4718592
v_cvt_pk_bf16_f32 v76, v76, v77
v_cvt_pk_bf16_f32 v77, v78, v79
s_waitcnt vmcnt(16)
v_smfmac_f32_16x16x64_bf16 v[84:87], v[190:193], v[44:51], v167
s_waitcnt vmcnt(15)
v_smfmac_f32_16x16x64_bf16 v[84:87], v[226:229], v[52:59], v171
s_add_u32 m0, s44, 0
s_nop 0
buffer_load_dwordx4 v3, s[16:19], s45 offen offset:0 nt lds
v_cvt_pk_bf16_f32 v78, v80, v81
v_cvt_pk_bf16_f32 v79, v82, v83
s_waitcnt lgkmcnt(0)
buffer_store_dwordx2 v[108:109], v5, s[20:23], s46 offen nt
s_waitcnt vmcnt(16)
v_smfmac_f32_16x16x64_bf16 v[88:91], v[194:197], v[44:51], v167 abid:1
s_add_u32 m0, s44, 3840
s_nop 0
buffer_load_dwordx4 v3, s[16:19], s45 offen offset:256 nt lds
s_waitcnt vmcnt(16)
v_smfmac_f32_16x16x64_bf16 v[88:91], v[230:233], v[52:59], v171 abid:1
s_add_u32 m0, s44, 7680
s_nop 0
buffer_load_dwordx4 v3, s[16:19], s45 offen offset:512 nt lds
v_cvt_pk_bf16_f32 v80, v84, v85
v_cvt_pk_bf16_f32 v81, v86, v87
s_waitcnt vmcnt(16)
v_smfmac_f32_16x16x64_bf16 v[92:95], v[198:201], v[44:51], v168
s_waitcnt vmcnt(15)
v_smfmac_f32_16x16x64_bf16 v[92:95], v[234:237], v[52:59], v172
s_add_u32 m0, s44, 11520
s_nop 0
buffer_load_dwordx4 v3, s[16:19], s45 offen offset:768 nt lds
v_cvt_pk_bf16_f32 v82, v88, v89
v_cvt_pk_bf16_f32 v83, v90, v91
v_cndmask_b32_dpp v114, v80, v76, vcc quad_perm:[1,0,3,2] row_mask:0xf bank_mask:0xf
v_cndmask_b32_dpp v115, v81, v77, vcc quad_perm:[1,0,3,2] row_mask:0xf bank_mask:0xf
v_cndmask_b32_dpp v116, v82, v78, vcc quad_perm:[1,0,3,2] row_mask:0xf bank_mask:0xf
v_cndmask_b32_dpp v117, v83, v79, vcc quad_perm:[1,0,3,2] row_mask:0xf bank_mask:0xf
buffer_store_dwordx4 v[114:117], v4, s[20:23], s46 offen offset:0 sc1
s_mov_b64 vcc, s[82:83]
s_waitcnt vmcnt(16)
v_smfmac_f32_16x16x64_bf16 v[96:99], v[202:205], v[44:51], v168 abid:1
s_add_u32 m0, s44, s8
s_mov_b64 exec, s[10:11]
buffer_load_dwordx4 v3, s[16:19], s7 offen offset:896 nt lds
s_mov_b64 exec, -1
s_add_u32 s7, s7, 4718592
s_add_u32 s44, s44, 18560
s_add_u32 s45, s45, 4718592
s_waitcnt vmcnt(16)
v_smfmac_f32_16x16x64_bf16 v[96:99], v[238:241], v[52:59], v172 abid:1
v_cvt_pk_bf16_f32 v84, v92, v93
v_cvt_pk_bf16_f32 v85, v94, v95
v_cndmask_b32_dpp v80, v76, v80, vcc quad_perm:[1,0,3,2] row_mask:0xf bank_mask:0xf
v_cndmask_b32_dpp v81, v77, v81, vcc quad_perm:[1,0,3,2] row_mask:0xf bank_mask:0xf
v_cndmask_b32_dpp v82, v78, v82, vcc quad_perm:[1,0,3,2] row_mask:0xf bank_mask:0xf
v_cndmask_b32_dpp v83, v79, v83, vcc quad_perm:[1,0,3,2] row_mask:0xf bank_mask:0xf
buffer_store_dwordx4 v[80:83], v4, s[20:23], s46 offen offset:1152 sc1
s_mov_b64 vcc, s[80:81]
s_waitcnt vmcnt(16)
v_smfmac_f32_16x16x64_bf16 v[100:103], v[206:209], v[44:51], v169
s_waitcnt vmcnt(15)
v_smfmac_f32_16x16x64_bf16 v[100:103], v[242:245], v[52:59], v173
v_cvt_pk_bf16_f32 v86, v96, v97
v_cvt_pk_bf16_f32 v87, v98, v99
v_add_u32_sdwa v76, s4, v118 dst_sel:DWORD dst_unused:UNUSED_PAD src0_sel:DWORD src1_sel:WORD_0
v_add_u32_sdwa v77, s4, v118 dst_sel:DWORD dst_unused:UNUSED_PAD src0_sel:DWORD src1_sel:WORD_1
v_add_u32_sdwa v78, s4, v119 dst_sel:DWORD dst_unused:UNUSED_PAD src0_sel:DWORD src1_sel:WORD_0
v_add_u32_sdwa v79, s4, v119 dst_sel:DWORD dst_unused:UNUSED_PAD src0_sel:DWORD src1_sel:WORD_1
s_waitcnt vmcnt(14)
v_smfmac_f32_16x16x64_bf16 v[104:107], v[210:213], v[44:51], v169 abid:1
s_waitcnt vmcnt(13)
v_smfmac_f32_16x16x64_bf16 v[104:107], v[246:249], v[52:59], v173 abid:1
v_cvt_pk_bf16_f32 v88, v100, v101
v_cvt_pk_bf16_f32 v89, v102, v103
v_add_u32_sdwa v80, s4, v120 dst_sel:DWORD dst_unused:UNUSED_PAD src0_sel:DWORD src1_sel:WORD_0
v_add_u32_sdwa v81, s4, v120 dst_sel:DWORD dst_unused:UNUSED_PAD src0_sel:DWORD src1_sel:WORD_1
v_add_u32_sdwa v82, s4, v121 dst_sel:DWORD dst_unused:UNUSED_PAD src0_sel:DWORD src1_sel:WORD_0
v_add_u32_sdwa v83, s4, v121 dst_sel:DWORD dst_unused:UNUSED_PAD src0_sel:DWORD src1_sel:WORD_1
s_nop 1
v_cvt_pk_bf16_f32 v90, v104, v105
v_cvt_pk_bf16_f32 v91, v106, v107
v_cndmask_b32_dpp v92, v88, v84, vcc quad_perm:[1,0,3,2] row_mask:0xf bank_mask:0xf
v_cndmask_b32_dpp v93, v89, v85, vcc quad_perm:[1,0,3,2] row_mask:0xf bank_mask:0xf
v_cndmask_b32_dpp v94, v90, v86, vcc quad_perm:[1,0,3,2] row_mask:0xf bank_mask:0xf
v_cndmask_b32_dpp v95, v91, v87, vcc quad_perm:[1,0,3,2] row_mask:0xf bank_mask:0xf
buffer_store_dwordx4 v[92:95], v4, s[20:23], s46 offen offset:128 sc1
s_mov_b64 vcc, s[82:83]
v_cndmask_b32_dpp v88, v84, v88, vcc quad_perm:[1,0,3,2] row_mask:0xf bank_mask:0xf
v_cndmask_b32_dpp v89, v85, v89, vcc quad_perm:[1,0,3,2] row_mask:0xf bank_mask:0xf
v_cndmask_b32_dpp v90, v86, v90, vcc quad_perm:[1,0,3,2] row_mask:0xf bank_mask:0xf
v_cndmask_b32_dpp v91, v87, v91, vcc quad_perm:[1,0,3,2] row_mask:0xf bank_mask:0xf
buffer_store_dwordx4 v[88:91], v4, s[20:23], s46 offen offset:1280 sc1
s_mov_b64 vcc, s[80:81]
s_branch L_ptail1
L_ptail0:
ds_read_b128 v[52:55], v0 offset:16384
ds_read_b128 v[56:59], v1 offset:16384
s_waitcnt vmcnt(17) lgkmcnt(2)
v_smfmac_f32_16x16x64_bf16 v[108:111], v[214:217], v[44:51], v177 abid:1
s_waitcnt vmcnt(16) lgkmcnt(0)
v_smfmac_f32_16x16x64_bf16 v[108:111], v[250:253], v[52:59], v178
v_add_u32 v0, 37120, v0
v_add_u32 v1, 37120, v1
s_waitcnt vmcnt(15)
v_smfmac_f32_16x16x64_bf16 v[76:79], a[252:255], v[44:51], v166
s_waitcnt vmcnt(14)
v_smfmac_f32_16x16x64_bf16 v[76:79], v[218:221], v[52:59], v170
s_nop 1
v_cvt_pk_bf16_f32 v108, v108, v109
v_cvt_pk_bf16_f32 v109, v110, v111
ds_bpermute_b32 v108, v6, v108
ds_bpermute_b32 v109, v6, v109
s_waitcnt vmcnt(13)
v_smfmac_f32_16x16x64_bf16 v[80:83], v[186:189], v[44:51], v166 abid:1
s_waitcnt vmcnt(12)
v_smfmac_f32_16x16x64_bf16 v[80:83], v[222:225], v[52:59], v170 abid:1
v_cvt_pk_bf16_f32 v76, v76, v77
v_cvt_pk_bf16_f32 v77, v78, v79
s_waitcnt vmcnt(11)
v_smfmac_f32_16x16x64_bf16 v[84:87], v[190:193], v[44:51], v167
s_waitcnt vmcnt(10)
v_smfmac_f32_16x16x64_bf16 v[84:87], v[226:229], v[52:59], v171
s_nop 1
v_cvt_pk_bf16_f32 v78, v80, v81
v_cvt_pk_bf16_f32 v79, v82, v83
s_waitcnt lgkmcnt(0)
buffer_store_dwordx2 v[108:109], v5, s[20:23], s46 offen nt
s_waitcnt vmcnt(10)
v_smfmac_f32_16x16x64_bf16 v[88:91], v[194:197], v[44:51], v167 abid:1
s_waitcnt vmcnt(9)
v_smfmac_f32_16x16x64_bf16 v[88:91], v[230:233], v[52:59], v171 abid:1
v_cvt_pk_bf16_f32 v80, v84, v85
v_cvt_pk_bf16_f32 v81, v86, v87
s_waitcnt vmcnt(8)
v_smfmac_f32_16x16x64_bf16 v[92:95], v[198:201], v[44:51], v168
s_waitcnt vmcnt(7)
v_smfmac_f32_16x16x64_bf16 v[92:95], v[234:237], v[52:59], v172
s_nop 1
v_cvt_pk_bf16_f32 v82, v88, v89
v_cvt_pk_bf16_f32 v83, v90, v91
v_cndmask_b32_dpp v114, v80, v76, vcc quad_perm:[1,0,3,2] row_mask:0xf bank_mask:0xf
v_cndmask_b32_dpp v115, v81, v77, vcc quad_perm:[1,0,3,2] row_mask:0xf bank_mask:0xf
v_cndmask_b32_dpp v116, v82, v78, vcc quad_perm:[1,0,3,2] row_mask:0xf bank_mask:0xf
v_cndmask_b32_dpp v117, v83, v79, vcc quad_perm:[1,0,3,2] row_mask:0xf bank_mask:0xf
buffer_store_dwordx4 v[114:117], v4, s[20:23], s46 offen offset:0 sc1
s_mov_b64 vcc, s[82:83]
s_waitcnt vmcnt(7)
v_smfmac_f32_16x16x64_bf16 v[96:99], v[202:205], v[44:51], v168 abid:1
s_waitcnt vmcnt(6)
v_smfmac_f32_16x16x64_bf16 v[96:99], v[238:241], v[52:59], v172 abid:1
v_cvt_pk_bf16_f32 v84, v92, v93
v_cvt_pk_bf16_f32 v85, v94, v95
v_cndmask_b32_dpp v80, v76, v80, vcc quad_perm:[1,0,3,2] row_mask:0xf bank_mask:0xf
v_cndmask_b32_dpp v81, v77, v81, vcc quad_perm:[1,0,3,2] row_mask:0xf bank_mask:0xf
v_cndmask_b32_dpp v82, v78, v82, vcc quad_perm:[1,0,3,2] row_mask:0xf bank_mask:0xf
v_cndmask_b32_dpp v83, v79, v83, vcc quad_perm:[1,0,3,2] row_mask:0xf bank_mask:0xf
buffer_store_dwordx4 v[80:83], v4, s[20:23], s46 offen offset:1152 sc1
s_mov_b64 vcc, s[80:81]
s_waitcnt vmcnt(6)
v_smfmac_f32_16x16x64_bf16 v[100:103], v[206:209], v[44:51], v169
s_waitcnt vmcnt(5)
v_smfmac_f32_16x16x64_bf16 v[100:103], v[242:245], v[52:59], v173
v_cvt_pk_bf16_f32 v86, v96, v97
v_cvt_pk_bf16_f32 v87, v98, v99
v_add_u32_sdwa v76, s4, v118 dst_sel:DWORD dst_unused:UNUSED_PAD src0_sel:DWORD src1_sel:WORD_0
v_add_u32_sdwa v77, s4, v118 dst_sel:DWORD dst_unused:UNUSED_PAD src0_sel:DWORD src1_sel:WORD_1
v_add_u32_sdwa v78, s4, v119 dst_sel:DWORD dst_unused:UNUSED_PAD src0_sel:DWORD src1_sel:WORD_0
v_add_u32_sdwa v79, s4, v119 dst_sel:DWORD dst_unused:UNUSED_PAD src0_sel:DWORD src1_sel:WORD_1
s_waitcnt vmcnt(4)
v_smfmac_f32_16x16x64_bf16 v[104:107], v[210:213], v[44:51], v169 abid:1
s_waitcnt vmcnt(3)
v_smfmac_f32_16x16x64_bf16 v[104:107], v[246:249], v[52:59], v173 abid:1
v_cvt_pk_bf16_f32 v88, v100, v101
v_cvt_pk_bf16_f32 v89, v102, v103
v_add_u32_sdwa v80, s4, v120 dst_sel:DWORD dst_unused:UNUSED_PAD src0_sel:DWORD src1_sel:WORD_0
v_add_u32_sdwa v81, s4, v120 dst_sel:DWORD dst_unused:UNUSED_PAD src0_sel:DWORD src1_sel:WORD_1
v_add_u32_sdwa v82, s4, v121 dst_sel:DWORD dst_unused:UNUSED_PAD src0_sel:DWORD src1_sel:WORD_0
v_add_u32_sdwa v83, s4, v121 dst_sel:DWORD dst_unused:UNUSED_PAD src0_sel:DWORD src1_sel:WORD_1
s_nop 1
v_cvt_pk_bf16_f32 v90, v104, v105
v_cvt_pk_bf16_f32 v91, v106, v107
v_cndmask_b32_dpp v92, v88, v84, vcc quad_perm:[1,0,3,2] row_mask:0xf bank_mask:0xf
v_cndmask_b32_dpp v93, v89, v85, vcc quad_perm:[1,0,3,2] row_mask:0xf bank_mask:0xf
v_cndmask_b32_dpp v94, v90, v86, vcc quad_perm:[1,0,3,2] row_mask:0xf bank_mask:0xf
v_cndmask_b32_dpp v95, v91, v87, vcc quad_perm:[1,0,3,2] row_mask:0xf bank_mask:0xf
buffer_store_dwordx4 v[92:95], v4, s[20:23], s46 offen offset:128 sc1
s_mov_b64 vcc, s[82:83]
v_cndmask_b32_dpp v88, v84, v88, vcc quad_perm:[1,0,3,2] row_mask:0xf bank_mask:0xf
v_cndmask_b32_dpp v89, v85, v89, vcc quad_perm:[1,0,3,2] row_mask:0xf bank_mask:0xf
v_cndmask_b32_dpp v90, v86, v90, vcc quad_perm:[1,0,3,2] row_mask:0xf bank_mask:0xf
v_cndmask_b32_dpp v91, v87, v91, vcc quad_perm:[1,0,3,2] row_mask:0xf bank_mask:0xf
buffer_store_dwordx4 v[88:91], v4, s[20:23], s46 offen offset:1280 sc1
s_mov_b64 vcc, s[80:81]
L_ptail1:
s_cmp_ge_u32 s44, 148480
s_cselect_b32 s44, s9, s44
s_add_u32 s46, s46, 4718592
s_waitcnt lgkmcnt(0)
s_barrier
s_cmp_lg_u32 s89, 0
s_cbranch_scc1 L_loopnk_p3
s_branch L_loopn_p3
.p2align 6
L_loop:
v_smfmac_f32_16x16x64_bf16 v[8:11], a[0:3], v[44:51], v138
ds_read_b128 v[32:35], v2 offset:1408
v_cvt_pk_bf16_f32 v106, v36, v37
v_smfmac_f32_16x16x64_bf16 v[8:11], a[36:39], v[52:59], v142
s_waitcnt lgkmcnt(9)
v_cvt_pk_bf16_f32 v107, v38, v39
v_smfmac_f32_16x16x64_bf16 v[12:15], a[4:7], v[44:51], v138 abid:1
ds_read_b128 v[36:39], v2 offset:1472
v_cvt_pk_bf16_f32 v112, v40, v41
v_smfmac_f32_16x16x64_bf16 v[12:15], a[40:43], v[52:59], v142 abid:1
s_waitcnt lgkmcnt(8)
ds_read_b128 v[60:63], v0 offset:4096
v_cvt_pk_bf16_f32 v113, v42, v43
v_smfmac_f32_16x16x64_bf16 v[16:19], a[8:11], v[44:51], v139
s_cmp_eq_u32 s4, 129920
ds_read_b128 v[40:43], v2 offset:1536
v_cndmask_b32_dpp v108, v96, v92, vcc quad_perm:[1,0,3,2] row_mask:0xf bank_mask:0xf
v_smfmac_f32_16x16x64_bf16 v[16:19], a[44:47], v[52:59], v143
s_waitcnt lgkmcnt(8)
ds_read_u16 v82, v82
v_cndmask_b32_dpp v109, v97, v93, vcc quad_perm:[1,0,3,2] row_mask:0xf bank_mask:0xf
v_smfmac_f32_16x16x64_bf16 v[20:23], a[12:15], v[44:51], v139 abid:1
s_cselect_b32 s43, -129920, s5
ds_read_u16 v84, v84
v_cndmask_b32_dpp v110, v98, v94, vcc quad_perm:[1,0,3,2] row_mask:0xf bank_mask:0xf
v_smfmac_f32_16x16x64_bf16 v[20:23], a[48:51], v[52:59], v143 abid:1
s_waitcnt lgkmcnt(8)
ds_read_b128 v[64:67], v1 offset:4096
v_cndmask_b32_dpp v111, v99, v95, vcc quad_perm:[1,0,3,2] row_mask:0xf bank_mask:0xf
v_smfmac_f32_16x16x64_bf16 v[24:27], a[16:19], v[44:51], v140
s_add_u32 s4, s4, s43
ds_read_b128 v[68:71], v0 offset:6144
v_add_u32_sdwa v87, s42, v123 dst_sel:DWORD dst_unused:UNUSED_PAD src0_sel:DWORD src1_sel:WORD_1
v_smfmac_f32_16x16x64_bf16 v[24:27], a[52:55], v[52:59], v144
buffer_store_dwordx4 v[108:111], v4, s[20:23], s46 offen offset:0 sc1
s_mov_b64 vcc, s[82:83]
s_waitcnt lgkmcnt(8)
ds_read_b128 v[72:75], v1 offset:6144
v_cndmask_b32_dpp v96, v92, v96, vcc quad_perm:[1,0,3,2] row_mask:0xf bank_mask:0xf
v_cndmask_b32_dpp v97, v93, v97, vcc quad_perm:[1,0,3,2] row_mask:0xf bank_mask:0xf
v_smfmac_f32_16x16x64_bf16 v[28:31], a[20:23], v[44:51], v140 abid:1
s_add_u32 s41, s41, 1
ds_read_u16 v83, v83
v_cndmask_b32_dpp v98, v94, v98, vcc quad_perm:[1,0,3,2] row_mask:0xf bank_mask:0xf
v_smfmac_f32_16x16x64_bf16 v[28:31], a[56:59], v[52:59], v144 abid:1
s_waitcnt lgkmcnt(9)
ds_read_b128 v[114:117], v2 offset:64
v_cndmask_b32_dpp v99, v95, v99, vcc quad_perm:[1,0,3,2] row_mask:0xf bank_mask:0xf
v_smfmac_f32_16x16x64_bf16 v[32:35], a[24:27], v[44:51], v141
ds_read_u16 v85, v85
v_add_u32_sdwa v88, s42, v124 dst_sel:DWORD dst_unused:UNUSED_PAD src0_sel:DWORD src1_sel:WORD_0
v_smfmac_f32_16x16x64_bf16 v[32:35], a[60:63], v[52:59], v145
s_waitcnt lgkmcnt(10)
ds_read_u16 v86, v86
v_add_u32_sdwa v89, s42, v124 dst_sel:DWORD dst_unused:UNUSED_PAD src0_sel:DWORD src1_sel:WORD_1
v_smfmac_f32_16x16x64_bf16 v[36:39], a[28:31], v[44:51], v141 abid:1
ds_read_u16 v87, v87
v_add_u32_sdwa v90, s42, v125 dst_sel:DWORD dst_unused:UNUSED_PAD src0_sel:DWORD src1_sel:WORD_0
v_smfmac_f32_16x16x64_bf16 v[36:39], a[64:67], v[52:59], v145 abid:1
s_waitcnt lgkmcnt(10)
ds_read_u16 v88, v88
v_add_u32_sdwa v91, s42, v125 dst_sel:DWORD dst_unused:UNUSED_PAD src0_sel:DWORD src1_sel:WORD_1
v_smfmac_f32_16x16x64_bf16 v[40:43], a[32:35], v[44:51], v174
buffer_store_dwordx4 v[96:99], v4, s[20:23], s46 offen offset:1152 sc1
s_mov_b64 vcc, s[80:81]
ds_read_u16 v89, v89
v_cndmask_b32_dpp v92, v104, v100, vcc quad_perm:[1,0,3,2] row_mask:0xf bank_mask:0xf
v_cndmask_b32_dpp v93, v105, v101, vcc quad_perm:[1,0,3,2] row_mask:0xf bank_mask:0xf
v_smfmac_f32_16x16x64_bf16 v[40:43], a[68:71], v[52:59], v174 abid:1
s_waitcnt lgkmcnt(9)
ds_read_u16 v90, v90
v_cndmask_b32_dpp v94, v106, v102, vcc quad_perm:[1,0,3,2] row_mask:0xf bank_mask:0xf
v_smfmac_f32_16x16x64_bf16 v[8:11], a[72:75], v[60:67], v146
s_waitcnt lgkmcnt(8)
ds_read_u16 v91, v91
v_cndmask_b32_dpp v95, v107, v103, vcc quad_perm:[1,0,3,2] row_mask:0xf bank_mask:0xf
v_smfmac_f32_16x16x64_bf16 v[8:11], a[108:111], v[68:75], v150
s_waitcnt lgkmcnt(7)
ds_bpermute_b32 v112, v6, v112
v_smfmac_f32_16x16x64_bf16 v[8:11], v[114:117], v[76:83], v179
ds_bpermute_b32 v113, v6, v113
v_smfmac_f32_16x16x64_bf16 v[12:15], v[114:117], v[76:83], v179 abid:1
ds_read_b128 v[114:117], v2 offset:128
v_add_u32_sdwa v76, s42, v126 dst_sel:DWORD dst_unused:UNUSED_PAD src0_sel:DWORD src1_sel:WORD_0
v_smfmac_f32_16x16x64_bf16 v[12:15], a[76:79], v[60:67], v146 abid:1
ds_read_u16 v76, v76
v_add_u32_sdwa v77, s42, v126 dst_sel:DWORD dst_unused:UNUSED_PAD src0_sel:DWORD src1_sel:WORD_1
v_smfmac_f32_16x16x64_bf16 v[12:15], a[112:115], v[68:75], v150 abid:1
buffer_store_dwordx4 v[92:95], v4, s[20:23], s46 offen offset:128 sc1
s_mov_b64 vcc, s[82:83]
ds_read_u16 v77, v77
v_cndmask_b32_dpp v104, v100, v104, vcc quad_perm:[1,0,3,2] row_mask:0xf bank_mask:0xf
v_add_u32_sdwa v78, s42, v127 dst_sel:DWORD dst_unused:UNUSED_PAD src0_sel:DWORD src1_sel:WORD_0
v_smfmac_f32_16x16x64_bf16 v[24:27], a[88:91], v[60:67], v148
ds_read_u16 v78, v78
v_cndmask_b32_dpp v105, v101, v105, vcc quad_perm:[1,0,3,2] row_mask:0xf bank_mask:0xf
v_smfmac_f32_16x16x64_bf16 v[24:27], a[124:127], v[68:75], v152
ds_read_b128 v[44:47], v0 offset:8192
v_cndmask_b32_dpp v106, v102, v106, vcc quad_perm:[1,0,3,2] row_mask:0xf bank_mask:0xf
v_smfmac_f32_16x16x64_bf16 v[28:31], a[92:95], v[60:67], v148 abid:1
ds_read_b128 v[48:51], v1 offset:8192
v_add_u32_sdwa v79, s42, v127 dst_sel:DWORD dst_unused:UNUSED_PAD src0_sel:DWORD src1_sel:WORD_1
v_smfmac_f32_16x16x64_bf16 v[28:31], a[128:131], v[68:75], v152 abid:1
ds_read_u16 v79, v79
v_cndmask_b32_dpp v107, v103, v107, vcc quad_perm:[1,0,3,2] row_mask:0xf bank_mask:0xf
v_smfmac_f32_16x16x64_bf16 v[32:35], a[96:99], v[60:67], v149
ds_read_b128 v[52:55], v0 offset:10240
v_add_u32_sdwa v80, s42, v128 dst_sel:DWORD dst_unused:UNUSED_PAD src0_sel:DWORD src1_sel:WORD_0
v_smfmac_f32_16x16x64_bf16 v[32:35], a[132:135], v[68:75], v153
ds_read_u16 v80, v80
v_add_u32_sdwa v81, s42, v128 dst_sel:DWORD dst_unused:UNUSED_PAD src0_sel:DWORD src1_sel:WORD_1
v_smfmac_f32_16x16x64_bf16 v[16:19], a[80:83], v[60:67], v147
buffer_store_dwordx4 v[104:107], v4, s[20:23], s46 offen offset:1280 sc1
s_mov_b64 vcc, s[80:81]
ds_read_b128 v[56:59], v1 offset:10240
v_add_u32_sdwa v82, s42, v129 dst_sel:DWORD dst_unused:UNUSED_PAD src0_sel:DWORD src1_sel:WORD_0
v_add_u32_sdwa v83, s42, v129 dst_sel:DWORD dst_unused:UNUSED_PAD src0_sel:DWORD src1_sel:WORD_1
v_smfmac_f32_16x16x64_bf16 v[16:19], a[116:119], v[68:75], v151
s_waitcnt lgkmcnt(9)
ds_read_b128 v[92:95], v0 offset:12288
v_add_u32_sdwa v100, s42, v130 dst_sel:DWORD dst_unused:UNUSED_PAD src0_sel:DWORD src1_sel:WORD_0
v_smfmac_f32_16x16x64_bf16 v[16:19], v[114:117], v[84:91], v180 abid:1
s_waitcnt vmcnt(4)
ds_read_u16 v81, v81
v_add_u32_sdwa v101, s42, v130 dst_sel:DWORD dst_unused:UNUSED_PAD src0_sel:DWORD src1_sel:WORD_1
v_smfmac_f32_16x16x64_bf16 v[20:23], v[114:117], v[84:91], v181
ds_read_b128 v[96:99], v1 offset:12288
v_add_u32_sdwa v102, s42, v131 dst_sel:DWORD dst_unused:UNUSED_PAD src0_sel:DWORD src1_sel:WORD_0
v_smfmac_f32_16x16x64_bf16 v[20:23], a[84:87], v[60:67], v147 abid:1
ds_read_u16 v100, v100
v_add_u32_sdwa v103, s42, v131 dst_sel:DWORD dst_unused:UNUSED_PAD src0_sel:DWORD src1_sel:WORD_1
v_smfmac_f32_16x16x64_bf16 v[20:23], a[120:123], v[68:75], v151 abid:1
ds_read_u16 v82, v82
v_add_u32_sdwa v104, s42, v132 dst_sel:DWORD dst_unused:UNUSED_PAD src0_sel:DWORD src1_sel:WORD_0
v_smfmac_f32_16x16x64_bf16 v[36:39], a[100:103], v[60:67], v149 abid:1
ds_read_u16 v101, v101
v_add_u32_sdwa v105, s42, v132 dst_sel:DWORD dst_unused:UNUSED_PAD src0_sel:DWORD src1_sel:WORD_1
v_smfmac_f32_16x16x64_bf16 v[36:39], a[136:139], v[68:75], v153 abid:1
buffer_store_dwordx2 v[112:113], v5, s[20:23], s46 offen nt
ds_read_u16 v83, v83
v_add_u32_sdwa v106, s42, v133 dst_sel:DWORD dst_unused:UNUSED_PAD src0_sel:DWORD src1_sel:WORD_0
v_smfmac_f32_16x16x64_bf16 v[40:43], a[104:107], v[60:67], v175
s_mov_b32 s22, 75497472
ds_read_b128 v[114:117], v2 offset:192
v_add_u32_sdwa v107, s42, v133 dst_sel:DWORD dst_unused:UNUSED_PAD src0_sel:DWORD src1_sel:WORD_1
v_smfmac_f32_16x16x64_bf16 v[40:43], a[140:143], v[68:75], v175 abid:1
s_waitcnt lgkmcnt(12)
ds_read_u16 v102, v102
v_add_u32_sdwa v84, s42, v134 dst_sel:DWORD dst_unused:UNUSED_PAD src0_sel:DWORD src1_sel:WORD_0
v_smfmac_f32_16x16x64_bf16 v[8:11], a[144:147], v[44:51], v154
s_waitcnt lgkmcnt(9)
ds_read_u16 v103, v103
v_add_u32_sdwa v85, s42, v134 dst_sel:DWORD dst_unused:UNUSED_PAD src0_sel:DWORD src1_sel:WORD_1
v_smfmac_f32_16x16x64_bf16 v[8:11], a[180:183], v[52:59], v158
s_waitcnt lgkmcnt(7)
ds_read_u16 v104, v104
v_add_u32_sdwa v86, s42, v135 dst_sel:DWORD dst_unused:UNUSED_PAD src0_sel:DWORD src1_sel:WORD_0
v_smfmac_f32_16x16x64_bf16 v[8:11], a[216:219], v[92:99], v162
s_mov_b32 s46, s48
ds_read_u16 v105, v105
v_add_u32_sdwa v87, s42, v135 dst_sel:DWORD dst_unused:UNUSED_PAD src0_sel:DWORD src1_sel:WORD_1
v_smfmac_f32_16x16x64_bf16 v[24:27], a[160:163], v[44:51], v156
s_add_u32 m0, s44, 0
ds_read_u16 v106, v106
v_add_u32_sdwa v88, s42, v136 dst_sel:DWORD dst_unused:UNUSED_PAD src0_sel:DWORD src1_sel:WORD_0
v_smfmac_f32_16x16x64_bf16 v[24:27], a[196:199], v[52:59], v160
buffer_load_dwordx4 v3, s[16:19], s45 offen offset:0 nt lds
v_add_u32_sdwa v89, s42, v136 dst_sel:DWORD dst_unused:UNUSED_PAD src0_sel:DWORD src1_sel:WORD_1
v_smfmac_f32_16x16x64_bf16 v[24:27], a[232:235], v[92:99], v164
s_waitcnt lgkmcnt(5)
ds_read_u16 v107, v107
v_add_u32_sdwa v90, s42, v137 dst_sel:DWORD dst_unused:UNUSED_PAD src0_sel:DWORD src1_sel:WORD_0
v_smfmac_f32_16x16x64_bf16 v[24:27], v[114:117], v[76:83], v182
s_mov_b32 s48, s49
ds_read_u16 v84, v84
v_add_u32_sdwa v91, s42, v137 dst_sel:DWORD dst_unused:UNUSED_PAD src0_sel:DWORD src1_sel:WORD_1
v_smfmac_f32_16x16x64_bf16 v[28:31], v[114:117], v[76:83], v182 abid:1
s_mov_b32 s49, s50
ds_read_b128 v[114:117], v2 offset:256
v_add_u32_sdwa v76, s4, v118 dst_sel:DWORD dst_unused:UNUSED_PAD src0_sel:DWORD src1_sel:WORD_0
v_smfmac_f32_16x16x64_bf16 v[28:31], a[164:167], v[44:51], v156 abid:1
s_add_u32 s50, s50, 4718592
ds_read_u16 v85, v85
v_add_u32_sdwa v77, s4, v118 dst_sel:DWORD dst_unused:UNUSED_PAD src0_sel:DWORD src1_sel:WORD_1
v_smfmac_f32_16x16x64_bf16 v[28:31], a[200:203], v[52:59], v160 abid:1
ds_read_u16 v86, v86
v_add_u32_sdwa v78, s4, v119 dst_sel:DWORD dst_unused:UNUSED_PAD src0_sel:DWORD src1_sel:WORD_0
v_smfmac_f32_16x16x64_bf16 v[28:31], a[236:239], v[92:99], v164 abid:1
ds_read_u16 v87, v87
v_add_u32_sdwa v79, s4, v119 dst_sel:DWORD dst_unused:UNUSED_PAD src0_sel:DWORD src1_sel:WORD_1
v_smfmac_f32_16x16x64_bf16 v[12:15], a[148:151], v[44:51], v154 abid:1
s_add_u32 m0, s44, 3840
ds_read_u16 v88, v88
v_add_u32_sdwa v80, s4, v120 dst_sel:DWORD dst_unused:UNUSED_PAD src0_sel:DWORD src1_sel:WORD_0
v_smfmac_f32_16x16x64_bf16 v[12:15], a[184:187], v[52:59], v158 abid:1
buffer_load_dwordx4 v3, s[16:19], s45 offen offset:256 nt lds
v_add_u32_sdwa v81, s4, v120 dst_sel:DWORD dst_unused:UNUSED_PAD src0_sel:DWORD src1_sel:WORD_1
v_smfmac_f32_16x16x64_bf16 v[12:15], a[220:223], v[92:99], v162 abid:1
ds_read_b128 v[60:63], v0 offset:14336
v_add_u32_sdwa v82, s4, v121 dst_sel:DWORD dst_unused:UNUSED_PAD src0_sel:DWORD src1_sel:WORD_0
v_smfmac_f32_16x16x64_bf16 v[32:35], a[168:171], v[44:51], v157
ds_read_u16 v89, v89
v_add_u32_sdwa v83, s4, v121 dst_sel:DWORD dst_unused:UNUSED_PAD src0_sel:DWORD src1_sel:WORD_1
v_smfmac_f32_16x16x64_bf16 v[32:35], a[204:207], v[52:59], v161
ds_read_b128 v[64:67], v1 offset:14336
v_smfmac_f32_16x16x64_bf16 v[32:35], a[240:243], v[92:99], v165
s_waitcnt lgkmcnt(7)
ds_read_b128 v[68:71], v0 offset:16384
v_smfmac_f32_16x16x64_bf16 v[32:35], v[114:117], v[100:107], v183 abid:1
ds_read_u16 v90, v90
v_smfmac_f32_16x16x64_bf16 v[36:39], v[114:117], v[100:107], v184
ds_read_b128 v[72:75], v1 offset:16384
v_add_u32 v0, s43, v0
v_smfmac_f32_16x16x64_bf16 v[36:39], a[172:175], v[44:51], v157 abid:1
s_add_u32 m0, s44, 7680
ds_read_u16 v91, v91
v_add_u32 v1, s43, v1
v_smfmac_f32_16x16x64_bf16 v[36:39], a[208:211], v[52:59], v161 abid:1
buffer_load_dwordx4 v3, s[16:19], s45 offen offset:512 nt lds
v_smfmac_f32_16x16x64_bf16 v[36:39], a[244:247], v[92:99], v165 abid:1
ds_read_b128 v[114:117], v2 offset:320
v_smfmac_f32_16x16x64_bf16 v[16:19], a[152:155], v[44:51], v155
s_add_u32 m0, s44, 11520
v_smfmac_f32_16x16x64_bf16 v[16:19], a[188:191], v[52:59], v159
buffer_load_dwordx4 v3, s[16:19], s45 offen offset:768 nt lds
v_smfmac_f32_16x16x64_bf16 v[16:19], a[224:227], v[92:99], v163
v_smfmac_f32_16x16x64_bf16 v[20:23], a[156:159], v[44:51], v155 abid:1
s_add_u32 m0, s44, s8
v_smfmac_f32_16x16x64_bf16 v[20:23], a[192:195], v[52:59], v159 abid:1
s_mov_b64 exec, s[10:11]
buffer_load_dwordx4 v3, s[16:19], s7 offen offset:896 nt lds
s_mov_b64 exec, -1
v_smfmac_f32_16x16x64_bf16 v[20:23], a[228:231], v[92:99], v163 abid:1
s_add_u32 s45, s45, 4718592
s_add_u32 s7, s7, 4718592
s_add_u32 s44, s44, s5
v_smfmac_f32_16x16x64_bf16 v[40:43], a[176:179], v[44:51], v176
s_cmp_ge_u32 s44, 148480
s_cselect_b32 s44, s9, s44
s_bitcmp1_b32 s92, s41
v_smfmac_f32_16x16x64_bf16 v[40:43], a[212:215], v[52:59], v176 abid:1
s_cbranch_scc1 L_loop_w
L_loop_wb:
v_smfmac_f32_16x16x64_bf16 v[40:43], a[248:251], v[92:99], v177
s_waitcnt lgkmcnt(0)
v_smfmac_f32_16x16x64_bf16 v[40:43], v[114:117], v[84:91], v185
s_waitcnt vmcnt(20)
s_barrier
v_smfmac_f32_16x16x64_bf16 v[8:11], a[252:255], v[60:67], v166
s_mov_b32 s42, s4
v_smfmac_f32_16x16x64_bf16 v[8:11], v[218:221], v[68:75], v170
ds_read_b128 v[44:47], v0 offset:0
v_add_u32_sdwa v84, s42, v122 dst_sel:DWORD dst_unused:UNUSED_PAD src0_sel:DWORD src1_sel:WORD_0
v_smfmac_f32_16x16x64_bf16 v[12:15], v[186:189], v[60:67], v166 abid:1
ds_read_b128 v[48:51], v1 offset:0
v_add_u32_sdwa v85, s42, v122 dst_sel:DWORD dst_unused:UNUSED_PAD src0_sel:DWORD src1_sel:WORD_1
v_smfmac_f32_16x16x64_bf16 v[12:15], v[222:225], v[68:75], v170 abid:1
ds_read_b128 v[52:55], v0 offset:2048
v_add_u32_sdwa v86, s42, v123 dst_sel:DWORD dst_unused:UNUSED_PAD src0_sel:DWORD src1_sel:WORD_0
v_smfmac_f32_16x16x64_bf16 v[16:19], v[190:193], v[60:67], v167
ds_read_b128 v[56:59], v1 offset:2048
v_cvt_pk_bf16_f32 v92, v8, v9
v_smfmac_f32_16x16x64_bf16 v[16:19], v[226:229], v[68:75], v171
ds_read_u16 v76, v76
v_cvt_pk_bf16_f32 v93, v10, v11
v_smfmac_f32_16x16x64_bf16 v[20:23], v[194:197], v[60:67], v167 abid:1
ds_read_b128 v[8:11], v2 offset:1024
v_cvt_pk_bf16_f32 v94, v12, v13
v_smfmac_f32_16x16x64_bf16 v[20:23], v[230:233], v[68:75], v171 abid:1
ds_read_u16 v77, v77
v_cvt_pk_bf16_f32 v95, v14, v15
v_smfmac_f32_16x16x64_bf16 v[24:27], v[198:201], v[60:67], v168
ds_read_b128 v[12:15], v2 offset:1088
v_cvt_pk_bf16_f32 v96, v16, v17
v_smfmac_f32_16x16x64_bf16 v[24:27], v[234:237], v[68:75], v172
ds_read_u16 v78, v78
v_cvt_pk_bf16_f32 v97, v18, v19
v_smfmac_f32_16x16x64_bf16 v[28:31], v[202:205], v[60:67], v168 abid:1
ds_read_b128 v[16:19], v2 offset:1152
v_cvt_pk_bf16_f32 v98, v20, v21
v_smfmac_f32_16x16x64_bf16 v[28:31], v[238:241], v[68:75], v172 abid:1
ds_read_u16 v79, v79
v_cvt_pk_bf16_f32 v99, v22, v23
v_smfmac_f32_16x16x64_bf16 v[32:35], v[206:209], v[60:67], v169
ds_read_b128 v[20:23], v2 offset:1216
v_cvt_pk_bf16_f32 v100, v24, v25
v_smfmac_f32_16x16x64_bf16 v[32:35], v[242:245], v[68:75], v173
ds_read_u16 v80, v80
v_cvt_pk_bf16_f32 v101, v26, v27
v_smfmac_f32_16x16x64_bf16 v[36:39], v[210:213], v[60:67], v169 abid:1
ds_read_b128 v[24:27], v2 offset:1280
v_cvt_pk_bf16_f32 v102, v28, v29
v_smfmac_f32_16x16x64_bf16 v[36:39], v[246:249], v[68:75], v173 abid:1
ds_read_u16 v81, v81
v_cvt_pk_bf16_f32 v103, v30, v31
v_smfmac_f32_16x16x64_bf16 v[40:43], v[214:217], v[60:67], v177 abid:1
s_bitcmp1_b32 s85, s41
ds_read_b128 v[28:31], v2 offset:1344
v_cvt_pk_bf16_f32 v104, v32, v33
v_smfmac_f32_16x16x64_bf16 v[40:43], v[250:253], v[68:75], v178
s_waitcnt lgkmcnt(10)
v_cvt_pk_bf16_f32 v105, v34, v35
s_cbranch_scc1 L_loop
s_cmp_lg_u32 s41, 6
s_cbranch_scc1 L_loopn
.p2align 3
L_loopc:
v_smfmac_f32_16x16x64_bf16 v[8:11], a[0:3], v[44:51], v138
s_cmp_lt_u32 s56, s65
s_cselect_b32 s34, s34, 0
s_cselect_b32 s64, s64, 0
ds_read_b128 v[32:35], v2 offset:1408
v_cvt_pk_bf16_f32 v106, v36, v37
v_mov_b32 v7, 1
v_smfmac_f32_16x16x64_bf16 v[8:11], a[36:39], v[52:59], v142
s_waitcnt lgkmcnt(9)
buffer_atomic_add v7, v6, s[32:35], 0 offen sc0 sc1
v_cvt_pk_bf16_f32 v107, v38, v39
v_smfmac_f32_16x16x64_bf16 v[12:15], a[4:7], v[44:51], v138 abid:1
ds_read_b128 v[36:39], v2 offset:1472
v_cvt_pk_bf16_f32 v112, v40, v41
v_smfmac_f32_16x16x64_bf16 v[12:15], a[40:43], v[52:59], v142 abid:1
s_waitcnt lgkmcnt(8)
ds_read_b128 v[60:63], v0 offset:4096
v_cvt_pk_bf16_f32 v113, v42, v43
v_smfmac_f32_16x16x64_bf16 v[16:19], a[8:11], v[44:51], v139
s_cmp_eq_u32 s4, 129920
ds_read_b128 v[40:43], v2 offset:1536
v_cndmask_b32_dpp v108, v96, v92, vcc quad_perm:[1,0,3,2] row_mask:0xf bank_mask:0xf
v_smfmac_f32_16x16x64_bf16 v[16:19], a[44:47], v[52:59], v143
s_waitcnt lgkmcnt(8)
ds_read_u16 v82, v82
v_cndmask_b32_dpp v109, v97, v93, vcc quad_perm:[1,0,3,2] row_mask:0xf bank_mask:0xf
v_smfmac_f32_16x16x64_bf16 v[20:23], a[12:15], v[44:51], v139 abid:1
s_cselect_b32 s43, -129920, s5
ds_read_u16 v84, v84
v_cndmask_b32_dpp v110, v98, v94, vcc quad_perm:[1,0,3,2] row_mask:0xf bank_mask:0xf
v_smfmac_f32_16x16x64_bf16 v[20:23], a[48:51], v[52:59], v143 abid:1
s_waitcnt lgkmcnt(8)
ds_read_b128 v[64:67], v1 offset:4096
v_cndmask_b32_dpp v111, v99, v95, vcc quad_perm:[1,0,3,2] row_mask:0xf bank_mask:0xf
v_smfmac_f32_16x16x64_bf16 v[24:27], a[16:19], v[44:51], v140
s_add_u32 s4, s4, s43
ds_read_b128 v[68:71], v0 offset:6144
v_add_u32_sdwa v87, s42, v123 dst_sel:DWORD dst_unused:UNUSED_PAD src0_sel:DWORD src1_sel:WORD_1
v_smfmac_f32_16x16x64_bf16 v[24:27], a[52:55], v[52:59], v144
buffer_store_dwordx4 v[108:111], v4, s[20:23], s46 offen offset:0 sc1
s_mov_b64 vcc, s[82:83]
s_waitcnt lgkmcnt(8)
ds_read_b128 v[72:75], v1 offset:6144
v_cndmask_b32_dpp v96, v92, v96, vcc quad_perm:[1,0,3,2] row_mask:0xf bank_mask:0xf
v_cndmask_b32_dpp v97, v93, v97, vcc quad_perm:[1,0,3,2] row_mask:0xf bank_mask:0xf
v_smfmac_f32_16x16x64_bf16 v[28:31], a[20:23], v[44:51], v140 abid:1
s_add_u32 s7, s45, s58
ds_read_u16 v83, v83
v_cndmask_b32_dpp v98, v94, v98, vcc quad_perm:[1,0,3,2] row_mask:0xf bank_mask:0xf
v_smfmac_f32_16x16x64_bf16 v[28:31], a[56:59], v[52:59], v144 abid:1
s_waitcnt lgkmcnt(9)
ds_read_b128 v[114:117], v2 offset:64
v_cndmask_b32_dpp v99, v95, v99, vcc quad_perm:[1,0,3,2] row_mask:0xf bank_mask:0xf
v_smfmac_f32_16x16x64_bf16 v[32:35], a[24:27], v[44:51], v141
ds_read_u16 v85, v85
v_add_u32_sdwa v88, s42, v124 dst_sel:DWORD dst_unused:UNUSED_PAD src0_sel:DWORD src1_sel:WORD_0
v_smfmac_f32_16x16x64_bf16 v[32:35], a[60:63], v[52:59], v145
s_waitcnt lgkmcnt(10)
ds_read_u16 v86, v86
v_add_u32_sdwa v89, s42, v124 dst_sel:DWORD dst_unused:UNUSED_PAD src0_sel:DWORD src1_sel:WORD_1
v_smfmac_f32_16x16x64_bf16 v[36:39], a[28:31], v[44:51], v141 abid:1
ds_read_u16 v87, v87
v_add_u32_sdwa v90, s42, v125 dst_sel:DWORD dst_unused:UNUSED_PAD src0_sel:DWORD src1_sel:WORD_0
v_smfmac_f32_16x16x64_bf16 v[36:39], a[64:67], v[52:59], v145 abid:1
s_waitcnt lgkmcnt(10)
ds_read_u16 v88, v88
v_add_u32_sdwa v91, s42, v125 dst_sel:DWORD dst_unused:UNUSED_PAD src0_sel:DWORD src1_sel:WORD_1
v_smfmac_f32_16x16x64_bf16 v[40:43], a[32:35], v[44:51], v174
buffer_store_dwordx4 v[96:99], v4, s[20:23], s46 offen offset:1152 sc1
s_mov_b64 vcc, s[80:81]
ds_read_u16 v89, v89
v_cndmask_b32_dpp v92, v104, v100, vcc quad_perm:[1,0,3,2] row_mask:0xf bank_mask:0xf
v_cndmask_b32_dpp v93, v105, v101, vcc quad_perm:[1,0,3,2] row_mask:0xf bank_mask:0xf
v_smfmac_f32_16x16x64_bf16 v[40:43], a[68:71], v[52:59], v174 abid:1
s_waitcnt lgkmcnt(9)
ds_read_u16 v90, v90
v_cndmask_b32_dpp v94, v106, v102, vcc quad_perm:[1,0,3,2] row_mask:0xf bank_mask:0xf
v_smfmac_f32_16x16x64_bf16 v[8:11], a[72:75], v[60:67], v146
s_waitcnt lgkmcnt(8)
ds_read_u16 v91, v91
v_cndmask_b32_dpp v95, v107, v103, vcc quad_perm:[1,0,3,2] row_mask:0xf bank_mask:0xf
v_smfmac_f32_16x16x64_bf16 v[8:11], a[108:111], v[68:75], v150
s_waitcnt lgkmcnt(7)
ds_bpermute_b32 v112, v6, v112
v_smfmac_f32_16x16x64_bf16 v[8:11], v[114:117], v[76:83], v179
ds_bpermute_b32 v113, v6, v113
v_smfmac_f32_16x16x64_bf16 v[12:15], v[114:117], v[76:83], v179 abid:1
ds_read_b128 v[114:117], v2 offset:128
v_add_u32_sdwa v76, s42, v126 dst_sel:DWORD dst_unused:UNUSED_PAD src0_sel:DWORD src1_sel:WORD_0
v_smfmac_f32_16x16x64_bf16 v[12:15], a[76:79], v[60:67], v146 abid:1
ds_read_u16 v76, v76
v_add_u32_sdwa v77, s42, v126 dst_sel:DWORD dst_unused:UNUSED_PAD src0_sel:DWORD src1_sel:WORD_1
v_smfmac_f32_16x16x64_bf16 v[12:15], a[112:115], v[68:75], v150 abid:1
buffer_store_dwordx4 v[92:95], v4, s[20:23], s46 offen offset:128 sc1
s_mov_b64 vcc, s[82:83]
ds_read_u16 v77, v77
v_cndmask_b32_dpp v104, v100, v104, vcc quad_perm:[1,0,3,2] row_mask:0xf bank_mask:0xf
v_add_u32_sdwa v78, s42, v127 dst_sel:DWORD dst_unused:UNUSED_PAD src0_sel:DWORD src1_sel:WORD_0
v_smfmac_f32_16x16x64_bf16 v[24:27], a[88:91], v[60:67], v148
ds_read_u16 v78, v78
v_cndmask_b32_dpp v105, v101, v105, vcc quad_perm:[1,0,3,2] row_mask:0xf bank_mask:0xf
v_smfmac_f32_16x16x64_bf16 v[24:27], a[124:127], v[68:75], v152
ds_read_b128 v[44:47], v0 offset:8192
v_cndmask_b32_dpp v106, v102, v106, vcc quad_perm:[1,0,3,2] row_mask:0xf bank_mask:0xf
v_smfmac_f32_16x16x64_bf16 v[28:31], a[92:95], v[60:67], v148 abid:1
ds_read_b128 v[48:51], v1 offset:8192
v_add_u32_sdwa v79, s42, v127 dst_sel:DWORD dst_unused:UNUSED_PAD src0_sel:DWORD src1_sel:WORD_1
v_smfmac_f32_16x16x64_bf16 v[28:31], a[128:131], v[68:75], v152 abid:1
ds_read_u16 v79, v79
v_cndmask_b32_dpp v107, v103, v107, vcc quad_perm:[1,0,3,2] row_mask:0xf bank_mask:0xf
v_smfmac_f32_16x16x64_bf16 v[32:35], a[96:99], v[60:67], v149
ds_read_b128 v[52:55], v0 offset:10240
v_add_u32_sdwa v80, s42, v128 dst_sel:DWORD dst_unused:UNUSED_PAD src0_sel:DWORD src1_sel:WORD_0
v_smfmac_f32_16x16x64_bf16 v[32:35], a[132:135], v[68:75], v153
ds_read_u16 v80, v80
v_add_u32_sdwa v81, s42, v128 dst_sel:DWORD dst_unused:UNUSED_PAD src0_sel:DWORD src1_sel:WORD_1
v_smfmac_f32_16x16x64_bf16 v[16:19], a[80:83], v[60:67], v147
buffer_store_dwordx4 v[104:107], v4, s[20:23], s46 offen offset:1280 sc1
s_mov_b64 vcc, s[80:81]
ds_read_b128 v[56:59], v1 offset:10240
v_add_u32_sdwa v82, s42, v129 dst_sel:DWORD dst_unused:UNUSED_PAD src0_sel:DWORD src1_sel:WORD_0
v_add_u32_sdwa v83, s42, v129 dst_sel:DWORD dst_unused:UNUSED_PAD src0_sel:DWORD src1_sel:WORD_1
v_smfmac_f32_16x16x64_bf16 v[16:19], a[116:119], v[68:75], v151
s_waitcnt lgkmcnt(9)
ds_read_b128 v[92:95], v0 offset:12288
v_add_u32_sdwa v100, s42, v130 dst_sel:DWORD dst_unused:UNUSED_PAD src0_sel:DWORD src1_sel:WORD_0
v_smfmac_f32_16x16x64_bf16 v[16:19], v[114:117], v[84:91], v180 abid:1
ds_read_u16 v81, v81
v_add_u32_sdwa v101, s42, v130 dst_sel:DWORD dst_unused:UNUSED_PAD src0_sel:DWORD src1_sel:WORD_1
v_smfmac_f32_16x16x64_bf16 v[20:23], v[114:117], v[84:91], v181
ds_read_b128 v[96:99], v1 offset:12288
v_add_u32_sdwa v102, s42, v131 dst_sel:DWORD dst_unused:UNUSED_PAD src0_sel:DWORD src1_sel:WORD_0
v_smfmac_f32_16x16x64_bf16 v[20:23], a[84:87], v[60:67], v147 abid:1
ds_read_u16 v100, v100
v_add_u32_sdwa v103, s42, v131 dst_sel:DWORD dst_unused:UNUSED_PAD src0_sel:DWORD src1_sel:WORD_1
v_smfmac_f32_16x16x64_bf16 v[20:23], a[120:123], v[68:75], v151 abid:1
ds_read_u16 v82, v82
v_add_u32_sdwa v104, s42, v132 dst_sel:DWORD dst_unused:UNUSED_PAD src0_sel:DWORD src1_sel:WORD_0
v_smfmac_f32_16x16x64_bf16 v[36:39], a[100:103], v[60:67], v149 abid:1
ds_read_u16 v101, v101
v_add_u32_sdwa v105, s42, v132 dst_sel:DWORD dst_unused:UNUSED_PAD src0_sel:DWORD src1_sel:WORD_1
v_smfmac_f32_16x16x64_bf16 v[36:39], a[136:139], v[68:75], v153 abid:1
buffer_store_dwordx2 v[112:113], v5, s[20:23], s46 offen nt
ds_read_u16 v83, v83
v_add_u32_sdwa v106, s42, v133 dst_sel:DWORD dst_unused:UNUSED_PAD src0_sel:DWORD src1_sel:WORD_0
v_smfmac_f32_16x16x64_bf16 v[40:43], a[104:107], v[60:67], v175
s_mov_b32 s46, s48
ds_read_b128 v[114:117], v2 offset:192
v_add_u32_sdwa v107, s42, v133 dst_sel:DWORD dst_unused:UNUSED_PAD src0_sel:DWORD src1_sel:WORD_1
v_smfmac_f32_16x16x64_bf16 v[40:43], a[140:143], v[68:75], v175 abid:1
s_waitcnt lgkmcnt(12)
ds_read_u16 v102, v102
v_add_u32_sdwa v84, s42, v134 dst_sel:DWORD dst_unused:UNUSED_PAD src0_sel:DWORD src1_sel:WORD_0
v_smfmac_f32_16x16x64_bf16 v[8:11], a[144:147], v[44:51], v154
s_waitcnt lgkmcnt(9)
ds_read_u16 v103, v103
v_add_u32_sdwa v85, s42, v134 dst_sel:DWORD dst_unused:UNUSED_PAD src0_sel:DWORD src1_sel:WORD_1
v_smfmac_f32_16x16x64_bf16 v[8:11], a[180:183], v[52:59], v158
s_waitcnt lgkmcnt(7)
ds_read_u16 v104, v104
v_add_u32_sdwa v86, s42, v135 dst_sel:DWORD dst_unused:UNUSED_PAD src0_sel:DWORD src1_sel:WORD_0
v_smfmac_f32_16x16x64_bf16 v[8:11], a[216:219], v[92:99], v162
s_mov_b32 s48, s49
ds_read_u16 v105, v105
v_add_u32_sdwa v87, s42, v135 dst_sel:DWORD dst_unused:UNUSED_PAD src0_sel:DWORD src1_sel:WORD_1
v_smfmac_f32_16x16x64_bf16 v[24:27], a[160:163], v[44:51], v156
s_add_u32 m0, s44, 0
ds_read_u16 v106, v106
v_add_u32_sdwa v88, s42, v136 dst_sel:DWORD dst_unused:UNUSED_PAD src0_sel:DWORD src1_sel:WORD_0
v_smfmac_f32_16x16x64_bf16 v[24:27], a[196:199], v[52:59], v160
buffer_load_dwordx4 v3, s[16:19], s45 offen offset:0 nt lds
v_add_u32_sdwa v89, s42, v136 dst_sel:DWORD dst_unused:UNUSED_PAD src0_sel:DWORD src1_sel:WORD_1
v_smfmac_f32_16x16x64_bf16 v[24:27], a[232:235], v[92:99], v164
s_waitcnt lgkmcnt(5)
ds_read_u16 v107, v107
v_add_u32_sdwa v90, s42, v137 dst_sel:DWORD dst_unused:UNUSED_PAD src0_sel:DWORD src1_sel:WORD_0
v_smfmac_f32_16x16x64_bf16 v[24:27], v[114:117], v[76:83], v182
s_mov_b32 s49, s50
ds_read_u16 v84, v84
v_add_u32_sdwa v91, s42, v137 dst_sel:DWORD dst_unused:UNUSED_PAD src0_sel:DWORD src1_sel:WORD_1
v_smfmac_f32_16x16x64_bf16 v[28:31], v[114:117], v[76:83], v182 abid:1
s_mov_b32 s50, s45
ds_read_b128 v[114:117], v2 offset:256
v_add_u32_sdwa v76, s4, v118 dst_sel:DWORD dst_unused:UNUSED_PAD src0_sel:DWORD src1_sel:WORD_0
v_smfmac_f32_16x16x64_bf16 v[28:31], a[164:167], v[44:51], v156 abid:1
ds_read_u16 v85, v85
v_add_u32_sdwa v77, s4, v118 dst_sel:DWORD dst_unused:UNUSED_PAD src0_sel:DWORD src1_sel:WORD_1
v_smfmac_f32_16x16x64_bf16 v[28:31], a[200:203], v[52:59], v160 abid:1
ds_read_u16 v86, v86
v_add_u32_sdwa v78, s4, v119 dst_sel:DWORD dst_unused:UNUSED_PAD src0_sel:DWORD src1_sel:WORD_0
v_smfmac_f32_16x16x64_bf16 v[28:31], a[236:239], v[92:99], v164 abid:1
ds_read_u16 v87, v87
v_add_u32_sdwa v79, s4, v119 dst_sel:DWORD dst_unused:UNUSED_PAD src0_sel:DWORD src1_sel:WORD_1
v_smfmac_f32_16x16x64_bf16 v[12:15], a[148:151], v[44:51], v154 abid:1
s_add_u32 m0, s44, 3840
ds_read_u16 v88, v88
v_add_u32_sdwa v80, s4, v120 dst_sel:DWORD dst_unused:UNUSED_PAD src0_sel:DWORD src1_sel:WORD_0
v_smfmac_f32_16x16x64_bf16 v[12:15], a[184:187], v[52:59], v158 abid:1
buffer_load_dwordx4 v3, s[16:19], s45 offen offset:256 nt lds
v_add_u32_sdwa v81, s4, v120 dst_sel:DWORD dst_unused:UNUSED_PAD src0_sel:DWORD src1_sel:WORD_1
v_smfmac_f32_16x16x64_bf16 v[12:15], a[220:223], v[92:99], v162 abid:1
ds_read_b128 v[60:63], v0 offset:14336
v_add_u32_sdwa v82, s4, v121 dst_sel:DWORD dst_unused:UNUSED_PAD src0_sel:DWORD src1_sel:WORD_0
v_smfmac_f32_16x16x64_bf16 v[32:35], a[168:171], v[44:51], v157
s_waitcnt vmcnt(7)
ds_read_u16 v89, v89
v_add_u32_sdwa v83, s4, v121 dst_sel:DWORD dst_unused:UNUSED_PAD src0_sel:DWORD src1_sel:WORD_1
v_smfmac_f32_16x16x64_bf16 v[32:35], a[204:207], v[52:59], v161
ds_read_b128 v[64:67], v1 offset:14336
v_smfmac_f32_16x16x64_bf16 v[32:35], a[240:243], v[92:99], v165
s_waitcnt lgkmcnt(7)
ds_read_b128 v[68:71], v0 offset:16384
v_smfmac_f32_16x16x64_bf16 v[32:35], v[114:117], v[100:107], v183 abid:1
ds_read_u16 v90, v90
v_smfmac_f32_16x16x64_bf16 v[36:39], v[114:117], v[100:107], v184
ds_read_b128 v[72:75], v1 offset:16384
v_add_u32 v0, s43, v0
v_smfmac_f32_16x16x64_bf16 v[36:39], a[172:175], v[44:51], v157 abid:1
s_add_u32 m0, s44, 7680
ds_read_u16 v91, v91
v_add_u32 v1, s43, v1
v_smfmac_f32_16x16x64_bf16 v[36:39], a[208:211], v[52:59], v161 abid:1
buffer_load_dwordx4 v3, s[16:19], s45 offen offset:512 nt lds
v_smfmac_f32_16x16x64_bf16 v[36:39], a[244:247], v[92:99], v165 abid:1
ds_read_b128 v[114:117], v2 offset:320
v_smfmac_f32_16x16x64_bf16 v[16:19], a[152:155], v[44:51], v155
s_add_u32 m0, s44, 11520
v_smfmac_f32_16x16x64_bf16 v[16:19], a[188:191], v[52:59], v159
buffer_load_dwordx4 v3, s[16:19], s45 offen offset:768 nt lds
v_smfmac_f32_16x16x64_bf16 v[16:19], a[224:227], v[92:99], v163
s_mov_b64 exec, s[62:63]
ds_write_b32 v0, v7 offset:18432
s_mov_b64 exec, -1
v_smfmac_f32_16x16x64_bf16 v[20:23], a[156:159], v[44:51], v155 abid:1
s_add_u32 m0, s44, s8
v_smfmac_f32_16x16x64_bf16 v[20:23], a[192:195], v[52:59], v159 abid:1
s_mov_b64 exec, s[10:11]
buffer_load_dwordx4 v3, s[16:19], s7 offen offset:896 nt lds
s_mov_b64 exec, -1
v_smfmac_f32_16x16x64_bf16 v[20:23], a[228:231], v[92:99], v163 abid:1
s_add_u32 s44, s44, s5
s_cmp_ge_u32 s44, 148480
s_cselect_b32 s44, s9, s44
v_smfmac_f32_16x16x64_bf16 v[40:43], a[176:179], v[44:51], v176
v_smfmac_f32_16x16x64_bf16 v[40:43], a[212:215], v[52:59], v176 abid:1
v_smfmac_f32_16x16x64_bf16 v[40:43], a[248:251], v[92:99], v177
s_waitcnt lgkmcnt(0)
v_smfmac_f32_16x16x64_bf16 v[40:43], v[114:117], v[84:91], v185
s_barrier
v_smfmac_f32_16x16x64_bf16 v[8:11], a[252:255], v[60:67], v166
s_mov_b32 s42, s4
ds_read_b32 v7, v0 offset:18432
v_smfmac_f32_16x16x64_bf16 v[8:11], v[218:221], v[68:75], v170
ds_read_b128 v[44:47], v0 offset:0
v_add_u32_sdwa v84, s42, v122 dst_sel:DWORD dst_unused:UNUSED_PAD src0_sel:DWORD src1_sel:WORD_0
v_smfmac_f32_16x16x64_bf16 v[12:15], v[186:189], v[60:67], v166 abid:1
ds_read_b128 v[48:51], v1 offset:0
v_add_u32_sdwa v85, s42, v122 dst_sel:DWORD dst_unused:UNUSED_PAD src0_sel:DWORD src1_sel:WORD_1
v_smfmac_f32_16x16x64_bf16 v[12:15], v[222:225], v[68:75], v170 abid:1
ds_read_b128 v[52:55], v0 offset:2048
v_add_u32_sdwa v86, s42, v123 dst_sel:DWORD dst_unused:UNUSED_PAD src0_sel:DWORD src1_sel:WORD_0
v_smfmac_f32_16x16x64_bf16 v[16:19], v[190:193], v[60:67], v167
ds_read_b128 v[56:59], v1 offset:2048
v_cvt_pk_bf16_f32 v92, v8, v9
v_smfmac_f32_16x16x64_bf16 v[16:19], v[226:229], v[68:75], v171
ds_read_u16 v76, v76
v_cvt_pk_bf16_f32 v93, v10, v11
v_smfmac_f32_16x16x64_bf16 v[20:23], v[194:197], v[60:67], v167 abid:1
ds_read_b128 v[8:11], v2 offset:1024
v_cvt_pk_bf16_f32 v94, v12, v13
v_smfmac_f32_16x16x64_bf16 v[20:23], v[230:233], v[68:75], v171 abid:1
ds_read_u16 v77, v77
v_cvt_pk_bf16_f32 v95, v14, v15
v_smfmac_f32_16x16x64_bf16 v[24:27], v[198:201], v[60:67], v168
ds_read_b128 v[12:15], v2 offset:1088
v_cvt_pk_bf16_f32 v96, v16, v17
v_smfmac_f32_16x16x64_bf16 v[24:27], v[234:237], v[68:75], v172
s_waitcnt lgkmcnt(8)
ds_read_u16 v78, v78
v_cvt_pk_bf16_f32 v97, v18, v19
v_readfirstlane_b32 s56, v7
v_smfmac_f32_16x16x64_bf16 v[28:31], v[202:205], v[60:67], v168 abid:1
s_lshr_b32 s60, s56, 4
ds_read_b128 v[16:19], v2 offset:1152
v_cvt_pk_bf16_f32 v98, v20, v21
v_smfmac_f32_16x16x64_bf16 v[28:31], v[238:241], v[68:75], v172 abid:1
s_mul_i32 s60, s60, 884736
ds_read_u16 v79, v79
v_cvt_pk_bf16_f32 v99, v22, v23
v_smfmac_f32_16x16x64_bf16 v[32:35], v[206:209], v[60:67], v169
s_mul_i32 s61, s56, 18432
ds_read_b128 v[20:23], v2 offset:1216
v_cvt_pk_bf16_f32 v100, v24, v25
v_smfmac_f32_16x16x64_bf16 v[32:35], v[242:245], v[68:75], v173
s_add_u32 s60, s60, s57
ds_read_u16 v80, v80
v_cvt_pk_bf16_f32 v101, v26, v27
v_smfmac_f32_16x16x64_bf16 v[36:39], v[210:213], v[60:67], v169 abid:1
s_add_u32 s45, s60, s61
ds_read_b128 v[24:27], v2 offset:1280
v_cvt_pk_bf16_f32 v102, v28, v29
v_smfmac_f32_16x16x64_bf16 v[36:39], v[246:249], v[68:75], v173 abid:1
ds_read_u16 v81, v81
v_cvt_pk_bf16_f32 v103, v30, v31
v_smfmac_f32_16x16x64_bf16 v[40:43], v[214:217], v[60:67], v177 abid:1
s_cmp_lt_u32 s56, s64
ds_read_b128 v[28:31], v2 offset:1344
v_cvt_pk_bf16_f32 v104, v32, v33
v_smfmac_f32_16x16x64_bf16 v[40:43], v[250:253], v[68:75], v178
s_waitcnt lgkmcnt(10)
v_cvt_pk_bf16_f32 v105, v34, v35
s_cbranch_scc1 L_loopc
s_mov_b32 s41, 0
s_mov_b32 s15, 3
s_mov_b32 s12, 7
s_mov_b32 s92, 4
s_mov_b32 s87, 4
s_mov_b32 s59, -1
.p2align 3
L_loopn:
v_smfmac_f32_16x16x64_bf16 v[8:11], a[0:3], v[44:51], v138
ds_read_b128 v[32:35], v2 offset:1408
v_cvt_pk_bf16_f32 v106, v36, v37
v_smfmac_f32_16x16x64_bf16 v[8:11], a[36:39], v[52:59], v142
s_waitcnt lgkmcnt(9)
v_cvt_pk_bf16_f32 v107, v38, v39
v_smfmac_f32_16x16x64_bf16 v[12:15], a[4:7], v[44:51], v138 abid:1
ds_read_b128 v[36:39], v2 offset:1472
v_cvt_pk_bf16_f32 v112, v40, v41
v_smfmac_f32_16x16x64_bf16 v[12:15], a[40:43], v[52:59], v142 abid:1
s_waitcnt lgkmcnt(8)
ds_read_b128 v[60:63], v0 offset:4096
v_cvt_pk_bf16_f32 v113, v42, v43
v_smfmac_f32_16x16x64_bf16 v[16:19], a[8:11], v[44:51], v139
s_cmp_eq_u32 s4, 129920
ds_read_b128 v[40:43], v2 offset:1536
v_cndmask_b32_dpp v108, v96, v92, vcc quad_perm:[1,0,3,2] row_mask:0xf bank_mask:0xf
v_smfmac_f32_16x16x64_bf16 v[16:19], a[44:47], v[52:59], v143
s_waitcnt lgkmcnt(8)
ds_read_u16 v82, v82
v_cndmask_b32_dpp v109, v97, v93, vcc quad_perm:[1,0,3,2] row_mask:0xf bank_mask:0xf
v_smfmac_f32_16x16x64_bf16 v[20:23], a[12:15], v[44:51], v139 abid:1
s_cselect_b32 s43, -129920, s5
ds_read_u16 v84, v84
v_cndmask_b32_dpp v110, v98, v94, vcc quad_perm:[1,0,3,2] row_mask:0xf bank_mask:0xf
v_smfmac_f32_16x16x64_bf16 v[20:23], a[48:51], v[52:59], v143 abid:1
s_waitcnt lgkmcnt(8)
ds_read_b128 v[64:67], v1 offset:4096
v_cndmask_b32_dpp v111, v99, v95, vcc quad_perm:[1,0,3,2] row_mask:0xf bank_mask:0xf
v_smfmac_f32_16x16x64_bf16 v[24:27], a[16:19], v[44:51], v140
s_add_u32 s4, s4, s43
ds_read_b128 v[68:71], v0 offset:6144
v_add_u32_sdwa v87, s42, v123 dst_sel:DWORD dst_unused:UNUSED_PAD src0_sel:DWORD src1_sel:WORD_1
v_smfmac_f32_16x16x64_bf16 v[24:27], a[52:55], v[52:59], v144
buffer_store_dwordx4 v[108:111], v4, s[20:23], s46 offen offset:0 sc1
s_mov_b64 vcc, s[82:83]
s_waitcnt lgkmcnt(8)
ds_read_b128 v[72:75], v1 offset:6144
v_cndmask_b32_dpp v96, v92, v96, vcc quad_perm:[1,0,3,2] row_mask:0xf bank_mask:0xf
v_cndmask_b32_dpp v97, v93, v97, vcc quad_perm:[1,0,3,2] row_mask:0xf bank_mask:0xf
v_smfmac_f32_16x16x64_bf16 v[28:31], a[20:23], v[44:51], v140 abid:1
s_add_u32 s41, s41, 1
ds_read_u16 v83, v83
v_cndmask_b32_dpp v98, v94, v98, vcc quad_perm:[1,0,3,2] row_mask:0xf bank_mask:0xf
v_smfmac_f32_16x16x64_bf16 v[28:31], a[56:59], v[52:59], v144 abid:1
s_waitcnt lgkmcnt(9)
ds_read_b128 v[114:117], v2 offset:64
v_cndmask_b32_dpp v99, v95, v99, vcc quad_perm:[1,0,3,2] row_mask:0xf bank_mask:0xf
v_smfmac_f32_16x16x64_bf16 v[32:35], a[24:27], v[44:51], v141
ds_read_u16 v85, v85
v_add_u32_sdwa v88, s42, v124 dst_sel:DWORD dst_unused:UNUSED_PAD src0_sel:DWORD src1_sel:WORD_0
v_smfmac_f32_16x16x64_bf16 v[32:35], a[60:63], v[52:59], v145
s_waitcnt lgkmcnt(10)
ds_read_u16 v86, v86
v_add_u32_sdwa v89, s42, v124 dst_sel:DWORD dst_unused:UNUSED_PAD src0_sel:DWORD src1_sel:WORD_1
v_smfmac_f32_16x16x64_bf16 v[36:39], a[28:31], v[44:51], v141 abid:1
ds_read_u16 v87, v87
v_add_u32_sdwa v90, s42, v125 dst_sel:DWORD dst_unused:UNUSED_PAD src0_sel:DWORD src1_sel:WORD_0
v_smfmac_f32_16x16x64_bf16 v[36:39], a[64:67], v[52:59], v145 abid:1
s_waitcnt lgkmcnt(10)
ds_read_u16 v88, v88
v_add_u32_sdwa v91, s42, v125 dst_sel:DWORD dst_unused:UNUSED_PAD src0_sel:DWORD src1_sel:WORD_1
v_smfmac_f32_16x16x64_bf16 v[40:43], a[32:35], v[44:51], v174
buffer_store_dwordx4 v[96:99], v4, s[20:23], s46 offen offset:1152 sc1
s_mov_b64 vcc, s[80:81]
ds_read_u16 v89, v89
v_cndmask_b32_dpp v92, v104, v100, vcc quad_perm:[1,0,3,2] row_mask:0xf bank_mask:0xf
v_cndmask_b32_dpp v93, v105, v101, vcc quad_perm:[1,0,3,2] row_mask:0xf bank_mask:0xf
v_smfmac_f32_16x16x64_bf16 v[40:43], a[68:71], v[52:59], v174 abid:1
s_waitcnt lgkmcnt(9)
ds_read_u16 v90, v90
v_cndmask_b32_dpp v94, v106, v102, vcc quad_perm:[1,0,3,2] row_mask:0xf bank_mask:0xf
v_smfmac_f32_16x16x64_bf16 v[8:11], a[72:75], v[60:67], v146
s_waitcnt lgkmcnt(8)
ds_read_u16 v91, v91
v_cndmask_b32_dpp v95, v107, v103, vcc quad_perm:[1,0,3,2] row_mask:0xf bank_mask:0xf
v_smfmac_f32_16x16x64_bf16 v[8:11], a[108:111], v[68:75], v150
s_waitcnt lgkmcnt(7)
ds_bpermute_b32 v112, v6, v112
v_smfmac_f32_16x16x64_bf16 v[8:11], v[114:117], v[76:83], v179
ds_bpermute_b32 v113, v6, v113
v_smfmac_f32_16x16x64_bf16 v[12:15], v[114:117], v[76:83], v179 abid:1
ds_read_b128 v[114:117], v2 offset:128
v_add_u32_sdwa v76, s42, v126 dst_sel:DWORD dst_unused:UNUSED_PAD src0_sel:DWORD src1_sel:WORD_0
v_smfmac_f32_16x16x64_bf16 v[12:15], a[76:79], v[60:67], v146 abid:1
ds_read_u16 v76, v76
v_add_u32_sdwa v77, s42, v126 dst_sel:DWORD dst_unused:UNUSED_PAD src0_sel:DWORD src1_sel:WORD_1
v_smfmac_f32_16x16x64_bf16 v[12:15], a[112:115], v[68:75], v150 abid:1
buffer_store_dwordx4 v[92:95], v4, s[20:23], s46 offen offset:128 sc1
s_mov_b64 vcc, s[82:83]
ds_read_u16 v77, v77
v_cndmask_b32_dpp v104, v100, v104, vcc quad_perm:[1,0,3,2] row_mask:0xf bank_mask:0xf
v_add_u32_sdwa v78, s42, v127 dst_sel:DWORD dst_unused:UNUSED_PAD src0_sel:DWORD src1_sel:WORD_0
v_smfmac_f32_16x16x64_bf16 v[24:27], a[88:91], v[60:67], v148
ds_read_u16 v78, v78
v_cndmask_b32_dpp v105, v101, v105, vcc quad_perm:[1,0,3,2] row_mask:0xf bank_mask:0xf
v_smfmac_f32_16x16x64_bf16 v[24:27], a[124:127], v[68:75], v152
ds_read_b128 v[44:47], v0 offset:8192
v_cndmask_b32_dpp v106, v102, v106, vcc quad_perm:[1,0,3,2] row_mask:0xf bank_mask:0xf
v_smfmac_f32_16x16x64_bf16 v[28:31], a[92:95], v[60:67], v148 abid:1
ds_read_b128 v[48:51], v1 offset:8192
v_add_u32_sdwa v79, s42, v127 dst_sel:DWORD dst_unused:UNUSED_PAD src0_sel:DWORD src1_sel:WORD_1
v_smfmac_f32_16x16x64_bf16 v[28:31], a[128:131], v[68:75], v152 abid:1
ds_read_u16 v79, v79
v_cndmask_b32_dpp v107, v103, v107, vcc quad_perm:[1,0,3,2] row_mask:0xf bank_mask:0xf
v_smfmac_f32_16x16x64_bf16 v[32:35], a[96:99], v[60:67], v149
ds_read_b128 v[52:55], v0 offset:10240
v_add_u32_sdwa v80, s42, v128 dst_sel:DWORD dst_unused:UNUSED_PAD src0_sel:DWORD src1_sel:WORD_0
v_smfmac_f32_16x16x64_bf16 v[32:35], a[132:135], v[68:75], v153
ds_read_u16 v80, v80
v_add_u32_sdwa v81, s42, v128 dst_sel:DWORD dst_unused:UNUSED_PAD src0_sel:DWORD src1_sel:WORD_1
v_smfmac_f32_16x16x64_bf16 v[16:19], a[80:83], v[60:67], v147
buffer_store_dwordx4 v[104:107], v4, s[20:23], s46 offen offset:1280 sc1
s_mov_b64 vcc, s[80:81]
ds_read_b128 v[56:59], v1 offset:10240
v_add_u32_sdwa v82, s42, v129 dst_sel:DWORD dst_unused:UNUSED_PAD src0_sel:DWORD src1_sel:WORD_0
v_add_u32_sdwa v83, s42, v129 dst_sel:DWORD dst_unused:UNUSED_PAD src0_sel:DWORD src1_sel:WORD_1
v_smfmac_f32_16x16x64_bf16 v[16:19], a[116:119], v[68:75], v151
s_waitcnt lgkmcnt(9)
ds_read_b128 v[92:95], v0 offset:12288
v_add_u32_sdwa v100, s42, v130 dst_sel:DWORD dst_unused:UNUSED_PAD src0_sel:DWORD src1_sel:WORD_0
v_smfmac_f32_16x16x64_bf16 v[16:19], v[114:117], v[84:91], v180 abid:1
ds_read_u16 v81, v81
v_add_u32_sdwa v101, s42, v130 dst_sel:DWORD dst_unused:UNUSED_PAD src0_sel:DWORD src1_sel:WORD_1
v_smfmac_f32_16x16x64_bf16 v[20:23], v[114:117], v[84:91], v181
ds_read_b128 v[96:99], v1 offset:12288
v_add_u32_sdwa v102, s42, v131 dst_sel:DWORD dst_unused:UNUSED_PAD src0_sel:DWORD src1_sel:WORD_0
v_smfmac_f32_16x16x64_bf16 v[20:23], a[84:87], v[60:67], v147 abid:1
ds_read_u16 v100, v100
v_add_u32_sdwa v103, s42, v131 dst_sel:DWORD dst_unused:UNUSED_PAD src0_sel:DWORD src1_sel:WORD_1
v_smfmac_f32_16x16x64_bf16 v[20:23], a[120:123], v[68:75], v151 abid:1
ds_read_u16 v82, v82
v_add_u32_sdwa v104, s42, v132 dst_sel:DWORD dst_unused:UNUSED_PAD src0_sel:DWORD src1_sel:WORD_0
v_smfmac_f32_16x16x64_bf16 v[36:39], a[100:103], v[60:67], v149 abid:1
ds_read_u16 v101, v101
v_add_u32_sdwa v105, s42, v132 dst_sel:DWORD dst_unused:UNUSED_PAD src0_sel:DWORD src1_sel:WORD_1
v_smfmac_f32_16x16x64_bf16 v[36:39], a[136:139], v[68:75], v153 abid:1
buffer_store_dwordx2 v[112:113], v5, s[20:23], s46 offen nt
ds_read_u16 v83, v83
v_add_u32_sdwa v106, s42, v133 dst_sel:DWORD dst_unused:UNUSED_PAD src0_sel:DWORD src1_sel:WORD_0
v_smfmac_f32_16x16x64_bf16 v[40:43], a[104:107], v[60:67], v175
s_mov_b32 s22, 75497472
ds_read_b128 v[114:117], v2 offset:192
v_add_u32_sdwa v107, s42, v133 dst_sel:DWORD dst_unused:UNUSED_PAD src0_sel:DWORD src1_sel:WORD_1
v_smfmac_f32_16x16x64_bf16 v[40:43], a[140:143], v[68:75], v175 abid:1
s_waitcnt lgkmcnt(12)
ds_read_u16 v102, v102
v_add_u32_sdwa v84, s42, v134 dst_sel:DWORD dst_unused:UNUSED_PAD src0_sel:DWORD src1_sel:WORD_0
v_smfmac_f32_16x16x64_bf16 v[8:11], a[144:147], v[44:51], v154
s_waitcnt lgkmcnt(9)
ds_read_u16 v103, v103
v_add_u32_sdwa v85, s42, v134 dst_sel:DWORD dst_unused:UNUSED_PAD src0_sel:DWORD src1_sel:WORD_1
v_smfmac_f32_16x16x64_bf16 v[8:11], a[180:183], v[52:59], v158
s_waitcnt lgkmcnt(7)
ds_read_u16 v104, v104
v_add_u32_sdwa v86, s42, v135 dst_sel:DWORD dst_unused:UNUSED_PAD src0_sel:DWORD src1_sel:WORD_0
v_smfmac_f32_16x16x64_bf16 v[8:11], a[216:219], v[92:99], v162
s_mov_b32 s46, s48
ds_read_u16 v105, v105
v_add_u32_sdwa v87, s42, v135 dst_sel:DWORD dst_unused:UNUSED_PAD src0_sel:DWORD src1_sel:WORD_1
v_smfmac_f32_16x16x64_bf16 v[24:27], a[160:163], v[44:51], v156
s_mov_b32 s48, s49
ds_read_u16 v106, v106
v_add_u32_sdwa v88, s42, v136 dst_sel:DWORD dst_unused:UNUSED_PAD src0_sel:DWORD src1_sel:WORD_0
v_smfmac_f32_16x16x64_bf16 v[24:27], a[196:199], v[52:59], v160
s_mov_b32 s49, s50
s_add_u32 s50, s50, 4718592
v_add_u32_sdwa v89, s42, v136 dst_sel:DWORD dst_unused:UNUSED_PAD src0_sel:DWORD src1_sel:WORD_1
v_smfmac_f32_16x16x64_bf16 v[24:27], a[232:235], v[92:99], v164
s_waitcnt lgkmcnt(5)
ds_read_u16 v107, v107
v_add_u32_sdwa v90, s42, v137 dst_sel:DWORD dst_unused:UNUSED_PAD src0_sel:DWORD src1_sel:WORD_0
v_smfmac_f32_16x16x64_bf16 v[24:27], v[114:117], v[76:83], v182
ds_read_u16 v84, v84
v_add_u32_sdwa v91, s42, v137 dst_sel:DWORD dst_unused:UNUSED_PAD src0_sel:DWORD src1_sel:WORD_1
v_smfmac_f32_16x16x64_bf16 v[28:31], v[114:117], v[76:83], v182 abid:1
ds_read_b128 v[114:117], v2 offset:256
v_add_u32_sdwa v76, s4, v118 dst_sel:DWORD dst_unused:UNUSED_PAD src0_sel:DWORD src1_sel:WORD_0
v_smfmac_f32_16x16x64_bf16 v[28:31], a[164:167], v[44:51], v156 abid:1
ds_read_u16 v85, v85
v_add_u32_sdwa v77, s4, v118 dst_sel:DWORD dst_unused:UNUSED_PAD src0_sel:DWORD src1_sel:WORD_1
v_smfmac_f32_16x16x64_bf16 v[28:31], a[200:203], v[52:59], v160 abid:1
ds_read_u16 v86, v86
v_add_u32_sdwa v78, s4, v119 dst_sel:DWORD dst_unused:UNUSED_PAD src0_sel:DWORD src1_sel:WORD_0
v_smfmac_f32_16x16x64_bf16 v[28:31], a[236:239], v[92:99], v164 abid:1
ds_read_u16 v87, v87
v_add_u32_sdwa v79, s4, v119 dst_sel:DWORD dst_unused:UNUSED_PAD src0_sel:DWORD src1_sel:WORD_1
v_smfmac_f32_16x16x64_bf16 v[12:15], a[148:151], v[44:51], v154 abid:1
ds_read_u16 v88, v88
v_add_u32_sdwa v80, s4, v120 dst_sel:DWORD dst_unused:UNUSED_PAD src0_sel:DWORD src1_sel:WORD_0
v_smfmac_f32_16x16x64_bf16 v[12:15], a[184:187], v[52:59], v158 abid:1
v_add_u32_sdwa v81, s4, v120 dst_sel:DWORD dst_unused:UNUSED_PAD src0_sel:DWORD src1_sel:WORD_1
v_smfmac_f32_16x16x64_bf16 v[12:15], a[220:223], v[92:99], v162 abid:1
ds_read_b128 v[60:63], v0 offset:14336
v_add_u32_sdwa v82, s4, v121 dst_sel:DWORD dst_unused:UNUSED_PAD src0_sel:DWORD src1_sel:WORD_0
v_smfmac_f32_16x16x64_bf16 v[32:35], a[168:171], v[44:51], v157
ds_read_u16 v89, v89
v_add_u32_sdwa v83, s4, v121 dst_sel:DWORD dst_unused:UNUSED_PAD src0_sel:DWORD src1_sel:WORD_1
v_smfmac_f32_16x16x64_bf16 v[32:35], a[204:207], v[52:59], v161
ds_read_b128 v[64:67], v1 offset:14336
v_smfmac_f32_16x16x64_bf16 v[32:35], a[240:243], v[92:99], v165
s_waitcnt lgkmcnt(7)
ds_read_b128 v[68:71], v0 offset:16384
v_smfmac_f32_16x16x64_bf16 v[32:35], v[114:117], v[100:107], v183 abid:1
ds_read_u16 v90, v90
v_smfmac_f32_16x16x64_bf16 v[36:39], v[114:117], v[100:107], v184
ds_read_b128 v[72:75], v1 offset:16384
v_add_u32 v0, s43, v0
v_smfmac_f32_16x16x64_bf16 v[36:39], a[172:175], v[44:51], v157 abid:1
ds_read_u16 v91, v91
v_add_u32 v1, s43, v1
v_smfmac_f32_16x16x64_bf16 v[36:39], a[208:211], v[52:59], v161 abid:1
v_smfmac_f32_16x16x64_bf16 v[36:39], a[244:247], v[92:99], v165 abid:1
ds_read_b128 v[114:117], v2 offset:320
v_smfmac_f32_16x16x64_bf16 v[16:19], a[152:155], v[44:51], v155
v_smfmac_f32_16x16x64_bf16 v[16:19], a[188:191], v[52:59], v159
v_smfmac_f32_16x16x64_bf16 v[16:19], a[224:227], v[92:99], v163
v_smfmac_f32_16x16x64_bf16 v[20:23], a[156:159], v[44:51], v155 abid:1
v_smfmac_f32_16x16x64_bf16 v[20:23], a[192:195], v[52:59], v159 abid:1
v_smfmac_f32_16x16x64_bf16 v[20:23], a[228:231], v[92:99], v163 abid:1
v_smfmac_f32_16x16x64_bf16 v[40:43], a[176:179], v[44:51], v176
s_bitcmp1_b32 s92, s41
v_smfmac_f32_16x16x64_bf16 v[40:43], a[212:215], v[52:59], v176 abid:1
s_cbranch_scc1 L_loopn_w
L_loopn_wb:
v_smfmac_f32_16x16x64_bf16 v[40:43], a[248:251], v[92:99], v177
s_waitcnt lgkmcnt(0)
v_smfmac_f32_16x16x64_bf16 v[40:43], v[114:117], v[84:91], v185
L_loopn_p3:
v_smfmac_f32_16x16x64_bf16 v[8:11], a[252:255], v[60:67], v166
s_mov_b32 s42, s4
v_smfmac_f32_16x16x64_bf16 v[8:11], v[218:221], v[68:75], v170
ds_read_b128 v[44:47], v0 offset:0
v_add_u32_sdwa v84, s42, v122 dst_sel:DWORD dst_unused:UNUSED_PAD src0_sel:DWORD src1_sel:WORD_0
v_smfmac_f32_16x16x64_bf16 v[12:15], v[186:189], v[60:67], v166 abid:1
ds_read_b128 v[48:51], v1 offset:0
v_add_u32_sdwa v85, s42, v122 dst_sel:DWORD dst_unused:UNUSED_PAD src0_sel:DWORD src1_sel:WORD_1
v_smfmac_f32_16x16x64_bf16 v[12:15], v[222:225], v[68:75], v170 abid:1
ds_read_b128 v[52:55], v0 offset:2048
v_add_u32_sdwa v86, s42, v123 dst_sel:DWORD dst_unused:UNUSED_PAD src0_sel:DWORD src1_sel:WORD_0
v_smfmac_f32_16x16x64_bf16 v[16:19], v[190:193], v[60:67], v167
ds_read_b128 v[56:59], v1 offset:2048
v_cvt_pk_bf16_f32 v92, v8, v9
v_smfmac_f32_16x16x64_bf16 v[16:19], v[226:229], v[68:75], v171
ds_read_u16 v76, v76
v_cvt_pk_bf16_f32 v93, v10, v11
v_smfmac_f32_16x16x64_bf16 v[20:23], v[194:197], v[60:67], v167 abid:1
ds_read_b128 v[8:11], v2 offset:1024
v_cvt_pk_bf16_f32 v94, v12, v13
v_smfmac_f32_16x16x64_bf16 v[20:23], v[230:233], v[68:75], v171 abid:1
ds_read_u16 v77, v77
v_cvt_pk_bf16_f32 v95, v14, v15
v_smfmac_f32_16x16x64_bf16 v[24:27], v[198:201], v[60:67], v168
ds_read_b128 v[12:15], v2 offset:1088
v_cvt_pk_bf16_f32 v96, v16, v17
v_smfmac_f32_16x16x64_bf16 v[24:27], v[234:237], v[68:75], v172
ds_read_u16 v78, v78
v_cvt_pk_bf16_f32 v97, v18, v19
v_smfmac_f32_16x16x64_bf16 v[28:31], v[202:205], v[60:67], v168 abid:1
ds_read_b128 v[16:19], v2 offset:1152
v_cvt_pk_bf16_f32 v98, v20, v21
v_smfmac_f32_16x16x64_bf16 v[28:31], v[238:241], v[68:75], v172 abid:1
ds_read_u16 v79, v79
v_cvt_pk_bf16_f32 v99, v22, v23
v_smfmac_f32_16x16x64_bf16 v[32:35], v[206:209], v[60:67], v169
ds_read_b128 v[20:23], v2 offset:1216
v_cvt_pk_bf16_f32 v100, v24, v25
v_smfmac_f32_16x16x64_bf16 v[32:35], v[242:245], v[68:75], v173
ds_read_u16 v80, v80
v_cvt_pk_bf16_f32 v101, v26, v27
v_smfmac_f32_16x16x64_bf16 v[36:39], v[210:213], v[60:67], v169 abid:1
ds_read_b128 v[24:27], v2 offset:1280
v_cvt_pk_bf16_f32 v102, v28, v29
v_smfmac_f32_16x16x64_bf16 v[36:39], v[246:249], v[68:75], v173 abid:1
ds_read_u16 v81, v81
v_cvt_pk_bf16_f32 v103, v30, v31
v_smfmac_f32_16x16x64_bf16 v[40:43], v[214:217], v[60:67], v177 abid:1
s_bitcmp1_b32 s12, s41
ds_read_b128 v[28:31], v2 offset:1344
v_cvt_pk_bf16_f32 v104, v32, v33
v_smfmac_f32_16x16x64_bf16 v[40:43], v[250:253], v[68:75], v178
s_waitcnt lgkmcnt(10)
v_cvt_pk_bf16_f32 v105, v34, v35
s_cbranch_scc1 L_loopn
s_cmp_eq_u32 s41, s59
s_cbranch_scc1 L_loopc
s_cmp_lt_u32 s41, s15
s_cbranch_scc1 L_loop
s_nop 0
v_cndmask_b32_dpp v108, v96, v92, vcc quad_perm:[1,0,3,2] row_mask:0xf bank_mask:0xf
v_cndmask_b32_dpp v109, v97, v93, vcc quad_perm:[1,0,3,2] row_mask:0xf bank_mask:0xf
v_cndmask_b32_dpp v110, v98, v94, vcc quad_perm:[1,0,3,2] row_mask:0xf bank_mask:0xf
v_cndmask_b32_dpp v111, v99, v95, vcc quad_perm:[1,0,3,2] row_mask:0xf bank_mask:0xf
buffer_store_dwordx4 v[108:111], v4, s[20:23], s46 offen offset:0 sc1
s_mov_b64 vcc, s[82:83]
v_cvt_pk_bf16_f32 v112, v40, v41
v_cvt_pk_bf16_f32 v113, v42, v43
ds_bpermute_b32 v112, v6, v112
ds_bpermute_b32 v113, v6, v113
v_cndmask_b32_dpp v96, v92, v96, vcc quad_perm:[1,0,3,2] row_mask:0xf bank_mask:0xf
v_cndmask_b32_dpp v97, v93, v97, vcc quad_perm:[1,0,3,2] row_mask:0xf bank_mask:0xf
v_cndmask_b32_dpp v98, v94, v98, vcc quad_perm:[1,0,3,2] row_mask:0xf bank_mask:0xf
v_cndmask_b32_dpp v99, v95, v99, vcc quad_perm:[1,0,3,2] row_mask:0xf bank_mask:0xf
buffer_store_dwordx4 v[96:99], v4, s[20:23], s46 offen offset:1152 sc1
s_mov_b64 vcc, s[80:81]
v_cvt_pk_bf16_f32 v106, v36, v37
v_cvt_pk_bf16_f32 v107, v38, v39
v_cndmask_b32_dpp v92, v104, v100, vcc quad_perm:[1,0,3,2] row_mask:0xf bank_mask:0xf
v_cndmask_b32_dpp v93, v105, v101, vcc quad_perm:[1,0,3,2] row_mask:0xf bank_mask:0xf
v_cndmask_b32_dpp v94, v106, v102, vcc quad_perm:[1,0,3,2] row_mask:0xf bank_mask:0xf
v_cndmask_b32_dpp v95, v107, v103, vcc quad_perm:[1,0,3,2] row_mask:0xf bank_mask:0xf
buffer_store_dwordx4 v[92:95], v4, s[20:23], s46 offen offset:128 sc1
s_mov_b64 vcc, s[82:83]
v_cndmask_b32_dpp v104, v100, v104, vcc quad_perm:[1,0,3,2] row_mask:0xf bank_mask:0xf
v_cndmask_b32_dpp v105, v101, v105, vcc quad_perm:[1,0,3,2] row_mask:0xf bank_mask:0xf
v_cndmask_b32_dpp v106, v102, v106, vcc quad_perm:[1,0,3,2] row_mask:0xf bank_mask:0xf
v_cndmask_b32_dpp v107, v103, v107, vcc quad_perm:[1,0,3,2] row_mask:0xf bank_mask:0xf
buffer_store_dwordx4 v[104:107], v4, s[20:23], s46 offen offset:1280 sc1
s_mov_b64 vcc, s[80:81]
s_waitcnt lgkmcnt(0)
buffer_store_dwordx2 v[112:113], v5, s[20:23], s46 offen nt
L_fin:
L_end_standalone__structured_sparse_n_m__ragged_kernel:
s_endpgm
L_more1:
v_and_b32 v73, v94, v16
v_lshrrev_b32 v72, 10, v16
v_cmp_eq_u32 s[64:65], v73, v95
v_and_or_b32 v32, v72, v96, v97
s_mov_b64 exec, s[64:65]
ds_add_rtn_u32 v48, v32, v88
s_mov_b64 exec, -1
v_and_b32 v73, v94, v17
v_lshrrev_b32 v72, 10, v17
v_cmp_eq_u32 s[66:67], v73, v95
v_and_or_b32 v33, v72, v96, v97
s_mov_b64 exec, s[66:67]
ds_add_rtn_u32 v49, v33, v88
s_mov_b64 exec, -1
v_and_b32 v73, v94, v18
v_lshrrev_b32 v72, 10, v18
v_cmp_eq_u32 s[68:69], v73, v95
v_and_or_b32 v34, v72, v96, v97
s_mov_b64 exec, s[68:69]
ds_add_rtn_u32 v50, v34, v88
s_mov_b64 exec, -1
v_and_b32 v73, v94, v19
v_lshrrev_b32 v72, 10, v19
v_cmp_eq_u32 s[70:71], v73, v95
v_and_or_b32 v35, v72, v96, v97
s_mov_b64 exec, s[70:71]
ds_add_rtn_u32 v51, v35, v88
s_mov_b64 exec, -1
v_and_b32 v73, v94, v20
v_lshrrev_b32 v72, 10, v20
v_cmp_eq_u32 s[72:73], v73, v95
v_and_or_b32 v36, v72, v96, v97
s_mov_b64 exec, s[72:73]
ds_add_rtn_u32 v52, v36, v88
s_mov_b64 exec, -1
v_and_b32 v73, v94, v21
v_lshrrev_b32 v72, 10, v21
v_cmp_eq_u32 s[74:75], v73, v95
v_and_or_b32 v37, v72, v96, v97
s_mov_b64 exec, s[74:75]
ds_add_rtn_u32 v53, v37, v88
s_mov_b64 exec, -1
v_and_b32 v73, v94, v22
v_lshrrev_b32 v72, 10, v22
v_cmp_eq_u32 s[76:77], v73, v95
v_and_or_b32 v38, v72, v96, v97
s_mov_b64 exec, s[76:77]
ds_add_rtn_u32 v54, v38, v88
s_mov_b64 exec, -1
s_branch L_more1b
L_greedy:
s_mov_b32 s47, 0
s_mov_b32 s89, 1
v_readlane_b32 s3, v72, 0
s_max_u32 s47, s47, 0
v_writelane_b32 v91, s47, 0
s_nop 1
s_add_u32 s47, s47, s3
s_cmp_gt_u32 s47, 32
s_cselect_b32 s90, 1, s90
v_readlane_b32 s3, v72, 1
s_max_u32 s47, s47, 0
v_writelane_b32 v91, s47, 1
s_nop 1
s_add_u32 s47, s47, s3
s_cmp_gt_u32 s47, 64
s_cselect_b32 s90, 1, s90
v_readlane_b32 s3, v72, 2
s_max_u32 s47, s47, 32
v_writelane_b32 v91, s47, 2
s_nop 1
s_add_u32 s47, s47, s3
s_cmp_gt_u32 s47, 64
s_cselect_b32 s90, 1, s90
v_readlane_b32 s3, v72, 3
s_max_u32 s47, s47, 32
v_writelane_b32 v91, s47, 3
s_nop 1
s_add_u32 s47, s47, s3
s_cmp_gt_u32 s47, 96
s_cselect_b32 s90, 1, s90
v_readlane_b32 s3, v72, 4
s_max_u32 s47, s47, 64
v_writelane_b32 v91, s47, 4
s_nop 1
s_add_u32 s47, s47, s3
s_cmp_gt_u32 s47, 96
s_cselect_b32 s90, 1, s90
v_readlane_b32 s3, v72, 5
s_max_u32 s47, s47, 64
v_writelane_b32 v91, s47, 5
s_nop 1
s_add_u32 s47, s47, s3
s_cmp_gt_u32 s47, 128
s_cselect_b32 s90, 1, s90
v_readlane_b32 s3, v72, 6
s_max_u32 s47, s47, 96
v_writelane_b32 v91, s47, 6
s_nop 1
s_add_u32 s47, s47, s3
s_cmp_gt_u32 s47, 128
s_cselect_b32 s90, 1, s90
v_readlane_b32 s3, v72, 7
s_max_u32 s47, s47, 96
v_writelane_b32 v91, s47, 7
s_nop 1
s_add_u32 s47, s47, s3
s_cmp_gt_u32 s47, 160
s_cselect_b32 s90, 1, s90
v_readlane_b32 s3, v72, 8
s_max_u32 s47, s47, 128
v_writelane_b32 v91, s47, 8
s_nop 1
s_add_u32 s47, s47, s3
s_cmp_gt_u32 s47, 160
s_cselect_b32 s90, 1, s90
s_cmp_lg_u32 s90, 0
s_cselect_b64 s[90:91], -1, 0
v_mov_b32 v73, 163072
s_mov_b64 exec, s[90:91]
ds_write_b32 v73, v88
s_mov_b64 exec, -1
s_branch L_greedyb
L_more2:
ds_bpermute_b32 v64, v32, v91
ds_bpermute_b32 v65, v33, v91
ds_bpermute_b32 v66, v34, v91
ds_bpermute_b32 v67, v35, v91
ds_bpermute_b32 v68, v36, v91
ds_bpermute_b32 v69, v37, v91
ds_bpermute_b32 v70, v38, v91
s_waitcnt lgkmcnt(0)
v_add_u32 v73, v48, v64
v_and_b32 v72, 0x87e, v16
v_lshl_add_u32 v73, v73, 1, s93
v_add_u32 v72, v90, v72
s_andn2_b64 exec, s[64:65], s[90:91]
ds_write_b16_d16_hi v73, v16 offset:64
ds_write_b16 v73, v72 offset:384
ds_write_b16 v73, v16 offset:704
s_mov_b64 exec, -1
v_add_u32 v73, v49, v65
v_and_b32 v72, 0x87e, v17
v_lshl_add_u32 v73, v73, 1, s93
v_add_u32 v72, v90, v72
s_andn2_b64 exec, s[66:67], s[90:91]
ds_write_b16_d16_hi v73, v17 offset:64
ds_write_b16 v73, v72 offset:384
ds_write_b16 v73, v17 offset:704
s_mov_b64 exec, -1
v_add_u32 v73, v50, v66
v_and_b32 v72, 0x87e, v18
v_lshl_add_u32 v73, v73, 1, s93
v_add_u32 v72, v90, v72
s_andn2_b64 exec, s[68:69], s[90:91]
ds_write_b16_d16_hi v73, v18 offset:64
ds_write_b16 v73, v72 offset:384
ds_write_b16 v73, v18 offset:704
s_mov_b64 exec, -1
v_add_u32 v73, v51, v67
v_and_b32 v72, 0x87e, v19
v_lshl_add_u32 v73, v73, 1, s93
v_add_u32 v72, v90, v72
s_andn2_b64 exec, s[70:71], s[90:91]
ds_write_b16_d16_hi v73, v19 offset:64
ds_write_b16 v73, v72 offset:384
ds_write_b16 v73, v19 offset:704
s_mov_b64 exec, -1
v_add_u32 v73, v52, v68
v_and_b32 v72, 0x87e, v20
v_lshl_add_u32 v73, v73, 1, s93
v_add_u32 v72, v90, v72
s_andn2_b64 exec, s[72:73], s[90:91]
ds_write_b16_d16_hi v73, v20 offset:64
ds_write_b16 v73, v72 offset:384
ds_write_b16 v73, v20 offset:704
s_mov_b64 exec, -1
v_add_u32 v73, v53, v69
v_and_b32 v72, 0x87e, v21
v_lshl_add_u32 v73, v73, 1, s93
v_add_u32 v72, v90, v72
s_andn2_b64 exec, s[74:75], s[90:91]
ds_write_b16_d16_hi v73, v21 offset:64
ds_write_b16 v73, v72 offset:384
ds_write_b16 v73, v21 offset:704
s_mov_b64 exec, -1
v_add_u32 v73, v54, v70
v_and_b32 v72, 0x87e, v22
v_lshl_add_u32 v73, v73, 1, s93
v_add_u32 v72, v90, v72
s_andn2_b64 exec, s[76:77], s[90:91]
ds_write_b16_d16_hi v73, v22 offset:64
ds_write_b16 v73, v72 offset:384
ds_write_b16 v73, v22 offset:704
s_mov_b64 exec, -1
s_branch L_more2b
L_cwait:
buffer_load_dword v8, off, s[36:39], 0 sc1
s_sub_u32 s3, s3, 1
s_cbranch_scc1 L_giveup
s_waitcnt vmcnt(0)
v_readfirstlane_b32 s47, v8
s_nop 3
s_cmp_lg_u32 s47, 1
s_cbranch_scc1 L_cwait
s_branch L_poll
L_giveup:
s_waitcnt vmcnt(0)
v_mov_b32 v8, 163072
v_mov_b32 v9, 1
ds_write_b32 v8, v9
s_branch L_polled
L_loop_w:
s_bitcmp1_b32 s87, s41
s_waitcnt vmcnt(15)
s_cbranch_scc0 L_loop_wb
s_waitcnt vmcnt(10)
s_branch L_loop_wb
L_loopn_w:
s_bitcmp1_b32 s87, s41
s_waitcnt vmcnt(15) lgkmcnt(0)
s_cbranch_scc0 L_loopn_w1
s_waitcnt vmcnt(10)
L_loopn_w1:
s_barrier
s_branch L_loopn_wb
L_linked:
.p2align 6
L_loopk:
v_smfmac_f32_16x16x64_bf16 v[8:11], a[0:3], v[44:51], v138
ds_read_b128 v[32:35], v2 offset:1408
v_cvt_pk_bf16_f32 v106, v36, v37
v_smfmac_f32_16x16x64_bf16 v[8:11], a[36:39], v[52:59], v142
s_waitcnt lgkmcnt(9)
v_cvt_pk_bf16_f32 v107, v38, v39
v_smfmac_f32_16x16x64_bf16 v[12:15], a[4:7], v[44:51], v138 abid:1
ds_read_b128 v[36:39], v2 offset:1472
v_cvt_pk_bf16_f32 v112, v40, v41
v_smfmac_f32_16x16x64_bf16 v[12:15], a[40:43], v[52:59], v142 abid:1
s_waitcnt lgkmcnt(8)
ds_read_b128 v[60:63], v0 offset:4096
v_cvt_pk_bf16_f32 v113, v42, v43
v_smfmac_f32_16x16x64_bf16 v[16:19], a[8:11], v[44:51], v139
s_cmp_eq_u32 s4, 129920
ds_read_b128 v[40:43], v2 offset:1536
v_cndmask_b32_dpp v108, v96, v92, vcc quad_perm:[1,0,3,2] row_mask:0xf bank_mask:0xf
v_smfmac_f32_16x16x64_bf16 v[16:19], a[44:47], v[52:59], v143
s_waitcnt lgkmcnt(8)
ds_read_u16 v82, v82
v_cndmask_b32_dpp v109, v97, v93, vcc quad_perm:[1,0,3,2] row_mask:0xf bank_mask:0xf
v_smfmac_f32_16x16x64_bf16 v[20:23], a[12:15], v[44:51], v139 abid:1
s_cselect_b32 s43, -129920, s5
ds_read_u16 v84, v84
v_cndmask_b32_dpp v110, v98, v94, vcc quad_perm:[1,0,3,2] row_mask:0xf bank_mask:0xf
v_smfmac_f32_16x16x64_bf16 v[20:23], a[48:51], v[52:59], v143 abid:1
s_waitcnt lgkmcnt(8)
ds_read_b128 v[64:67], v1 offset:4096
v_cndmask_b32_dpp v111, v99, v95, vcc quad_perm:[1,0,3,2] row_mask:0xf bank_mask:0xf
v_smfmac_f32_16x16x64_bf16 v[24:27], a[16:19], v[44:51], v140
s_add_u32 s4, s4, s43
ds_read_b128 v[68:71], v0 offset:6144
v_add_u32_sdwa v87, s42, v123 dst_sel:DWORD dst_unused:UNUSED_PAD src0_sel:DWORD src1_sel:WORD_1
v_smfmac_f32_16x16x64_bf16 v[24:27], a[52:55], v[52:59], v144
buffer_store_dwordx4 v[108:111], v4, s[20:23], s46 offen offset:0 sc1
s_mov_b64 vcc, s[82:83]
s_waitcnt lgkmcnt(8)
ds_read_b128 v[72:75], v1 offset:6144
v_cndmask_b32_dpp v96, v92, v96, vcc quad_perm:[1,0,3,2] row_mask:0xf bank_mask:0xf
v_cndmask_b32_dpp v97, v93, v97, vcc quad_perm:[1,0,3,2] row_mask:0xf bank_mask:0xf
v_smfmac_f32_16x16x64_bf16 v[28:31], a[20:23], v[44:51], v140 abid:1
s_add_u32 s41, s41, 1
ds_read_u16 v83, v83
v_cndmask_b32_dpp v98, v94, v98, vcc quad_perm:[1,0,3,2] row_mask:0xf bank_mask:0xf
v_smfmac_f32_16x16x64_bf16 v[28:31], a[56:59], v[52:59], v144 abid:1
s_waitcnt lgkmcnt(9)
ds_read_b128 v[114:117], v2 offset:64
v_cndmask_b32_dpp v99, v95, v99, vcc quad_perm:[1,0,3,2] row_mask:0xf bank_mask:0xf
v_smfmac_f32_16x16x64_bf16 v[32:35], a[24:27], v[44:51], v141
ds_read_u16 v85, v85
v_add_u32_sdwa v88, s42, v124 dst_sel:DWORD dst_unused:UNUSED_PAD src0_sel:DWORD src1_sel:WORD_0
v_smfmac_f32_16x16x64_bf16 v[32:35], a[60:63], v[52:59], v145
s_waitcnt lgkmcnt(10)
ds_read_u16 v86, v86
v_add_u32_sdwa v89, s42, v124 dst_sel:DWORD dst_unused:UNUSED_PAD src0_sel:DWORD src1_sel:WORD_1
v_smfmac_f32_16x16x64_bf16 v[36:39], a[28:31], v[44:51], v141 abid:1
ds_read_u16 v87, v87
v_add_u32_sdwa v90, s42, v125 dst_sel:DWORD dst_unused:UNUSED_PAD src0_sel:DWORD src1_sel:WORD_0
v_smfmac_f32_16x16x64_bf16 v[36:39], a[64:67], v[52:59], v145 abid:1
s_waitcnt lgkmcnt(10)
ds_read_u16 v88, v88
v_add_u32_sdwa v91, s42, v125 dst_sel:DWORD dst_unused:UNUSED_PAD src0_sel:DWORD src1_sel:WORD_1
v_smfmac_f32_16x16x64_bf16 v[40:43], a[32:35], v[44:51], v174
buffer_store_dwordx4 v[96:99], v4, s[20:23], s46 offen offset:1152 sc1
s_mov_b64 vcc, s[80:81]
ds_read_u16 v89, v89
v_cndmask_b32_dpp v92, v104, v100, vcc quad_perm:[1,0,3,2] row_mask:0xf bank_mask:0xf
v_cndmask_b32_dpp v93, v105, v101, vcc quad_perm:[1,0,3,2] row_mask:0xf bank_mask:0xf
v_smfmac_f32_16x16x64_bf16 v[40:43], a[68:71], v[52:59], v174 abid:1
s_waitcnt lgkmcnt(9)
ds_read_u16 v90, v90
v_cndmask_b32_dpp v94, v106, v102, vcc quad_perm:[1,0,3,2] row_mask:0xf bank_mask:0xf
v_smfmac_f32_16x16x64_bf16 v[8:11], a[72:75], v[60:67], v146
s_waitcnt lgkmcnt(8)
ds_read_u16 v91, v91
v_cndmask_b32_dpp v95, v107, v103, vcc quad_perm:[1,0,3,2] row_mask:0xf bank_mask:0xf
v_smfmac_f32_16x16x64_bf16 v[8:11], a[108:111], v[68:75], v150
s_waitcnt lgkmcnt(7)
ds_bpermute_b32 v112, v6, v112
v_smfmac_f32_16x16x64_bf16 v[8:11], v[114:117], v[76:83], v179
ds_bpermute_b32 v113, v6, v113
v_smfmac_f32_16x16x64_bf16 v[12:15], v[114:117], v[76:83], v179 abid:1
ds_read_b128 v[114:117], v2 offset:128
v_add_u32_sdwa v76, s42, v126 dst_sel:DWORD dst_unused:UNUSED_PAD src0_sel:DWORD src1_sel:WORD_0
v_smfmac_f32_16x16x64_bf16 v[12:15], a[76:79], v[60:67], v146 abid:1
ds_read_u16 v76, v76
v_add_u32_sdwa v77, s42, v126 dst_sel:DWORD dst_unused:UNUSED_PAD src0_sel:DWORD src1_sel:WORD_1
v_smfmac_f32_16x16x64_bf16 v[12:15], a[112:115], v[68:75], v150 abid:1
buffer_store_dwordx4 v[92:95], v4, s[20:23], s46 offen offset:128 sc1
s_mov_b64 vcc, s[82:83]
ds_read_u16 v77, v77
v_cndmask_b32_dpp v104, v100, v104, vcc quad_perm:[1,0,3,2] row_mask:0xf bank_mask:0xf
v_cndmask_b32_dpp v105, v101, v105, vcc quad_perm:[1,0,3,2] row_mask:0xf bank_mask:0xf
v_smfmac_f32_16x16x64_bf16 v[24:27], a[88:91], v[60:67], v148
ds_read_b128 v[44:47], v0 offset:8192
v_add_u32_sdwa v78, s42, v127 dst_sel:DWORD dst_unused:UNUSED_PAD src0_sel:DWORD src1_sel:WORD_0
v_smfmac_f32_16x16x64_bf16 v[24:27], a[124:127], v[68:75], v152
ds_read_u16 v78, v78
v_cndmask_b32_dpp v106, v102, v106, vcc quad_perm:[1,0,3,2] row_mask:0xf bank_mask:0xf
v_smfmac_f32_16x16x64_bf16 v[28:31], a[92:95], v[60:67], v148 abid:1
ds_read_b128 v[48:51], v1 offset:8192
v_cndmask_b32_dpp v107, v103, v107, vcc quad_perm:[1,0,3,2] row_mask:0xf bank_mask:0xf
v_smfmac_f32_16x16x64_bf16 v[28:31], a[128:131], v[68:75], v152 abid:1
ds_read_b128 v[52:55], v0 offset:10240
v_add_u32_sdwa v79, s42, v127 dst_sel:DWORD dst_unused:UNUSED_PAD src0_sel:DWORD src1_sel:WORD_1
v_smfmac_f32_16x16x64_bf16 v[32:35], a[96:99], v[60:67], v149
ds_read_u16 v79, v79
v_add_u32_sdwa v80, s42, v128 dst_sel:DWORD dst_unused:UNUSED_PAD src0_sel:DWORD src1_sel:WORD_0
v_smfmac_f32_16x16x64_bf16 v[32:35], a[132:135], v[68:75], v153
ds_read_u16 v80, v80
v_add_u32_sdwa v81, s42, v128 dst_sel:DWORD dst_unused:UNUSED_PAD src0_sel:DWORD src1_sel:WORD_1
v_smfmac_f32_16x16x64_bf16 v[16:19], a[80:83], v[60:67], v147
buffer_store_dwordx4 v[104:107], v4, s[20:23], s46 offen offset:1280 sc1
s_mov_b64 vcc, s[80:81]
ds_read_b128 v[56:59], v1 offset:10240
v_add_u32_sdwa v82, s42, v129 dst_sel:DWORD dst_unused:UNUSED_PAD src0_sel:DWORD src1_sel:WORD_0
v_add_u32_sdwa v83, s42, v129 dst_sel:DWORD dst_unused:UNUSED_PAD src0_sel:DWORD src1_sel:WORD_1
v_smfmac_f32_16x16x64_bf16 v[16:19], a[116:119], v[68:75], v151
s_waitcnt lgkmcnt(9)
ds_read_b128 v[92:95], v0 offset:12288
v_add_u32_sdwa v100, s42, v130 dst_sel:DWORD dst_unused:UNUSED_PAD src0_sel:DWORD src1_sel:WORD_0
v_smfmac_f32_16x16x64_bf16 v[16:19], v[114:117], v[84:91], v180 abid:1
s_waitcnt vmcnt(4)
ds_read_u16 v81, v81
v_add_u32_sdwa v101, s42, v130 dst_sel:DWORD dst_unused:UNUSED_PAD src0_sel:DWORD src1_sel:WORD_1
v_smfmac_f32_16x16x64_bf16 v[12:15], v[114:117], v[84:91], v180
ds_read_b128 v[96:99], v1 offset:12288
v_add_u32_sdwa v102, s42, v131 dst_sel:DWORD dst_unused:UNUSED_PAD src0_sel:DWORD src1_sel:WORD_0
v_smfmac_f32_16x16x64_bf16 v[20:23], v[114:117], v[84:91], v181
ds_read_u16 v82, v82
v_add_u32_sdwa v103, s42, v131 dst_sel:DWORD dst_unused:UNUSED_PAD src0_sel:DWORD src1_sel:WORD_1
v_smfmac_f32_16x16x64_bf16 v[20:23], a[84:87], v[60:67], v147 abid:1
ds_read_u16 v100, v100
v_add_u32_sdwa v104, s42, v132 dst_sel:DWORD dst_unused:UNUSED_PAD src0_sel:DWORD src1_sel:WORD_0
v_smfmac_f32_16x16x64_bf16 v[20:23], a[120:123], v[68:75], v151 abid:1
ds_read_u16 v83, v83
v_add_u32_sdwa v105, s42, v132 dst_sel:DWORD dst_unused:UNUSED_PAD src0_sel:DWORD src1_sel:WORD_1
v_smfmac_f32_16x16x64_bf16 v[36:39], a[100:103], v[60:67], v149 abid:1
buffer_store_dwordx2 v[112:113], v5, s[20:23], s46 offen nt
ds_read_b128 v[114:117], v2 offset:192
v_add_u32_sdwa v106, s42, v133 dst_sel:DWORD dst_unused:UNUSED_PAD src0_sel:DWORD src1_sel:WORD_0
v_smfmac_f32_16x16x64_bf16 v[36:39], a[136:139], v[68:75], v153 abid:1
s_mov_b32 s22, 75497472
ds_read_u16 v101, v101
v_add_u32_sdwa v107, s42, v133 dst_sel:DWORD dst_unused:UNUSED_PAD src0_sel:DWORD src1_sel:WORD_1
v_smfmac_f32_16x16x64_bf16 v[40:43], a[104:107], v[60:67], v175
s_mov_b32 s46, s48
ds_read_u16 v102, v102
v_add_u32_sdwa v84, s42, v134 dst_sel:DWORD dst_unused:UNUSED_PAD src0_sel:DWORD src1_sel:WORD_0
v_smfmac_f32_16x16x64_bf16 v[40:43], a[140:143], v[68:75], v175 abid:1
s_waitcnt lgkmcnt(13)
ds_read_u16 v103, v103
v_add_u32_sdwa v85, s42, v134 dst_sel:DWORD dst_unused:UNUSED_PAD src0_sel:DWORD src1_sel:WORD_1
v_smfmac_f32_16x16x64_bf16 v[8:11], a[144:147], v[44:51], v154
s_waitcnt lgkmcnt(10)
ds_read_u16 v104, v104
v_add_u32_sdwa v86, s42, v135 dst_sel:DWORD dst_unused:UNUSED_PAD src0_sel:DWORD src1_sel:WORD_0
v_smfmac_f32_16x16x64_bf16 v[8:11], a[180:183], v[52:59], v158
s_waitcnt lgkmcnt(8)
ds_read_u16 v105, v105
v_add_u32_sdwa v87, s42, v135 dst_sel:DWORD dst_unused:UNUSED_PAD src0_sel:DWORD src1_sel:WORD_1
v_smfmac_f32_16x16x64_bf16 v[8:11], a[216:219], v[92:99], v162
s_add_u32 m0, s44, 0
ds_read_u16 v106, v106
v_add_u32_sdwa v88, s42, v136 dst_sel:DWORD dst_unused:UNUSED_PAD src0_sel:DWORD src1_sel:WORD_0
v_smfmac_f32_16x16x64_bf16 v[24:27], a[160:163], v[44:51], v156
buffer_load_dwordx4 v3, s[16:19], s45 offen offset:0 nt lds
v_add_u32_sdwa v89, s42, v136 dst_sel:DWORD dst_unused:UNUSED_PAD src0_sel:DWORD src1_sel:WORD_1
v_smfmac_f32_16x16x64_bf16 v[24:27], a[196:199], v[52:59], v160
s_mov_b32 s48, s49
ds_read_u16 v107, v107
v_add_u32_sdwa v90, s42, v137 dst_sel:DWORD dst_unused:UNUSED_PAD src0_sel:DWORD src1_sel:WORD_0
v_smfmac_f32_16x16x64_bf16 v[24:27], a[232:235], v[92:99], v164
s_waitcnt lgkmcnt(7)
ds_read_u16 v84, v84
v_add_u32_sdwa v91, s42, v137 dst_sel:DWORD dst_unused:UNUSED_PAD src0_sel:DWORD src1_sel:WORD_1
v_smfmac_f32_16x16x64_bf16 v[24:27], v[114:117], v[76:83], v182
s_mov_b32 s49, s50
ds_read_u16 v85, v85
v_smfmac_f32_16x16x64_bf16 v[20:23], v[114:117], v[76:83], v181 abid:1
s_add_u32 s50, s50, 4718592
ds_read_u16 v86, v86
v_smfmac_f32_16x16x64_bf16 v[28:31], v[114:117], v[76:83], v182 abid:1
ds_read_b128 v[114:117], v2 offset:256
v_add_u32_sdwa v76, s4, v118 dst_sel:DWORD dst_unused:UNUSED_PAD src0_sel:DWORD src1_sel:WORD_0
v_smfmac_f32_16x16x64_bf16 v[28:31], a[164:167], v[44:51], v156 abid:1
ds_read_u16 v87, v87
v_add_u32_sdwa v77, s4, v118 dst_sel:DWORD dst_unused:UNUSED_PAD src0_sel:DWORD src1_sel:WORD_1
v_smfmac_f32_16x16x64_bf16 v[28:31], a[200:203], v[52:59], v160 abid:1
ds_read_u16 v88, v88
v_add_u32_sdwa v78, s4, v119 dst_sel:DWORD dst_unused:UNUSED_PAD src0_sel:DWORD src1_sel:WORD_0
v_smfmac_f32_16x16x64_bf16 v[28:31], a[236:239], v[92:99], v164 abid:1
ds_read_b128 v[60:63], v0 offset:14336
v_add_u32_sdwa v79, s4, v119 dst_sel:DWORD dst_unused:UNUSED_PAD src0_sel:DWORD src1_sel:WORD_1
v_smfmac_f32_16x16x64_bf16 v[12:15], a[148:151], v[44:51], v154 abid:1
ds_read_u16 v89, v89
v_add_u32_sdwa v80, s4, v120 dst_sel:DWORD dst_unused:UNUSED_PAD src0_sel:DWORD src1_sel:WORD_0
v_smfmac_f32_16x16x64_bf16 v[12:15], a[184:187], v[52:59], v158 abid:1
s_add_u32 m0, s44, 3840
ds_read_b128 v[64:67], v1 offset:14336
v_add_u32_sdwa v81, s4, v120 dst_sel:DWORD dst_unused:UNUSED_PAD src0_sel:DWORD src1_sel:WORD_1
v_smfmac_f32_16x16x64_bf16 v[12:15], a[220:223], v[92:99], v162 abid:1
buffer_load_dwordx4 v3, s[16:19], s45 offen offset:256 nt lds
v_add_u32_sdwa v82, s4, v121 dst_sel:DWORD dst_unused:UNUSED_PAD src0_sel:DWORD src1_sel:WORD_0
v_smfmac_f32_16x16x64_bf16 v[32:35], a[168:171], v[44:51], v157
ds_read_b128 v[68:71], v0 offset:16384
v_add_u32_sdwa v83, s4, v121 dst_sel:DWORD dst_unused:UNUSED_PAD src0_sel:DWORD src1_sel:WORD_1
v_smfmac_f32_16x16x64_bf16 v[32:35], a[204:207], v[52:59], v161
ds_read_u16 v90, v90
v_smfmac_f32_16x16x64_bf16 v[32:35], a[240:243], v[92:99], v165
s_waitcnt lgkmcnt(7)
ds_read_b128 v[72:75], v1 offset:16384
v_add_u32 v0, s43, v0
v_smfmac_f32_16x16x64_bf16 v[32:35], v[114:117], v[100:107], v183 abid:1
ds_read_u16 v91, v91
v_add_u32 v1, s43, v1
v_smfmac_f32_16x16x64_bf16 v[28:31], v[114:117], v[100:107], v183
v_smfmac_f32_16x16x64_bf16 v[36:39], v[114:117], v[100:107], v184
ds_read_b128 v[114:117], v2 offset:320
v_smfmac_f32_16x16x64_bf16 v[36:39], a[172:175], v[44:51], v157 abid:1
s_add_u32 m0, s44, 7680
v_smfmac_f32_16x16x64_bf16 v[36:39], a[208:211], v[52:59], v161 abid:1
buffer_load_dwordx4 v3, s[16:19], s45 offen offset:512 nt lds
v_smfmac_f32_16x16x64_bf16 v[36:39], a[244:247], v[92:99], v165 abid:1
v_smfmac_f32_16x16x64_bf16 v[16:19], a[152:155], v[44:51], v155
s_add_u32 m0, s44, 11520
v_smfmac_f32_16x16x64_bf16 v[16:19], a[188:191], v[52:59], v159
buffer_load_dwordx4 v3, s[16:19], s45 offen offset:768 nt lds
v_smfmac_f32_16x16x64_bf16 v[16:19], a[224:227], v[92:99], v163
v_smfmac_f32_16x16x64_bf16 v[20:23], a[156:159], v[44:51], v155 abid:1
s_add_u32 m0, s44, s8
v_smfmac_f32_16x16x64_bf16 v[20:23], a[192:195], v[52:59], v159 abid:1
s_mov_b64 exec, s[10:11]
buffer_load_dwordx4 v3, s[16:19], s7 offen offset:896 nt lds
s_mov_b64 exec, -1
v_smfmac_f32_16x16x64_bf16 v[20:23], a[228:231], v[92:99], v163 abid:1
s_add_u32 s45, s45, 4718592
s_add_u32 s7, s7, 4718592
s_add_u32 s44, s44, s5
v_smfmac_f32_16x16x64_bf16 v[40:43], a[176:179], v[44:51], v176
s_cmp_ge_u32 s44, 148480
s_cselect_b32 s44, s9, s44
s_bitcmp1_b32 s92, s41
v_smfmac_f32_16x16x64_bf16 v[40:43], a[212:215], v[52:59], v176 abid:1
s_cbranch_scc1 L_loopk_w
L_loopk_wb:
v_smfmac_f32_16x16x64_bf16 v[40:43], a[248:251], v[92:99], v177
s_waitcnt lgkmcnt(0)
v_smfmac_f32_16x16x64_bf16 v[40:43], v[114:117], v[84:91], v185
v_smfmac_f32_16x16x64_bf16 v[36:39], v[114:117], v[84:91], v184 abid:1
s_waitcnt vmcnt(20)
s_barrier
v_smfmac_f32_16x16x64_bf16 v[8:11], a[252:255], v[60:67], v166
s_mov_b32 s42, s4
v_smfmac_f32_16x16x64_bf16 v[8:11], v[218:221], v[68:75], v170
ds_read_b128 v[44:47], v0 offset:0
v_add_u32_sdwa v84, s42, v122 dst_sel:DWORD dst_unused:UNUSED_PAD src0_sel:DWORD src1_sel:WORD_0
v_smfmac_f32_16x16x64_bf16 v[12:15], v[186:189], v[60:67], v166 abid:1
ds_read_b128 v[48:51], v1 offset:0
v_add_u32_sdwa v85, s42, v122 dst_sel:DWORD dst_unused:UNUSED_PAD src0_sel:DWORD src1_sel:WORD_1
v_smfmac_f32_16x16x64_bf16 v[12:15], v[222:225], v[68:75], v170 abid:1
ds_read_b128 v[52:55], v0 offset:2048
v_add_u32_sdwa v86, s42, v123 dst_sel:DWORD dst_unused:UNUSED_PAD src0_sel:DWORD src1_sel:WORD_0
v_smfmac_f32_16x16x64_bf16 v[16:19], v[190:193], v[60:67], v167
ds_read_b128 v[56:59], v1 offset:2048
v_cvt_pk_bf16_f32 v92, v8, v9
v_smfmac_f32_16x16x64_bf16 v[16:19], v[226:229], v[68:75], v171
ds_read_u16 v76, v76
v_cvt_pk_bf16_f32 v93, v10, v11
v_smfmac_f32_16x16x64_bf16 v[20:23], v[194:197], v[60:67], v167 abid:1
ds_read_b128 v[8:11], v2 offset:1024
v_cvt_pk_bf16_f32 v94, v12, v13
v_smfmac_f32_16x16x64_bf16 v[20:23], v[230:233], v[68:75], v171 abid:1
ds_read_u16 v77, v77
v_cvt_pk_bf16_f32 v95, v14, v15
v_smfmac_f32_16x16x64_bf16 v[24:27], v[198:201], v[60:67], v168
ds_read_b128 v[12:15], v2 offset:1088
v_cvt_pk_bf16_f32 v96, v16, v17
v_smfmac_f32_16x16x64_bf16 v[24:27], v[234:237], v[68:75], v172
ds_read_u16 v78, v78
v_cvt_pk_bf16_f32 v97, v18, v19
v_smfmac_f32_16x16x64_bf16 v[28:31], v[202:205], v[60:67], v168 abid:1
ds_read_b128 v[16:19], v2 offset:1152
v_cvt_pk_bf16_f32 v98, v20, v21
v_smfmac_f32_16x16x64_bf16 v[28:31], v[238:241], v[68:75], v172 abid:1
ds_read_u16 v79, v79
v_cvt_pk_bf16_f32 v99, v22, v23
v_smfmac_f32_16x16x64_bf16 v[32:35], v[206:209], v[60:67], v169
ds_read_b128 v[20:23], v2 offset:1216
v_cvt_pk_bf16_f32 v100, v24, v25
v_smfmac_f32_16x16x64_bf16 v[32:35], v[242:245], v[68:75], v173
ds_read_u16 v80, v80
v_cvt_pk_bf16_f32 v101, v26, v27
v_smfmac_f32_16x16x64_bf16 v[36:39], v[210:213], v[60:67], v169 abid:1
ds_read_b128 v[24:27], v2 offset:1280
v_cvt_pk_bf16_f32 v102, v28, v29
v_smfmac_f32_16x16x64_bf16 v[36:39], v[246:249], v[68:75], v173 abid:1
ds_read_u16 v81, v81
v_cvt_pk_bf16_f32 v103, v30, v31
v_smfmac_f32_16x16x64_bf16 v[40:43], v[214:217], v[60:67], v177 abid:1
s_bitcmp1_b32 s85, s41
ds_read_b128 v[28:31], v2 offset:1344
v_cvt_pk_bf16_f32 v104, v32, v33
v_smfmac_f32_16x16x64_bf16 v[40:43], v[250:253], v[68:75], v178
s_waitcnt lgkmcnt(10)
v_cvt_pk_bf16_f32 v105, v34, v35
s_cbranch_scc1 L_loopk
s_cmp_lg_u32 s41, 6
s_cbranch_scc1 L_loopnk
.p2align 3
L_loopck:
v_smfmac_f32_16x16x64_bf16 v[8:11], a[0:3], v[44:51], v138
s_cmp_lt_u32 s56, s65
s_cselect_b32 s34, s34, 0
s_cselect_b32 s64, s64, 0
ds_read_b128 v[32:35], v2 offset:1408
v_cvt_pk_bf16_f32 v106, v36, v37
v_mov_b32 v7, 1
v_smfmac_f32_16x16x64_bf16 v[8:11], a[36:39], v[52:59], v142
s_waitcnt lgkmcnt(9)
buffer_atomic_add v7, v6, s[32:35], 0 offen sc0 sc1
v_cvt_pk_bf16_f32 v107, v38, v39
v_smfmac_f32_16x16x64_bf16 v[12:15], a[4:7], v[44:51], v138 abid:1
ds_read_b128 v[36:39], v2 offset:1472
v_cvt_pk_bf16_f32 v112, v40, v41
v_smfmac_f32_16x16x64_bf16 v[12:15], a[40:43], v[52:59], v142 abid:1
s_waitcnt lgkmcnt(8)
ds_read_b128 v[60:63], v0 offset:4096
v_cvt_pk_bf16_f32 v113, v42, v43
v_smfmac_f32_16x16x64_bf16 v[16:19], a[8:11], v[44:51], v139
s_cmp_eq_u32 s4, 129920
ds_read_b128 v[40:43], v2 offset:1536
v_cndmask_b32_dpp v108, v96, v92, vcc quad_perm:[1,0,3,2] row_mask:0xf bank_mask:0xf
v_smfmac_f32_16x16x64_bf16 v[16:19], a[44:47], v[52:59], v143
s_waitcnt lgkmcnt(8)
ds_read_u16 v82, v82
v_cndmask_b32_dpp v109, v97, v93, vcc quad_perm:[1,0,3,2] row_mask:0xf bank_mask:0xf
v_smfmac_f32_16x16x64_bf16 v[20:23], a[12:15], v[44:51], v139 abid:1
s_cselect_b32 s43, -129920, s5
ds_read_u16 v84, v84
v_cndmask_b32_dpp v110, v98, v94, vcc quad_perm:[1,0,3,2] row_mask:0xf bank_mask:0xf
v_smfmac_f32_16x16x64_bf16 v[20:23], a[48:51], v[52:59], v143 abid:1
s_waitcnt lgkmcnt(8)
ds_read_b128 v[64:67], v1 offset:4096
v_cndmask_b32_dpp v111, v99, v95, vcc quad_perm:[1,0,3,2] row_mask:0xf bank_mask:0xf
v_smfmac_f32_16x16x64_bf16 v[24:27], a[16:19], v[44:51], v140
s_add_u32 s4, s4, s43
ds_read_b128 v[68:71], v0 offset:6144
v_add_u32_sdwa v87, s42, v123 dst_sel:DWORD dst_unused:UNUSED_PAD src0_sel:DWORD src1_sel:WORD_1
v_smfmac_f32_16x16x64_bf16 v[24:27], a[52:55], v[52:59], v144
buffer_store_dwordx4 v[108:111], v4, s[20:23], s46 offen offset:0 sc1
s_mov_b64 vcc, s[82:83]
s_waitcnt lgkmcnt(8)
ds_read_b128 v[72:75], v1 offset:6144
v_cndmask_b32_dpp v96, v92, v96, vcc quad_perm:[1,0,3,2] row_mask:0xf bank_mask:0xf
v_cndmask_b32_dpp v97, v93, v97, vcc quad_perm:[1,0,3,2] row_mask:0xf bank_mask:0xf
v_smfmac_f32_16x16x64_bf16 v[28:31], a[20:23], v[44:51], v140 abid:1
s_add_u32 s7, s45, s58
ds_read_u16 v83, v83
v_cndmask_b32_dpp v98, v94, v98, vcc quad_perm:[1,0,3,2] row_mask:0xf bank_mask:0xf
v_smfmac_f32_16x16x64_bf16 v[28:31], a[56:59], v[52:59], v144 abid:1
s_waitcnt lgkmcnt(9)
ds_read_b128 v[114:117], v2 offset:64
v_cndmask_b32_dpp v99, v95, v99, vcc quad_perm:[1,0,3,2] row_mask:0xf bank_mask:0xf
v_smfmac_f32_16x16x64_bf16 v[32:35], a[24:27], v[44:51], v141
ds_read_u16 v85, v85
v_add_u32_sdwa v88, s42, v124 dst_sel:DWORD dst_unused:UNUSED_PAD src0_sel:DWORD src1_sel:WORD_0
v_smfmac_f32_16x16x64_bf16 v[32:35], a[60:63], v[52:59], v145
s_waitcnt lgkmcnt(10)
ds_read_u16 v86, v86
v_add_u32_sdwa v89, s42, v124 dst_sel:DWORD dst_unused:UNUSED_PAD src0_sel:DWORD src1_sel:WORD_1
v_smfmac_f32_16x16x64_bf16 v[36:39], a[28:31], v[44:51], v141 abid:1
ds_read_u16 v87, v87
v_add_u32_sdwa v90, s42, v125 dst_sel:DWORD dst_unused:UNUSED_PAD src0_sel:DWORD src1_sel:WORD_0
v_smfmac_f32_16x16x64_bf16 v[36:39], a[64:67], v[52:59], v145 abid:1
s_waitcnt lgkmcnt(10)
ds_read_u16 v88, v88
v_add_u32_sdwa v91, s42, v125 dst_sel:DWORD dst_unused:UNUSED_PAD src0_sel:DWORD src1_sel:WORD_1
v_smfmac_f32_16x16x64_bf16 v[40:43], a[32:35], v[44:51], v174
buffer_store_dwordx4 v[96:99], v4, s[20:23], s46 offen offset:1152 sc1
s_mov_b64 vcc, s[80:81]
ds_read_u16 v89, v89
v_cndmask_b32_dpp v92, v104, v100, vcc quad_perm:[1,0,3,2] row_mask:0xf bank_mask:0xf
v_cndmask_b32_dpp v93, v105, v101, vcc quad_perm:[1,0,3,2] row_mask:0xf bank_mask:0xf
v_smfmac_f32_16x16x64_bf16 v[40:43], a[68:71], v[52:59], v174 abid:1
s_waitcnt lgkmcnt(9)
ds_read_u16 v90, v90
v_cndmask_b32_dpp v94, v106, v102, vcc quad_perm:[1,0,3,2] row_mask:0xf bank_mask:0xf
v_smfmac_f32_16x16x64_bf16 v[8:11], a[72:75], v[60:67], v146
s_waitcnt lgkmcnt(8)
ds_read_u16 v91, v91
v_cndmask_b32_dpp v95, v107, v103, vcc quad_perm:[1,0,3,2] row_mask:0xf bank_mask:0xf
v_smfmac_f32_16x16x64_bf16 v[8:11], a[108:111], v[68:75], v150
s_waitcnt lgkmcnt(7)
ds_bpermute_b32 v112, v6, v112
v_smfmac_f32_16x16x64_bf16 v[8:11], v[114:117], v[76:83], v179
ds_bpermute_b32 v113, v6, v113
v_smfmac_f32_16x16x64_bf16 v[12:15], v[114:117], v[76:83], v179 abid:1
ds_read_b128 v[114:117], v2 offset:128
v_add_u32_sdwa v76, s42, v126 dst_sel:DWORD dst_unused:UNUSED_PAD src0_sel:DWORD src1_sel:WORD_0
v_smfmac_f32_16x16x64_bf16 v[12:15], a[76:79], v[60:67], v146 abid:1
ds_read_u16 v76, v76
v_add_u32_sdwa v77, s42, v126 dst_sel:DWORD dst_unused:UNUSED_PAD src0_sel:DWORD src1_sel:WORD_1
v_smfmac_f32_16x16x64_bf16 v[12:15], a[112:115], v[68:75], v150 abid:1
buffer_store_dwordx4 v[92:95], v4, s[20:23], s46 offen offset:128 sc1
s_mov_b64 vcc, s[82:83]
ds_read_u16 v77, v77
v_cndmask_b32_dpp v104, v100, v104, vcc quad_perm:[1,0,3,2] row_mask:0xf bank_mask:0xf
v_cndmask_b32_dpp v105, v101, v105, vcc quad_perm:[1,0,3,2] row_mask:0xf bank_mask:0xf
v_smfmac_f32_16x16x64_bf16 v[24:27], a[88:91], v[60:67], v148
ds_read_b128 v[44:47], v0 offset:8192
v_add_u32_sdwa v78, s42, v127 dst_sel:DWORD dst_unused:UNUSED_PAD src0_sel:DWORD src1_sel:WORD_0
v_smfmac_f32_16x16x64_bf16 v[24:27], a[124:127], v[68:75], v152
ds_read_u16 v78, v78
v_cndmask_b32_dpp v106, v102, v106, vcc quad_perm:[1,0,3,2] row_mask:0xf bank_mask:0xf
v_smfmac_f32_16x16x64_bf16 v[28:31], a[92:95], v[60:67], v148 abid:1
ds_read_b128 v[48:51], v1 offset:8192
v_cndmask_b32_dpp v107, v103, v107, vcc quad_perm:[1,0,3,2] row_mask:0xf bank_mask:0xf
v_smfmac_f32_16x16x64_bf16 v[28:31], a[128:131], v[68:75], v152 abid:1
ds_read_b128 v[52:55], v0 offset:10240
v_add_u32_sdwa v79, s42, v127 dst_sel:DWORD dst_unused:UNUSED_PAD src0_sel:DWORD src1_sel:WORD_1
v_smfmac_f32_16x16x64_bf16 v[32:35], a[96:99], v[60:67], v149
ds_read_u16 v79, v79
v_add_u32_sdwa v80, s42, v128 dst_sel:DWORD dst_unused:UNUSED_PAD src0_sel:DWORD src1_sel:WORD_0
v_smfmac_f32_16x16x64_bf16 v[32:35], a[132:135], v[68:75], v153
ds_read_u16 v80, v80
v_add_u32_sdwa v81, s42, v128 dst_sel:DWORD dst_unused:UNUSED_PAD src0_sel:DWORD src1_sel:WORD_1
v_smfmac_f32_16x16x64_bf16 v[16:19], a[80:83], v[60:67], v147
buffer_store_dwordx4 v[104:107], v4, s[20:23], s46 offen offset:1280 sc1
s_mov_b64 vcc, s[80:81]
ds_read_b128 v[56:59], v1 offset:10240
v_add_u32_sdwa v82, s42, v129 dst_sel:DWORD dst_unused:UNUSED_PAD src0_sel:DWORD src1_sel:WORD_0
v_add_u32_sdwa v83, s42, v129 dst_sel:DWORD dst_unused:UNUSED_PAD src0_sel:DWORD src1_sel:WORD_1
v_smfmac_f32_16x16x64_bf16 v[16:19], a[116:119], v[68:75], v151
s_waitcnt lgkmcnt(9)
ds_read_b128 v[92:95], v0 offset:12288
v_add_u32_sdwa v100, s42, v130 dst_sel:DWORD dst_unused:UNUSED_PAD src0_sel:DWORD src1_sel:WORD_0
v_smfmac_f32_16x16x64_bf16 v[16:19], v[114:117], v[84:91], v180 abid:1
ds_read_u16 v81, v81
v_add_u32_sdwa v101, s42, v130 dst_sel:DWORD dst_unused:UNUSED_PAD src0_sel:DWORD src1_sel:WORD_1
v_smfmac_f32_16x16x64_bf16 v[12:15], v[114:117], v[84:91], v180
ds_read_b128 v[96:99], v1 offset:12288
v_add_u32_sdwa v102, s42, v131 dst_sel:DWORD dst_unused:UNUSED_PAD src0_sel:DWORD src1_sel:WORD_0
v_smfmac_f32_16x16x64_bf16 v[20:23], v[114:117], v[84:91], v181
ds_read_u16 v82, v82
v_add_u32_sdwa v103, s42, v131 dst_sel:DWORD dst_unused:UNUSED_PAD src0_sel:DWORD src1_sel:WORD_1
v_smfmac_f32_16x16x64_bf16 v[20:23], a[84:87], v[60:67], v147 abid:1
ds_read_u16 v100, v100
v_add_u32_sdwa v104, s42, v132 dst_sel:DWORD dst_unused:UNUSED_PAD src0_sel:DWORD src1_sel:WORD_0
v_smfmac_f32_16x16x64_bf16 v[20:23], a[120:123], v[68:75], v151 abid:1
ds_read_u16 v83, v83
v_add_u32_sdwa v105, s42, v132 dst_sel:DWORD dst_unused:UNUSED_PAD src0_sel:DWORD src1_sel:WORD_1
v_smfmac_f32_16x16x64_bf16 v[36:39], a[100:103], v[60:67], v149 abid:1
buffer_store_dwordx2 v[112:113], v5, s[20:23], s46 offen nt
ds_read_b128 v[114:117], v2 offset:192
v_add_u32_sdwa v106, s42, v133 dst_sel:DWORD dst_unused:UNUSED_PAD src0_sel:DWORD src1_sel:WORD_0
v_smfmac_f32_16x16x64_bf16 v[36:39], a[136:139], v[68:75], v153 abid:1
s_mov_b32 s46, s48
ds_read_u16 v101, v101
v_add_u32_sdwa v107, s42, v133 dst_sel:DWORD dst_unused:UNUSED_PAD src0_sel:DWORD src1_sel:WORD_1
v_smfmac_f32_16x16x64_bf16 v[40:43], a[104:107], v[60:67], v175
s_mov_b32 s48, s49
ds_read_u16 v102, v102
v_add_u32_sdwa v84, s42, v134 dst_sel:DWORD dst_unused:UNUSED_PAD src0_sel:DWORD src1_sel:WORD_0
v_smfmac_f32_16x16x64_bf16 v[40:43], a[140:143], v[68:75], v175 abid:1
s_waitcnt lgkmcnt(13)
ds_read_u16 v103, v103
v_add_u32_sdwa v85, s42, v134 dst_sel:DWORD dst_unused:UNUSED_PAD src0_sel:DWORD src1_sel:WORD_1
v_smfmac_f32_16x16x64_bf16 v[8:11], a[144:147], v[44:51], v154
s_waitcnt lgkmcnt(10)
ds_read_u16 v104, v104
v_add_u32_sdwa v86, s42, v135 dst_sel:DWORD dst_unused:UNUSED_PAD src0_sel:DWORD src1_sel:WORD_0
v_smfmac_f32_16x16x64_bf16 v[8:11], a[180:183], v[52:59], v158
s_waitcnt lgkmcnt(8)
ds_read_u16 v105, v105
v_add_u32_sdwa v87, s42, v135 dst_sel:DWORD dst_unused:UNUSED_PAD src0_sel:DWORD src1_sel:WORD_1
v_smfmac_f32_16x16x64_bf16 v[8:11], a[216:219], v[92:99], v162
s_add_u32 m0, s44, 0
ds_read_u16 v106, v106
v_add_u32_sdwa v88, s42, v136 dst_sel:DWORD dst_unused:UNUSED_PAD src0_sel:DWORD src1_sel:WORD_0
v_smfmac_f32_16x16x64_bf16 v[24:27], a[160:163], v[44:51], v156
buffer_load_dwordx4 v3, s[16:19], s45 offen offset:0 nt lds
v_add_u32_sdwa v89, s42, v136 dst_sel:DWORD dst_unused:UNUSED_PAD src0_sel:DWORD src1_sel:WORD_1
v_smfmac_f32_16x16x64_bf16 v[24:27], a[196:199], v[52:59], v160
s_mov_b32 s49, s50
ds_read_u16 v107, v107
v_add_u32_sdwa v90, s42, v137 dst_sel:DWORD dst_unused:UNUSED_PAD src0_sel:DWORD src1_sel:WORD_0
v_smfmac_f32_16x16x64_bf16 v[24:27], a[232:235], v[92:99], v164
s_waitcnt lgkmcnt(7)
ds_read_u16 v84, v84
v_add_u32_sdwa v91, s42, v137 dst_sel:DWORD dst_unused:UNUSED_PAD src0_sel:DWORD src1_sel:WORD_1
v_smfmac_f32_16x16x64_bf16 v[24:27], v[114:117], v[76:83], v182
s_mov_b32 s50, s45
ds_read_u16 v85, v85
v_smfmac_f32_16x16x64_bf16 v[20:23], v[114:117], v[76:83], v181 abid:1
ds_read_u16 v86, v86
v_smfmac_f32_16x16x64_bf16 v[28:31], v[114:117], v[76:83], v182 abid:1
ds_read_b128 v[114:117], v2 offset:256
v_add_u32_sdwa v76, s4, v118 dst_sel:DWORD dst_unused:UNUSED_PAD src0_sel:DWORD src1_sel:WORD_0
v_smfmac_f32_16x16x64_bf16 v[28:31], a[164:167], v[44:51], v156 abid:1
ds_read_u16 v87, v87
v_add_u32_sdwa v77, s4, v118 dst_sel:DWORD dst_unused:UNUSED_PAD src0_sel:DWORD src1_sel:WORD_1
v_smfmac_f32_16x16x64_bf16 v[28:31], a[200:203], v[52:59], v160 abid:1
ds_read_u16 v88, v88
v_add_u32_sdwa v78, s4, v119 dst_sel:DWORD dst_unused:UNUSED_PAD src0_sel:DWORD src1_sel:WORD_0
v_smfmac_f32_16x16x64_bf16 v[28:31], a[236:239], v[92:99], v164 abid:1
ds_read_b128 v[60:63], v0 offset:14336
v_add_u32_sdwa v79, s4, v119 dst_sel:DWORD dst_unused:UNUSED_PAD src0_sel:DWORD src1_sel:WORD_1
v_smfmac_f32_16x16x64_bf16 v[12:15], a[148:151], v[44:51], v154 abid:1
ds_read_u16 v89, v89
v_add_u32_sdwa v80, s4, v120 dst_sel:DWORD dst_unused:UNUSED_PAD src0_sel:DWORD src1_sel:WORD_0
v_smfmac_f32_16x16x64_bf16 v[12:15], a[184:187], v[52:59], v158 abid:1
s_add_u32 m0, s44, 3840
s_waitcnt vmcnt(6)
ds_read_b128 v[64:67], v1 offset:14336
v_add_u32_sdwa v81, s4, v120 dst_sel:DWORD dst_unused:UNUSED_PAD src0_sel:DWORD src1_sel:WORD_1
v_smfmac_f32_16x16x64_bf16 v[12:15], a[220:223], v[92:99], v162 abid:1
buffer_load_dwordx4 v3, s[16:19], s45 offen offset:256 nt lds
v_add_u32_sdwa v82, s4, v121 dst_sel:DWORD dst_unused:UNUSED_PAD src0_sel:DWORD src1_sel:WORD_0
v_smfmac_f32_16x16x64_bf16 v[32:35], a[168:171], v[44:51], v157
ds_read_b128 v[68:71], v0 offset:16384
v_add_u32_sdwa v83, s4, v121 dst_sel:DWORD dst_unused:UNUSED_PAD src0_sel:DWORD src1_sel:WORD_1
v_smfmac_f32_16x16x64_bf16 v[32:35], a[204:207], v[52:59], v161
ds_read_u16 v90, v90
v_smfmac_f32_16x16x64_bf16 v[32:35], a[240:243], v[92:99], v165
s_waitcnt lgkmcnt(7)
ds_read_b128 v[72:75], v1 offset:16384
v_add_u32 v0, s43, v0
v_smfmac_f32_16x16x64_bf16 v[32:35], v[114:117], v[100:107], v183 abid:1
ds_read_u16 v91, v91
v_add_u32 v1, s43, v1
v_smfmac_f32_16x16x64_bf16 v[28:31], v[114:117], v[100:107], v183
v_smfmac_f32_16x16x64_bf16 v[36:39], v[114:117], v[100:107], v184
ds_read_b128 v[114:117], v2 offset:320
v_smfmac_f32_16x16x64_bf16 v[36:39], a[172:175], v[44:51], v157 abid:1
s_add_u32 m0, s44, 7680
v_smfmac_f32_16x16x64_bf16 v[36:39], a[208:211], v[52:59], v161 abid:1
buffer_load_dwordx4 v3, s[16:19], s45 offen offset:512 nt lds
v_smfmac_f32_16x16x64_bf16 v[36:39], a[244:247], v[92:99], v165 abid:1
v_smfmac_f32_16x16x64_bf16 v[16:19], a[152:155], v[44:51], v155
s_add_u32 m0, s44, 11520
v_smfmac_f32_16x16x64_bf16 v[16:19], a[188:191], v[52:59], v159
buffer_load_dwordx4 v3, s[16:19], s45 offen offset:768 nt lds
v_smfmac_f32_16x16x64_bf16 v[16:19], a[224:227], v[92:99], v163
s_mov_b64 exec, s[62:63]
ds_write_b32 v0, v7 offset:18432
s_mov_b64 exec, -1
v_smfmac_f32_16x16x64_bf16 v[20:23], a[156:159], v[44:51], v155 abid:1
s_add_u32 m0, s44, s8
v_smfmac_f32_16x16x64_bf16 v[20:23], a[192:195], v[52:59], v159 abid:1
s_mov_b64 exec, s[10:11]
buffer_load_dwordx4 v3, s[16:19], s7 offen offset:896 nt lds
s_mov_b64 exec, -1
v_smfmac_f32_16x16x64_bf16 v[20:23], a[228:231], v[92:99], v163 abid:1
s_add_u32 s44, s44, s5
s_cmp_ge_u32 s44, 148480
s_cselect_b32 s44, s9, s44
v_smfmac_f32_16x16x64_bf16 v[40:43], a[176:179], v[44:51], v176
v_smfmac_f32_16x16x64_bf16 v[40:43], a[212:215], v[52:59], v176 abid:1
v_smfmac_f32_16x16x64_bf16 v[40:43], a[248:251], v[92:99], v177
s_waitcnt lgkmcnt(0)
v_smfmac_f32_16x16x64_bf16 v[40:43], v[114:117], v[84:91], v185
v_smfmac_f32_16x16x64_bf16 v[36:39], v[114:117], v[84:91], v184 abid:1
s_barrier
v_smfmac_f32_16x16x64_bf16 v[8:11], a[252:255], v[60:67], v166
s_mov_b32 s42, s4
ds_read_b32 v7, v0 offset:18432
v_smfmac_f32_16x16x64_bf16 v[8:11], v[218:221], v[68:75], v170
ds_read_b128 v[44:47], v0 offset:0
v_add_u32_sdwa v84, s42, v122 dst_sel:DWORD dst_unused:UNUSED_PAD src0_sel:DWORD src1_sel:WORD_0
v_smfmac_f32_16x16x64_bf16 v[12:15], v[186:189], v[60:67], v166 abid:1
ds_read_b128 v[48:51], v1 offset:0
v_add_u32_sdwa v85, s42, v122 dst_sel:DWORD dst_unused:UNUSED_PAD src0_sel:DWORD src1_sel:WORD_1
v_smfmac_f32_16x16x64_bf16 v[12:15], v[222:225], v[68:75], v170 abid:1
ds_read_b128 v[52:55], v0 offset:2048
v_add_u32_sdwa v86, s42, v123 dst_sel:DWORD dst_unused:UNUSED_PAD src0_sel:DWORD src1_sel:WORD_0
v_smfmac_f32_16x16x64_bf16 v[16:19], v[190:193], v[60:67], v167
ds_read_b128 v[56:59], v1 offset:2048
v_cvt_pk_bf16_f32 v92, v8, v9
v_smfmac_f32_16x16x64_bf16 v[16:19], v[226:229], v[68:75], v171
ds_read_u16 v76, v76
v_cvt_pk_bf16_f32 v93, v10, v11
v_smfmac_f32_16x16x64_bf16 v[20:23], v[194:197], v[60:67], v167 abid:1
ds_read_b128 v[8:11], v2 offset:1024
v_cvt_pk_bf16_f32 v94, v12, v13
v_smfmac_f32_16x16x64_bf16 v[20:23], v[230:233], v[68:75], v171 abid:1
ds_read_u16 v77, v77
v_cvt_pk_bf16_f32 v95, v14, v15
v_smfmac_f32_16x16x64_bf16 v[24:27], v[198:201], v[60:67], v168
ds_read_b128 v[12:15], v2 offset:1088
v_cvt_pk_bf16_f32 v96, v16, v17
v_smfmac_f32_16x16x64_bf16 v[24:27], v[234:237], v[68:75], v172
s_waitcnt lgkmcnt(8)
ds_read_u16 v78, v78
v_cvt_pk_bf16_f32 v97, v18, v19
v_readfirstlane_b32 s56, v7
v_smfmac_f32_16x16x64_bf16 v[28:31], v[202:205], v[60:67], v168 abid:1
s_lshr_b32 s60, s56, 4
ds_read_b128 v[16:19], v2 offset:1152
v_cvt_pk_bf16_f32 v98, v20, v21
v_smfmac_f32_16x16x64_bf16 v[28:31], v[238:241], v[68:75], v172 abid:1
s_mul_i32 s60, s60, 884736
ds_read_u16 v79, v79
v_cvt_pk_bf16_f32 v99, v22, v23
v_smfmac_f32_16x16x64_bf16 v[32:35], v[206:209], v[60:67], v169
s_mul_i32 s61, s56, 18432
ds_read_b128 v[20:23], v2 offset:1216
v_cvt_pk_bf16_f32 v100, v24, v25
v_smfmac_f32_16x16x64_bf16 v[32:35], v[242:245], v[68:75], v173
s_add_u32 s60, s60, s57
ds_read_u16 v80, v80
v_cvt_pk_bf16_f32 v101, v26, v27
v_smfmac_f32_16x16x64_bf16 v[36:39], v[210:213], v[60:67], v169 abid:1
s_add_u32 s45, s60, s61
ds_read_b128 v[24:27], v2 offset:1280
v_cvt_pk_bf16_f32 v102, v28, v29
v_smfmac_f32_16x16x64_bf16 v[36:39], v[246:249], v[68:75], v173 abid:1
ds_read_u16 v81, v81
v_cvt_pk_bf16_f32 v103, v30, v31
v_smfmac_f32_16x16x64_bf16 v[40:43], v[214:217], v[60:67], v177 abid:1
s_cmp_lt_u32 s56, s64
ds_read_b128 v[28:31], v2 offset:1344
v_cvt_pk_bf16_f32 v104, v32, v33
v_smfmac_f32_16x16x64_bf16 v[40:43], v[250:253], v[68:75], v178
s_waitcnt lgkmcnt(10)
v_cvt_pk_bf16_f32 v105, v34, v35
s_cbranch_scc1 L_loopck
s_mov_b32 s41, 0
s_mov_b32 s15, 3
s_mov_b32 s12, 7
s_mov_b32 s92, 4
s_mov_b32 s87, 4
s_mov_b32 s59, -1
.p2align 3
L_loopnk:
v_smfmac_f32_16x16x64_bf16 v[8:11], a[0:3], v[44:51], v138
ds_read_b128 v[32:35], v2 offset:1408
v_cvt_pk_bf16_f32 v106, v36, v37
v_smfmac_f32_16x16x64_bf16 v[8:11], a[36:39], v[52:59], v142
s_waitcnt lgkmcnt(9)
v_cvt_pk_bf16_f32 v107, v38, v39
v_smfmac_f32_16x16x64_bf16 v[12:15], a[4:7], v[44:51], v138 abid:1
ds_read_b128 v[36:39], v2 offset:1472
v_cvt_pk_bf16_f32 v112, v40, v41
v_smfmac_f32_16x16x64_bf16 v[12:15], a[40:43], v[52:59], v142 abid:1
s_waitcnt lgkmcnt(8)
ds_read_b128 v[60:63], v0 offset:4096
v_cvt_pk_bf16_f32 v113, v42, v43
v_smfmac_f32_16x16x64_bf16 v[16:19], a[8:11], v[44:51], v139
s_cmp_eq_u32 s4, 129920
ds_read_b128 v[40:43], v2 offset:1536
v_cndmask_b32_dpp v108, v96, v92, vcc quad_perm:[1,0,3,2] row_mask:0xf bank_mask:0xf
v_smfmac_f32_16x16x64_bf16 v[16:19], a[44:47], v[52:59], v143
s_waitcnt lgkmcnt(8)
ds_read_u16 v82, v82
v_cndmask_b32_dpp v109, v97, v93, vcc quad_perm:[1,0,3,2] row_mask:0xf bank_mask:0xf
v_smfmac_f32_16x16x64_bf16 v[20:23], a[12:15], v[44:51], v139 abid:1
s_cselect_b32 s43, -129920, s5
ds_read_u16 v84, v84
v_cndmask_b32_dpp v110, v98, v94, vcc quad_perm:[1,0,3,2] row_mask:0xf bank_mask:0xf
v_smfmac_f32_16x16x64_bf16 v[20:23], a[48:51], v[52:59], v143 abid:1
s_waitcnt lgkmcnt(8)
ds_read_b128 v[64:67], v1 offset:4096
v_cndmask_b32_dpp v111, v99, v95, vcc quad_perm:[1,0,3,2] row_mask:0xf bank_mask:0xf
v_smfmac_f32_16x16x64_bf16 v[24:27], a[16:19], v[44:51], v140
s_add_u32 s4, s4, s43
ds_read_b128 v[68:71], v0 offset:6144
v_add_u32_sdwa v87, s42, v123 dst_sel:DWORD dst_unused:UNUSED_PAD src0_sel:DWORD src1_sel:WORD_1
v_smfmac_f32_16x16x64_bf16 v[24:27], a[52:55], v[52:59], v144
buffer_store_dwordx4 v[108:111], v4, s[20:23], s46 offen offset:0 sc1
s_mov_b64 vcc, s[82:83]
s_waitcnt lgkmcnt(8)
ds_read_b128 v[72:75], v1 offset:6144
v_cndmask_b32_dpp v96, v92, v96, vcc quad_perm:[1,0,3,2] row_mask:0xf bank_mask:0xf
v_cndmask_b32_dpp v97, v93, v97, vcc quad_perm:[1,0,3,2] row_mask:0xf bank_mask:0xf
v_smfmac_f32_16x16x64_bf16 v[28:31], a[20:23], v[44:51], v140 abid:1
s_add_u32 s41, s41, 1
ds_read_u16 v83, v83
v_cndmask_b32_dpp v98, v94, v98, vcc quad_perm:[1,0,3,2] row_mask:0xf bank_mask:0xf
v_smfmac_f32_16x16x64_bf16 v[28:31], a[56:59], v[52:59], v144 abid:1
s_waitcnt lgkmcnt(9)
ds_read_b128 v[114:117], v2 offset:64
v_cndmask_b32_dpp v99, v95, v99, vcc quad_perm:[1,0,3,2] row_mask:0xf bank_mask:0xf
v_smfmac_f32_16x16x64_bf16 v[32:35], a[24:27], v[44:51], v141
ds_read_u16 v85, v85
v_add_u32_sdwa v88, s42, v124 dst_sel:DWORD dst_unused:UNUSED_PAD src0_sel:DWORD src1_sel:WORD_0
v_smfmac_f32_16x16x64_bf16 v[32:35], a[60:63], v[52:59], v145
s_waitcnt lgkmcnt(10)
ds_read_u16 v86, v86
v_add_u32_sdwa v89, s42, v124 dst_sel:DWORD dst_unused:UNUSED_PAD src0_sel:DWORD src1_sel:WORD_1
v_smfmac_f32_16x16x64_bf16 v[36:39], a[28:31], v[44:51], v141 abid:1
ds_read_u16 v87, v87
v_add_u32_sdwa v90, s42, v125 dst_sel:DWORD dst_unused:UNUSED_PAD src0_sel:DWORD src1_sel:WORD_0
v_smfmac_f32_16x16x64_bf16 v[36:39], a[64:67], v[52:59], v145 abid:1
s_waitcnt lgkmcnt(10)
ds_read_u16 v88, v88
v_add_u32_sdwa v91, s42, v125 dst_sel:DWORD dst_unused:UNUSED_PAD src0_sel:DWORD src1_sel:WORD_1
v_smfmac_f32_16x16x64_bf16 v[40:43], a[32:35], v[44:51], v174
buffer_store_dwordx4 v[96:99], v4, s[20:23], s46 offen offset:1152 sc1
s_mov_b64 vcc, s[80:81]
ds_read_u16 v89, v89
v_cndmask_b32_dpp v92, v104, v100, vcc quad_perm:[1,0,3,2] row_mask:0xf bank_mask:0xf
v_cndmask_b32_dpp v93, v105, v101, vcc quad_perm:[1,0,3,2] row_mask:0xf bank_mask:0xf
v_smfmac_f32_16x16x64_bf16 v[40:43], a[68:71], v[52:59], v174 abid:1
s_waitcnt lgkmcnt(9)
ds_read_u16 v90, v90
v_cndmask_b32_dpp v94, v106, v102, vcc quad_perm:[1,0,3,2] row_mask:0xf bank_mask:0xf
v_smfmac_f32_16x16x64_bf16 v[8:11], a[72:75], v[60:67], v146
s_waitcnt lgkmcnt(8)
ds_read_u16 v91, v91
v_cndmask_b32_dpp v95, v107, v103, vcc quad_perm:[1,0,3,2] row_mask:0xf bank_mask:0xf
v_smfmac_f32_16x16x64_bf16 v[8:11], a[108:111], v[68:75], v150
s_waitcnt lgkmcnt(7)
ds_bpermute_b32 v112, v6, v112
v_smfmac_f32_16x16x64_bf16 v[8:11], v[114:117], v[76:83], v179
ds_bpermute_b32 v113, v6, v113
v_smfmac_f32_16x16x64_bf16 v[12:15], v[114:117], v[76:83], v179 abid:1
ds_read_b128 v[114:117], v2 offset:128
v_add_u32_sdwa v76, s42, v126 dst_sel:DWORD dst_unused:UNUSED_PAD src0_sel:DWORD src1_sel:WORD_0
v_smfmac_f32_16x16x64_bf16 v[12:15], a[76:79], v[60:67], v146 abid:1
ds_read_u16 v76, v76
v_add_u32_sdwa v77, s42, v126 dst_sel:DWORD dst_unused:UNUSED_PAD src0_sel:DWORD src1_sel:WORD_1
v_smfmac_f32_16x16x64_bf16 v[12:15], a[112:115], v[68:75], v150 abid:1
buffer_store_dwordx4 v[92:95], v4, s[20:23], s46 offen offset:128 sc1
s_mov_b64 vcc, s[82:83]
ds_read_u16 v77, v77
v_cndmask_b32_dpp v104, v100, v104, vcc quad_perm:[1,0,3,2] row_mask:0xf bank_mask:0xf
v_cndmask_b32_dpp v105, v101, v105, vcc quad_perm:[1,0,3,2] row_mask:0xf bank_mask:0xf
v_smfmac_f32_16x16x64_bf16 v[24:27], a[88:91], v[60:67], v148
ds_read_b128 v[44:47], v0 offset:8192
v_add_u32_sdwa v78, s42, v127 dst_sel:DWORD dst_unused:UNUSED_PAD src0_sel:DWORD src1_sel:WORD_0
v_smfmac_f32_16x16x64_bf16 v[24:27], a[124:127], v[68:75], v152
ds_read_u16 v78, v78
v_cndmask_b32_dpp v106, v102, v106, vcc quad_perm:[1,0,3,2] row_mask:0xf bank_mask:0xf
v_smfmac_f32_16x16x64_bf16 v[28:31], a[92:95], v[60:67], v148 abid:1
ds_read_b128 v[48:51], v1 offset:8192
v_cndmask_b32_dpp v107, v103, v107, vcc quad_perm:[1,0,3,2] row_mask:0xf bank_mask:0xf
v_smfmac_f32_16x16x64_bf16 v[28:31], a[128:131], v[68:75], v152 abid:1
ds_read_b128 v[52:55], v0 offset:10240
v_add_u32_sdwa v79, s42, v127 dst_sel:DWORD dst_unused:UNUSED_PAD src0_sel:DWORD src1_sel:WORD_1
v_smfmac_f32_16x16x64_bf16 v[32:35], a[96:99], v[60:67], v149
ds_read_u16 v79, v79
v_add_u32_sdwa v80, s42, v128 dst_sel:DWORD dst_unused:UNUSED_PAD src0_sel:DWORD src1_sel:WORD_0
v_smfmac_f32_16x16x64_bf16 v[32:35], a[132:135], v[68:75], v153
ds_read_u16 v80, v80
v_add_u32_sdwa v81, s42, v128 dst_sel:DWORD dst_unused:UNUSED_PAD src0_sel:DWORD src1_sel:WORD_1
v_smfmac_f32_16x16x64_bf16 v[16:19], a[80:83], v[60:67], v147
buffer_store_dwordx4 v[104:107], v4, s[20:23], s46 offen offset:1280 sc1
s_mov_b64 vcc, s[80:81]
ds_read_b128 v[56:59], v1 offset:10240
v_add_u32_sdwa v82, s42, v129 dst_sel:DWORD dst_unused:UNUSED_PAD src0_sel:DWORD src1_sel:WORD_0
v_add_u32_sdwa v83, s42, v129 dst_sel:DWORD dst_unused:UNUSED_PAD src0_sel:DWORD src1_sel:WORD_1
v_smfmac_f32_16x16x64_bf16 v[16:19], a[116:119], v[68:75], v151
s_waitcnt lgkmcnt(9)
ds_read_b128 v[92:95], v0 offset:12288
v_add_u32_sdwa v100, s42, v130 dst_sel:DWORD dst_unused:UNUSED_PAD src0_sel:DWORD src1_sel:WORD_0
v_smfmac_f32_16x16x64_bf16 v[16:19], v[114:117], v[84:91], v180 abid:1
ds_read_u16 v81, v81
v_add_u32_sdwa v101, s42, v130 dst_sel:DWORD dst_unused:UNUSED_PAD src0_sel:DWORD src1_sel:WORD_1
v_smfmac_f32_16x16x64_bf16 v[12:15], v[114:117], v[84:91], v180
ds_read_b128 v[96:99], v1 offset:12288
v_add_u32_sdwa v102, s42, v131 dst_sel:DWORD dst_unused:UNUSED_PAD src0_sel:DWORD src1_sel:WORD_0
v_smfmac_f32_16x16x64_bf16 v[20:23], v[114:117], v[84:91], v181
ds_read_u16 v82, v82
v_add_u32_sdwa v103, s42, v131 dst_sel:DWORD dst_unused:UNUSED_PAD src0_sel:DWORD src1_sel:WORD_1
v_smfmac_f32_16x16x64_bf16 v[20:23], a[84:87], v[60:67], v147 abid:1
ds_read_u16 v100, v100
v_add_u32_sdwa v104, s42, v132 dst_sel:DWORD dst_unused:UNUSED_PAD src0_sel:DWORD src1_sel:WORD_0
v_smfmac_f32_16x16x64_bf16 v[20:23], a[120:123], v[68:75], v151 abid:1
ds_read_u16 v83, v83
v_add_u32_sdwa v105, s42, v132 dst_sel:DWORD dst_unused:UNUSED_PAD src0_sel:DWORD src1_sel:WORD_1
v_smfmac_f32_16x16x64_bf16 v[36:39], a[100:103], v[60:67], v149 abid:1
buffer_store_dwordx2 v[112:113], v5, s[20:23], s46 offen nt
ds_read_b128 v[114:117], v2 offset:192
v_add_u32_sdwa v106, s42, v133 dst_sel:DWORD dst_unused:UNUSED_PAD src0_sel:DWORD src1_sel:WORD_0
v_smfmac_f32_16x16x64_bf16 v[36:39], a[136:139], v[68:75], v153 abid:1
s_mov_b32 s22, 75497472
ds_read_u16 v101, v101
v_add_u32_sdwa v107, s42, v133 dst_sel:DWORD dst_unused:UNUSED_PAD src0_sel:DWORD src1_sel:WORD_1
v_smfmac_f32_16x16x64_bf16 v[40:43], a[104:107], v[60:67], v175
s_mov_b32 s46, s48
ds_read_u16 v102, v102
v_add_u32_sdwa v84, s42, v134 dst_sel:DWORD dst_unused:UNUSED_PAD src0_sel:DWORD src1_sel:WORD_0
v_smfmac_f32_16x16x64_bf16 v[40:43], a[140:143], v[68:75], v175 abid:1
s_waitcnt lgkmcnt(13)
ds_read_u16 v103, v103
v_add_u32_sdwa v85, s42, v134 dst_sel:DWORD dst_unused:UNUSED_PAD src0_sel:DWORD src1_sel:WORD_1
v_smfmac_f32_16x16x64_bf16 v[8:11], a[144:147], v[44:51], v154
s_waitcnt lgkmcnt(10)
ds_read_u16 v104, v104
v_add_u32_sdwa v86, s42, v135 dst_sel:DWORD dst_unused:UNUSED_PAD src0_sel:DWORD src1_sel:WORD_0
v_smfmac_f32_16x16x64_bf16 v[8:11], a[180:183], v[52:59], v158
s_waitcnt lgkmcnt(8)
ds_read_u16 v105, v105
v_add_u32_sdwa v87, s42, v135 dst_sel:DWORD dst_unused:UNUSED_PAD src0_sel:DWORD src1_sel:WORD_1
v_smfmac_f32_16x16x64_bf16 v[8:11], a[216:219], v[92:99], v162
s_mov_b32 s48, s49
ds_read_u16 v106, v106
v_add_u32_sdwa v88, s42, v136 dst_sel:DWORD dst_unused:UNUSED_PAD src0_sel:DWORD src1_sel:WORD_0
v_smfmac_f32_16x16x64_bf16 v[24:27], a[160:163], v[44:51], v156
s_mov_b32 s49, s50
s_add_u32 s50, s50, 4718592
v_add_u32_sdwa v89, s42, v136 dst_sel:DWORD dst_unused:UNUSED_PAD src0_sel:DWORD src1_sel:WORD_1
v_smfmac_f32_16x16x64_bf16 v[24:27], a[196:199], v[52:59], v160
ds_read_u16 v107, v107
v_add_u32_sdwa v90, s42, v137 dst_sel:DWORD dst_unused:UNUSED_PAD src0_sel:DWORD src1_sel:WORD_0
v_smfmac_f32_16x16x64_bf16 v[24:27], a[232:235], v[92:99], v164
s_waitcnt lgkmcnt(7)
ds_read_u16 v84, v84
v_add_u32_sdwa v91, s42, v137 dst_sel:DWORD dst_unused:UNUSED_PAD src0_sel:DWORD src1_sel:WORD_1
v_smfmac_f32_16x16x64_bf16 v[24:27], v[114:117], v[76:83], v182
ds_read_u16 v85, v85
v_smfmac_f32_16x16x64_bf16 v[20:23], v[114:117], v[76:83], v181 abid:1
ds_read_u16 v86, v86
v_smfmac_f32_16x16x64_bf16 v[28:31], v[114:117], v[76:83], v182 abid:1
ds_read_b128 v[114:117], v2 offset:256
v_add_u32_sdwa v76, s4, v118 dst_sel:DWORD dst_unused:UNUSED_PAD src0_sel:DWORD src1_sel:WORD_0
v_smfmac_f32_16x16x64_bf16 v[28:31], a[164:167], v[44:51], v156 abid:1
ds_read_u16 v87, v87
v_add_u32_sdwa v77, s4, v118 dst_sel:DWORD dst_unused:UNUSED_PAD src0_sel:DWORD src1_sel:WORD_1
v_smfmac_f32_16x16x64_bf16 v[28:31], a[200:203], v[52:59], v160 abid:1
ds_read_u16 v88, v88
v_add_u32_sdwa v78, s4, v119 dst_sel:DWORD dst_unused:UNUSED_PAD src0_sel:DWORD src1_sel:WORD_0
v_smfmac_f32_16x16x64_bf16 v[28:31], a[236:239], v[92:99], v164 abid:1
ds_read_b128 v[60:63], v0 offset:14336
v_add_u32_sdwa v79, s4, v119 dst_sel:DWORD dst_unused:UNUSED_PAD src0_sel:DWORD src1_sel:WORD_1
v_smfmac_f32_16x16x64_bf16 v[12:15], a[148:151], v[44:51], v154 abid:1
ds_read_u16 v89, v89
v_add_u32_sdwa v80, s4, v120 dst_sel:DWORD dst_unused:UNUSED_PAD src0_sel:DWORD src1_sel:WORD_0
v_smfmac_f32_16x16x64_bf16 v[12:15], a[184:187], v[52:59], v158 abid:1
ds_read_b128 v[64:67], v1 offset:14336
v_add_u32_sdwa v81, s4, v120 dst_sel:DWORD dst_unused:UNUSED_PAD src0_sel:DWORD src1_sel:WORD_1
v_smfmac_f32_16x16x64_bf16 v[12:15], a[220:223], v[92:99], v162 abid:1
v_add_u32_sdwa v82, s4, v121 dst_sel:DWORD dst_unused:UNUSED_PAD src0_sel:DWORD src1_sel:WORD_0
v_smfmac_f32_16x16x64_bf16 v[32:35], a[168:171], v[44:51], v157
ds_read_b128 v[68:71], v0 offset:16384
v_add_u32_sdwa v83, s4, v121 dst_sel:DWORD dst_unused:UNUSED_PAD src0_sel:DWORD src1_sel:WORD_1
v_smfmac_f32_16x16x64_bf16 v[32:35], a[204:207], v[52:59], v161
ds_read_u16 v90, v90
v_smfmac_f32_16x16x64_bf16 v[32:35], a[240:243], v[92:99], v165
s_waitcnt lgkmcnt(7)
ds_read_b128 v[72:75], v1 offset:16384
v_add_u32 v0, s43, v0
v_smfmac_f32_16x16x64_bf16 v[32:35], v[114:117], v[100:107], v183 abid:1
ds_read_u16 v91, v91
v_add_u32 v1, s43, v1
v_smfmac_f32_16x16x64_bf16 v[28:31], v[114:117], v[100:107], v183
v_smfmac_f32_16x16x64_bf16 v[36:39], v[114:117], v[100:107], v184
ds_read_b128 v[114:117], v2 offset:320
v_smfmac_f32_16x16x64_bf16 v[36:39], a[172:175], v[44:51], v157 abid:1
v_smfmac_f32_16x16x64_bf16 v[36:39], a[208:211], v[52:59], v161 abid:1
v_smfmac_f32_16x16x64_bf16 v[36:39], a[244:247], v[92:99], v165 abid:1
v_smfmac_f32_16x16x64_bf16 v[16:19], a[152:155], v[44:51], v155
v_smfmac_f32_16x16x64_bf16 v[16:19], a[188:191], v[52:59], v159
v_smfmac_f32_16x16x64_bf16 v[16:19], a[224:227], v[92:99], v163
v_smfmac_f32_16x16x64_bf16 v[20:23], a[156:159], v[44:51], v155 abid:1
v_smfmac_f32_16x16x64_bf16 v[20:23], a[192:195], v[52:59], v159 abid:1
v_smfmac_f32_16x16x64_bf16 v[20:23], a[228:231], v[92:99], v163 abid:1
v_smfmac_f32_16x16x64_bf16 v[40:43], a[176:179], v[44:51], v176
s_bitcmp1_b32 s92, s41
v_smfmac_f32_16x16x64_bf16 v[40:43], a[212:215], v[52:59], v176 abid:1
s_cbranch_scc1 L_loopnk_w
L_loopnk_wb:
v_smfmac_f32_16x16x64_bf16 v[40:43], a[248:251], v[92:99], v177
s_waitcnt lgkmcnt(0)
v_smfmac_f32_16x16x64_bf16 v[40:43], v[114:117], v[84:91], v185
v_smfmac_f32_16x16x64_bf16 v[36:39], v[114:117], v[84:91], v184 abid:1
L_loopnk_p3:
v_smfmac_f32_16x16x64_bf16 v[8:11], a[252:255], v[60:67], v166
s_mov_b32 s42, s4
v_smfmac_f32_16x16x64_bf16 v[8:11], v[218:221], v[68:75], v170
ds_read_b128 v[44:47], v0 offset:0
v_add_u32_sdwa v84, s42, v122 dst_sel:DWORD dst_unused:UNUSED_PAD src0_sel:DWORD src1_sel:WORD_0
v_smfmac_f32_16x16x64_bf16 v[12:15], v[186:189], v[60:67], v166 abid:1
ds_read_b128 v[48:51], v1 offset:0
v_add_u32_sdwa v85, s42, v122 dst_sel:DWORD dst_unused:UNUSED_PAD src0_sel:DWORD src1_sel:WORD_1
v_smfmac_f32_16x16x64_bf16 v[12:15], v[222:225], v[68:75], v170 abid:1
ds_read_b128 v[52:55], v0 offset:2048
v_add_u32_sdwa v86, s42, v123 dst_sel:DWORD dst_unused:UNUSED_PAD src0_sel:DWORD src1_sel:WORD_0
v_smfmac_f32_16x16x64_bf16 v[16:19], v[190:193], v[60:67], v167
ds_read_b128 v[56:59], v1 offset:2048
v_cvt_pk_bf16_f32 v92, v8, v9
v_smfmac_f32_16x16x64_bf16 v[16:19], v[226:229], v[68:75], v171
ds_read_u16 v76, v76
v_cvt_pk_bf16_f32 v93, v10, v11
v_smfmac_f32_16x16x64_bf16 v[20:23], v[194:197], v[60:67], v167 abid:1
ds_read_b128 v[8:11], v2 offset:1024
v_cvt_pk_bf16_f32 v94, v12, v13
v_smfmac_f32_16x16x64_bf16 v[20:23], v[230:233], v[68:75], v171 abid:1
ds_read_u16 v77, v77
v_cvt_pk_bf16_f32 v95, v14, v15
v_smfmac_f32_16x16x64_bf16 v[24:27], v[198:201], v[60:67], v168
ds_read_b128 v[12:15], v2 offset:1088
v_cvt_pk_bf16_f32 v96, v16, v17
v_smfmac_f32_16x16x64_bf16 v[24:27], v[234:237], v[68:75], v172
ds_read_u16 v78, v78
v_cvt_pk_bf16_f32 v97, v18, v19
v_smfmac_f32_16x16x64_bf16 v[28:31], v[202:205], v[60:67], v168 abid:1
ds_read_b128 v[16:19], v2 offset:1152
v_cvt_pk_bf16_f32 v98, v20, v21
v_smfmac_f32_16x16x64_bf16 v[28:31], v[238:241], v[68:75], v172 abid:1
ds_read_u16 v79, v79
v_cvt_pk_bf16_f32 v99, v22, v23
v_smfmac_f32_16x16x64_bf16 v[32:35], v[206:209], v[60:67], v169
ds_read_b128 v[20:23], v2 offset:1216
v_cvt_pk_bf16_f32 v100, v24, v25
v_smfmac_f32_16x16x64_bf16 v[32:35], v[242:245], v[68:75], v173
ds_read_u16 v80, v80
v_cvt_pk_bf16_f32 v101, v26, v27
v_smfmac_f32_16x16x64_bf16 v[36:39], v[210:213], v[60:67], v169 abid:1
ds_read_b128 v[24:27], v2 offset:1280
v_cvt_pk_bf16_f32 v102, v28, v29
v_smfmac_f32_16x16x64_bf16 v[36:39], v[246:249], v[68:75], v173 abid:1
ds_read_u16 v81, v81
v_cvt_pk_bf16_f32 v103, v30, v31
v_smfmac_f32_16x16x64_bf16 v[40:43], v[214:217], v[60:67], v177 abid:1
s_bitcmp1_b32 s12, s41
ds_read_b128 v[28:31], v2 offset:1344
v_cvt_pk_bf16_f32 v104, v32, v33
v_smfmac_f32_16x16x64_bf16 v[40:43], v[250:253], v[68:75], v178
s_waitcnt lgkmcnt(10)
v_cvt_pk_bf16_f32 v105, v34, v35
s_cbranch_scc1 L_loopnk
s_cmp_eq_u32 s41, s59
s_cbranch_scc1 L_loopck
s_cmp_lt_u32 s41, s15
s_cbranch_scc1 L_loopk
s_nop 0
v_cndmask_b32_dpp v108, v96, v92, vcc quad_perm:[1,0,3,2] row_mask:0xf bank_mask:0xf
v_cndmask_b32_dpp v109, v97, v93, vcc quad_perm:[1,0,3,2] row_mask:0xf bank_mask:0xf
v_cndmask_b32_dpp v110, v98, v94, vcc quad_perm:[1,0,3,2] row_mask:0xf bank_mask:0xf
v_cndmask_b32_dpp v111, v99, v95, vcc quad_perm:[1,0,3,2] row_mask:0xf bank_mask:0xf
buffer_store_dwordx4 v[108:111], v4, s[20:23], s46 offen offset:0 sc1
s_mov_b64 vcc, s[82:83]
v_cvt_pk_bf16_f32 v112, v40, v41
v_cvt_pk_bf16_f32 v113, v42, v43
ds_bpermute_b32 v112, v6, v112
ds_bpermute_b32 v113, v6, v113
v_cndmask_b32_dpp v96, v92, v96, vcc quad_perm:[1,0,3,2] row_mask:0xf bank_mask:0xf
v_cndmask_b32_dpp v97, v93, v97, vcc quad_perm:[1,0,3,2] row_mask:0xf bank_mask:0xf
v_cndmask_b32_dpp v98, v94, v98, vcc quad_perm:[1,0,3,2] row_mask:0xf bank_mask:0xf
v_cndmask_b32_dpp v99, v95, v99, vcc quad_perm:[1,0,3,2] row_mask:0xf bank_mask:0xf
buffer_store_dwordx4 v[96:99], v4, s[20:23], s46 offen offset:1152 sc1
s_mov_b64 vcc, s[80:81]
v_cvt_pk_bf16_f32 v106, v36, v37
v_cvt_pk_bf16_f32 v107, v38, v39
v_cndmask_b32_dpp v92, v104, v100, vcc quad_perm:[1,0,3,2] row_mask:0xf bank_mask:0xf
v_cndmask_b32_dpp v93, v105, v101, vcc quad_perm:[1,0,3,2] row_mask:0xf bank_mask:0xf
v_cndmask_b32_dpp v94, v106, v102, vcc quad_perm:[1,0,3,2] row_mask:0xf bank_mask:0xf
v_cndmask_b32_dpp v95, v107, v103, vcc quad_perm:[1,0,3,2] row_mask:0xf bank_mask:0xf
buffer_store_dwordx4 v[92:95], v4, s[20:23], s46 offen offset:128 sc1
s_mov_b64 vcc, s[82:83]
v_cndmask_b32_dpp v104, v100, v104, vcc quad_perm:[1,0,3,2] row_mask:0xf bank_mask:0xf
v_cndmask_b32_dpp v105, v101, v105, vcc quad_perm:[1,0,3,2] row_mask:0xf bank_mask:0xf
v_cndmask_b32_dpp v106, v102, v106, vcc quad_perm:[1,0,3,2] row_mask:0xf bank_mask:0xf
v_cndmask_b32_dpp v107, v103, v107, vcc quad_perm:[1,0,3,2] row_mask:0xf bank_mask:0xf
buffer_store_dwordx4 v[104:107], v4, s[20:23], s46 offen offset:1280 sc1
s_mov_b64 vcc, s[80:81]
s_waitcnt lgkmcnt(0)
buffer_store_dwordx2 v[112:113], v5, s[20:23], s46 offen nt
s_branch L_fin
L_loopk_w:
s_bitcmp1_b32 s87, s41
s_waitcnt vmcnt(15)
s_cbranch_scc0 L_loopk_wb
s_waitcnt vmcnt(10)
s_branch L_loopk_wb
L_loopnk_w:
s_bitcmp1_b32 s87, s41
s_waitcnt vmcnt(15) lgkmcnt(0)
s_cbranch_scc0 L_loopnk_w1
s_waitcnt vmcnt(10)
L_loopnk_w1:
s_barrier
s_branch L_loopnk_wb
L_slow:
s_waitcnt vmcnt(0) lgkmcnt(0)
s_mov_b32 s87, 0
L_sm:
s_lshl_b32 s86, s2, 1
s_add_u32 s86, s86, s87
s_add_u32 s86, s86, 2
s_mul_i32 s86, s86, 393216
s_mov_b32 s84, 0
L_st:
s_and_b32 s48, s84, 3
s_lshr_b32 s49, s84, 2
s_cmp_ge_u32 s84, 36
s_cbranch_scc1 L_pbg
s_mul_i32 s52, s49, 288
s_add_u32 s52, s52, s48
s_lshl_b32 s52, s52, 8
v_lshl_add_u32 v50, v7, 2, s52
L_pbbg:
s_mul_i32 s52, s40, 18432
v_mov_b32 v62, s52
v_add_u32 v50, v62, v50
buffer_load_dword v8, v50, s[28:31], 0 offen offset:0
buffer_load_dword v9, v50, s[28:31], 0 offen offset:1152
buffer_load_dword v10, v50, s[28:31], 0 offen offset:2304
buffer_load_dword v11, v50, s[28:31], 0 offen offset:3456
v_add_u32 v50, 4608, v50
buffer_load_dword v12, v50, s[28:31], 0 offen offset:0
buffer_load_dword v13, v50, s[28:31], 0 offen offset:1152
buffer_load_dword v14, v50, s[28:31], 0 offen offset:2304
buffer_load_dword v15, v50, s[28:31], 0 offen offset:3456
v_add_u32 v50, 4608, v50
buffer_load_dword v16, v50, s[28:31], 0 offen offset:0
buffer_load_dword v17, v50, s[28:31], 0 offen offset:1152
buffer_load_dword v18, v50, s[28:31], 0 offen offset:2304
buffer_load_dword v19, v50, s[28:31], 0 offen offset:3456
v_add_u32 v50, 4608, v50
buffer_load_dword v20, v50, s[28:31], 0 offen offset:0
buffer_load_dword v21, v50, s[28:31], 0 offen offset:1152
buffer_load_dword v22, v50, s[28:31], 0 offen offset:2304
buffer_load_dword v23, v50, s[28:31], 0 offen offset:3456
s_branch L_pcg
L_pbg:
s_mul_i32 s52, s84, 147456
s_sub_u32 s52, s52, 5307392
v_and_b32 v62, 2, v7
v_mul_u32_u24 v50, 36864, v62
v_and_b32 v62, 1, v7
v_lshl_add_u32 v50, v62, 2, v50
v_and_b32 v62, 4, v7
v_lshl_add_u32 v50, v62, 3, v50
v_and_b32 v62, 32, v7
v_lshl_add_u32 v50, v62, 1, v50
v_and_b32 v62, 24, v7
v_add3_u32 v50, v50, v62, s52
s_branch L_pbbg
L_pcg:
s_sub_u32 s50, s84, 36
s_lshl_b32 s51, s40, 4
v_and_b32 v58, 1, v7
v_bfe_u32 v59, v7, 1, 1
v_bfe_u32 v60, v7, 3, 2
s_mul_i32 s52, s48, 9
s_add_u32 s52, s52, s49
s_mul_i32 s53, s52, 9
s_mul_i32 s54, s50, 18
s_add_u32 s54, s54, 8
s_lshl_b32 s55, s52, 2
s_add_u32 s55, s55, s40
s_lshl_b32 s56, s50, 2
s_add_u32 s56, s56, s40
s_cmp_eq_u32 s84, 40
s_cselect_b32 s57, 0x100000, 9
s_cmp_lt_u32 s84, 36
s_cselect_b32 s53, s53, s54
s_cselect_b32 s54, 2, 81
s_cselect_b32 s57, 1, s57
s_cselect_b32 s55, s55, s56
s_mov_b32 s56, 331776
s_cselect_b32 s56, s56, 368640
s_mov_b32 s58, 373760
s_cselect_b32 s58, s58, 382976
s_cselect_b32 s59, 16, 4
s_cselect_b32 s60, 4, 64
s_cselect_b32 s61, 12, 11
s_cselect_b32 s62, 1, 0x8001
v_bfe_u32 v61, v7, 2, 1
v_lshrrev_b32 v62, 5, v7
v_lshl_add_u32 v61, v62, 1, v61
v_lshlrev_b32 v62, 1, v58
v_lshl_add_u32 v60, v60, 2, v62
v_add_u32 v62, v60, v59
v_mul_u32_u24 v51, s54, v61
v_add_lshl_u32 v51, v51, s53, 6
v_add3_u32 v51, v51, v62, s51
v_lshl_add_u32 v51, v51, 4, s86
s_lshl_b32 s57, s57, 10
v_add_u32 v66, s57, v51
s_lshl_b32 s52, s55, 8
s_add_u32 s52, s52, s56
s_add_u32 s52, s52, s86
v_mul_u32_u24 v52, s59, v62
v_mad_u32_u24 v52, v61, s60, v52
v_lshl_add_u32 v54, v7, 2, s52
v_mov_b32 v55, 0x05040100
v_mov_b32 v62, 0x03020706
v_cmp_eq_u32 vcc, 1, v59
v_mov_b32 v68, 0xf0a0500
v_mov_b32 v69, 0x8f8a8580
v_mov_b32 v70, 0x1f1a1510
v_mov_b32 v71, 0x9f9a9590
v_mov_b32 v72, 0x2f2a2520
v_mov_b32 v73, 0xafaaa5a0
v_mov_b32 v74, 0x3f3a3530
v_mov_b32 v75, 0xbfbab5b0
v_cndmask_b32 v55, v55, v62, vcc
s_mov_b32 s64, 0x5040500
s_mov_b32 s65, 0x5040501
s_mov_b32 s66, 0x5040502
s_mov_b32 s67, 0x5040503
s_mov_b32 s68, 0x7060700
s_mov_b32 s69, 0x7060701
s_mov_b32 s70, 0x7060702
s_mov_b32 s71, 0x7060703
s_mov_b32 s72, 0x05060102
s_cmp_lg_u32 s87, 0
s_waitcnt vmcnt(12)
v_perm_b32 v24, v8, v68, s64
v_perm_b32 v25, v9, v68, s65
v_perm_b32 v26, v10, v68, s66
v_perm_b32 v27, v11, v68, s67
v_max3_f32 v28, |v24|, |v25|, |v26|
v_med3_f32 v29, |v24|, |v25|, |v26|
v_min3_f32 v30, |v24|, |v25|, |v26|
v_med3_f32 v32, v28, v29, |v27|
v_med3_f32 v33, v29, v30, |v27|
v_max_f32 v31, v28, |v27|
v_cmp_eq_u32_sdwa vcc, v33, v32 src0_sel:WORD_1 src1_sel:WORD_1
s_cbranch_scc0 L_rb0g
v_min_f32 v30, v30, |v27|
v_cndmask_b32 v31, 0, v33, vcc
v_cmp_eq_u32_sdwa vcc, v30, v32 src0_sel:WORD_1 src1_sel:WORD_1
s_nop 1
v_cndmask_b32 v32, 0, v30, vcc
L_rb0g:
v_perm_b32 v36, v31, v32, s72
v_bfi_b32 v44, 3, v32, v31
v_perm_b32 v24, v8, v69, s68
v_perm_b32 v25, v9, v69, s69
v_perm_b32 v26, v10, v69, s70
v_perm_b32 v27, v11, v69, s71
v_max3_f32 v28, |v24|, |v25|, |v26|
v_med3_f32 v29, |v24|, |v25|, |v26|
v_min3_f32 v30, |v24|, |v25|, |v26|
v_med3_f32 v32, v28, v29, |v27|
v_med3_f32 v33, v29, v30, |v27|
v_max_f32 v31, v28, |v27|
v_cmp_eq_u32_sdwa vcc, v33, v32 src0_sel:WORD_1 src1_sel:WORD_1
s_cbranch_scc0 L_rb1g
v_min_f32 v30, v30, |v27|
v_cndmask_b32 v31, 0, v33, vcc
v_cmp_eq_u32_sdwa vcc, v30, v32 src0_sel:WORD_1 src1_sel:WORD_1
s_nop 1
v_cndmask_b32 v32, 0, v30, vcc
L_rb1g:
v_perm_b32 v40, v31, v32, s72
v_bfi_b32 v46, 3, v32, v31
s_waitcnt vmcnt(8)
v_perm_b32 v24, v12, v70, s64
v_perm_b32 v25, v13, v70, s65
v_perm_b32 v26, v14, v70, s66
v_perm_b32 v27, v15, v70, s67
v_max3_f32 v28, |v24|, |v25|, |v26|
v_med3_f32 v29, |v24|, |v25|, |v26|
v_min3_f32 v30, |v24|, |v25|, |v26|
v_med3_f32 v32, v28, v29, |v27|
v_med3_f32 v33, v29, v30, |v27|
v_max_f32 v31, v28, |v27|
v_cmp_eq_u32_sdwa vcc, v33, v32 src0_sel:WORD_1 src1_sel:WORD_1
s_cbranch_scc0 L_rb2g
v_min_f32 v30, v30, |v27|
v_cndmask_b32 v31, 0, v33, vcc
v_cmp_eq_u32_sdwa vcc, v30, v32 src0_sel:WORD_1 src1_sel:WORD_1
s_nop 1
v_cndmask_b32 v32, 0, v30, vcc
L_rb2g:
v_perm_b32 v37, v31, v32, s72
v_bfi_b32 v31, 3, v32, v31
v_lshlrev_b32 v31, 4, v31
v_bfi_b32 v44, 15, v44, v31
v_perm_b32 v24, v12, v71, s68
v_perm_b32 v25, v13, v71, s69
v_perm_b32 v26, v14, v71, s70
v_perm_b32 v27, v15, v71, s71
v_max3_f32 v28, |v24|, |v25|, |v26|
v_med3_f32 v29, |v24|, |v25|, |v26|
v_min3_f32 v30, |v24|, |v25|, |v26|
v_med3_f32 v32, v28, v29, |v27|
v_med3_f32 v33, v29, v30, |v27|
v_max_f32 v31, v28, |v27|
v_cmp_eq_u32_sdwa vcc, v33, v32 src0_sel:WORD_1 src1_sel:WORD_1
s_cbranch_scc0 L_rb3g
v_min_f32 v30, v30, |v27|
v_cndmask_b32 v31, 0, v33, vcc
v_cmp_eq_u32_sdwa vcc, v30, v32 src0_sel:WORD_1 src1_sel:WORD_1
s_nop 1
v_cndmask_b32 v32, 0, v30, vcc
L_rb3g:
v_perm_b32 v41, v31, v32, s72
v_bfi_b32 v31, 3, v32, v31
v_lshlrev_b32 v31, 4, v31
v_bfi_b32 v46, 15, v46, v31
s_waitcnt vmcnt(4)
v_perm_b32 v24, v16, v72, s64
v_perm_b32 v25, v17, v72, s65
v_perm_b32 v26, v18, v72, s66
v_perm_b32 v27, v19, v72, s67
v_max3_f32 v28, |v24|, |v25|, |v26|
v_med3_f32 v29, |v24|, |v25|, |v26|
v_min3_f32 v30, |v24|, |v25|, |v26|
v_med3_f32 v32, v28, v29, |v27|
v_med3_f32 v33, v29, v30, |v27|
v_max_f32 v31, v28, |v27|
v_cmp_eq_u32_sdwa vcc, v33, v32 src0_sel:WORD_1 src1_sel:WORD_1
s_cbranch_scc0 L_rb4g
v_min_f32 v30, v30, |v27|
v_cndmask_b32 v31, 0, v33, vcc
v_cmp_eq_u32_sdwa vcc, v30, v32 src0_sel:WORD_1 src1_sel:WORD_1
s_nop 1
v_cndmask_b32 v32, 0, v30, vcc
L_rb4g:
v_perm_b32 v38, v31, v32, s72
v_bfi_b32 v45, 3, v32, v31
v_perm_b32 v24, v16, v73, s68
v_perm_b32 v25, v17, v73, s69
v_perm_b32 v26, v18, v73, s70
v_perm_b32 v27, v19, v73, s71
v_max3_f32 v28, |v24|, |v25|, |v26|
v_med3_f32 v29, |v24|, |v25|, |v26|
v_min3_f32 v30, |v24|, |v25|, |v26|
v_med3_f32 v32, v28, v29, |v27|
v_med3_f32 v33, v29, v30, |v27|
v_max_f32 v31, v28, |v27|
v_cmp_eq_u32_sdwa vcc, v33, v32 src0_sel:WORD_1 src1_sel:WORD_1
s_cbranch_scc0 L_rb5g
v_min_f32 v30, v30, |v27|
v_cndmask_b32 v31, 0, v33, vcc
v_cmp_eq_u32_sdwa vcc, v30, v32 src0_sel:WORD_1 src1_sel:WORD_1
s_nop 1
v_cndmask_b32 v32, 0, v30, vcc
L_rb5g:
v_perm_b32 v42, v31, v32, s72
v_bfi_b32 v47, 3, v32, v31
s_waitcnt vmcnt(0)
v_perm_b32 v24, v20, v74, s64
v_perm_b32 v25, v21, v74, s65
v_perm_b32 v26, v22, v74, s66
v_perm_b32 v27, v23, v74, s67
v_max3_f32 v28, |v24|, |v25|, |v26|
v_med3_f32 v29, |v24|, |v25|, |v26|
v_min3_f32 v30, |v24|, |v25|, |v26|
v_med3_f32 v32, v28, v29, |v27|
v_med3_f32 v33, v29, v30, |v27|
v_max_f32 v31, v28, |v27|
v_cmp_eq_u32_sdwa vcc, v33, v32 src0_sel:WORD_1 src1_sel:WORD_1
s_cbranch_scc0 L_rb6g
v_min_f32 v30, v30, |v27|
v_cndmask_b32 v31, 0, v33, vcc
v_cmp_eq_u32_sdwa vcc, v30, v32 src0_sel:WORD_1 src1_sel:WORD_1
s_nop 1
v_cndmask_b32 v32, 0, v30, vcc
L_rb6g:
v_perm_b32 v39, v31, v32, s72
v_bfi_b32 v31, 3, v32, v31
v_lshlrev_b32 v31, 4, v31
v_bfi_b32 v45, 15, v45, v31
v_perm_b32 v24, v20, v75, s68
v_perm_b32 v25, v21, v75, s69
v_perm_b32 v26, v22, v75, s70
v_perm_b32 v27, v23, v75, s71
v_max3_f32 v28, |v24|, |v25|, |v26|
v_med3_f32 v29, |v24|, |v25|, |v26|
v_min3_f32 v30, |v24|, |v25|, |v26|
v_med3_f32 v32, v28, v29, |v27|
v_med3_f32 v33, v29, v30, |v27|
v_max_f32 v31, v28, |v27|
v_cmp_eq_u32_sdwa vcc, v33, v32 src0_sel:WORD_1 src1_sel:WORD_1
s_cbranch_scc0 L_rb7g
v_min_f32 v30, v30, |v27|
v_cndmask_b32 v31, 0, v33, vcc
v_cmp_eq_u32_sdwa vcc, v30, v32 src0_sel:WORD_1 src1_sel:WORD_1
s_nop 1
v_cndmask_b32 v32, 0, v30, vcc
L_rb7g:
v_perm_b32 v43, v31, v32, s72
v_bfi_b32 v31, 3, v32, v31
v_lshlrev_b32 v31, 4, v31
v_bfi_b32 v47, 15, v47, v31
s_mov_b32 vcc_lo, 0x33333333
s_mov_b32 vcc_hi, 0x33333333
v_cndmask_b32_dpp v24, v40, v36, vcc quad_perm:[2,3,0,1] row_mask:0xf bank_mask:0xf
v_cndmask_b32_dpp v25, v41, v37, vcc quad_perm:[2,3,0,1] row_mask:0xf bank_mask:0xf
v_cndmask_b32_dpp v26, v42, v38, vcc quad_perm:[2,3,0,1] row_mask:0xf bank_mask:0xf
v_cndmask_b32_dpp v27, v43, v39, vcc quad_perm:[2,3,0,1] row_mask:0xf bank_mask:0xf
s_not_b64 vcc, vcc
buffer_store_dwordx4 v[24:27], v51, s[24:27], 0 offen sc1
v_cndmask_b32_dpp v40, v36, v40, vcc quad_perm:[2,3,0,1] row_mask:0xf bank_mask:0xf
v_cndmask_b32_dpp v41, v37, v41, vcc quad_perm:[2,3,0,1] row_mask:0xf bank_mask:0xf
v_cndmask_b32_dpp v42, v38, v42, vcc quad_perm:[2,3,0,1] row_mask:0xf bank_mask:0xf
v_cndmask_b32_dpp v43, v39, v43, vcc quad_perm:[2,3,0,1] row_mask:0xf bank_mask:0xf
s_mov_b32 s52, 0x0c0c0400
s_mov_b32 s53, 0x04000c0c
buffer_store_dwordx4 v[40:43], v66, s[24:27], 0 offen sc1
v_perm_b32 v48, v45, v44, s52
v_perm_b32 v49, v47, v46, s53
v_or_b32 v48, v48, v49
s_nop 1
v_mov_b32_dpp v49, v48 quad_perm:[2,3,0,1] row_mask:0xf bank_mask:0xf
v_perm_b32 v48, v49, v48, v55
ds_permute_b32 v48, v52, v48
s_waitcnt lgkmcnt(0)
buffer_store_dword v48, v54, s[24:27], 0 offen sc1
s_waitcnt vmcnt(0)
s_add_u32 s84, s84, 1
s_cmp_lt_u32 s84, 41
s_cbranch_scc1 L_st
s_add_u32 s87, s87, 1
s_cmp_lt_u32 s87, 2
s_cbranch_scc1 L_sm
v_lshrrev_b32 v72, 3, v7
v_and_b32 v73, 7, v7
v_xor_b32 v73, v73, v72
v_mul_u32_u24 v72, 1152, v72
s_and_b32 s47, s40, 1
s_mul_i32 s47, s47, 9216
s_lshr_b32 s3, s40, 1
s_lshl_b32 s3, s3, 7
s_add_u32 s47, s47, s3
v_lshl_add_u32 v72, v73, 4, v72
v_add_u32 v3, s47, v72
s_lshl_b32 s44, s40, 10
s_mul_i32 s45, s2, 18432
s_mov_b32 s46, s45
s_lshr_b32 s47, s40, 1
s_lshl_b32 s3, s47, 11
s_sub_u32 s8, 15488, s3
s_lshl_b32 s3, s47, 7
s_add_u32 s7, s45, 128
s_sub_u32 s7, s7, s3
s_sub_u32 s10, s47, 1
s_sub_u32 s11, 0, s47
s_mov_b32 s9, s44
s_mov_b32 s13, 4718592
s_mov_b32 s15, 16
s_mov_b32 s14, s13
s_mov_b32 s22, 75497472
s_mov_b32 s18, 75497472
s_mov_b32 s41, 0
s_bitcmp1_b32 s2, 0
s_cselect_b32 s15, 16, 22
L_stile:
s_barrier
s_add_u32 m0, s44, 0
s_nop 0
buffer_load_dwordx4 v3, s[16:19], s45 offen offset:0 nt lds
s_add_u32 m0, s44, 3840
s_nop 0
buffer_load_dwordx4 v3, s[16:19], s45 offen offset:256 nt lds
s_add_u32 m0, s44, 7680
s_nop 0
buffer_load_dwordx4 v3, s[16:19], s45 offen offset:512 nt lds
s_add_u32 m0, s44, 11520
s_nop 0
buffer_load_dwordx4 v3, s[16:19], s45 offen offset:768 nt lds
s_add_u32 m0, s44, s8
s_mov_b64 exec, s[10:11]
buffer_load_dwordx4 v3, s[16:19], s7 offen offset:896 nt lds
s_mov_b64 exec, -1
ds_read_b128 v[8:11], v2 offset:1024
ds_read_b128 v[12:15], v2 offset:1088
ds_read_b128 v[16:19], v2 offset:1152
ds_read_b128 v[20:23], v2 offset:1216
ds_read_b128 v[24:27], v2 offset:1280
ds_read_b128 v[28:31], v2 offset:1344
ds_read_b128 v[32:35], v2 offset:1408
ds_read_b128 v[36:39], v2 offset:1472
ds_read_b128 v[40:43], v2 offset:1536
s_mov_b32 s87, 0
L_spass:
s_lshl_b32 s86, s2, 1
s_add_u32 s86, s86, s87
s_add_u32 s86, s86, 2
s_mul_i32 s86, s86, 393216
s_mul_i32 s47, s40, 82944
s_add_u32 s47, s47, s86
v_lshl_add_u32 v104, v7, 4, s47
s_mul_i32 s47, s40, 9216
s_add_u32 s47, s47, s86
s_add_u32 s47, s47, 331776
v_lshl_add_u32 v105, v7, 4, s47
s_lshl_b32 s47, s40, 6
s_add_u32 s47, s47, s86
s_add_u32 s47, s47, 368640
v_and_b32 v106, 15, v7
v_lshl_add_u32 v106, v106, 2, s47
v_lshrrev_b32 v107, 4, v7
v_lshl_add_u32 v106, v107, 8, v106
buffer_load_dword v174, v106, s[24:27], 0 offen offset:0 sc1
buffer_load_dword v175, v106, s[24:27], 0 offen offset:1024 sc1
buffer_load_dword v176, v106, s[24:27], 0 offen offset:2048 sc1
buffer_load_dword v177, v106, s[24:27], 0 offen offset:3072 sc1
s_mov_b32 s99, 4096
buffer_load_dword v178, v106, s[24:27], s99 offen offset:0 sc1
s_mov_b32 s98, 0
buffer_load_dwordx4 v[138:141], v105, s[24:27], s98 offen sc1
s_mov_b32 s99, 0
buffer_load_dwordx4 a[0:3], v104, s[24:27], s99 offen offset:0 sc1
buffer_load_dwordx4 a[4:7], v104, s[24:27], s99 offen offset:1024 sc1
buffer_load_dwordx4 a[8:11], v104, s[24:27], s99 offen offset:2048 sc1
buffer_load_dwordx4 a[12:15], v104, s[24:27], s99 offen offset:3072 sc1
s_mov_b32 s99, 4096
buffer_load_dwordx4 a[16:19], v104, s[24:27], s99 offen offset:0 sc1
buffer_load_dwordx4 a[20:23], v104, s[24:27], s99 offen offset:1024 sc1
buffer_load_dwordx4 a[24:27], v104, s[24:27], s99 offen offset:2048 sc1
buffer_load_dwordx4 a[28:31], v104, s[24:27], s99 offen offset:3072 sc1
s_mov_b32 s99, 8192
buffer_load_dwordx4 a[32:35], v104, s[24:27], s99 offen offset:0 sc1
s_mov_b32 s98, 1024
buffer_load_dwordx4 v[142:145], v105, s[24:27], s98 offen sc1
buffer_load_dwordx4 a[36:39], v104, s[24:27], s99 offen offset:1024 sc1
buffer_load_dwordx4 a[40:43], v104, s[24:27], s99 offen offset:2048 sc1
buffer_load_dwordx4 a[44:47], v104, s[24:27], s99 offen offset:3072 sc1
s_mov_b32 s99, 12288
buffer_load_dwordx4 a[48:51], v104, s[24:27], s99 offen offset:0 sc1
buffer_load_dwordx4 a[52:55], v104, s[24:27], s99 offen offset:1024 sc1
buffer_load_dwordx4 a[56:59], v104, s[24:27], s99 offen offset:2048 sc1
buffer_load_dwordx4 a[60:63], v104, s[24:27], s99 offen offset:3072 sc1
s_mov_b32 s99, 16384
buffer_load_dwordx4 a[64:67], v104, s[24:27], s99 offen offset:0 sc1
buffer_load_dwordx4 a[68:71], v104, s[24:27], s99 offen offset:1024 sc1
s_mov_b32 s98, 2048
buffer_load_dwordx4 v[146:149], v105, s[24:27], s98 offen sc1
buffer_load_dwordx4 a[72:75], v104, s[24:27], s99 offen offset:2048 sc1
buffer_load_dwordx4 a[76:79], v104, s[24:27], s99 offen offset:3072 sc1
s_mov_b32 s99, 20480
buffer_load_dwordx4 a[80:83], v104, s[24:27], s99 offen offset:0 sc1
buffer_load_dwordx4 a[84:87], v104, s[24:27], s99 offen offset:1024 sc1
buffer_load_dwordx4 a[88:91], v104, s[24:27], s99 offen offset:2048 sc1
buffer_load_dwordx4 a[92:95], v104, s[24:27], s99 offen offset:3072 sc1
s_mov_b32 s99, 24576
buffer_load_dwordx4 a[96:99], v104, s[24:27], s99 offen offset:0 sc1
buffer_load_dwordx4 a[100:103], v104, s[24:27], s99 offen offset:1024 sc1
buffer_load_dwordx4 a[104:107], v104, s[24:27], s99 offen offset:2048 sc1
s_mov_b32 s98, 3072
buffer_load_dwordx4 v[150:153], v105, s[24:27], s98 offen sc1
buffer_load_dwordx4 a[108:111], v104, s[24:27], s99 offen offset:3072 sc1
s_mov_b32 s99, 28672
buffer_load_dwordx4 a[112:115], v104, s[24:27], s99 offen offset:0 sc1
buffer_load_dwordx4 a[116:119], v104, s[24:27], s99 offen offset:1024 sc1
buffer_load_dwordx4 a[120:123], v104, s[24:27], s99 offen offset:2048 sc1
buffer_load_dwordx4 a[124:127], v104, s[24:27], s99 offen offset:3072 sc1
s_mov_b32 s99, 32768
buffer_load_dwordx4 a[128:131], v104, s[24:27], s99 offen offset:0 sc1
buffer_load_dwordx4 a[132:135], v104, s[24:27], s99 offen offset:1024 sc1
buffer_load_dwordx4 a[136:139], v104, s[24:27], s99 offen offset:2048 sc1
buffer_load_dwordx4 a[140:143], v104, s[24:27], s99 offen offset:3072 sc1
s_mov_b32 s98, 4096
buffer_load_dwordx4 v[154:157], v105, s[24:27], s98 offen sc1
s_mov_b32 s99, 36864
buffer_load_dwordx4 a[144:147], v104, s[24:27], s99 offen offset:0 sc1
buffer_load_dwordx4 a[148:151], v104, s[24:27], s99 offen offset:1024 sc1
buffer_load_dwordx4 a[152:155], v104, s[24:27], s99 offen offset:2048 sc1
buffer_load_dwordx4 a[156:159], v104, s[24:27], s99 offen offset:3072 sc1
s_mov_b32 s99, 40960
buffer_load_dwordx4 a[160:163], v104, s[24:27], s99 offen offset:0 sc1
buffer_load_dwordx4 a[164:167], v104, s[24:27], s99 offen offset:1024 sc1
buffer_load_dwordx4 a[168:171], v104, s[24:27], s99 offen offset:2048 sc1
buffer_load_dwordx4 a[172:175], v104, s[24:27], s99 offen offset:3072 sc1
s_mov_b32 s99, 45056
buffer_load_dwordx4 a[176:179], v104, s[24:27], s99 offen offset:0 sc1
s_mov_b32 s98, 5120
buffer_load_dwordx4 v[158:161], v105, s[24:27], s98 offen sc1
buffer_load_dwordx4 a[180:183], v104, s[24:27], s99 offen offset:1024 sc1
buffer_load_dwordx4 a[184:187], v104, s[24:27], s99 offen offset:2048 sc1
buffer_load_dwordx4 a[188:191], v104, s[24:27], s99 offen offset:3072 sc1
s_mov_b32 s99, 49152
buffer_load_dwordx4 a[192:195], v104, s[24:27], s99 offen offset:0 sc1
buffer_load_dwordx4 a[196:199], v104, s[24:27], s99 offen offset:1024 sc1
buffer_load_dwordx4 a[200:203], v104, s[24:27], s99 offen offset:2048 sc1
buffer_load_dwordx4 a[204:207], v104, s[24:27], s99 offen offset:3072 sc1
s_mov_b32 s99, 53248
buffer_load_dwordx4 a[208:211], v104, s[24:27], s99 offen offset:0 sc1
buffer_load_dwordx4 a[212:215], v104, s[24:27], s99 offen offset:1024 sc1
s_mov_b32 s98, 6144
buffer_load_dwordx4 v[162:165], v105, s[24:27], s98 offen sc1
buffer_load_dwordx4 a[216:219], v104, s[24:27], s99 offen offset:2048 sc1
buffer_load_dwordx4 a[220:223], v104, s[24:27], s99 offen offset:3072 sc1
s_mov_b32 s99, 57344
buffer_load_dwordx4 a[224:227], v104, s[24:27], s99 offen offset:0 sc1
buffer_load_dwordx4 a[228:231], v104, s[24:27], s99 offen offset:1024 sc1
buffer_load_dwordx4 a[232:235], v104, s[24:27], s99 offen offset:2048 sc1
buffer_load_dwordx4 a[236:239], v104, s[24:27], s99 offen offset:3072 sc1
s_mov_b32 s99, 61440
buffer_load_dwordx4 a[240:243], v104, s[24:27], s99 offen offset:0 sc1
buffer_load_dwordx4 a[244:247], v104, s[24:27], s99 offen offset:1024 sc1
buffer_load_dwordx4 a[248:251], v104, s[24:27], s99 offen offset:2048 sc1
s_mov_b32 s98, 7168
buffer_load_dwordx4 v[166:169], v105, s[24:27], s98 offen sc1
buffer_load_dwordx4 a[252:255], v104, s[24:27], s99 offen offset:3072 sc1
s_mov_b32 s99, 65536
buffer_load_dwordx4 v[186:189], v104, s[24:27], s99 offen offset:0 sc1
buffer_load_dwordx4 v[190:193], v104, s[24:27], s99 offen offset:1024 sc1
buffer_load_dwordx4 v[194:197], v104, s[24:27], s99 offen offset:2048 sc1
buffer_load_dwordx4 v[198:201], v104, s[24:27], s99 offen offset:3072 sc1
s_mov_b32 s99, 69632
buffer_load_dwordx4 v[202:205], v104, s[24:27], s99 offen offset:0 sc1
buffer_load_dwordx4 v[206:209], v104, s[24:27], s99 offen offset:1024 sc1
buffer_load_dwordx4 v[210:213], v104, s[24:27], s99 offen offset:2048 sc1
buffer_load_dwordx4 v[214:217], v104, s[24:27], s99 offen offset:3072 sc1
s_mov_b32 s98, 8192
buffer_load_dwordx4 v[170:173], v105, s[24:27], s98 offen sc1
s_mov_b32 s99, 73728
buffer_load_dwordx4 v[218:221], v104, s[24:27], s99 offen offset:0 sc1
buffer_load_dwordx4 v[222:225], v104, s[24:27], s99 offen offset:1024 sc1
buffer_load_dwordx4 v[226:229], v104, s[24:27], s99 offen offset:2048 sc1
buffer_load_dwordx4 v[230:233], v104, s[24:27], s99 offen offset:3072 sc1
s_mov_b32 s99, 77824
buffer_load_dwordx4 v[234:237], v104, s[24:27], s99 offen offset:0 sc1
buffer_load_dwordx4 v[238:241], v104, s[24:27], s99 offen offset:1024 sc1
buffer_load_dwordx4 v[242:245], v104, s[24:27], s99 offen offset:2048 sc1
buffer_load_dwordx4 v[246:249], v104, s[24:27], s99 offen offset:3072 sc1
s_mov_b32 s99, 81920
buffer_load_dwordx4 v[250:253], v104, s[24:27], s99 offen offset:0 sc1
s_waitcnt vmcnt(0)
s_barrier
ds_read_b128 v[44:47], v0 offset:0
ds_read_b128 v[48:51], v1 offset:0
s_waitcnt lgkmcnt(0)
v_smfmac_f32_16x16x64_bf16 v[8:11], a[0:3], v[44:51], v138
v_smfmac_f32_16x16x64_bf16 v[12:15], a[4:7], v[44:51], v138 abid:1
v_smfmac_f32_16x16x64_bf16 v[16:19], a[8:11], v[44:51], v139
v_smfmac_f32_16x16x64_bf16 v[20:23], a[12:15], v[44:51], v139 abid:1
v_smfmac_f32_16x16x64_bf16 v[24:27], a[16:19], v[44:51], v140
v_smfmac_f32_16x16x64_bf16 v[28:31], a[20:23], v[44:51], v140 abid:1
v_smfmac_f32_16x16x64_bf16 v[32:35], a[24:27], v[44:51], v141
v_smfmac_f32_16x16x64_bf16 v[36:39], a[28:31], v[44:51], v141 abid:1
v_smfmac_f32_16x16x64_bf16 v[40:43], a[32:35], v[44:51], v174
s_nop 7
ds_read_b128 v[44:47], v0 offset:2048
ds_read_b128 v[48:51], v1 offset:2048
s_waitcnt lgkmcnt(0)
v_smfmac_f32_16x16x64_bf16 v[8:11], a[36:39], v[44:51], v142
v_smfmac_f32_16x16x64_bf16 v[12:15], a[40:43], v[44:51], v142 abid:1
v_smfmac_f32_16x16x64_bf16 v[16:19], a[44:47], v[44:51], v143
v_smfmac_f32_16x16x64_bf16 v[20:23], a[48:51], v[44:51], v143 abid:1
v_smfmac_f32_16x16x64_bf16 v[24:27], a[52:55], v[44:51], v144
v_smfmac_f32_16x16x64_bf16 v[28:31], a[56:59], v[44:51], v144 abid:1
v_smfmac_f32_16x16x64_bf16 v[32:35], a[60:63], v[44:51], v145
v_smfmac_f32_16x16x64_bf16 v[36:39], a[64:67], v[44:51], v145 abid:1
v_smfmac_f32_16x16x64_bf16 v[40:43], a[68:71], v[44:51], v174 abid:1
s_nop 7
ds_read_b128 v[44:47], v0 offset:4096
ds_read_b128 v[48:51], v1 offset:4096
s_waitcnt lgkmcnt(0)
v_smfmac_f32_16x16x64_bf16 v[8:11], a[72:75], v[44:51], v146
v_smfmac_f32_16x16x64_bf16 v[12:15], a[76:79], v[44:51], v146 abid:1
v_smfmac_f32_16x16x64_bf16 v[16:19], a[80:83], v[44:51], v147
v_smfmac_f32_16x16x64_bf16 v[20:23], a[84:87], v[44:51], v147 abid:1
v_smfmac_f32_16x16x64_bf16 v[24:27], a[88:91], v[44:51], v148
v_smfmac_f32_16x16x64_bf16 v[28:31], a[92:95], v[44:51], v148 abid:1
v_smfmac_f32_16x16x64_bf16 v[32:35], a[96:99], v[44:51], v149
v_smfmac_f32_16x16x64_bf16 v[36:39], a[100:103], v[44:51], v149 abid:1
v_smfmac_f32_16x16x64_bf16 v[40:43], a[104:107], v[44:51], v175
s_nop 7
ds_read_b128 v[44:47], v0 offset:6144
ds_read_b128 v[48:51], v1 offset:6144
s_waitcnt lgkmcnt(0)
v_smfmac_f32_16x16x64_bf16 v[8:11], a[108:111], v[44:51], v150
v_smfmac_f32_16x16x64_bf16 v[12:15], a[112:115], v[44:51], v150 abid:1
v_smfmac_f32_16x16x64_bf16 v[16:19], a[116:119], v[44:51], v151
v_smfmac_f32_16x16x64_bf16 v[20:23], a[120:123], v[44:51], v151 abid:1
v_smfmac_f32_16x16x64_bf16 v[24:27], a[124:127], v[44:51], v152
v_smfmac_f32_16x16x64_bf16 v[28:31], a[128:131], v[44:51], v152 abid:1
v_smfmac_f32_16x16x64_bf16 v[32:35], a[132:135], v[44:51], v153
v_smfmac_f32_16x16x64_bf16 v[36:39], a[136:139], v[44:51], v153 abid:1
v_smfmac_f32_16x16x64_bf16 v[40:43], a[140:143], v[44:51], v175 abid:1
s_nop 7
ds_read_b128 v[44:47], v0 offset:8192
ds_read_b128 v[48:51], v1 offset:8192
s_waitcnt lgkmcnt(0)
v_smfmac_f32_16x16x64_bf16 v[8:11], a[144:147], v[44:51], v154
v_smfmac_f32_16x16x64_bf16 v[12:15], a[148:151], v[44:51], v154 abid:1
v_smfmac_f32_16x16x64_bf16 v[16:19], a[152:155], v[44:51], v155
v_smfmac_f32_16x16x64_bf16 v[20:23], a[156:159], v[44:51], v155 abid:1
v_smfmac_f32_16x16x64_bf16 v[24:27], a[160:163], v[44:51], v156
v_smfmac_f32_16x16x64_bf16 v[28:31], a[164:167], v[44:51], v156 abid:1
v_smfmac_f32_16x16x64_bf16 v[32:35], a[168:171], v[44:51], v157
v_smfmac_f32_16x16x64_bf16 v[36:39], a[172:175], v[44:51], v157 abid:1
v_smfmac_f32_16x16x64_bf16 v[40:43], a[176:179], v[44:51], v176
s_nop 7
ds_read_b128 v[44:47], v0 offset:10240
ds_read_b128 v[48:51], v1 offset:10240
s_waitcnt lgkmcnt(0)
v_smfmac_f32_16x16x64_bf16 v[8:11], a[180:183], v[44:51], v158
v_smfmac_f32_16x16x64_bf16 v[12:15], a[184:187], v[44:51], v158 abid:1
v_smfmac_f32_16x16x64_bf16 v[16:19], a[188:191], v[44:51], v159
v_smfmac_f32_16x16x64_bf16 v[20:23], a[192:195], v[44:51], v159 abid:1
v_smfmac_f32_16x16x64_bf16 v[24:27], a[196:199], v[44:51], v160
v_smfmac_f32_16x16x64_bf16 v[28:31], a[200:203], v[44:51], v160 abid:1
v_smfmac_f32_16x16x64_bf16 v[32:35], a[204:207], v[44:51], v161
v_smfmac_f32_16x16x64_bf16 v[36:39], a[208:211], v[44:51], v161 abid:1
v_smfmac_f32_16x16x64_bf16 v[40:43], a[212:215], v[44:51], v176 abid:1
s_nop 7
ds_read_b128 v[44:47], v0 offset:12288
ds_read_b128 v[48:51], v1 offset:12288
s_waitcnt lgkmcnt(0)
v_smfmac_f32_16x16x64_bf16 v[8:11], a[216:219], v[44:51], v162
v_smfmac_f32_16x16x64_bf16 v[12:15], a[220:223], v[44:51], v162 abid:1
v_smfmac_f32_16x16x64_bf16 v[16:19], a[224:227], v[44:51], v163
v_smfmac_f32_16x16x64_bf16 v[20:23], a[228:231], v[44:51], v163 abid:1
v_smfmac_f32_16x16x64_bf16 v[24:27], a[232:235], v[44:51], v164
v_smfmac_f32_16x16x64_bf16 v[28:31], a[236:239], v[44:51], v164 abid:1
v_smfmac_f32_16x16x64_bf16 v[32:35], a[240:243], v[44:51], v165
v_smfmac_f32_16x16x64_bf16 v[36:39], a[244:247], v[44:51], v165 abid:1
v_smfmac_f32_16x16x64_bf16 v[40:43], a[248:251], v[44:51], v177
s_nop 7
ds_read_b128 v[44:47], v0 offset:14336
ds_read_b128 v[48:51], v1 offset:14336
s_waitcnt lgkmcnt(0)
v_smfmac_f32_16x16x64_bf16 v[8:11], a[252:255], v[44:51], v166
v_smfmac_f32_16x16x64_bf16 v[12:15], v[186:189], v[44:51], v166 abid:1
v_smfmac_f32_16x16x64_bf16 v[16:19], v[190:193], v[44:51], v167
v_smfmac_f32_16x16x64_bf16 v[20:23], v[194:197], v[44:51], v167 abid:1
v_smfmac_f32_16x16x64_bf16 v[24:27], v[198:201], v[44:51], v168
v_smfmac_f32_16x16x64_bf16 v[28:31], v[202:205], v[44:51], v168 abid:1
v_smfmac_f32_16x16x64_bf16 v[32:35], v[206:209], v[44:51], v169
v_smfmac_f32_16x16x64_bf16 v[36:39], v[210:213], v[44:51], v169 abid:1
v_smfmac_f32_16x16x64_bf16 v[40:43], v[214:217], v[44:51], v177 abid:1
s_nop 7
ds_read_b128 v[44:47], v0 offset:16384
ds_read_b128 v[48:51], v1 offset:16384
s_waitcnt lgkmcnt(0)
v_smfmac_f32_16x16x64_bf16 v[8:11], v[218:221], v[44:51], v170
v_smfmac_f32_16x16x64_bf16 v[12:15], v[222:225], v[44:51], v170 abid:1
v_smfmac_f32_16x16x64_bf16 v[16:19], v[226:229], v[44:51], v171
v_smfmac_f32_16x16x64_bf16 v[20:23], v[230:233], v[44:51], v171 abid:1
v_smfmac_f32_16x16x64_bf16 v[24:27], v[234:237], v[44:51], v172
v_smfmac_f32_16x16x64_bf16 v[28:31], v[238:241], v[44:51], v172 abid:1
v_smfmac_f32_16x16x64_bf16 v[32:35], v[242:245], v[44:51], v173
v_smfmac_f32_16x16x64_bf16 v[36:39], v[246:249], v[44:51], v173 abid:1
v_smfmac_f32_16x16x64_bf16 v[40:43], v[250:253], v[44:51], v178
s_nop 7
s_add_u32 s87, s87, 1
s_cmp_lt_u32 s87, 2
s_cbranch_scc1 L_spass
v_cvt_pk_bf16_f32 v92, v8, v9
v_cvt_pk_bf16_f32 v93, v10, v11
v_cvt_pk_bf16_f32 v94, v12, v13
v_cvt_pk_bf16_f32 v95, v14, v15
v_cvt_pk_bf16_f32 v96, v16, v17
v_cvt_pk_bf16_f32 v97, v18, v19
v_cvt_pk_bf16_f32 v98, v20, v21
v_cvt_pk_bf16_f32 v99, v22, v23
v_cvt_pk_bf16_f32 v100, v24, v25
v_cvt_pk_bf16_f32 v101, v26, v27
v_cvt_pk_bf16_f32 v102, v28, v29
v_cvt_pk_bf16_f32 v103, v30, v31
v_cvt_pk_bf16_f32 v104, v32, v33
v_cvt_pk_bf16_f32 v105, v34, v35
s_mov_b64 vcc, s[80:81]
s_nop 0
v_cndmask_b32_dpp v108, v96, v92, vcc quad_perm:[1,0,3,2] row_mask:0xf bank_mask:0xf
v_cndmask_b32_dpp v109, v97, v93, vcc quad_perm:[1,0,3,2] row_mask:0xf bank_mask:0xf
v_cndmask_b32_dpp v110, v98, v94, vcc quad_perm:[1,0,3,2] row_mask:0xf bank_mask:0xf
v_cndmask_b32_dpp v111, v99, v95, vcc quad_perm:[1,0,3,2] row_mask:0xf bank_mask:0xf
buffer_store_dwordx4 v[108:111], v4, s[20:23], s46 offen offset:0 sc1
s_mov_b64 vcc, s[82:83]
v_cvt_pk_bf16_f32 v112, v40, v41
v_cvt_pk_bf16_f32 v113, v42, v43
ds_bpermute_b32 v112, v6, v112
ds_bpermute_b32 v113, v6, v113
v_cndmask_b32_dpp v96, v92, v96, vcc quad_perm:[1,0,3,2] row_mask:0xf bank_mask:0xf
v_cndmask_b32_dpp v97, v93, v97, vcc quad_perm:[1,0,3,2] row_mask:0xf bank_mask:0xf
v_cndmask_b32_dpp v98, v94, v98, vcc quad_perm:[1,0,3,2] row_mask:0xf bank_mask:0xf
v_cndmask_b32_dpp v99, v95, v99, vcc quad_perm:[1,0,3,2] row_mask:0xf bank_mask:0xf
buffer_store_dwordx4 v[96:99], v4, s[20:23], s46 offen offset:1152 sc1
s_mov_b64 vcc, s[80:81]
v_cvt_pk_bf16_f32 v106, v36, v37
v_cvt_pk_bf16_f32 v107, v38, v39
v_cndmask_b32_dpp v92, v104, v100, vcc quad_perm:[1,0,3,2] row_mask:0xf bank_mask:0xf
v_cndmask_b32_dpp v93, v105, v101, vcc quad_perm:[1,0,3,2] row_mask:0xf bank_mask:0xf
v_cndmask_b32_dpp v94, v106, v102, vcc quad_perm:[1,0,3,2] row_mask:0xf bank_mask:0xf
v_cndmask_b32_dpp v95, v107, v103, vcc quad_perm:[1,0,3,2] row_mask:0xf bank_mask:0xf
buffer_store_dwordx4 v[92:95], v4, s[20:23], s46 offen offset:128 sc1
s_mov_b64 vcc, s[82:83]
v_cndmask_b32_dpp v104, v100, v104, vcc quad_perm:[1,0,3,2] row_mask:0xf bank_mask:0xf
v_cndmask_b32_dpp v105, v101, v105, vcc quad_perm:[1,0,3,2] row_mask:0xf bank_mask:0xf
v_cndmask_b32_dpp v106, v102, v106, vcc quad_perm:[1,0,3,2] row_mask:0xf bank_mask:0xf
v_cndmask_b32_dpp v107, v103, v107, vcc quad_perm:[1,0,3,2] row_mask:0xf bank_mask:0xf
buffer_store_dwordx4 v[104:107], v4, s[20:23], s46 offen offset:1280 sc1
s_mov_b64 vcc, s[80:81]
s_waitcnt lgkmcnt(0)
buffer_store_dwordx2 v[112:113], v5, s[20:23], s46 offen nt
s_cmp_eq_u32 s41, 15
s_cselect_b32 s13, -23574528, s13
s_add_u32 s45, s45, s13
s_add_u32 s7, s7, s13
s_add_u32 s46, s46, s13
s_mov_b32 s13, 4718592
s_add_u32 s41, s41, 1
s_cmp_lt_u32 s41, s15
s_cbranch_scc1 L_stile
s_branch L_fin
.section .rodata,"a"
.p2align 6
.amdhsa_kernel standalone__structured_sparse_n_m__ragged_kernel
  .amdhsa_next_free_vgpr 512
  .amdhsa_next_free_sgpr 102
  .amdhsa_accum_offset 256
  .amdhsa_group_segment_fixed_size 0
  .amdhsa_float_denorm_mode_32 3
  .amdhsa_kernarg_size 48
  .amdhsa_user_sgpr_count 2
  .amdhsa_user_sgpr_kernarg_segment_ptr 1
  .amdhsa_system_sgpr_workgroup_id_x 1
.end_amdhsa_kernel
```

```asm
; @launch grid=(256,1,1) block=(256,1,1) lds=163840
.amdgcn_target "amdgcn-amd-amdhsa--gfx950"
.text
.globl standalone__structured_sparse_n_m__ragged_kernel
.p2align 8
.type standalone__structured_sparse_n_m__ragged_kernel,@function
standalone__structured_sparse_n_m__ragged_kernel:
s_load_dwordx8 s[4:11], s[0:1], 0
s_load_dwordx4 s[12:15], s[0:1], 32
s_cmp_ge_u32 s2, 256
s_cbranch_scc1 L_end_standalone__structured_sparse_n_m__ragged_kernel
v_lshrrev_b32 v1, 6, v0
v_and_b32 v7, 63, v0
s_lshr_b32 s49, s2, 6
s_and_b32 s47, s2, 9
s_lshl1_add_u32 s49, s49, s47
s_bfe_u32 s48, s2, 0x20004
s_lshl2_add_u32 s84, s49, s48
s_and_b32 s47, s2, 6
s_cselect_b32 s84, 63, s84
s_cmp_lt_u32 s84, 41
s_cbranch_scc0 L_cw
s_cmp_ge_u32 s84, 36
s_cbranch_scc1 L_pb
s_mul_i32 s52, s49, 288
s_add_u32 s52, s52, s48
s_lshl_b32 s52, s52, 8
v_lshl_add_u32 v50, v7, 2, s52
L_pbb:
v_mul_u32_u24 v62, 18432, v1
v_add_u32 v50, v62, v50
s_mov_b32 s30, 663552
s_mov_b32 s31, 0x20000
s_waitcnt lgkmcnt(0)
s_mov_b32 s28, s6
s_and_b32 s29, s7, 0xffff
buffer_load_dword v8, v50, s[28:31], 0 offen offset:0 nt
buffer_load_dword v9, v50, s[28:31], 0 offen offset:1152 nt
buffer_load_dword v10, v50, s[28:31], 0 offen offset:2304 nt
buffer_load_dword v11, v50, s[28:31], 0 offen offset:3456 nt
v_add_u32 v50, 4608, v50
buffer_load_dword v12, v50, s[28:31], 0 offen offset:0 nt
buffer_load_dword v13, v50, s[28:31], 0 offen offset:1152 nt
buffer_load_dword v14, v50, s[28:31], 0 offen offset:2304 nt
buffer_load_dword v15, v50, s[28:31], 0 offen offset:3456 nt
v_add_u32 v50, 4608, v50
buffer_load_dword v16, v50, s[28:31], 0 offen offset:0 nt
buffer_load_dword v17, v50, s[28:31], 0 offen offset:1152 nt
buffer_load_dword v18, v50, s[28:31], 0 offen offset:2304 nt
buffer_load_dword v19, v50, s[28:31], 0 offen offset:3456 nt
v_add_u32 v50, 4608, v50
buffer_load_dword v20, v50, s[28:31], 0 offen offset:0 nt
buffer_load_dword v21, v50, s[28:31], 0 offen offset:1152 nt
buffer_load_dword v22, v50, s[28:31], 0 offen offset:2304 nt
buffer_load_dword v23, v50, s[28:31], 0 offen offset:3456 nt
s_branch L_pc
L_pb:
s_mul_i32 s52, s84, 147456
s_sub_u32 s52, s52, 5307392
v_and_b32 v62, 2, v7
v_mul_u32_u24 v50, 36864, v62
v_and_b32 v62, 1, v7
v_lshl_add_u32 v50, v62, 2, v50
v_and_b32 v62, 4, v7
v_lshl_add_u32 v50, v62, 3, v50
v_and_b32 v62, 32, v7
v_lshl_add_u32 v50, v62, 1, v50
v_and_b32 v62, 24, v7
v_add3_u32 v50, v50, v62, s52
s_branch L_pbb
L_cw:
v_lshlrev_b32 v3, 7, v0
s_getpc_b64 s[96:97]
v_min_u32 v2, L_slow-standalone__structured_sparse_n_m__ragged_kernel, v3
global_load_dword v120, v2, s[96:97]
s_branch L_cons
L_pc:
v_readfirstlane_b32 s40, v1
s_mov_b32 s86, 0
s_mov_b32 s18, 75497472
s_mov_b32 s19, 0x20000
s_mov_b32 s16, s4
s_and_b32 s17, s5, 0xffff
s_mov_b32 s26, 301989888
s_mov_b32 s27, 0x20000
s_mov_b32 s24, s14
s_and_b32 s25, s15, 0xffff
s_mov_b32 s34, 1152
s_mov_b32 s35, 0x20000
s_mov_b32 s32, s8
s_and_b32 s33, s9, 0xffff
s_mov_b32 s22, 0
s_mov_b32 s23, 0x20000
s_mov_b32 s20, s10
s_and_b32 s21, s11, 0xffff
s_mov_b32 s38, 256
s_mov_b32 s39, 0x20000
s_mov_b32 s36, s12
s_and_b32 s37, s13, 0xffff
s_sub_u32 s50, s84, 36
s_lshl_b32 s51, s40, 4
v_and_b32 v58, 1, v7
v_bfe_u32 v59, v7, 1, 1
v_bfe_u32 v60, v7, 3, 2
s_mul_i32 s52, s48, 9
s_add_u32 s52, s52, s49
s_mul_i32 s53, s52, 9
s_mul_i32 s54, s50, 18
s_add_u32 s54, s54, 8
s_lshl_b32 s55, s52, 2
s_add_u32 s55, s55, s40
s_lshl_b32 s56, s50, 2
s_add_u32 s56, s56, s40
s_cmp_eq_u32 s84, 40
s_cselect_b32 s57, 0x100000, 9
s_cmp_lt_u32 s84, 36
s_cselect_b32 s53, s53, s54
s_cselect_b32 s54, 2, 81
s_cselect_b32 s57, 1, s57
s_cselect_b32 s55, s55, s56
s_mov_b32 s56, 331776
s_cselect_b32 s56, s56, 368640
s_mov_b32 s58, 373760
s_cselect_b32 s58, s58, 382976
s_cselect_b32 s59, 16, 4
s_cselect_b32 s60, 4, 64
s_cselect_b32 s61, 12, 11
s_cselect_b32 s62, 1, 0x8001
v_bfe_u32 v61, v7, 2, 1
v_lshrrev_b32 v62, 5, v7
v_lshl_add_u32 v61, v62, 1, v61
v_lshlrev_b32 v62, 1, v58
v_lshl_add_u32 v60, v60, 2, v62
v_add_u32 v62, v60, v59
v_mul_u32_u24 v51, s54, v61
v_add_lshl_u32 v51, v51, s53, 6
v_add3_u32 v51, v51, v62, s51
v_lshl_add_u32 v51, v51, 4, s86
s_lshl_b32 s57, s57, 10
v_add_u32 v66, s57, v51
s_lshl_b32 s52, s55, 8
s_add_u32 s52, s52, s56
s_add_u32 s52, s52, s86
v_mul_u32_u24 v52, s59, v62
v_mad_u32_u24 v52, v61, s60, v52
v_lshl_add_u32 v54, v7, 2, s52
s_lshr_b32 s52, s55, 2
s_lshl_b32 s52, s52, 8
s_add_u32 s58, s58, s52
s_lshl2_add_u32 s58, s51, s58
s_lshl_b32 s52, s51, 1
s_add_u32 s52, s52, s62
v_lshl_add_u32 v62, v61, 1, v59
v_lshlrev_b32 v62, s61, v62
v_lshl_add_u32 v53, v60, 7, v62
v_add_u32 v53, s52, v53
v_and_b32 v62, 12, v7
v_and_b32 v63, 15, v7
v_mad_u32_u24 v62, v62, 3, v63
v_lshl_add_u32 v62, v62, 2, s51
v_mov_b32 v67, 0
ds_write_b32 v62, v67
s_lshl2_add_u32 s52, s84, s40
s_lshl_b32 s52, s52, 7
s_add_u32 s52, s52, 393152
v_lshl_add_u32 v65, v7, 2, s58
v_lshl_add_u32 v62, v7, 2, s52
v_cmp_gt_u32 vcc, 16, v7
s_lshl_b32 s52, s51, 2
v_lshl_add_u32 v57, v7, 2, s52
v_cndmask_b32 v65, v62, v65, vcc
s_mov_b32 s75, 0
s_mov_b32 s73, 0x05060100
s_mov_b32 s74, 0xffff
v_mov_b32 v55, 0x05040100
v_mov_b32 v62, 0x03020706
v_cmp_eq_u32 vcc, 1, v59
v_mov_b32 v68, 0xf0a0500
v_mov_b32 v69, 0x8f8a8580
v_mov_b32 v70, 0x1f1a1510
v_mov_b32 v71, 0x9f9a9590
v_mov_b32 v72, 0x2f2a2520
v_mov_b32 v73, 0xafaaa5a0
v_mov_b32 v74, 0x3f3a3530
v_mov_b32 v75, 0xbfbab5b0
v_cndmask_b32 v55, v55, v62, vcc
v_mov_b64 v[76:77], 0
v_mov_b64 v[78:79], 0
v_mov_b64 v[80:81], 0
v_mov_b32 v82, 0
s_mov_b32 s64, 0x5040500
s_mov_b32 s65, 0x5040501
s_mov_b32 s66, 0x5040502
s_mov_b32 s67, 0x5040503
s_mov_b32 s68, 0x7060700
s_mov_b32 s69, 0x7060701
s_mov_b32 s70, 0x7060702
s_mov_b32 s71, 0x7060703
s_mov_b32 s72, 0x05060102
s_waitcnt vmcnt(12)
v_perm_b32 v24, v8, v68, s64
v_perm_b32 v25, v9, v68, s65
v_perm_b32 v26, v10, v68, s66
v_perm_b32 v27, v11, v68, s67
v_max3_f32 v28, |v24|, |v25|, |v26|
v_med3_f32 v29, |v24|, |v25|, |v26|
v_min3_f32 v30, |v24|, |v25|, |v26|
v_med3_f32 v32, v28, v29, |v27|
v_med3_f32 v33, v29, v30, |v27|
v_max_f32 v31, v28, |v27|
v_perm_b32 v36, v31, v32, s72
v_bfi_b32 v44, 3, v32, v31
v_cmpx_eq_u32_sdwa vcc, v33, v32 src0_sel:WORD_1 src1_sel:WORD_1
v_mov_b32 v76, v33
v_min_f32 v77, v30, |v27|
s_mov_b64 exec, -1
v_perm_b32 v24, v8, v69, s68
v_perm_b32 v25, v9, v69, s69
v_perm_b32 v26, v10, v69, s70
v_perm_b32 v27, v11, v69, s71
v_max3_f32 v28, |v24|, |v25|, |v26|
v_med3_f32 v29, |v24|, |v25|, |v26|
v_min3_f32 v30, |v24|, |v25|, |v26|
v_med3_f32 v32, v28, v29, |v27|
v_med3_f32 v33, v29, v30, |v27|
v_max_f32 v31, v28, |v27|
v_perm_b32 v40, v31, v32, s72
v_bfi_b32 v46, 3, v32, v31
v_cmpx_eq_u32_sdwa vcc, v33, v32 src0_sel:WORD_1 src1_sel:WORD_1
v_mov_b64 v[78:79], v[76:77]
v_mov_b32 v76, v33
v_min_f32 v77, v30, |v27|
s_mov_b64 exec, -1
s_waitcnt vmcnt(8)
v_perm_b32 v24, v12, v70, s64
v_perm_b32 v25, v13, v70, s65
v_perm_b32 v26, v14, v70, s66
v_perm_b32 v27, v15, v70, s67
v_max3_f32 v28, |v24|, |v25|, |v26|
v_med3_f32 v29, |v24|, |v25|, |v26|
v_min3_f32 v30, |v24|, |v25|, |v26|
v_med3_f32 v32, v28, v29, |v27|
v_med3_f32 v33, v29, v30, |v27|
v_max_f32 v31, v28, |v27|
v_perm_b32 v37, v31, v32, s72
v_bfi_b32 v31, 3, v32, v31
v_lshlrev_b32 v31, 4, v31
v_bfi_b32 v44, 15, v44, v31
v_cmpx_eq_u32_sdwa vcc, v33, v32 src0_sel:WORD_1 src1_sel:WORD_1
v_mov_b64 v[80:81], v[78:79]
v_mov_b64 v[78:79], v[76:77]
v_mov_b32 v76, v33
v_min_f32 v77, v30, |v27|
s_mov_b64 exec, -1
v_perm_b32 v24, v12, v71, s68
v_perm_b32 v25, v13, v71, s69
v_perm_b32 v26, v14, v71, s70
v_perm_b32 v27, v15, v71, s71
v_max3_f32 v28, |v24|, |v25|, |v26|
v_med3_f32 v29, |v24|, |v25|, |v26|
v_min3_f32 v30, |v24|, |v25|, |v26|
v_med3_f32 v32, v28, v29, |v27|
v_med3_f32 v33, v29, v30, |v27|
v_max_f32 v31, v28, |v27|
v_perm_b32 v41, v31, v32, s72
v_bfi_b32 v31, 3, v32, v31
v_lshlrev_b32 v31, 4, v31
v_bfi_b32 v46, 15, v46, v31
v_cmpx_eq_u32_sdwa vcc, v33, v32 src0_sel:WORD_1 src1_sel:WORD_1
v_or_b32 v82, v82, v80
v_mov_b64 v[80:81], v[78:79]
v_mov_b64 v[78:79], v[76:77]
v_mov_b32 v76, v33
v_min_f32 v77, v30, |v27|
s_mov_b64 exec, -1
s_waitcnt vmcnt(4)
v_perm_b32 v24, v16, v72, s64
v_perm_b32 v25, v17, v72, s65
v_perm_b32 v26, v18, v72, s66
v_perm_b32 v27, v19, v72, s67
v_max3_f32 v28, |v24|, |v25|, |v26|
v_med3_f32 v29, |v24|, |v25|, |v26|
v_min3_f32 v30, |v24|, |v25|, |v26|
v_med3_f32 v32, v28, v29, |v27|
v_med3_f32 v33, v29, v30, |v27|
v_max_f32 v31, v28, |v27|
v_perm_b32 v38, v31, v32, s72
v_bfi_b32 v45, 3, v32, v31
v_cmpx_eq_u32_sdwa vcc, v33, v32 src0_sel:WORD_1 src1_sel:WORD_1
v_or_b32 v82, v82, v80
v_mov_b64 v[80:81], v[78:79]
v_mov_b64 v[78:79], v[76:77]
v_mov_b32 v76, v33
v_min_f32 v77, v30, |v27|
s_mov_b64 exec, -1
v_perm_b32 v24, v16, v73, s68
v_perm_b32 v25, v17, v73, s69
v_perm_b32 v26, v18, v73, s70
v_perm_b32 v27, v19, v73, s71
v_max3_f32 v28, |v24|, |v25|, |v26|
v_med3_f32 v29, |v24|, |v25|, |v26|
v_min3_f32 v30, |v24|, |v25|, |v26|
v_med3_f32 v32, v28, v29, |v27|
v_med3_f32 v33, v29, v30, |v27|
v_max_f32 v31, v28, |v27|
v_perm_b32 v42, v31, v32, s72
v_bfi_b32 v47, 3, v32, v31
v_cmpx_eq_u32_sdwa vcc, v33, v32 src0_sel:WORD_1 src1_sel:WORD_1
v_or_b32 v82, v82, v80
v_mov_b64 v[80:81], v[78:79]
v_mov_b64 v[78:79], v[76:77]
v_mov_b32 v76, v33
v_min_f32 v77, v30, |v27|
s_mov_b64 exec, -1
s_waitcnt vmcnt(0)
v_perm_b32 v24, v20, v74, s64
v_perm_b32 v25, v21, v74, s65
v_perm_b32 v26, v22, v74, s66
v_perm_b32 v27, v23, v74, s67
v_max3_f32 v28, |v24|, |v25|, |v26|
v_med3_f32 v29, |v24|, |v25|, |v26|
v_min3_f32 v30, |v24|, |v25|, |v26|
v_med3_f32 v32, v28, v29, |v27|
v_med3_f32 v33, v29, v30, |v27|
v_max_f32 v31, v28, |v27|
v_perm_b32 v39, v31, v32, s72
v_bfi_b32 v31, 3, v32, v31
v_lshlrev_b32 v31, 4, v31
v_bfi_b32 v45, 15, v45, v31
v_cmpx_eq_u32_sdwa vcc, v33, v32 src0_sel:WORD_1 src1_sel:WORD_1
v_or_b32 v82, v82, v80
v_mov_b64 v[80:81], v[78:79]
v_mov_b64 v[78:79], v[76:77]
v_mov_b32 v76, v33
v_min_f32 v77, v30, |v27|
s_mov_b64 exec, -1
v_perm_b32 v24, v20, v75, s68
v_perm_b32 v25, v21, v75, s69
v_perm_b32 v26, v22, v75, s70
v_perm_b32 v27, v23, v75, s71
v_max3_f32 v28, |v24|, |v25|, |v26|
v_med3_f32 v29, |v24|, |v25|, |v26|
v_min3_f32 v30, |v24|, |v25|, |v26|
v_med3_f32 v32, v28, v29, |v27|
v_med3_f32 v33, v29, v30, |v27|
v_max_f32 v31, v28, |v27|
v_perm_b32 v43, v31, v32, s72
v_bfi_b32 v31, 3, v32, v31
v_lshlrev_b32 v31, 4, v31
v_bfi_b32 v47, 15, v47, v31
v_cmpx_eq_u32_sdwa vcc, v33, v32 src0_sel:WORD_1 src1_sel:WORD_1
v_or_b32 v82, v82, v80
v_mov_b64 v[80:81], v[78:79]
v_mov_b64 v[78:79], v[76:77]
v_mov_b32 v76, v33
v_min_f32 v77, v30, |v27|
s_mov_b64 exec, -1
s_mov_b32 vcc_lo, 0x33333333
s_mov_b32 vcc_hi, 0x33333333
v_cndmask_b32_dpp v24, v40, v36, vcc quad_perm:[2,3,0,1] row_mask:0xf bank_mask:0xf
v_cndmask_b32_dpp v25, v41, v37, vcc quad_perm:[2,3,0,1] row_mask:0xf bank_mask:0xf
v_cndmask_b32_dpp v26, v42, v38, vcc quad_perm:[2,3,0,1] row_mask:0xf bank_mask:0xf
v_cndmask_b32_dpp v27, v43, v39, vcc quad_perm:[2,3,0,1] row_mask:0xf bank_mask:0xf
s_not_b64 vcc, vcc
buffer_store_dwordx4 v[24:27], v51, s[24:27], 0 offen sc1
v_cndmask_b32_dpp v40, v36, v40, vcc quad_perm:[2,3,0,1] row_mask:0xf bank_mask:0xf
v_cndmask_b32_dpp v41, v37, v41, vcc quad_perm:[2,3,0,1] row_mask:0xf bank_mask:0xf
v_cndmask_b32_dpp v42, v38, v42, vcc quad_perm:[2,3,0,1] row_mask:0xf bank_mask:0xf
v_cndmask_b32_dpp v43, v39, v43, vcc quad_perm:[2,3,0,1] row_mask:0xf bank_mask:0xf
s_mov_b32 s52, 0x0c0c0400
s_mov_b32 s53, 0x04000c0c
buffer_store_dwordx4 v[40:43], v66, s[24:27], 0 offen sc1
v_perm_b32 v48, v45, v44, s52
v_perm_b32 v49, v47, v46, s53
v_or_b32 v48, v48, v49
s_nop 1
v_mov_b32_dpp v49, v48 quad_perm:[2,3,0,1] row_mask:0xf bank_mask:0xf
v_perm_b32 v48, v49, v48, v55
ds_permute_b32 v48, v52, v48
v_cmp_lt_u32 s[54:55], s74, v82
L_emit:
v_cmp_lt_u32 vcc, s74, v76
v_cmp_eq_u32_sdwa s[48:49], v77, v76 src0_sel:WORD_1 src1_sel:WORD_1
v_perm_b32 v63, v76, v53, s73
v_bfe_u32 v62, v76, 2, 4
v_and_b32 v64, 0x80, v76
v_lshl_add_u32 v63, v62, 1, v63
v_mbcnt_lo_u32_b32 v62, vcc_lo, 0
v_mbcnt_hi_u32_b32 v62, vcc_hi, v62
v_add_u32 v63, v64, v63
v_add_u32 v62, s75, v62
s_bcnt1_i32_b64 s52, vcc
s_add_u32 s75, s75, s52
v_cmp_gt_u32 s[52:53], 15, v62
v_and_b32 v64, 12, v62
v_mad_u32_u24 v62, v64, 3, v62
v_lshl_add_u32 v62, v62, 2, s51
s_and_b64 s[48:49], s[48:49], vcc
s_and_b64 exec, s[52:53], vcc
ds_write_b32 v62, v63
s_mov_b64 exec, s[48:49]
v_mov_b32 v76, v77
v_mov_b32 v77, 0
s_not_b64 exec, exec
v_mov_b64 v[76:77], v[78:79]
v_mov_b64 v[78:79], v[80:81]
v_mov_b64 v[80:81], 0
s_mov_b64 exec, -1
v_or3_b32 v62, v76, v78, v80
v_cmp_lt_u32 vcc, s74, v62
s_cmp_lg_u64 s[54:55], 0
s_cselect_b32 s52, 99, s75
s_cmp_gt_u32 s52, 15
s_cselect_b32 s52, -1, 0
v_mov_b32 v63, s51
s_cbranch_vccnz L_emit
v_mov_b32 v62, s52
ds_write_b32 v63, v62 offset:204
v_lshlrev_b32 v11, 4, v63
s_waitcnt lgkmcnt(0)
s_barrier
s_mov_b64 exec, 0xffff
ds_read_b32 v67, v57
s_mov_b64 exec, -1
buffer_store_dword v48, v54, s[24:27], 0 offen sc1
s_mov_b32 exec_hi, 0xffff
s_waitcnt lgkmcnt(0)
buffer_store_dword v67, v65, s[24:27], 0 offen sc1
s_mov_b64 exec, 1
buffer_load_dword v8, v11, s[36:39], 0 offen sc1
s_mov_b64 exec, -1
s_lshl_b32 s52, s84, 7
s_add_u32 s52, s52, 458752
v_lshl_add_u32 v9, v7, 2, s52
v_mov_b32 v10, 1
s_waitcnt vmcnt(0)
s_mov_b32 s85, 0x230003c
s_barrier
s_cmp_lg_u32 s40, 0
s_cbranch_scc1 L_cons2
v_readfirstlane_b32 s47, v8
s_mov_b64 exec, 0xffff
s_cmp_lg_u32 s47, 1
s_cbranch_scc1 L_pwait
L_pset:
buffer_store_dword v10, v9, s[24:27], 0 offen sc1
L_notlast:
s_mov_b64 exec, -1
L_cons2:
v_lshrrev_b32 v72, 3, v7
v_and_b32 v73, 7, v7
v_xor_b32 v73, v73, v72
v_mul_u32_u24 v72, 1152, v72
s_and_b32 s47, s40, 1
s_mul_i32 s47, s47, 9216
s_lshr_b32 s3, s40, 1
s_lshl_b32 s3, s3, 7
s_add_u32 s47, s47, s3
v_lshl_add_u32 v72, v73, 4, v72
v_add_u32 v3, s47, v72
s_lshl_b32 s44, s40, 10
s_mul_i32 s45, s2, 18432
s_mov_b32 s46, s45
s_branch L_cons3
L_pwait:
s_mov_b32 s3, 20015
L_pwait1:
buffer_load_dword v8, off, s[36:39], 0 sc1
s_waitcnt vmcnt(0)
v_readfirstlane_b32 s47, v8
s_nop 3
s_cmp_eq_u32 s47, 1
s_cbranch_scc1 L_pset
s_sub_u32 s3, s3, 1
s_cbranch_scc0 L_pwait1
s_branch L_notlast
L_cons:
v_readfirstlane_b32 s40, v1
s_mov_b32 s86, 0
s_mov_b32 s85, 0x700030
s_mov_b32 s47, 0x700030
s_bitcmp1_b32 s2, 3
s_cselect_b32 s85, s85, 0x230003c
s_cselect_b32 s47, s47, 0x230003c
s_bitcmp1_b32 s2, 6
s_cselect_b32 s85, s47, s85
v_lshrrev_b32 v72, 3, v7
v_and_b32 v73, 7, v7
v_xor_b32 v73, v73, v72
v_mul_u32_u24 v72, 1152, v72
s_and_b32 s47, s40, 1
s_mul_i32 s47, s47, 9216
s_lshr_b32 s3, s40, 1
s_lshl_b32 s3, s3, 7
s_add_u32 s47, s47, s3
v_lshl_add_u32 v72, v73, 4, v72
v_add_u32 v3, s47, v72
s_lshl_b32 s44, s40, 10
s_mul_i32 s45, s2, 18432
s_mov_b32 s46, s45
s_waitcnt lgkmcnt(0)
s_mov_b32 s30, 663552
s_mov_b32 s31, 0x20000
s_mov_b32 s28, s6
s_and_b32 s29, s7, 0xffff
s_mov_b32 s18, 75497472
s_mov_b32 s19, 0x20000
s_mov_b32 s16, s4
s_and_b32 s17, s5, 0xffff
s_mov_b32 s26, 301989888
s_mov_b32 s27, 0x20000
s_mov_b32 s24, s14
s_and_b32 s25, s15, 0xffff
s_mov_b32 s34, 1152
s_mov_b32 s35, 0x20000
s_mov_b32 s32, s8
s_and_b32 s33, s9, 0xffff
s_mov_b32 s22, 0
s_mov_b32 s23, 0x20000
s_mov_b32 s20, s10
s_and_b32 s21, s11, 0xffff
s_mov_b32 s38, 256
s_mov_b32 s39, 0x20000
s_mov_b32 s36, s12
s_and_b32 s37, s13, 0xffff
s_cmp_lg_u32 s2, 200
s_cbranch_scc1 L_cons3
v_lshlrev_b32 v8, 4, v0
v_mov_b64 v[12:13], 0
v_mov_b64 v[14:15], 0
buffer_store_dwordx4 v[12:15], v8, s[36:39], 0 offen sc1
v_add_u32 v8, 458752, v8
v_add_u32 v9, 4096, v8
buffer_store_dwordx4 v[12:15], v8, s[24:27], 0 offen sc1
buffer_store_dwordx4 v[12:15], v9, s[24:27], 0 offen sc1
v_mov_b32 v10, 1
v_lshlrev_b32 v11, 2, v0
s_waitcnt vmcnt(0)
s_barrier
s_mov_b32 exec_hi, 0
buffer_store_dword v10, v11, s[36:39], 0 offen sc1
s_mov_b64 exec, -1
L_cons3:
s_lshr_b32 s47, s40, 1
s_lshl_b32 s3, s47, 11
s_sub_u32 s8, 15488, s3
s_lshl_b32 s3, s47, 7
s_add_u32 s7, s45, 128
s_sub_u32 s7, s7, s3
s_sub_u32 s10, s47, 1
s_sub_u32 s11, 0, s47
s_mov_b32 s9, s44
s_mov_b32 s13, 4718592
s_mov_b32 s15, 16
s_mov_b32 s14, s13
v_and_b32 v80, 3, v7
v_bfe_u32 v81, v7, 2, 2
v_bfe_u32 v82, v7, 4, 1
v_lshlrev_b32 v81, 3, v81
v_lshl_add_u32 v81, v80, 5, v81
v_lshl_add_u32 v81, v82, 7, v81
s_lshl_b32 s47, s40, 8
v_add_u32 v81, s47, v81
s_lshl_b32 s47, s40, 5
s_add_u32 s47, s47, 1024
v_lshl_add_u32 v80, v80, 3, s47
v_cmp_gt_u32 vcc, 32, v7
s_nop 1
v_cndmask_b32 v80, v80, v81, vcc
buffer_load_dwordx2 v[110:111], v80, s[32:35], 0 offen
s_cmp_lt_u32 s84, 41
s_cbranch_scc1 L_pfd
s_waitcnt vmcnt(0)
L_pfd:
s_bfe_u32 s88, s85, 0x40014
s_mov_b32 s3, 55680
s_cmp_ge_u32 s88, 6
s_cselect_b32 s3, s3, 0
s_cmp_ge_u32 s84, 41
s_cselect_b32 s3, s3, 0
L_pf:
s_add_u32 m0, s44, 0
s_nop 0
buffer_load_dwordx4 v3, s[16:19], s45 offen offset:0 nt lds
s_add_u32 m0, s44, 3840
s_nop 0
buffer_load_dwordx4 v3, s[16:19], s45 offen offset:256 nt lds
s_add_u32 m0, s44, 7680
s_nop 0
buffer_load_dwordx4 v3, s[16:19], s45 offen offset:512 nt lds
s_add_u32 m0, s44, 11520
s_nop 0
buffer_load_dwordx4 v3, s[16:19], s45 offen offset:768 nt lds
s_add_u32 m0, s44, s8
s_mov_b64 exec, s[10:11]
buffer_load_dwordx4 v3, s[16:19], s7 offen offset:896 nt lds
s_mov_b64 exec, -1
s_cmp_lg_u32 s44, 37120
s_cbranch_scc1 L_pf_f
s_mov_b64 exec, 1
buffer_load_dword v124, off, s[36:39], 0 sc1
s_mov_b64 exec, -1
L_pf_f:
s_cmp_ge_u32 s44, s3
s_cbranch_scc1 L_pf_n
s_waitcnt vmcnt(1)
L_pf_n:
s_add_u32 s7, s7, s13
s_add_u32 s44, s44, 18560
s_add_u32 s45, s45, s13
s_mov_b32 s13, 4718592
s_sub_u32 s88, s88, 1
s_cmp_lg_u32 s88, 0
s_cbranch_scc1 L_pf
L_pf_e:
L_rest:
s_mov_b32 s92, 0x80
s_mov_b32 s47, 0x80
s_bitcmp1_b32 s2, 3
s_cselect_b32 s92, s92, 0x88
s_cselect_b32 s47, s47, 0x88
s_bitcmp1_b32 s2, 6
s_cselect_b32 s92, s47, s92
s_mov_b32 s3, 0x88
s_cmp_lt_u32 s84, 41
s_cselect_b32 s92, s3, s92
s_mov_b32 s87, 0x80
s_mov_b32 s3, 0x80
s_cmp_lt_u32 s84, 41
s_cselect_b32 s87, s3, s87
v_and_b32 v72, 15, v7
v_lshrrev_b32 v73, 4, v7
v_and_b32 v74, 7, v7
v_xor_b32 v74, v74, v73
v_lshlrev_b32 v74, 4, v74
v_lshl_add_u32 v0, v72, 7, v74
v_xor_b32 v1, 64, v0
s_mul_i32 s93, s40, 3584
s_add_u32 s93, s93, 148480
v_lshl_add_u32 v2, v73, 4, s93
v_and_b32 v74, 14, v7
v_mul_u32_u24 v4, 1152, v74
v_and_b32 v74, 1, v7
v_lshl_add_u32 v4, v74, 4, v4
v_lshl_add_u32 v4, v73, 5, v4
s_lshl_b32 s47, s40, 8
v_add_u32 v4, s47, v4
s_lshl_b32 s47, s40, 5
s_add_u32 s47, s47, 1024
v_lshrrev_b32 v72, 2, v7
v_and_b32 v73, 3, v7
v_lshl_add_u32 v6, v73, 4, v72
v_lshlrev_b32 v6, 2, v6
v_mul_u32_u24 v5, 1152, v72
v_lshl_add_u32 v5, v73, 3, v5
v_add_u32 v5, s47, v5
v_and_b32 v72, 15, v7
v_lshrrev_b32 v73, 4, v7
v_lshl_add_u32 v74, s40, 2, v73
v_xor_b32 v74, v74, v72
v_lshlrev_b32 v74, 3, v74
v_lshl_add_u32 v6, v73, 7, v74
v_add_u32 v6, s93, v6
v_add_u32 v6, 2560, v6
v_and_b32 v73, 3, v7
v_lshl_add_u32 v74, v73, 7, v74
v_lshrrev_b32 v72, 2, v72
v_mul_u32_u24 v72, 3584, v72
v_add_u32 v74, 151040, v74
v_add_u32 v254, v72, v74
v_lshrrev_b32 v72, 4, v7
v_lshl_add_u32 v72, s40, 2, v72
v_mul_u32_u24 v5, 1152, v72
v_and_b32 v72, 15, v7
v_lshl_add_u32 v5, v72, 3, v5
v_add_u32 v5, 1024, v5
s_mov_b32 s80, 0x55555555
s_mov_b32 s81, 0x55555555
s_mov_b32 s82, 0xaaaaaaaa
s_mov_b32 s83, 0xaaaaaaaa
v_lshl_add_u32 v109, v7, 4, s93
v_lshl_add_u32 v89, v7, 2, s93
v_mov_b32 v76, 0
v_mov_b32 v77, 0
v_mov_b32 v78, 0
v_mov_b32 v79, 0
v_mov_b32 v90, 0xdddddddd
ds_write_b128 v109, v[76:79]
ds_write_b32 v89, v90 offset:1792
ds_write_b32 v89, v90 offset:2048
ds_write_b32 v89, v90 offset:2304
ds_write_b32 v89, v90 offset:2560
ds_write_b32 v89, v90 offset:2816
ds_write_b32 v89, v90 offset:3072
ds_write_b32 v89, v90 offset:3328
s_lshl_b32 s47, s40, 2
s_add_u32 s47, s47, 163072
v_mov_b32 v88, s47
ds_write_b32 v88, v76
s_mul_i32 s47, s40, 2304
s_add_u32 s47, s47, 373760
v_and_b32 v73, 60, v7
v_mad_u32_u24 v73, v73, 3, v7
v_lshl_add_u32 v72, v73, 4, s47
s_mov_b32 s47, 380672
v_lshl_add_u32 v73, v73, 4, s47
v_lshrrev_b32 v74, 2, v7
v_cmp_gt_u32 vcc, 36, v7
v_lshlrev_b32 v90, 11, v74
v_subrev_u32 v74, 9, v74
v_lshlrev_b32 v74, 12, v74
v_cndmask_b32 v72, v73, v72, vcc
v_cndmask_b32 v90, v74, v90, vcc
s_lshl_b32 s47, s40, 12
s_add_u32 s47, s47, 0x8001
v_mov_b32 v88, 1
v_mov_b32 v94, 0xf001
v_mov_b32 v95, s47
v_cndmask_b32 v94, v94, v88, vcc
v_cndmask_b32 v95, v95, v88, vcc
v_cndmask_b32 v96, 0, 28, vcc
v_cndmask_b32 v97, 32, 0, vcc
v_add_u32 v97, s93, v97
v_cmp_gt_u32 vcc, 56, v7
v_mov_b32 v73, 0x40000000
s_lshr_b32 s47, s2, 3
s_lshl_b32 s47, s47, 2
s_add_u32 s47, s47, s40
s_mul_i32 s47, s47, 2944
v_cndmask_b32 v72, v73, v72, vcc
v_lshl_add_u32 v93, v7, 4, s47
s_mul_i32 s47, s40, 82944
s_add_u32 s47, s47, s86
v_lshl_add_u32 v112, v7, 4, s47
s_mul_i32 s47, s40, 9216
s_add_u32 s47, s47, s86
s_add_u32 s47, s47, 331776
v_lshl_add_u32 v113, v7, 4, s47
s_lshl_b32 s47, s40, 6
s_add_u32 s47, s47, s86
s_add_u32 s47, s47, 368640
v_and_b32 v106, 15, v7
v_lshl_add_u32 v106, v106, 2, s47
v_lshrrev_b32 v107, 4, v7
v_lshl_add_u32 v106, v107, 8, v106
v_and_b32 v74, 15, v7
v_and_b32 v73, 7, v7
v_lshlrev_b32 v100, 1, v73
v_lshlrev_b32 v100, v100, v88
v_lshlrev_b32 v73, 4, v73
v_lshl_add_u32 v92, v74, 7, v73
v_lshl_or_b32 v92, v92, 16, v92
v_lshrrev_b32 v98, 5, v7
v_bfe_u32 v99, v7, 3, 2
v_lshl_add_u32 v99, v99, 6, s93
v_lshl_add_u32 v101, v7, 1, s93
v_lshrrev_b32 v102, 4, v7
v_lshl_add_u32 v102, v102, 3, s93
v_lshrrev_b32 v103, 1, v7
v_lshlrev_b32 v103, 5, v103
s_mov_b32 s89, 0
s_cmp_lg_u32 s40, 0
s_cbranch_scc1 L_ready
s_mov_b32 s3, 20015
s_mov_b32 s47, 458752
v_lshl_add_u32 v9, v7, 7, s47
s_bfe_u32 s47, s85, 0x40014
s_cmp_ge_u32 s47, 6
s_waitcnt vmcnt(15)
s_cbranch_scc1 L_deep
s_waitcnt vmcnt(0)
L_deep:
v_readfirstlane_b32 s47, v124
s_mov_b32 exec_hi, 511
s_cmp_lg_u32 s47, 1
s_cbranch_scc1 L_cwait
L_poll:
buffer_load_dword v8, v9, s[24:27], 0 offen sc1
s_sub_u32 s3, s3, 1
s_cbranch_scc1 L_giveup
s_waitcnt vmcnt(0)
v_cmp_ne_u32 vcc, 1, v8
s_nop 4
s_cbranch_vccnz L_poll
L_polled:
s_mov_b64 exec, -1
L_ready:
s_waitcnt lgkmcnt(0)
s_barrier
buffer_load_dwordx4 v[8:11], v72, s[24:27], 0 offen offset:0 sc1
buffer_load_dwordx4 v[12:15], v72, s[24:27], 0 offen offset:64 sc1
buffer_load_dwordx4 v[16:19], v72, s[24:27], 0 offen offset:128 sc1
buffer_load_dwordx4 v[20:23], v72, s[24:27], 0 offen offset:192 sc1
buffer_load_dwordx4 v[76:79], v93, s[24:27], 0 offen offset:0 sc1
buffer_load_dwordx4 v[80:83], v93, s[24:27], 0 offen offset:1024 sc1
buffer_load_dwordx4 v[84:87], v93, s[24:27], 0 offen offset:2048 sc1
buffer_load_dword v174, v106, s[24:27], 0 offen offset:0 sc1
buffer_load_dword v175, v106, s[24:27], 0 offen offset:1024 sc1
buffer_load_dword v176, v106, s[24:27], 0 offen offset:2048 sc1
buffer_load_dword v177, v106, s[24:27], 0 offen offset:3072 sc1
s_mov_b32 s99, 4096
buffer_load_dword v178, v106, s[24:27], s99 offen offset:0 sc1
s_mov_b32 s98, 0
buffer_load_dwordx4 v[138:141], v113, s[24:27], s98 offen sc1
s_mov_b32 s99, 0
buffer_load_dwordx4 a[0:3], v112, s[24:27], s99 offen offset:0 sc1
buffer_load_dwordx4 a[4:7], v112, s[24:27], s99 offen offset:1024 sc1
buffer_load_dwordx4 a[8:11], v112, s[24:27], s99 offen offset:2048 sc1
s_waitcnt vmcnt(12)
v_cmp_ne_u32 s[90:91], 0, v23
v_cmp_ne_u32 s[78:79], 0, v16
v_and_b32 v73, v94, v8
v_lshrrev_b32 v72, 10, v8
v_cmp_eq_u32 s[48:49], v73, v95
v_and_or_b32 v24, v72, v96, v97
s_mov_b64 exec, s[48:49]
ds_add_rtn_u32 v40, v24, v88
s_mov_b64 exec, -1
buffer_load_dwordx4 a[12:15], v112, s[24:27], s99 offen offset:3072 sc1
v_and_b32 v73, v94, v9
v_lshrrev_b32 v72, 10, v9
v_cmp_eq_u32 s[50:51], v73, v95
v_and_or_b32 v25, v72, v96, v97
s_mov_b64 exec, s[50:51]
ds_add_rtn_u32 v41, v25, v88
s_mov_b64 exec, -1
v_and_b32 v73, v94, v10
v_lshrrev_b32 v72, 10, v10
v_cmp_eq_u32 s[52:53], v73, v95
v_and_or_b32 v26, v72, v96, v97
s_mov_b64 exec, s[52:53]
ds_add_rtn_u32 v42, v26, v88
s_mov_b64 exec, -1
s_mov_b32 s99, 4096
buffer_load_dwordx4 a[16:19], v112, s[24:27], s99 offen offset:0 sc1
v_and_b32 v73, v94, v11
v_lshrrev_b32 v72, 10, v11
v_cmp_eq_u32 s[54:55], v73, v95
v_and_or_b32 v27, v72, v96, v97
s_mov_b64 exec, s[54:55]
ds_add_rtn_u32 v43, v27, v88
s_mov_b64 exec, -1
buffer_load_dwordx4 a[20:23], v112, s[24:27], s99 offen offset:1024 sc1
v_and_b32 v73, v94, v12
v_lshrrev_b32 v72, 10, v12
v_cmp_eq_u32 s[56:57], v73, v95
v_and_or_b32 v28, v72, v96, v97
s_mov_b64 exec, s[56:57]
ds_add_rtn_u32 v44, v28, v88
s_mov_b64 exec, -1
buffer_load_dwordx4 a[24:27], v112, s[24:27], s99 offen offset:2048 sc1
v_and_b32 v73, v94, v13
v_lshrrev_b32 v72, 10, v13
v_cmp_eq_u32 s[58:59], v73, v95
v_and_or_b32 v29, v72, v96, v97
s_mov_b64 exec, s[58:59]
ds_add_rtn_u32 v45, v29, v88
s_mov_b64 exec, -1
v_and_b32 v73, v94, v14
v_lshrrev_b32 v72, 10, v14
v_cmp_eq_u32 s[60:61], v73, v95
v_and_or_b32 v30, v72, v96, v97
s_mov_b64 exec, s[60:61]
ds_add_rtn_u32 v46, v30, v88
s_mov_b64 exec, -1
buffer_load_dwordx4 a[28:31], v112, s[24:27], s99 offen offset:3072 sc1
v_and_b32 v73, v94, v15
v_lshrrev_b32 v72, 10, v15
v_cmp_eq_u32 s[62:63], v73, v95
v_and_or_b32 v31, v72, v96, v97
s_mov_b64 exec, s[62:63]
ds_add_rtn_u32 v47, v31, v88
s_mov_b64 exec, -1
s_mov_b32 s99, 8192
buffer_load_dwordx4 a[32:35], v112, s[24:27], s99 offen offset:0 sc1
s_cmp_lg_u64 s[78:79], 0
s_cbranch_scc1 L_more1
L_more1b:
ds_read_b32 v72, v89
v_mov_b32 v73, 0
s_mov_b32 s98, 1024
buffer_load_dwordx4 v[142:145], v113, s[24:27], s98 offen sc1
buffer_load_dwordx4 a[36:39], v112, s[24:27], s99 offen offset:1024 sc1
buffer_load_dwordx4 a[40:43], v112, s[24:27], s99 offen offset:2048 sc1
s_waitcnt lgkmcnt(0)
s_mov_b64 vcc, s[80:81]
v_cndmask_b32_dpp v73, v72, v73, vcc quad_perm:[0,0,2,2] row_mask:0xf bank_mask:0xf
v_add_u32 v91, v103, v73
v_add_u32 v73, v72, v73
v_cmp_lt_u32 vcc, 32, v73
s_or_b32 s90, s90, s91
s_and_b32 s47, vcc_lo, 0x1ff
s_or_b32 s47, s47, s90
s_cbranch_scc1 L_greedy
L_greedyb:
buffer_load_dwordx4 a[44:47], v112, s[24:27], s99 offen offset:3072 sc1
ds_bpermute_b32 v56, v24, v91
ds_bpermute_b32 v57, v25, v91
ds_bpermute_b32 v58, v26, v91
ds_bpermute_b32 v59, v27, v91
ds_bpermute_b32 v60, v28, v91
ds_bpermute_b32 v61, v29, v91
ds_bpermute_b32 v62, v30, v91
ds_bpermute_b32 v63, v31, v91
s_mov_b32 s99, 12288
buffer_load_dwordx4 a[48:51], v112, s[24:27], s99 offen offset:0 sc1
buffer_load_dwordx4 a[52:55], v112, s[24:27], s99 offen offset:1024 sc1
buffer_load_dwordx4 a[56:59], v112, s[24:27], s99 offen offset:2048 sc1
s_waitcnt lgkmcnt(7)
v_add_u32 v73, v40, v56
v_and_b32 v72, 0x87e, v8
v_lshl_add_u32 v73, v73, 1, s93
v_add_u32 v72, v90, v72
s_andn2_b64 exec, s[48:49], s[90:91]
ds_write_b16_d16_hi v73, v8 offset:64
ds_write_b16 v73, v72 offset:384
ds_write_b16 v73, v8 offset:704
s_mov_b64 exec, -1
buffer_load_dwordx4 a[60:63], v112, s[24:27], s99 offen offset:3072 sc1
s_waitcnt lgkmcnt(9)
v_add_u32 v73, v41, v57
v_and_b32 v72, 0x87e, v9
v_lshl_add_u32 v73, v73, 1, s93
v_add_u32 v72, v90, v72
s_andn2_b64 exec, s[50:51], s[90:91]
ds_write_b16_d16_hi v73, v9 offset:64
ds_write_b16 v73, v72 offset:384
ds_write_b16 v73, v9 offset:704
s_mov_b64 exec, -1
s_mov_b32 s99, 16384
buffer_load_dwordx4 a[64:67], v112, s[24:27], s99 offen offset:0 sc1
s_waitcnt lgkmcnt(11)
v_add_u32 v73, v42, v58
v_and_b32 v72, 0x87e, v10
v_lshl_add_u32 v73, v73, 1, s93
v_add_u32 v72, v90, v72
s_andn2_b64 exec, s[52:53], s[90:91]
ds_write_b16_d16_hi v73, v10 offset:64
ds_write_b16 v73, v72 offset:384
ds_write_b16 v73, v10 offset:704
s_mov_b64 exec, -1
buffer_load_dwordx4 a[68:71], v112, s[24:27], s99 offen offset:1024 sc1
s_waitcnt lgkmcnt(13)
v_add_u32 v73, v43, v59
v_and_b32 v72, 0x87e, v11
v_lshl_add_u32 v73, v73, 1, s93
v_add_u32 v72, v90, v72
s_andn2_b64 exec, s[54:55], s[90:91]
ds_write_b16_d16_hi v73, v11 offset:64
ds_write_b16 v73, v72 offset:384
ds_write_b16 v73, v11 offset:704
s_mov_b64 exec, -1
s_mov_b32 s98, 2048
buffer_load_dwordx4 v[146:149], v113, s[24:27], s98 offen sc1
s_waitcnt lgkmcnt(15)
v_add_u32 v73, v44, v60
v_and_b32 v72, 0x87e, v12
v_lshl_add_u32 v73, v73, 1, s93
v_add_u32 v72, v90, v72
s_andn2_b64 exec, s[56:57], s[90:91]
ds_write_b16_d16_hi v73, v12 offset:64
ds_write_b16 v73, v72 offset:384
ds_write_b16 v73, v12 offset:704
s_mov_b64 exec, -1
buffer_load_dwordx4 a[72:75], v112, s[24:27], s99 offen offset:2048 sc1
s_waitcnt lgkmcnt(15)
v_add_u32 v73, v45, v61
v_and_b32 v72, 0x87e, v13
v_lshl_add_u32 v73, v73, 1, s93
v_add_u32 v72, v90, v72
s_andn2_b64 exec, s[58:59], s[90:91]
ds_write_b16_d16_hi v73, v13 offset:64
ds_write_b16 v73, v72 offset:384
ds_write_b16 v73, v13 offset:704
s_mov_b64 exec, -1
buffer_load_dwordx4 a[76:79], v112, s[24:27], s99 offen offset:3072 sc1
s_waitcnt lgkmcnt(15)
v_add_u32 v73, v46, v62
v_and_b32 v72, 0x87e, v14
v_lshl_add_u32 v73, v73, 1, s93
v_add_u32 v72, v90, v72
s_andn2_b64 exec, s[60:61], s[90:91]
ds_write_b16_d16_hi v73, v14 offset:64
ds_write_b16 v73, v72 offset:384
ds_write_b16 v73, v14 offset:704
s_mov_b64 exec, -1
s_mov_b32 s99, 20480
buffer_load_dwordx4 a[80:83], v112, s[24:27], s99 offen offset:0 sc1
s_waitcnt lgkmcnt(15)
v_add_u32 v73, v47, v63
v_and_b32 v72, 0x87e, v15
v_lshl_add_u32 v73, v73, 1, s93
v_add_u32 v72, v90, v72
s_andn2_b64 exec, s[62:63], s[90:91]
ds_write_b16_d16_hi v73, v15 offset:64
ds_write_b16 v73, v72 offset:384
ds_write_b16 v73, v15 offset:704
s_mov_b64 exec, -1
buffer_load_dwordx4 a[84:87], v112, s[24:27], s99 offen offset:1024 sc1
buffer_load_dwordx4 a[88:91], v112, s[24:27], s99 offen offset:2048 sc1
s_cmp_lg_u64 s[78:79], 0
s_cbranch_scc1 L_more2
L_more2b:
ds_read_u16 v8, v101 offset:704
ds_read_u16 v9, v101 offset:832
ds_read_u16 v10, v101 offset:960
ds_read2_b64 v[118:121], v102 offset0:48 offset1:52
ds_read2_b64 v[122:125], v102 offset0:56 offset1:60
ds_read2_b64 v[126:129], v102 offset0:64 offset1:68
ds_read2_b64 v[130:133], v102 offset0:72 offset1:76
ds_read2_b64 v[134:137], v102 offset0:80 offset1:84
buffer_load_dwordx4 a[92:95], v112, s[24:27], s99 offen offset:3072 sc1
s_mov_b32 s99, 24576
buffer_load_dwordx4 a[96:99], v112, s[24:27], s99 offen offset:0 sc1
buffer_load_dwordx4 a[100:103], v112, s[24:27], s99 offen offset:1024 sc1
s_waitcnt lgkmcnt(5)
v_lshrrev_b32 v72, 12, v8
v_cmp_ne_u32 vcc, 0, v8
v_min_u32 v72, 8, v72
v_add3_u32 v72, v72, v98, 0
v_lshlrev_b32 v73, 4, v72
v_lshrrev_b32 v72, 1, v72
buffer_load_dwordx4 a[104:107], v112, s[24:27], s99 offen offset:2048 sc1
v_lshlrev_b32 v73, v73, v100
v_lshl_add_u32 v72, v72, 8, v99
v_bfe_u32 v74, v8, 7, 4
v_lshl_add_u32 v72, v74, 2, v72
s_mov_b64 exec, vcc
ds_xor_b32 v72, v73 offset:1792
s_mov_b64 exec, -1
v_lshrrev_b32 v72, 12, v9
v_cmp_ne_u32 vcc, 0, v9
v_min_u32 v72, 8, v72
v_add3_u32 v72, v72, v98, 2
v_lshlrev_b32 v73, 4, v72
v_lshrrev_b32 v72, 1, v72
s_mov_b32 s98, 3072
buffer_load_dwordx4 v[150:153], v113, s[24:27], s98 offen sc1
v_lshlrev_b32 v73, v73, v100
v_lshl_add_u32 v72, v72, 8, v99
v_bfe_u32 v74, v9, 7, 4
v_lshl_add_u32 v72, v74, 2, v72
s_mov_b64 exec, vcc
ds_xor_b32 v72, v73 offset:1792
s_mov_b64 exec, -1
buffer_load_dwordx4 a[108:111], v112, s[24:27], s99 offen offset:3072 sc1
v_lshrrev_b32 v72, 12, v10
v_cmp_ne_u32 vcc, 0, v10
v_min_u32 v72, 8, v72
v_add3_u32 v72, v72, v98, 4
v_lshlrev_b32 v73, 4, v72
v_lshrrev_b32 v72, 1, v72
v_lshlrev_b32 v73, v73, v100
v_lshl_add_u32 v72, v72, 8, v99
v_bfe_u32 v74, v10, 7, 4
v_lshl_add_u32 v72, v74, 2, v72
s_mov_b64 exec, vcc
s_mov_b32 exec_hi, 0
ds_xor_b32 v72, v73 offset:1792
s_mov_b64 exec, -1
s_mov_b32 s99, 28672
buffer_load_dwordx4 a[112:115], v112, s[24:27], s99 offen offset:0 sc1
ds_read_b32 v179, v89 offset:1792
ds_read_b32 v180, v89 offset:2048
ds_read_b32 v181, v89 offset:2304
ds_read_b32 v182, v89 offset:2560
ds_read_b32 v183, v89 offset:2816
ds_read_b32 v184, v89 offset:3072
ds_read_b32 v185, v89 offset:3328
buffer_load_dwordx4 a[116:119], v112, s[24:27], s99 offen offset:1024 sc1
s_waitcnt lgkmcnt(10)
v_xor_b32 v118, v92, v118
v_xor_b32 v119, v92, v119
v_xor_b32 v120, v92, v120
v_xor_b32 v121, v92, v121
buffer_load_dwordx4 a[120:123], v112, s[24:27], s99 offen offset:2048 sc1
v_xor_b32 v122, v92, v122
v_xor_b32 v123, v92, v123
v_xor_b32 v124, v92, v124
v_xor_b32 v125, v92, v125
v_xor_b32 v126, v92, v126
v_xor_b32 v127, v92, v127
v_xor_b32 v128, v92, v128
v_xor_b32 v129, v92, v129
buffer_load_dwordx4 a[124:127], v112, s[24:27], s99 offen offset:3072 sc1
v_xor_b32 v130, v92, v130
v_xor_b32 v131, v92, v131
v_xor_b32 v132, v92, v132
v_xor_b32 v133, v92, v133
v_xor_b32 v134, v92, v134
v_xor_b32 v135, v92, v135
v_xor_b32 v136, v92, v136
v_xor_b32 v137, v92, v137
v_lshlrev_b32 v114, 16, v110
v_and_b32 v115, 0xffff0000, v110
v_lshlrev_b32 v116, 16, v111
v_and_b32 v117, 0xffff0000, v111
s_mov_b32 exec_hi, 15
ds_write_b128 v109, v[114:117] offset:1024
s_mov_b64 exec, -1
s_mov_b32 s99, 32768
buffer_load_dwordx4 a[128:131], v112, s[24:27], s99 offen offset:0 sc1
s_mov_b32 s41, 2
s_mov_b32 s42, 0
s_mov_b32 s4, 37120
s_mov_b32 s22, 75497472
s_mov_b32 s5, 18560
s_mov_b32 s6, 4718592
s_mov_b64 vcc, s[80:81]
s_andn2_b32 s12, 63, s85
s_mov_b32 s59, 6
s_mov_b32 s56, 0
s_mov_b32 s64, 384
s_bitcmp1_b32 s2, 0
s_cselect_b32 s65, 288, -1
s_add_u32 s48, s46, 9437184
s_add_u32 s49, s48, 4718592
s_add_u32 s50, s49, 4718592
s_sub_u32 s58, s7, s45
s_bfe_u32 s47, s2, 0x20004
s_mul_i32 s57, s47, 294912
s_add_u32 s57, s57, 47185920
s_lshl_b32 s47, s47, 7
s_add_u32 s47, s47, 393216
s_add_u32 s32, s24, s47
s_addc_u32 s33, s25, 0
s_cmp_eq_u32 s40, 0
s_cselect_b32 s34, 4, 0
s_cselect_b64 s[62:63], 1, 0
s_waitcnt lgkmcnt(0)
v_mov_b32 v114, 163072
s_barrier
ds_read_b32 v114, v114
ds_read_b128 v[44:47], v0 offset:0
ds_read_b128 v[48:51], v1 offset:0
s_waitcnt vmcnt(18)
ds_read_b128 v[76:79], v2 offset:1024
ds_read_b128 v[80:83], v2 offset:1088
ds_read_b128 v[84:87], v2 offset:1152
ds_read_b128 v[88:91], v2 offset:1216
ds_read_b128 v[92:95], v2 offset:1280
ds_read_b128 v[96:99], v2 offset:1344
ds_read_b128 v[100:103], v2 offset:1408
ds_read_b128 v[104:107], v2 offset:1472
ds_read_b128 v[108:111], v2 offset:1536
buffer_load_dwordx4 a[132:135], v112, s[24:27], s99 offen offset:1024 sc1
ds_read_b128 v[8:11], v2 offset:1024
ds_read_b128 v[12:15], v2 offset:1088
ds_read_b128 v[16:19], v2 offset:1152
ds_read_b128 v[20:23], v2 offset:1216
ds_read_b128 v[24:27], v2 offset:1280
ds_read_b128 v[28:31], v2 offset:1344
ds_read_b128 v[32:35], v2 offset:1408
ds_read_b128 v[36:39], v2 offset:1472
ds_read_b128 v[40:43], v2 offset:1536
buffer_load_dwordx4 a[136:139], v112, s[24:27], s99 offen offset:2048 sc1
s_waitcnt lgkmcnt(15)
v_readfirstlane_b32 s47, v114
v_add_u32_sdwa v60, s42, v118 dst_sel:DWORD dst_unused:UNUSED_PAD src0_sel:DWORD src1_sel:WORD_0
s_cmp_lg_u32 s47, 0
s_cbranch_scc1 L_slow
v_smfmac_f32_16x16x64_bf16 v[76:79], a[0:3], v[44:51], v138
ds_read_b128 v[52:55], v0 offset:18560
ds_read_b128 v[56:59], v1 offset:18560
v_add_u32_sdwa v68, s42, v118 dst_sel:DWORD dst_unused:UNUSED_PAD src0_sel:DWORD src1_sel:WORD_0
v_smfmac_f32_16x16x64_bf16 v[80:83], a[4:7], v[44:51], v138 abid:1
ds_read_u16 v68, v68 offset:18560
v_add_u32_sdwa v69, s42, v118 dst_sel:DWORD dst_unused:UNUSED_PAD src0_sel:DWORD src1_sel:WORD_1
v_smfmac_f32_16x16x64_bf16 v[84:87], a[8:11], v[44:51], v139
s_waitcnt lgkmcnt(15)
buffer_load_dwordx4 a[140:143], v112, s[24:27], s99 offen offset:3072 sc1
ds_read_u16 v69, v69 offset:18560
v_add_u32_sdwa v70, s42, v119 dst_sel:DWORD dst_unused:UNUSED_PAD src0_sel:DWORD src1_sel:WORD_0
v_smfmac_f32_16x16x64_bf16 v[88:91], a[12:15], v[44:51], v139 abid:1
ds_read_u16 v70, v70 offset:18560
v_add_u32_sdwa v71, s42, v119 dst_sel:DWORD dst_unused:UNUSED_PAD src0_sel:DWORD src1_sel:WORD_1
v_smfmac_f32_16x16x64_bf16 v[92:95], a[16:19], v[44:51], v140
ds_read_u16 v71, v71 offset:18560
v_add_u32_sdwa v72, s42, v120 dst_sel:DWORD dst_unused:UNUSED_PAD src0_sel:DWORD src1_sel:WORD_0
v_smfmac_f32_16x16x64_bf16 v[96:99], a[20:23], v[44:51], v140 abid:1
s_waitcnt lgkmcnt(15)
s_mov_b32 s98, 4096
buffer_load_dwordx4 v[154:157], v113, s[24:27], s98 offen sc1
ds_read_u16 v72, v72 offset:18560
v_add_u32_sdwa v73, s42, v120 dst_sel:DWORD dst_unused:UNUSED_PAD src0_sel:DWORD src1_sel:WORD_1
v_smfmac_f32_16x16x64_bf16 v[100:103], a[24:27], v[44:51], v141
ds_read_u16 v73, v73 offset:18560
v_add_u32_sdwa v74, s42, v121 dst_sel:DWORD dst_unused:UNUSED_PAD src0_sel:DWORD src1_sel:WORD_0
v_smfmac_f32_16x16x64_bf16 v[104:107], a[28:31], v[44:51], v141 abid:1
ds_read_u16 v74, v74 offset:18560
v_add_u32_sdwa v75, s42, v121 dst_sel:DWORD dst_unused:UNUSED_PAD src0_sel:DWORD src1_sel:WORD_1
v_smfmac_f32_16x16x64_bf16 v[108:111], a[32:35], v[44:51], v174
s_waitcnt lgkmcnt(7)
s_mov_b32 s99, 36864
buffer_load_dwordx4 a[144:147], v112, s[24:27], s99 offen offset:0 sc1
ds_read_u16 v75, v75 offset:18560
v_smfmac_f32_16x16x64_bf16 v[8:11], a[0:3], v[52:59], v138
ds_read_b128 v[114:117], v2 offset:64
v_add_u32_sdwa v60, s42, v118 dst_sel:DWORD dst_unused:UNUSED_PAD src0_sel:DWORD src1_sel:WORD_0
v_smfmac_f32_16x16x64_bf16 v[12:15], a[4:7], v[52:59], v138 abid:1
ds_read_b128 v[44:47], v0 offset:2048
v_add_u32_sdwa v61, s42, v118 dst_sel:DWORD dst_unused:UNUSED_PAD src0_sel:DWORD src1_sel:WORD_1
v_smfmac_f32_16x16x64_bf16 v[16:19], a[8:11], v[52:59], v139
buffer_load_dwordx4 a[148:151], v112, s[24:27], s99 offen offset:1024 sc1
ds_read_b128 v[48:51], v1 offset:2048
v_add_u32_sdwa v62, s42, v119 dst_sel:DWORD dst_unused:UNUSED_PAD src0_sel:DWORD src1_sel:WORD_0
v_smfmac_f32_16x16x64_bf16 v[20:23], a[12:15], v[52:59], v139 abid:1
ds_read_u16 v60, v60 offset:0
v_add_u32_sdwa v63, s42, v119 dst_sel:DWORD dst_unused:UNUSED_PAD src0_sel:DWORD src1_sel:WORD_1
v_smfmac_f32_16x16x64_bf16 v[24:27], a[16:19], v[52:59], v140
ds_read_u16 v61, v61 offset:0
v_add_u32_sdwa v64, s42, v120 dst_sel:DWORD dst_unused:UNUSED_PAD src0_sel:DWORD src1_sel:WORD_0
v_smfmac_f32_16x16x64_bf16 v[28:31], a[20:23], v[52:59], v140 abid:1
buffer_load_dwordx4 a[152:155], v112, s[24:27], s99 offen offset:2048 sc1
ds_read_u16 v62, v62 offset:0
v_add_u32_sdwa v65, s42, v120 dst_sel:DWORD dst_unused:UNUSED_PAD src0_sel:DWORD src1_sel:WORD_1
v_smfmac_f32_16x16x64_bf16 v[32:35], a[24:27], v[52:59], v141
ds_read_u16 v63, v63 offset:0
v_add_u32_sdwa v66, s42, v121 dst_sel:DWORD dst_unused:UNUSED_PAD src0_sel:DWORD src1_sel:WORD_0
v_smfmac_f32_16x16x64_bf16 v[36:39], a[28:31], v[52:59], v141 abid:1
ds_read_u16 v64, v64 offset:0
v_add_u32_sdwa v67, s42, v121 dst_sel:DWORD dst_unused:UNUSED_PAD src0_sel:DWORD src1_sel:WORD_1
v_smfmac_f32_16x16x64_bf16 v[40:43], a[32:35], v[52:59], v174
s_waitcnt lgkmcnt(7)
buffer_load_dwordx4 a[156:159], v112, s[24:27], s99 offen offset:3072 sc1
ds_read_u16 v65, v65 offset:0
v_smfmac_f32_16x16x64_bf16 v[8:11], v[114:117], v[68:75], v179
ds_read_u16 v66, v66 offset:0
v_smfmac_f32_16x16x64_bf16 v[12:15], v[114:117], v[68:75], v179 abid:1
s_waitcnt lgkmcnt(7)
ds_read_u16 v67, v67 offset:0
v_smfmac_f32_16x16x64_bf16 v[76:79], a[36:39], v[44:51], v142
s_mov_b32 s99, 40960
buffer_load_dwordx4 a[160:163], v112, s[24:27], s99 offen offset:0 sc1
ds_read_b128 v[52:55], v0 offset:20608
v_add_u32_sdwa v68, s42, v122 dst_sel:DWORD dst_unused:UNUSED_PAD src0_sel:DWORD src1_sel:WORD_0
v_smfmac_f32_16x16x64_bf16 v[80:83], a[40:43], v[44:51], v142 abid:1
ds_read_b128 v[56:59], v1 offset:20608
v_add_u32_sdwa v69, s42, v122 dst_sel:DWORD dst_unused:UNUSED_PAD src0_sel:DWORD src1_sel:WORD_1
v_smfmac_f32_16x16x64_bf16 v[84:87], a[44:47], v[44:51], v143
ds_read_u16 v68, v68 offset:18560
v_add_u32_sdwa v70, s42, v123 dst_sel:DWORD dst_unused:UNUSED_PAD src0_sel:DWORD src1_sel:WORD_0
v_smfmac_f32_16x16x64_bf16 v[88:91], a[48:51], v[44:51], v143 abid:1
buffer_load_dwordx4 a[164:167], v112, s[24:27], s99 offen offset:1024 sc1
ds_read_u16 v69, v69 offset:18560
v_add_u32_sdwa v71, s42, v123 dst_sel:DWORD dst_unused:UNUSED_PAD src0_sel:DWORD src1_sel:WORD_1
v_smfmac_f32_16x16x64_bf16 v[92:95], a[52:55], v[44:51], v144
ds_read_u16 v70, v70 offset:18560
v_add_u32_sdwa v72, s42, v124 dst_sel:DWORD dst_unused:UNUSED_PAD src0_sel:DWORD src1_sel:WORD_0
v_smfmac_f32_16x16x64_bf16 v[96:99], a[56:59], v[44:51], v144 abid:1
ds_read_u16 v71, v71 offset:18560
v_add_u32_sdwa v73, s42, v124 dst_sel:DWORD dst_unused:UNUSED_PAD src0_sel:DWORD src1_sel:WORD_1
v_smfmac_f32_16x16x64_bf16 v[100:103], a[60:63], v[44:51], v145
buffer_load_dwordx4 a[168:171], v112, s[24:27], s99 offen offset:2048 sc1
ds_read_u16 v72, v72 offset:18560
v_add_u32_sdwa v74, s42, v125 dst_sel:DWORD dst_unused:UNUSED_PAD src0_sel:DWORD src1_sel:WORD_0
v_smfmac_f32_16x16x64_bf16 v[104:107], a[64:67], v[44:51], v145 abid:1
s_waitcnt vmcnt(18)
ds_read_u16 v73, v73 offset:18560
v_add_u32_sdwa v75, s42, v125 dst_sel:DWORD dst_unused:UNUSED_PAD src0_sel:DWORD src1_sel:WORD_1
v_smfmac_f32_16x16x64_bf16 v[108:111], a[68:71], v[44:51], v174 abid:1
s_waitcnt lgkmcnt(8)
ds_read_u16 v74, v74 offset:18560
v_smfmac_f32_16x16x64_bf16 v[76:79], v[114:117], v[60:67], v179
buffer_load_dwordx4 a[172:175], v112, s[24:27], s99 offen offset:3072 sc1
ds_read_u16 v75, v75 offset:18560
v_smfmac_f32_16x16x64_bf16 v[80:83], v[114:117], v[60:67], v179 abid:1
s_waitcnt lgkmcnt(8)
v_smfmac_f32_16x16x64_bf16 v[8:11], a[36:39], v[52:59], v142
ds_read_b128 v[114:117], v2 offset:128
v_add_u32_sdwa v60, s42, v122 dst_sel:DWORD dst_unused:UNUSED_PAD src0_sel:DWORD src1_sel:WORD_0
v_smfmac_f32_16x16x64_bf16 v[12:15], a[40:43], v[52:59], v142 abid:1
s_mov_b32 s99, 45056
buffer_load_dwordx4 a[176:179], v112, s[24:27], s99 offen offset:0 sc1
ds_read_b128 v[44:47], v0 offset:4096
v_add_u32_sdwa v61, s42, v122 dst_sel:DWORD dst_unused:UNUSED_PAD src0_sel:DWORD src1_sel:WORD_1
v_smfmac_f32_16x16x64_bf16 v[16:19], a[44:47], v[52:59], v143
ds_read_b128 v[48:51], v1 offset:4096
v_add_u32_sdwa v62, s42, v123 dst_sel:DWORD dst_unused:UNUSED_PAD src0_sel:DWORD src1_sel:WORD_0
v_smfmac_f32_16x16x64_bf16 v[20:23], a[48:51], v[52:59], v143 abid:1
ds_read_u16 v60, v60 offset:0
v_add_u32_sdwa v63, s42, v123 dst_sel:DWORD dst_unused:UNUSED_PAD src0_sel:DWORD src1_sel:WORD_1
v_smfmac_f32_16x16x64_bf16 v[24:27], a[52:55], v[52:59], v144
s_mov_b32 s98, 5120
buffer_load_dwordx4 v[158:161], v113, s[24:27], s98 offen sc1
ds_read_u16 v61, v61 offset:0
v_add_u32_sdwa v64, s42, v124 dst_sel:DWORD dst_unused:UNUSED_PAD src0_sel:DWORD src1_sel:WORD_0
v_smfmac_f32_16x16x64_bf16 v[28:31], a[56:59], v[52:59], v144 abid:1
ds_read_u16 v62, v62 offset:0
v_add_u32_sdwa v65, s42, v124 dst_sel:DWORD dst_unused:UNUSED_PAD src0_sel:DWORD src1_sel:WORD_1
v_smfmac_f32_16x16x64_bf16 v[32:35], a[60:63], v[52:59], v145
ds_read_u16 v63, v63 offset:0
v_add_u32_sdwa v66, s42, v125 dst_sel:DWORD dst_unused:UNUSED_PAD src0_sel:DWORD src1_sel:WORD_0
v_smfmac_f32_16x16x64_bf16 v[36:39], a[64:67], v[52:59], v145 abid:1
buffer_load_dwordx4 a[180:183], v112, s[24:27], s99 offen offset:1024 sc1
ds_read_u16 v64, v64 offset:0
v_add_u32_sdwa v67, s42, v125 dst_sel:DWORD dst_unused:UNUSED_PAD src0_sel:DWORD src1_sel:WORD_1
v_smfmac_f32_16x16x64_bf16 v[40:43], a[68:71], v[52:59], v174 abid:1
s_waitcnt lgkmcnt(7)
ds_read_u16 v65, v65 offset:0
v_smfmac_f32_16x16x64_bf16 v[12:15], v[114:117], v[68:75], v180
ds_read_u16 v66, v66 offset:0
v_smfmac_f32_16x16x64_bf16 v[16:19], v[114:117], v[68:75], v180 abid:1
buffer_load_dwordx4 a[184:187], v112, s[24:27], s99 offen offset:2048 sc1
ds_read_u16 v67, v67 offset:0
v_smfmac_f32_16x16x64_bf16 v[20:23], v[114:117], v[68:75], v181
s_waitcnt lgkmcnt(8)
v_smfmac_f32_16x16x64_bf16 v[76:79], a[72:75], v[44:51], v146
ds_read_b128 v[52:55], v0 offset:22656
v_add_u32_sdwa v68, s42, v126 dst_sel:DWORD dst_unused:UNUSED_PAD src0_sel:DWORD src1_sel:WORD_0
v_smfmac_f32_16x16x64_bf16 v[80:83], a[76:79], v[44:51], v146 abid:1
buffer_load_dwordx4 a[188:191], v112, s[24:27], s99 offen offset:3072 sc1
ds_read_b128 v[56:59], v1 offset:22656
v_add_u32_sdwa v69, s42, v126 dst_sel:DWORD dst_unused:UNUSED_PAD src0_sel:DWORD src1_sel:WORD_1
v_smfmac_f32_16x16x64_bf16 v[84:87], a[80:83], v[44:51], v147
ds_read_u16 v68, v68 offset:18560
v_add_u32_sdwa v70, s42, v127 dst_sel:DWORD dst_unused:UNUSED_PAD src0_sel:DWORD src1_sel:WORD_0
v_smfmac_f32_16x16x64_bf16 v[88:91], a[84:87], v[44:51], v147 abid:1
ds_read_u16 v69, v69 offset:18560
v_add_u32_sdwa v71, s42, v127 dst_sel:DWORD dst_unused:UNUSED_PAD src0_sel:DWORD src1_sel:WORD_1
v_smfmac_f32_16x16x64_bf16 v[92:95], a[88:91], v[44:51], v148
s_mov_b32 s99, 49152
buffer_load_dwordx4 a[192:195], v112, s[24:27], s99 offen offset:0 sc1
ds_read_u16 v70, v70 offset:18560
v_add_u32_sdwa v72, s42, v128 dst_sel:DWORD dst_unused:UNUSED_PAD src0_sel:DWORD src1_sel:WORD_0
v_smfmac_f32_16x16x64_bf16 v[96:99], a[92:95], v[44:51], v148 abid:1
ds_read_u16 v71, v71 offset:18560
v_add_u32_sdwa v73, s42, v128 dst_sel:DWORD dst_unused:UNUSED_PAD src0_sel:DWORD src1_sel:WORD_1
v_smfmac_f32_16x16x64_bf16 v[100:103], a[96:99], v[44:51], v149
ds_read_u16 v72, v72 offset:18560
v_add_u32_sdwa v74, s42, v129 dst_sel:DWORD dst_unused:UNUSED_PAD src0_sel:DWORD src1_sel:WORD_0
v_smfmac_f32_16x16x64_bf16 v[104:107], a[100:103], v[44:51], v149 abid:1
buffer_load_dwordx4 a[196:199], v112, s[24:27], s99 offen offset:1024 sc1
ds_read_u16 v73, v73 offset:18560
v_add_u32_sdwa v75, s42, v129 dst_sel:DWORD dst_unused:UNUSED_PAD src0_sel:DWORD src1_sel:WORD_1
v_smfmac_f32_16x16x64_bf16 v[108:111], a[104:107], v[44:51], v175
s_waitcnt lgkmcnt(8)
ds_read_u16 v74, v74 offset:18560
v_smfmac_f32_16x16x64_bf16 v[80:83], v[114:117], v[60:67], v180
ds_read_u16 v75, v75 offset:18560
v_smfmac_f32_16x16x64_bf16 v[84:87], v[114:117], v[60:67], v180 abid:1
buffer_load_dwordx4 a[200:203], v112, s[24:27], s99 offen offset:2048 sc1
v_smfmac_f32_16x16x64_bf16 v[88:91], v[114:117], v[60:67], v181
s_waitcnt lgkmcnt(8)
v_smfmac_f32_16x16x64_bf16 v[8:11], a[72:75], v[52:59], v146
ds_read_b128 v[114:117], v2 offset:192
v_add_u32_sdwa v60, s42, v126 dst_sel:DWORD dst_unused:UNUSED_PAD src0_sel:DWORD src1_sel:WORD_0
v_smfmac_f32_16x16x64_bf16 v[12:15], a[76:79], v[52:59], v146 abid:1
buffer_load_dwordx4 a[204:207], v112, s[24:27], s99 offen offset:3072 sc1
ds_read_b128 v[44:47], v0 offset:6144
v_add_u32_sdwa v61, s42, v126 dst_sel:DWORD dst_unused:UNUSED_PAD src0_sel:DWORD src1_sel:WORD_1
v_smfmac_f32_16x16x64_bf16 v[16:19], a[80:83], v[52:59], v147
ds_read_b128 v[48:51], v1 offset:6144
v_add_u32_sdwa v62, s42, v127 dst_sel:DWORD dst_unused:UNUSED_PAD src0_sel:DWORD src1_sel:WORD_0
v_smfmac_f32_16x16x64_bf16 v[20:23], a[84:87], v[52:59], v147 abid:1
ds_read_u16 v60, v60 offset:0
v_add_u32_sdwa v63, s42, v127 dst_sel:DWORD dst_unused:UNUSED_PAD src0_sel:DWORD src1_sel:WORD_1
v_smfmac_f32_16x16x64_bf16 v[24:27], a[88:91], v[52:59], v148
s_mov_b32 s99, 53248
buffer_load_dwordx4 a[208:211], v112, s[24:27], s99 offen offset:0 sc1
ds_read_u16 v61, v61 offset:0
v_add_u32_sdwa v64, s42, v128 dst_sel:DWORD dst_unused:UNUSED_PAD src0_sel:DWORD src1_sel:WORD_0
v_smfmac_f32_16x16x64_bf16 v[28:31], a[92:95], v[52:59], v148 abid:1
ds_read_u16 v62, v62 offset:0
v_add_u32_sdwa v65, s42, v128 dst_sel:DWORD dst_unused:UNUSED_PAD src0_sel:DWORD src1_sel:WORD_1
v_smfmac_f32_16x16x64_bf16 v[32:35], a[96:99], v[52:59], v149
ds_read_u16 v63, v63 offset:0
v_add_u32_sdwa v66, s42, v129 dst_sel:DWORD dst_unused:UNUSED_PAD src0_sel:DWORD src1_sel:WORD_0
v_smfmac_f32_16x16x64_bf16 v[36:39], a[100:103], v[52:59], v149 abid:1
buffer_load_dwordx4 a[212:215], v112, s[24:27], s99 offen offset:1024 sc1
ds_read_u16 v64, v64 offset:0
v_add_u32_sdwa v67, s42, v129 dst_sel:DWORD dst_unused:UNUSED_PAD src0_sel:DWORD src1_sel:WORD_1
v_smfmac_f32_16x16x64_bf16 v[40:43], a[104:107], v[52:59], v175
s_waitcnt lgkmcnt(7)
ds_read_u16 v65, v65 offset:0
v_smfmac_f32_16x16x64_bf16 v[20:23], v[114:117], v[68:75], v181 abid:1
ds_read_u16 v66, v66 offset:0
v_smfmac_f32_16x16x64_bf16 v[24:27], v[114:117], v[68:75], v182
s_mov_b32 s98, 6144
buffer_load_dwordx4 v[162:165], v113, s[24:27], s98 offen sc1
ds_read_u16 v67, v67 offset:0
v_smfmac_f32_16x16x64_bf16 v[28:31], v[114:117], v[68:75], v182 abid:1
s_waitcnt vmcnt(18) lgkmcnt(8)
v_smfmac_f32_16x16x64_bf16 v[76:79], a[108:111], v[44:51], v150
ds_read_b128 v[52:55], v0 offset:24704
v_add_u32_sdwa v68, s42, v130 dst_sel:DWORD dst_unused:UNUSED_PAD src0_sel:DWORD src1_sel:WORD_0
v_smfmac_f32_16x16x64_bf16 v[80:83], a[112:115], v[44:51], v150 abid:1
buffer_load_dwordx4 a[216:219], v112, s[24:27], s99 offen offset:2048 sc1
ds_read_b128 v[56:59], v1 offset:24704
v_add_u32_sdwa v69, s42, v130 dst_sel:DWORD dst_unused:UNUSED_PAD src0_sel:DWORD src1_sel:WORD_1
v_smfmac_f32_16x16x64_bf16 v[84:87], a[116:119], v[44:51], v151
ds_read_u16 v68, v68 offset:18560
v_add_u32_sdwa v70, s42, v131 dst_sel:DWORD dst_unused:UNUSED_PAD src0_sel:DWORD src1_sel:WORD_0
v_smfmac_f32_16x16x64_bf16 v[88:91], a[120:123], v[44:51], v151 abid:1
ds_read_u16 v69, v69 offset:18560
v_add_u32_sdwa v71, s42, v131 dst_sel:DWORD dst_unused:UNUSED_PAD src0_sel:DWORD src1_sel:WORD_1
v_smfmac_f32_16x16x64_bf16 v[92:95], a[124:127], v[44:51], v152
buffer_load_dwordx4 a[220:223], v112, s[24:27], s99 offen offset:3072 sc1
ds_read_u16 v70, v70 offset:18560
v_add_u32_sdwa v72, s42, v132 dst_sel:DWORD dst_unused:UNUSED_PAD src0_sel:DWORD src1_sel:WORD_0
v_smfmac_f32_16x16x64_bf16 v[96:99], a[128:131], v[44:51], v152 abid:1
ds_read_u16 v71, v71 offset:18560
v_add_u32_sdwa v73, s42, v132 dst_sel:DWORD dst_unused:UNUSED_PAD src0_sel:DWORD src1_sel:WORD_1
v_smfmac_f32_16x16x64_bf16 v[100:103], a[132:135], v[44:51], v153
ds_read_u16 v72, v72 offset:18560
v_add_u32_sdwa v74, s42, v133 dst_sel:DWORD dst_unused:UNUSED_PAD src0_sel:DWORD src1_sel:WORD_0
v_smfmac_f32_16x16x64_bf16 v[104:107], a[136:139], v[44:51], v153 abid:1
s_mov_b32 s99, 57344
buffer_load_dwordx4 a[224:227], v112, s[24:27], s99 offen offset:0 sc1
ds_read_u16 v73, v73 offset:18560
v_add_u32_sdwa v75, s42, v133 dst_sel:DWORD dst_unused:UNUSED_PAD src0_sel:DWORD src1_sel:WORD_1
v_smfmac_f32_16x16x64_bf16 v[108:111], a[140:143], v[44:51], v175 abid:1
s_waitcnt lgkmcnt(8)
ds_read_u16 v74, v74 offset:18560
v_smfmac_f32_16x16x64_bf16 v[88:91], v[114:117], v[60:67], v181 abid:1
buffer_load_dwordx4 a[228:231], v112, s[24:27], s99 offen offset:1024 sc1
ds_read_u16 v75, v75 offset:18560
v_smfmac_f32_16x16x64_bf16 v[92:95], v[114:117], v[60:67], v182
v_smfmac_f32_16x16x64_bf16 v[96:99], v[114:117], v[60:67], v182 abid:1
s_waitcnt lgkmcnt(8)
v_smfmac_f32_16x16x64_bf16 v[8:11], a[108:111], v[52:59], v150
buffer_load_dwordx4 a[232:235], v112, s[24:27], s99 offen offset:2048 sc1
ds_read_b128 v[114:117], v2 offset:256
v_add_u32_sdwa v60, s42, v130 dst_sel:DWORD dst_unused:UNUSED_PAD src0_sel:DWORD src1_sel:WORD_0
v_smfmac_f32_16x16x64_bf16 v[12:15], a[112:115], v[52:59], v150 abid:1
ds_read_b128 v[44:47], v0 offset:8192
v_add_u32_sdwa v61, s42, v130 dst_sel:DWORD dst_unused:UNUSED_PAD src0_sel:DWORD src1_sel:WORD_1
v_smfmac_f32_16x16x64_bf16 v[16:19], a[116:119], v[52:59], v151
ds_read_b128 v[48:51], v1 offset:8192
v_add_u32_sdwa v62, s42, v131 dst_sel:DWORD dst_unused:UNUSED_PAD src0_sel:DWORD src1_sel:WORD_0
v_smfmac_f32_16x16x64_bf16 v[20:23], a[120:123], v[52:59], v151 abid:1
buffer_load_dwordx4 a[236:239], v112, s[24:27], s99 offen offset:3072 sc1
ds_read_u16 v60, v60 offset:0
v_add_u32_sdwa v63, s42, v131 dst_sel:DWORD dst_unused:UNUSED_PAD src0_sel:DWORD src1_sel:WORD_1
v_smfmac_f32_16x16x64_bf16 v[24:27], a[124:127], v[52:59], v152
ds_read_u16 v61, v61 offset:0
v_add_u32_sdwa v64, s42, v132 dst_sel:DWORD dst_unused:UNUSED_PAD src0_sel:DWORD src1_sel:WORD_0
v_smfmac_f32_16x16x64_bf16 v[28:31], a[128:131], v[52:59], v152 abid:1
ds_read_u16 v62, v62 offset:0
v_add_u32_sdwa v65, s42, v132 dst_sel:DWORD dst_unused:UNUSED_PAD src0_sel:DWORD src1_sel:WORD_1
v_smfmac_f32_16x16x64_bf16 v[32:35], a[132:135], v[52:59], v153
s_mov_b32 s99, 61440
buffer_load_dwordx4 a[240:243], v112, s[24:27], s99 offen offset:0 sc1
ds_read_u16 v63, v63 offset:0
v_add_u32_sdwa v66, s42, v133 dst_sel:DWORD dst_unused:UNUSED_PAD src0_sel:DWORD src1_sel:WORD_0
v_smfmac_f32_16x16x64_bf16 v[36:39], a[136:139], v[52:59], v153 abid:1
ds_read_u16 v64, v64 offset:0
v_add_u32_sdwa v67, s42, v133 dst_sel:DWORD dst_unused:UNUSED_PAD src0_sel:DWORD src1_sel:WORD_1
v_smfmac_f32_16x16x64_bf16 v[40:43], a[140:143], v[52:59], v175 abid:1
s_waitcnt lgkmcnt(7)
ds_read_u16 v65, v65 offset:0
v_smfmac_f32_16x16x64_bf16 v[28:31], v[114:117], v[68:75], v183
buffer_load_dwordx4 a[244:247], v112, s[24:27], s99 offen offset:1024 sc1
ds_read_u16 v66, v66 offset:0
v_smfmac_f32_16x16x64_bf16 v[32:35], v[114:117], v[68:75], v183 abid:1
ds_read_u16 v67, v67 offset:0
v_smfmac_f32_16x16x64_bf16 v[36:39], v[114:117], v[68:75], v184
s_waitcnt lgkmcnt(8)
v_smfmac_f32_16x16x64_bf16 v[76:79], a[144:147], v[44:51], v154
buffer_load_dwordx4 a[248:251], v112, s[24:27], s99 offen offset:2048 sc1
ds_read_b128 v[52:55], v0 offset:26752
v_add_u32_sdwa v68, s42, v134 dst_sel:DWORD dst_unused:UNUSED_PAD src0_sel:DWORD src1_sel:WORD_0
v_smfmac_f32_16x16x64_bf16 v[80:83], a[148:151], v[44:51], v154 abid:1
s_waitcnt vmcnt(18)
ds_read_b128 v[56:59], v1 offset:26752
v_add_u32_sdwa v69, s42, v134 dst_sel:DWORD dst_unused:UNUSED_PAD src0_sel:DWORD src1_sel:WORD_1
v_smfmac_f32_16x16x64_bf16 v[84:87], a[152:155], v[44:51], v155
ds_read_u16 v68, v68 offset:18560
v_add_u32_sdwa v70, s42, v135 dst_sel:DWORD dst_unused:UNUSED_PAD src0_sel:DWORD src1_sel:WORD_0
v_smfmac_f32_16x16x64_bf16 v[88:91], a[156:159], v[44:51], v155 abid:1
s_mov_b32 s98, 7168
buffer_load_dwordx4 v[166:169], v113, s[24:27], s98 offen sc1
ds_read_u16 v69, v69 offset:18560
v_add_u32_sdwa v71, s42, v135 dst_sel:DWORD dst_unused:UNUSED_PAD src0_sel:DWORD src1_sel:WORD_1
v_smfmac_f32_16x16x64_bf16 v[92:95], a[160:163], v[44:51], v156
ds_read_u16 v70, v70 offset:18560
v_add_u32_sdwa v72, s42, v136 dst_sel:DWORD dst_unused:UNUSED_PAD src0_sel:DWORD src1_sel:WORD_0
v_smfmac_f32_16x16x64_bf16 v[96:99], a[164:167], v[44:51], v156 abid:1
ds_read_u16 v71, v71 offset:18560
v_add_u32_sdwa v73, s42, v136 dst_sel:DWORD dst_unused:UNUSED_PAD src0_sel:DWORD src1_sel:WORD_1
v_smfmac_f32_16x16x64_bf16 v[100:103], a[168:171], v[44:51], v157
s_mov_b32 s98, 8192
buffer_load_dwordx4 v[170:173], v113, s[24:27], s98 offen sc1
ds_read_u16 v72, v72 offset:18560
v_add_u32_sdwa v74, s42, v137 dst_sel:DWORD dst_unused:UNUSED_PAD src0_sel:DWORD src1_sel:WORD_0
v_smfmac_f32_16x16x64_bf16 v[104:107], a[172:175], v[44:51], v157 abid:1
ds_read_u16 v73, v73 offset:18560
v_add_u32_sdwa v75, s42, v137 dst_sel:DWORD dst_unused:UNUSED_PAD src0_sel:DWORD src1_sel:WORD_1
v_smfmac_f32_16x16x64_bf16 v[108:111], a[176:179], v[44:51], v176
s_waitcnt lgkmcnt(8)
ds_read_u16 v74, v74 offset:18560
v_smfmac_f32_16x16x64_bf16 v[96:99], v[114:117], v[60:67], v183
s_mov_b32 s99, 69632
buffer_load_dwordx4 v[214:217], v112, s[24:27], s99 offen offset:3072 sc1
ds_read_u16 v75, v75 offset:18560
v_smfmac_f32_16x16x64_bf16 v[100:103], v[114:117], v[60:67], v183 abid:1
v_smfmac_f32_16x16x64_bf16 v[104:107], v[114:117], v[60:67], v184
s_waitcnt lgkmcnt(8)
v_smfmac_f32_16x16x64_bf16 v[8:11], a[144:147], v[52:59], v154
s_mov_b32 s99, 81920
buffer_load_dwordx4 v[250:253], v112, s[24:27], s99 offen offset:0 sc1
ds_read_b128 v[114:117], v2 offset:320
v_add_u32_sdwa v60, s42, v134 dst_sel:DWORD dst_unused:UNUSED_PAD src0_sel:DWORD src1_sel:WORD_0
v_smfmac_f32_16x16x64_bf16 v[12:15], a[148:151], v[52:59], v154 abid:1
ds_read_b128 v[44:47], v0 offset:10240
v_add_u32_sdwa v61, s42, v134 dst_sel:DWORD dst_unused:UNUSED_PAD src0_sel:DWORD src1_sel:WORD_1
v_smfmac_f32_16x16x64_bf16 v[16:19], a[152:155], v[52:59], v155
ds_read_b128 v[48:51], v1 offset:10240
v_add_u32_sdwa v62, s42, v135 dst_sel:DWORD dst_unused:UNUSED_PAD src0_sel:DWORD src1_sel:WORD_0
v_smfmac_f32_16x16x64_bf16 v[20:23], a[156:159], v[52:59], v155 abid:1
s_mov_b32 s99, 61440
buffer_load_dwordx4 a[252:255], v112, s[24:27], s99 offen offset:3072 sc1
ds_read_u16 v60, v60 offset:0
v_add_u32_sdwa v63, s42, v135 dst_sel:DWORD dst_unused:UNUSED_PAD src0_sel:DWORD src1_sel:WORD_1
v_smfmac_f32_16x16x64_bf16 v[24:27], a[160:163], v[52:59], v156
ds_read_u16 v61, v61 offset:0
v_add_u32_sdwa v64, s42, v136 dst_sel:DWORD dst_unused:UNUSED_PAD src0_sel:DWORD src1_sel:WORD_0
v_smfmac_f32_16x16x64_bf16 v[28:31], a[164:167], v[52:59], v156 abid:1
ds_read_u16 v62, v62 offset:0
v_add_u32_sdwa v65, s42, v136 dst_sel:DWORD dst_unused:UNUSED_PAD src0_sel:DWORD src1_sel:WORD_1
v_smfmac_f32_16x16x64_bf16 v[32:35], a[168:171], v[52:59], v157
s_mov_b32 s99, 73728
buffer_load_dwordx4 v[218:221], v112, s[24:27], s99 offen offset:0 sc1
ds_read_u16 v63, v63 offset:0
v_add_u32_sdwa v66, s42, v137 dst_sel:DWORD dst_unused:UNUSED_PAD src0_sel:DWORD src1_sel:WORD_0
v_smfmac_f32_16x16x64_bf16 v[36:39], a[172:175], v[52:59], v157 abid:1
ds_read_u16 v64, v64 offset:0
v_add_u32_sdwa v67, s42, v137 dst_sel:DWORD dst_unused:UNUSED_PAD src0_sel:DWORD src1_sel:WORD_1
v_smfmac_f32_16x16x64_bf16 v[40:43], a[176:179], v[52:59], v176
s_waitcnt lgkmcnt(7)
ds_read_u16 v65, v65 offset:0
v_smfmac_f32_16x16x64_bf16 v[36:39], v[114:117], v[68:75], v184 abid:1
s_mov_b32 s99, 65536
buffer_load_dwordx4 v[186:189], v112, s[24:27], s99 offen offset:0 sc1
ds_read_u16 v66, v66 offset:0
v_smfmac_f32_16x16x64_bf16 v[40:43], v[114:117], v[68:75], v185
s_waitcnt lgkmcnt(7)
ds_read_u16 v67, v67 offset:0
v_smfmac_f32_16x16x64_bf16 v[76:79], a[180:183], v[44:51], v158
s_waitcnt vmcnt(18)
ds_read_b128 v[52:55], v0 offset:28800
v_smfmac_f32_16x16x64_bf16 v[80:83], a[184:187], v[44:51], v158 abid:1
s_mov_b32 s99, 73728
buffer_load_dwordx4 v[222:225], v112, s[24:27], s99 offen offset:1024 sc1
ds_read_b128 v[56:59], v1 offset:28800
v_smfmac_f32_16x16x64_bf16 v[84:87], a[188:191], v[44:51], v159
ds_read_b128 v[68:71], v0 offset:34944
v_smfmac_f32_16x16x64_bf16 v[88:91], a[192:195], v[44:51], v159 abid:1
ds_read_b128 v[72:75], v1 offset:34944
v_smfmac_f32_16x16x64_bf16 v[92:95], a[196:199], v[44:51], v160
s_mov_b32 s99, 65536
buffer_load_dwordx4 v[190:193], v112, s[24:27], s99 offen offset:1024 sc1
v_smfmac_f32_16x16x64_bf16 v[96:99], a[200:203], v[44:51], v160 abid:1
v_smfmac_f32_16x16x64_bf16 v[100:103], a[204:207], v[44:51], v161
v_smfmac_f32_16x16x64_bf16 v[104:107], a[208:211], v[44:51], v161 abid:1
s_waitcnt vmcnt(18)
s_mov_b32 s99, 73728
buffer_load_dwordx4 v[226:229], v112, s[24:27], s99 offen offset:2048 sc1
v_smfmac_f32_16x16x64_bf16 v[108:111], a[212:215], v[44:51], v176 abid:1
s_waitcnt lgkmcnt(4)
v_smfmac_f32_16x16x64_bf16 v[104:107], v[114:117], v[60:67], v184 abid:1
v_smfmac_f32_16x16x64_bf16 v[108:111], v[114:117], v[60:67], v185
s_waitcnt lgkmcnt(2)
s_mov_b32 s99, 65536
buffer_load_dwordx4 v[194:197], v112, s[24:27], s99 offen offset:2048 sc1
v_smfmac_f32_16x16x64_bf16 v[8:11], a[180:183], v[52:59], v158
ds_read_b128 v[44:47], v0 offset:12288
v_smfmac_f32_16x16x64_bf16 v[12:15], a[184:187], v[52:59], v158 abid:1
ds_read_b128 v[48:51], v1 offset:12288
v_smfmac_f32_16x16x64_bf16 v[16:19], a[188:191], v[52:59], v159
s_mov_b32 s99, 73728
buffer_load_dwordx4 v[230:233], v112, s[24:27], s99 offen offset:3072 sc1
ds_read_b128 v[60:63], v0 offset:32896
v_smfmac_f32_16x16x64_bf16 v[20:23], a[192:195], v[52:59], v159 abid:1
ds_read_b128 v[64:67], v1 offset:32896
v_smfmac_f32_16x16x64_bf16 v[24:27], a[196:199], v[52:59], v160
v_smfmac_f32_16x16x64_bf16 v[28:31], a[200:203], v[52:59], v160 abid:1
s_mov_b32 s99, 65536
buffer_load_dwordx4 v[198:201], v112, s[24:27], s99 offen offset:3072 sc1
v_smfmac_f32_16x16x64_bf16 v[32:35], a[204:207], v[52:59], v161
v_smfmac_f32_16x16x64_bf16 v[36:39], a[208:211], v[52:59], v161 abid:1
v_smfmac_f32_16x16x64_bf16 v[40:43], a[212:215], v[52:59], v176 abid:1
s_waitcnt vmcnt(18) lgkmcnt(2)
s_mov_b32 s99, 77824
buffer_load_dwordx4 v[234:237], v112, s[24:27], s99 offen offset:0 sc1
v_smfmac_f32_16x16x64_bf16 v[76:79], a[216:219], v[44:51], v162
ds_read_b128 v[52:55], v0 offset:30848
v_smfmac_f32_16x16x64_bf16 v[80:83], a[220:223], v[44:51], v162 abid:1
ds_read_b128 v[56:59], v1 offset:30848
v_smfmac_f32_16x16x64_bf16 v[84:87], a[224:227], v[44:51], v163
s_mov_b32 s99, 69632
buffer_load_dwordx4 v[202:205], v112, s[24:27], s99 offen offset:0 sc1
v_smfmac_f32_16x16x64_bf16 v[88:91], a[228:231], v[44:51], v163 abid:1
s_waitcnt vmcnt(18)
v_smfmac_f32_16x16x64_bf16 v[92:95], a[232:235], v[44:51], v164
v_smfmac_f32_16x16x64_bf16 v[96:99], a[236:239], v[44:51], v164 abid:1
s_waitcnt vmcnt(17)
s_mov_b32 s99, 77824
buffer_load_dwordx4 v[238:241], v112, s[24:27], s99 offen offset:1024 sc1
v_smfmac_f32_16x16x64_bf16 v[100:103], a[240:243], v[44:51], v165
s_waitcnt vmcnt(17)
v_smfmac_f32_16x16x64_bf16 v[104:107], a[244:247], v[44:51], v165 abid:1
s_waitcnt vmcnt(16)
v_smfmac_f32_16x16x64_bf16 v[108:111], a[248:251], v[44:51], v177
s_waitcnt lgkmcnt(0)
s_mov_b32 s99, 69632
buffer_load_dwordx4 v[206:209], v112, s[24:27], s99 offen offset:1024 sc1
v_smfmac_f32_16x16x64_bf16 v[8:11], a[216:219], v[52:59], v162
ds_read_b128 v[44:47], v0 offset:14336
v_smfmac_f32_16x16x64_bf16 v[12:15], a[220:223], v[52:59], v162 abid:1
ds_read_b128 v[48:51], v1 offset:14336
v_smfmac_f32_16x16x64_bf16 v[16:19], a[224:227], v[52:59], v163
s_mov_b32 s99, 77824
buffer_load_dwordx4 v[242:245], v112, s[24:27], s99 offen offset:2048 sc1
v_smfmac_f32_16x16x64_bf16 v[20:23], a[228:231], v[52:59], v163 abid:1
v_smfmac_f32_16x16x64_bf16 v[24:27], a[232:235], v[52:59], v164
v_smfmac_f32_16x16x64_bf16 v[28:31], a[236:239], v[52:59], v164 abid:1
s_mov_b32 s99, 69632
buffer_load_dwordx4 v[210:213], v112, s[24:27], s99 offen offset:2048 sc1
v_smfmac_f32_16x16x64_bf16 v[32:35], a[240:243], v[52:59], v165
v_smfmac_f32_16x16x64_bf16 v[36:39], a[244:247], v[52:59], v165 abid:1
v_smfmac_f32_16x16x64_bf16 v[40:43], a[248:251], v[52:59], v177
s_mov_b32 s99, 77824
buffer_load_dwordx4 v[246:249], v112, s[24:27], s99 offen offset:3072 sc1
s_bfe_u32 s47, s85, 0x40018
s_cbranch_scc0 L_ptail0
ds_read_b128 v[52:55], v0 offset:16384
ds_read_b128 v[56:59], v1 offset:16384
s_waitcnt vmcnt(17) lgkmcnt(2)
v_smfmac_f32_16x16x64_bf16 v[108:111], v[214:217], v[44:51], v177 abid:1
s_add_u32 m0, s44, 0
s_nop 0
buffer_load_dwordx4 v3, s[16:19], s45 offen offset:0 nt lds
s_waitcnt vmcnt(17) lgkmcnt(0)
v_smfmac_f32_16x16x64_bf16 v[108:111], v[250:253], v[52:59], v178
s_add_u32 m0, s44, 3840
s_nop 0
buffer_load_dwordx4 v3, s[16:19], s45 offen offset:256 nt lds
v_add_u32 v0, 37120, v0
v_add_u32 v1, 37120, v1
s_waitcnt vmcnt(17)
v_smfmac_f32_16x16x64_bf16 v[76:79], a[252:255], v[44:51], v166
s_add_u32 m0, s44, 7680
s_nop 0
buffer_load_dwordx4 v3, s[16:19], s45 offen offset:512 nt lds
s_waitcnt vmcnt(17)
v_smfmac_f32_16x16x64_bf16 v[76:79], v[218:221], v[52:59], v170
v_cvt_pk_bf16_f32 v108, v108, v109
v_cvt_pk_bf16_f32 v109, v110, v111
ds_write_b64 v254, v[108:109]
s_waitcnt vmcnt(16)
v_smfmac_f32_16x16x64_bf16 v[80:83], v[186:189], v[44:51], v166 abid:1
s_add_u32 m0, s44, 11520
s_nop 0
buffer_load_dwordx4 v3, s[16:19], s45 offen offset:768 nt lds
s_waitcnt vmcnt(16)
v_smfmac_f32_16x16x64_bf16 v[80:83], v[222:225], v[52:59], v170 abid:1
s_add_u32 m0, s44, s8
s_mov_b64 exec, s[10:11]
buffer_load_dwordx4 v3, s[16:19], s7 offen offset:896 nt lds
s_mov_b64 exec, -1
s_add_u32 s7, s7, 4718592
s_add_u32 s44, s44, 18560
s_add_u32 s45, s45, 4718592
v_cvt_pk_bf16_f32 v76, v76, v77
v_cvt_pk_bf16_f32 v77, v78, v79
s_waitcnt vmcnt(16)
v_smfmac_f32_16x16x64_bf16 v[84:87], v[190:193], v[44:51], v167
s_waitcnt vmcnt(15)
v_smfmac_f32_16x16x64_bf16 v[84:87], v[226:229], v[52:59], v171
s_add_u32 m0, s44, 0
s_nop 0
buffer_load_dwordx4 v3, s[16:19], s45 offen offset:0 nt lds
v_cvt_pk_bf16_f32 v78, v80, v81
v_cvt_pk_bf16_f32 v79, v82, v83
v_xor_b32 v254, 512, v254
s_waitcnt vmcnt(15)
v_smfmac_f32_16x16x64_bf16 v[88:91], v[194:197], v[44:51], v167 abid:1
s_add_u32 m0, s44, 3840
s_nop 0
buffer_load_dwordx4 v3, s[16:19], s45 offen offset:256 nt lds
s_waitcnt vmcnt(15)
v_smfmac_f32_16x16x64_bf16 v[88:91], v[230:233], v[52:59], v171 abid:1
s_add_u32 m0, s44, 7680
s_nop 0
buffer_load_dwordx4 v3, s[16:19], s45 offen offset:512 nt lds
v_cvt_pk_bf16_f32 v80, v84, v85
v_cvt_pk_bf16_f32 v81, v86, v87
s_waitcnt vmcnt(15)
v_smfmac_f32_16x16x64_bf16 v[92:95], v[198:201], v[44:51], v168
s_waitcnt vmcnt(14)
v_smfmac_f32_16x16x64_bf16 v[92:95], v[234:237], v[52:59], v172
s_add_u32 m0, s44, 11520
s_nop 0
buffer_load_dwordx4 v3, s[16:19], s45 offen offset:768 nt lds
v_cvt_pk_bf16_f32 v82, v88, v89
v_cvt_pk_bf16_f32 v83, v90, v91
v_cndmask_b32_dpp v114, v80, v76, vcc quad_perm:[1,0,3,2] row_mask:0xf bank_mask:0xf
v_cndmask_b32_dpp v115, v81, v77, vcc quad_perm:[1,0,3,2] row_mask:0xf bank_mask:0xf
v_cndmask_b32_dpp v116, v82, v78, vcc quad_perm:[1,0,3,2] row_mask:0xf bank_mask:0xf
v_cndmask_b32_dpp v117, v83, v79, vcc quad_perm:[1,0,3,2] row_mask:0xf bank_mask:0xf
buffer_store_dwordx4 v[114:117], v4, s[20:23], s46 offen offset:0 sc1
s_mov_b64 vcc, s[82:83]
s_waitcnt vmcnt(15)
v_smfmac_f32_16x16x64_bf16 v[96:99], v[202:205], v[44:51], v168 abid:1
s_add_u32 m0, s44, s8
s_mov_b64 exec, s[10:11]
buffer_load_dwordx4 v3, s[16:19], s7 offen offset:896 nt lds
s_mov_b64 exec, -1
s_add_u32 s7, s7, 4718592
s_add_u32 s44, s44, 18560
s_add_u32 s45, s45, 4718592
s_waitcnt vmcnt(15)
v_smfmac_f32_16x16x64_bf16 v[96:99], v[238:241], v[52:59], v172 abid:1
v_cvt_pk_bf16_f32 v84, v92, v93
v_cvt_pk_bf16_f32 v85, v94, v95
v_cndmask_b32_dpp v80, v76, v80, vcc quad_perm:[1,0,3,2] row_mask:0xf bank_mask:0xf
v_cndmask_b32_dpp v81, v77, v81, vcc quad_perm:[1,0,3,2] row_mask:0xf bank_mask:0xf
v_cndmask_b32_dpp v82, v78, v82, vcc quad_perm:[1,0,3,2] row_mask:0xf bank_mask:0xf
v_cndmask_b32_dpp v83, v79, v83, vcc quad_perm:[1,0,3,2] row_mask:0xf bank_mask:0xf
buffer_store_dwordx4 v[80:83], v4, s[20:23], s46 offen offset:1152 sc1
s_mov_b64 vcc, s[80:81]
s_waitcnt vmcnt(15)
v_smfmac_f32_16x16x64_bf16 v[100:103], v[206:209], v[44:51], v169
s_waitcnt vmcnt(14)
v_smfmac_f32_16x16x64_bf16 v[100:103], v[242:245], v[52:59], v173
v_cvt_pk_bf16_f32 v86, v96, v97
v_cvt_pk_bf16_f32 v87, v98, v99
v_add_u32_sdwa v76, s4, v118 dst_sel:DWORD dst_unused:UNUSED_PAD src0_sel:DWORD src1_sel:WORD_0
v_add_u32_sdwa v77, s4, v118 dst_sel:DWORD dst_unused:UNUSED_PAD src0_sel:DWORD src1_sel:WORD_1
v_add_u32_sdwa v78, s4, v119 dst_sel:DWORD dst_unused:UNUSED_PAD src0_sel:DWORD src1_sel:WORD_0
v_add_u32_sdwa v79, s4, v119 dst_sel:DWORD dst_unused:UNUSED_PAD src0_sel:DWORD src1_sel:WORD_1
s_waitcnt vmcnt(13)
v_smfmac_f32_16x16x64_bf16 v[104:107], v[210:213], v[44:51], v169 abid:1
s_waitcnt vmcnt(12)
v_smfmac_f32_16x16x64_bf16 v[104:107], v[246:249], v[52:59], v173 abid:1
v_cvt_pk_bf16_f32 v88, v100, v101
v_cvt_pk_bf16_f32 v89, v102, v103
v_add_u32_sdwa v80, s4, v120 dst_sel:DWORD dst_unused:UNUSED_PAD src0_sel:DWORD src1_sel:WORD_0
v_add_u32_sdwa v81, s4, v120 dst_sel:DWORD dst_unused:UNUSED_PAD src0_sel:DWORD src1_sel:WORD_1
v_add_u32_sdwa v82, s4, v121 dst_sel:DWORD dst_unused:UNUSED_PAD src0_sel:DWORD src1_sel:WORD_0
v_add_u32_sdwa v83, s4, v121 dst_sel:DWORD dst_unused:UNUSED_PAD src0_sel:DWORD src1_sel:WORD_1
s_nop 1
v_cvt_pk_bf16_f32 v90, v104, v105
v_cvt_pk_bf16_f32 v91, v106, v107
v_cndmask_b32_dpp v92, v88, v84, vcc quad_perm:[1,0,3,2] row_mask:0xf bank_mask:0xf
v_cndmask_b32_dpp v93, v89, v85, vcc quad_perm:[1,0,3,2] row_mask:0xf bank_mask:0xf
v_cndmask_b32_dpp v94, v90, v86, vcc quad_perm:[1,0,3,2] row_mask:0xf bank_mask:0xf
v_cndmask_b32_dpp v95, v91, v87, vcc quad_perm:[1,0,3,2] row_mask:0xf bank_mask:0xf
buffer_store_dwordx4 v[92:95], v4, s[20:23], s46 offen offset:128 sc1
s_mov_b64 vcc, s[82:83]
v_cndmask_b32_dpp v88, v84, v88, vcc quad_perm:[1,0,3,2] row_mask:0xf bank_mask:0xf
v_cndmask_b32_dpp v89, v85, v89, vcc quad_perm:[1,0,3,2] row_mask:0xf bank_mask:0xf
v_cndmask_b32_dpp v90, v86, v90, vcc quad_perm:[1,0,3,2] row_mask:0xf bank_mask:0xf
v_cndmask_b32_dpp v91, v87, v91, vcc quad_perm:[1,0,3,2] row_mask:0xf bank_mask:0xf
buffer_store_dwordx4 v[88:91], v4, s[20:23], s46 offen offset:1280 sc1
s_mov_b64 vcc, s[80:81]
s_branch L_ptail1
L_ptail0:
ds_read_b128 v[52:55], v0 offset:16384
ds_read_b128 v[56:59], v1 offset:16384
s_waitcnt vmcnt(17) lgkmcnt(2)
v_smfmac_f32_16x16x64_bf16 v[108:111], v[214:217], v[44:51], v177 abid:1
s_waitcnt vmcnt(16) lgkmcnt(0)
v_smfmac_f32_16x16x64_bf16 v[108:111], v[250:253], v[52:59], v178
v_add_u32 v0, 37120, v0
v_add_u32 v1, 37120, v1
s_waitcnt vmcnt(15)
v_smfmac_f32_16x16x64_bf16 v[76:79], a[252:255], v[44:51], v166
s_waitcnt vmcnt(14)
v_smfmac_f32_16x16x64_bf16 v[76:79], v[218:221], v[52:59], v170
s_nop 1
v_cvt_pk_bf16_f32 v108, v108, v109
v_cvt_pk_bf16_f32 v109, v110, v111
ds_write_b64 v254, v[108:109]
s_waitcnt vmcnt(13)
v_smfmac_f32_16x16x64_bf16 v[80:83], v[186:189], v[44:51], v166 abid:1
s_waitcnt vmcnt(12)
v_smfmac_f32_16x16x64_bf16 v[80:83], v[222:225], v[52:59], v170 abid:1
v_cvt_pk_bf16_f32 v76, v76, v77
v_cvt_pk_bf16_f32 v77, v78, v79
s_waitcnt vmcnt(11)
v_smfmac_f32_16x16x64_bf16 v[84:87], v[190:193], v[44:51], v167
s_waitcnt vmcnt(10)
v_smfmac_f32_16x16x64_bf16 v[84:87], v[226:229], v[52:59], v171
s_nop 1
v_cvt_pk_bf16_f32 v78, v80, v81
v_cvt_pk_bf16_f32 v79, v82, v83
v_xor_b32 v254, 512, v254
s_waitcnt vmcnt(9)
v_smfmac_f32_16x16x64_bf16 v[88:91], v[194:197], v[44:51], v167 abid:1
s_waitcnt vmcnt(8)
v_smfmac_f32_16x16x64_bf16 v[88:91], v[230:233], v[52:59], v171 abid:1
v_cvt_pk_bf16_f32 v80, v84, v85
v_cvt_pk_bf16_f32 v81, v86, v87
s_waitcnt vmcnt(7)
v_smfmac_f32_16x16x64_bf16 v[92:95], v[198:201], v[44:51], v168
s_waitcnt vmcnt(6)
v_smfmac_f32_16x16x64_bf16 v[92:95], v[234:237], v[52:59], v172
s_nop 1
v_cvt_pk_bf16_f32 v82, v88, v89
v_cvt_pk_bf16_f32 v83, v90, v91
v_cndmask_b32_dpp v114, v80, v76, vcc quad_perm:[1,0,3,2] row_mask:0xf bank_mask:0xf
v_cndmask_b32_dpp v115, v81, v77, vcc quad_perm:[1,0,3,2] row_mask:0xf bank_mask:0xf
v_cndmask_b32_dpp v116, v82, v78, vcc quad_perm:[1,0,3,2] row_mask:0xf bank_mask:0xf
v_cndmask_b32_dpp v117, v83, v79, vcc quad_perm:[1,0,3,2] row_mask:0xf bank_mask:0xf
buffer_store_dwordx4 v[114:117], v4, s[20:23], s46 offen offset:0 sc1
s_mov_b64 vcc, s[82:83]
s_waitcnt vmcnt(6)
v_smfmac_f32_16x16x64_bf16 v[96:99], v[202:205], v[44:51], v168 abid:1
s_waitcnt vmcnt(5)
v_smfmac_f32_16x16x64_bf16 v[96:99], v[238:241], v[52:59], v172 abid:1
v_cvt_pk_bf16_f32 v84, v92, v93
v_cvt_pk_bf16_f32 v85, v94, v95
v_cndmask_b32_dpp v80, v76, v80, vcc quad_perm:[1,0,3,2] row_mask:0xf bank_mask:0xf
v_cndmask_b32_dpp v81, v77, v81, vcc quad_perm:[1,0,3,2] row_mask:0xf bank_mask:0xf
v_cndmask_b32_dpp v82, v78, v82, vcc quad_perm:[1,0,3,2] row_mask:0xf bank_mask:0xf
v_cndmask_b32_dpp v83, v79, v83, vcc quad_perm:[1,0,3,2] row_mask:0xf bank_mask:0xf
buffer_store_dwordx4 v[80:83], v4, s[20:23], s46 offen offset:1152 sc1
s_mov_b64 vcc, s[80:81]
s_waitcnt vmcnt(5)
v_smfmac_f32_16x16x64_bf16 v[100:103], v[206:209], v[44:51], v169
s_waitcnt vmcnt(4)
v_smfmac_f32_16x16x64_bf16 v[100:103], v[242:245], v[52:59], v173
v_cvt_pk_bf16_f32 v86, v96, v97
v_cvt_pk_bf16_f32 v87, v98, v99
v_add_u32_sdwa v76, s4, v118 dst_sel:DWORD dst_unused:UNUSED_PAD src0_sel:DWORD src1_sel:WORD_0
v_add_u32_sdwa v77, s4, v118 dst_sel:DWORD dst_unused:UNUSED_PAD src0_sel:DWORD src1_sel:WORD_1
v_add_u32_sdwa v78, s4, v119 dst_sel:DWORD dst_unused:UNUSED_PAD src0_sel:DWORD src1_sel:WORD_0
v_add_u32_sdwa v79, s4, v119 dst_sel:DWORD dst_unused:UNUSED_PAD src0_sel:DWORD src1_sel:WORD_1
s_waitcnt vmcnt(3)
v_smfmac_f32_16x16x64_bf16 v[104:107], v[210:213], v[44:51], v169 abid:1
s_waitcnt vmcnt(2)
v_smfmac_f32_16x16x64_bf16 v[104:107], v[246:249], v[52:59], v173 abid:1
v_cvt_pk_bf16_f32 v88, v100, v101
v_cvt_pk_bf16_f32 v89, v102, v103
v_add_u32_sdwa v80, s4, v120 dst_sel:DWORD dst_unused:UNUSED_PAD src0_sel:DWORD src1_sel:WORD_0
v_add_u32_sdwa v81, s4, v120 dst_sel:DWORD dst_unused:UNUSED_PAD src0_sel:DWORD src1_sel:WORD_1
v_add_u32_sdwa v82, s4, v121 dst_sel:DWORD dst_unused:UNUSED_PAD src0_sel:DWORD src1_sel:WORD_0
v_add_u32_sdwa v83, s4, v121 dst_sel:DWORD dst_unused:UNUSED_PAD src0_sel:DWORD src1_sel:WORD_1
s_nop 1
v_cvt_pk_bf16_f32 v90, v104, v105
v_cvt_pk_bf16_f32 v91, v106, v107
v_cndmask_b32_dpp v92, v88, v84, vcc quad_perm:[1,0,3,2] row_mask:0xf bank_mask:0xf
v_cndmask_b32_dpp v93, v89, v85, vcc quad_perm:[1,0,3,2] row_mask:0xf bank_mask:0xf
v_cndmask_b32_dpp v94, v90, v86, vcc quad_perm:[1,0,3,2] row_mask:0xf bank_mask:0xf
v_cndmask_b32_dpp v95, v91, v87, vcc quad_perm:[1,0,3,2] row_mask:0xf bank_mask:0xf
buffer_store_dwordx4 v[92:95], v4, s[20:23], s46 offen offset:128 sc1
s_mov_b64 vcc, s[82:83]
v_cndmask_b32_dpp v88, v84, v88, vcc quad_perm:[1,0,3,2] row_mask:0xf bank_mask:0xf
v_cndmask_b32_dpp v89, v85, v89, vcc quad_perm:[1,0,3,2] row_mask:0xf bank_mask:0xf
v_cndmask_b32_dpp v90, v86, v90, vcc quad_perm:[1,0,3,2] row_mask:0xf bank_mask:0xf
v_cndmask_b32_dpp v91, v87, v91, vcc quad_perm:[1,0,3,2] row_mask:0xf bank_mask:0xf
buffer_store_dwordx4 v[88:91], v4, s[20:23], s46 offen offset:1280 sc1
s_mov_b64 vcc, s[80:81]
L_ptail1:
s_cmp_ge_u32 s44, 148480
s_cselect_b32 s44, s9, s44
s_mov_b32 s66, s46
s_add_u32 s46, s46, 4718592
s_waitcnt lgkmcnt(0)
s_barrier
s_cmp_lg_u32 s89, 0
s_cbranch_scc1 L_loopnk_p3
s_branch L_loopn_p3
.p2align 6
L_loop:
v_smfmac_f32_16x16x64_bf16 v[8:11], a[0:3], v[44:51], v138
ds_read_b128 v[32:35], v2 offset:1408
v_cvt_pk_bf16_f32 v106, v36, v37
v_smfmac_f32_16x16x64_bf16 v[8:11], a[36:39], v[52:59], v142
s_waitcnt lgkmcnt(9)
v_cvt_pk_bf16_f32 v107, v38, v39
v_smfmac_f32_16x16x64_bf16 v[12:15], a[4:7], v[44:51], v138 abid:1
ds_read_b128 v[36:39], v2 offset:1472
v_cvt_pk_bf16_f32 v112, v40, v41
v_smfmac_f32_16x16x64_bf16 v[12:15], a[40:43], v[52:59], v142 abid:1
s_waitcnt lgkmcnt(8)
ds_read_u16 v81, v81
v_cvt_pk_bf16_f32 v113, v42, v43
v_smfmac_f32_16x16x64_bf16 v[16:19], a[8:11], v[44:51], v139
s_cmp_eq_u32 s4, 129920
ds_read_b128 v[40:43], v2 offset:1536
v_cndmask_b32_dpp v108, v96, v92, vcc quad_perm:[1,0,3,2] row_mask:0xf bank_mask:0xf
v_smfmac_f32_16x16x64_bf16 v[16:19], a[44:47], v[52:59], v143
s_waitcnt lgkmcnt(8)
ds_read_b128 v[60:63], v0 offset:4096
v_cndmask_b32_dpp v109, v97, v93, vcc quad_perm:[1,0,3,2] row_mask:0xf bank_mask:0xf
v_smfmac_f32_16x16x64_bf16 v[20:23], a[12:15], v[44:51], v139 abid:1
s_cselect_b32 s43, -129920, s5
ds_read_u16 v82, v82
v_cndmask_b32_dpp v110, v98, v94, vcc quad_perm:[1,0,3,2] row_mask:0xf bank_mask:0xf
v_smfmac_f32_16x16x64_bf16 v[20:23], a[48:51], v[52:59], v143 abid:1
s_waitcnt lgkmcnt(8)
ds_read_u16 v84, v84
v_cndmask_b32_dpp v111, v99, v95, vcc quad_perm:[1,0,3,2] row_mask:0xf bank_mask:0xf
v_smfmac_f32_16x16x64_bf16 v[24:27], a[16:19], v[44:51], v140
s_add_u32 s4, s4, s43
ds_read_b128 v[64:67], v1 offset:4096
v_add_u32_sdwa v87, s42, v123 dst_sel:DWORD dst_unused:UNUSED_PAD src0_sel:DWORD src1_sel:WORD_1
v_smfmac_f32_16x16x64_bf16 v[24:27], a[52:55], v[52:59], v144
buffer_store_dwordx4 v[108:111], v4, s[20:23], s46 offen offset:0 sc1
s_mov_b64 vcc, s[82:83]
s_waitcnt lgkmcnt(8)
ds_read_b128 v[68:71], v0 offset:6144
v_cndmask_b32_dpp v96, v92, v96, vcc quad_perm:[1,0,3,2] row_mask:0xf bank_mask:0xf
v_cndmask_b32_dpp v97, v93, v97, vcc quad_perm:[1,0,3,2] row_mask:0xf bank_mask:0xf
v_smfmac_f32_16x16x64_bf16 v[28:31], a[20:23], v[44:51], v140 abid:1
s_add_u32 s41, s41, 1
ds_read_b128 v[72:75], v1 offset:6144
v_cndmask_b32_dpp v98, v94, v98, vcc quad_perm:[1,0,3,2] row_mask:0xf bank_mask:0xf
v_smfmac_f32_16x16x64_bf16 v[28:31], a[56:59], v[52:59], v144 abid:1
s_waitcnt lgkmcnt(9)
ds_read_u16 v83, v83
v_cndmask_b32_dpp v99, v95, v99, vcc quad_perm:[1,0,3,2] row_mask:0xf bank_mask:0xf
v_smfmac_f32_16x16x64_bf16 v[32:35], a[24:27], v[44:51], v141
ds_read_b128 v[114:117], v2 offset:64
v_add_u32_sdwa v88, s42, v124 dst_sel:DWORD dst_unused:UNUSED_PAD src0_sel:DWORD src1_sel:WORD_0
v_smfmac_f32_16x16x64_bf16 v[32:35], a[60:63], v[52:59], v145
s_waitcnt lgkmcnt(10)
ds_read_u16 v85, v85
v_add_u32_sdwa v89, s42, v124 dst_sel:DWORD dst_unused:UNUSED_PAD src0_sel:DWORD src1_sel:WORD_1
v_smfmac_f32_16x16x64_bf16 v[36:39], a[28:31], v[44:51], v141 abid:1
ds_read_u16 v86, v86
v_add_u32_sdwa v90, s42, v125 dst_sel:DWORD dst_unused:UNUSED_PAD src0_sel:DWORD src1_sel:WORD_0
v_smfmac_f32_16x16x64_bf16 v[36:39], a[64:67], v[52:59], v145 abid:1
s_waitcnt lgkmcnt(10)
ds_read_u16 v87, v87
v_add_u32_sdwa v91, s42, v125 dst_sel:DWORD dst_unused:UNUSED_PAD src0_sel:DWORD src1_sel:WORD_1
v_smfmac_f32_16x16x64_bf16 v[40:43], a[32:35], v[44:51], v174
buffer_store_dwordx4 v[96:99], v4, s[20:23], s46 offen offset:1152 sc1
s_mov_b64 vcc, s[80:81]
ds_read_u16 v88, v88
v_cndmask_b32_dpp v92, v104, v100, vcc quad_perm:[1,0,3,2] row_mask:0xf bank_mask:0xf
v_cndmask_b32_dpp v93, v105, v101, vcc quad_perm:[1,0,3,2] row_mask:0xf bank_mask:0xf
v_smfmac_f32_16x16x64_bf16 v[40:43], a[68:71], v[52:59], v174 abid:1
s_waitcnt lgkmcnt(8)
ds_read_u16 v89, v89
v_cndmask_b32_dpp v94, v106, v102, vcc quad_perm:[1,0,3,2] row_mask:0xf bank_mask:0xf
v_smfmac_f32_16x16x64_bf16 v[8:11], a[72:75], v[60:67], v146
s_waitcnt lgkmcnt(7)
ds_read_u16 v90, v90
v_cndmask_b32_dpp v95, v107, v103, vcc quad_perm:[1,0,3,2] row_mask:0xf bank_mask:0xf
v_smfmac_f32_16x16x64_bf16 v[8:11], a[108:111], v[68:75], v150
s_waitcnt lgkmcnt(6)
ds_read_u16 v91, v91
v_smfmac_f32_16x16x64_bf16 v[8:11], v[114:117], v[76:83], v179
ds_read_b128 v[44:47], v0 offset:8192
v_smfmac_f32_16x16x64_bf16 v[12:15], v[114:117], v[76:83], v179 abid:1
ds_read_b128 v[114:117], v2 offset:128
v_add_u32_sdwa v76, s42, v126 dst_sel:DWORD dst_unused:UNUSED_PAD src0_sel:DWORD src1_sel:WORD_0
v_smfmac_f32_16x16x64_bf16 v[12:15], a[76:79], v[60:67], v146 abid:1
ds_read_u16 v76, v76
v_add_u32_sdwa v77, s42, v126 dst_sel:DWORD dst_unused:UNUSED_PAD src0_sel:DWORD src1_sel:WORD_1
v_smfmac_f32_16x16x64_bf16 v[12:15], a[112:115], v[68:75], v150 abid:1
buffer_store_dwordx4 v[92:95], v4, s[20:23], s46 offen offset:128 sc1
s_mov_b64 vcc, s[82:83]
ds_read_u16 v77, v77
v_cndmask_b32_dpp v104, v100, v104, vcc quad_perm:[1,0,3,2] row_mask:0xf bank_mask:0xf
v_add_u32_sdwa v78, s42, v127 dst_sel:DWORD dst_unused:UNUSED_PAD src0_sel:DWORD src1_sel:WORD_0
v_smfmac_f32_16x16x64_bf16 v[24:27], a[88:91], v[60:67], v148
ds_read_u16 v78, v78
v_cndmask_b32_dpp v105, v101, v105, vcc quad_perm:[1,0,3,2] row_mask:0xf bank_mask:0xf
v_smfmac_f32_16x16x64_bf16 v[24:27], a[124:127], v[68:75], v152
ds_read_b128 v[48:51], v1 offset:8192
v_cndmask_b32_dpp v106, v102, v106, vcc quad_perm:[1,0,3,2] row_mask:0xf bank_mask:0xf
v_smfmac_f32_16x16x64_bf16 v[28:31], a[92:95], v[60:67], v148 abid:1
ds_read_b128 v[52:55], v0 offset:10240
v_add_u32_sdwa v79, s42, v127 dst_sel:DWORD dst_unused:UNUSED_PAD src0_sel:DWORD src1_sel:WORD_1
v_smfmac_f32_16x16x64_bf16 v[28:31], a[128:131], v[68:75], v152 abid:1
ds_read_u16 v79, v79
v_cndmask_b32_dpp v107, v103, v107, vcc quad_perm:[1,0,3,2] row_mask:0xf bank_mask:0xf
v_smfmac_f32_16x16x64_bf16 v[32:35], a[96:99], v[60:67], v149
ds_read_b128 v[56:59], v1 offset:10240
v_add_u32_sdwa v80, s42, v128 dst_sel:DWORD dst_unused:UNUSED_PAD src0_sel:DWORD src1_sel:WORD_0
v_smfmac_f32_16x16x64_bf16 v[32:35], a[132:135], v[68:75], v153
ds_read_u16 v80, v80
v_add_u32_sdwa v81, s42, v128 dst_sel:DWORD dst_unused:UNUSED_PAD src0_sel:DWORD src1_sel:WORD_1
v_smfmac_f32_16x16x64_bf16 v[16:19], a[80:83], v[60:67], v147
buffer_store_dwordx4 v[104:107], v4, s[20:23], s46 offen offset:1280 sc1
s_mov_b64 vcc, s[80:81]
ds_read_b128 v[92:95], v0 offset:12288
v_add_u32_sdwa v82, s42, v129 dst_sel:DWORD dst_unused:UNUSED_PAD src0_sel:DWORD src1_sel:WORD_0
v_add_u32_sdwa v83, s42, v129 dst_sel:DWORD dst_unused:UNUSED_PAD src0_sel:DWORD src1_sel:WORD_1
v_smfmac_f32_16x16x64_bf16 v[16:19], a[116:119], v[68:75], v151
s_waitcnt lgkmcnt(9)
ds_read_u16 v81, v81
v_add_u32_sdwa v100, s42, v130 dst_sel:DWORD dst_unused:UNUSED_PAD src0_sel:DWORD src1_sel:WORD_0
v_smfmac_f32_16x16x64_bf16 v[16:19], v[114:117], v[84:91], v180 abid:1
s_waitcnt vmcnt(5)
ds_read_b128 v[96:99], v1 offset:12288
v_add_u32_sdwa v101, s42, v130 dst_sel:DWORD dst_unused:UNUSED_PAD src0_sel:DWORD src1_sel:WORD_1
v_smfmac_f32_16x16x64_bf16 v[20:23], v[114:117], v[84:91], v181
s_mov_b32 s66, s46
ds_read_u16 v100, v100
v_add_u32_sdwa v102, s42, v131 dst_sel:DWORD dst_unused:UNUSED_PAD src0_sel:DWORD src1_sel:WORD_0
v_smfmac_f32_16x16x64_bf16 v[20:23], a[84:87], v[60:67], v147 abid:1
s_mov_b32 s46, s48
ds_read_u16 v82, v82
v_add_u32_sdwa v103, s42, v131 dst_sel:DWORD dst_unused:UNUSED_PAD src0_sel:DWORD src1_sel:WORD_1
v_smfmac_f32_16x16x64_bf16 v[20:23], a[120:123], v[68:75], v151 abid:1
s_mov_b32 s48, s49
ds_read_u16 v101, v101
v_add_u32_sdwa v104, s42, v132 dst_sel:DWORD dst_unused:UNUSED_PAD src0_sel:DWORD src1_sel:WORD_0
v_smfmac_f32_16x16x64_bf16 v[36:39], a[100:103], v[60:67], v149 abid:1
s_mov_b32 s49, s50
ds_read_u16 v83, v83
v_add_u32_sdwa v105, s42, v132 dst_sel:DWORD dst_unused:UNUSED_PAD src0_sel:DWORD src1_sel:WORD_1
v_smfmac_f32_16x16x64_bf16 v[36:39], a[136:139], v[68:75], v153 abid:1
s_add_u32 s50, s50, 4718592
ds_read_b128 v[114:117], v2 offset:192
v_add_u32_sdwa v106, s42, v133 dst_sel:DWORD dst_unused:UNUSED_PAD src0_sel:DWORD src1_sel:WORD_0
v_smfmac_f32_16x16x64_bf16 v[40:43], a[104:107], v[60:67], v175
ds_read_u16 v102, v102
v_add_u32_sdwa v107, s42, v133 dst_sel:DWORD dst_unused:UNUSED_PAD src0_sel:DWORD src1_sel:WORD_1
v_smfmac_f32_16x16x64_bf16 v[40:43], a[140:143], v[68:75], v175 abid:1
s_waitcnt lgkmcnt(13)
ds_read_u16 v103, v103
v_add_u32_sdwa v84, s42, v134 dst_sel:DWORD dst_unused:UNUSED_PAD src0_sel:DWORD src1_sel:WORD_0
v_smfmac_f32_16x16x64_bf16 v[8:11], a[144:147], v[44:51], v154
s_waitcnt lgkmcnt(11)
ds_read_u16 v104, v104
v_add_u32_sdwa v85, s42, v134 dst_sel:DWORD dst_unused:UNUSED_PAD src0_sel:DWORD src1_sel:WORD_1
v_smfmac_f32_16x16x64_bf16 v[8:11], a[180:183], v[52:59], v158
s_waitcnt lgkmcnt(8)
ds_read_u16 v105, v105
v_add_u32_sdwa v86, s42, v135 dst_sel:DWORD dst_unused:UNUSED_PAD src0_sel:DWORD src1_sel:WORD_0
v_smfmac_f32_16x16x64_bf16 v[8:11], a[216:219], v[92:99], v162
ds_read_u16 v106, v106
v_add_u32_sdwa v87, s42, v135 dst_sel:DWORD dst_unused:UNUSED_PAD src0_sel:DWORD src1_sel:WORD_1
v_smfmac_f32_16x16x64_bf16 v[24:27], a[160:163], v[44:51], v156
s_add_u32 m0, s44, 0
ds_read_u16 v107, v107
v_add_u32_sdwa v88, s42, v136 dst_sel:DWORD dst_unused:UNUSED_PAD src0_sel:DWORD src1_sel:WORD_0
v_smfmac_f32_16x16x64_bf16 v[24:27], a[196:199], v[52:59], v160
buffer_load_dwordx4 v3, s[16:19], s45 offen offset:0 nt lds
v_add_u32_sdwa v89, s42, v136 dst_sel:DWORD dst_unused:UNUSED_PAD src0_sel:DWORD src1_sel:WORD_1
v_smfmac_f32_16x16x64_bf16 v[24:27], a[232:235], v[92:99], v164
s_waitcnt lgkmcnt(6)
ds_read_u16 v84, v84
v_add_u32_sdwa v90, s42, v137 dst_sel:DWORD dst_unused:UNUSED_PAD src0_sel:DWORD src1_sel:WORD_0
v_smfmac_f32_16x16x64_bf16 v[24:27], v[114:117], v[76:83], v182
ds_read_u16 v85, v85
v_add_u32_sdwa v91, s42, v137 dst_sel:DWORD dst_unused:UNUSED_PAD src0_sel:DWORD src1_sel:WORD_1
v_smfmac_f32_16x16x64_bf16 v[28:31], v[114:117], v[76:83], v182 abid:1
ds_read_b128 v[114:117], v2 offset:256
v_add_u32_sdwa v76, s4, v118 dst_sel:DWORD dst_unused:UNUSED_PAD src0_sel:DWORD src1_sel:WORD_0
v_smfmac_f32_16x16x64_bf16 v[28:31], a[164:167], v[44:51], v156 abid:1
ds_read_u16 v86, v86
v_add_u32_sdwa v77, s4, v118 dst_sel:DWORD dst_unused:UNUSED_PAD src0_sel:DWORD src1_sel:WORD_1
v_smfmac_f32_16x16x64_bf16 v[28:31], a[200:203], v[52:59], v160 abid:1
ds_read_u16 v87, v87
v_add_u32_sdwa v78, s4, v119 dst_sel:DWORD dst_unused:UNUSED_PAD src0_sel:DWORD src1_sel:WORD_0
v_smfmac_f32_16x16x64_bf16 v[28:31], a[236:239], v[92:99], v164 abid:1
ds_read_u16 v88, v88
v_add_u32_sdwa v79, s4, v119 dst_sel:DWORD dst_unused:UNUSED_PAD src0_sel:DWORD src1_sel:WORD_1
v_smfmac_f32_16x16x64_bf16 v[12:15], a[148:151], v[44:51], v154 abid:1
s_add_u32 m0, s44, 3840
ds_read_b128 v[60:63], v0 offset:14336
v_add_u32_sdwa v80, s4, v120 dst_sel:DWORD dst_unused:UNUSED_PAD src0_sel:DWORD src1_sel:WORD_0
v_smfmac_f32_16x16x64_bf16 v[12:15], a[184:187], v[52:59], v158 abid:1
buffer_load_dwordx4 v3, s[16:19], s45 offen offset:256 nt lds
v_add_u32_sdwa v81, s4, v120 dst_sel:DWORD dst_unused:UNUSED_PAD src0_sel:DWORD src1_sel:WORD_1
v_smfmac_f32_16x16x64_bf16 v[12:15], a[220:223], v[92:99], v162 abid:1
ds_read_u16 v89, v89
v_add_u32_sdwa v82, s4, v121 dst_sel:DWORD dst_unused:UNUSED_PAD src0_sel:DWORD src1_sel:WORD_0
v_smfmac_f32_16x16x64_bf16 v[32:35], a[168:171], v[44:51], v157
ds_read_b128 v[64:67], v1 offset:14336
v_add_u32_sdwa v83, s4, v121 dst_sel:DWORD dst_unused:UNUSED_PAD src0_sel:DWORD src1_sel:WORD_1
v_smfmac_f32_16x16x64_bf16 v[32:35], a[204:207], v[52:59], v161
ds_read_b128 v[68:71], v0 offset:16384
v_smfmac_f32_16x16x64_bf16 v[32:35], a[240:243], v[92:99], v165
s_waitcnt lgkmcnt(7)
ds_read_u16 v90, v90
v_smfmac_f32_16x16x64_bf16 v[32:35], v[114:117], v[100:107], v183 abid:1
ds_read_b128 v[72:75], v1 offset:16384
v_add_u32 v0, s43, v0
v_smfmac_f32_16x16x64_bf16 v[36:39], v[114:117], v[100:107], v184
ds_read_u16 v91, v91
v_add_u32 v1, s43, v1
v_smfmac_f32_16x16x64_bf16 v[36:39], a[172:175], v[44:51], v157 abid:1
s_add_u32 m0, s44, 7680
ds_read_b128 v[114:117], v2 offset:320
v_smfmac_f32_16x16x64_bf16 v[36:39], a[208:211], v[52:59], v161 abid:1
buffer_load_dwordx4 v3, s[16:19], s45 offen offset:512 nt lds
v_smfmac_f32_16x16x64_bf16 v[36:39], a[244:247], v[92:99], v165 abid:1
ds_write_b64 v254, v[112:113]
v_xor_b32 v254, 512, v254
v_smfmac_f32_16x16x64_bf16 v[16:19], a[152:155], v[44:51], v155
s_add_u32 m0, s44, 11520
v_smfmac_f32_16x16x64_bf16 v[16:19], a[188:191], v[52:59], v159
buffer_load_dwordx4 v3, s[16:19], s45 offen offset:768 nt lds
v_smfmac_f32_16x16x64_bf16 v[16:19], a[224:227], v[92:99], v163
v_smfmac_f32_16x16x64_bf16 v[20:23], a[156:159], v[44:51], v155 abid:1
s_add_u32 m0, s44, s8
v_smfmac_f32_16x16x64_bf16 v[20:23], a[192:195], v[52:59], v159 abid:1
s_mov_b64 exec, s[10:11]
buffer_load_dwordx4 v3, s[16:19], s7 offen offset:896 nt lds
s_mov_b64 exec, -1
v_smfmac_f32_16x16x64_bf16 v[20:23], a[228:231], v[92:99], v163 abid:1
s_add_u32 s45, s45, 4718592
s_add_u32 s7, s7, 4718592
s_add_u32 s44, s44, s5
v_smfmac_f32_16x16x64_bf16 v[40:43], a[176:179], v[44:51], v176
s_cmp_ge_u32 s44, 148480
s_cselect_b32 s44, s9, s44
s_bitcmp1_b32 s92, s41
v_smfmac_f32_16x16x64_bf16 v[40:43], a[212:215], v[52:59], v176 abid:1
s_cbranch_scc1 L_loop_w
L_loop_wb:
v_smfmac_f32_16x16x64_bf16 v[40:43], a[248:251], v[92:99], v177
s_waitcnt lgkmcnt(0)
v_smfmac_f32_16x16x64_bf16 v[40:43], v[114:117], v[84:91], v185
s_waitcnt vmcnt(20)
s_barrier
v_smfmac_f32_16x16x64_bf16 v[8:11], a[252:255], v[60:67], v166
s_mov_b32 s42, s4
ds_read_b64 v[112:113], v6
v_xor_b32 v6, 512, v6
v_smfmac_f32_16x16x64_bf16 v[8:11], v[218:221], v[68:75], v170
v_add_u32_sdwa v84, s42, v122 dst_sel:DWORD dst_unused:UNUSED_PAD src0_sel:DWORD src1_sel:WORD_0
v_smfmac_f32_16x16x64_bf16 v[12:15], v[186:189], v[60:67], v166 abid:1
ds_read_b128 v[44:47], v0 offset:0
v_add_u32_sdwa v85, s42, v122 dst_sel:DWORD dst_unused:UNUSED_PAD src0_sel:DWORD src1_sel:WORD_1
v_smfmac_f32_16x16x64_bf16 v[12:15], v[222:225], v[68:75], v170 abid:1
ds_read_b128 v[48:51], v1 offset:0
v_add_u32_sdwa v86, s42, v123 dst_sel:DWORD dst_unused:UNUSED_PAD src0_sel:DWORD src1_sel:WORD_0
v_smfmac_f32_16x16x64_bf16 v[16:19], v[190:193], v[60:67], v167
ds_read_b128 v[52:55], v0 offset:2048
v_cvt_pk_bf16_f32 v92, v8, v9
v_smfmac_f32_16x16x64_bf16 v[16:19], v[226:229], v[68:75], v171
ds_read_b128 v[56:59], v1 offset:2048
v_cvt_pk_bf16_f32 v93, v10, v11
v_smfmac_f32_16x16x64_bf16 v[20:23], v[194:197], v[60:67], v167 abid:1
ds_read_b128 v[8:11], v2 offset:1024
v_cvt_pk_bf16_f32 v94, v12, v13
v_smfmac_f32_16x16x64_bf16 v[20:23], v[230:233], v[68:75], v171 abid:1
ds_read_u16 v76, v76
v_cvt_pk_bf16_f32 v95, v14, v15
v_smfmac_f32_16x16x64_bf16 v[24:27], v[198:201], v[60:67], v168
ds_read_b128 v[12:15], v2 offset:1088
v_cvt_pk_bf16_f32 v96, v16, v17
v_smfmac_f32_16x16x64_bf16 v[24:27], v[234:237], v[68:75], v172
s_waitcnt lgkmcnt(7)
ds_read_u16 v77, v77
v_cvt_pk_bf16_f32 v97, v18, v19
v_smfmac_f32_16x16x64_bf16 v[28:31], v[202:205], v[60:67], v168 abid:1
buffer_store_dwordx2 v[112:113], v5, s[20:23], s66 offen sc1
ds_read_b128 v[16:19], v2 offset:1152
v_cvt_pk_bf16_f32 v98, v20, v21
v_smfmac_f32_16x16x64_bf16 v[28:31], v[238:241], v[68:75], v172 abid:1
ds_read_u16 v78, v78
v_cvt_pk_bf16_f32 v99, v22, v23
v_smfmac_f32_16x16x64_bf16 v[32:35], v[206:209], v[60:67], v169
ds_read_b128 v[20:23], v2 offset:1216
v_cvt_pk_bf16_f32 v100, v24, v25
v_smfmac_f32_16x16x64_bf16 v[32:35], v[242:245], v[68:75], v173
ds_read_u16 v79, v79
v_cvt_pk_bf16_f32 v101, v26, v27
v_smfmac_f32_16x16x64_bf16 v[36:39], v[210:213], v[60:67], v169 abid:1
ds_read_b128 v[24:27], v2 offset:1280
v_cvt_pk_bf16_f32 v102, v28, v29
v_smfmac_f32_16x16x64_bf16 v[36:39], v[246:249], v[68:75], v173 abid:1
ds_read_u16 v80, v80
v_cvt_pk_bf16_f32 v103, v30, v31
v_smfmac_f32_16x16x64_bf16 v[40:43], v[214:217], v[60:67], v177 abid:1
s_bitcmp1_b32 s85, s41
ds_read_b128 v[28:31], v2 offset:1344
v_cvt_pk_bf16_f32 v104, v32, v33
v_smfmac_f32_16x16x64_bf16 v[40:43], v[250:253], v[68:75], v178
s_waitcnt lgkmcnt(10)
v_cvt_pk_bf16_f32 v105, v34, v35
s_cbranch_scc1 L_loop
s_cmp_lg_u32 s41, 6
s_cbranch_scc1 L_loopn
.p2align 3
L_loopc:
v_smfmac_f32_16x16x64_bf16 v[8:11], a[0:3], v[44:51], v138
s_cmp_lt_u32 s56, s65
s_cselect_b32 s34, s34, 0
s_cselect_b32 s64, s64, 0
ds_read_b128 v[32:35], v2 offset:1408
v_cvt_pk_bf16_f32 v106, v36, v37
v_mov_b32 v7, 1
v_smfmac_f32_16x16x64_bf16 v[8:11], a[36:39], v[52:59], v142
s_waitcnt lgkmcnt(9)
buffer_atomic_add v7, v3, s[32:35], 0 offen sc0 sc1
v_cvt_pk_bf16_f32 v107, v38, v39
v_smfmac_f32_16x16x64_bf16 v[12:15], a[4:7], v[44:51], v138 abid:1
ds_read_b128 v[36:39], v2 offset:1472
v_cvt_pk_bf16_f32 v112, v40, v41
v_smfmac_f32_16x16x64_bf16 v[12:15], a[40:43], v[52:59], v142 abid:1
s_waitcnt lgkmcnt(8)
ds_read_u16 v81, v81
v_cvt_pk_bf16_f32 v113, v42, v43
v_smfmac_f32_16x16x64_bf16 v[16:19], a[8:11], v[44:51], v139
s_cmp_eq_u32 s4, 129920
ds_read_b128 v[40:43], v2 offset:1536
v_cndmask_b32_dpp v108, v96, v92, vcc quad_perm:[1,0,3,2] row_mask:0xf bank_mask:0xf
v_smfmac_f32_16x16x64_bf16 v[16:19], a[44:47], v[52:59], v143
s_waitcnt lgkmcnt(8)
ds_read_b128 v[60:63], v0 offset:4096
v_cndmask_b32_dpp v109, v97, v93, vcc quad_perm:[1,0,3,2] row_mask:0xf bank_mask:0xf
v_smfmac_f32_16x16x64_bf16 v[20:23], a[12:15], v[44:51], v139 abid:1
s_cselect_b32 s43, -129920, s5
ds_read_u16 v82, v82
v_cndmask_b32_dpp v110, v98, v94, vcc quad_perm:[1,0,3,2] row_mask:0xf bank_mask:0xf
v_smfmac_f32_16x16x64_bf16 v[20:23], a[48:51], v[52:59], v143 abid:1
s_waitcnt lgkmcnt(8)
ds_read_u16 v84, v84
v_cndmask_b32_dpp v111, v99, v95, vcc quad_perm:[1,0,3,2] row_mask:0xf bank_mask:0xf
v_smfmac_f32_16x16x64_bf16 v[24:27], a[16:19], v[44:51], v140
s_add_u32 s4, s4, s43
ds_read_b128 v[64:67], v1 offset:4096
v_add_u32_sdwa v87, s42, v123 dst_sel:DWORD dst_unused:UNUSED_PAD src0_sel:DWORD src1_sel:WORD_1
v_smfmac_f32_16x16x64_bf16 v[24:27], a[52:55], v[52:59], v144
buffer_store_dwordx4 v[108:111], v4, s[20:23], s46 offen offset:0 sc1
s_mov_b64 vcc, s[82:83]
s_waitcnt lgkmcnt(8)
ds_read_b128 v[68:71], v0 offset:6144
v_cndmask_b32_dpp v96, v92, v96, vcc quad_perm:[1,0,3,2] row_mask:0xf bank_mask:0xf
v_cndmask_b32_dpp v97, v93, v97, vcc quad_perm:[1,0,3,2] row_mask:0xf bank_mask:0xf
v_smfmac_f32_16x16x64_bf16 v[28:31], a[20:23], v[44:51], v140 abid:1
s_add_u32 s7, s45, s58
ds_read_b128 v[72:75], v1 offset:6144
v_cndmask_b32_dpp v98, v94, v98, vcc quad_perm:[1,0,3,2] row_mask:0xf bank_mask:0xf
v_smfmac_f32_16x16x64_bf16 v[28:31], a[56:59], v[52:59], v144 abid:1
s_waitcnt lgkmcnt(9)
ds_read_u16 v83, v83
v_cndmask_b32_dpp v99, v95, v99, vcc quad_perm:[1,0,3,2] row_mask:0xf bank_mask:0xf
v_smfmac_f32_16x16x64_bf16 v[32:35], a[24:27], v[44:51], v141
ds_read_b128 v[114:117], v2 offset:64
v_add_u32_sdwa v88, s42, v124 dst_sel:DWORD dst_unused:UNUSED_PAD src0_sel:DWORD src1_sel:WORD_0
v_smfmac_f32_16x16x64_bf16 v[32:35], a[60:63], v[52:59], v145
s_waitcnt lgkmcnt(10)
ds_read_u16 v85, v85
v_add_u32_sdwa v89, s42, v124 dst_sel:DWORD dst_unused:UNUSED_PAD src0_sel:DWORD src1_sel:WORD_1
v_smfmac_f32_16x16x64_bf16 v[36:39], a[28:31], v[44:51], v141 abid:1
ds_read_u16 v86, v86
v_add_u32_sdwa v90, s42, v125 dst_sel:DWORD dst_unused:UNUSED_PAD src0_sel:DWORD src1_sel:WORD_0
v_smfmac_f32_16x16x64_bf16 v[36:39], a[64:67], v[52:59], v145 abid:1
s_waitcnt lgkmcnt(10)
ds_read_u16 v87, v87
v_add_u32_sdwa v91, s42, v125 dst_sel:DWORD dst_unused:UNUSED_PAD src0_sel:DWORD src1_sel:WORD_1
v_smfmac_f32_16x16x64_bf16 v[40:43], a[32:35], v[44:51], v174
buffer_store_dwordx4 v[96:99], v4, s[20:23], s46 offen offset:1152 sc1
s_mov_b64 vcc, s[80:81]
ds_read_u16 v88, v88
v_cndmask_b32_dpp v92, v104, v100, vcc quad_perm:[1,0,3,2] row_mask:0xf bank_mask:0xf
v_cndmask_b32_dpp v93, v105, v101, vcc quad_perm:[1,0,3,2] row_mask:0xf bank_mask:0xf
v_smfmac_f32_16x16x64_bf16 v[40:43], a[68:71], v[52:59], v174 abid:1
s_waitcnt lgkmcnt(8)
ds_read_u16 v89, v89
v_cndmask_b32_dpp v94, v106, v102, vcc quad_perm:[1,0,3,2] row_mask:0xf bank_mask:0xf
v_smfmac_f32_16x16x64_bf16 v[8:11], a[72:75], v[60:67], v146
s_waitcnt lgkmcnt(7)
ds_read_u16 v90, v90
v_cndmask_b32_dpp v95, v107, v103, vcc quad_perm:[1,0,3,2] row_mask:0xf bank_mask:0xf
v_smfmac_f32_16x16x64_bf16 v[8:11], a[108:111], v[68:75], v150
s_waitcnt lgkmcnt(6)
ds_read_u16 v91, v91
v_smfmac_f32_16x16x64_bf16 v[8:11], v[114:117], v[76:83], v179
ds_read_b128 v[44:47], v0 offset:8192
v_smfmac_f32_16x16x64_bf16 v[12:15], v[114:117], v[76:83], v179 abid:1
ds_read_b128 v[114:117], v2 offset:128
v_add_u32_sdwa v76, s42, v126 dst_sel:DWORD dst_unused:UNUSED_PAD src0_sel:DWORD src1_sel:WORD_0
v_smfmac_f32_16x16x64_bf16 v[12:15], a[76:79], v[60:67], v146 abid:1
ds_read_u16 v76, v76
v_add_u32_sdwa v77, s42, v126 dst_sel:DWORD dst_unused:UNUSED_PAD src0_sel:DWORD src1_sel:WORD_1
v_smfmac_f32_16x16x64_bf16 v[12:15], a[112:115], v[68:75], v150 abid:1
buffer_store_dwordx4 v[92:95], v4, s[20:23], s46 offen offset:128 sc1
s_mov_b64 vcc, s[82:83]
ds_read_u16 v77, v77
v_cndmask_b32_dpp v104, v100, v104, vcc quad_perm:[1,0,3,2] row_mask:0xf bank_mask:0xf
v_add_u32_sdwa v78, s42, v127 dst_sel:DWORD dst_unused:UNUSED_PAD src0_sel:DWORD src1_sel:WORD_0
v_smfmac_f32_16x16x64_bf16 v[24:27], a[88:91], v[60:67], v148
ds_read_u16 v78, v78
v_cndmask_b32_dpp v105, v101, v105, vcc quad_perm:[1,0,3,2] row_mask:0xf bank_mask:0xf
v_smfmac_f32_16x16x64_bf16 v[24:27], a[124:127], v[68:75], v152
ds_read_b128 v[48:51], v1 offset:8192
v_cndmask_b32_dpp v106, v102, v106, vcc quad_perm:[1,0,3,2] row_mask:0xf bank_mask:0xf
v_smfmac_f32_16x16x64_bf16 v[28:31], a[92:95], v[60:67], v148 abid:1
ds_read_b128 v[52:55], v0 offset:10240
v_add_u32_sdwa v79, s42, v127 dst_sel:DWORD dst_unused:UNUSED_PAD src0_sel:DWORD src1_sel:WORD_1
v_smfmac_f32_16x16x64_bf16 v[28:31], a[128:131], v[68:75], v152 abid:1
ds_read_u16 v79, v79
v_cndmask_b32_dpp v107, v103, v107, vcc quad_perm:[1,0,3,2] row_mask:0xf bank_mask:0xf
v_smfmac_f32_16x16x64_bf16 v[32:35], a[96:99], v[60:67], v149
ds_read_b128 v[56:59], v1 offset:10240
v_add_u32_sdwa v80, s42, v128 dst_sel:DWORD dst_unused:UNUSED_PAD src0_sel:DWORD src1_sel:WORD_0
v_smfmac_f32_16x16x64_bf16 v[32:35], a[132:135], v[68:75], v153
ds_read_u16 v80, v80
v_add_u32_sdwa v81, s42, v128 dst_sel:DWORD dst_unused:UNUSED_PAD src0_sel:DWORD src1_sel:WORD_1
v_smfmac_f32_16x16x64_bf16 v[16:19], a[80:83], v[60:67], v147
buffer_store_dwordx4 v[104:107], v4, s[20:23], s46 offen offset:1280 sc1
s_mov_b64 vcc, s[80:81]
ds_read_b128 v[92:95], v0 offset:12288
v_add_u32_sdwa v82, s42, v129 dst_sel:DWORD dst_unused:UNUSED_PAD src0_sel:DWORD src1_sel:WORD_0
v_add_u32_sdwa v83, s42, v129 dst_sel:DWORD dst_unused:UNUSED_PAD src0_sel:DWORD src1_sel:WORD_1
v_smfmac_f32_16x16x64_bf16 v[16:19], a[116:119], v[68:75], v151
s_waitcnt lgkmcnt(9)
ds_read_u16 v81, v81
v_add_u32_sdwa v100, s42, v130 dst_sel:DWORD dst_unused:UNUSED_PAD src0_sel:DWORD src1_sel:WORD_0
v_smfmac_f32_16x16x64_bf16 v[16:19], v[114:117], v[84:91], v180 abid:1
s_mov_b32 s66, s46
ds_read_b128 v[96:99], v1 offset:12288
v_add_u32_sdwa v101, s42, v130 dst_sel:DWORD dst_unused:UNUSED_PAD src0_sel:DWORD src1_sel:WORD_1
v_smfmac_f32_16x16x64_bf16 v[20:23], v[114:117], v[84:91], v181
s_mov_b32 s46, s48
ds_read_u16 v100, v100
v_add_u32_sdwa v102, s42, v131 dst_sel:DWORD dst_unused:UNUSED_PAD src0_sel:DWORD src1_sel:WORD_0
v_smfmac_f32_16x16x64_bf16 v[20:23], a[84:87], v[60:67], v147 abid:1
s_mov_b32 s48, s49
ds_read_u16 v82, v82
v_add_u32_sdwa v103, s42, v131 dst_sel:DWORD dst_unused:UNUSED_PAD src0_sel:DWORD src1_sel:WORD_1
v_smfmac_f32_16x16x64_bf16 v[20:23], a[120:123], v[68:75], v151 abid:1
s_mov_b32 s49, s50
ds_read_u16 v101, v101
v_add_u32_sdwa v104, s42, v132 dst_sel:DWORD dst_unused:UNUSED_PAD src0_sel:DWORD src1_sel:WORD_0
v_smfmac_f32_16x16x64_bf16 v[36:39], a[100:103], v[60:67], v149 abid:1
s_mov_b32 s50, s45
ds_read_u16 v83, v83
v_add_u32_sdwa v105, s42, v132 dst_sel:DWORD dst_unused:UNUSED_PAD src0_sel:DWORD src1_sel:WORD_1
v_smfmac_f32_16x16x64_bf16 v[36:39], a[136:139], v[68:75], v153 abid:1
ds_read_b128 v[114:117], v2 offset:192
v_add_u32_sdwa v106, s42, v133 dst_sel:DWORD dst_unused:UNUSED_PAD src0_sel:DWORD src1_sel:WORD_0
v_smfmac_f32_16x16x64_bf16 v[40:43], a[104:107], v[60:67], v175
ds_read_u16 v102, v102
v_add_u32_sdwa v107, s42, v133 dst_sel:DWORD dst_unused:UNUSED_PAD src0_sel:DWORD src1_sel:WORD_1
v_smfmac_f32_16x16x64_bf16 v[40:43], a[140:143], v[68:75], v175 abid:1
s_waitcnt lgkmcnt(13)
ds_read_u16 v103, v103
v_add_u32_sdwa v84, s42, v134 dst_sel:DWORD dst_unused:UNUSED_PAD src0_sel:DWORD src1_sel:WORD_0
v_smfmac_f32_16x16x64_bf16 v[8:11], a[144:147], v[44:51], v154
s_waitcnt lgkmcnt(11)
ds_read_u16 v104, v104
v_add_u32_sdwa v85, s42, v134 dst_sel:DWORD dst_unused:UNUSED_PAD src0_sel:DWORD src1_sel:WORD_1
v_smfmac_f32_16x16x64_bf16 v[8:11], a[180:183], v[52:59], v158
s_waitcnt lgkmcnt(8)
ds_read_u16 v105, v105
v_add_u32_sdwa v86, s42, v135 dst_sel:DWORD dst_unused:UNUSED_PAD src0_sel:DWORD src1_sel:WORD_0
v_smfmac_f32_16x16x64_bf16 v[8:11], a[216:219], v[92:99], v162
ds_read_u16 v106, v106
v_add_u32_sdwa v87, s42, v135 dst_sel:DWORD dst_unused:UNUSED_PAD src0_sel:DWORD src1_sel:WORD_1
v_smfmac_f32_16x16x64_bf16 v[24:27], a[160:163], v[44:51], v156
s_add_u32 m0, s44, 0
ds_read_u16 v107, v107
v_add_u32_sdwa v88, s42, v136 dst_sel:DWORD dst_unused:UNUSED_PAD src0_sel:DWORD src1_sel:WORD_0
v_smfmac_f32_16x16x64_bf16 v[24:27], a[196:199], v[52:59], v160
buffer_load_dwordx4 v3, s[16:19], s45 offen offset:0 nt lds
v_add_u32_sdwa v89, s42, v136 dst_sel:DWORD dst_unused:UNUSED_PAD src0_sel:DWORD src1_sel:WORD_1
v_smfmac_f32_16x16x64_bf16 v[24:27], a[232:235], v[92:99], v164
s_waitcnt lgkmcnt(6)
ds_read_u16 v84, v84
v_add_u32_sdwa v90, s42, v137 dst_sel:DWORD dst_unused:UNUSED_PAD src0_sel:DWORD src1_sel:WORD_0
v_smfmac_f32_16x16x64_bf16 v[24:27], v[114:117], v[76:83], v182
ds_read_u16 v85, v85
v_add_u32_sdwa v91, s42, v137 dst_sel:DWORD dst_unused:UNUSED_PAD src0_sel:DWORD src1_sel:WORD_1
v_smfmac_f32_16x16x64_bf16 v[28:31], v[114:117], v[76:83], v182 abid:1
ds_read_b128 v[114:117], v2 offset:256
v_add_u32_sdwa v76, s4, v118 dst_sel:DWORD dst_unused:UNUSED_PAD src0_sel:DWORD src1_sel:WORD_0
v_smfmac_f32_16x16x64_bf16 v[28:31], a[164:167], v[44:51], v156 abid:1
ds_read_u16 v86, v86
v_add_u32_sdwa v77, s4, v118 dst_sel:DWORD dst_unused:UNUSED_PAD src0_sel:DWORD src1_sel:WORD_1
v_smfmac_f32_16x16x64_bf16 v[28:31], a[200:203], v[52:59], v160 abid:1
ds_read_u16 v87, v87
v_add_u32_sdwa v78, s4, v119 dst_sel:DWORD dst_unused:UNUSED_PAD src0_sel:DWORD src1_sel:WORD_0
v_smfmac_f32_16x16x64_bf16 v[28:31], a[236:239], v[92:99], v164 abid:1
ds_read_u16 v88, v88
v_add_u32_sdwa v79, s4, v119 dst_sel:DWORD dst_unused:UNUSED_PAD src0_sel:DWORD src1_sel:WORD_1
v_smfmac_f32_16x16x64_bf16 v[12:15], a[148:151], v[44:51], v154 abid:1
s_add_u32 m0, s44, 3840
ds_read_b128 v[60:63], v0 offset:14336
v_add_u32_sdwa v80, s4, v120 dst_sel:DWORD dst_unused:UNUSED_PAD src0_sel:DWORD src1_sel:WORD_0
v_smfmac_f32_16x16x64_bf16 v[12:15], a[184:187], v[52:59], v158 abid:1
buffer_load_dwordx4 v3, s[16:19], s45 offen offset:256 nt lds
v_add_u32_sdwa v81, s4, v120 dst_sel:DWORD dst_unused:UNUSED_PAD src0_sel:DWORD src1_sel:WORD_1
v_smfmac_f32_16x16x64_bf16 v[12:15], a[220:223], v[92:99], v162 abid:1
ds_read_u16 v89, v89
v_add_u32_sdwa v82, s4, v121 dst_sel:DWORD dst_unused:UNUSED_PAD src0_sel:DWORD src1_sel:WORD_0
v_smfmac_f32_16x16x64_bf16 v[32:35], a[168:171], v[44:51], v157
s_waitcnt vmcnt(6)
ds_read_b128 v[64:67], v1 offset:14336
v_add_u32_sdwa v83, s4, v121 dst_sel:DWORD dst_unused:UNUSED_PAD src0_sel:DWORD src1_sel:WORD_1
v_smfmac_f32_16x16x64_bf16 v[32:35], a[204:207], v[52:59], v161
ds_read_b128 v[68:71], v0 offset:16384
v_smfmac_f32_16x16x64_bf16 v[32:35], a[240:243], v[92:99], v165
s_waitcnt lgkmcnt(7)
ds_read_u16 v90, v90
v_smfmac_f32_16x16x64_bf16 v[32:35], v[114:117], v[100:107], v183 abid:1
ds_read_b128 v[72:75], v1 offset:16384
v_add_u32 v0, s43, v0
v_smfmac_f32_16x16x64_bf16 v[36:39], v[114:117], v[100:107], v184
ds_read_u16 v91, v91
v_add_u32 v1, s43, v1
v_smfmac_f32_16x16x64_bf16 v[36:39], a[172:175], v[44:51], v157 abid:1
s_add_u32 m0, s44, 7680
ds_read_b128 v[114:117], v2 offset:320
v_smfmac_f32_16x16x64_bf16 v[36:39], a[208:211], v[52:59], v161 abid:1
buffer_load_dwordx4 v3, s[16:19], s45 offen offset:512 nt lds
v_smfmac_f32_16x16x64_bf16 v[36:39], a[244:247], v[92:99], v165 abid:1
ds_write_b64 v254, v[112:113]
v_xor_b32 v254, 512, v254
v_smfmac_f32_16x16x64_bf16 v[16:19], a[152:155], v[44:51], v155
s_add_u32 m0, s44, 11520
v_smfmac_f32_16x16x64_bf16 v[16:19], a[188:191], v[52:59], v159
buffer_load_dwordx4 v3, s[16:19], s45 offen offset:768 nt lds
v_smfmac_f32_16x16x64_bf16 v[16:19], a[224:227], v[92:99], v163
s_mov_b64 exec, s[62:63]
ds_write_b32 v0, v7 offset:18432
s_mov_b64 exec, -1
v_smfmac_f32_16x16x64_bf16 v[20:23], a[156:159], v[44:51], v155 abid:1
s_add_u32 m0, s44, s8
v_smfmac_f32_16x16x64_bf16 v[20:23], a[192:195], v[52:59], v159 abid:1
s_mov_b64 exec, s[10:11]
buffer_load_dwordx4 v3, s[16:19], s7 offen offset:896 nt lds
s_mov_b64 exec, -1
v_smfmac_f32_16x16x64_bf16 v[20:23], a[228:231], v[92:99], v163 abid:1
s_add_u32 s44, s44, s5
s_cmp_ge_u32 s44, 148480
s_cselect_b32 s44, s9, s44
v_smfmac_f32_16x16x64_bf16 v[40:43], a[176:179], v[44:51], v176
v_smfmac_f32_16x16x64_bf16 v[40:43], a[212:215], v[52:59], v176 abid:1
v_smfmac_f32_16x16x64_bf16 v[40:43], a[248:251], v[92:99], v177
s_waitcnt lgkmcnt(0)
v_smfmac_f32_16x16x64_bf16 v[40:43], v[114:117], v[84:91], v185
s_barrier
v_smfmac_f32_16x16x64_bf16 v[8:11], a[252:255], v[60:67], v166
s_mov_b32 s42, s4
ds_read_b64 v[112:113], v6
v_xor_b32 v6, 512, v6
v_smfmac_f32_16x16x64_bf16 v[8:11], v[218:221], v[68:75], v170
ds_read_b32 v7, v0 offset:18432
v_add_u32_sdwa v84, s42, v122 dst_sel:DWORD dst_unused:UNUSED_PAD src0_sel:DWORD src1_sel:WORD_0
v_smfmac_f32_16x16x64_bf16 v[12:15], v[186:189], v[60:67], v166 abid:1
ds_read_b128 v[44:47], v0 offset:0
v_add_u32_sdwa v85, s42, v122 dst_sel:DWORD dst_unused:UNUSED_PAD src0_sel:DWORD src1_sel:WORD_1
v_smfmac_f32_16x16x64_bf16 v[12:15], v[222:225], v[68:75], v170 abid:1
ds_read_b128 v[48:51], v1 offset:0
v_add_u32_sdwa v86, s42, v123 dst_sel:DWORD dst_unused:UNUSED_PAD src0_sel:DWORD src1_sel:WORD_0
v_smfmac_f32_16x16x64_bf16 v[16:19], v[190:193], v[60:67], v167
ds_read_b128 v[52:55], v0 offset:2048
v_cvt_pk_bf16_f32 v92, v8, v9
v_smfmac_f32_16x16x64_bf16 v[16:19], v[226:229], v[68:75], v171
ds_read_b128 v[56:59], v1 offset:2048
v_cvt_pk_bf16_f32 v93, v10, v11
v_smfmac_f32_16x16x64_bf16 v[20:23], v[194:197], v[60:67], v167 abid:1
ds_read_b128 v[8:11], v2 offset:1024
v_cvt_pk_bf16_f32 v94, v12, v13
v_smfmac_f32_16x16x64_bf16 v[20:23], v[230:233], v[68:75], v171 abid:1
ds_read_u16 v76, v76
v_cvt_pk_bf16_f32 v95, v14, v15
v_smfmac_f32_16x16x64_bf16 v[24:27], v[198:201], v[60:67], v168
ds_read_b128 v[12:15], v2 offset:1088
v_cvt_pk_bf16_f32 v96, v16, v17
v_smfmac_f32_16x16x64_bf16 v[24:27], v[234:237], v[68:75], v172
s_waitcnt lgkmcnt(8)
ds_read_u16 v77, v77
v_cvt_pk_bf16_f32 v97, v18, v19
v_smfmac_f32_16x16x64_bf16 v[28:31], v[202:205], v[60:67], v168 abid:1
buffer_store_dwordx2 v[112:113], v5, s[20:23], s66 offen sc1
s_waitcnt lgkmcnt(8)
ds_read_b128 v[16:19], v2 offset:1152
v_cvt_pk_bf16_f32 v98, v20, v21
v_readfirstlane_b32 s56, v7
v_smfmac_f32_16x16x64_bf16 v[28:31], v[238:241], v[68:75], v172 abid:1
s_lshr_b32 s60, s56, 4
ds_read_u16 v78, v78
v_cvt_pk_bf16_f32 v99, v22, v23
v_smfmac_f32_16x16x64_bf16 v[32:35], v[206:209], v[60:67], v169
s_mul_i32 s60, s60, 884736
ds_read_b128 v[20:23], v2 offset:1216
v_cvt_pk_bf16_f32 v100, v24, v25
v_smfmac_f32_16x16x64_bf16 v[32:35], v[242:245], v[68:75], v173
s_mul_i32 s61, s56, 18432
ds_read_u16 v79, v79
v_cvt_pk_bf16_f32 v101, v26, v27
v_smfmac_f32_16x16x64_bf16 v[36:39], v[210:213], v[60:67], v169 abid:1
s_add_u32 s60, s60, s57
ds_read_b128 v[24:27], v2 offset:1280
v_cvt_pk_bf16_f32 v102, v28, v29
v_smfmac_f32_16x16x64_bf16 v[36:39], v[246:249], v[68:75], v173 abid:1
s_add_u32 s45, s60, s61
ds_read_u16 v80, v80
v_cvt_pk_bf16_f32 v103, v30, v31
v_smfmac_f32_16x16x64_bf16 v[40:43], v[214:217], v[60:67], v177 abid:1
s_cmp_lt_u32 s56, s64
ds_read_b128 v[28:31], v2 offset:1344
v_cvt_pk_bf16_f32 v104, v32, v33
v_smfmac_f32_16x16x64_bf16 v[40:43], v[250:253], v[68:75], v178
s_waitcnt lgkmcnt(10)
v_cvt_pk_bf16_f32 v105, v34, v35
s_cbranch_scc1 L_loopc
s_mov_b32 s41, 0
s_mov_b32 s15, 3
s_mov_b32 s12, 7
s_mov_b32 s92, 4
s_mov_b32 s87, 4
s_mov_b32 s59, -1
.p2align 3
L_loopn:
v_smfmac_f32_16x16x64_bf16 v[8:11], a[0:3], v[44:51], v138
ds_read_b128 v[32:35], v2 offset:1408
v_cvt_pk_bf16_f32 v106, v36, v37
v_smfmac_f32_16x16x64_bf16 v[8:11], a[36:39], v[52:59], v142
s_waitcnt lgkmcnt(9)
v_cvt_pk_bf16_f32 v107, v38, v39
v_smfmac_f32_16x16x64_bf16 v[12:15], a[4:7], v[44:51], v138 abid:1
ds_read_b128 v[36:39], v2 offset:1472
v_cvt_pk_bf16_f32 v112, v40, v41
v_smfmac_f32_16x16x64_bf16 v[12:15], a[40:43], v[52:59], v142 abid:1
s_waitcnt lgkmcnt(8)
ds_read_u16 v81, v81
v_cvt_pk_bf16_f32 v113, v42, v43
v_smfmac_f32_16x16x64_bf16 v[16:19], a[8:11], v[44:51], v139
s_cmp_eq_u32 s4, 129920
ds_read_b128 v[40:43], v2 offset:1536
v_cndmask_b32_dpp v108, v96, v92, vcc quad_perm:[1,0,3,2] row_mask:0xf bank_mask:0xf
v_smfmac_f32_16x16x64_bf16 v[16:19], a[44:47], v[52:59], v143
s_waitcnt lgkmcnt(8)
ds_read_b128 v[60:63], v0 offset:4096
v_cndmask_b32_dpp v109, v97, v93, vcc quad_perm:[1,0,3,2] row_mask:0xf bank_mask:0xf
v_smfmac_f32_16x16x64_bf16 v[20:23], a[12:15], v[44:51], v139 abid:1
s_cselect_b32 s43, -129920, s5
ds_read_u16 v82, v82
v_cndmask_b32_dpp v110, v98, v94, vcc quad_perm:[1,0,3,2] row_mask:0xf bank_mask:0xf
v_smfmac_f32_16x16x64_bf16 v[20:23], a[48:51], v[52:59], v143 abid:1
s_waitcnt lgkmcnt(8)
ds_read_u16 v84, v84
v_cndmask_b32_dpp v111, v99, v95, vcc quad_perm:[1,0,3,2] row_mask:0xf bank_mask:0xf
v_smfmac_f32_16x16x64_bf16 v[24:27], a[16:19], v[44:51], v140
s_add_u32 s4, s4, s43
ds_read_b128 v[64:67], v1 offset:4096
v_add_u32_sdwa v87, s42, v123 dst_sel:DWORD dst_unused:UNUSED_PAD src0_sel:DWORD src1_sel:WORD_1
v_smfmac_f32_16x16x64_bf16 v[24:27], a[52:55], v[52:59], v144
buffer_store_dwordx4 v[108:111], v4, s[20:23], s46 offen offset:0 sc1
s_mov_b64 vcc, s[82:83]
s_waitcnt lgkmcnt(8)
ds_read_b128 v[68:71], v0 offset:6144
v_cndmask_b32_dpp v96, v92, v96, vcc quad_perm:[1,0,3,2] row_mask:0xf bank_mask:0xf
v_cndmask_b32_dpp v97, v93, v97, vcc quad_perm:[1,0,3,2] row_mask:0xf bank_mask:0xf
v_smfmac_f32_16x16x64_bf16 v[28:31], a[20:23], v[44:51], v140 abid:1
s_add_u32 s41, s41, 1
ds_read_b128 v[72:75], v1 offset:6144
v_cndmask_b32_dpp v98, v94, v98, vcc quad_perm:[1,0,3,2] row_mask:0xf bank_mask:0xf
v_smfmac_f32_16x16x64_bf16 v[28:31], a[56:59], v[52:59], v144 abid:1
s_waitcnt lgkmcnt(9)
ds_read_u16 v83, v83
v_cndmask_b32_dpp v99, v95, v99, vcc quad_perm:[1,0,3,2] row_mask:0xf bank_mask:0xf
v_smfmac_f32_16x16x64_bf16 v[32:35], a[24:27], v[44:51], v141
ds_read_b128 v[114:117], v2 offset:64
v_add_u32_sdwa v88, s42, v124 dst_sel:DWORD dst_unused:UNUSED_PAD src0_sel:DWORD src1_sel:WORD_0
v_smfmac_f32_16x16x64_bf16 v[32:35], a[60:63], v[52:59], v145
s_waitcnt lgkmcnt(10)
ds_read_u16 v85, v85
v_add_u32_sdwa v89, s42, v124 dst_sel:DWORD dst_unused:UNUSED_PAD src0_sel:DWORD src1_sel:WORD_1
v_smfmac_f32_16x16x64_bf16 v[36:39], a[28:31], v[44:51], v141 abid:1
ds_read_u16 v86, v86
v_add_u32_sdwa v90, s42, v125 dst_sel:DWORD dst_unused:UNUSED_PAD src0_sel:DWORD src1_sel:WORD_0
v_smfmac_f32_16x16x64_bf16 v[36:39], a[64:67], v[52:59], v145 abid:1
s_waitcnt lgkmcnt(10)
ds_read_u16 v87, v87
v_add_u32_sdwa v91, s42, v125 dst_sel:DWORD dst_unused:UNUSED_PAD src0_sel:DWORD src1_sel:WORD_1
v_smfmac_f32_16x16x64_bf16 v[40:43], a[32:35], v[44:51], v174
buffer_store_dwordx4 v[96:99], v4, s[20:23], s46 offen offset:1152 sc1
s_mov_b64 vcc, s[80:81]
ds_read_u16 v88, v88
v_cndmask_b32_dpp v92, v104, v100, vcc quad_perm:[1,0,3,2] row_mask:0xf bank_mask:0xf
v_cndmask_b32_dpp v93, v105, v101, vcc quad_perm:[1,0,3,2] row_mask:0xf bank_mask:0xf
v_smfmac_f32_16x16x64_bf16 v[40:43], a[68:71], v[52:59], v174 abid:1
s_waitcnt lgkmcnt(8)
ds_read_u16 v89, v89
v_cndmask_b32_dpp v94, v106, v102, vcc quad_perm:[1,0,3,2] row_mask:0xf bank_mask:0xf
v_smfmac_f32_16x16x64_bf16 v[8:11], a[72:75], v[60:67], v146
s_waitcnt lgkmcnt(7)
ds_read_u16 v90, v90
v_cndmask_b32_dpp v95, v107, v103, vcc quad_perm:[1,0,3,2] row_mask:0xf bank_mask:0xf
v_smfmac_f32_16x16x64_bf16 v[8:11], a[108:111], v[68:75], v150
s_waitcnt lgkmcnt(6)
ds_read_u16 v91, v91
v_smfmac_f32_16x16x64_bf16 v[8:11], v[114:117], v[76:83], v179
ds_read_b128 v[44:47], v0 offset:8192
v_smfmac_f32_16x16x64_bf16 v[12:15], v[114:117], v[76:83], v179 abid:1
ds_read_b128 v[114:117], v2 offset:128
v_add_u32_sdwa v76, s42, v126 dst_sel:DWORD dst_unused:UNUSED_PAD src0_sel:DWORD src1_sel:WORD_0
v_smfmac_f32_16x16x64_bf16 v[12:15], a[76:79], v[60:67], v146 abid:1
ds_read_u16 v76, v76
v_add_u32_sdwa v77, s42, v126 dst_sel:DWORD dst_unused:UNUSED_PAD src0_sel:DWORD src1_sel:WORD_1
v_smfmac_f32_16x16x64_bf16 v[12:15], a[112:115], v[68:75], v150 abid:1
buffer_store_dwordx4 v[92:95], v4, s[20:23], s46 offen offset:128 sc1
s_mov_b64 vcc, s[82:83]
ds_read_u16 v77, v77
v_cndmask_b32_dpp v104, v100, v104, vcc quad_perm:[1,0,3,2] row_mask:0xf bank_mask:0xf
v_add_u32_sdwa v78, s42, v127 dst_sel:DWORD dst_unused:UNUSED_PAD src0_sel:DWORD src1_sel:WORD_0
v_smfmac_f32_16x16x64_bf16 v[24:27], a[88:91], v[60:67], v148
ds_read_u16 v78, v78
v_cndmask_b32_dpp v105, v101, v105, vcc quad_perm:[1,0,3,2] row_mask:0xf bank_mask:0xf
v_smfmac_f32_16x16x64_bf16 v[24:27], a[124:127], v[68:75], v152
ds_read_b128 v[48:51], v1 offset:8192
v_cndmask_b32_dpp v106, v102, v106, vcc quad_perm:[1,0,3,2] row_mask:0xf bank_mask:0xf
v_smfmac_f32_16x16x64_bf16 v[28:31], a[92:95], v[60:67], v148 abid:1
ds_read_b128 v[52:55], v0 offset:10240
v_add_u32_sdwa v79, s42, v127 dst_sel:DWORD dst_unused:UNUSED_PAD src0_sel:DWORD src1_sel:WORD_1
v_smfmac_f32_16x16x64_bf16 v[28:31], a[128:131], v[68:75], v152 abid:1
ds_read_u16 v79, v79
v_cndmask_b32_dpp v107, v103, v107, vcc quad_perm:[1,0,3,2] row_mask:0xf bank_mask:0xf
v_smfmac_f32_16x16x64_bf16 v[32:35], a[96:99], v[60:67], v149
ds_read_b128 v[56:59], v1 offset:10240
v_add_u32_sdwa v80, s42, v128 dst_sel:DWORD dst_unused:UNUSED_PAD src0_sel:DWORD src1_sel:WORD_0
v_smfmac_f32_16x16x64_bf16 v[32:35], a[132:135], v[68:75], v153
ds_read_u16 v80, v80
v_add_u32_sdwa v81, s42, v128 dst_sel:DWORD dst_unused:UNUSED_PAD src0_sel:DWORD src1_sel:WORD_1
v_smfmac_f32_16x16x64_bf16 v[16:19], a[80:83], v[60:67], v147
buffer_store_dwordx4 v[104:107], v4, s[20:23], s46 offen offset:1280 sc1
s_mov_b64 vcc, s[80:81]
ds_read_b128 v[92:95], v0 offset:12288
v_add_u32_sdwa v82, s42, v129 dst_sel:DWORD dst_unused:UNUSED_PAD src0_sel:DWORD src1_sel:WORD_0
v_add_u32_sdwa v83, s42, v129 dst_sel:DWORD dst_unused:UNUSED_PAD src0_sel:DWORD src1_sel:WORD_1
v_smfmac_f32_16x16x64_bf16 v[16:19], a[116:119], v[68:75], v151
s_waitcnt lgkmcnt(9)
ds_read_u16 v81, v81
v_add_u32_sdwa v100, s42, v130 dst_sel:DWORD dst_unused:UNUSED_PAD src0_sel:DWORD src1_sel:WORD_0
v_smfmac_f32_16x16x64_bf16 v[16:19], v[114:117], v[84:91], v180 abid:1
s_mov_b32 s66, s46
ds_read_b128 v[96:99], v1 offset:12288
v_add_u32_sdwa v101, s42, v130 dst_sel:DWORD dst_unused:UNUSED_PAD src0_sel:DWORD src1_sel:WORD_1
v_smfmac_f32_16x16x64_bf16 v[20:23], v[114:117], v[84:91], v181
s_mov_b32 s46, s48
ds_read_u16 v100, v100
v_add_u32_sdwa v102, s42, v131 dst_sel:DWORD dst_unused:UNUSED_PAD src0_sel:DWORD src1_sel:WORD_0
v_smfmac_f32_16x16x64_bf16 v[20:23], a[84:87], v[60:67], v147 abid:1
s_mov_b32 s48, s49
ds_read_u16 v82, v82
v_add_u32_sdwa v103, s42, v131 dst_sel:DWORD dst_unused:UNUSED_PAD src0_sel:DWORD src1_sel:WORD_1
v_smfmac_f32_16x16x64_bf16 v[20:23], a[120:123], v[68:75], v151 abid:1
s_mov_b32 s49, s50
ds_read_u16 v101, v101
v_add_u32_sdwa v104, s42, v132 dst_sel:DWORD dst_unused:UNUSED_PAD src0_sel:DWORD src1_sel:WORD_0
v_smfmac_f32_16x16x64_bf16 v[36:39], a[100:103], v[60:67], v149 abid:1
s_add_u32 s50, s50, 4718592
ds_read_u16 v83, v83
v_add_u32_sdwa v105, s42, v132 dst_sel:DWORD dst_unused:UNUSED_PAD src0_sel:DWORD src1_sel:WORD_1
v_smfmac_f32_16x16x64_bf16 v[36:39], a[136:139], v[68:75], v153 abid:1
ds_read_b128 v[114:117], v2 offset:192
v_add_u32_sdwa v106, s42, v133 dst_sel:DWORD dst_unused:UNUSED_PAD src0_sel:DWORD src1_sel:WORD_0
v_smfmac_f32_16x16x64_bf16 v[40:43], a[104:107], v[60:67], v175
ds_read_u16 v102, v102
v_add_u32_sdwa v107, s42, v133 dst_sel:DWORD dst_unused:UNUSED_PAD src0_sel:DWORD src1_sel:WORD_1
v_smfmac_f32_16x16x64_bf16 v[40:43], a[140:143], v[68:75], v175 abid:1
s_waitcnt lgkmcnt(13)
ds_read_u16 v103, v103
v_add_u32_sdwa v84, s42, v134 dst_sel:DWORD dst_unused:UNUSED_PAD src0_sel:DWORD src1_sel:WORD_0
v_smfmac_f32_16x16x64_bf16 v[8:11], a[144:147], v[44:51], v154
s_waitcnt lgkmcnt(11)
ds_read_u16 v104, v104
v_add_u32_sdwa v85, s42, v134 dst_sel:DWORD dst_unused:UNUSED_PAD src0_sel:DWORD src1_sel:WORD_1
v_smfmac_f32_16x16x64_bf16 v[8:11], a[180:183], v[52:59], v158
s_waitcnt lgkmcnt(8)
ds_read_u16 v105, v105
v_add_u32_sdwa v86, s42, v135 dst_sel:DWORD dst_unused:UNUSED_PAD src0_sel:DWORD src1_sel:WORD_0
v_smfmac_f32_16x16x64_bf16 v[8:11], a[216:219], v[92:99], v162
ds_read_u16 v106, v106
v_add_u32_sdwa v87, s42, v135 dst_sel:DWORD dst_unused:UNUSED_PAD src0_sel:DWORD src1_sel:WORD_1
v_smfmac_f32_16x16x64_bf16 v[24:27], a[160:163], v[44:51], v156
ds_read_u16 v107, v107
v_add_u32_sdwa v88, s42, v136 dst_sel:DWORD dst_unused:UNUSED_PAD src0_sel:DWORD src1_sel:WORD_0
v_smfmac_f32_16x16x64_bf16 v[24:27], a[196:199], v[52:59], v160
v_add_u32_sdwa v89, s42, v136 dst_sel:DWORD dst_unused:UNUSED_PAD src0_sel:DWORD src1_sel:WORD_1
v_smfmac_f32_16x16x64_bf16 v[24:27], a[232:235], v[92:99], v164
s_waitcnt lgkmcnt(6)
ds_read_u16 v84, v84
v_add_u32_sdwa v90, s42, v137 dst_sel:DWORD dst_unused:UNUSED_PAD src0_sel:DWORD src1_sel:WORD_0
v_smfmac_f32_16x16x64_bf16 v[24:27], v[114:117], v[76:83], v182
ds_read_u16 v85, v85
v_add_u32_sdwa v91, s42, v137 dst_sel:DWORD dst_unused:UNUSED_PAD src0_sel:DWORD src1_sel:WORD_1
v_smfmac_f32_16x16x64_bf16 v[28:31], v[114:117], v[76:83], v182 abid:1
ds_read_b128 v[114:117], v2 offset:256
v_add_u32_sdwa v76, s4, v118 dst_sel:DWORD dst_unused:UNUSED_PAD src0_sel:DWORD src1_sel:WORD_0
v_smfmac_f32_16x16x64_bf16 v[28:31], a[164:167], v[44:51], v156 abid:1
ds_read_u16 v86, v86
v_add_u32_sdwa v77, s4, v118 dst_sel:DWORD dst_unused:UNUSED_PAD src0_sel:DWORD src1_sel:WORD_1
v_smfmac_f32_16x16x64_bf16 v[28:31], a[200:203], v[52:59], v160 abid:1
ds_read_u16 v87, v87
v_add_u32_sdwa v78, s4, v119 dst_sel:DWORD dst_unused:UNUSED_PAD src0_sel:DWORD src1_sel:WORD_0
v_smfmac_f32_16x16x64_bf16 v[28:31], a[236:239], v[92:99], v164 abid:1
ds_read_u16 v88, v88
v_add_u32_sdwa v79, s4, v119 dst_sel:DWORD dst_unused:UNUSED_PAD src0_sel:DWORD src1_sel:WORD_1
v_smfmac_f32_16x16x64_bf16 v[12:15], a[148:151], v[44:51], v154 abid:1
ds_read_b128 v[60:63], v0 offset:14336
v_add_u32_sdwa v80, s4, v120 dst_sel:DWORD dst_unused:UNUSED_PAD src0_sel:DWORD src1_sel:WORD_0
v_smfmac_f32_16x16x64_bf16 v[12:15], a[184:187], v[52:59], v158 abid:1
v_add_u32_sdwa v81, s4, v120 dst_sel:DWORD dst_unused:UNUSED_PAD src0_sel:DWORD src1_sel:WORD_1
v_smfmac_f32_16x16x64_bf16 v[12:15], a[220:223], v[92:99], v162 abid:1
ds_read_u16 v89, v89
v_add_u32_sdwa v82, s4, v121 dst_sel:DWORD dst_unused:UNUSED_PAD src0_sel:DWORD src1_sel:WORD_0
v_smfmac_f32_16x16x64_bf16 v[32:35], a[168:171], v[44:51], v157
ds_read_b128 v[64:67], v1 offset:14336
v_add_u32_sdwa v83, s4, v121 dst_sel:DWORD dst_unused:UNUSED_PAD src0_sel:DWORD src1_sel:WORD_1
v_smfmac_f32_16x16x64_bf16 v[32:35], a[204:207], v[52:59], v161
ds_read_b128 v[68:71], v0 offset:16384
v_smfmac_f32_16x16x64_bf16 v[32:35], a[240:243], v[92:99], v165
s_waitcnt lgkmcnt(7)
ds_read_u16 v90, v90
v_smfmac_f32_16x16x64_bf16 v[32:35], v[114:117], v[100:107], v183 abid:1
ds_read_b128 v[72:75], v1 offset:16384
v_add_u32 v0, s43, v0
v_smfmac_f32_16x16x64_bf16 v[36:39], v[114:117], v[100:107], v184
ds_read_u16 v91, v91
v_add_u32 v1, s43, v1
v_smfmac_f32_16x16x64_bf16 v[36:39], a[172:175], v[44:51], v157 abid:1
ds_read_b128 v[114:117], v2 offset:320
v_smfmac_f32_16x16x64_bf16 v[36:39], a[208:211], v[52:59], v161 abid:1
v_smfmac_f32_16x16x64_bf16 v[36:39], a[244:247], v[92:99], v165 abid:1
ds_write_b64 v254, v[112:113]
v_xor_b32 v254, 512, v254
v_smfmac_f32_16x16x64_bf16 v[16:19], a[152:155], v[44:51], v155
v_smfmac_f32_16x16x64_bf16 v[16:19], a[188:191], v[52:59], v159
v_smfmac_f32_16x16x64_bf16 v[16:19], a[224:227], v[92:99], v163
v_smfmac_f32_16x16x64_bf16 v[20:23], a[156:159], v[44:51], v155 abid:1
v_smfmac_f32_16x16x64_bf16 v[20:23], a[192:195], v[52:59], v159 abid:1
v_smfmac_f32_16x16x64_bf16 v[20:23], a[228:231], v[92:99], v163 abid:1
v_smfmac_f32_16x16x64_bf16 v[40:43], a[176:179], v[44:51], v176
s_bitcmp1_b32 s92, s41
v_smfmac_f32_16x16x64_bf16 v[40:43], a[212:215], v[52:59], v176 abid:1
s_cbranch_scc1 L_loopn_w
L_loopn_wb:
v_smfmac_f32_16x16x64_bf16 v[40:43], a[248:251], v[92:99], v177
s_waitcnt lgkmcnt(0)
v_smfmac_f32_16x16x64_bf16 v[40:43], v[114:117], v[84:91], v185
s_waitcnt vmcnt(20)
s_barrier
L_loopn_p3:
v_smfmac_f32_16x16x64_bf16 v[8:11], a[252:255], v[60:67], v166
s_mov_b32 s42, s4
ds_read_b64 v[112:113], v6
v_xor_b32 v6, 512, v6
v_smfmac_f32_16x16x64_bf16 v[8:11], v[218:221], v[68:75], v170
v_add_u32_sdwa v84, s42, v122 dst_sel:DWORD dst_unused:UNUSED_PAD src0_sel:DWORD src1_sel:WORD_0
v_smfmac_f32_16x16x64_bf16 v[12:15], v[186:189], v[60:67], v166 abid:1
ds_read_b128 v[44:47], v0 offset:0
v_add_u32_sdwa v85, s42, v122 dst_sel:DWORD dst_unused:UNUSED_PAD src0_sel:DWORD src1_sel:WORD_1
v_smfmac_f32_16x16x64_bf16 v[12:15], v[222:225], v[68:75], v170 abid:1
ds_read_b128 v[48:51], v1 offset:0
v_add_u32_sdwa v86, s42, v123 dst_sel:DWORD dst_unused:UNUSED_PAD src0_sel:DWORD src1_sel:WORD_0
v_smfmac_f32_16x16x64_bf16 v[16:19], v[190:193], v[60:67], v167
ds_read_b128 v[52:55], v0 offset:2048
v_cvt_pk_bf16_f32 v92, v8, v9
v_smfmac_f32_16x16x64_bf16 v[16:19], v[226:229], v[68:75], v171
ds_read_b128 v[56:59], v1 offset:2048
v_cvt_pk_bf16_f32 v93, v10, v11
v_smfmac_f32_16x16x64_bf16 v[20:23], v[194:197], v[60:67], v167 abid:1
ds_read_b128 v[8:11], v2 offset:1024
v_cvt_pk_bf16_f32 v94, v12, v13
v_smfmac_f32_16x16x64_bf16 v[20:23], v[230:233], v[68:75], v171 abid:1
ds_read_u16 v76, v76
v_cvt_pk_bf16_f32 v95, v14, v15
v_smfmac_f32_16x16x64_bf16 v[24:27], v[198:201], v[60:67], v168
ds_read_b128 v[12:15], v2 offset:1088
v_cvt_pk_bf16_f32 v96, v16, v17
v_smfmac_f32_16x16x64_bf16 v[24:27], v[234:237], v[68:75], v172
s_waitcnt lgkmcnt(7)
ds_read_u16 v77, v77
v_cvt_pk_bf16_f32 v97, v18, v19
v_smfmac_f32_16x16x64_bf16 v[28:31], v[202:205], v[60:67], v168 abid:1
buffer_store_dwordx2 v[112:113], v5, s[20:23], s66 offen sc1
ds_read_b128 v[16:19], v2 offset:1152
v_cvt_pk_bf16_f32 v98, v20, v21
v_smfmac_f32_16x16x64_bf16 v[28:31], v[238:241], v[68:75], v172 abid:1
ds_read_u16 v78, v78
v_cvt_pk_bf16_f32 v99, v22, v23
v_smfmac_f32_16x16x64_bf16 v[32:35], v[206:209], v[60:67], v169
ds_read_b128 v[20:23], v2 offset:1216
v_cvt_pk_bf16_f32 v100, v24, v25
v_smfmac_f32_16x16x64_bf16 v[32:35], v[242:245], v[68:75], v173
ds_read_u16 v79, v79
v_cvt_pk_bf16_f32 v101, v26, v27
v_smfmac_f32_16x16x64_bf16 v[36:39], v[210:213], v[60:67], v169 abid:1
ds_read_b128 v[24:27], v2 offset:1280
v_cvt_pk_bf16_f32 v102, v28, v29
v_smfmac_f32_16x16x64_bf16 v[36:39], v[246:249], v[68:75], v173 abid:1
ds_read_u16 v80, v80
v_cvt_pk_bf16_f32 v103, v30, v31
v_smfmac_f32_16x16x64_bf16 v[40:43], v[214:217], v[60:67], v177 abid:1
s_bitcmp1_b32 s12, s41
ds_read_b128 v[28:31], v2 offset:1344
v_cvt_pk_bf16_f32 v104, v32, v33
v_smfmac_f32_16x16x64_bf16 v[40:43], v[250:253], v[68:75], v178
s_waitcnt lgkmcnt(10)
v_cvt_pk_bf16_f32 v105, v34, v35
s_cbranch_scc1 L_loopn
s_cmp_eq_u32 s41, s59
s_cbranch_scc1 L_loopc
s_cmp_lt_u32 s41, s15
s_cbranch_scc1 L_loop
s_nop 0
v_cndmask_b32_dpp v108, v96, v92, vcc quad_perm:[1,0,3,2] row_mask:0xf bank_mask:0xf
v_cndmask_b32_dpp v109, v97, v93, vcc quad_perm:[1,0,3,2] row_mask:0xf bank_mask:0xf
v_cndmask_b32_dpp v110, v98, v94, vcc quad_perm:[1,0,3,2] row_mask:0xf bank_mask:0xf
v_cndmask_b32_dpp v111, v99, v95, vcc quad_perm:[1,0,3,2] row_mask:0xf bank_mask:0xf
buffer_store_dwordx4 v[108:111], v4, s[20:23], s46 offen offset:0 sc1
s_mov_b64 vcc, s[82:83]
v_cvt_pk_bf16_f32 v112, v40, v41
v_cvt_pk_bf16_f32 v113, v42, v43
ds_write_b64 v254, v[112:113]
v_cndmask_b32_dpp v96, v92, v96, vcc quad_perm:[1,0,3,2] row_mask:0xf bank_mask:0xf
v_cndmask_b32_dpp v97, v93, v97, vcc quad_perm:[1,0,3,2] row_mask:0xf bank_mask:0xf
v_cndmask_b32_dpp v98, v94, v98, vcc quad_perm:[1,0,3,2] row_mask:0xf bank_mask:0xf
v_cndmask_b32_dpp v99, v95, v99, vcc quad_perm:[1,0,3,2] row_mask:0xf bank_mask:0xf
buffer_store_dwordx4 v[96:99], v4, s[20:23], s46 offen offset:1152 sc1
s_mov_b64 vcc, s[80:81]
v_cvt_pk_bf16_f32 v106, v36, v37
v_cvt_pk_bf16_f32 v107, v38, v39
s_waitcnt lgkmcnt(0)
s_barrier
ds_read_b64 v[112:113], v6
v_cndmask_b32_dpp v92, v104, v100, vcc quad_perm:[1,0,3,2] row_mask:0xf bank_mask:0xf
v_cndmask_b32_dpp v93, v105, v101, vcc quad_perm:[1,0,3,2] row_mask:0xf bank_mask:0xf
v_cndmask_b32_dpp v94, v106, v102, vcc quad_perm:[1,0,3,2] row_mask:0xf bank_mask:0xf
v_cndmask_b32_dpp v95, v107, v103, vcc quad_perm:[1,0,3,2] row_mask:0xf bank_mask:0xf
buffer_store_dwordx4 v[92:95], v4, s[20:23], s46 offen offset:128 sc1
s_mov_b64 vcc, s[82:83]
v_cndmask_b32_dpp v104, v100, v104, vcc quad_perm:[1,0,3,2] row_mask:0xf bank_mask:0xf
v_cndmask_b32_dpp v105, v101, v105, vcc quad_perm:[1,0,3,2] row_mask:0xf bank_mask:0xf
v_cndmask_b32_dpp v106, v102, v106, vcc quad_perm:[1,0,3,2] row_mask:0xf bank_mask:0xf
v_cndmask_b32_dpp v107, v103, v107, vcc quad_perm:[1,0,3,2] row_mask:0xf bank_mask:0xf
buffer_store_dwordx4 v[104:107], v4, s[20:23], s46 offen offset:1280 sc1
s_mov_b64 vcc, s[80:81]
s_waitcnt lgkmcnt(0)
buffer_store_dwordx2 v[112:113], v5, s[20:23], s46 offen sc1
L_fin:
L_end_standalone__structured_sparse_n_m__ragged_kernel:
s_endpgm
L_more1:
v_and_b32 v73, v94, v16
v_lshrrev_b32 v72, 10, v16
v_cmp_eq_u32 s[64:65], v73, v95
v_and_or_b32 v32, v72, v96, v97
s_mov_b64 exec, s[64:65]
ds_add_rtn_u32 v48, v32, v88
s_mov_b64 exec, -1
v_and_b32 v73, v94, v17
v_lshrrev_b32 v72, 10, v17
v_cmp_eq_u32 s[66:67], v73, v95
v_and_or_b32 v33, v72, v96, v97
s_mov_b64 exec, s[66:67]
ds_add_rtn_u32 v49, v33, v88
s_mov_b64 exec, -1
v_and_b32 v73, v94, v18
v_lshrrev_b32 v72, 10, v18
v_cmp_eq_u32 s[68:69], v73, v95
v_and_or_b32 v34, v72, v96, v97
s_mov_b64 exec, s[68:69]
ds_add_rtn_u32 v50, v34, v88
s_mov_b64 exec, -1
v_and_b32 v73, v94, v19
v_lshrrev_b32 v72, 10, v19
v_cmp_eq_u32 s[70:71], v73, v95
v_and_or_b32 v35, v72, v96, v97
s_mov_b64 exec, s[70:71]
ds_add_rtn_u32 v51, v35, v88
s_mov_b64 exec, -1
v_and_b32 v73, v94, v20
v_lshrrev_b32 v72, 10, v20
v_cmp_eq_u32 s[72:73], v73, v95
v_and_or_b32 v36, v72, v96, v97
s_mov_b64 exec, s[72:73]
ds_add_rtn_u32 v52, v36, v88
s_mov_b64 exec, -1
v_and_b32 v73, v94, v21
v_lshrrev_b32 v72, 10, v21
v_cmp_eq_u32 s[74:75], v73, v95
v_and_or_b32 v37, v72, v96, v97
s_mov_b64 exec, s[74:75]
ds_add_rtn_u32 v53, v37, v88
s_mov_b64 exec, -1
v_and_b32 v73, v94, v22
v_lshrrev_b32 v72, 10, v22
v_cmp_eq_u32 s[76:77], v73, v95
v_and_or_b32 v38, v72, v96, v97
s_mov_b64 exec, s[76:77]
ds_add_rtn_u32 v54, v38, v88
s_mov_b64 exec, -1
s_branch L_more1b
L_greedy:
s_mov_b32 s47, 0
s_mov_b32 s89, 1
v_readlane_b32 s3, v72, 0
s_max_u32 s47, s47, 0
v_writelane_b32 v91, s47, 0
s_nop 1
s_add_u32 s47, s47, s3
s_cmp_gt_u32 s47, 32
s_cselect_b32 s90, 1, s90
v_readlane_b32 s3, v72, 1
s_max_u32 s47, s47, 0
v_writelane_b32 v91, s47, 1
s_nop 1
s_add_u32 s47, s47, s3
s_cmp_gt_u32 s47, 64
s_cselect_b32 s90, 1, s90
v_readlane_b32 s3, v72, 2
s_max_u32 s47, s47, 32
v_writelane_b32 v91, s47, 2
s_nop 1
s_add_u32 s47, s47, s3
s_cmp_gt_u32 s47, 64
s_cselect_b32 s90, 1, s90
v_readlane_b32 s3, v72, 3
s_max_u32 s47, s47, 32
v_writelane_b32 v91, s47, 3
s_nop 1
s_add_u32 s47, s47, s3
s_cmp_gt_u32 s47, 96
s_cselect_b32 s90, 1, s90
v_readlane_b32 s3, v72, 4
s_max_u32 s47, s47, 64
v_writelane_b32 v91, s47, 4
s_nop 1
s_add_u32 s47, s47, s3
s_cmp_gt_u32 s47, 96
s_cselect_b32 s90, 1, s90
v_readlane_b32 s3, v72, 5
s_max_u32 s47, s47, 64
v_writelane_b32 v91, s47, 5
s_nop 1
s_add_u32 s47, s47, s3
s_cmp_gt_u32 s47, 128
s_cselect_b32 s90, 1, s90
v_readlane_b32 s3, v72, 6
s_max_u32 s47, s47, 96
v_writelane_b32 v91, s47, 6
s_nop 1
s_add_u32 s47, s47, s3
s_cmp_gt_u32 s47, 128
s_cselect_b32 s90, 1, s90
v_readlane_b32 s3, v72, 7
s_max_u32 s47, s47, 96
v_writelane_b32 v91, s47, 7
s_nop 1
s_add_u32 s47, s47, s3
s_cmp_gt_u32 s47, 160
s_cselect_b32 s90, 1, s90
v_readlane_b32 s3, v72, 8
s_max_u32 s47, s47, 128
v_writelane_b32 v91, s47, 8
s_nop 1
s_add_u32 s47, s47, s3
s_cmp_gt_u32 s47, 160
s_cselect_b32 s90, 1, s90
s_cmp_lg_u32 s90, 0
s_cselect_b64 s[90:91], -1, 0
v_mov_b32 v73, 163072
s_mov_b64 exec, s[90:91]
ds_write_b32 v73, v88
s_mov_b64 exec, -1
s_branch L_greedyb
L_more2:
ds_bpermute_b32 v64, v32, v91
ds_bpermute_b32 v65, v33, v91
ds_bpermute_b32 v66, v34, v91
ds_bpermute_b32 v67, v35, v91
ds_bpermute_b32 v68, v36, v91
ds_bpermute_b32 v69, v37, v91
ds_bpermute_b32 v70, v38, v91
s_waitcnt lgkmcnt(0)
v_add_u32 v73, v48, v64
v_and_b32 v72, 0x87e, v16
v_lshl_add_u32 v73, v73, 1, s93
v_add_u32 v72, v90, v72
s_andn2_b64 exec, s[64:65], s[90:91]
ds_write_b16_d16_hi v73, v16 offset:64
ds_write_b16 v73, v72 offset:384
ds_write_b16 v73, v16 offset:704
s_mov_b64 exec, -1
v_add_u32 v73, v49, v65
v_and_b32 v72, 0x87e, v17
v_lshl_add_u32 v73, v73, 1, s93
v_add_u32 v72, v90, v72
s_andn2_b64 exec, s[66:67], s[90:91]
ds_write_b16_d16_hi v73, v17 offset:64
ds_write_b16 v73, v72 offset:384
ds_write_b16 v73, v17 offset:704
s_mov_b64 exec, -1
v_add_u32 v73, v50, v66
v_and_b32 v72, 0x87e, v18
v_lshl_add_u32 v73, v73, 1, s93
v_add_u32 v72, v90, v72
s_andn2_b64 exec, s[68:69], s[90:91]
ds_write_b16_d16_hi v73, v18 offset:64
ds_write_b16 v73, v72 offset:384
ds_write_b16 v73, v18 offset:704
s_mov_b64 exec, -1
v_add_u32 v73, v51, v67
v_and_b32 v72, 0x87e, v19
v_lshl_add_u32 v73, v73, 1, s93
v_add_u32 v72, v90, v72
s_andn2_b64 exec, s[70:71], s[90:91]
ds_write_b16_d16_hi v73, v19 offset:64
ds_write_b16 v73, v72 offset:384
ds_write_b16 v73, v19 offset:704
s_mov_b64 exec, -1
v_add_u32 v73, v52, v68
v_and_b32 v72, 0x87e, v20
v_lshl_add_u32 v73, v73, 1, s93
v_add_u32 v72, v90, v72
s_andn2_b64 exec, s[72:73], s[90:91]
ds_write_b16_d16_hi v73, v20 offset:64
ds_write_b16 v73, v72 offset:384
ds_write_b16 v73, v20 offset:704
s_mov_b64 exec, -1
v_add_u32 v73, v53, v69
v_and_b32 v72, 0x87e, v21
v_lshl_add_u32 v73, v73, 1, s93
v_add_u32 v72, v90, v72
s_andn2_b64 exec, s[74:75], s[90:91]
ds_write_b16_d16_hi v73, v21 offset:64
ds_write_b16 v73, v72 offset:384
ds_write_b16 v73, v21 offset:704
s_mov_b64 exec, -1
v_add_u32 v73, v54, v70
v_and_b32 v72, 0x87e, v22
v_lshl_add_u32 v73, v73, 1, s93
v_add_u32 v72, v90, v72
s_andn2_b64 exec, s[76:77], s[90:91]
ds_write_b16_d16_hi v73, v22 offset:64
ds_write_b16 v73, v72 offset:384
ds_write_b16 v73, v22 offset:704
s_mov_b64 exec, -1
s_branch L_more2b
L_cwait:
buffer_load_dword v8, off, s[36:39], 0 sc1
s_sub_u32 s3, s3, 1
s_cbranch_scc1 L_giveup
s_waitcnt vmcnt(0)
v_readfirstlane_b32 s47, v8
s_nop 3
s_cmp_lg_u32 s47, 1
s_cbranch_scc1 L_cwait
s_branch L_poll
L_giveup:
s_waitcnt vmcnt(0)
v_mov_b32 v8, 163072
v_mov_b32 v9, 1
ds_write_b32 v8, v9
s_branch L_polled
L_loop_w:
s_bitcmp1_b32 s87, s41
s_waitcnt vmcnt(15)
s_cbranch_scc0 L_loop_wb
s_waitcnt vmcnt(10)
s_branch L_loop_wb
L_loopn_w:
s_bitcmp1_b32 s87, s41
s_waitcnt vmcnt(15)
s_cbranch_scc0 L_loopn_wb
s_waitcnt vmcnt(10)
s_branch L_loopn_wb
L_linked:
.p2align 6
L_loopk:
v_smfmac_f32_16x16x64_bf16 v[8:11], a[0:3], v[44:51], v138
ds_read_b128 v[32:35], v2 offset:1408
v_cvt_pk_bf16_f32 v106, v36, v37
v_smfmac_f32_16x16x64_bf16 v[8:11], a[36:39], v[52:59], v142
s_waitcnt lgkmcnt(9)
v_cvt_pk_bf16_f32 v107, v38, v39
v_smfmac_f32_16x16x64_bf16 v[12:15], a[4:7], v[44:51], v138 abid:1
ds_read_b128 v[36:39], v2 offset:1472
v_cvt_pk_bf16_f32 v112, v40, v41
v_smfmac_f32_16x16x64_bf16 v[12:15], a[40:43], v[52:59], v142 abid:1
s_waitcnt lgkmcnt(8)
ds_read_u16 v81, v81
v_cvt_pk_bf16_f32 v113, v42, v43
v_smfmac_f32_16x16x64_bf16 v[16:19], a[8:11], v[44:51], v139
s_cmp_eq_u32 s4, 129920
ds_read_b128 v[40:43], v2 offset:1536
v_cndmask_b32_dpp v108, v96, v92, vcc quad_perm:[1,0,3,2] row_mask:0xf bank_mask:0xf
v_smfmac_f32_16x16x64_bf16 v[16:19], a[44:47], v[52:59], v143
s_waitcnt lgkmcnt(8)
ds_read_b128 v[60:63], v0 offset:4096
v_cndmask_b32_dpp v109, v97, v93, vcc quad_perm:[1,0,3,2] row_mask:0xf bank_mask:0xf
v_smfmac_f32_16x16x64_bf16 v[20:23], a[12:15], v[44:51], v139 abid:1
s_cselect_b32 s43, -129920, s5
ds_read_u16 v82, v82
v_cndmask_b32_dpp v110, v98, v94, vcc quad_perm:[1,0,3,2] row_mask:0xf bank_mask:0xf
v_smfmac_f32_16x16x64_bf16 v[20:23], a[48:51], v[52:59], v143 abid:1
s_waitcnt lgkmcnt(8)
ds_read_u16 v84, v84
v_cndmask_b32_dpp v111, v99, v95, vcc quad_perm:[1,0,3,2] row_mask:0xf bank_mask:0xf
v_smfmac_f32_16x16x64_bf16 v[24:27], a[16:19], v[44:51], v140
s_add_u32 s4, s4, s43
ds_read_b128 v[64:67], v1 offset:4096
v_add_u32_sdwa v87, s42, v123 dst_sel:DWORD dst_unused:UNUSED_PAD src0_sel:DWORD src1_sel:WORD_1
v_smfmac_f32_16x16x64_bf16 v[24:27], a[52:55], v[52:59], v144
buffer_store_dwordx4 v[108:111], v4, s[20:23], s46 offen offset:0 sc1
s_mov_b64 vcc, s[82:83]
s_waitcnt lgkmcnt(8)
ds_read_b128 v[68:71], v0 offset:6144
v_cndmask_b32_dpp v96, v92, v96, vcc quad_perm:[1,0,3,2] row_mask:0xf bank_mask:0xf
v_cndmask_b32_dpp v97, v93, v97, vcc quad_perm:[1,0,3,2] row_mask:0xf bank_mask:0xf
v_smfmac_f32_16x16x64_bf16 v[28:31], a[20:23], v[44:51], v140 abid:1
s_add_u32 s41, s41, 1
ds_read_b128 v[72:75], v1 offset:6144
v_cndmask_b32_dpp v98, v94, v98, vcc quad_perm:[1,0,3,2] row_mask:0xf bank_mask:0xf
v_smfmac_f32_16x16x64_bf16 v[28:31], a[56:59], v[52:59], v144 abid:1
s_waitcnt lgkmcnt(9)
ds_read_u16 v83, v83
v_cndmask_b32_dpp v99, v95, v99, vcc quad_perm:[1,0,3,2] row_mask:0xf bank_mask:0xf
v_smfmac_f32_16x16x64_bf16 v[32:35], a[24:27], v[44:51], v141
ds_read_b128 v[114:117], v2 offset:64
v_add_u32_sdwa v88, s42, v124 dst_sel:DWORD dst_unused:UNUSED_PAD src0_sel:DWORD src1_sel:WORD_0
v_smfmac_f32_16x16x64_bf16 v[32:35], a[60:63], v[52:59], v145
s_waitcnt lgkmcnt(10)
ds_read_u16 v85, v85
v_add_u32_sdwa v89, s42, v124 dst_sel:DWORD dst_unused:UNUSED_PAD src0_sel:DWORD src1_sel:WORD_1
v_smfmac_f32_16x16x64_bf16 v[36:39], a[28:31], v[44:51], v141 abid:1
ds_read_u16 v86, v86
v_add_u32_sdwa v90, s42, v125 dst_sel:DWORD dst_unused:UNUSED_PAD src0_sel:DWORD src1_sel:WORD_0
v_smfmac_f32_16x16x64_bf16 v[36:39], a[64:67], v[52:59], v145 abid:1
s_waitcnt lgkmcnt(10)
ds_read_u16 v87, v87
v_add_u32_sdwa v91, s42, v125 dst_sel:DWORD dst_unused:UNUSED_PAD src0_sel:DWORD src1_sel:WORD_1
v_smfmac_f32_16x16x64_bf16 v[40:43], a[32:35], v[44:51], v174
buffer_store_dwordx4 v[96:99], v4, s[20:23], s46 offen offset:1152 sc1
s_mov_b64 vcc, s[80:81]
ds_read_u16 v88, v88
v_cndmask_b32_dpp v92, v104, v100, vcc quad_perm:[1,0,3,2] row_mask:0xf bank_mask:0xf
v_cndmask_b32_dpp v93, v105, v101, vcc quad_perm:[1,0,3,2] row_mask:0xf bank_mask:0xf
v_smfmac_f32_16x16x64_bf16 v[40:43], a[68:71], v[52:59], v174 abid:1
s_waitcnt lgkmcnt(8)
ds_read_u16 v89, v89
v_cndmask_b32_dpp v94, v106, v102, vcc quad_perm:[1,0,3,2] row_mask:0xf bank_mask:0xf
v_smfmac_f32_16x16x64_bf16 v[8:11], a[72:75], v[60:67], v146
s_waitcnt lgkmcnt(7)
ds_read_u16 v90, v90
v_cndmask_b32_dpp v95, v107, v103, vcc quad_perm:[1,0,3,2] row_mask:0xf bank_mask:0xf
v_smfmac_f32_16x16x64_bf16 v[8:11], a[108:111], v[68:75], v150
s_waitcnt lgkmcnt(6)
ds_read_u16 v91, v91
v_smfmac_f32_16x16x64_bf16 v[8:11], v[114:117], v[76:83], v179
ds_read_b128 v[44:47], v0 offset:8192
v_smfmac_f32_16x16x64_bf16 v[12:15], v[114:117], v[76:83], v179 abid:1
ds_read_b128 v[114:117], v2 offset:128
v_add_u32_sdwa v76, s42, v126 dst_sel:DWORD dst_unused:UNUSED_PAD src0_sel:DWORD src1_sel:WORD_0
v_smfmac_f32_16x16x64_bf16 v[12:15], a[76:79], v[60:67], v146 abid:1
ds_read_u16 v76, v76
v_add_u32_sdwa v77, s42, v126 dst_sel:DWORD dst_unused:UNUSED_PAD src0_sel:DWORD src1_sel:WORD_1
v_smfmac_f32_16x16x64_bf16 v[12:15], a[112:115], v[68:75], v150 abid:1
buffer_store_dwordx4 v[92:95], v4, s[20:23], s46 offen offset:128 sc1
s_mov_b64 vcc, s[82:83]
ds_read_u16 v77, v77
v_cndmask_b32_dpp v104, v100, v104, vcc quad_perm:[1,0,3,2] row_mask:0xf bank_mask:0xf
v_cndmask_b32_dpp v105, v101, v105, vcc quad_perm:[1,0,3,2] row_mask:0xf bank_mask:0xf
v_smfmac_f32_16x16x64_bf16 v[24:27], a[88:91], v[60:67], v148
ds_read_b128 v[48:51], v1 offset:8192
v_add_u32_sdwa v78, s42, v127 dst_sel:DWORD dst_unused:UNUSED_PAD src0_sel:DWORD src1_sel:WORD_0
v_smfmac_f32_16x16x64_bf16 v[24:27], a[124:127], v[68:75], v152
ds_read_u16 v78, v78
v_cndmask_b32_dpp v106, v102, v106, vcc quad_perm:[1,0,3,2] row_mask:0xf bank_mask:0xf
v_smfmac_f32_16x16x64_bf16 v[28:31], a[92:95], v[60:67], v148 abid:1
ds_read_b128 v[52:55], v0 offset:10240
v_cndmask_b32_dpp v107, v103, v107, vcc quad_perm:[1,0,3,2] row_mask:0xf bank_mask:0xf
v_smfmac_f32_16x16x64_bf16 v[28:31], a[128:131], v[68:75], v152 abid:1
ds_read_b128 v[56:59], v1 offset:10240
v_add_u32_sdwa v79, s42, v127 dst_sel:DWORD dst_unused:UNUSED_PAD src0_sel:DWORD src1_sel:WORD_1
v_smfmac_f32_16x16x64_bf16 v[32:35], a[96:99], v[60:67], v149
ds_read_u16 v79, v79
v_add_u32_sdwa v80, s42, v128 dst_sel:DWORD dst_unused:UNUSED_PAD src0_sel:DWORD src1_sel:WORD_0
v_smfmac_f32_16x16x64_bf16 v[32:35], a[132:135], v[68:75], v153
ds_read_u16 v80, v80
v_add_u32_sdwa v81, s42, v128 dst_sel:DWORD dst_unused:UNUSED_PAD src0_sel:DWORD src1_sel:WORD_1
v_smfmac_f32_16x16x64_bf16 v[16:19], a[80:83], v[60:67], v147
buffer_store_dwordx4 v[104:107], v4, s[20:23], s46 offen offset:1280 sc1
s_mov_b64 vcc, s[80:81]
ds_read_b128 v[92:95], v0 offset:12288
v_add_u32_sdwa v82, s42, v129 dst_sel:DWORD dst_unused:UNUSED_PAD src0_sel:DWORD src1_sel:WORD_0
v_add_u32_sdwa v83, s42, v129 dst_sel:DWORD dst_unused:UNUSED_PAD src0_sel:DWORD src1_sel:WORD_1
v_smfmac_f32_16x16x64_bf16 v[16:19], a[116:119], v[68:75], v151
s_waitcnt lgkmcnt(9)
ds_read_u16 v81, v81
v_add_u32_sdwa v100, s42, v130 dst_sel:DWORD dst_unused:UNUSED_PAD src0_sel:DWORD src1_sel:WORD_0
v_smfmac_f32_16x16x64_bf16 v[16:19], v[114:117], v[84:91], v180 abid:1
s_waitcnt vmcnt(5)
ds_read_b128 v[96:99], v1 offset:12288
v_add_u32_sdwa v101, s42, v130 dst_sel:DWORD dst_unused:UNUSED_PAD src0_sel:DWORD src1_sel:WORD_1
v_smfmac_f32_16x16x64_bf16 v[12:15], v[114:117], v[84:91], v180
s_mov_b32 s66, s46
ds_read_u16 v82, v82
v_add_u32_sdwa v102, s42, v131 dst_sel:DWORD dst_unused:UNUSED_PAD src0_sel:DWORD src1_sel:WORD_0
v_smfmac_f32_16x16x64_bf16 v[20:23], v[114:117], v[84:91], v181
s_mov_b32 s46, s48
ds_read_u16 v100, v100
v_add_u32_sdwa v103, s42, v131 dst_sel:DWORD dst_unused:UNUSED_PAD src0_sel:DWORD src1_sel:WORD_1
v_smfmac_f32_16x16x64_bf16 v[20:23], a[84:87], v[60:67], v147 abid:1
s_mov_b32 s48, s49
ds_read_u16 v83, v83
v_add_u32_sdwa v104, s42, v132 dst_sel:DWORD dst_unused:UNUSED_PAD src0_sel:DWORD src1_sel:WORD_0
v_smfmac_f32_16x16x64_bf16 v[20:23], a[120:123], v[68:75], v151 abid:1
s_mov_b32 s49, s50
ds_read_b128 v[114:117], v2 offset:192
v_add_u32_sdwa v105, s42, v132 dst_sel:DWORD dst_unused:UNUSED_PAD src0_sel:DWORD src1_sel:WORD_1
v_smfmac_f32_16x16x64_bf16 v[36:39], a[100:103], v[60:67], v149 abid:1
s_add_u32 s50, s50, 4718592
ds_read_u16 v101, v101
v_add_u32_sdwa v106, s42, v133 dst_sel:DWORD dst_unused:UNUSED_PAD src0_sel:DWORD src1_sel:WORD_0
v_smfmac_f32_16x16x64_bf16 v[36:39], a[136:139], v[68:75], v153 abid:1
ds_read_u16 v102, v102
v_add_u32_sdwa v107, s42, v133 dst_sel:DWORD dst_unused:UNUSED_PAD src0_sel:DWORD src1_sel:WORD_1
v_smfmac_f32_16x16x64_bf16 v[40:43], a[104:107], v[60:67], v175
ds_read_u16 v103, v103
v_add_u32_sdwa v84, s42, v134 dst_sel:DWORD dst_unused:UNUSED_PAD src0_sel:DWORD src1_sel:WORD_0
v_smfmac_f32_16x16x64_bf16 v[40:43], a[140:143], v[68:75], v175 abid:1
s_waitcnt lgkmcnt(15)
ds_read_u16 v104, v104
v_add_u32_sdwa v85, s42, v134 dst_sel:DWORD dst_unused:UNUSED_PAD src0_sel:DWORD src1_sel:WORD_1
v_smfmac_f32_16x16x64_bf16 v[8:11], a[144:147], v[44:51], v154
s_waitcnt lgkmcnt(13)
ds_read_u16 v105, v105
v_add_u32_sdwa v86, s42, v135 dst_sel:DWORD dst_unused:UNUSED_PAD src0_sel:DWORD src1_sel:WORD_0
v_smfmac_f32_16x16x64_bf16 v[8:11], a[180:183], v[52:59], v158
s_waitcnt lgkmcnt(9)
ds_read_u16 v106, v106
v_add_u32_sdwa v87, s42, v135 dst_sel:DWORD dst_unused:UNUSED_PAD src0_sel:DWORD src1_sel:WORD_1
v_smfmac_f32_16x16x64_bf16 v[8:11], a[216:219], v[92:99], v162
s_add_u32 m0, s44, 0
ds_read_u16 v107, v107
v_add_u32_sdwa v88, s42, v136 dst_sel:DWORD dst_unused:UNUSED_PAD src0_sel:DWORD src1_sel:WORD_0
v_smfmac_f32_16x16x64_bf16 v[24:27], a[160:163], v[44:51], v156
buffer_load_dwordx4 v3, s[16:19], s45 offen offset:0 nt lds
v_add_u32_sdwa v89, s42, v136 dst_sel:DWORD dst_unused:UNUSED_PAD src0_sel:DWORD src1_sel:WORD_1
v_smfmac_f32_16x16x64_bf16 v[24:27], a[196:199], v[52:59], v160
ds_read_u16 v84, v84
v_add_u32_sdwa v90, s42, v137 dst_sel:DWORD dst_unused:UNUSED_PAD src0_sel:DWORD src1_sel:WORD_0
v_smfmac_f32_16x16x64_bf16 v[24:27], a[232:235], v[92:99], v164
s_waitcnt lgkmcnt(8)
ds_read_u16 v85, v85
v_add_u32_sdwa v91, s42, v137 dst_sel:DWORD dst_unused:UNUSED_PAD src0_sel:DWORD src1_sel:WORD_1
v_smfmac_f32_16x16x64_bf16 v[24:27], v[114:117], v[76:83], v182
ds_read_u16 v86, v86
v_smfmac_f32_16x16x64_bf16 v[20:23], v[114:117], v[76:83], v181 abid:1
ds_read_u16 v87, v87
v_smfmac_f32_16x16x64_bf16 v[28:31], v[114:117], v[76:83], v182 abid:1
ds_read_b128 v[114:117], v2 offset:256
v_add_u32_sdwa v76, s4, v118 dst_sel:DWORD dst_unused:UNUSED_PAD src0_sel:DWORD src1_sel:WORD_0
v_smfmac_f32_16x16x64_bf16 v[28:31], a[164:167], v[44:51], v156 abid:1
ds_read_u16 v88, v88
v_add_u32_sdwa v77, s4, v118 dst_sel:DWORD dst_unused:UNUSED_PAD src0_sel:DWORD src1_sel:WORD_1
v_smfmac_f32_16x16x64_bf16 v[28:31], a[200:203], v[52:59], v160 abid:1
ds_read_b128 v[60:63], v0 offset:14336
v_add_u32_sdwa v78, s4, v119 dst_sel:DWORD dst_unused:UNUSED_PAD src0_sel:DWORD src1_sel:WORD_0
v_smfmac_f32_16x16x64_bf16 v[28:31], a[236:239], v[92:99], v164 abid:1
ds_read_u16 v89, v89
v_add_u32_sdwa v79, s4, v119 dst_sel:DWORD dst_unused:UNUSED_PAD src0_sel:DWORD src1_sel:WORD_1
v_smfmac_f32_16x16x64_bf16 v[12:15], a[148:151], v[44:51], v154 abid:1
ds_read_b128 v[64:67], v1 offset:14336
v_add_u32_sdwa v80, s4, v120 dst_sel:DWORD dst_unused:UNUSED_PAD src0_sel:DWORD src1_sel:WORD_0
v_smfmac_f32_16x16x64_bf16 v[12:15], a[184:187], v[52:59], v158 abid:1
s_add_u32 m0, s44, 3840
ds_read_b128 v[68:71], v0 offset:16384
v_add_u32_sdwa v81, s4, v120 dst_sel:DWORD dst_unused:UNUSED_PAD src0_sel:DWORD src1_sel:WORD_1
v_smfmac_f32_16x16x64_bf16 v[12:15], a[220:223], v[92:99], v162 abid:1
buffer_load_dwordx4 v3, s[16:19], s45 offen offset:256 nt lds
v_add_u32_sdwa v82, s4, v121 dst_sel:DWORD dst_unused:UNUSED_PAD src0_sel:DWORD src1_sel:WORD_0
v_smfmac_f32_16x16x64_bf16 v[32:35], a[168:171], v[44:51], v157
ds_read_u16 v90, v90
v_add_u32_sdwa v83, s4, v121 dst_sel:DWORD dst_unused:UNUSED_PAD src0_sel:DWORD src1_sel:WORD_1
v_smfmac_f32_16x16x64_bf16 v[32:35], a[204:207], v[52:59], v161
ds_read_b128 v[72:75], v1 offset:16384
v_add_u32 v0, s43, v0
v_smfmac_f32_16x16x64_bf16 v[32:35], a[240:243], v[92:99], v165
s_waitcnt lgkmcnt(7)
ds_read_u16 v91, v91
v_add_u32 v1, s43, v1
v_smfmac_f32_16x16x64_bf16 v[32:35], v[114:117], v[100:107], v183 abid:1
ds_write_b64 v254, v[112:113]
v_xor_b32 v254, 512, v254
v_smfmac_f32_16x16x64_bf16 v[28:31], v[114:117], v[100:107], v183
v_smfmac_f32_16x16x64_bf16 v[36:39], v[114:117], v[100:107], v184
ds_read_b128 v[114:117], v2 offset:320
v_smfmac_f32_16x16x64_bf16 v[36:39], a[172:175], v[44:51], v157 abid:1
s_add_u32 m0, s44, 7680
v_smfmac_f32_16x16x64_bf16 v[36:39], a[208:211], v[52:59], v161 abid:1
buffer_load_dwordx4 v3, s[16:19], s45 offen offset:512 nt lds
v_smfmac_f32_16x16x64_bf16 v[36:39], a[244:247], v[92:99], v165 abid:1
v_smfmac_f32_16x16x64_bf16 v[16:19], a[152:155], v[44:51], v155
s_add_u32 m0, s44, 11520
v_smfmac_f32_16x16x64_bf16 v[16:19], a[188:191], v[52:59], v159
buffer_load_dwordx4 v3, s[16:19], s45 offen offset:768 nt lds
v_smfmac_f32_16x16x64_bf16 v[16:19], a[224:227], v[92:99], v163
v_smfmac_f32_16x16x64_bf16 v[20:23], a[156:159], v[44:51], v155 abid:1
s_add_u32 m0, s44, s8
v_smfmac_f32_16x16x64_bf16 v[20:23], a[192:195], v[52:59], v159 abid:1
s_mov_b64 exec, s[10:11]
buffer_load_dwordx4 v3, s[16:19], s7 offen offset:896 nt lds
s_mov_b64 exec, -1
v_smfmac_f32_16x16x64_bf16 v[20:23], a[228:231], v[92:99], v163 abid:1
s_add_u32 s45, s45, 4718592
s_add_u32 s7, s7, 4718592
s_add_u32 s44, s44, s5
v_smfmac_f32_16x16x64_bf16 v[40:43], a[176:179], v[44:51], v176
s_cmp_ge_u32 s44, 148480
s_cselect_b32 s44, s9, s44
s_bitcmp1_b32 s92, s41
v_smfmac_f32_16x16x64_bf16 v[40:43], a[212:215], v[52:59], v176 abid:1
s_cbranch_scc1 L_loopk_w
L_loopk_wb:
v_smfmac_f32_16x16x64_bf16 v[40:43], a[248:251], v[92:99], v177
s_waitcnt lgkmcnt(0)
v_smfmac_f32_16x16x64_bf16 v[40:43], v[114:117], v[84:91], v185
v_smfmac_f32_16x16x64_bf16 v[36:39], v[114:117], v[84:91], v184 abid:1
s_waitcnt vmcnt(20)
s_barrier
v_smfmac_f32_16x16x64_bf16 v[8:11], a[252:255], v[60:67], v166
s_mov_b32 s42, s4
ds_read_b64 v[112:113], v6
v_xor_b32 v6, 512, v6
v_smfmac_f32_16x16x64_bf16 v[8:11], v[218:221], v[68:75], v170
v_add_u32_sdwa v84, s42, v122 dst_sel:DWORD dst_unused:UNUSED_PAD src0_sel:DWORD src1_sel:WORD_0
v_smfmac_f32_16x16x64_bf16 v[12:15], v[186:189], v[60:67], v166 abid:1
ds_read_b128 v[44:47], v0 offset:0
v_add_u32_sdwa v85, s42, v122 dst_sel:DWORD dst_unused:UNUSED_PAD src0_sel:DWORD src1_sel:WORD_1
v_smfmac_f32_16x16x64_bf16 v[12:15], v[222:225], v[68:75], v170 abid:1
ds_read_b128 v[48:51], v1 offset:0
v_add_u32_sdwa v86, s42, v123 dst_sel:DWORD dst_unused:UNUSED_PAD src0_sel:DWORD src1_sel:WORD_0
v_smfmac_f32_16x16x64_bf16 v[16:19], v[190:193], v[60:67], v167
ds_read_b128 v[52:55], v0 offset:2048
v_cvt_pk_bf16_f32 v92, v8, v9
v_smfmac_f32_16x16x64_bf16 v[16:19], v[226:229], v[68:75], v171
ds_read_b128 v[56:59], v1 offset:2048
v_cvt_pk_bf16_f32 v93, v10, v11
v_smfmac_f32_16x16x64_bf16 v[20:23], v[194:197], v[60:67], v167 abid:1
ds_read_b128 v[8:11], v2 offset:1024
v_cvt_pk_bf16_f32 v94, v12, v13
v_smfmac_f32_16x16x64_bf16 v[20:23], v[230:233], v[68:75], v171 abid:1
ds_read_u16 v76, v76
v_cvt_pk_bf16_f32 v95, v14, v15
v_smfmac_f32_16x16x64_bf16 v[24:27], v[198:201], v[60:67], v168
ds_read_b128 v[12:15], v2 offset:1088
v_cvt_pk_bf16_f32 v96, v16, v17
v_smfmac_f32_16x16x64_bf16 v[24:27], v[234:237], v[68:75], v172
s_waitcnt lgkmcnt(7)
ds_read_u16 v77, v77
v_cvt_pk_bf16_f32 v97, v18, v19
v_smfmac_f32_16x16x64_bf16 v[28:31], v[202:205], v[60:67], v168 abid:1
buffer_store_dwordx2 v[112:113], v5, s[20:23], s66 offen sc1
ds_read_b128 v[16:19], v2 offset:1152
v_cvt_pk_bf16_f32 v98, v20, v21
v_smfmac_f32_16x16x64_bf16 v[28:31], v[238:241], v[68:75], v172 abid:1
ds_read_u16 v78, v78
v_cvt_pk_bf16_f32 v99, v22, v23
v_smfmac_f32_16x16x64_bf16 v[32:35], v[206:209], v[60:67], v169
ds_read_b128 v[20:23], v2 offset:1216
v_cvt_pk_bf16_f32 v100, v24, v25
v_smfmac_f32_16x16x64_bf16 v[32:35], v[242:245], v[68:75], v173
ds_read_u16 v79, v79
v_cvt_pk_bf16_f32 v101, v26, v27
v_smfmac_f32_16x16x64_bf16 v[36:39], v[210:213], v[60:67], v169 abid:1
ds_read_b128 v[24:27], v2 offset:1280
v_cvt_pk_bf16_f32 v102, v28, v29
v_smfmac_f32_16x16x64_bf16 v[36:39], v[246:249], v[68:75], v173 abid:1
ds_read_u16 v80, v80
v_cvt_pk_bf16_f32 v103, v30, v31
v_smfmac_f32_16x16x64_bf16 v[40:43], v[214:217], v[60:67], v177 abid:1
s_bitcmp1_b32 s85, s41
ds_read_b128 v[28:31], v2 offset:1344
v_cvt_pk_bf16_f32 v104, v32, v33
v_smfmac_f32_16x16x64_bf16 v[40:43], v[250:253], v[68:75], v178
s_waitcnt lgkmcnt(10)
v_cvt_pk_bf16_f32 v105, v34, v35
s_cbranch_scc1 L_loopk
s_cmp_lg_u32 s41, 6
s_cbranch_scc1 L_loopnk
.p2align 3
L_loopck:
v_smfmac_f32_16x16x64_bf16 v[8:11], a[0:3], v[44:51], v138
s_cmp_lt_u32 s56, s65
s_cselect_b32 s34, s34, 0
s_cselect_b32 s64, s64, 0
ds_read_b128 v[32:35], v2 offset:1408
v_cvt_pk_bf16_f32 v106, v36, v37
v_mov_b32 v7, 1
v_smfmac_f32_16x16x64_bf16 v[8:11], a[36:39], v[52:59], v142
s_waitcnt lgkmcnt(9)
buffer_atomic_add v7, v3, s[32:35], 0 offen sc0 sc1
v_cvt_pk_bf16_f32 v107, v38, v39
v_smfmac_f32_16x16x64_bf16 v[12:15], a[4:7], v[44:51], v138 abid:1
ds_read_b128 v[36:39], v2 offset:1472
v_cvt_pk_bf16_f32 v112, v40, v41
v_smfmac_f32_16x16x64_bf16 v[12:15], a[40:43], v[52:59], v142 abid:1
s_waitcnt lgkmcnt(8)
ds_read_u16 v81, v81
v_cvt_pk_bf16_f32 v113, v42, v43
v_smfmac_f32_16x16x64_bf16 v[16:19], a[8:11], v[44:51], v139
s_cmp_eq_u32 s4, 129920
ds_read_b128 v[40:43], v2 offset:1536
v_cndmask_b32_dpp v108, v96, v92, vcc quad_perm:[1,0,3,2] row_mask:0xf bank_mask:0xf
v_smfmac_f32_16x16x64_bf16 v[16:19], a[44:47], v[52:59], v143
s_waitcnt lgkmcnt(8)
ds_read_b128 v[60:63], v0 offset:4096
v_cndmask_b32_dpp v109, v97, v93, vcc quad_perm:[1,0,3,2] row_mask:0xf bank_mask:0xf
v_smfmac_f32_16x16x64_bf16 v[20:23], a[12:15], v[44:51], v139 abid:1
s_cselect_b32 s43, -129920, s5
ds_read_u16 v82, v82
v_cndmask_b32_dpp v110, v98, v94, vcc quad_perm:[1,0,3,2] row_mask:0xf bank_mask:0xf
v_smfmac_f32_16x16x64_bf16 v[20:23], a[48:51], v[52:59], v143 abid:1
s_waitcnt lgkmcnt(8)
ds_read_u16 v84, v84
v_cndmask_b32_dpp v111, v99, v95, vcc quad_perm:[1,0,3,2] row_mask:0xf bank_mask:0xf
v_smfmac_f32_16x16x64_bf16 v[24:27], a[16:19], v[44:51], v140
s_add_u32 s4, s4, s43
ds_read_b128 v[64:67], v1 offset:4096
v_add_u32_sdwa v87, s42, v123 dst_sel:DWORD dst_unused:UNUSED_PAD src0_sel:DWORD src1_sel:WORD_1
v_smfmac_f32_16x16x64_bf16 v[24:27], a[52:55], v[52:59], v144
buffer_store_dwordx4 v[108:111], v4, s[20:23], s46 offen offset:0 sc1
s_mov_b64 vcc, s[82:83]
s_waitcnt lgkmcnt(8)
ds_read_b128 v[68:71], v0 offset:6144
v_cndmask_b32_dpp v96, v92, v96, vcc quad_perm:[1,0,3,2] row_mask:0xf bank_mask:0xf
v_cndmask_b32_dpp v97, v93, v97, vcc quad_perm:[1,0,3,2] row_mask:0xf bank_mask:0xf
v_smfmac_f32_16x16x64_bf16 v[28:31], a[20:23], v[44:51], v140 abid:1
s_add_u32 s7, s45, s58
ds_read_b128 v[72:75], v1 offset:6144
v_cndmask_b32_dpp v98, v94, v98, vcc quad_perm:[1,0,3,2] row_mask:0xf bank_mask:0xf
v_smfmac_f32_16x16x64_bf16 v[28:31], a[56:59], v[52:59], v144 abid:1
s_waitcnt lgkmcnt(9)
ds_read_u16 v83, v83
v_cndmask_b32_dpp v99, v95, v99, vcc quad_perm:[1,0,3,2] row_mask:0xf bank_mask:0xf
v_smfmac_f32_16x16x64_bf16 v[32:35], a[24:27], v[44:51], v141
ds_read_b128 v[114:117], v2 offset:64
v_add_u32_sdwa v88, s42, v124 dst_sel:DWORD dst_unused:UNUSED_PAD src0_sel:DWORD src1_sel:WORD_0
v_smfmac_f32_16x16x64_bf16 v[32:35], a[60:63], v[52:59], v145
s_waitcnt lgkmcnt(10)
ds_read_u16 v85, v85
v_add_u32_sdwa v89, s42, v124 dst_sel:DWORD dst_unused:UNUSED_PAD src0_sel:DWORD src1_sel:WORD_1
v_smfmac_f32_16x16x64_bf16 v[36:39], a[28:31], v[44:51], v141 abid:1
ds_read_u16 v86, v86
v_add_u32_sdwa v90, s42, v125 dst_sel:DWORD dst_unused:UNUSED_PAD src0_sel:DWORD src1_sel:WORD_0
v_smfmac_f32_16x16x64_bf16 v[36:39], a[64:67], v[52:59], v145 abid:1
s_waitcnt lgkmcnt(10)
ds_read_u16 v87, v87
v_add_u32_sdwa v91, s42, v125 dst_sel:DWORD dst_unused:UNUSED_PAD src0_sel:DWORD src1_sel:WORD_1
v_smfmac_f32_16x16x64_bf16 v[40:43], a[32:35], v[44:51], v174
buffer_store_dwordx4 v[96:99], v4, s[20:23], s46 offen offset:1152 sc1
s_mov_b64 vcc, s[80:81]
ds_read_u16 v88, v88
v_cndmask_b32_dpp v92, v104, v100, vcc quad_perm:[1,0,3,2] row_mask:0xf bank_mask:0xf
v_cndmask_b32_dpp v93, v105, v101, vcc quad_perm:[1,0,3,2] row_mask:0xf bank_mask:0xf
v_smfmac_f32_16x16x64_bf16 v[40:43], a[68:71], v[52:59], v174 abid:1
s_waitcnt lgkmcnt(8)
ds_read_u16 v89, v89
v_cndmask_b32_dpp v94, v106, v102, vcc quad_perm:[1,0,3,2] row_mask:0xf bank_mask:0xf
v_smfmac_f32_16x16x64_bf16 v[8:11], a[72:75], v[60:67], v146
s_waitcnt lgkmcnt(7)
ds_read_u16 v90, v90
v_cndmask_b32_dpp v95, v107, v103, vcc quad_perm:[1,0,3,2] row_mask:0xf bank_mask:0xf
v_smfmac_f32_16x16x64_bf16 v[8:11], a[108:111], v[68:75], v150
s_waitcnt lgkmcnt(6)
ds_read_u16 v91, v91
v_smfmac_f32_16x16x64_bf16 v[8:11], v[114:117], v[76:83], v179
ds_read_b128 v[44:47], v0 offset:8192
v_smfmac_f32_16x16x64_bf16 v[12:15], v[114:117], v[76:83], v179 abid:1
ds_read_b128 v[114:117], v2 offset:128
v_add_u32_sdwa v76, s42, v126 dst_sel:DWORD dst_unused:UNUSED_PAD src0_sel:DWORD src1_sel:WORD_0
v_smfmac_f32_16x16x64_bf16 v[12:15], a[76:79], v[60:67], v146 abid:1
ds_read_u16 v76, v76
v_add_u32_sdwa v77, s42, v126 dst_sel:DWORD dst_unused:UNUSED_PAD src0_sel:DWORD src1_sel:WORD_1
v_smfmac_f32_16x16x64_bf16 v[12:15], a[112:115], v[68:75], v150 abid:1
buffer_store_dwordx4 v[92:95], v4, s[20:23], s46 offen offset:128 sc1
s_mov_b64 vcc, s[82:83]
ds_read_u16 v77, v77
v_cndmask_b32_dpp v104, v100, v104, vcc quad_perm:[1,0,3,2] row_mask:0xf bank_mask:0xf
v_cndmask_b32_dpp v105, v101, v105, vcc quad_perm:[1,0,3,2] row_mask:0xf bank_mask:0xf
v_smfmac_f32_16x16x64_bf16 v[24:27], a[88:91], v[60:67], v148
ds_read_b128 v[48:51], v1 offset:8192
v_add_u32_sdwa v78, s42, v127 dst_sel:DWORD dst_unused:UNUSED_PAD src0_sel:DWORD src1_sel:WORD_0
v_smfmac_f32_16x16x64_bf16 v[24:27], a[124:127], v[68:75], v152
ds_read_u16 v78, v78
v_cndmask_b32_dpp v106, v102, v106, vcc quad_perm:[1,0,3,2] row_mask:0xf bank_mask:0xf
v_smfmac_f32_16x16x64_bf16 v[28:31], a[92:95], v[60:67], v148 abid:1
ds_read_b128 v[52:55], v0 offset:10240
v_cndmask_b32_dpp v107, v103, v107, vcc quad_perm:[1,0,3,2] row_mask:0xf bank_mask:0xf
v_smfmac_f32_16x16x64_bf16 v[28:31], a[128:131], v[68:75], v152 abid:1
ds_read_b128 v[56:59], v1 offset:10240
v_add_u32_sdwa v79, s42, v127 dst_sel:DWORD dst_unused:UNUSED_PAD src0_sel:DWORD src1_sel:WORD_1
v_smfmac_f32_16x16x64_bf16 v[32:35], a[96:99], v[60:67], v149
ds_read_u16 v79, v79
v_add_u32_sdwa v80, s42, v128 dst_sel:DWORD dst_unused:UNUSED_PAD src0_sel:DWORD src1_sel:WORD_0
v_smfmac_f32_16x16x64_bf16 v[32:35], a[132:135], v[68:75], v153
ds_read_u16 v80, v80
v_add_u32_sdwa v81, s42, v128 dst_sel:DWORD dst_unused:UNUSED_PAD src0_sel:DWORD src1_sel:WORD_1
v_smfmac_f32_16x16x64_bf16 v[16:19], a[80:83], v[60:67], v147
buffer_store_dwordx4 v[104:107], v4, s[20:23], s46 offen offset:1280 sc1
s_mov_b64 vcc, s[80:81]
ds_read_b128 v[92:95], v0 offset:12288
v_add_u32_sdwa v82, s42, v129 dst_sel:DWORD dst_unused:UNUSED_PAD src0_sel:DWORD src1_sel:WORD_0
v_add_u32_sdwa v83, s42, v129 dst_sel:DWORD dst_unused:UNUSED_PAD src0_sel:DWORD src1_sel:WORD_1
v_smfmac_f32_16x16x64_bf16 v[16:19], a[116:119], v[68:75], v151
s_waitcnt lgkmcnt(9)
ds_read_u16 v81, v81
v_add_u32_sdwa v100, s42, v130 dst_sel:DWORD dst_unused:UNUSED_PAD src0_sel:DWORD src1_sel:WORD_0
v_smfmac_f32_16x16x64_bf16 v[16:19], v[114:117], v[84:91], v180 abid:1
s_mov_b32 s66, s46
ds_read_b128 v[96:99], v1 offset:12288
v_add_u32_sdwa v101, s42, v130 dst_sel:DWORD dst_unused:UNUSED_PAD src0_sel:DWORD src1_sel:WORD_1
v_smfmac_f32_16x16x64_bf16 v[12:15], v[114:117], v[84:91], v180
s_mov_b32 s46, s48
ds_read_u16 v82, v82
v_add_u32_sdwa v102, s42, v131 dst_sel:DWORD dst_unused:UNUSED_PAD src0_sel:DWORD src1_sel:WORD_0
v_smfmac_f32_16x16x64_bf16 v[20:23], v[114:117], v[84:91], v181
s_mov_b32 s48, s49
ds_read_u16 v100, v100
v_add_u32_sdwa v103, s42, v131 dst_sel:DWORD dst_unused:UNUSED_PAD src0_sel:DWORD src1_sel:WORD_1
v_smfmac_f32_16x16x64_bf16 v[20:23], a[84:87], v[60:67], v147 abid:1
s_mov_b32 s49, s50
ds_read_u16 v83, v83
v_add_u32_sdwa v104, s42, v132 dst_sel:DWORD dst_unused:UNUSED_PAD src0_sel:DWORD src1_sel:WORD_0
v_smfmac_f32_16x16x64_bf16 v[20:23], a[120:123], v[68:75], v151 abid:1
s_mov_b32 s50, s45
ds_read_b128 v[114:117], v2 offset:192
v_add_u32_sdwa v105, s42, v132 dst_sel:DWORD dst_unused:UNUSED_PAD src0_sel:DWORD src1_sel:WORD_1
v_smfmac_f32_16x16x64_bf16 v[36:39], a[100:103], v[60:67], v149 abid:1
ds_read_u16 v101, v101
v_add_u32_sdwa v106, s42, v133 dst_sel:DWORD dst_unused:UNUSED_PAD src0_sel:DWORD src1_sel:WORD_0
v_smfmac_f32_16x16x64_bf16 v[36:39], a[136:139], v[68:75], v153 abid:1
ds_read_u16 v102, v102
v_add_u32_sdwa v107, s42, v133 dst_sel:DWORD dst_unused:UNUSED_PAD src0_sel:DWORD src1_sel:WORD_1
v_smfmac_f32_16x16x64_bf16 v[40:43], a[104:107], v[60:67], v175
ds_read_u16 v103, v103
v_add_u32_sdwa v84, s42, v134 dst_sel:DWORD dst_unused:UNUSED_PAD src0_sel:DWORD src1_sel:WORD_0
v_smfmac_f32_16x16x64_bf16 v[40:43], a[140:143], v[68:75], v175 abid:1
s_waitcnt lgkmcnt(15)
ds_read_u16 v104, v104
v_add_u32_sdwa v85, s42, v134 dst_sel:DWORD dst_unused:UNUSED_PAD src0_sel:DWORD src1_sel:WORD_1
v_smfmac_f32_16x16x64_bf16 v[8:11], a[144:147], v[44:51], v154
s_waitcnt lgkmcnt(13)
ds_read_u16 v105, v105
v_add_u32_sdwa v86, s42, v135 dst_sel:DWORD dst_unused:UNUSED_PAD src0_sel:DWORD src1_sel:WORD_0
v_smfmac_f32_16x16x64_bf16 v[8:11], a[180:183], v[52:59], v158
s_waitcnt lgkmcnt(9)
ds_read_u16 v106, v106
v_add_u32_sdwa v87, s42, v135 dst_sel:DWORD dst_unused:UNUSED_PAD src0_sel:DWORD src1_sel:WORD_1
v_smfmac_f32_16x16x64_bf16 v[8:11], a[216:219], v[92:99], v162
s_add_u32 m0, s44, 0
ds_read_u16 v107, v107
v_add_u32_sdwa v88, s42, v136 dst_sel:DWORD dst_unused:UNUSED_PAD src0_sel:DWORD src1_sel:WORD_0
v_smfmac_f32_16x16x64_bf16 v[24:27], a[160:163], v[44:51], v156
buffer_load_dwordx4 v3, s[16:19], s45 offen offset:0 nt lds
v_add_u32_sdwa v89, s42, v136 dst_sel:DWORD dst_unused:UNUSED_PAD src0_sel:DWORD src1_sel:WORD_1
v_smfmac_f32_16x16x64_bf16 v[24:27], a[196:199], v[52:59], v160
ds_read_u16 v84, v84
v_add_u32_sdwa v90, s42, v137 dst_sel:DWORD dst_unused:UNUSED_PAD src0_sel:DWORD src1_sel:WORD_0
v_smfmac_f32_16x16x64_bf16 v[24:27], a[232:235], v[92:99], v164
s_waitcnt lgkmcnt(8)
ds_read_u16 v85, v85
v_add_u32_sdwa v91, s42, v137 dst_sel:DWORD dst_unused:UNUSED_PAD src0_sel:DWORD src1_sel:WORD_1
v_smfmac_f32_16x16x64_bf16 v[24:27], v[114:117], v[76:83], v182
ds_read_u16 v86, v86
v_smfmac_f32_16x16x64_bf16 v[20:23], v[114:117], v[76:83], v181 abid:1
ds_read_u16 v87, v87
v_smfmac_f32_16x16x64_bf16 v[28:31], v[114:117], v[76:83], v182 abid:1
ds_read_b128 v[114:117], v2 offset:256
v_add_u32_sdwa v76, s4, v118 dst_sel:DWORD dst_unused:UNUSED_PAD src0_sel:DWORD src1_sel:WORD_0
v_smfmac_f32_16x16x64_bf16 v[28:31], a[164:167], v[44:51], v156 abid:1
ds_read_u16 v88, v88
v_add_u32_sdwa v77, s4, v118 dst_sel:DWORD dst_unused:UNUSED_PAD src0_sel:DWORD src1_sel:WORD_1
v_smfmac_f32_16x16x64_bf16 v[28:31], a[200:203], v[52:59], v160 abid:1
ds_read_b128 v[60:63], v0 offset:14336
v_add_u32_sdwa v78, s4, v119 dst_sel:DWORD dst_unused:UNUSED_PAD src0_sel:DWORD src1_sel:WORD_0
v_smfmac_f32_16x16x64_bf16 v[28:31], a[236:239], v[92:99], v164 abid:1
ds_read_u16 v89, v89
v_add_u32_sdwa v79, s4, v119 dst_sel:DWORD dst_unused:UNUSED_PAD src0_sel:DWORD src1_sel:WORD_1
v_smfmac_f32_16x16x64_bf16 v[12:15], a[148:151], v[44:51], v154 abid:1
ds_read_b128 v[64:67], v1 offset:14336
v_add_u32_sdwa v80, s4, v120 dst_sel:DWORD dst_unused:UNUSED_PAD src0_sel:DWORD src1_sel:WORD_0
v_smfmac_f32_16x16x64_bf16 v[12:15], a[184:187], v[52:59], v158 abid:1
s_add_u32 m0, s44, 3840
s_waitcnt vmcnt(5)
ds_read_b128 v[68:71], v0 offset:16384
v_add_u32_sdwa v81, s4, v120 dst_sel:DWORD dst_unused:UNUSED_PAD src0_sel:DWORD src1_sel:WORD_1
v_smfmac_f32_16x16x64_bf16 v[12:15], a[220:223], v[92:99], v162 abid:1
buffer_load_dwordx4 v3, s[16:19], s45 offen offset:256 nt lds
v_add_u32_sdwa v82, s4, v121 dst_sel:DWORD dst_unused:UNUSED_PAD src0_sel:DWORD src1_sel:WORD_0
v_smfmac_f32_16x16x64_bf16 v[32:35], a[168:171], v[44:51], v157
ds_read_u16 v90, v90
v_add_u32_sdwa v83, s4, v121 dst_sel:DWORD dst_unused:UNUSED_PAD src0_sel:DWORD src1_sel:WORD_1
v_smfmac_f32_16x16x64_bf16 v[32:35], a[204:207], v[52:59], v161
ds_read_b128 v[72:75], v1 offset:16384
v_add_u32 v0, s43, v0
v_smfmac_f32_16x16x64_bf16 v[32:35], a[240:243], v[92:99], v165
s_waitcnt lgkmcnt(7)
ds_read_u16 v91, v91
v_add_u32 v1, s43, v1
v_smfmac_f32_16x16x64_bf16 v[32:35], v[114:117], v[100:107], v183 abid:1
ds_write_b64 v254, v[112:113]
v_xor_b32 v254, 512, v254
v_smfmac_f32_16x16x64_bf16 v[28:31], v[114:117], v[100:107], v183
v_smfmac_f32_16x16x64_bf16 v[36:39], v[114:117], v[100:107], v184
ds_read_b128 v[114:117], v2 offset:320
v_smfmac_f32_16x16x64_bf16 v[36:39], a[172:175], v[44:51], v157 abid:1
s_add_u32 m0, s44, 7680
v_smfmac_f32_16x16x64_bf16 v[36:39], a[208:211], v[52:59], v161 abid:1
buffer_load_dwordx4 v3, s[16:19], s45 offen offset:512 nt lds
v_smfmac_f32_16x16x64_bf16 v[36:39], a[244:247], v[92:99], v165 abid:1
v_smfmac_f32_16x16x64_bf16 v[16:19], a[152:155], v[44:51], v155
s_add_u32 m0, s44, 11520
v_smfmac_f32_16x16x64_bf16 v[16:19], a[188:191], v[52:59], v159
buffer_load_dwordx4 v3, s[16:19], s45 offen offset:768 nt lds
v_smfmac_f32_16x16x64_bf16 v[16:19], a[224:227], v[92:99], v163
s_mov_b64 exec, s[62:63]
ds_write_b32 v0, v7 offset:18432
s_mov_b64 exec, -1
v_smfmac_f32_16x16x64_bf16 v[20:23], a[156:159], v[44:51], v155 abid:1
s_add_u32 m0, s44, s8
v_smfmac_f32_16x16x64_bf16 v[20:23], a[192:195], v[52:59], v159 abid:1
s_mov_b64 exec, s[10:11]
buffer_load_dwordx4 v3, s[16:19], s7 offen offset:896 nt lds
s_mov_b64 exec, -1
v_smfmac_f32_16x16x64_bf16 v[20:23], a[228:231], v[92:99], v163 abid:1
s_add_u32 s44, s44, s5
s_cmp_ge_u32 s44, 148480
s_cselect_b32 s44, s9, s44
v_smfmac_f32_16x16x64_bf16 v[40:43], a[176:179], v[44:51], v176
v_smfmac_f32_16x16x64_bf16 v[40:43], a[212:215], v[52:59], v176 abid:1
v_smfmac_f32_16x16x64_bf16 v[40:43], a[248:251], v[92:99], v177
s_waitcnt lgkmcnt(0)
v_smfmac_f32_16x16x64_bf16 v[40:43], v[114:117], v[84:91], v185
v_smfmac_f32_16x16x64_bf16 v[36:39], v[114:117], v[84:91], v184 abid:1
s_barrier
v_smfmac_f32_16x16x64_bf16 v[8:11], a[252:255], v[60:67], v166
s_mov_b32 s42, s4
ds_read_b64 v[112:113], v6
v_xor_b32 v6, 512, v6
v_smfmac_f32_16x16x64_bf16 v[8:11], v[218:221], v[68:75], v170
ds_read_b32 v7, v0 offset:18432
v_add_u32_sdwa v84, s42, v122 dst_sel:DWORD dst_unused:UNUSED_PAD src0_sel:DWORD src1_sel:WORD_0
v_smfmac_f32_16x16x64_bf16 v[12:15], v[186:189], v[60:67], v166 abid:1
ds_read_b128 v[44:47], v0 offset:0
v_add_u32_sdwa v85, s42, v122 dst_sel:DWORD dst_unused:UNUSED_PAD src0_sel:DWORD src1_sel:WORD_1
v_smfmac_f32_16x16x64_bf16 v[12:15], v[222:225], v[68:75], v170 abid:1
ds_read_b128 v[48:51], v1 offset:0
v_add_u32_sdwa v86, s42, v123 dst_sel:DWORD dst_unused:UNUSED_PAD src0_sel:DWORD src1_sel:WORD_0
v_smfmac_f32_16x16x64_bf16 v[16:19], v[190:193], v[60:67], v167
ds_read_b128 v[52:55], v0 offset:2048
v_cvt_pk_bf16_f32 v92, v8, v9
v_smfmac_f32_16x16x64_bf16 v[16:19], v[226:229], v[68:75], v171
ds_read_b128 v[56:59], v1 offset:2048
v_cvt_pk_bf16_f32 v93, v10, v11
v_smfmac_f32_16x16x64_bf16 v[20:23], v[194:197], v[60:67], v167 abid:1
ds_read_b128 v[8:11], v2 offset:1024
v_cvt_pk_bf16_f32 v94, v12, v13
v_smfmac_f32_16x16x64_bf16 v[20:23], v[230:233], v[68:75], v171 abid:1
ds_read_u16 v76, v76
v_cvt_pk_bf16_f32 v95, v14, v15
v_smfmac_f32_16x16x64_bf16 v[24:27], v[198:201], v[60:67], v168
ds_read_b128 v[12:15], v2 offset:1088
v_cvt_pk_bf16_f32 v96, v16, v17
v_smfmac_f32_16x16x64_bf16 v[24:27], v[234:237], v[68:75], v172
s_waitcnt lgkmcnt(8)
ds_read_u16 v77, v77
v_cvt_pk_bf16_f32 v97, v18, v19
v_smfmac_f32_16x16x64_bf16 v[28:31], v[202:205], v[60:67], v168 abid:1
buffer_store_dwordx2 v[112:113], v5, s[20:23], s66 offen sc1
s_waitcnt lgkmcnt(8)
ds_read_b128 v[16:19], v2 offset:1152
v_cvt_pk_bf16_f32 v98, v20, v21
v_readfirstlane_b32 s56, v7
v_smfmac_f32_16x16x64_bf16 v[28:31], v[238:241], v[68:75], v172 abid:1
s_lshr_b32 s60, s56, 4
ds_read_u16 v78, v78
v_cvt_pk_bf16_f32 v99, v22, v23
v_smfmac_f32_16x16x64_bf16 v[32:35], v[206:209], v[60:67], v169
s_mul_i32 s60, s60, 884736
ds_read_b128 v[20:23], v2 offset:1216
v_cvt_pk_bf16_f32 v100, v24, v25
v_smfmac_f32_16x16x64_bf16 v[32:35], v[242:245], v[68:75], v173
s_mul_i32 s61, s56, 18432
ds_read_u16 v79, v79
v_cvt_pk_bf16_f32 v101, v26, v27
v_smfmac_f32_16x16x64_bf16 v[36:39], v[210:213], v[60:67], v169 abid:1
s_add_u32 s60, s60, s57
ds_read_b128 v[24:27], v2 offset:1280
v_cvt_pk_bf16_f32 v102, v28, v29
v_smfmac_f32_16x16x64_bf16 v[36:39], v[246:249], v[68:75], v173 abid:1
s_add_u32 s45, s60, s61
ds_read_u16 v80, v80
v_cvt_pk_bf16_f32 v103, v30, v31
v_smfmac_f32_16x16x64_bf16 v[40:43], v[214:217], v[60:67], v177 abid:1
s_cmp_lt_u32 s56, s64
ds_read_b128 v[28:31], v2 offset:1344
v_cvt_pk_bf16_f32 v104, v32, v33
v_smfmac_f32_16x16x64_bf16 v[40:43], v[250:253], v[68:75], v178
s_waitcnt lgkmcnt(10)
v_cvt_pk_bf16_f32 v105, v34, v35
s_cbranch_scc1 L_loopck
s_mov_b32 s41, 0
s_mov_b32 s15, 3
s_mov_b32 s12, 7
s_mov_b32 s92, 4
s_mov_b32 s87, 4
s_mov_b32 s59, -1
.p2align 3
L_loopnk:
v_smfmac_f32_16x16x64_bf16 v[8:11], a[0:3], v[44:51], v138
ds_read_b128 v[32:35], v2 offset:1408
v_cvt_pk_bf16_f32 v106, v36, v37
v_smfmac_f32_16x16x64_bf16 v[8:11], a[36:39], v[52:59], v142
s_waitcnt lgkmcnt(9)
v_cvt_pk_bf16_f32 v107, v38, v39
v_smfmac_f32_16x16x64_bf16 v[12:15], a[4:7], v[44:51], v138 abid:1
ds_read_b128 v[36:39], v2 offset:1472
v_cvt_pk_bf16_f32 v112, v40, v41
v_smfmac_f32_16x16x64_bf16 v[12:15], a[40:43], v[52:59], v142 abid:1
s_waitcnt lgkmcnt(8)
ds_read_u16 v81, v81
v_cvt_pk_bf16_f32 v113, v42, v43
v_smfmac_f32_16x16x64_bf16 v[16:19], a[8:11], v[44:51], v139
s_cmp_eq_u32 s4, 129920
ds_read_b128 v[40:43], v2 offset:1536
v_cndmask_b32_dpp v108, v96, v92, vcc quad_perm:[1,0,3,2] row_mask:0xf bank_mask:0xf
v_smfmac_f32_16x16x64_bf16 v[16:19], a[44:47], v[52:59], v143
s_waitcnt lgkmcnt(8)
ds_read_b128 v[60:63], v0 offset:4096
v_cndmask_b32_dpp v109, v97, v93, vcc quad_perm:[1,0,3,2] row_mask:0xf bank_mask:0xf
v_smfmac_f32_16x16x64_bf16 v[20:23], a[12:15], v[44:51], v139 abid:1
s_cselect_b32 s43, -129920, s5
ds_read_u16 v82, v82
v_cndmask_b32_dpp v110, v98, v94, vcc quad_perm:[1,0,3,2] row_mask:0xf bank_mask:0xf
v_smfmac_f32_16x16x64_bf16 v[20:23], a[48:51], v[52:59], v143 abid:1
s_waitcnt lgkmcnt(8)
ds_read_u16 v84, v84
v_cndmask_b32_dpp v111, v99, v95, vcc quad_perm:[1,0,3,2] row_mask:0xf bank_mask:0xf
v_smfmac_f32_16x16x64_bf16 v[24:27], a[16:19], v[44:51], v140
s_add_u32 s4, s4, s43
ds_read_b128 v[64:67], v1 offset:4096
v_add_u32_sdwa v87, s42, v123 dst_sel:DWORD dst_unused:UNUSED_PAD src0_sel:DWORD src1_sel:WORD_1
v_smfmac_f32_16x16x64_bf16 v[24:27], a[52:55], v[52:59], v144
buffer_store_dwordx4 v[108:111], v4, s[20:23], s46 offen offset:0 sc1
s_mov_b64 vcc, s[82:83]
s_waitcnt lgkmcnt(8)
ds_read_b128 v[68:71], v0 offset:6144
v_cndmask_b32_dpp v96, v92, v96, vcc quad_perm:[1,0,3,2] row_mask:0xf bank_mask:0xf
v_cndmask_b32_dpp v97, v93, v97, vcc quad_perm:[1,0,3,2] row_mask:0xf bank_mask:0xf
v_smfmac_f32_16x16x64_bf16 v[28:31], a[20:23], v[44:51], v140 abid:1
s_add_u32 s41, s41, 1
ds_read_b128 v[72:75], v1 offset:6144
v_cndmask_b32_dpp v98, v94, v98, vcc quad_perm:[1,0,3,2] row_mask:0xf bank_mask:0xf
v_smfmac_f32_16x16x64_bf16 v[28:31], a[56:59], v[52:59], v144 abid:1
s_waitcnt lgkmcnt(9)
ds_read_u16 v83, v83
v_cndmask_b32_dpp v99, v95, v99, vcc quad_perm:[1,0,3,2] row_mask:0xf bank_mask:0xf
v_smfmac_f32_16x16x64_bf16 v[32:35], a[24:27], v[44:51], v141
ds_read_b128 v[114:117], v2 offset:64
v_add_u32_sdwa v88, s42, v124 dst_sel:DWORD dst_unused:UNUSED_PAD src0_sel:DWORD src1_sel:WORD_0
v_smfmac_f32_16x16x64_bf16 v[32:35], a[60:63], v[52:59], v145
s_waitcnt lgkmcnt(10)
ds_read_u16 v85, v85
v_add_u32_sdwa v89, s42, v124 dst_sel:DWORD dst_unused:UNUSED_PAD src0_sel:DWORD src1_sel:WORD_1
v_smfmac_f32_16x16x64_bf16 v[36:39], a[28:31], v[44:51], v141 abid:1
ds_read_u16 v86, v86
v_add_u32_sdwa v90, s42, v125 dst_sel:DWORD dst_unused:UNUSED_PAD src0_sel:DWORD src1_sel:WORD_0
v_smfmac_f32_16x16x64_bf16 v[36:39], a[64:67], v[52:59], v145 abid:1
s_waitcnt lgkmcnt(10)
ds_read_u16 v87, v87
v_add_u32_sdwa v91, s42, v125 dst_sel:DWORD dst_unused:UNUSED_PAD src0_sel:DWORD src1_sel:WORD_1
v_smfmac_f32_16x16x64_bf16 v[40:43], a[32:35], v[44:51], v174
buffer_store_dwordx4 v[96:99], v4, s[20:23], s46 offen offset:1152 sc1
s_mov_b64 vcc, s[80:81]
ds_read_u16 v88, v88
v_cndmask_b32_dpp v92, v104, v100, vcc quad_perm:[1,0,3,2] row_mask:0xf bank_mask:0xf
v_cndmask_b32_dpp v93, v105, v101, vcc quad_perm:[1,0,3,2] row_mask:0xf bank_mask:0xf
v_smfmac_f32_16x16x64_bf16 v[40:43], a[68:71], v[52:59], v174 abid:1
s_waitcnt lgkmcnt(8)
ds_read_u16 v89, v89
v_cndmask_b32_dpp v94, v106, v102, vcc quad_perm:[1,0,3,2] row_mask:0xf bank_mask:0xf
v_smfmac_f32_16x16x64_bf16 v[8:11], a[72:75], v[60:67], v146
s_waitcnt lgkmcnt(7)
ds_read_u16 v90, v90
v_cndmask_b32_dpp v95, v107, v103, vcc quad_perm:[1,0,3,2] row_mask:0xf bank_mask:0xf
v_smfmac_f32_16x16x64_bf16 v[8:11], a[108:111], v[68:75], v150
s_waitcnt lgkmcnt(6)
ds_read_u16 v91, v91
v_smfmac_f32_16x16x64_bf16 v[8:11], v[114:117], v[76:83], v179
ds_read_b128 v[44:47], v0 offset:8192
v_smfmac_f32_16x16x64_bf16 v[12:15], v[114:117], v[76:83], v179 abid:1
ds_read_b128 v[114:117], v2 offset:128
v_add_u32_sdwa v76, s42, v126 dst_sel:DWORD dst_unused:UNUSED_PAD src0_sel:DWORD src1_sel:WORD_0
v_smfmac_f32_16x16x64_bf16 v[12:15], a[76:79], v[60:67], v146 abid:1
ds_read_u16 v76, v76
v_add_u32_sdwa v77, s42, v126 dst_sel:DWORD dst_unused:UNUSED_PAD src0_sel:DWORD src1_sel:WORD_1
v_smfmac_f32_16x16x64_bf16 v[12:15], a[112:115], v[68:75], v150 abid:1
buffer_store_dwordx4 v[92:95], v4, s[20:23], s46 offen offset:128 sc1
s_mov_b64 vcc, s[82:83]
ds_read_u16 v77, v77
v_cndmask_b32_dpp v104, v100, v104, vcc quad_perm:[1,0,3,2] row_mask:0xf bank_mask:0xf
v_cndmask_b32_dpp v105, v101, v105, vcc quad_perm:[1,0,3,2] row_mask:0xf bank_mask:0xf
v_smfmac_f32_16x16x64_bf16 v[24:27], a[88:91], v[60:67], v148
ds_read_b128 v[48:51], v1 offset:8192
v_add_u32_sdwa v78, s42, v127 dst_sel:DWORD dst_unused:UNUSED_PAD src0_sel:DWORD src1_sel:WORD_0
v_smfmac_f32_16x16x64_bf16 v[24:27], a[124:127], v[68:75], v152
ds_read_u16 v78, v78
v_cndmask_b32_dpp v106, v102, v106, vcc quad_perm:[1,0,3,2] row_mask:0xf bank_mask:0xf
v_smfmac_f32_16x16x64_bf16 v[28:31], a[92:95], v[60:67], v148 abid:1
ds_read_b128 v[52:55], v0 offset:10240
v_cndmask_b32_dpp v107, v103, v107, vcc quad_perm:[1,0,3,2] row_mask:0xf bank_mask:0xf
v_smfmac_f32_16x16x64_bf16 v[28:31], a[128:131], v[68:75], v152 abid:1
ds_read_b128 v[56:59], v1 offset:10240
v_add_u32_sdwa v79, s42, v127 dst_sel:DWORD dst_unused:UNUSED_PAD src0_sel:DWORD src1_sel:WORD_1
v_smfmac_f32_16x16x64_bf16 v[32:35], a[96:99], v[60:67], v149
ds_read_u16 v79, v79
v_add_u32_sdwa v80, s42, v128 dst_sel:DWORD dst_unused:UNUSED_PAD src0_sel:DWORD src1_sel:WORD_0
v_smfmac_f32_16x16x64_bf16 v[32:35], a[132:135], v[68:75], v153
ds_read_u16 v80, v80
v_add_u32_sdwa v81, s42, v128 dst_sel:DWORD dst_unused:UNUSED_PAD src0_sel:DWORD src1_sel:WORD_1
v_smfmac_f32_16x16x64_bf16 v[16:19], a[80:83], v[60:67], v147
buffer_store_dwordx4 v[104:107], v4, s[20:23], s46 offen offset:1280 sc1
s_mov_b64 vcc, s[80:81]
ds_read_b128 v[92:95], v0 offset:12288
v_add_u32_sdwa v82, s42, v129 dst_sel:DWORD dst_unused:UNUSED_PAD src0_sel:DWORD src1_sel:WORD_0
v_add_u32_sdwa v83, s42, v129 dst_sel:DWORD dst_unused:UNUSED_PAD src0_sel:DWORD src1_sel:WORD_1
v_smfmac_f32_16x16x64_bf16 v[16:19], a[116:119], v[68:75], v151
s_waitcnt lgkmcnt(9)
ds_read_u16 v81, v81
v_add_u32_sdwa v100, s42, v130 dst_sel:DWORD dst_unused:UNUSED_PAD src0_sel:DWORD src1_sel:WORD_0
v_smfmac_f32_16x16x64_bf16 v[16:19], v[114:117], v[84:91], v180 abid:1
s_mov_b32 s66, s46
ds_read_b128 v[96:99], v1 offset:12288
v_add_u32_sdwa v101, s42, v130 dst_sel:DWORD dst_unused:UNUSED_PAD src0_sel:DWORD src1_sel:WORD_1
v_smfmac_f32_16x16x64_bf16 v[12:15], v[114:117], v[84:91], v180
s_mov_b32 s46, s48
ds_read_u16 v82, v82
v_add_u32_sdwa v102, s42, v131 dst_sel:DWORD dst_unused:UNUSED_PAD src0_sel:DWORD src1_sel:WORD_0
v_smfmac_f32_16x16x64_bf16 v[20:23], v[114:117], v[84:91], v181
s_mov_b32 s48, s49
ds_read_u16 v100, v100
v_add_u32_sdwa v103, s42, v131 dst_sel:DWORD dst_unused:UNUSED_PAD src0_sel:DWORD src1_sel:WORD_1
v_smfmac_f32_16x16x64_bf16 v[20:23], a[84:87], v[60:67], v147 abid:1
s_mov_b32 s49, s50
ds_read_u16 v83, v83
v_add_u32_sdwa v104, s42, v132 dst_sel:DWORD dst_unused:UNUSED_PAD src0_sel:DWORD src1_sel:WORD_0
v_smfmac_f32_16x16x64_bf16 v[20:23], a[120:123], v[68:75], v151 abid:1
s_add_u32 s50, s50, 4718592
ds_read_b128 v[114:117], v2 offset:192
v_add_u32_sdwa v105, s42, v132 dst_sel:DWORD dst_unused:UNUSED_PAD src0_sel:DWORD src1_sel:WORD_1
v_smfmac_f32_16x16x64_bf16 v[36:39], a[100:103], v[60:67], v149 abid:1
ds_read_u16 v101, v101
v_add_u32_sdwa v106, s42, v133 dst_sel:DWORD dst_unused:UNUSED_PAD src0_sel:DWORD src1_sel:WORD_0
v_smfmac_f32_16x16x64_bf16 v[36:39], a[136:139], v[68:75], v153 abid:1
ds_read_u16 v102, v102
v_add_u32_sdwa v107, s42, v133 dst_sel:DWORD dst_unused:UNUSED_PAD src0_sel:DWORD src1_sel:WORD_1
v_smfmac_f32_16x16x64_bf16 v[40:43], a[104:107], v[60:67], v175
ds_read_u16 v103, v103
v_add_u32_sdwa v84, s42, v134 dst_sel:DWORD dst_unused:UNUSED_PAD src0_sel:DWORD src1_sel:WORD_0
v_smfmac_f32_16x16x64_bf16 v[40:43], a[140:143], v[68:75], v175 abid:1
s_waitcnt lgkmcnt(15)
ds_read_u16 v104, v104
v_add_u32_sdwa v85, s42, v134 dst_sel:DWORD dst_unused:UNUSED_PAD src0_sel:DWORD src1_sel:WORD_1
v_smfmac_f32_16x16x64_bf16 v[8:11], a[144:147], v[44:51], v154
s_waitcnt lgkmcnt(13)
ds_read_u16 v105, v105
v_add_u32_sdwa v86, s42, v135 dst_sel:DWORD dst_unused:UNUSED_PAD src0_sel:DWORD src1_sel:WORD_0
v_smfmac_f32_16x16x64_bf16 v[8:11], a[180:183], v[52:59], v158
s_waitcnt lgkmcnt(9)
ds_read_u16 v106, v106
v_add_u32_sdwa v87, s42, v135 dst_sel:DWORD dst_unused:UNUSED_PAD src0_sel:DWORD src1_sel:WORD_1
v_smfmac_f32_16x16x64_bf16 v[8:11], a[216:219], v[92:99], v162
ds_read_u16 v107, v107
v_add_u32_sdwa v88, s42, v136 dst_sel:DWORD dst_unused:UNUSED_PAD src0_sel:DWORD src1_sel:WORD_0
v_smfmac_f32_16x16x64_bf16 v[24:27], a[160:163], v[44:51], v156
v_add_u32_sdwa v89, s42, v136 dst_sel:DWORD dst_unused:UNUSED_PAD src0_sel:DWORD src1_sel:WORD_1
v_smfmac_f32_16x16x64_bf16 v[24:27], a[196:199], v[52:59], v160
ds_read_u16 v84, v84
v_add_u32_sdwa v90, s42, v137 dst_sel:DWORD dst_unused:UNUSED_PAD src0_sel:DWORD src1_sel:WORD_0
v_smfmac_f32_16x16x64_bf16 v[24:27], a[232:235], v[92:99], v164
s_waitcnt lgkmcnt(8)
ds_read_u16 v85, v85
v_add_u32_sdwa v91, s42, v137 dst_sel:DWORD dst_unused:UNUSED_PAD src0_sel:DWORD src1_sel:WORD_1
v_smfmac_f32_16x16x64_bf16 v[24:27], v[114:117], v[76:83], v182
ds_read_u16 v86, v86
v_smfmac_f32_16x16x64_bf16 v[20:23], v[114:117], v[76:83], v181 abid:1
ds_read_u16 v87, v87
v_smfmac_f32_16x16x64_bf16 v[28:31], v[114:117], v[76:83], v182 abid:1
ds_read_b128 v[114:117], v2 offset:256
v_add_u32_sdwa v76, s4, v118 dst_sel:DWORD dst_unused:UNUSED_PAD src0_sel:DWORD src1_sel:WORD_0
v_smfmac_f32_16x16x64_bf16 v[28:31], a[164:167], v[44:51], v156 abid:1
ds_read_u16 v88, v88
v_add_u32_sdwa v77, s4, v118 dst_sel:DWORD dst_unused:UNUSED_PAD src0_sel:DWORD src1_sel:WORD_1
v_smfmac_f32_16x16x64_bf16 v[28:31], a[200:203], v[52:59], v160 abid:1
ds_read_b128 v[60:63], v0 offset:14336
v_add_u32_sdwa v78, s4, v119 dst_sel:DWORD dst_unused:UNUSED_PAD src0_sel:DWORD src1_sel:WORD_0
v_smfmac_f32_16x16x64_bf16 v[28:31], a[236:239], v[92:99], v164 abid:1
ds_read_u16 v89, v89
v_add_u32_sdwa v79, s4, v119 dst_sel:DWORD dst_unused:UNUSED_PAD src0_sel:DWORD src1_sel:WORD_1
v_smfmac_f32_16x16x64_bf16 v[12:15], a[148:151], v[44:51], v154 abid:1
ds_read_b128 v[64:67], v1 offset:14336
v_add_u32_sdwa v80, s4, v120 dst_sel:DWORD dst_unused:UNUSED_PAD src0_sel:DWORD src1_sel:WORD_0
v_smfmac_f32_16x16x64_bf16 v[12:15], a[184:187], v[52:59], v158 abid:1
ds_read_b128 v[68:71], v0 offset:16384
v_add_u32_sdwa v81, s4, v120 dst_sel:DWORD dst_unused:UNUSED_PAD src0_sel:DWORD src1_sel:WORD_1
v_smfmac_f32_16x16x64_bf16 v[12:15], a[220:223], v[92:99], v162 abid:1
v_add_u32_sdwa v82, s4, v121 dst_sel:DWORD dst_unused:UNUSED_PAD src0_sel:DWORD src1_sel:WORD_0
v_smfmac_f32_16x16x64_bf16 v[32:35], a[168:171], v[44:51], v157
ds_read_u16 v90, v90
v_add_u32_sdwa v83, s4, v121 dst_sel:DWORD dst_unused:UNUSED_PAD src0_sel:DWORD src1_sel:WORD_1
v_smfmac_f32_16x16x64_bf16 v[32:35], a[204:207], v[52:59], v161
ds_read_b128 v[72:75], v1 offset:16384
v_add_u32 v0, s43, v0
v_smfmac_f32_16x16x64_bf16 v[32:35], a[240:243], v[92:99], v165
s_waitcnt lgkmcnt(7)
ds_read_u16 v91, v91
v_add_u32 v1, s43, v1
v_smfmac_f32_16x16x64_bf16 v[32:35], v[114:117], v[100:107], v183 abid:1
ds_write_b64 v254, v[112:113]
v_xor_b32 v254, 512, v254
v_smfmac_f32_16x16x64_bf16 v[28:31], v[114:117], v[100:107], v183
v_smfmac_f32_16x16x64_bf16 v[36:39], v[114:117], v[100:107], v184
ds_read_b128 v[114:117], v2 offset:320
v_smfmac_f32_16x16x64_bf16 v[36:39], a[172:175], v[44:51], v157 abid:1
v_smfmac_f32_16x16x64_bf16 v[36:39], a[208:211], v[52:59], v161 abid:1
v_smfmac_f32_16x16x64_bf16 v[36:39], a[244:247], v[92:99], v165 abid:1
v_smfmac_f32_16x16x64_bf16 v[16:19], a[152:155], v[44:51], v155
v_smfmac_f32_16x16x64_bf16 v[16:19], a[188:191], v[52:59], v159
v_smfmac_f32_16x16x64_bf16 v[16:19], a[224:227], v[92:99], v163
v_smfmac_f32_16x16x64_bf16 v[20:23], a[156:159], v[44:51], v155 abid:1
v_smfmac_f32_16x16x64_bf16 v[20:23], a[192:195], v[52:59], v159 abid:1
v_smfmac_f32_16x16x64_bf16 v[20:23], a[228:231], v[92:99], v163 abid:1
v_smfmac_f32_16x16x64_bf16 v[40:43], a[176:179], v[44:51], v176
s_bitcmp1_b32 s92, s41
v_smfmac_f32_16x16x64_bf16 v[40:43], a[212:215], v[52:59], v176 abid:1
s_cbranch_scc1 L_loopnk_w
L_loopnk_wb:
v_smfmac_f32_16x16x64_bf16 v[40:43], a[248:251], v[92:99], v177
s_waitcnt lgkmcnt(0)
v_smfmac_f32_16x16x64_bf16 v[40:43], v[114:117], v[84:91], v185
v_smfmac_f32_16x16x64_bf16 v[36:39], v[114:117], v[84:91], v184 abid:1
s_waitcnt vmcnt(20)
s_barrier
L_loopnk_p3:
v_smfmac_f32_16x16x64_bf16 v[8:11], a[252:255], v[60:67], v166
s_mov_b32 s42, s4
ds_read_b64 v[112:113], v6
v_xor_b32 v6, 512, v6
v_smfmac_f32_16x16x64_bf16 v[8:11], v[218:221], v[68:75], v170
v_add_u32_sdwa v84, s42, v122 dst_sel:DWORD dst_unused:UNUSED_PAD src0_sel:DWORD src1_sel:WORD_0
v_smfmac_f32_16x16x64_bf16 v[12:15], v[186:189], v[60:67], v166 abid:1
ds_read_b128 v[44:47], v0 offset:0
v_add_u32_sdwa v85, s42, v122 dst_sel:DWORD dst_unused:UNUSED_PAD src0_sel:DWORD src1_sel:WORD_1
v_smfmac_f32_16x16x64_bf16 v[12:15], v[222:225], v[68:75], v170 abid:1
ds_read_b128 v[48:51], v1 offset:0
v_add_u32_sdwa v86, s42, v123 dst_sel:DWORD dst_unused:UNUSED_PAD src0_sel:DWORD src1_sel:WORD_0
v_smfmac_f32_16x16x64_bf16 v[16:19], v[190:193], v[60:67], v167
ds_read_b128 v[52:55], v0 offset:2048
v_cvt_pk_bf16_f32 v92, v8, v9
v_smfmac_f32_16x16x64_bf16 v[16:19], v[226:229], v[68:75], v171
ds_read_b128 v[56:59], v1 offset:2048
v_cvt_pk_bf16_f32 v93, v10, v11
v_smfmac_f32_16x16x64_bf16 v[20:23], v[194:197], v[60:67], v167 abid:1
ds_read_b128 v[8:11], v2 offset:1024
v_cvt_pk_bf16_f32 v94, v12, v13
v_smfmac_f32_16x16x64_bf16 v[20:23], v[230:233], v[68:75], v171 abid:1
ds_read_u16 v76, v76
v_cvt_pk_bf16_f32 v95, v14, v15
v_smfmac_f32_16x16x64_bf16 v[24:27], v[198:201], v[60:67], v168
ds_read_b128 v[12:15], v2 offset:1088
v_cvt_pk_bf16_f32 v96, v16, v17
v_smfmac_f32_16x16x64_bf16 v[24:27], v[234:237], v[68:75], v172
s_waitcnt lgkmcnt(7)
ds_read_u16 v77, v77
v_cvt_pk_bf16_f32 v97, v18, v19
v_smfmac_f32_16x16x64_bf16 v[28:31], v[202:205], v[60:67], v168 abid:1
buffer_store_dwordx2 v[112:113], v5, s[20:23], s66 offen sc1
ds_read_b128 v[16:19], v2 offset:1152
v_cvt_pk_bf16_f32 v98, v20, v21
v_smfmac_f32_16x16x64_bf16 v[28:31], v[238:241], v[68:75], v172 abid:1
ds_read_u16 v78, v78
v_cvt_pk_bf16_f32 v99, v22, v23
v_smfmac_f32_16x16x64_bf16 v[32:35], v[206:209], v[60:67], v169
ds_read_b128 v[20:23], v2 offset:1216
v_cvt_pk_bf16_f32 v100, v24, v25
v_smfmac_f32_16x16x64_bf16 v[32:35], v[242:245], v[68:75], v173
ds_read_u16 v79, v79
v_cvt_pk_bf16_f32 v101, v26, v27
v_smfmac_f32_16x16x64_bf16 v[36:39], v[210:213], v[60:67], v169 abid:1
ds_read_b128 v[24:27], v2 offset:1280
v_cvt_pk_bf16_f32 v102, v28, v29
v_smfmac_f32_16x16x64_bf16 v[36:39], v[246:249], v[68:75], v173 abid:1
ds_read_u16 v80, v80
v_cvt_pk_bf16_f32 v103, v30, v31
v_smfmac_f32_16x16x64_bf16 v[40:43], v[214:217], v[60:67], v177 abid:1
s_bitcmp1_b32 s12, s41
ds_read_b128 v[28:31], v2 offset:1344
v_cvt_pk_bf16_f32 v104, v32, v33
v_smfmac_f32_16x16x64_bf16 v[40:43], v[250:253], v[68:75], v178
s_waitcnt lgkmcnt(10)
v_cvt_pk_bf16_f32 v105, v34, v35
s_cbranch_scc1 L_loopnk
s_cmp_eq_u32 s41, s59
s_cbranch_scc1 L_loopck
s_cmp_lt_u32 s41, s15
s_cbranch_scc1 L_loopk
s_nop 0
v_cndmask_b32_dpp v108, v96, v92, vcc quad_perm:[1,0,3,2] row_mask:0xf bank_mask:0xf
v_cndmask_b32_dpp v109, v97, v93, vcc quad_perm:[1,0,3,2] row_mask:0xf bank_mask:0xf
v_cndmask_b32_dpp v110, v98, v94, vcc quad_perm:[1,0,3,2] row_mask:0xf bank_mask:0xf
v_cndmask_b32_dpp v111, v99, v95, vcc quad_perm:[1,0,3,2] row_mask:0xf bank_mask:0xf
buffer_store_dwordx4 v[108:111], v4, s[20:23], s46 offen offset:0 sc1
s_mov_b64 vcc, s[82:83]
v_cvt_pk_bf16_f32 v112, v40, v41
v_cvt_pk_bf16_f32 v113, v42, v43
ds_write_b64 v254, v[112:113]
v_cndmask_b32_dpp v96, v92, v96, vcc quad_perm:[1,0,3,2] row_mask:0xf bank_mask:0xf
v_cndmask_b32_dpp v97, v93, v97, vcc quad_perm:[1,0,3,2] row_mask:0xf bank_mask:0xf
v_cndmask_b32_dpp v98, v94, v98, vcc quad_perm:[1,0,3,2] row_mask:0xf bank_mask:0xf
v_cndmask_b32_dpp v99, v95, v99, vcc quad_perm:[1,0,3,2] row_mask:0xf bank_mask:0xf
buffer_store_dwordx4 v[96:99], v4, s[20:23], s46 offen offset:1152 sc1
s_mov_b64 vcc, s[80:81]
v_cvt_pk_bf16_f32 v106, v36, v37
v_cvt_pk_bf16_f32 v107, v38, v39
s_waitcnt lgkmcnt(0)
s_barrier
ds_read_b64 v[112:113], v6
v_cndmask_b32_dpp v92, v104, v100, vcc quad_perm:[1,0,3,2] row_mask:0xf bank_mask:0xf
v_cndmask_b32_dpp v93, v105, v101, vcc quad_perm:[1,0,3,2] row_mask:0xf bank_mask:0xf
v_cndmask_b32_dpp v94, v106, v102, vcc quad_perm:[1,0,3,2] row_mask:0xf bank_mask:0xf
v_cndmask_b32_dpp v95, v107, v103, vcc quad_perm:[1,0,3,2] row_mask:0xf bank_mask:0xf
buffer_store_dwordx4 v[92:95], v4, s[20:23], s46 offen offset:128 sc1
s_mov_b64 vcc, s[82:83]
v_cndmask_b32_dpp v104, v100, v104, vcc quad_perm:[1,0,3,2] row_mask:0xf bank_mask:0xf
v_cndmask_b32_dpp v105, v101, v105, vcc quad_perm:[1,0,3,2] row_mask:0xf bank_mask:0xf
v_cndmask_b32_dpp v106, v102, v106, vcc quad_perm:[1,0,3,2] row_mask:0xf bank_mask:0xf
v_cndmask_b32_dpp v107, v103, v107, vcc quad_perm:[1,0,3,2] row_mask:0xf bank_mask:0xf
buffer_store_dwordx4 v[104:107], v4, s[20:23], s46 offen offset:1280 sc1
s_mov_b64 vcc, s[80:81]
s_waitcnt lgkmcnt(0)
buffer_store_dwordx2 v[112:113], v5, s[20:23], s46 offen sc1
s_branch L_fin
L_loopk_w:
s_bitcmp1_b32 s87, s41
s_waitcnt vmcnt(15)
s_cbranch_scc0 L_loopk_wb
s_waitcnt vmcnt(10)
s_branch L_loopk_wb
L_loopnk_w:
s_bitcmp1_b32 s87, s41
s_waitcnt vmcnt(15)
s_cbranch_scc0 L_loopnk_wb
s_waitcnt vmcnt(10)
s_branch L_loopnk_wb
L_slow:
s_waitcnt vmcnt(0) lgkmcnt(0)
s_mov_b32 s87, 0
L_sm:
s_lshl_b32 s86, s2, 1
s_add_u32 s86, s86, s87
s_add_u32 s86, s86, 2
s_mul_i32 s86, s86, 393216
s_mov_b32 s84, 0
L_st:
s_and_b32 s48, s84, 3
s_lshr_b32 s49, s84, 2
s_cmp_ge_u32 s84, 36
s_cbranch_scc1 L_pbg
s_mul_i32 s52, s49, 288
s_add_u32 s52, s52, s48
s_lshl_b32 s52, s52, 8
v_lshl_add_u32 v50, v7, 2, s52
L_pbbg:
s_mul_i32 s52, s40, 18432
v_mov_b32 v62, s52
v_add_u32 v50, v62, v50
buffer_load_dword v8, v50, s[28:31], 0 offen offset:0
buffer_load_dword v9, v50, s[28:31], 0 offen offset:1152
buffer_load_dword v10, v50, s[28:31], 0 offen offset:2304
buffer_load_dword v11, v50, s[28:31], 0 offen offset:3456
v_add_u32 v50, 4608, v50
buffer_load_dword v12, v50, s[28:31], 0 offen offset:0
buffer_load_dword v13, v50, s[28:31], 0 offen offset:1152
buffer_load_dword v14, v50, s[28:31], 0 offen offset:2304
buffer_load_dword v15, v50, s[28:31], 0 offen offset:3456
v_add_u32 v50, 4608, v50
buffer_load_dword v16, v50, s[28:31], 0 offen offset:0
buffer_load_dword v17, v50, s[28:31], 0 offen offset:1152
buffer_load_dword v18, v50, s[28:31], 0 offen offset:2304
buffer_load_dword v19, v50, s[28:31], 0 offen offset:3456
v_add_u32 v50, 4608, v50
buffer_load_dword v20, v50, s[28:31], 0 offen offset:0
buffer_load_dword v21, v50, s[28:31], 0 offen offset:1152
buffer_load_dword v22, v50, s[28:31], 0 offen offset:2304
buffer_load_dword v23, v50, s[28:31], 0 offen offset:3456
s_branch L_pcg
L_pbg:
s_mul_i32 s52, s84, 147456
s_sub_u32 s52, s52, 5307392
v_and_b32 v62, 2, v7
v_mul_u32_u24 v50, 36864, v62
v_and_b32 v62, 1, v7
v_lshl_add_u32 v50, v62, 2, v50
v_and_b32 v62, 4, v7
v_lshl_add_u32 v50, v62, 3, v50
v_and_b32 v62, 32, v7
v_lshl_add_u32 v50, v62, 1, v50
v_and_b32 v62, 24, v7
v_add3_u32 v50, v50, v62, s52
s_branch L_pbbg
L_pcg:
s_sub_u32 s50, s84, 36
s_lshl_b32 s51, s40, 4
v_and_b32 v58, 1, v7
v_bfe_u32 v59, v7, 1, 1
v_bfe_u32 v60, v7, 3, 2
s_mul_i32 s52, s48, 9
s_add_u32 s52, s52, s49
s_mul_i32 s53, s52, 9
s_mul_i32 s54, s50, 18
s_add_u32 s54, s54, 8
s_lshl_b32 s55, s52, 2
s_add_u32 s55, s55, s40
s_lshl_b32 s56, s50, 2
s_add_u32 s56, s56, s40
s_cmp_eq_u32 s84, 40
s_cselect_b32 s57, 0x100000, 9
s_cmp_lt_u32 s84, 36
s_cselect_b32 s53, s53, s54
s_cselect_b32 s54, 2, 81
s_cselect_b32 s57, 1, s57
s_cselect_b32 s55, s55, s56
s_mov_b32 s56, 331776
s_cselect_b32 s56, s56, 368640
s_mov_b32 s58, 373760
s_cselect_b32 s58, s58, 382976
s_cselect_b32 s59, 16, 4
s_cselect_b32 s60, 4, 64
s_cselect_b32 s61, 12, 11
s_cselect_b32 s62, 1, 0x8001
v_bfe_u32 v61, v7, 2, 1
v_lshrrev_b32 v62, 5, v7
v_lshl_add_u32 v61, v62, 1, v61
v_lshlrev_b32 v62, 1, v58
v_lshl_add_u32 v60, v60, 2, v62
v_add_u32 v62, v60, v59
v_mul_u32_u24 v51, s54, v61
v_add_lshl_u32 v51, v51, s53, 6
v_add3_u32 v51, v51, v62, s51
v_lshl_add_u32 v51, v51, 4, s86
s_lshl_b32 s57, s57, 10
v_add_u32 v66, s57, v51
s_lshl_b32 s52, s55, 8
s_add_u32 s52, s52, s56
s_add_u32 s52, s52, s86
v_mul_u32_u24 v52, s59, v62
v_mad_u32_u24 v52, v61, s60, v52
v_lshl_add_u32 v54, v7, 2, s52
v_mov_b32 v55, 0x05040100
v_mov_b32 v62, 0x03020706
v_cmp_eq_u32 vcc, 1, v59
v_mov_b32 v68, 0xf0a0500
v_mov_b32 v69, 0x8f8a8580
v_mov_b32 v70, 0x1f1a1510
v_mov_b32 v71, 0x9f9a9590
v_mov_b32 v72, 0x2f2a2520
v_mov_b32 v73, 0xafaaa5a0
v_mov_b32 v74, 0x3f3a3530
v_mov_b32 v75, 0xbfbab5b0
v_cndmask_b32 v55, v55, v62, vcc
s_mov_b32 s64, 0x5040500
s_mov_b32 s65, 0x5040501
s_mov_b32 s66, 0x5040502
s_mov_b32 s67, 0x5040503
s_mov_b32 s68, 0x7060700
s_mov_b32 s69, 0x7060701
s_mov_b32 s70, 0x7060702
s_mov_b32 s71, 0x7060703
s_mov_b32 s72, 0x05060102
s_cmp_lg_u32 s87, 0
s_waitcnt vmcnt(12)
v_perm_b32 v24, v8, v68, s64
v_perm_b32 v25, v9, v68, s65
v_perm_b32 v26, v10, v68, s66
v_perm_b32 v27, v11, v68, s67
v_max3_f32 v28, |v24|, |v25|, |v26|
v_med3_f32 v29, |v24|, |v25|, |v26|
v_min3_f32 v30, |v24|, |v25|, |v26|
v_med3_f32 v32, v28, v29, |v27|
v_med3_f32 v33, v29, v30, |v27|
v_max_f32 v31, v28, |v27|
v_cmp_eq_u32_sdwa vcc, v33, v32 src0_sel:WORD_1 src1_sel:WORD_1
s_cbranch_scc0 L_rb0g
v_min_f32 v30, v30, |v27|
v_cndmask_b32 v31, 0, v33, vcc
v_cmp_eq_u32_sdwa vcc, v30, v32 src0_sel:WORD_1 src1_sel:WORD_1
s_nop 1
v_cndmask_b32 v32, 0, v30, vcc
L_rb0g:
v_perm_b32 v36, v31, v32, s72
v_bfi_b32 v44, 3, v32, v31
v_perm_b32 v24, v8, v69, s68
v_perm_b32 v25, v9, v69, s69
v_perm_b32 v26, v10, v69, s70
v_perm_b32 v27, v11, v69, s71
v_max3_f32 v28, |v24|, |v25|, |v26|
v_med3_f32 v29, |v24|, |v25|, |v26|
v_min3_f32 v30, |v24|, |v25|, |v26|
v_med3_f32 v32, v28, v29, |v27|
v_med3_f32 v33, v29, v30, |v27|
v_max_f32 v31, v28, |v27|
v_cmp_eq_u32_sdwa vcc, v33, v32 src0_sel:WORD_1 src1_sel:WORD_1
s_cbranch_scc0 L_rb1g
v_min_f32 v30, v30, |v27|
v_cndmask_b32 v31, 0, v33, vcc
v_cmp_eq_u32_sdwa vcc, v30, v32 src0_sel:WORD_1 src1_sel:WORD_1
s_nop 1
v_cndmask_b32 v32, 0, v30, vcc
L_rb1g:
v_perm_b32 v40, v31, v32, s72
v_bfi_b32 v46, 3, v32, v31
s_waitcnt vmcnt(8)
v_perm_b32 v24, v12, v70, s64
v_perm_b32 v25, v13, v70, s65
v_perm_b32 v26, v14, v70, s66
v_perm_b32 v27, v15, v70, s67
v_max3_f32 v28, |v24|, |v25|, |v26|
v_med3_f32 v29, |v24|, |v25|, |v26|
v_min3_f32 v30, |v24|, |v25|, |v26|
v_med3_f32 v32, v28, v29, |v27|
v_med3_f32 v33, v29, v30, |v27|
v_max_f32 v31, v28, |v27|
v_cmp_eq_u32_sdwa vcc, v33, v32 src0_sel:WORD_1 src1_sel:WORD_1
s_cbranch_scc0 L_rb2g
v_min_f32 v30, v30, |v27|
v_cndmask_b32 v31, 0, v33, vcc
v_cmp_eq_u32_sdwa vcc, v30, v32 src0_sel:WORD_1 src1_sel:WORD_1
s_nop 1
v_cndmask_b32 v32, 0, v30, vcc
L_rb2g:
v_perm_b32 v37, v31, v32, s72
v_bfi_b32 v31, 3, v32, v31
v_lshlrev_b32 v31, 4, v31
v_bfi_b32 v44, 15, v44, v31
v_perm_b32 v24, v12, v71, s68
v_perm_b32 v25, v13, v71, s69
v_perm_b32 v26, v14, v71, s70
v_perm_b32 v27, v15, v71, s71
v_max3_f32 v28, |v24|, |v25|, |v26|
v_med3_f32 v29, |v24|, |v25|, |v26|
v_min3_f32 v30, |v24|, |v25|, |v26|
v_med3_f32 v32, v28, v29, |v27|
v_med3_f32 v33, v29, v30, |v27|
v_max_f32 v31, v28, |v27|
v_cmp_eq_u32_sdwa vcc, v33, v32 src0_sel:WORD_1 src1_sel:WORD_1
s_cbranch_scc0 L_rb3g
v_min_f32 v30, v30, |v27|
v_cndmask_b32 v31, 0, v33, vcc
v_cmp_eq_u32_sdwa vcc, v30, v32 src0_sel:WORD_1 src1_sel:WORD_1
s_nop 1
v_cndmask_b32 v32, 0, v30, vcc
L_rb3g:
v_perm_b32 v41, v31, v32, s72
v_bfi_b32 v31, 3, v32, v31
v_lshlrev_b32 v31, 4, v31
v_bfi_b32 v46, 15, v46, v31
s_waitcnt vmcnt(4)
v_perm_b32 v24, v16, v72, s64
v_perm_b32 v25, v17, v72, s65
v_perm_b32 v26, v18, v72, s66
v_perm_b32 v27, v19, v72, s67
v_max3_f32 v28, |v24|, |v25|, |v26|
v_med3_f32 v29, |v24|, |v25|, |v26|
v_min3_f32 v30, |v24|, |v25|, |v26|
v_med3_f32 v32, v28, v29, |v27|
v_med3_f32 v33, v29, v30, |v27|
v_max_f32 v31, v28, |v27|
v_cmp_eq_u32_sdwa vcc, v33, v32 src0_sel:WORD_1 src1_sel:WORD_1
s_cbranch_scc0 L_rb4g
v_min_f32 v30, v30, |v27|
v_cndmask_b32 v31, 0, v33, vcc
v_cmp_eq_u32_sdwa vcc, v30, v32 src0_sel:WORD_1 src1_sel:WORD_1
s_nop 1
v_cndmask_b32 v32, 0, v30, vcc
L_rb4g:
v_perm_b32 v38, v31, v32, s72
v_bfi_b32 v45, 3, v32, v31
v_perm_b32 v24, v16, v73, s68
v_perm_b32 v25, v17, v73, s69
v_perm_b32 v26, v18, v73, s70
v_perm_b32 v27, v19, v73, s71
v_max3_f32 v28, |v24|, |v25|, |v26|
v_med3_f32 v29, |v24|, |v25|, |v26|
v_min3_f32 v30, |v24|, |v25|, |v26|
v_med3_f32 v32, v28, v29, |v27|
v_med3_f32 v33, v29, v30, |v27|
v_max_f32 v31, v28, |v27|
v_cmp_eq_u32_sdwa vcc, v33, v32 src0_sel:WORD_1 src1_sel:WORD_1
s_cbranch_scc0 L_rb5g
v_min_f32 v30, v30, |v27|
v_cndmask_b32 v31, 0, v33, vcc
v_cmp_eq_u32_sdwa vcc, v30, v32 src0_sel:WORD_1 src1_sel:WORD_1
s_nop 1
v_cndmask_b32 v32, 0, v30, vcc
L_rb5g:
v_perm_b32 v42, v31, v32, s72
v_bfi_b32 v47, 3, v32, v31
s_waitcnt vmcnt(0)
v_perm_b32 v24, v20, v74, s64
v_perm_b32 v25, v21, v74, s65
v_perm_b32 v26, v22, v74, s66
v_perm_b32 v27, v23, v74, s67
v_max3_f32 v28, |v24|, |v25|, |v26|
v_med3_f32 v29, |v24|, |v25|, |v26|
v_min3_f32 v30, |v24|, |v25|, |v26|
v_med3_f32 v32, v28, v29, |v27|
v_med3_f32 v33, v29, v30, |v27|
v_max_f32 v31, v28, |v27|
v_cmp_eq_u32_sdwa vcc, v33, v32 src0_sel:WORD_1 src1_sel:WORD_1
s_cbranch_scc0 L_rb6g
v_min_f32 v30, v30, |v27|
v_cndmask_b32 v31, 0, v33, vcc
v_cmp_eq_u32_sdwa vcc, v30, v32 src0_sel:WORD_1 src1_sel:WORD_1
s_nop 1
v_cndmask_b32 v32, 0, v30, vcc
L_rb6g:
v_perm_b32 v39, v31, v32, s72
v_bfi_b32 v31, 3, v32, v31
v_lshlrev_b32 v31, 4, v31
v_bfi_b32 v45, 15, v45, v31
v_perm_b32 v24, v20, v75, s68
v_perm_b32 v25, v21, v75, s69
v_perm_b32 v26, v22, v75, s70
v_perm_b32 v27, v23, v75, s71
v_max3_f32 v28, |v24|, |v25|, |v26|
v_med3_f32 v29, |v24|, |v25|, |v26|
v_min3_f32 v30, |v24|, |v25|, |v26|
v_med3_f32 v32, v28, v29, |v27|
v_med3_f32 v33, v29, v30, |v27|
v_max_f32 v31, v28, |v27|
v_cmp_eq_u32_sdwa vcc, v33, v32 src0_sel:WORD_1 src1_sel:WORD_1
s_cbranch_scc0 L_rb7g
v_min_f32 v30, v30, |v27|
v_cndmask_b32 v31, 0, v33, vcc
v_cmp_eq_u32_sdwa vcc, v30, v32 src0_sel:WORD_1 src1_sel:WORD_1
s_nop 1
v_cndmask_b32 v32, 0, v30, vcc
L_rb7g:
v_perm_b32 v43, v31, v32, s72
v_bfi_b32 v31, 3, v32, v31
v_lshlrev_b32 v31, 4, v31
v_bfi_b32 v47, 15, v47, v31
s_mov_b32 vcc_lo, 0x33333333
s_mov_b32 vcc_hi, 0x33333333
v_cndmask_b32_dpp v24, v40, v36, vcc quad_perm:[2,3,0,1] row_mask:0xf bank_mask:0xf
v_cndmask_b32_dpp v25, v41, v37, vcc quad_perm:[2,3,0,1] row_mask:0xf bank_mask:0xf
v_cndmask_b32_dpp v26, v42, v38, vcc quad_perm:[2,3,0,1] row_mask:0xf bank_mask:0xf
v_cndmask_b32_dpp v27, v43, v39, vcc quad_perm:[2,3,0,1] row_mask:0xf bank_mask:0xf
s_not_b64 vcc, vcc
buffer_store_dwordx4 v[24:27], v51, s[24:27], 0 offen sc1
v_cndmask_b32_dpp v40, v36, v40, vcc quad_perm:[2,3,0,1] row_mask:0xf bank_mask:0xf
v_cndmask_b32_dpp v41, v37, v41, vcc quad_perm:[2,3,0,1] row_mask:0xf bank_mask:0xf
v_cndmask_b32_dpp v42, v38, v42, vcc quad_perm:[2,3,0,1] row_mask:0xf bank_mask:0xf
v_cndmask_b32_dpp v43, v39, v43, vcc quad_perm:[2,3,0,1] row_mask:0xf bank_mask:0xf
s_mov_b32 s52, 0x0c0c0400
s_mov_b32 s53, 0x04000c0c
buffer_store_dwordx4 v[40:43], v66, s[24:27], 0 offen sc1
v_perm_b32 v48, v45, v44, s52
v_perm_b32 v49, v47, v46, s53
v_or_b32 v48, v48, v49
s_nop 1
v_mov_b32_dpp v49, v48 quad_perm:[2,3,0,1] row_mask:0xf bank_mask:0xf
v_perm_b32 v48, v49, v48, v55
ds_permute_b32 v48, v52, v48
s_waitcnt lgkmcnt(0)
buffer_store_dword v48, v54, s[24:27], 0 offen sc1
s_waitcnt vmcnt(0)
s_add_u32 s84, s84, 1
s_cmp_lt_u32 s84, 41
s_cbranch_scc1 L_st
s_add_u32 s87, s87, 1
s_cmp_lt_u32 s87, 2
s_cbranch_scc1 L_sm
v_lshrrev_b32 v72, 3, v7
v_and_b32 v73, 7, v7
v_xor_b32 v73, v73, v72
v_mul_u32_u24 v72, 1152, v72
s_and_b32 s47, s40, 1
s_mul_i32 s47, s47, 9216
s_lshr_b32 s3, s40, 1
s_lshl_b32 s3, s3, 7
s_add_u32 s47, s47, s3
v_lshl_add_u32 v72, v73, 4, v72
v_add_u32 v3, s47, v72
s_lshl_b32 s44, s40, 10
s_mul_i32 s45, s2, 18432
s_mov_b32 s46, s45
s_lshr_b32 s47, s40, 1
s_lshl_b32 s3, s47, 11
s_sub_u32 s8, 15488, s3
s_lshl_b32 s3, s47, 7
s_add_u32 s7, s45, 128
s_sub_u32 s7, s7, s3
s_sub_u32 s10, s47, 1
s_sub_u32 s11, 0, s47
s_mov_b32 s9, s44
s_mov_b32 s13, 4718592
s_mov_b32 s15, 16
s_mov_b32 s14, s13
s_mov_b32 s22, 75497472
s_mov_b32 s18, 75497472
s_mov_b32 s41, 0
s_bitcmp1_b32 s2, 0
s_cselect_b32 s15, 16, 22
L_stile:
s_barrier
s_add_u32 m0, s44, 0
s_nop 0
buffer_load_dwordx4 v3, s[16:19], s45 offen offset:0 nt lds
s_add_u32 m0, s44, 3840
s_nop 0
buffer_load_dwordx4 v3, s[16:19], s45 offen offset:256 nt lds
s_add_u32 m0, s44, 7680
s_nop 0
buffer_load_dwordx4 v3, s[16:19], s45 offen offset:512 nt lds
s_add_u32 m0, s44, 11520
s_nop 0
buffer_load_dwordx4 v3, s[16:19], s45 offen offset:768 nt lds
s_add_u32 m0, s44, s8
s_mov_b64 exec, s[10:11]
buffer_load_dwordx4 v3, s[16:19], s7 offen offset:896 nt lds
s_mov_b64 exec, -1
ds_read_b128 v[8:11], v2 offset:1024
ds_read_b128 v[12:15], v2 offset:1088
ds_read_b128 v[16:19], v2 offset:1152
ds_read_b128 v[20:23], v2 offset:1216
ds_read_b128 v[24:27], v2 offset:1280
ds_read_b128 v[28:31], v2 offset:1344
ds_read_b128 v[32:35], v2 offset:1408
ds_read_b128 v[36:39], v2 offset:1472
ds_read_b128 v[40:43], v2 offset:1536
s_mov_b32 s87, 0
L_spass:
s_lshl_b32 s86, s2, 1
s_add_u32 s86, s86, s87
s_add_u32 s86, s86, 2
s_mul_i32 s86, s86, 393216
s_mul_i32 s47, s40, 82944
s_add_u32 s47, s47, s86
v_lshl_add_u32 v104, v7, 4, s47
s_mul_i32 s47, s40, 9216
s_add_u32 s47, s47, s86
s_add_u32 s47, s47, 331776
v_lshl_add_u32 v105, v7, 4, s47
s_lshl_b32 s47, s40, 6
s_add_u32 s47, s47, s86
s_add_u32 s47, s47, 368640
v_and_b32 v106, 15, v7
v_lshl_add_u32 v106, v106, 2, s47
v_lshrrev_b32 v107, 4, v7
v_lshl_add_u32 v106, v107, 8, v106
buffer_load_dword v174, v106, s[24:27], 0 offen offset:0 sc1
buffer_load_dword v175, v106, s[24:27], 0 offen offset:1024 sc1
buffer_load_dword v176, v106, s[24:27], 0 offen offset:2048 sc1
buffer_load_dword v177, v106, s[24:27], 0 offen offset:3072 sc1
s_mov_b32 s99, 4096
buffer_load_dword v178, v106, s[24:27], s99 offen offset:0 sc1
s_mov_b32 s98, 0
buffer_load_dwordx4 v[138:141], v105, s[24:27], s98 offen sc1
s_mov_b32 s99, 0
buffer_load_dwordx4 a[0:3], v104, s[24:27], s99 offen offset:0 sc1
buffer_load_dwordx4 a[4:7], v104, s[24:27], s99 offen offset:1024 sc1
buffer_load_dwordx4 a[8:11], v104, s[24:27], s99 offen offset:2048 sc1
buffer_load_dwordx4 a[12:15], v104, s[24:27], s99 offen offset:3072 sc1
s_mov_b32 s99, 4096
buffer_load_dwordx4 a[16:19], v104, s[24:27], s99 offen offset:0 sc1
buffer_load_dwordx4 a[20:23], v104, s[24:27], s99 offen offset:1024 sc1
buffer_load_dwordx4 a[24:27], v104, s[24:27], s99 offen offset:2048 sc1
buffer_load_dwordx4 a[28:31], v104, s[24:27], s99 offen offset:3072 sc1
s_mov_b32 s99, 8192
buffer_load_dwordx4 a[32:35], v104, s[24:27], s99 offen offset:0 sc1
s_mov_b32 s98, 1024
buffer_load_dwordx4 v[142:145], v105, s[24:27], s98 offen sc1
buffer_load_dwordx4 a[36:39], v104, s[24:27], s99 offen offset:1024 sc1
buffer_load_dwordx4 a[40:43], v104, s[24:27], s99 offen offset:2048 sc1
buffer_load_dwordx4 a[44:47], v104, s[24:27], s99 offen offset:3072 sc1
s_mov_b32 s99, 12288
buffer_load_dwordx4 a[48:51], v104, s[24:27], s99 offen offset:0 sc1
buffer_load_dwordx4 a[52:55], v104, s[24:27], s99 offen offset:1024 sc1
buffer_load_dwordx4 a[56:59], v104, s[24:27], s99 offen offset:2048 sc1
buffer_load_dwordx4 a[60:63], v104, s[24:27], s99 offen offset:3072 sc1
s_mov_b32 s99, 16384
buffer_load_dwordx4 a[64:67], v104, s[24:27], s99 offen offset:0 sc1
buffer_load_dwordx4 a[68:71], v104, s[24:27], s99 offen offset:1024 sc1
s_mov_b32 s98, 2048
buffer_load_dwordx4 v[146:149], v105, s[24:27], s98 offen sc1
buffer_load_dwordx4 a[72:75], v104, s[24:27], s99 offen offset:2048 sc1
buffer_load_dwordx4 a[76:79], v104, s[24:27], s99 offen offset:3072 sc1
s_mov_b32 s99, 20480
buffer_load_dwordx4 a[80:83], v104, s[24:27], s99 offen offset:0 sc1
buffer_load_dwordx4 a[84:87], v104, s[24:27], s99 offen offset:1024 sc1
buffer_load_dwordx4 a[88:91], v104, s[24:27], s99 offen offset:2048 sc1
buffer_load_dwordx4 a[92:95], v104, s[24:27], s99 offen offset:3072 sc1
s_mov_b32 s99, 24576
buffer_load_dwordx4 a[96:99], v104, s[24:27], s99 offen offset:0 sc1
buffer_load_dwordx4 a[100:103], v104, s[24:27], s99 offen offset:1024 sc1
buffer_load_dwordx4 a[104:107], v104, s[24:27], s99 offen offset:2048 sc1
s_mov_b32 s98, 3072
buffer_load_dwordx4 v[150:153], v105, s[24:27], s98 offen sc1
buffer_load_dwordx4 a[108:111], v104, s[24:27], s99 offen offset:3072 sc1
s_mov_b32 s99, 28672
buffer_load_dwordx4 a[112:115], v104, s[24:27], s99 offen offset:0 sc1
buffer_load_dwordx4 a[116:119], v104, s[24:27], s99 offen offset:1024 sc1
buffer_load_dwordx4 a[120:123], v104, s[24:27], s99 offen offset:2048 sc1
buffer_load_dwordx4 a[124:127], v104, s[24:27], s99 offen offset:3072 sc1
s_mov_b32 s99, 32768
buffer_load_dwordx4 a[128:131], v104, s[24:27], s99 offen offset:0 sc1
buffer_load_dwordx4 a[132:135], v104, s[24:27], s99 offen offset:1024 sc1
buffer_load_dwordx4 a[136:139], v104, s[24:27], s99 offen offset:2048 sc1
buffer_load_dwordx4 a[140:143], v104, s[24:27], s99 offen offset:3072 sc1
s_mov_b32 s98, 4096
buffer_load_dwordx4 v[154:157], v105, s[24:27], s98 offen sc1
s_mov_b32 s99, 36864
buffer_load_dwordx4 a[144:147], v104, s[24:27], s99 offen offset:0 sc1
buffer_load_dwordx4 a[148:151], v104, s[24:27], s99 offen offset:1024 sc1
buffer_load_dwordx4 a[152:155], v104, s[24:27], s99 offen offset:2048 sc1
buffer_load_dwordx4 a[156:159], v104, s[24:27], s99 offen offset:3072 sc1
s_mov_b32 s99, 40960
buffer_load_dwordx4 a[160:163], v104, s[24:27], s99 offen offset:0 sc1
buffer_load_dwordx4 a[164:167], v104, s[24:27], s99 offen offset:1024 sc1
buffer_load_dwordx4 a[168:171], v104, s[24:27], s99 offen offset:2048 sc1
buffer_load_dwordx4 a[172:175], v104, s[24:27], s99 offen offset:3072 sc1
s_mov_b32 s99, 45056
buffer_load_dwordx4 a[176:179], v104, s[24:27], s99 offen offset:0 sc1
s_mov_b32 s98, 5120
buffer_load_dwordx4 v[158:161], v105, s[24:27], s98 offen sc1
buffer_load_dwordx4 a[180:183], v104, s[24:27], s99 offen offset:1024 sc1
buffer_load_dwordx4 a[184:187], v104, s[24:27], s99 offen offset:2048 sc1
buffer_load_dwordx4 a[188:191], v104, s[24:27], s99 offen offset:3072 sc1
s_mov_b32 s99, 49152
buffer_load_dwordx4 a[192:195], v104, s[24:27], s99 offen offset:0 sc1
buffer_load_dwordx4 a[196:199], v104, s[24:27], s99 offen offset:1024 sc1
buffer_load_dwordx4 a[200:203], v104, s[24:27], s99 offen offset:2048 sc1
buffer_load_dwordx4 a[204:207], v104, s[24:27], s99 offen offset:3072 sc1
s_mov_b32 s99, 53248
buffer_load_dwordx4 a[208:211], v104, s[24:27], s99 offen offset:0 sc1
buffer_load_dwordx4 a[212:215], v104, s[24:27], s99 offen offset:1024 sc1
s_mov_b32 s98, 6144
buffer_load_dwordx4 v[162:165], v105, s[24:27], s98 offen sc1
buffer_load_dwordx4 a[216:219], v104, s[24:27], s99 offen offset:2048 sc1
buffer_load_dwordx4 a[220:223], v104, s[24:27], s99 offen offset:3072 sc1
s_mov_b32 s99, 57344
buffer_load_dwordx4 a[224:227], v104, s[24:27], s99 offen offset:0 sc1
buffer_load_dwordx4 a[228:231], v104, s[24:27], s99 offen offset:1024 sc1
buffer_load_dwordx4 a[232:235], v104, s[24:27], s99 offen offset:2048 sc1
buffer_load_dwordx4 a[236:239], v104, s[24:27], s99 offen offset:3072 sc1
s_mov_b32 s99, 61440
buffer_load_dwordx4 a[240:243], v104, s[24:27], s99 offen offset:0 sc1
buffer_load_dwordx4 a[244:247], v104, s[24:27], s99 offen offset:1024 sc1
buffer_load_dwordx4 a[248:251], v104, s[24:27], s99 offen offset:2048 sc1
s_mov_b32 s98, 7168
buffer_load_dwordx4 v[166:169], v105, s[24:27], s98 offen sc1
buffer_load_dwordx4 a[252:255], v104, s[24:27], s99 offen offset:3072 sc1
s_mov_b32 s99, 65536
buffer_load_dwordx4 v[186:189], v104, s[24:27], s99 offen offset:0 sc1
buffer_load_dwordx4 v[190:193], v104, s[24:27], s99 offen offset:1024 sc1
buffer_load_dwordx4 v[194:197], v104, s[24:27], s99 offen offset:2048 sc1
buffer_load_dwordx4 v[198:201], v104, s[24:27], s99 offen offset:3072 sc1
s_mov_b32 s99, 69632
buffer_load_dwordx4 v[202:205], v104, s[24:27], s99 offen offset:0 sc1
buffer_load_dwordx4 v[206:209], v104, s[24:27], s99 offen offset:1024 sc1
buffer_load_dwordx4 v[210:213], v104, s[24:27], s99 offen offset:2048 sc1
buffer_load_dwordx4 v[214:217], v104, s[24:27], s99 offen offset:3072 sc1
s_mov_b32 s98, 8192
buffer_load_dwordx4 v[170:173], v105, s[24:27], s98 offen sc1
s_mov_b32 s99, 73728
buffer_load_dwordx4 v[218:221], v104, s[24:27], s99 offen offset:0 sc1
buffer_load_dwordx4 v[222:225], v104, s[24:27], s99 offen offset:1024 sc1
buffer_load_dwordx4 v[226:229], v104, s[24:27], s99 offen offset:2048 sc1
buffer_load_dwordx4 v[230:233], v104, s[24:27], s99 offen offset:3072 sc1
s_mov_b32 s99, 77824
buffer_load_dwordx4 v[234:237], v104, s[24:27], s99 offen offset:0 sc1
buffer_load_dwordx4 v[238:241], v104, s[24:27], s99 offen offset:1024 sc1
buffer_load_dwordx4 v[242:245], v104, s[24:27], s99 offen offset:2048 sc1
buffer_load_dwordx4 v[246:249], v104, s[24:27], s99 offen offset:3072 sc1
s_mov_b32 s99, 81920
buffer_load_dwordx4 v[250:253], v104, s[24:27], s99 offen offset:0 sc1
s_waitcnt vmcnt(0)
s_barrier
ds_read_b128 v[44:47], v0 offset:0
ds_read_b128 v[48:51], v1 offset:0
s_waitcnt lgkmcnt(0)
v_smfmac_f32_16x16x64_bf16 v[8:11], a[0:3], v[44:51], v138
v_smfmac_f32_16x16x64_bf16 v[12:15], a[4:7], v[44:51], v138 abid:1
v_smfmac_f32_16x16x64_bf16 v[16:19], a[8:11], v[44:51], v139
v_smfmac_f32_16x16x64_bf16 v[20:23], a[12:15], v[44:51], v139 abid:1
v_smfmac_f32_16x16x64_bf16 v[24:27], a[16:19], v[44:51], v140
v_smfmac_f32_16x16x64_bf16 v[28:31], a[20:23], v[44:51], v140 abid:1
v_smfmac_f32_16x16x64_bf16 v[32:35], a[24:27], v[44:51], v141
v_smfmac_f32_16x16x64_bf16 v[36:39], a[28:31], v[44:51], v141 abid:1
v_smfmac_f32_16x16x64_bf16 v[40:43], a[32:35], v[44:51], v174
s_nop 7
ds_read_b128 v[44:47], v0 offset:2048
ds_read_b128 v[48:51], v1 offset:2048
s_waitcnt lgkmcnt(0)
v_smfmac_f32_16x16x64_bf16 v[8:11], a[36:39], v[44:51], v142
v_smfmac_f32_16x16x64_bf16 v[12:15], a[40:43], v[44:51], v142 abid:1
v_smfmac_f32_16x16x64_bf16 v[16:19], a[44:47], v[44:51], v143
v_smfmac_f32_16x16x64_bf16 v[20:23], a[48:51], v[44:51], v143 abid:1
v_smfmac_f32_16x16x64_bf16 v[24:27], a[52:55], v[44:51], v144
v_smfmac_f32_16x16x64_bf16 v[28:31], a[56:59], v[44:51], v144 abid:1
v_smfmac_f32_16x16x64_bf16 v[32:35], a[60:63], v[44:51], v145
v_smfmac_f32_16x16x64_bf16 v[36:39], a[64:67], v[44:51], v145 abid:1
v_smfmac_f32_16x16x64_bf16 v[40:43], a[68:71], v[44:51], v174 abid:1
s_nop 7
ds_read_b128 v[44:47], v0 offset:4096
ds_read_b128 v[48:51], v1 offset:4096
s_waitcnt lgkmcnt(0)
v_smfmac_f32_16x16x64_bf16 v[8:11], a[72:75], v[44:51], v146
v_smfmac_f32_16x16x64_bf16 v[12:15], a[76:79], v[44:51], v146 abid:1
v_smfmac_f32_16x16x64_bf16 v[16:19], a[80:83], v[44:51], v147
v_smfmac_f32_16x16x64_bf16 v[20:23], a[84:87], v[44:51], v147 abid:1
v_smfmac_f32_16x16x64_bf16 v[24:27], a[88:91], v[44:51], v148
v_smfmac_f32_16x16x64_bf16 v[28:31], a[92:95], v[44:51], v148 abid:1
v_smfmac_f32_16x16x64_bf16 v[32:35], a[96:99], v[44:51], v149
v_smfmac_f32_16x16x64_bf16 v[36:39], a[100:103], v[44:51], v149 abid:1
v_smfmac_f32_16x16x64_bf16 v[40:43], a[104:107], v[44:51], v175
s_nop 7
ds_read_b128 v[44:47], v0 offset:6144
ds_read_b128 v[48:51], v1 offset:6144
s_waitcnt lgkmcnt(0)
v_smfmac_f32_16x16x64_bf16 v[8:11], a[108:111], v[44:51], v150
v_smfmac_f32_16x16x64_bf16 v[12:15], a[112:115], v[44:51], v150 abid:1
v_smfmac_f32_16x16x64_bf16 v[16:19], a[116:119], v[44:51], v151
v_smfmac_f32_16x16x64_bf16 v[20:23], a[120:123], v[44:51], v151 abid:1
v_smfmac_f32_16x16x64_bf16 v[24:27], a[124:127], v[44:51], v152
v_smfmac_f32_16x16x64_bf16 v[28:31], a[128:131], v[44:51], v152 abid:1
v_smfmac_f32_16x16x64_bf16 v[32:35], a[132:135], v[44:51], v153
v_smfmac_f32_16x16x64_bf16 v[36:39], a[136:139], v[44:51], v153 abid:1
v_smfmac_f32_16x16x64_bf16 v[40:43], a[140:143], v[44:51], v175 abid:1
s_nop 7
ds_read_b128 v[44:47], v0 offset:8192
ds_read_b128 v[48:51], v1 offset:8192
s_waitcnt lgkmcnt(0)
v_smfmac_f32_16x16x64_bf16 v[8:11], a[144:147], v[44:51], v154
v_smfmac_f32_16x16x64_bf16 v[12:15], a[148:151], v[44:51], v154 abid:1
v_smfmac_f32_16x16x64_bf16 v[16:19], a[152:155], v[44:51], v155
v_smfmac_f32_16x16x64_bf16 v[20:23], a[156:159], v[44:51], v155 abid:1
v_smfmac_f32_16x16x64_bf16 v[24:27], a[160:163], v[44:51], v156
v_smfmac_f32_16x16x64_bf16 v[28:31], a[164:167], v[44:51], v156 abid:1
v_smfmac_f32_16x16x64_bf16 v[32:35], a[168:171], v[44:51], v157
v_smfmac_f32_16x16x64_bf16 v[36:39], a[172:175], v[44:51], v157 abid:1
v_smfmac_f32_16x16x64_bf16 v[40:43], a[176:179], v[44:51], v176
s_nop 7
ds_read_b128 v[44:47], v0 offset:10240
ds_read_b128 v[48:51], v1 offset:10240
s_waitcnt lgkmcnt(0)
v_smfmac_f32_16x16x64_bf16 v[8:11], a[180:183], v[44:51], v158
v_smfmac_f32_16x16x64_bf16 v[12:15], a[184:187], v[44:51], v158 abid:1
v_smfmac_f32_16x16x64_bf16 v[16:19], a[188:191], v[44:51], v159
v_smfmac_f32_16x16x64_bf16 v[20:23], a[192:195], v[44:51], v159 abid:1
v_smfmac_f32_16x16x64_bf16 v[24:27], a[196:199], v[44:51], v160
v_smfmac_f32_16x16x64_bf16 v[28:31], a[200:203], v[44:51], v160 abid:1
v_smfmac_f32_16x16x64_bf16 v[32:35], a[204:207], v[44:51], v161
v_smfmac_f32_16x16x64_bf16 v[36:39], a[208:211], v[44:51], v161 abid:1
v_smfmac_f32_16x16x64_bf16 v[40:43], a[212:215], v[44:51], v176 abid:1
s_nop 7
ds_read_b128 v[44:47], v0 offset:12288
ds_read_b128 v[48:51], v1 offset:12288
s_waitcnt lgkmcnt(0)
v_smfmac_f32_16x16x64_bf16 v[8:11], a[216:219], v[44:51], v162
v_smfmac_f32_16x16x64_bf16 v[12:15], a[220:223], v[44:51], v162 abid:1
v_smfmac_f32_16x16x64_bf16 v[16:19], a[224:227], v[44:51], v163
v_smfmac_f32_16x16x64_bf16 v[20:23], a[228:231], v[44:51], v163 abid:1
v_smfmac_f32_16x16x64_bf16 v[24:27], a[232:235], v[44:51], v164
v_smfmac_f32_16x16x64_bf16 v[28:31], a[236:239], v[44:51], v164 abid:1
v_smfmac_f32_16x16x64_bf16 v[32:35], a[240:243], v[44:51], v165
v_smfmac_f32_16x16x64_bf16 v[36:39], a[244:247], v[44:51], v165 abid:1
v_smfmac_f32_16x16x64_bf16 v[40:43], a[248:251], v[44:51], v177
s_nop 7
ds_read_b128 v[44:47], v0 offset:14336
ds_read_b128 v[48:51], v1 offset:14336
s_waitcnt lgkmcnt(0)
v_smfmac_f32_16x16x64_bf16 v[8:11], a[252:255], v[44:51], v166
v_smfmac_f32_16x16x64_bf16 v[12:15], v[186:189], v[44:51], v166 abid:1
v_smfmac_f32_16x16x64_bf16 v[16:19], v[190:193], v[44:51], v167
v_smfmac_f32_16x16x64_bf16 v[20:23], v[194:197], v[44:51], v167 abid:1
v_smfmac_f32_16x16x64_bf16 v[24:27], v[198:201], v[44:51], v168
v_smfmac_f32_16x16x64_bf16 v[28:31], v[202:205], v[44:51], v168 abid:1
v_smfmac_f32_16x16x64_bf16 v[32:35], v[206:209], v[44:51], v169
v_smfmac_f32_16x16x64_bf16 v[36:39], v[210:213], v[44:51], v169 abid:1
v_smfmac_f32_16x16x64_bf16 v[40:43], v[214:217], v[44:51], v177 abid:1
s_nop 7
ds_read_b128 v[44:47], v0 offset:16384
ds_read_b128 v[48:51], v1 offset:16384
s_waitcnt lgkmcnt(0)
v_smfmac_f32_16x16x64_bf16 v[8:11], v[218:221], v[44:51], v170
v_smfmac_f32_16x16x64_bf16 v[12:15], v[222:225], v[44:51], v170 abid:1
v_smfmac_f32_16x16x64_bf16 v[16:19], v[226:229], v[44:51], v171
v_smfmac_f32_16x16x64_bf16 v[20:23], v[230:233], v[44:51], v171 abid:1
v_smfmac_f32_16x16x64_bf16 v[24:27], v[234:237], v[44:51], v172
v_smfmac_f32_16x16x64_bf16 v[28:31], v[238:241], v[44:51], v172 abid:1
v_smfmac_f32_16x16x64_bf16 v[32:35], v[242:245], v[44:51], v173
v_smfmac_f32_16x16x64_bf16 v[36:39], v[246:249], v[44:51], v173 abid:1
v_smfmac_f32_16x16x64_bf16 v[40:43], v[250:253], v[44:51], v178
s_nop 7
s_add_u32 s87, s87, 1
s_cmp_lt_u32 s87, 2
s_cbranch_scc1 L_spass
v_cvt_pk_bf16_f32 v92, v8, v9
v_cvt_pk_bf16_f32 v93, v10, v11
v_cvt_pk_bf16_f32 v94, v12, v13
v_cvt_pk_bf16_f32 v95, v14, v15
v_cvt_pk_bf16_f32 v96, v16, v17
v_cvt_pk_bf16_f32 v97, v18, v19
v_cvt_pk_bf16_f32 v98, v20, v21
v_cvt_pk_bf16_f32 v99, v22, v23
v_cvt_pk_bf16_f32 v100, v24, v25
v_cvt_pk_bf16_f32 v101, v26, v27
v_cvt_pk_bf16_f32 v102, v28, v29
v_cvt_pk_bf16_f32 v103, v30, v31
v_cvt_pk_bf16_f32 v104, v32, v33
v_cvt_pk_bf16_f32 v105, v34, v35
s_mov_b64 vcc, s[80:81]
s_nop 0
v_cndmask_b32_dpp v108, v96, v92, vcc quad_perm:[1,0,3,2] row_mask:0xf bank_mask:0xf
v_cndmask_b32_dpp v109, v97, v93, vcc quad_perm:[1,0,3,2] row_mask:0xf bank_mask:0xf
v_cndmask_b32_dpp v110, v98, v94, vcc quad_perm:[1,0,3,2] row_mask:0xf bank_mask:0xf
v_cndmask_b32_dpp v111, v99, v95, vcc quad_perm:[1,0,3,2] row_mask:0xf bank_mask:0xf
buffer_store_dwordx4 v[108:111], v4, s[20:23], s46 offen offset:0 sc1
s_mov_b64 vcc, s[82:83]
v_cvt_pk_bf16_f32 v112, v40, v41
v_cvt_pk_bf16_f32 v113, v42, v43
ds_write_b64 v254, v[112:113]
v_cndmask_b32_dpp v96, v92, v96, vcc quad_perm:[1,0,3,2] row_mask:0xf bank_mask:0xf
v_cndmask_b32_dpp v97, v93, v97, vcc quad_perm:[1,0,3,2] row_mask:0xf bank_mask:0xf
v_cndmask_b32_dpp v98, v94, v98, vcc quad_perm:[1,0,3,2] row_mask:0xf bank_mask:0xf
v_cndmask_b32_dpp v99, v95, v99, vcc quad_perm:[1,0,3,2] row_mask:0xf bank_mask:0xf
buffer_store_dwordx4 v[96:99], v4, s[20:23], s46 offen offset:1152 sc1
s_mov_b64 vcc, s[80:81]
v_cvt_pk_bf16_f32 v106, v36, v37
v_cvt_pk_bf16_f32 v107, v38, v39
s_waitcnt lgkmcnt(0)
s_barrier
ds_read_b64 v[112:113], v6
v_cndmask_b32_dpp v92, v104, v100, vcc quad_perm:[1,0,3,2] row_mask:0xf bank_mask:0xf
v_cndmask_b32_dpp v93, v105, v101, vcc quad_perm:[1,0,3,2] row_mask:0xf bank_mask:0xf
v_cndmask_b32_dpp v94, v106, v102, vcc quad_perm:[1,0,3,2] row_mask:0xf bank_mask:0xf
v_cndmask_b32_dpp v95, v107, v103, vcc quad_perm:[1,0,3,2] row_mask:0xf bank_mask:0xf
buffer_store_dwordx4 v[92:95], v4, s[20:23], s46 offen offset:128 sc1
s_mov_b64 vcc, s[82:83]
v_cndmask_b32_dpp v104, v100, v104, vcc quad_perm:[1,0,3,2] row_mask:0xf bank_mask:0xf
v_cndmask_b32_dpp v105, v101, v105, vcc quad_perm:[1,0,3,2] row_mask:0xf bank_mask:0xf
v_cndmask_b32_dpp v106, v102, v106, vcc quad_perm:[1,0,3,2] row_mask:0xf bank_mask:0xf
v_cndmask_b32_dpp v107, v103, v107, vcc quad_perm:[1,0,3,2] row_mask:0xf bank_mask:0xf
buffer_store_dwordx4 v[104:107], v4, s[20:23], s46 offen offset:1280 sc1
s_mov_b64 vcc, s[80:81]
s_waitcnt lgkmcnt(0)
buffer_store_dwordx2 v[112:113], v5, s[20:23], s46 offen sc1
s_cmp_eq_u32 s41, 15
s_cselect_b32 s13, -23574528, s13
s_add_u32 s45, s45, s13
s_add_u32 s7, s7, s13
s_add_u32 s46, s46, s13
s_mov_b32 s13, 4718592
s_add_u32 s41, s41, 1
s_cmp_lt_u32 s41, s15
s_cbranch_scc1 L_stile
s_branch L_fin
.section .rodata,"a"
.p2align 6
.amdhsa_kernel standalone__structured_sparse_n_m__ragged_kernel
  .amdhsa_next_free_vgpr 512
  .amdhsa_next_free_sgpr 102
  .amdhsa_accum_offset 256
  .amdhsa_group_segment_fixed_size 0
  .amdhsa_float_denorm_mode_32 3
  .amdhsa_kernarg_size 48
  .amdhsa_user_sgpr_count 2
  .amdhsa_user_sgpr_kernarg_segment_ptr 1
  .amdhsa_system_sgpr_workgroup_id_x 1
.end_amdhsa_kernel
```
